```python
import torch

def _softmax(x, axis=-1):
    return torch.softmax(x, dim=axis)

def _gelu(x):
    return torch.nn.functional.gelu(x, approximate='tanh')

def _silu(x):
    return torch.nn.functional.silu(x)

def _sigmoid(x):
    return torch.sigmoid(x)

def _layernorm(x, axis=-1, eps=1e-05):
    m = x.mean(dim=axis, keepdim=True)
    v = x.var(dim=axis, keepdim=True, unbiased=False)
    return (x - m) / torch.sqrt(v + eps)

def _scatter_add(tgt, idx, src, axis=0):
    return tgt.clone().index_add_(axis, idx, src)

def _segment_sum(src, seg, n):
    out = torch.zeros((n,) + src.shape[1:], dtype=src.dtype)
    return out.index_add_(0, seg, src)

def _pad(x, pw):
    flat = tuple((v for pair in reversed(pw) for v in pair))
    return torch.nn.functional.pad(x, flat)
kernel_name = 'standalone__tensor_product_equiv_tfn__graph'

def setup_inputs():

    _w = lambda a: (lambda t: t.to(torch.bfloat16) if t.is_floating_point() else t)(torch.as_tensor(a))
    N, deg, C, L, DE = (10000, 32, 128, 1, 16)
    E = N * deg
    M = (L + 1) ** 2
    src = (lambda lo, hi, *s: torch.randint(lo, hi, s))(0, N, E).to(torch.int64)
    dst = (lambda lo, hi, *s: torch.randint(lo, hi, s))(0, N, E).to(torch.int64)
    r = (lambda *s: torch.randn(*s, dtype=torch.bfloat16) * 0.05)(E, 3)
    r = r / (torch.linalg.norm(r, dim=-1, keepdim=True) + 1e-09)
    rx, ry, rz = (r[:, 0].clone(), r[:, 1].clone(), r[:, 2].clone())
    Ys = [torch.ones((E, 1), dtype=float)]
    if L >= 1:
        Ys.append(r.to(float))
    if L >= 2:
        Ys.append(torch.stack([2 * rx * ry, 2 * ry * rz, (3 * rz * rz - 1.0) / (lambda _x: torch.sqrt(torch.as_tensor(_x)))(3.0), 2 * rx * rz, rx * rx - ry * ry], dim=-1).to(float))
    for _l in range(3, L + 1):
        Ys.append(((lambda *s: torch.randn(*s, dtype=torch.bfloat16) * 0.05)(E, 2 * _l + 1) * 0.3).to(float))
    Y = torch.cat(Ys, dim=-1)
    cg = torch.zeros((M, M, M), dtype=float)
    off = [_l * _l for _l in range(L + 2)]
    for l1 in range(L + 1):
        for l2 in range(L + 1):
            for l3 in range(abs(l1 - l2), min(L, l1 + l2) + 1):
                d1, d2, d3 = (2 * l1 + 1, 2 * l2 + 1, 2 * l3 + 1)
                cg[off[l1]:off[l1 + 1], off[l2]:off[l2 + 1], off[l3]:off[l3 + 1]] = (lambda *s: torch.randn(*s, dtype=torch.bfloat16) * 0.05)(d1, d2, d3) / (lambda _x: torch.sqrt(torch.as_tensor(_x)))(float(d1 * d2))
    return {'x': _w((lambda *s: torch.randn(*s, dtype=torch.bfloat16) * 0.05)(N, C, M) * 0.2), 'src': _w(src), 'dst': _w(dst), 'Y': _w(Y), 'edge_feat': _w((lambda *s: torch.randn(*s, dtype=torch.bfloat16) * 0.05)(E, DE)), 'w_rad': _w((lambda *s: torch.randn(*s, dtype=torch.bfloat16) * 0.05)(DE, C) * (1.0 / max(1.0, DE) ** 0.5)), 'cg': _w(cg), 'w_mix': _w((lambda *s: torch.randn(*s, dtype=torch.bfloat16) * 0.05)(C, C) * (1.0 / max(1.0, C) ** 0.5))}

def reference(x, src, dst, Y, edge_feat, w_rad, cg, w_mix):
    N, C, M = (x.shape[0], x.shape[1], x.shape[2])
    R = _silu(edge_feat @ w_rad)
    xs = x[src]
    tp = torch.einsum('eci,ef,ifo->eco', xs, Y, cg)
    msg = R[:, :, None] * tp
    agg = _segment_sum(msg.reshape(-1, C * M), dst, N).reshape(N, C, M)
    return torch.einsum('ncm,cd->ndm', agg, w_mix)
```

```asm
; @launch kernel=tfn_bin_kernel grid=(256,1,1) block=(640,1,1) lds=83968
; @launch kernel=standalone__tensor_product_equiv_tfn__graph_kernel grid=(256,1,1) block=(512,1,1) lds=157184
.amdgcn_target "amdgcn-amd-amdhsa--gfx950"
.text
.globl tfn_bin_kernel
.p2align 8
.type tfn_bin_kernel,@function
tfn_bin_kernel:
    s_cmp_ge_u32 s2, 256
    s_cbranch_scc1 L1_end
    s_load_dwordx16 s[4:19], s[0:1], 0
    s_load_dwordx2 s[20:21], s[0:1], 80
    v_lshrrev_b32 v1, 6, v0
    v_lshlrev_b32 v2, 2, v0
    v_mov_b32 v3, 0
    v_readfirstlane_b32 s22, v1
    v_cmp_gt_u32 vcc, 256, v0
    s_and_saveexec_b64 s[32:33], vcc
    ds_write_b32 v2, v3 offset:61440
    s_mov_b64 exec, s[32:33]
    s_mul_i32 s34, s2, 5000
    s_mul_i32 s35, s2, 10000
    s_mul_i32 s36, s2, 40000
    v_lshl_add_u32 v4, v0, 3, s34
    v_lshlrev_b32 v6, 4, v0
    v_add_u32 v5, s35, v6
    v_cmp_gt_u32 vcc, 625, v0
    s_mov_b64 s[40:41], vcc
    s_lshl_b32 s37, s22, 10
    s_waitcnt lgkmcnt(0)
    s_mov_b64 exec, s[40:41]
    global_load_dwordx2 v[8:9], v4, s[8:9]
    global_load_dwordx2 v[10:11], v4, s[6:7]
    global_load_dwordx4 v[12:15], v5, s[10:11]
    s_mov_b64 exec, -1
    s_mov_b32 s24, s12
    s_mov_b32 s25, s13
    s_mov_b32 s26, 10240000
    s_mov_b32 s27, 0x00020000
    s_add_u32 m0, s37, 0
    s_add_u32 s38, s36, 0
    buffer_load_dwordx4 v6, s[24:27], s38 offen lds
    s_add_u32 m0, s37, 10240
    s_add_u32 s38, s36, 10240
    buffer_load_dwordx4 v6, s[24:27], s38 offen lds
    s_add_u32 m0, s37, 20480
    s_add_u32 s38, s36, 20480
    buffer_load_dwordx4 v6, s[24:27], s38 offen lds
    s_add_u32 m0, s37, 30720
    s_add_u32 s38, s36, 30720
    buffer_load_dwordx4 v6, s[24:27], s38 offen lds
    v_and_b32 v30, 63, v0
    s_waitcnt lgkmcnt(0)
    s_barrier
    v_mov_b32 v3, 1
    s_mov_b64 exec, s[40:41]
    s_waitcnt vmcnt(6)
    v_and_b32 v16, 7, v8
    v_bfe_u32 v18, v8, 3, 5
    v_lshl_add_u32 v16, v16, 5, v18
    v_lshlrev_b32 v16, 2, v16
    ds_add_rtn_u32 v18, v16, v3 offset:61440
    v_and_b32 v17, 7, v9
    v_bfe_u32 v19, v9, 3, 5
    v_lshl_add_u32 v17, v17, 5, v19
    v_lshlrev_b32 v17, 2, v17
    ds_add_rtn_u32 v19, v17, v3 offset:61440
    s_waitcnt vmcnt(4)
    v_lshlrev_b32 v20, 10, v10
    v_lshrrev_b32 v21, 8, v8
    v_lshrrev_b32 v22, 8, v10
    v_lshl_add_u32 v21, v21, 6, v22
    v_lshlrev_b32 v21, 2, v21
    v_lshl_add_u32 v22, v0, 1, 0
    v_lshl_add_u32 v21, v22, 16, v21
    v_mov_b32 v22, v12
    v_mov_b32 v23, v13
    v_lshlrev_b32 v24, 10, v11
    v_lshrrev_b32 v25, 8, v9
    v_lshrrev_b32 v26, 8, v11
    v_lshl_add_u32 v25, v25, 6, v26
    v_lshlrev_b32 v25, 2, v25
    v_lshl_add_u32 v26, v0, 1, 1
    v_lshl_add_u32 v25, v26, 16, v25
    v_mov_b32 v26, v14
    v_mov_b32 v27, v15
    s_mov_b64 exec, -1
    v_lshlrev_b32 v31, 4, v30
    s_waitcnt lgkmcnt(0)
    s_barrier
    ds_read_b128 v[32:35], v31 offset:61440
    s_waitcnt lgkmcnt(0)
    v_add_u32 v36, v32, v33
    v_add3_u32 v36, v36, v34, v35
    v_mov_b32 v37, v36
    s_nop 1
    v_add_u32_dpp v37, v37, v37 row_shr:1 row_mask:0xf bank_mask:0xf
    s_nop 1
    v_add_u32_dpp v37, v37, v37 row_shr:2 row_mask:0xf bank_mask:0xf
    s_nop 1
    v_add_u32_dpp v37, v37, v37 row_shr:4 row_mask:0xf bank_mask:0xf
    s_nop 1
    v_add_u32_dpp v37, v37, v37 row_shr:8 row_mask:0xf bank_mask:0xf
    s_nop 1
    v_add_u32_dpp v37, v37, v37 row_bcast:15 row_mask:0xa bank_mask:0xf
    s_nop 1
    v_add_u32_dpp v37, v37, v37 row_bcast:31 row_mask:0xc bank_mask:0xf
    v_sub_u32 v40, v37, v36
    v_add_u32 v41, v40, v32
    v_add_u32 v42, v41, v33
    v_add_u32 v43, v42, v34
    ds_write_b128 v31, v[40:43] offset:62464
    s_mov_b64 exec, s[40:41]
    s_waitcnt lgkmcnt(0)
    ds_read_b32 v28, v16 offset:62464
    ds_read_b32 v29, v17 offset:62464
    s_waitcnt lgkmcnt(1)
    v_add_lshl_u32 v28, v28, v18, 4
    ds_write_b128 v28, v[20:23] offset:40960
    s_waitcnt lgkmcnt(1)
    v_add_lshl_u32 v29, v29, v19, 4
    ds_write_b128 v29, v[24:27] offset:40960
    s_mov_b64 exec, -1
    s_cmp_lt_u32 s22, 4
    s_cbranch_scc0 L1_notab
    s_set_gpr_idx_on s22, gpr_idx(SRC0)
    v_mov_b32 v44, v32
    v_mov_b32 v45, v40
    s_set_gpr_idx_off
    s_mul_i32 s3, s2, 1280
    v_add_u32 v45, s3, v45
    v_lshl_add_u32 v47, v44, 19, v45
    v_lshl_add_u32 v46, v30, 2, s22
    v_and_b32 v48, 31, v46
    v_lshrrev_b32 v46, 5, v46
    v_lshl_add_u32 v46, v48, 3, v46
    s_and_b32 s3, s2, 7
    s_lshl_b32 s3, s3, 5
    s_lshr_b32 s38, s2, 3
    s_add_u32 s3, s3, s38
    s_lshl_b32 s3, s3, 2
    v_lshl_add_u32 v46, v46, 10, s3
    global_store_dword v46, v47, s[20:21]
L1_notab:
    s_waitcnt lgkmcnt(0)
    s_barrier
    ds_read_b128 v[8:11], v6 offset:40960
    ds_read_b128 v[12:15], v6 offset:51200
    v_lshrrev_b32 v7, 1, v0
    v_lshlrev_b32 v7, 4, v7
    ds_read_u16 v16, v7 offset:40966
    ds_read_u16 v17, v7 offset:46086
    ds_read_u16 v18, v7 offset:51206
    ds_read_u16 v19, v7 offset:56326
    s_mul_i32 s3, s2, 20480
    s_add_u32 s3, s3, 1048576
    v_add_u32 v4, s3, v6
    v_add_u32 v5, 10240, v4
    v_cmp_gt_u32 vcc, 610, v0
    v_and_b32 v20, 16, v6
    s_waitcnt lgkmcnt(5)
    global_store_dwordx4 v4, v[8:11], s[20:21]
    s_waitcnt lgkmcnt(4)
    s_and_saveexec_b64 s[32:33], vcc
    global_store_dwordx4 v5, v[12:15], s[20:21]
    s_mov_b64 exec, -1
    s_waitcnt lgkmcnt(0)
    v_and_b32 v16, 0x7ff, v16
    v_lshl_add_u32 v16, v16, 5, v20
    v_and_b32 v17, 0x7ff, v17
    v_lshl_add_u32 v17, v17, 5, v20
    v_and_b32 v18, 0x7ff, v18
    v_lshl_add_u32 v18, v18, 5, v20
    v_and_b32 v19, 0x7ff, v19
    v_lshl_add_u32 v19, v19, 5, v20
    s_mov_b32 s39, 0
    v_mov_b32 v40, 0
    s_lshl_b32 s3, s2, 6
    v_add_u32 v31, s3, v30
    s_cmp_eq_u32 s22, 4
    s_cbranch_scc0 L1_nomix
    v_bfe_u32 v32, v31, 10, 2
    v_lshlrev_b32 v32, 5, v32
    v_bfe_u32 v33, v31, 7, 2
    v_lshl_add_u32 v32, v33, 3, v32
    v_and_b32 v33, 7, v31
    v_add_u32 v32, v32, v33
    v_bfe_u32 v33, v31, 12, 2
    v_lshlrev_b32 v33, 5, v33
    v_bfe_u32 v34, v31, 3, 4
    v_lshl_add_u32 v33, v34, 1, v33
    v_bfe_u32 v34, v31, 9, 1
    v_add_u32 v33, v33, v34
    v_lshl_add_u32 v32, v32, 7, v33
    v_lshlrev_b32 v32, 1, v32
    global_load_ushort v41, v32, s[18:19]
    v_lshlrev_b32 v40, 1, v31
    v_add_u32 v40, 278528, v40
    s_mov_b32 s39, 1
L1_nomix:
    s_cmp_eq_u32 s22, 5
    s_cbranch_scc0 L1_now
    s_cmp_lt_u32 s2, 32
    s_cbranch_scc0 L1_now
    v_bfe_u32 v32, v31, 8, 1
    v_and_b32 v33, 7, v31
    v_lshl_add_u32 v32, v32, 3, v33
    v_bfe_u32 v33, v31, 9, 1
    v_bfe_u32 v34, v31, 3, 5
    v_lshl_add_u32 v33, v33, 5, v34
    v_bfe_u32 v34, v31, 10, 1
    v_lshl_add_u32 v33, v33, 1, v34
    v_lshl_add_u32 v32, v32, 7, v33
    v_lshlrev_b32 v32, 1, v32
    global_load_ushort v41, v32, s[14:15]
    v_lshlrev_b32 v40, 1, v31
    v_add_u32 v40, 262144, v40
    s_mov_b32 s39, 2
L1_now:
    s_cmp_eq_u32 s22, 6
    s_cbranch_scc0 L1_nocg
    s_cmp_eq_u32 s2, 0
    s_cbranch_scc0 L1_nocg
    v_and_b32 v32, 0x30, v30
    v_and_b32 v33, 3, v30
    v_lshl_add_u32 v32, v33, 2, v32
    v_bfe_u32 v33, v30, 2, 2
    v_add_u32 v32, v32, v33
    v_lshlrev_b32 v32, 1, v32
    global_load_ushort v41, v32, s[16:17]
    v_lshlrev_b32 v40, 1, v30
    v_add_u32 v40, 270336, v40
    s_mov_b32 s39, 1
L1_nocg:
    s_mul_i32 s3, s2, 40960
    s_add_u32 s3, s3, 8388608
    v_add_u32 v4, s3, v6
    v_cmp_gt_u32 vcc, 580, v0
    s_waitcnt vmcnt(0)
    s_barrier
    ds_read_b128 v[24:27], v16 offset:0
    ds_read_b128 v[28:31], v17 offset:0
    ds_read_b128 v[32:35], v18 offset:0
    ds_read_b128 v[36:39], v19 offset:0
    s_cmp_eq_u32 s39, 0
    s_cbranch_scc1 L1_nost
    s_cmp_eq_u32 s39, 1
    s_cbranch_scc1 L1_st1
    v_lshlrev_b32 v42, 16, v41
    v_mul_f32 v42, 0xbfb8aa3b, v42
    v_cvt_pk_bf16_f32 v41, v42, v42
    v_lshlrev_b32 v43, 16, v41
    v_sub_f32 v43, v42, v43
    v_cvt_pk_bf16_f32 v43, v43, v43
    v_add_u32 v44, 4096, v40
    global_store_short v44, v43, s[20:21]
L1_st1:
    global_store_short v40, v41, s[20:21]
L1_nost:
    s_mov_b32 s28, s4
    s_mov_b32 s29, s5
    s_mov_b32 s30, 10240000
    s_mov_b32 s31, 0x00020000
    s_mul_i32 s3, s2, 40064
    v_lshlrev_b32 v21, 7, v0
    s_cmp_lt_u32 s22, 5
    s_cbranch_scc0 L1_nopf
    buffer_load_dword v22, v21, s[28:31], s3 offen
L1_nopf:
    s_waitcnt lgkmcnt(3)
    global_store_dwordx4 v4, v[24:27], s[20:21]
    v_add_u32 v4, 10240, v4
    s_waitcnt lgkmcnt(2)
    global_store_dwordx4 v4, v[28:31], s[20:21]
    v_add_u32 v4, 10240, v4
    s_waitcnt lgkmcnt(1)
    global_store_dwordx4 v4, v[32:35], s[20:21]
    v_add_u32 v4, 10240, v4
    s_waitcnt lgkmcnt(0)
    s_and_saveexec_b64 s[32:33], vcc
    global_store_dwordx4 v4, v[36:39], s[20:21]
L1_end:
    s_endpgm
.globl standalone__tensor_product_equiv_tfn__graph_kernel
.p2align 8
.type standalone__tensor_product_equiv_tfn__graph_kernel,@function
standalone__tensor_product_equiv_tfn__graph_kernel:
    s_cmp_ge_u32 s2, 256
    s_cbranch_scc1 L2_end
    s_load_dwordx2 s[4:5], s[0:1], 0
    s_load_dwordx2 s[6:7], s[0:1], 64
    s_load_dwordx2 s[8:9], s[0:1], 80
    v_lshrrev_b32 v116, 6, v0
    v_and_b32 v11, 63, v0
    v_lshlrev_b32 v1, 4, v11
    v_readfirstlane_b32 s10, v116
    s_lshl_b32 s3, s2, 10
    v_add_u32 v117, s3, v1
    v_mov_b32 v68, 0
    v_mov_b32 v69, 0
    v_mov_b32 v70, 0
    v_mov_b32 v71, 0
    v_mov_b32 v72, 0
    v_mov_b32 v73, 0
    v_mov_b32 v74, 0
    v_mov_b32 v75, 0
    v_mov_b32 v76, 0
    v_mov_b32 v77, 0
    v_mov_b32 v78, 0
    v_mov_b32 v79, 0
    v_mov_b32 v80, 0
    v_mov_b32 v81, 0
    v_mov_b32 v82, 0
    v_mov_b32 v83, 0
    v_mov_b32 v84, 0
    v_mov_b32 v85, 0
    v_mov_b32 v86, 0
    v_mov_b32 v87, 0
    v_mov_b32 v88, 0
    v_mov_b32 v89, 0
    v_mov_b32 v90, 0
    v_mov_b32 v91, 0
    v_mov_b32 v92, 0
    v_mov_b32 v93, 0
    v_mov_b32 v94, 0
    v_mov_b32 v95, 0
    v_mov_b32 v96, 0
    v_mov_b32 v97, 0
    v_mov_b32 v98, 0
    v_mov_b32 v99, 0
    v_mov_b32 v100, 0
    v_mov_b32 v101, 0
    v_mov_b32 v102, 0
    v_mov_b32 v103, 0
    v_mov_b32 v104, 0
    v_mov_b32 v105, 0
    v_mov_b32 v106, 0
    v_mov_b32 v107, 0
    v_mov_b32 v108, 0
    v_mov_b32 v109, 0
    v_mov_b32 v110, 0
    v_mov_b32 v111, 0
    v_mov_b32 v112, 0
    v_mov_b32 v113, 0
    v_mov_b32 v114, 0
    v_mov_b32 v115, 0
    v_mov_b32 v24, 0
    v_mov_b32 v25, 0
    v_mov_b32 v26, 0
    v_mov_b32 v27, 0
    v_mov_b32 v28, 0
    v_mov_b32 v29, 0
    v_mov_b32 v30, 0
    v_mov_b32 v31, 0
    s_mov_b32 s32, 0x0f0f0f0f
    s_mov_b32 s33, 0x0f0f0f0f
    s_mov_b32 s34, 0xf0f0f0f0
    s_mov_b32 s35, 0xf0f0f0f0
    v_lshrrev_b32 v2, 5, v11
    v_lshlrev_b32 v2, 4, v2
    v_and_b32 v3, 3, v11
    v_lshlrev_b32 v3, 3, v3
    s_mov_b32 s28, 0
    s_waitcnt lgkmcnt(0)
    global_load_dwordx4 v[120:123], v117, s[8:9]
    v_add_u32 v118, 262144, v1
    global_load_dwordx4 v[36:39], v118, s[8:9] offset:0
    global_load_dwordx4 v[40:43], v118, s[8:9] offset:1024
    global_load_dwordx4 v[44:47], v118, s[8:9] offset:2048
    global_load_dwordx4 v[48:51], v118, s[8:9] offset:3072
    v_add_u32 v118, 4096, v118
    global_load_dwordx4 v[52:55], v118, s[8:9] offset:0
    global_load_dwordx4 v[56:59], v118, s[8:9] offset:1024
    global_load_dwordx4 v[60:63], v118, s[8:9] offset:2048
    global_load_dwordx4 v[64:67], v118, s[8:9] offset:3072
    s_mov_b32 s12, s4
    s_mov_b32 s13, s5
    s_mov_b32 s14, 10240000
    s_mov_b32 s15, 0x00020000
    s_add_u32 s16, s8, 1048576
    s_addc_u32 s17, s9, 0
    s_mov_b32 s18, 5242880
    s_mov_b32 s19, 0x00020000
    s_add_u32 s20, s8, 8388608
    s_addc_u32 s21, s9, 0
    s_mov_b32 s22, 10485760
    s_mov_b32 s23, 0x00020000
    s_mov_b32 s24, s6
    s_mov_b32 s25, s7
    s_mov_b32 s26, 10240000
    s_mov_b32 s27, 0x00020000
    s_branch L2_round1
L2_round:
    s_lshl_b32 s3, s2, 10
    v_add_u32 v117, s3, v1
    s_waitcnt vmcnt(0)
    global_load_dwordx4 v[120:123], v117, s[8:9]
    s_waitcnt vmcnt(0) lgkmcnt(0)
    s_barrier
L2_round1:
    s_add_u32 s68, s8, 270336
    s_addc_u32 s69, s9, 0
    s_load_dwordx16 s[36:51], s[68:69], 0
    s_load_dwordx16 s[52:67], s[68:69], 64
    v_mov_b32 v124, 0
    v_mov_b32 v125, 0
    v_mov_b32 v126, 0
    v_mov_b32 v127, 0
    v_lshlrev_b32 v118, 4, v0
    v_add_u32 v118, 111104, v118
    ds_write_b128 v118, v[124:127]
    s_cmp_lt_u32 s10, 2
    s_cbranch_scc0 L2_z1
    ds_write_b128 v118, v[124:127] offset:8192
L2_z1:
    v_mov_b32 v119, 110080
    ds_write_b32 v119, v124
    s_waitcnt vmcnt(8)
    v_lshrrev_b32 v124, 19, v120
    v_and_b32 v120, 0x7ffff, v120
    v_lshrrev_b32 v125, 19, v121
    v_and_b32 v121, 0x7ffff, v121
    v_lshrrev_b32 v126, 19, v122
    v_and_b32 v122, 0x7ffff, v122
    v_lshrrev_b32 v127, 19, v123
    v_and_b32 v123, 0x7ffff, v123
    v_add_u32 v132, v124, v125
    v_add3_u32 v132, v132, v126, v127
    v_mov_b32 v133, v132
    s_nop 1
    v_add_u32_dpp v133, v133, v133 row_shr:1 row_mask:0xf bank_mask:0xf
    s_nop 1
    v_add_u32_dpp v133, v133, v133 row_shr:2 row_mask:0xf bank_mask:0xf
    s_nop 1
    v_add_u32_dpp v133, v133, v133 row_shr:4 row_mask:0xf bank_mask:0xf
    s_nop 1
    v_add_u32_dpp v133, v133, v133 row_shr:8 row_mask:0xf bank_mask:0xf
    s_nop 1
    v_add_u32_dpp v133, v133, v133 row_bcast:15 row_mask:0xa bank_mask:0xf
    s_nop 1
    v_add_u32_dpp v133, v133, v133 row_bcast:31 row_mask:0xc bank_mask:0xf
    v_sub_u32 v128, v133, v132
    v_readlane_b32 s11, v133, 63
    v_add_u32 v129, v128, v124
    v_add_u32 v130, v129, v125
    v_add_u32 v131, v130, v126
    s_and_b32 s3, s10, 3
    s_lshr_b32 s31, s10, 2
    s_set_gpr_idx_on s3, gpr_idx(SRC0)
    v_mov_b32 v134, v120
    v_mov_b32 v135, v124
    v_mov_b32 v136, v128
    s_set_gpr_idx_off
    v_add_u32 v134, s31, v134
    v_subrev_u32 v136, s28, v136
    v_add_u32 v136, s31, v136
    s_movk_i32 s68, 1536
    s_mov_b32 s69, 121344
L2_exp:
    v_cmp_lt_u32 vcc, s31, v135
    s_cbranch_vccz L2_expd
    v_cmp_gt_u32 s[70:71], s68, v136
    v_lshl_add_u32 v137, v136, 2, s69
    s_and_b64 exec, vcc, s[70:71]
    ds_write_b32 v137, v134
    s_mov_b64 exec, -1
    v_add_u32 v134, 2, v134
    v_add_u32 v136, 2, v136
    s_add_u32 s31, s31, 2
    s_branch L2_exp
L2_expd:
    s_sub_u32 s29, s11, s28
    s_min_u32 s29, s29, 1536
    v_lshl_add_u32 v118, v0, 2, s69
    v_lshrrev_b32 v119, 1, v0
    v_lshl_add_u32 v120, v119, 2, s69
    s_waitcnt lgkmcnt(0)
    s_barrier
    ds_read_b32 v124, v118 offset:0
    ds_read_b32 v125, v118 offset:2048
    ds_read_b32 v126, v118 offset:4096
    ds_read_b32 v128, v120 offset:0
    ds_read_b32 v129, v120 offset:1024
    ds_read_b32 v130, v120 offset:2048
    ds_read_b32 v131, v120 offset:3072
    ds_read_b32 v132, v120 offset:4096
    ds_read_b32 v133, v120 offset:5120
    v_mov_b32 v121, 0x7ffffff0
    v_lshlrev_b32 v122, 4, v0
    v_and_b32 v122, 16, v122
    v_add_u32 v123, 0, v0
    v_cmp_gt_u32 s[70:71], s29, v123
    s_waitcnt lgkmcnt(8)
    v_lshlrev_b32 v124, 4, v124
    v_cndmask_b32 v124, v121, v124, s[70:71]
    buffer_load_dwordx4 v[136:139], v124, s[16:19], 0 offen
    v_add_u32 v123, 512, v0
    v_cmp_gt_u32 s[92:93], s29, v123
    s_waitcnt lgkmcnt(7)
    v_lshlrev_b32 v125, 4, v125
    v_cndmask_b32 v125, v121, v125, s[92:93]
    buffer_load_dwordx4 v[140:143], v125, s[16:19], 0 offen
    v_add_u32 v123, 1024, v0
    v_cmp_gt_u32 s[94:95], s29, v123
    s_waitcnt lgkmcnt(6)
    v_lshlrev_b32 v126, 4, v126
    v_cndmask_b32 v126, v121, v126, s[94:95]
    buffer_load_dwordx4 v[144:147], v126, s[16:19], 0 offen
    s_lshl_b32 s3, s10, 10
    v_add_u32 v123, 0, v119
    v_cmp_gt_u32 vcc, s29, v123
    s_add_u32 m0, s3, 0
    s_waitcnt lgkmcnt(5)
    v_lshl_add_u32 v128, v128, 5, v122
    v_cndmask_b32 v128, v121, v128, vcc
    buffer_load_dwordx4 v128, s[20:23], 0 offen lds
    v_add_u32 v123, 256, v119
    v_cmp_gt_u32 vcc, s29, v123
    s_add_u32 m0, s3, 8192
    s_waitcnt lgkmcnt(4)
    v_lshl_add_u32 v129, v129, 5, v122
    v_cndmask_b32 v129, v121, v129, vcc
    buffer_load_dwordx4 v129, s[20:23], 0 offen lds
    v_add_u32 v123, 512, v119
    v_cmp_gt_u32 vcc, s29, v123
    s_add_u32 m0, s3, 16384
    s_waitcnt lgkmcnt(3)
    v_lshl_add_u32 v130, v130, 5, v122
    v_cndmask_b32 v130, v121, v130, vcc
    buffer_load_dwordx4 v130, s[20:23], 0 offen lds
    v_add_u32 v123, 768, v119
    v_cmp_gt_u32 vcc, s29, v123
    s_add_u32 m0, s3, 24576
    s_waitcnt lgkmcnt(2)
    v_lshl_add_u32 v131, v131, 5, v122
    v_cndmask_b32 v131, v121, v131, vcc
    buffer_load_dwordx4 v131, s[20:23], 0 offen lds
    v_add_u32 v123, 1024, v119
    v_cmp_gt_u32 vcc, s29, v123
    s_add_u32 m0, s3, 32768
    s_waitcnt lgkmcnt(1)
    v_lshl_add_u32 v132, v132, 5, v122
    v_cndmask_b32 v132, v121, v132, vcc
    buffer_load_dwordx4 v132, s[20:23], 0 offen lds
    v_add_u32 v123, 1280, v119
    v_cmp_gt_u32 vcc, s29, v123
    s_add_u32 m0, s3, 40960
    s_waitcnt lgkmcnt(0)
    v_lshl_add_u32 v133, v133, 5, v122
    v_cndmask_b32 v133, v121, v133, vcc
    buffer_load_dwordx4 v133, s[20:23], 0 offen lds
    v_mov_b32 v121, 1
    s_mov_b32 s3, 111104
    s_waitcnt vmcnt(8)
    v_and_b32 v137, 0xffff, v137
    v_add_u32 v137, s3, v137
    s_mov_b64 exec, s[70:71]
    ds_add_rtn_u32 v124, v137, v121
    s_mov_b64 exec, -1
    s_waitcnt vmcnt(7)
    v_and_b32 v141, 0xffff, v141
    v_add_u32 v141, s3, v141
    s_mov_b64 exec, s[92:93]
    ds_add_rtn_u32 v125, v141, v121
    s_mov_b64 exec, -1
    s_waitcnt vmcnt(6)
    v_and_b32 v145, 0xffff, v145
    v_add_u32 v145, s3, v145
    s_mov_b64 exec, s[94:95]
    ds_add_rtn_u32 v126, v145, v121
    s_mov_b64 exec, -1
    s_lshl_b32 s31, s10, 8
    s_add_u32 s31, s31, s3
    v_lshl_add_u32 v118, v11, 2, s31
    s_waitcnt lgkmcnt(0)
    s_barrier
    ds_read_b32 v128, v118 offset:0
    ds_read_b32 v129, v118 offset:2048
    ds_read_b32 v130, v118 offset:4096
    ds_read_b32 v131, v118 offset:6144
    ds_read_b32 v132, v118 offset:8192
    s_waitcnt lgkmcnt(0)
    v_add3_u32 v133, v128, v129, v130
    v_add3_u32 v133, v133, v131, v132
    v_mov_b32 v134, v133
    s_nop 1
    v_add_u32_dpp v134, v134, v134 row_shr:1 row_mask:0xf bank_mask:0xf
    s_nop 1
    v_add_u32_dpp v134, v134, v134 row_shr:2 row_mask:0xf bank_mask:0xf
    s_nop 1
    v_add_u32_dpp v134, v134, v134 row_shr:4 row_mask:0xf bank_mask:0xf
    s_nop 1
    v_add_u32_dpp v134, v134, v134 row_shr:8 row_mask:0xf bank_mask:0xf
    s_nop 1
    v_add_u32_dpp v134, v134, v134 row_bcast:15 row_mask:0xa bank_mask:0xf
    s_nop 1
    v_add_u32_dpp v134, v134, v134 row_bcast:31 row_mask:0xc bank_mask:0xf
    v_mov_b32 v119, 110080
    v_add_u32 v135, 48, v134
    v_readlane_b32 s29, v134, 63
    s_mov_b32 exec_lo, 0
    s_brev_b32 exec_hi, 1
    ds_add_rtn_u32 v135, v119, v135
    s_mov_b64 exec, -1
    v_sub_u32 v134, v134, v133
    s_waitcnt lgkmcnt(0)
    v_readlane_b32 s30, v135, 63
    s_nop 1
    v_add_u32 v134, s30, v134
    ds_write_b32 v118, v134 offset:0
    s_mov_b32 s3, 524288
    v_add3_u32 v134, v134, v128, s3
    ds_write_b32 v118, v134 offset:2048
    s_mov_b32 s3, 524288
    v_add3_u32 v134, v134, v129, s3
    ds_write_b32 v118, v134 offset:4096
    s_mov_b32 s3, 524288
    v_add3_u32 v134, v134, v130, s3
    ds_write_b32 v118, v134 offset:6144
    s_mov_b32 s3, 524288
    v_add3_u32 v134, v134, v131, s3
    ds_write_b32 v118, v134 offset:8192
    s_add_u32 s3, s30, s29
    s_lshl_b32 s3, s3, 2
    s_add_u32 s3, s3, 98304
    v_lshl_add_u32 v119, v11, 2, s3
    v_mov_b32 v120, 2147482664
    s_mov_b32 exec_hi, 0xffff
    ds_write_b32 v119, v120
    s_mov_b64 exec, -1
    v_and_b32 v119, 15, v11
    v_add_u32 v119, s30, v119
    v_lshlrev_b32 v119, 2, v119
    v_add_u32 v4, 98304, v119
    v_bfe_u32 v119, v11, 3, 2
    v_and_b32 v120, 3, v11
    v_lshl_add_u32 v119, v119, 2, v120
    v_add_u32 v119, s30, v119
    v_lshlrev_b32 v119, 1, v119
    v_add_u32 v5, 105984, v119
    v_lshrrev_b32 v119, 2, v11
    v_add_u32 v119, s30, v119
    v_lshlrev_b32 v119, 1, v119
    v_add_u32 v6, 105984, v119
    s_waitcnt lgkmcnt(0)
    s_barrier
    ds_read_b32 v128, v137
    ds_read_b32 v129, v141
    ds_read_b32 v130, v145
    s_mov_b32 s3, 98304
    s_mov_b32 s31, 105984
    v_add_u32 v123, 0, v0
    v_lshlrev_b32 v123, 5, v123
    s_waitcnt lgkmcnt(2)
    v_and_b32 v131, 0xffff, v128
    v_add_u32 v131, v131, v124
    v_lshrrev_b32 v132, 16, v128
    v_or_b32 v132, v132, v136
    v_lshl_add_u32 v133, v131, 2, s3
    v_lshl_add_u32 v131, v131, 1, s31
    s_mov_b64 exec, s[70:71]
    ds_write_b32 v133, v132
    ds_write_b16 v131, v123
    s_mov_b64 exec, -1
    v_add_u32 v123, 512, v0
    v_lshlrev_b32 v123, 5, v123
    s_waitcnt lgkmcnt(3)
    v_and_b32 v131, 0xffff, v129
    v_add_u32 v131, v131, v125
    v_lshrrev_b32 v132, 16, v129
    v_or_b32 v132, v132, v140
    v_lshl_add_u32 v133, v131, 2, s3
    v_lshl_add_u32 v131, v131, 1, s31
    s_mov_b64 exec, s[92:93]
    ds_write_b32 v133, v132
    ds_write_b16 v131, v123
    s_mov_b64 exec, -1
    v_add_u32 v123, 1024, v0
    v_lshlrev_b32 v123, 5, v123
    s_waitcnt lgkmcnt(4)
    v_and_b32 v131, 0xffff, v130
    v_add_u32 v131, v131, v126
    v_lshrrev_b32 v132, 16, v130
    v_or_b32 v132, v132, v144
    v_lshl_add_u32 v133, v131, 2, s3
    v_lshl_add_u32 v131, v131, 1, s31
    s_mov_b64 exec, s[94:95]
    ds_write_b32 v133, v132
    ds_write_b16 v131, v123
    s_mov_b64 exec, -1
    s_waitcnt lgkmcnt(0)
    s_barrier
    ds_read_b32 v118, v4
    ds_read_b32 v7, v4 offset:64
    ds_read_u16 v9, v5
    ds_read_u16 v10, v6
    s_waitcnt lgkmcnt(0)
    v_readlane_b32 s68, v118, 0
    s_and_b32 s68, s68, 0xfffffc00
    buffer_load_dwordx4 v[180:183], v1, s[12:15], s68 offen
    v_readlane_b32 s69, v118, 1
    s_and_b32 s69, s69, 0xfffffc00
    buffer_load_dwordx4 v[184:187], v1, s[12:15], s69 offen
    v_readlane_b32 s68, v118, 2
    s_and_b32 s68, s68, 0xfffffc00
    buffer_load_dwordx4 v[188:191], v1, s[12:15], s68 offen
    v_readlane_b32 s69, v118, 3
    s_and_b32 s69, s69, 0xfffffc00
    buffer_load_dwordx4 v[192:195], v1, s[12:15], s69 offen
    v_readlane_b32 s68, v118, 4
    s_and_b32 s68, s68, 0xfffffc00
    buffer_load_dwordx4 v[196:199], v1, s[12:15], s68 offen
    v_readlane_b32 s69, v118, 5
    s_and_b32 s69, s69, 0xfffffc00
    buffer_load_dwordx4 v[200:203], v1, s[12:15], s69 offen
    v_readlane_b32 s68, v118, 6
    s_and_b32 s68, s68, 0xfffffc00
    buffer_load_dwordx4 v[204:207], v1, s[12:15], s68 offen
    v_readlane_b32 s69, v118, 7
    s_and_b32 s69, s69, 0xfffffc00
    buffer_load_dwordx4 v[208:211], v1, s[12:15], s69 offen
    v_readlane_b32 s68, v118, 8
    s_and_b32 s68, s68, 0xfffffc00
    buffer_load_dwordx4 v[212:215], v1, s[12:15], s68 offen
    v_readlane_b32 s69, v118, 9
    s_and_b32 s69, s69, 0xfffffc00
    buffer_load_dwordx4 v[216:219], v1, s[12:15], s69 offen
    v_readlane_b32 s68, v118, 10
    s_and_b32 s68, s68, 0xfffffc00
    buffer_load_dwordx4 v[220:223], v1, s[12:15], s68 offen
    v_readlane_b32 s69, v118, 11
    s_and_b32 s69, s69, 0xfffffc00
    buffer_load_dwordx4 v[224:227], v1, s[12:15], s69 offen
    v_readlane_b32 s68, v118, 12
    s_and_b32 s68, s68, 0xfffffc00
    buffer_load_dwordx4 v[228:231], v1, s[12:15], s68 offen
    v_readlane_b32 s69, v118, 13
    s_and_b32 s69, s69, 0xfffffc00
    buffer_load_dwordx4 v[232:235], v1, s[12:15], s69 offen
    v_readlane_b32 s68, v118, 14
    s_and_b32 s68, s68, 0xfffffc00
    buffer_load_dwordx4 v[236:239], v1, s[12:15], s68 offen
    v_readlane_b32 s69, v118, 15
    s_and_b32 s69, s69, 0xfffffc00
    buffer_load_dwordx4 v[240:243], v1, s[12:15], s69 offen
    v_lshlrev_b32 v119, 5, v0
    v_add_u32 v119, 49152, v119
    v_dot2_f32_bf16 v148, v138, s36, 0
    v_dot2_f32_bf16 v152, v138, s38, 0
    v_dot2_f32_bf16 v156, v138, s40, 0
    v_dot2_f32_bf16 v160, v138, s42, 0
    v_dot2_f32_bf16 v149, v138, s44, 0
    v_dot2_f32_bf16 v153, v138, s46, 0
    v_dot2_f32_bf16 v157, v138, s48, 0
    v_dot2_f32_bf16 v161, v138, s50, 0
    v_dot2_f32_bf16 v150, v138, s52, 0
    v_dot2_f32_bf16 v154, v138, s54, 0
    v_dot2_f32_bf16 v158, v138, s56, 0
    v_dot2_f32_bf16 v162, v138, s58, 0
    v_dot2_f32_bf16 v151, v138, s60, 0
    v_dot2_f32_bf16 v155, v138, s62, 0
    v_dot2_f32_bf16 v159, v138, s64, 0
    v_dot2_f32_bf16 v163, v138, s66, 0
    v_dot2_f32_bf16 v148, v139, s37, v148
    v_dot2_f32_bf16 v152, v139, s39, v152
    v_dot2_f32_bf16 v156, v139, s41, v156
    v_dot2_f32_bf16 v160, v139, s43, v160
    v_dot2_f32_bf16 v149, v139, s45, v149
    v_dot2_f32_bf16 v153, v139, s47, v153
    v_dot2_f32_bf16 v157, v139, s49, v157
    v_dot2_f32_bf16 v161, v139, s51, v161
    v_dot2_f32_bf16 v150, v139, s53, v150
    v_dot2_f32_bf16 v154, v139, s55, v154
    v_dot2_f32_bf16 v158, v139, s57, v158
    v_dot2_f32_bf16 v162, v139, s59, v162
    v_dot2_f32_bf16 v151, v139, s61, v151
    v_dot2_f32_bf16 v155, v139, s63, v155
    v_dot2_f32_bf16 v159, v139, s65, v159
    v_dot2_f32_bf16 v163, v139, s67, v163
    s_nop 1
    v_cvt_pk_bf16_f32 v164, v148, v149
    v_cvt_pk_bf16_f32 v165, v150, v151
    v_cvt_pk_bf16_f32 v166, v152, v153
    v_cvt_pk_bf16_f32 v167, v154, v155
    v_cvt_pk_bf16_f32 v168, v156, v157
    v_cvt_pk_bf16_f32 v169, v158, v159
    v_cvt_pk_bf16_f32 v170, v160, v161
    v_cvt_pk_bf16_f32 v171, v162, v163
    ds_write_b128 v119, v[164:167] offset:0
    ds_write_b128 v119, v[168:171] offset:16
    v_dot2_f32_bf16 v148, v142, s36, 0
    v_dot2_f32_bf16 v152, v142, s38, 0
    v_dot2_f32_bf16 v156, v142, s40, 0
    v_dot2_f32_bf16 v160, v142, s42, 0
    v_dot2_f32_bf16 v149, v142, s44, 0
    v_dot2_f32_bf16 v153, v142, s46, 0
    v_dot2_f32_bf16 v157, v142, s48, 0
    v_dot2_f32_bf16 v161, v142, s50, 0
    v_dot2_f32_bf16 v150, v142, s52, 0
    v_dot2_f32_bf16 v154, v142, s54, 0
    v_dot2_f32_bf16 v158, v142, s56, 0
    v_dot2_f32_bf16 v162, v142, s58, 0
    v_dot2_f32_bf16 v151, v142, s60, 0
    v_dot2_f32_bf16 v155, v142, s62, 0
    v_dot2_f32_bf16 v159, v142, s64, 0
    v_dot2_f32_bf16 v163, v142, s66, 0
    v_dot2_f32_bf16 v148, v143, s37, v148
    v_dot2_f32_bf16 v152, v143, s39, v152
    v_dot2_f32_bf16 v156, v143, s41, v156
    v_dot2_f32_bf16 v160, v143, s43, v160
    v_dot2_f32_bf16 v149, v143, s45, v149
    v_dot2_f32_bf16 v153, v143, s47, v153
    v_dot2_f32_bf16 v157, v143, s49, v157
    v_dot2_f32_bf16 v161, v143, s51, v161
    v_dot2_f32_bf16 v150, v143, s53, v150
    v_dot2_f32_bf16 v154, v143, s55, v154
    v_dot2_f32_bf16 v158, v143, s57, v158
    v_dot2_f32_bf16 v162, v143, s59, v162
    v_dot2_f32_bf16 v151, v143, s61, v151
    v_dot2_f32_bf16 v155, v143, s63, v155
    v_dot2_f32_bf16 v159, v143, s65, v159
    v_dot2_f32_bf16 v163, v143, s67, v163
    s_nop 1
    v_cvt_pk_bf16_f32 v164, v148, v149
    v_cvt_pk_bf16_f32 v165, v150, v151
    v_cvt_pk_bf16_f32 v166, v152, v153
    v_cvt_pk_bf16_f32 v167, v154, v155
    v_cvt_pk_bf16_f32 v168, v156, v157
    v_cvt_pk_bf16_f32 v169, v158, v159
    v_cvt_pk_bf16_f32 v170, v160, v161
    v_cvt_pk_bf16_f32 v171, v162, v163
    ds_write_b128 v119, v[164:167] offset:16384
    ds_write_b128 v119, v[168:171] offset:16400
    s_cmp_eq_u64 s[94:95], 0
    s_cbranch_scc1 L2_not3
    v_dot2_f32_bf16 v148, v146, s36, 0
    v_dot2_f32_bf16 v152, v146, s38, 0
    v_dot2_f32_bf16 v156, v146, s40, 0
    v_dot2_f32_bf16 v160, v146, s42, 0
    v_dot2_f32_bf16 v149, v146, s44, 0
    v_dot2_f32_bf16 v153, v146, s46, 0
    v_dot2_f32_bf16 v157, v146, s48, 0
    v_dot2_f32_bf16 v161, v146, s50, 0
    v_dot2_f32_bf16 v150, v146, s52, 0
    v_dot2_f32_bf16 v154, v146, s54, 0
    v_dot2_f32_bf16 v158, v146, s56, 0
    v_dot2_f32_bf16 v162, v146, s58, 0
    v_dot2_f32_bf16 v151, v146, s60, 0
    v_dot2_f32_bf16 v155, v146, s62, 0
    v_dot2_f32_bf16 v159, v146, s64, 0
    v_dot2_f32_bf16 v163, v146, s66, 0
    v_dot2_f32_bf16 v148, v147, s37, v148
    v_dot2_f32_bf16 v152, v147, s39, v152
    v_dot2_f32_bf16 v156, v147, s41, v156
    v_dot2_f32_bf16 v160, v147, s43, v160
    v_dot2_f32_bf16 v149, v147, s45, v149
    v_dot2_f32_bf16 v153, v147, s47, v153
    v_dot2_f32_bf16 v157, v147, s49, v157
    v_dot2_f32_bf16 v161, v147, s51, v161
    v_dot2_f32_bf16 v150, v147, s53, v150
    v_dot2_f32_bf16 v154, v147, s55, v154
    v_dot2_f32_bf16 v158, v147, s57, v158
    v_dot2_f32_bf16 v162, v147, s59, v162
    v_dot2_f32_bf16 v151, v147, s61, v151
    v_dot2_f32_bf16 v155, v147, s63, v155
    v_dot2_f32_bf16 v159, v147, s65, v159
    v_dot2_f32_bf16 v163, v147, s67, v163
    s_nop 1
    v_cvt_pk_bf16_f32 v164, v148, v149
    v_cvt_pk_bf16_f32 v165, v150, v151
    v_cvt_pk_bf16_f32 v166, v152, v153
    v_cvt_pk_bf16_f32 v167, v154, v155
    v_cvt_pk_bf16_f32 v168, v156, v157
    v_cvt_pk_bf16_f32 v169, v158, v159
    v_cvt_pk_bf16_f32 v170, v160, v161
    v_cvt_pk_bf16_f32 v171, v162, v163
    ds_write_b128 v119, v[164:167] offset:32768
    ds_write_b128 v119, v[168:171] offset:32784
L2_not3:
    v_readlane_b32 s36, v118, 0
    v_readlane_b32 s37, v118, 1
    v_readlane_b32 s38, v118, 2
    v_readlane_b32 s39, v118, 3
    v_readlane_b32 s40, v118, 4
    v_readlane_b32 s41, v118, 5
    v_readlane_b32 s42, v118, 6
    v_readlane_b32 s43, v118, 7
    v_readlane_b32 s44, v118, 8
    v_readlane_b32 s45, v118, 9
    v_readlane_b32 s46, v118, 10
    v_readlane_b32 s47, v118, 11
    v_readlane_b32 s48, v118, 12
    v_readlane_b32 s49, v118, 13
    v_readlane_b32 s50, v118, 14
    v_readlane_b32 s51, v118, 15
    v_add_u32 v9, v9, v2
    v_add_u32 v10, v10, v3
    s_waitcnt vmcnt(16) lgkmcnt(0)
    s_barrier
    s_cmp_eq_u32 s29, 0
    s_cbranch_scc1 L2_exit
    s_sub_u32 s29, s29, 1
    s_mov_b64 exec, s[32:33]
    ds_read_b128 v[24:27], v9 offset:0
    s_mov_b64 exec, s[34:35]
    ds_read_b128 v[28:31], v9 offset:0
    s_mov_b64 exec, -1
    ds_read_b64 v[32:33], v10 offset:49152
    s_waitcnt lgkmcnt(0)
    v_mfma_f32_32x32x16_bf16 v[116:131], v[24:27], v[36:39], 0
    v_mfma_f32_32x32x16_bf16 v[116:131], v[24:27], v[52:55], v[116:131]
    v_mfma_f32_32x32x16_bf16 v[116:131], v[28:31], v[40:43], v[116:131]
    v_mfma_f32_32x32x16_bf16 v[116:131], v[28:31], v[56:59], v[116:131]
    v_mfma_f32_32x32x16_bf16 v[132:147], v[24:27], v[44:47], 0
    v_mfma_f32_32x32x16_bf16 v[132:147], v[24:27], v[60:63], v[132:147]
    v_mfma_f32_32x32x16_bf16 v[132:147], v[28:31], v[48:51], v[132:147]
    v_mfma_f32_32x32x16_bf16 v[132:147], v[28:31], v[64:67], v[132:147]
    s_nop 7
    s_nop 3
    v_exp_f32 v12, v116
    v_exp_f32 v13, v117
    v_exp_f32 v14, v132
    v_exp_f32 v15, v133
    v_pk_add_f32 v[12:13], v[12:13], 1.0 op_sel_hi:[1,0]
    v_pk_add_f32 v[14:15], v[14:15], 1.0 op_sel_hi:[1,0]
    v_rcp_f32 v12, v12
    v_rcp_f32 v13, v13
    s_nop 0
    v_pk_mul_f32 v[116:117], v[116:117], v[12:13]
L2_loop:
    ds_read_u16 v9, v5 offset:32
    ds_read_u16 v10, v6 offset:32
    ds_read_b32 v8, v4 offset:128
    v_exp_f32 v12, v118
    s_waitcnt vmcnt(15)
    v_mfma_f32_4x4x4_16b_bf16 v[16:19], v[32:33], v[180:181], 0 cbsz:4 abid:0
    v_exp_f32 v13, v119
    v_mfma_f32_4x4x4_16b_bf16 v[20:23], v[32:33], v[182:183], 0 cbsz:4 abid:0
    v_readlane_b32 s52, v7, 0
    v_rcp_f32 v14, v14
    s_and_b32 s31, s52, 0xfffffc00
    v_rcp_f32 v15, v15
    buffer_load_dwordx4 v[180:183], v1, s[12:15], s31 offen
    v_pk_add_f32 v[12:13], v[12:13], 1.0 op_sel_hi:[1,0]
    v_pk_mul_f32 v[132:133], v[132:133], v[14:15]
    s_set_gpr_idx_on s36, gpr_idx(SRC2,DST)
    v_pk_fma_f32 v[68:69], v[116:117], v[16:17], v[68:69] op_sel_hi:[0,1,1]
    v_pk_fma_f32 v[70:71], v[116:117], v[18:19], v[70:71] op_sel_hi:[0,1,1]
    v_pk_fma_f32 v[72:73], v[132:133], v[20:21], v[72:73] op_sel_hi:[0,1,1]
    v_pk_fma_f32 v[74:75], v[132:133], v[22:23], v[74:75] op_sel_hi:[0,1,1]
    s_set_gpr_idx_off
    v_exp_f32 v14, v134
    s_waitcnt vmcnt(15)
    v_mfma_f32_4x4x4_16b_bf16 v[16:19], v[32:33], v[184:185], 0 cbsz:4 abid:1
    v_exp_f32 v15, v135
    v_mfma_f32_4x4x4_16b_bf16 v[20:23], v[32:33], v[186:187], 0 cbsz:4 abid:1
    v_readlane_b32 s53, v7, 1
    v_rcp_f32 v12, v12
    s_and_b32 s31, s53, 0xfffffc00
    v_rcp_f32 v13, v13
    buffer_load_dwordx4 v[184:187], v1, s[12:15], s31 offen
    v_pk_add_f32 v[14:15], v[14:15], 1.0 op_sel_hi:[1,0]
    v_pk_mul_f32 v[118:119], v[118:119], v[12:13]
    s_set_gpr_idx_on s37, gpr_idx(SRC2,DST)
    v_pk_fma_f32 v[68:69], v[116:117], v[16:17], v[68:69] op_sel:[1,0,0]
    v_pk_fma_f32 v[70:71], v[116:117], v[18:19], v[70:71] op_sel:[1,0,0]
    v_pk_fma_f32 v[72:73], v[132:133], v[20:21], v[72:73] op_sel:[1,0,0]
    v_pk_fma_f32 v[74:75], v[132:133], v[22:23], v[74:75] op_sel:[1,0,0]
    s_set_gpr_idx_off
    s_waitcnt lgkmcnt(0)
    v_add_u32 v9, v9, v2
    v_add_u32 v10, v10, v3
    s_mov_b64 exec, s[32:33]
    ds_read_b128 v[24:27], v9 offset:0
    s_mov_b64 exec, s[34:35]
    ds_read_b128 v[28:31], v9 offset:0
    s_mov_b64 exec, -1
    ds_read_b64 v[34:35], v10 offset:49152
    v_exp_f32 v12, v120
    s_waitcnt vmcnt(15)
    v_mfma_f32_4x4x4_16b_bf16 v[16:19], v[32:33], v[188:189], 0 cbsz:4 abid:2
    v_exp_f32 v13, v121
    v_mfma_f32_4x4x4_16b_bf16 v[20:23], v[32:33], v[190:191], 0 cbsz:4 abid:2
    v_readlane_b32 s54, v7, 2
    v_rcp_f32 v14, v14
    s_and_b32 s31, s54, 0xfffffc00
    v_rcp_f32 v15, v15
    buffer_load_dwordx4 v[188:191], v1, s[12:15], s31 offen
    v_pk_add_f32 v[12:13], v[12:13], 1.0 op_sel_hi:[1,0]
    v_pk_mul_f32 v[134:135], v[134:135], v[14:15]
    s_set_gpr_idx_on s38, gpr_idx(SRC2,DST)
    v_pk_fma_f32 v[68:69], v[118:119], v[16:17], v[68:69] op_sel_hi:[0,1,1]
    v_pk_fma_f32 v[70:71], v[118:119], v[18:19], v[70:71] op_sel_hi:[0,1,1]
    v_pk_fma_f32 v[72:73], v[134:135], v[20:21], v[72:73] op_sel_hi:[0,1,1]
    v_pk_fma_f32 v[74:75], v[134:135], v[22:23], v[74:75] op_sel_hi:[0,1,1]
    s_set_gpr_idx_off
    v_exp_f32 v14, v136
    s_waitcnt vmcnt(15)
    v_mfma_f32_4x4x4_16b_bf16 v[16:19], v[32:33], v[192:193], 0 cbsz:4 abid:3
    v_exp_f32 v15, v137
    v_mfma_f32_4x4x4_16b_bf16 v[20:23], v[32:33], v[194:195], 0 cbsz:4 abid:3
    v_readlane_b32 s55, v7, 3
    v_rcp_f32 v12, v12
    s_and_b32 s31, s55, 0xfffffc00
    v_rcp_f32 v13, v13
    buffer_load_dwordx4 v[192:195], v1, s[12:15], s31 offen
    v_pk_add_f32 v[14:15], v[14:15], 1.0 op_sel_hi:[1,0]
    v_pk_mul_f32 v[120:121], v[120:121], v[12:13]
    s_set_gpr_idx_on s39, gpr_idx(SRC2,DST)
    v_pk_fma_f32 v[68:69], v[118:119], v[16:17], v[68:69] op_sel:[1,0,0]
    v_pk_fma_f32 v[70:71], v[118:119], v[18:19], v[70:71] op_sel:[1,0,0]
    v_pk_fma_f32 v[72:73], v[134:135], v[20:21], v[72:73] op_sel:[1,0,0]
    v_pk_fma_f32 v[74:75], v[134:135], v[22:23], v[74:75] op_sel:[1,0,0]
    s_set_gpr_idx_off
    s_sub_u32 s29, s29, 4
    s_cbranch_scc1 L2_exit
    s_waitcnt lgkmcnt(0)
    v_mfma_f32_32x32x16_bf16 v[148:163], v[24:27], v[36:39], 0
    v_exp_f32 v12, v122
    v_exp_f32 v13, v123
    v_rcp_f32 v14, v14
    v_rcp_f32 v15, v15
    s_waitcnt vmcnt(15)
    v_mfma_f32_4x4x4_16b_bf16 v[16:19], v[32:33], v[196:197], 0 cbsz:4 abid:4
    v_readlane_b32 s56, v7, 4
    v_mfma_f32_4x4x4_16b_bf16 v[20:23], v[32:33], v[198:199], 0 cbsz:4 abid:4
    s_and_b32 s31, s56, 0xfffffc00
    v_add_f32 v12, 1.0, v12
    buffer_load_dwordx4 v[196:199], v1, s[12:15], s31 offen
    v_add_f32 v13, 1.0, v13
    v_mul_f32 v136, v136, v14
    v_mul_f32 v137, v137, v15
    s_set_gpr_idx_on s40, gpr_idx(SRC2,DST)
    v_pk_fma_f32 v[68:69], v[120:121], v[16:17], v[68:69] op_sel_hi:[0,1,1]
    v_pk_fma_f32 v[70:71], v[120:121], v[18:19], v[70:71] op_sel_hi:[0,1,1]
    v_pk_fma_f32 v[72:73], v[136:137], v[20:21], v[72:73] op_sel_hi:[0,1,1]
    v_pk_fma_f32 v[74:75], v[136:137], v[22:23], v[74:75] op_sel_hi:[0,1,1]
    s_set_gpr_idx_off
    v_mfma_f32_32x32x16_bf16 v[148:163], v[24:27], v[52:55], v[148:163]
    v_exp_f32 v14, v138
    v_exp_f32 v15, v139
    v_rcp_f32 v12, v12
    v_rcp_f32 v13, v13
    s_waitcnt vmcnt(15)
    v_mfma_f32_4x4x4_16b_bf16 v[16:19], v[32:33], v[200:201], 0 cbsz:4 abid:5
    v_readlane_b32 s57, v7, 5
    v_mfma_f32_4x4x4_16b_bf16 v[20:23], v[32:33], v[202:203], 0 cbsz:4 abid:5
    s_and_b32 s31, s57, 0xfffffc00
    v_add_f32 v14, 1.0, v14
    buffer_load_dwordx4 v[200:203], v1, s[12:15], s31 offen
    v_add_f32 v15, 1.0, v15
    v_mul_f32 v122, v122, v12
    v_mul_f32 v123, v123, v13
    s_set_gpr_idx_on s41, gpr_idx(SRC2,DST)
    v_pk_fma_f32 v[68:69], v[120:121], v[16:17], v[68:69] op_sel:[1,0,0]
    v_pk_fma_f32 v[70:71], v[120:121], v[18:19], v[70:71] op_sel:[1,0,0]
    v_pk_fma_f32 v[72:73], v[136:137], v[20:21], v[72:73] op_sel:[1,0,0]
    v_pk_fma_f32 v[74:75], v[136:137], v[22:23], v[74:75] op_sel:[1,0,0]
    s_set_gpr_idx_off
    v_mfma_f32_32x32x16_bf16 v[148:163], v[28:31], v[40:43], v[148:163]
    v_exp_f32 v12, v124
    v_exp_f32 v13, v125
    v_rcp_f32 v14, v14
    v_rcp_f32 v15, v15
    s_waitcnt vmcnt(15)
    v_mfma_f32_4x4x4_16b_bf16 v[16:19], v[32:33], v[204:205], 0 cbsz:4 abid:6
    v_readlane_b32 s58, v7, 6
    v_mfma_f32_4x4x4_16b_bf16 v[20:23], v[32:33], v[206:207], 0 cbsz:4 abid:6
    s_and_b32 s31, s58, 0xfffffc00
    v_add_f32 v12, 1.0, v12
    buffer_load_dwordx4 v[204:207], v1, s[12:15], s31 offen
    v_add_f32 v13, 1.0, v13
    v_mul_f32 v138, v138, v14
    v_mul_f32 v139, v139, v15
    s_set_gpr_idx_on s42, gpr_idx(SRC2,DST)
    v_pk_fma_f32 v[68:69], v[122:123], v[16:17], v[68:69] op_sel_hi:[0,1,1]
    v_pk_fma_f32 v[70:71], v[122:123], v[18:19], v[70:71] op_sel_hi:[0,1,1]
    v_pk_fma_f32 v[72:73], v[138:139], v[20:21], v[72:73] op_sel_hi:[0,1,1]
    v_pk_fma_f32 v[74:75], v[138:139], v[22:23], v[74:75] op_sel_hi:[0,1,1]
    s_set_gpr_idx_off
    v_mfma_f32_32x32x16_bf16 v[148:163], v[28:31], v[56:59], v[148:163]
    v_exp_f32 v14, v140
    v_exp_f32 v15, v141
    v_rcp_f32 v12, v12
    v_rcp_f32 v13, v13
    s_waitcnt vmcnt(15)
    v_mfma_f32_4x4x4_16b_bf16 v[16:19], v[32:33], v[208:209], 0 cbsz:4 abid:7
    v_readlane_b32 s59, v7, 7
    v_mfma_f32_4x4x4_16b_bf16 v[20:23], v[32:33], v[210:211], 0 cbsz:4 abid:7
    s_and_b32 s31, s59, 0xfffffc00
    v_add_f32 v14, 1.0, v14
    buffer_load_dwordx4 v[208:211], v1, s[12:15], s31 offen
    v_add_f32 v15, 1.0, v15
    v_mul_f32 v124, v124, v12
    v_mul_f32 v125, v125, v13
    s_set_gpr_idx_on s43, gpr_idx(SRC2,DST)
    v_pk_fma_f32 v[68:69], v[122:123], v[16:17], v[68:69] op_sel:[1,0,0]
    v_pk_fma_f32 v[70:71], v[122:123], v[18:19], v[70:71] op_sel:[1,0,0]
    v_pk_fma_f32 v[72:73], v[138:139], v[20:21], v[72:73] op_sel:[1,0,0]
    v_pk_fma_f32 v[74:75], v[138:139], v[22:23], v[74:75] op_sel:[1,0,0]
    s_set_gpr_idx_off
    s_sub_u32 s29, s29, 4
    s_cbranch_scc1 L2_exit
    v_mfma_f32_32x32x16_bf16 v[164:179], v[24:27], v[44:47], 0
    v_exp_f32 v12, v126
    v_exp_f32 v13, v127
    v_rcp_f32 v14, v14
    v_rcp_f32 v15, v15
    s_waitcnt vmcnt(15)
    v_mfma_f32_4x4x4_16b_bf16 v[16:19], v[32:33], v[212:213], 0 cbsz:4 abid:8
    v_readlane_b32 s60, v7, 8
    v_mfma_f32_4x4x4_16b_bf16 v[20:23], v[32:33], v[214:215], 0 cbsz:4 abid:8
    s_and_b32 s31, s60, 0xfffffc00
    v_add_f32 v12, 1.0, v12
    buffer_load_dwordx4 v[212:215], v1, s[12:15], s31 offen
    v_add_f32 v13, 1.0, v13
    v_mul_f32 v140, v140, v14
    v_mul_f32 v141, v141, v15
    s_set_gpr_idx_on s44, gpr_idx(SRC2,DST)
    v_pk_fma_f32 v[68:69], v[124:125], v[16:17], v[68:69] op_sel_hi:[0,1,1]
    v_pk_fma_f32 v[70:71], v[124:125], v[18:19], v[70:71] op_sel_hi:[0,1,1]
    v_pk_fma_f32 v[72:73], v[140:141], v[20:21], v[72:73] op_sel_hi:[0,1,1]
    v_pk_fma_f32 v[74:75], v[140:141], v[22:23], v[74:75] op_sel_hi:[0,1,1]
    s_set_gpr_idx_off
    v_mfma_f32_32x32x16_bf16 v[164:179], v[24:27], v[60:63], v[164:179]
    v_exp_f32 v14, v142
    v_exp_f32 v15, v143
    v_rcp_f32 v12, v12
    v_rcp_f32 v13, v13
    s_waitcnt vmcnt(15)
    v_mfma_f32_4x4x4_16b_bf16 v[16:19], v[32:33], v[216:217], 0 cbsz:4 abid:9
    v_readlane_b32 s61, v7, 9
    v_mfma_f32_4x4x4_16b_bf16 v[20:23], v[32:33], v[218:219], 0 cbsz:4 abid:9
    s_and_b32 s31, s61, 0xfffffc00
    v_add_f32 v14, 1.0, v14
    buffer_load_dwordx4 v[216:219], v1, s[12:15], s31 offen
    v_add_f32 v15, 1.0, v15
    v_mul_f32 v126, v126, v12
    v_mul_f32 v127, v127, v13
    s_set_gpr_idx_on s45, gpr_idx(SRC2,DST)
    v_pk_fma_f32 v[68:69], v[124:125], v[16:17], v[68:69] op_sel:[1,0,0]
    v_pk_fma_f32 v[70:71], v[124:125], v[18:19], v[70:71] op_sel:[1,0,0]
    v_pk_fma_f32 v[72:73], v[140:141], v[20:21], v[72:73] op_sel:[1,0,0]
    v_pk_fma_f32 v[74:75], v[140:141], v[22:23], v[74:75] op_sel:[1,0,0]
    s_set_gpr_idx_off
    v_mfma_f32_32x32x16_bf16 v[164:179], v[28:31], v[48:51], v[164:179]
    v_exp_f32 v12, v128
    v_exp_f32 v13, v129
    v_rcp_f32 v14, v14
    v_rcp_f32 v15, v15
    s_waitcnt vmcnt(15)
    v_mfma_f32_4x4x4_16b_bf16 v[16:19], v[32:33], v[220:221], 0 cbsz:4 abid:10
    v_readlane_b32 s62, v7, 10
    v_mfma_f32_4x4x4_16b_bf16 v[20:23], v[32:33], v[222:223], 0 cbsz:4 abid:10
    s_and_b32 s31, s62, 0xfffffc00
    v_add_f32 v12, 1.0, v12
    buffer_load_dwordx4 v[220:223], v1, s[12:15], s31 offen
    v_add_f32 v13, 1.0, v13
    v_mul_f32 v142, v142, v14
    v_mul_f32 v143, v143, v15
    s_set_gpr_idx_on s46, gpr_idx(SRC2,DST)
    v_pk_fma_f32 v[68:69], v[126:127], v[16:17], v[68:69] op_sel_hi:[0,1,1]
    v_pk_fma_f32 v[70:71], v[126:127], v[18:19], v[70:71] op_sel_hi:[0,1,1]
    v_pk_fma_f32 v[72:73], v[142:143], v[20:21], v[72:73] op_sel_hi:[0,1,1]
    v_pk_fma_f32 v[74:75], v[142:143], v[22:23], v[74:75] op_sel_hi:[0,1,1]
    s_set_gpr_idx_off
    v_mfma_f32_32x32x16_bf16 v[164:179], v[28:31], v[64:67], v[164:179]
    v_exp_f32 v14, v144
    v_exp_f32 v15, v145
    v_rcp_f32 v12, v12
    v_rcp_f32 v13, v13
    s_waitcnt vmcnt(15)
    v_mfma_f32_4x4x4_16b_bf16 v[16:19], v[32:33], v[224:225], 0 cbsz:4 abid:11
    v_readlane_b32 s63, v7, 11
    v_mfma_f32_4x4x4_16b_bf16 v[20:23], v[32:33], v[226:227], 0 cbsz:4 abid:11
    s_and_b32 s31, s63, 0xfffffc00
    v_add_f32 v14, 1.0, v14
    buffer_load_dwordx4 v[224:227], v1, s[12:15], s31 offen
    v_add_f32 v15, 1.0, v15
    v_mul_f32 v128, v128, v12
    v_mul_f32 v129, v129, v13
    s_set_gpr_idx_on s47, gpr_idx(SRC2,DST)
    v_pk_fma_f32 v[68:69], v[126:127], v[16:17], v[68:69] op_sel:[1,0,0]
    v_pk_fma_f32 v[70:71], v[126:127], v[18:19], v[70:71] op_sel:[1,0,0]
    v_pk_fma_f32 v[72:73], v[142:143], v[20:21], v[72:73] op_sel:[1,0,0]
    v_pk_fma_f32 v[74:75], v[142:143], v[22:23], v[74:75] op_sel:[1,0,0]
    s_set_gpr_idx_off
    s_sub_u32 s29, s29, 4
    s_cbranch_scc1 L2_exit
    v_exp_f32 v12, v130
    s_waitcnt vmcnt(15)
    v_mfma_f32_4x4x4_16b_bf16 v[16:19], v[32:33], v[228:229], 0 cbsz:4 abid:12
    v_exp_f32 v13, v131
    v_mfma_f32_4x4x4_16b_bf16 v[20:23], v[32:33], v[230:231], 0 cbsz:4 abid:12
    v_readlane_b32 s64, v7, 12
    v_rcp_f32 v14, v14
    s_and_b32 s31, s64, 0xfffffc00
    v_rcp_f32 v15, v15
    buffer_load_dwordx4 v[228:231], v1, s[12:15], s31 offen
    v_pk_add_f32 v[12:13], v[12:13], 1.0 op_sel_hi:[1,0]
    v_pk_mul_f32 v[144:145], v[144:145], v[14:15]
    s_set_gpr_idx_on s48, gpr_idx(SRC2,DST)
    v_pk_fma_f32 v[68:69], v[128:129], v[16:17], v[68:69] op_sel_hi:[0,1,1]
    v_pk_fma_f32 v[70:71], v[128:129], v[18:19], v[70:71] op_sel_hi:[0,1,1]
    v_pk_fma_f32 v[72:73], v[144:145], v[20:21], v[72:73] op_sel_hi:[0,1,1]
    v_pk_fma_f32 v[74:75], v[144:145], v[22:23], v[74:75] op_sel_hi:[0,1,1]
    s_set_gpr_idx_off
    v_exp_f32 v14, v146
    s_waitcnt vmcnt(15)
    v_mfma_f32_4x4x4_16b_bf16 v[16:19], v[32:33], v[232:233], 0 cbsz:4 abid:13
    v_exp_f32 v15, v147
    v_mfma_f32_4x4x4_16b_bf16 v[20:23], v[32:33], v[234:235], 0 cbsz:4 abid:13
    v_readlane_b32 s65, v7, 13
    v_rcp_f32 v12, v12
    s_and_b32 s31, s65, 0xfffffc00
    v_rcp_f32 v13, v13
    buffer_load_dwordx4 v[232:235], v1, s[12:15], s31 offen
    v_pk_add_f32 v[14:15], v[14:15], 1.0 op_sel_hi:[1,0]
    v_pk_mul_f32 v[130:131], v[130:131], v[12:13]
    s_set_gpr_idx_on s49, gpr_idx(SRC2,DST)
    v_pk_fma_f32 v[68:69], v[128:129], v[16:17], v[68:69] op_sel:[1,0,0]
    v_pk_fma_f32 v[70:71], v[128:129], v[18:19], v[70:71] op_sel:[1,0,0]
    v_pk_fma_f32 v[72:73], v[144:145], v[20:21], v[72:73] op_sel:[1,0,0]
    v_pk_fma_f32 v[74:75], v[144:145], v[22:23], v[74:75] op_sel:[1,0,0]
    s_set_gpr_idx_off
    v_exp_f32 v12, v148
    s_waitcnt vmcnt(15)
    v_mfma_f32_4x4x4_16b_bf16 v[16:19], v[32:33], v[236:237], 0 cbsz:4 abid:14
    v_exp_f32 v13, v149
    v_mfma_f32_4x4x4_16b_bf16 v[20:23], v[32:33], v[238:239], 0 cbsz:4 abid:14
    v_readlane_b32 s66, v7, 14
    v_rcp_f32 v14, v14
    s_and_b32 s31, s66, 0xfffffc00
    v_rcp_f32 v15, v15
    buffer_load_dwordx4 v[236:239], v1, s[12:15], s31 offen
    v_pk_add_f32 v[12:13], v[12:13], 1.0 op_sel_hi:[1,0]
    v_pk_mul_f32 v[146:147], v[146:147], v[14:15]
    s_set_gpr_idx_on s50, gpr_idx(SRC2,DST)
    v_pk_fma_f32 v[68:69], v[130:131], v[16:17], v[68:69] op_sel_hi:[0,1,1]
    v_pk_fma_f32 v[70:71], v[130:131], v[18:19], v[70:71] op_sel_hi:[0,1,1]
    v_pk_fma_f32 v[72:73], v[146:147], v[20:21], v[72:73] op_sel_hi:[0,1,1]
    v_pk_fma_f32 v[74:75], v[146:147], v[22:23], v[74:75] op_sel_hi:[0,1,1]
    s_set_gpr_idx_off
    v_exp_f32 v14, v164
    s_waitcnt vmcnt(15)
    v_mfma_f32_4x4x4_16b_bf16 v[16:19], v[32:33], v[240:241], 0 cbsz:4 abid:15
    v_exp_f32 v15, v165
    v_mfma_f32_4x4x4_16b_bf16 v[20:23], v[32:33], v[242:243], 0 cbsz:4 abid:15
    v_readlane_b32 s67, v7, 15
    v_rcp_f32 v12, v12
    s_and_b32 s31, s67, 0xfffffc00
    v_rcp_f32 v13, v13
    buffer_load_dwordx4 v[240:243], v1, s[12:15], s31 offen
    v_pk_add_f32 v[14:15], v[14:15], 1.0 op_sel_hi:[1,0]
    v_pk_mul_f32 v[148:149], v[148:149], v[12:13]
    s_set_gpr_idx_on s51, gpr_idx(SRC2,DST)
    v_pk_fma_f32 v[68:69], v[130:131], v[16:17], v[68:69] op_sel:[1,0,0]
    v_pk_fma_f32 v[70:71], v[130:131], v[18:19], v[70:71] op_sel:[1,0,0]
    v_pk_fma_f32 v[72:73], v[146:147], v[20:21], v[72:73] op_sel:[1,0,0]
    v_pk_fma_f32 v[74:75], v[146:147], v[22:23], v[74:75] op_sel:[1,0,0]
    s_set_gpr_idx_off
    s_sub_u32 s29, s29, 4
    s_cbranch_scc1 L2_exit
    ds_read_u16 v9, v5 offset:64
    ds_read_u16 v10, v6 offset:64
    ds_read_b32 v7, v4 offset:192
    v_exp_f32 v12, v150
    s_waitcnt vmcnt(15)
    v_mfma_f32_4x4x4_16b_bf16 v[16:19], v[34:35], v[180:181], 0 cbsz:4 abid:0
    v_exp_f32 v13, v151
    v_mfma_f32_4x4x4_16b_bf16 v[20:23], v[34:35], v[182:183], 0 cbsz:4 abid:0
    v_readlane_b32 s36, v8, 0
    v_rcp_f32 v14, v14
    s_and_b32 s31, s36, 0xfffffc00
    v_rcp_f32 v15, v15
    buffer_load_dwordx4 v[180:183], v1, s[12:15], s31 offen
    v_pk_add_f32 v[12:13], v[12:13], 1.0 op_sel_hi:[1,0]
    v_pk_mul_f32 v[164:165], v[164:165], v[14:15]
    s_set_gpr_idx_on s52, gpr_idx(SRC2,DST)
    v_pk_fma_f32 v[68:69], v[148:149], v[16:17], v[68:69] op_sel_hi:[0,1,1]
    v_pk_fma_f32 v[70:71], v[148:149], v[18:19], v[70:71] op_sel_hi:[0,1,1]
    v_pk_fma_f32 v[72:73], v[164:165], v[20:21], v[72:73] op_sel_hi:[0,1,1]
    v_pk_fma_f32 v[74:75], v[164:165], v[22:23], v[74:75] op_sel_hi:[0,1,1]
    s_set_gpr_idx_off
    v_exp_f32 v14, v166
    s_waitcnt vmcnt(15)
    v_mfma_f32_4x4x4_16b_bf16 v[16:19], v[34:35], v[184:185], 0 cbsz:4 abid:1
    v_exp_f32 v15, v167
    v_mfma_f32_4x4x4_16b_bf16 v[20:23], v[34:35], v[186:187], 0 cbsz:4 abid:1
    v_readlane_b32 s37, v8, 1
    v_rcp_f32 v12, v12
    s_and_b32 s31, s37, 0xfffffc00
    v_rcp_f32 v13, v13
    buffer_load_dwordx4 v[184:187], v1, s[12:15], s31 offen
    v_pk_add_f32 v[14:15], v[14:15], 1.0 op_sel_hi:[1,0]
    v_pk_mul_f32 v[150:151], v[150:151], v[12:13]
    s_set_gpr_idx_on s53, gpr_idx(SRC2,DST)
    v_pk_fma_f32 v[68:69], v[148:149], v[16:17], v[68:69] op_sel:[1,0,0]
    v_pk_fma_f32 v[70:71], v[148:149], v[18:19], v[70:71] op_sel:[1,0,0]
    v_pk_fma_f32 v[72:73], v[164:165], v[20:21], v[72:73] op_sel:[1,0,0]
    v_pk_fma_f32 v[74:75], v[164:165], v[22:23], v[74:75] op_sel:[1,0,0]
    s_set_gpr_idx_off
    s_waitcnt lgkmcnt(0)
    v_add_u32 v9, v9, v2
    v_add_u32 v10, v10, v3
    s_mov_b64 exec, s[32:33]
    ds_read_b128 v[24:27], v9 offset:0
    s_mov_b64 exec, s[34:35]
    ds_read_b128 v[28:31], v9 offset:0
    s_mov_b64 exec, -1
    ds_read_b64 v[32:33], v10 offset:49152
    v_exp_f32 v12, v152
    s_waitcnt vmcnt(15)
    v_mfma_f32_4x4x4_16b_bf16 v[16:19], v[34:35], v[188:189], 0 cbsz:4 abid:2
    v_exp_f32 v13, v153
    v_mfma_f32_4x4x4_16b_bf16 v[20:23], v[34:35], v[190:191], 0 cbsz:4 abid:2
    v_readlane_b32 s38, v8, 2
    v_rcp_f32 v14, v14
    s_and_b32 s31, s38, 0xfffffc00
    v_rcp_f32 v15, v15
    buffer_load_dwordx4 v[188:191], v1, s[12:15], s31 offen
    v_pk_add_f32 v[12:13], v[12:13], 1.0 op_sel_hi:[1,0]
    v_pk_mul_f32 v[166:167], v[166:167], v[14:15]
    s_set_gpr_idx_on s54, gpr_idx(SRC2,DST)
    v_pk_fma_f32 v[68:69], v[150:151], v[16:17], v[68:69] op_sel_hi:[0,1,1]
    v_pk_fma_f32 v[70:71], v[150:151], v[18:19], v[70:71] op_sel_hi:[0,1,1]
    v_pk_fma_f32 v[72:73], v[166:167], v[20:21], v[72:73] op_sel_hi:[0,1,1]
    v_pk_fma_f32 v[74:75], v[166:167], v[22:23], v[74:75] op_sel_hi:[0,1,1]
    s_set_gpr_idx_off
    v_exp_f32 v14, v168
    s_waitcnt vmcnt(15)
    v_mfma_f32_4x4x4_16b_bf16 v[16:19], v[34:35], v[192:193], 0 cbsz:4 abid:3
    v_exp_f32 v15, v169
    v_mfma_f32_4x4x4_16b_bf16 v[20:23], v[34:35], v[194:195], 0 cbsz:4 abid:3
    v_readlane_b32 s39, v8, 3
    v_rcp_f32 v12, v12
    s_and_b32 s31, s39, 0xfffffc00
    v_rcp_f32 v13, v13
    buffer_load_dwordx4 v[192:195], v1, s[12:15], s31 offen
    v_pk_add_f32 v[14:15], v[14:15], 1.0 op_sel_hi:[1,0]
    v_pk_mul_f32 v[152:153], v[152:153], v[12:13]
    s_set_gpr_idx_on s55, gpr_idx(SRC2,DST)
    v_pk_fma_f32 v[68:69], v[150:151], v[16:17], v[68:69] op_sel:[1,0,0]
    v_pk_fma_f32 v[70:71], v[150:151], v[18:19], v[70:71] op_sel:[1,0,0]
    v_pk_fma_f32 v[72:73], v[166:167], v[20:21], v[72:73] op_sel:[1,0,0]
    v_pk_fma_f32 v[74:75], v[166:167], v[22:23], v[74:75] op_sel:[1,0,0]
    s_set_gpr_idx_off
    s_sub_u32 s29, s29, 4
    s_cbranch_scc1 L2_exit
    s_waitcnt lgkmcnt(0)
    v_mfma_f32_32x32x16_bf16 v[116:131], v[24:27], v[36:39], 0
    v_exp_f32 v12, v154
    v_exp_f32 v13, v155
    v_rcp_f32 v14, v14
    v_rcp_f32 v15, v15
    s_waitcnt vmcnt(15)
    v_mfma_f32_4x4x4_16b_bf16 v[16:19], v[34:35], v[196:197], 0 cbsz:4 abid:4
    v_readlane_b32 s40, v8, 4
    v_mfma_f32_4x4x4_16b_bf16 v[20:23], v[34:35], v[198:199], 0 cbsz:4 abid:4
    s_and_b32 s31, s40, 0xfffffc00
    v_add_f32 v12, 1.0, v12
    buffer_load_dwordx4 v[196:199], v1, s[12:15], s31 offen
    v_add_f32 v13, 1.0, v13
    v_mul_f32 v168, v168, v14
    v_mul_f32 v169, v169, v15
    s_set_gpr_idx_on s56, gpr_idx(SRC2,DST)
    v_pk_fma_f32 v[68:69], v[152:153], v[16:17], v[68:69] op_sel_hi:[0,1,1]
    v_pk_fma_f32 v[70:71], v[152:153], v[18:19], v[70:71] op_sel_hi:[0,1,1]
    v_pk_fma_f32 v[72:73], v[168:169], v[20:21], v[72:73] op_sel_hi:[0,1,1]
    v_pk_fma_f32 v[74:75], v[168:169], v[22:23], v[74:75] op_sel_hi:[0,1,1]
    s_set_gpr_idx_off
    v_mfma_f32_32x32x16_bf16 v[116:131], v[24:27], v[52:55], v[116:131]
    v_exp_f32 v14, v170
    v_exp_f32 v15, v171
    v_rcp_f32 v12, v12
    v_rcp_f32 v13, v13
    s_waitcnt vmcnt(15)
    v_mfma_f32_4x4x4_16b_bf16 v[16:19], v[34:35], v[200:201], 0 cbsz:4 abid:5
    v_readlane_b32 s41, v8, 5
    v_mfma_f32_4x4x4_16b_bf16 v[20:23], v[34:35], v[202:203], 0 cbsz:4 abid:5
    s_and_b32 s31, s41, 0xfffffc00
    v_add_f32 v14, 1.0, v14
    buffer_load_dwordx4 v[200:203], v1, s[12:15], s31 offen
    v_add_f32 v15, 1.0, v15
    v_mul_f32 v154, v154, v12
    v_mul_f32 v155, v155, v13
    s_set_gpr_idx_on s57, gpr_idx(SRC2,DST)
    v_pk_fma_f32 v[68:69], v[152:153], v[16:17], v[68:69] op_sel:[1,0,0]
    v_pk_fma_f32 v[70:71], v[152:153], v[18:19], v[70:71] op_sel:[1,0,0]
    v_pk_fma_f32 v[72:73], v[168:169], v[20:21], v[72:73] op_sel:[1,0,0]
    v_pk_fma_f32 v[74:75], v[168:169], v[22:23], v[74:75] op_sel:[1,0,0]
    s_set_gpr_idx_off
    v_mfma_f32_32x32x16_bf16 v[116:131], v[28:31], v[40:43], v[116:131]
    v_exp_f32 v12, v156
    v_exp_f32 v13, v157
    v_rcp_f32 v14, v14
    v_rcp_f32 v15, v15
    s_waitcnt vmcnt(15)
    v_mfma_f32_4x4x4_16b_bf16 v[16:19], v[34:35], v[204:205], 0 cbsz:4 abid:6
    v_readlane_b32 s42, v8, 6
    v_mfma_f32_4x4x4_16b_bf16 v[20:23], v[34:35], v[206:207], 0 cbsz:4 abid:6
    s_and_b32 s31, s42, 0xfffffc00
    v_add_f32 v12, 1.0, v12
    buffer_load_dwordx4 v[204:207], v1, s[12:15], s31 offen
    v_add_f32 v13, 1.0, v13
    v_mul_f32 v170, v170, v14
    v_mul_f32 v171, v171, v15
    s_set_gpr_idx_on s58, gpr_idx(SRC2,DST)
    v_pk_fma_f32 v[68:69], v[154:155], v[16:17], v[68:69] op_sel_hi:[0,1,1]
    v_pk_fma_f32 v[70:71], v[154:155], v[18:19], v[70:71] op_sel_hi:[0,1,1]
    v_pk_fma_f32 v[72:73], v[170:171], v[20:21], v[72:73] op_sel_hi:[0,1,1]
    v_pk_fma_f32 v[74:75], v[170:171], v[22:23], v[74:75] op_sel_hi:[0,1,1]
    s_set_gpr_idx_off
    v_mfma_f32_32x32x16_bf16 v[116:131], v[28:31], v[56:59], v[116:131]
    v_exp_f32 v14, v172
    v_exp_f32 v15, v173
    v_rcp_f32 v12, v12
    v_rcp_f32 v13, v13
    s_waitcnt vmcnt(15)
    v_mfma_f32_4x4x4_16b_bf16 v[16:19], v[34:35], v[208:209], 0 cbsz:4 abid:7
    v_readlane_b32 s43, v8, 7
    v_mfma_f32_4x4x4_16b_bf16 v[20:23], v[34:35], v[210:211], 0 cbsz:4 abid:7
    s_and_b32 s31, s43, 0xfffffc00
    v_add_f32 v14, 1.0, v14
    buffer_load_dwordx4 v[208:211], v1, s[12:15], s31 offen
    v_add_f32 v15, 1.0, v15
    v_mul_f32 v156, v156, v12
    v_mul_f32 v157, v157, v13
    s_set_gpr_idx_on s59, gpr_idx(SRC2,DST)
    v_pk_fma_f32 v[68:69], v[154:155], v[16:17], v[68:69] op_sel:[1,0,0]
    v_pk_fma_f32 v[70:71], v[154:155], v[18:19], v[70:71] op_sel:[1,0,0]
    v_pk_fma_f32 v[72:73], v[170:171], v[20:21], v[72:73] op_sel:[1,0,0]
    v_pk_fma_f32 v[74:75], v[170:171], v[22:23], v[74:75] op_sel:[1,0,0]
    s_set_gpr_idx_off
    s_sub_u32 s29, s29, 4
    s_cbranch_scc1 L2_exit
    v_mfma_f32_32x32x16_bf16 v[132:147], v[24:27], v[44:47], 0
    v_exp_f32 v12, v158
    v_exp_f32 v13, v159
    v_rcp_f32 v14, v14
    v_rcp_f32 v15, v15
    s_waitcnt vmcnt(15)
    v_mfma_f32_4x4x4_16b_bf16 v[16:19], v[34:35], v[212:213], 0 cbsz:4 abid:8
    v_readlane_b32 s44, v8, 8
    v_mfma_f32_4x4x4_16b_bf16 v[20:23], v[34:35], v[214:215], 0 cbsz:4 abid:8
    s_and_b32 s31, s44, 0xfffffc00
    v_add_f32 v12, 1.0, v12
    buffer_load_dwordx4 v[212:215], v1, s[12:15], s31 offen
    v_add_f32 v13, 1.0, v13
    v_mul_f32 v172, v172, v14
    v_mul_f32 v173, v173, v15
    s_set_gpr_idx_on s60, gpr_idx(SRC2,DST)
    v_pk_fma_f32 v[68:69], v[156:157], v[16:17], v[68:69] op_sel_hi:[0,1,1]
    v_pk_fma_f32 v[70:71], v[156:157], v[18:19], v[70:71] op_sel_hi:[0,1,1]
    v_pk_fma_f32 v[72:73], v[172:173], v[20:21], v[72:73] op_sel_hi:[0,1,1]
    v_pk_fma_f32 v[74:75], v[172:173], v[22:23], v[74:75] op_sel_hi:[0,1,1]
    s_set_gpr_idx_off
    v_mfma_f32_32x32x16_bf16 v[132:147], v[24:27], v[60:63], v[132:147]
    v_exp_f32 v14, v174
    v_exp_f32 v15, v175
    v_rcp_f32 v12, v12
    v_rcp_f32 v13, v13
    s_waitcnt vmcnt(15)
    v_mfma_f32_4x4x4_16b_bf16 v[16:19], v[34:35], v[216:217], 0 cbsz:4 abid:9
    v_readlane_b32 s45, v8, 9
    v_mfma_f32_4x4x4_16b_bf16 v[20:23], v[34:35], v[218:219], 0 cbsz:4 abid:9
    s_and_b32 s31, s45, 0xfffffc00
    v_add_f32 v14, 1.0, v14
    buffer_load_dwordx4 v[216:219], v1, s[12:15], s31 offen
    v_add_f32 v15, 1.0, v15
    v_mul_f32 v158, v158, v12
    v_mul_f32 v159, v159, v13
    s_set_gpr_idx_on s61, gpr_idx(SRC2,DST)
    v_pk_fma_f32 v[68:69], v[156:157], v[16:17], v[68:69] op_sel:[1,0,0]
    v_pk_fma_f32 v[70:71], v[156:157], v[18:19], v[70:71] op_sel:[1,0,0]
    v_pk_fma_f32 v[72:73], v[172:173], v[20:21], v[72:73] op_sel:[1,0,0]
    v_pk_fma_f32 v[74:75], v[172:173], v[22:23], v[74:75] op_sel:[1,0,0]
    s_set_gpr_idx_off
    v_mfma_f32_32x32x16_bf16 v[132:147], v[28:31], v[48:51], v[132:147]
    v_exp_f32 v12, v160
    v_exp_f32 v13, v161
    v_rcp_f32 v14, v14
    v_rcp_f32 v15, v15
    s_waitcnt vmcnt(15)
    v_mfma_f32_4x4x4_16b_bf16 v[16:19], v[34:35], v[220:221], 0 cbsz:4 abid:10
    v_readlane_b32 s46, v8, 10
    v_mfma_f32_4x4x4_16b_bf16 v[20:23], v[34:35], v[222:223], 0 cbsz:4 abid:10
    s_and_b32 s31, s46, 0xfffffc00
    v_add_f32 v12, 1.0, v12
    buffer_load_dwordx4 v[220:223], v1, s[12:15], s31 offen
    v_add_f32 v13, 1.0, v13
    v_mul_f32 v174, v174, v14
    v_mul_f32 v175, v175, v15
    s_set_gpr_idx_on s62, gpr_idx(SRC2,DST)
    v_pk_fma_f32 v[68:69], v[158:159], v[16:17], v[68:69] op_sel_hi:[0,1,1]
    v_pk_fma_f32 v[70:71], v[158:159], v[18:19], v[70:71] op_sel_hi:[0,1,1]
    v_pk_fma_f32 v[72:73], v[174:175], v[20:21], v[72:73] op_sel_hi:[0,1,1]
    v_pk_fma_f32 v[74:75], v[174:175], v[22:23], v[74:75] op_sel_hi:[0,1,1]
    s_set_gpr_idx_off
    v_mfma_f32_32x32x16_bf16 v[132:147], v[28:31], v[64:67], v[132:147]
    v_exp_f32 v14, v176
    v_exp_f32 v15, v177
    v_rcp_f32 v12, v12
    v_rcp_f32 v13, v13
    s_waitcnt vmcnt(15)
    v_mfma_f32_4x4x4_16b_bf16 v[16:19], v[34:35], v[224:225], 0 cbsz:4 abid:11
    v_readlane_b32 s47, v8, 11
    v_mfma_f32_4x4x4_16b_bf16 v[20:23], v[34:35], v[226:227], 0 cbsz:4 abid:11
    s_and_b32 s31, s47, 0xfffffc00
    v_add_f32 v14, 1.0, v14
    buffer_load_dwordx4 v[224:227], v1, s[12:15], s31 offen
    v_add_f32 v15, 1.0, v15
    v_mul_f32 v160, v160, v12
    v_mul_f32 v161, v161, v13
    s_set_gpr_idx_on s63, gpr_idx(SRC2,DST)
    v_pk_fma_f32 v[68:69], v[158:159], v[16:17], v[68:69] op_sel:[1,0,0]
    v_pk_fma_f32 v[70:71], v[158:159], v[18:19], v[70:71] op_sel:[1,0,0]
    v_pk_fma_f32 v[72:73], v[174:175], v[20:21], v[72:73] op_sel:[1,0,0]
    v_pk_fma_f32 v[74:75], v[174:175], v[22:23], v[74:75] op_sel:[1,0,0]
    s_set_gpr_idx_off
    s_sub_u32 s29, s29, 4
    s_cbranch_scc1 L2_exit
    v_exp_f32 v12, v162
    s_waitcnt vmcnt(15)
    v_mfma_f32_4x4x4_16b_bf16 v[16:19], v[34:35], v[228:229], 0 cbsz:4 abid:12
    v_exp_f32 v13, v163
    v_mfma_f32_4x4x4_16b_bf16 v[20:23], v[34:35], v[230:231], 0 cbsz:4 abid:12
    v_readlane_b32 s48, v8, 12
    v_rcp_f32 v14, v14
    s_and_b32 s31, s48, 0xfffffc00
    v_rcp_f32 v15, v15
    buffer_load_dwordx4 v[228:231], v1, s[12:15], s31 offen
    v_pk_add_f32 v[12:13], v[12:13], 1.0 op_sel_hi:[1,0]
    v_pk_mul_f32 v[176:177], v[176:177], v[14:15]
    s_set_gpr_idx_on s64, gpr_idx(SRC2,DST)
    v_pk_fma_f32 v[68:69], v[160:161], v[16:17], v[68:69] op_sel_hi:[0,1,1]
    v_pk_fma_f32 v[70:71], v[160:161], v[18:19], v[70:71] op_sel_hi:[0,1,1]
    v_pk_fma_f32 v[72:73], v[176:177], v[20:21], v[72:73] op_sel_hi:[0,1,1]
    v_pk_fma_f32 v[74:75], v[176:177], v[22:23], v[74:75] op_sel_hi:[0,1,1]
    s_set_gpr_idx_off
    v_exp_f32 v14, v178
    s_waitcnt vmcnt(15)
    v_mfma_f32_4x4x4_16b_bf16 v[16:19], v[34:35], v[232:233], 0 cbsz:4 abid:13
    v_exp_f32 v15, v179
    v_mfma_f32_4x4x4_16b_bf16 v[20:23], v[34:35], v[234:235], 0 cbsz:4 abid:13
    v_readlane_b32 s49, v8, 13
    v_rcp_f32 v12, v12
    s_and_b32 s31, s49, 0xfffffc00
    v_rcp_f32 v13, v13
    buffer_load_dwordx4 v[232:235], v1, s[12:15], s31 offen
    v_pk_add_f32 v[14:15], v[14:15], 1.0 op_sel_hi:[1,0]
    v_pk_mul_f32 v[162:163], v[162:163], v[12:13]
    s_set_gpr_idx_on s65, gpr_idx(SRC2,DST)
    v_pk_fma_f32 v[68:69], v[160:161], v[16:17], v[68:69] op_sel:[1,0,0]
    v_pk_fma_f32 v[70:71], v[160:161], v[18:19], v[70:71] op_sel:[1,0,0]
    v_pk_fma_f32 v[72:73], v[176:177], v[20:21], v[72:73] op_sel:[1,0,0]
    v_pk_fma_f32 v[74:75], v[176:177], v[22:23], v[74:75] op_sel:[1,0,0]
    s_set_gpr_idx_off
    v_exp_f32 v12, v116
    s_waitcnt vmcnt(15)
    v_mfma_f32_4x4x4_16b_bf16 v[16:19], v[34:35], v[236:237], 0 cbsz:4 abid:14
    v_exp_f32 v13, v117
    v_mfma_f32_4x4x4_16b_bf16 v[20:23], v[34:35], v[238:239], 0 cbsz:4 abid:14
    v_readlane_b32 s50, v8, 14
    v_rcp_f32 v14, v14
    s_and_b32 s31, s50, 0xfffffc00
    v_rcp_f32 v15, v15
    buffer_load_dwordx4 v[236:239], v1, s[12:15], s31 offen
    v_pk_add_f32 v[12:13], v[12:13], 1.0 op_sel_hi:[1,0]
    v_pk_mul_f32 v[178:179], v[178:179], v[14:15]
    s_set_gpr_idx_on s66, gpr_idx(SRC2,DST)
    v_pk_fma_f32 v[68:69], v[162:163], v[16:17], v[68:69] op_sel_hi:[0,1,1]
    v_pk_fma_f32 v[70:71], v[162:163], v[18:19], v[70:71] op_sel_hi:[0,1,1]
    v_pk_fma_f32 v[72:73], v[178:179], v[20:21], v[72:73] op_sel_hi:[0,1,1]
    v_pk_fma_f32 v[74:75], v[178:179], v[22:23], v[74:75] op_sel_hi:[0,1,1]
    s_set_gpr_idx_off
    v_exp_f32 v14, v132
    s_waitcnt vmcnt(15)
    v_mfma_f32_4x4x4_16b_bf16 v[16:19], v[34:35], v[240:241], 0 cbsz:4 abid:15
    v_exp_f32 v15, v133
    v_mfma_f32_4x4x4_16b_bf16 v[20:23], v[34:35], v[242:243], 0 cbsz:4 abid:15
    v_readlane_b32 s51, v8, 15
    v_rcp_f32 v12, v12
    s_and_b32 s31, s51, 0xfffffc00
    v_rcp_f32 v13, v13
    buffer_load_dwordx4 v[240:243], v1, s[12:15], s31 offen
    v_pk_add_f32 v[14:15], v[14:15], 1.0 op_sel_hi:[1,0]
    v_pk_mul_f32 v[116:117], v[116:117], v[12:13]
    s_set_gpr_idx_on s67, gpr_idx(SRC2,DST)
    v_pk_fma_f32 v[68:69], v[162:163], v[16:17], v[68:69] op_sel:[1,0,0]
    v_pk_fma_f32 v[70:71], v[162:163], v[18:19], v[70:71] op_sel:[1,0,0]
    v_pk_fma_f32 v[72:73], v[178:179], v[20:21], v[72:73] op_sel:[1,0,0]
    v_pk_fma_f32 v[74:75], v[178:179], v[22:23], v[74:75] op_sel:[1,0,0]
    s_set_gpr_idx_off
    s_sub_u32 s29, s29, 4
    s_cbranch_scc1 L2_exit
    v_add_u32 v4, 128, v4
    v_add_u32 v5, 64, v5
    v_add_u32 v6, 64, v6
    s_branch L2_loop
L2_exit:
    s_add_u32 s28, s28, 1536
    s_cmp_lt_u32 s28, s11
    s_cbranch_scc1 L2_round
    s_and_b32 s3, s10, 3
    s_lshl_b32 s31, s3, 13
    s_add_u32 s31, s31, 278528
    s_waitcnt lgkmcnt(0)
    s_nop 7
    s_nop 3
    v_add_u32 v148, s31, v1
    v_add_u32 v149, 4096, v148
    global_load_dwordx4 v[116:119], v148, s[8:9] offset:0
    global_load_dwordx4 v[120:123], v148, s[8:9] offset:1024
    global_load_dwordx4 v[124:127], v148, s[8:9] offset:2048
    global_load_dwordx4 v[128:131], v148, s[8:9] offset:3072
    global_load_dwordx4 v[132:135], v149, s[8:9] offset:0
    global_load_dwordx4 v[136:139], v149, s[8:9] offset:1024
    global_load_dwordx4 v[140:143], v149, s[8:9] offset:2048
    global_load_dwordx4 v[144:147], v149, s[8:9] offset:3072
    s_mov_b32 s68, 0xbf317218
    s_mov_b32 s69, 0xbf317218
    s_mul_i32 s31, s10, 1152
    s_add_u32 s31, s31, 111104
    v_lshl_add_u32 v150, v11, 2, s31
    v_pk_mul_f32 v[68:69], v[68:69], s[68:69]
    v_pk_mul_f32 v[70:71], v[70:71], s[68:69]
    v_pk_mul_f32 v[72:73], v[72:73], s[68:69]
    v_pk_mul_f32 v[74:75], v[74:75], s[68:69]
    v_cvt_pk_bf16_f32 v68, v68, v72
    v_cvt_pk_bf16_f32 v69, v69, v73
    v_cvt_pk_bf16_f32 v70, v70, v74
    v_cvt_pk_bf16_f32 v71, v71, v75
    ds_write_b32 v150, v68 offset:0
    ds_write_b32 v150, v69 offset:288
    ds_write_b32 v150, v70 offset:576
    ds_write_b32 v150, v71 offset:864
    v_pk_mul_f32 v[76:77], v[76:77], s[68:69]
    v_pk_mul_f32 v[78:79], v[78:79], s[68:69]
    v_pk_mul_f32 v[80:81], v[80:81], s[68:69]
    v_pk_mul_f32 v[82:83], v[82:83], s[68:69]
    v_cvt_pk_bf16_f32 v76, v76, v80
    v_cvt_pk_bf16_f32 v77, v77, v81
    v_cvt_pk_bf16_f32 v78, v78, v82
    v_cvt_pk_bf16_f32 v79, v79, v83
    ds_write_b32 v150, v76 offset:9216
    ds_write_b32 v150, v77 offset:9504
    ds_write_b32 v150, v78 offset:9792
    ds_write_b32 v150, v79 offset:10080
    v_pk_mul_f32 v[84:85], v[84:85], s[68:69]
    v_pk_mul_f32 v[86:87], v[86:87], s[68:69]
    v_pk_mul_f32 v[88:89], v[88:89], s[68:69]
    v_pk_mul_f32 v[90:91], v[90:91], s[68:69]
    v_cvt_pk_bf16_f32 v84, v84, v88
    v_cvt_pk_bf16_f32 v85, v85, v89
    v_cvt_pk_bf16_f32 v86, v86, v90
    v_cvt_pk_bf16_f32 v87, v87, v91
    ds_write_b32 v150, v84 offset:18432
    ds_write_b32 v150, v85 offset:18720
    ds_write_b32 v150, v86 offset:19008
    ds_write_b32 v150, v87 offset:19296
    v_pk_mul_f32 v[92:93], v[92:93], s[68:69]
    v_pk_mul_f32 v[94:95], v[94:95], s[68:69]
    v_pk_mul_f32 v[96:97], v[96:97], s[68:69]
    v_pk_mul_f32 v[98:99], v[98:99], s[68:69]
    v_cvt_pk_bf16_f32 v92, v92, v96
    v_cvt_pk_bf16_f32 v93, v93, v97
    v_cvt_pk_bf16_f32 v94, v94, v98
    v_cvt_pk_bf16_f32 v95, v95, v99
    ds_write_b32 v150, v92 offset:27648
    ds_write_b32 v150, v93 offset:27936
    ds_write_b32 v150, v94 offset:28224
    ds_write_b32 v150, v95 offset:28512
    v_pk_mul_f32 v[100:101], v[100:101], s[68:69]
    v_pk_mul_f32 v[102:103], v[102:103], s[68:69]
    v_pk_mul_f32 v[104:105], v[104:105], s[68:69]
    v_pk_mul_f32 v[106:107], v[106:107], s[68:69]
    v_cvt_pk_bf16_f32 v100, v100, v104
    v_cvt_pk_bf16_f32 v101, v101, v105
    v_cvt_pk_bf16_f32 v102, v102, v106
    v_cvt_pk_bf16_f32 v103, v103, v107
    ds_write_b32 v150, v100 offset:36864
    ds_write_b32 v150, v101 offset:37152
    ds_write_b32 v150, v102 offset:37440
    ds_write_b32 v150, v103 offset:37728
    s_lshr_b32 s68, s10, 2
    s_mul_i32 s31, s68, 23040
    s_add_u32 s31, s31, 111104
    v_and_b32 v151, 15, v11
    v_lshrrev_b32 v152, 4, v11
    v_mul_u32_u24 v153, 288, v151
    v_lshl_add_u32 v153, v152, 4, v153
    v_add_u32 v153, s31, v153
    s_mul_i32 s68, s68, 5120
    s_add_u32 s68, s68, s2
    s_lshl_b32 s68, s68, 10
    s_lshl_b32 s3, s3, 8
    s_add_u32 s68, s68, s3
    v_lshlrev_b32 v152, 18, v152
    v_lshl_add_u32 v152, v151, 4, v152
    v_add_u32 v152, s68, v152
    s_waitcnt lgkmcnt(0)
    s_barrier
    ds_read_b128 v[68:71], v153 offset:0
    ds_read_b128 v[72:75], v153 offset:64
    ds_read_b128 v[76:79], v153 offset:128
    ds_read_b128 v[80:83], v153 offset:192
    s_waitcnt vmcnt(0)
    ds_read_b128 v[84:87], v153 offset:4608
    ds_read_b128 v[88:91], v153 offset:4672
    ds_read_b128 v[92:95], v153 offset:4736
    ds_read_b128 v[96:99], v153 offset:4800
    s_waitcnt lgkmcnt(7)
    v_mfma_f32_16x16x32_bf16 v[100:103], v[68:71], v[116:119], 0
    v_mfma_f32_16x16x32_bf16 v[104:107], v[68:71], v[120:123], 0
    s_waitcnt lgkmcnt(6)
    v_mfma_f32_16x16x32_bf16 v[100:103], v[72:75], v[124:127], v[100:103]
    v_mfma_f32_16x16x32_bf16 v[104:107], v[72:75], v[128:131], v[104:107]
    s_waitcnt lgkmcnt(5)
    v_mfma_f32_16x16x32_bf16 v[100:103], v[76:79], v[132:135], v[100:103]
    v_mfma_f32_16x16x32_bf16 v[104:107], v[76:79], v[136:139], v[104:107]
    s_waitcnt lgkmcnt(4)
    v_mfma_f32_16x16x32_bf16 v[100:103], v[80:83], v[140:143], v[100:103]
    v_mfma_f32_16x16x32_bf16 v[104:107], v[80:83], v[144:147], v[104:107]
    ds_read_b128 v[68:71], v153 offset:9216
    ds_read_b128 v[72:75], v153 offset:9280
    ds_read_b128 v[76:79], v153 offset:9344
    ds_read_b128 v[80:83], v153 offset:9408
    s_waitcnt lgkmcnt(7)
    v_mfma_f32_16x16x32_bf16 v[108:111], v[84:87], v[116:119], 0
    v_mfma_f32_16x16x32_bf16 v[112:115], v[84:87], v[120:123], 0
    s_waitcnt lgkmcnt(6)
    v_mfma_f32_16x16x32_bf16 v[108:111], v[88:91], v[124:127], v[108:111]
    v_mfma_f32_16x16x32_bf16 v[112:115], v[88:91], v[128:131], v[112:115]
    s_waitcnt lgkmcnt(5)
    v_mfma_f32_16x16x32_bf16 v[108:111], v[92:95], v[132:135], v[108:111]
    v_mfma_f32_16x16x32_bf16 v[112:115], v[92:95], v[136:139], v[112:115]
    s_waitcnt lgkmcnt(4)
    v_mfma_f32_16x16x32_bf16 v[108:111], v[96:99], v[140:143], v[108:111]
    v_mfma_f32_16x16x32_bf16 v[112:115], v[96:99], v[144:147], v[112:115]
    v_cvt_pk_bf16_f32 v156, v100, v101
    v_cvt_pk_bf16_f32 v157, v102, v103
    v_cvt_pk_bf16_f32 v158, v104, v105
    v_cvt_pk_bf16_f32 v159, v106, v107
    s_mov_b32 s3, 0
    buffer_store_dwordx4 v[156:159], v152, s[24:27], s3 offen
    ds_read_b128 v[84:87], v153 offset:13824
    ds_read_b128 v[88:91], v153 offset:13888
    ds_read_b128 v[92:95], v153 offset:13952
    ds_read_b128 v[96:99], v153 offset:14016
    s_waitcnt lgkmcnt(7)
    v_mfma_f32_16x16x32_bf16 v[100:103], v[68:71], v[116:119], 0
    v_mfma_f32_16x16x32_bf16 v[104:107], v[68:71], v[120:123], 0
    s_waitcnt lgkmcnt(6)
    v_mfma_f32_16x16x32_bf16 v[100:103], v[72:75], v[124:127], v[100:103]
    v_mfma_f32_16x16x32_bf16 v[104:107], v[72:75], v[128:131], v[104:107]
    s_waitcnt lgkmcnt(5)
    v_mfma_f32_16x16x32_bf16 v[100:103], v[76:79], v[132:135], v[100:103]
    v_mfma_f32_16x16x32_bf16 v[104:107], v[76:79], v[136:139], v[104:107]
    s_waitcnt lgkmcnt(4)
    v_mfma_f32_16x16x32_bf16 v[100:103], v[80:83], v[140:143], v[100:103]
    v_mfma_f32_16x16x32_bf16 v[104:107], v[80:83], v[144:147], v[104:107]
    v_cvt_pk_bf16_f32 v160, v108, v109
    v_cvt_pk_bf16_f32 v161, v110, v111
    v_cvt_pk_bf16_f32 v162, v112, v113
    v_cvt_pk_bf16_f32 v163, v114, v115
    s_mov_b32 s3, 1048576
    buffer_store_dwordx4 v[160:163], v152, s[24:27], s3 offen
    ds_read_b128 v[68:71], v153 offset:18432
    ds_read_b128 v[72:75], v153 offset:18496
    ds_read_b128 v[76:79], v153 offset:18560
    ds_read_b128 v[80:83], v153 offset:18624
    s_waitcnt lgkmcnt(7)
    v_mfma_f32_16x16x32_bf16 v[108:111], v[84:87], v[116:119], 0
    v_mfma_f32_16x16x32_bf16 v[112:115], v[84:87], v[120:123], 0
    s_waitcnt lgkmcnt(6)
    v_mfma_f32_16x16x32_bf16 v[108:111], v[88:91], v[124:127], v[108:111]
    v_mfma_f32_16x16x32_bf16 v[112:115], v[88:91], v[128:131], v[112:115]
    s_waitcnt lgkmcnt(5)
    v_mfma_f32_16x16x32_bf16 v[108:111], v[92:95], v[132:135], v[108:111]
    v_mfma_f32_16x16x32_bf16 v[112:115], v[92:95], v[136:139], v[112:115]
    s_waitcnt lgkmcnt(4)
    v_mfma_f32_16x16x32_bf16 v[108:111], v[96:99], v[140:143], v[108:111]
    v_mfma_f32_16x16x32_bf16 v[112:115], v[96:99], v[144:147], v[112:115]
    v_cvt_pk_bf16_f32 v156, v100, v101
    v_cvt_pk_bf16_f32 v157, v102, v103
    v_cvt_pk_bf16_f32 v158, v104, v105
    v_cvt_pk_bf16_f32 v159, v106, v107
    s_mov_b32 s3, 2097152
    buffer_store_dwordx4 v[156:159], v152, s[24:27], s3 offen
    s_waitcnt lgkmcnt(3)
    v_mfma_f32_16x16x32_bf16 v[100:103], v[68:71], v[116:119], 0
    v_mfma_f32_16x16x32_bf16 v[104:107], v[68:71], v[120:123], 0
    s_waitcnt lgkmcnt(2)
    v_mfma_f32_16x16x32_bf16 v[100:103], v[72:75], v[124:127], v[100:103]
    v_mfma_f32_16x16x32_bf16 v[104:107], v[72:75], v[128:131], v[104:107]
    s_waitcnt lgkmcnt(1)
    v_mfma_f32_16x16x32_bf16 v[100:103], v[76:79], v[132:135], v[100:103]
    v_mfma_f32_16x16x32_bf16 v[104:107], v[76:79], v[136:139], v[104:107]
    s_waitcnt lgkmcnt(0)
    v_mfma_f32_16x16x32_bf16 v[100:103], v[80:83], v[140:143], v[100:103]
    v_mfma_f32_16x16x32_bf16 v[104:107], v[80:83], v[144:147], v[104:107]
    v_cvt_pk_bf16_f32 v160, v108, v109
    v_cvt_pk_bf16_f32 v161, v110, v111
    v_cvt_pk_bf16_f32 v162, v112, v113
    v_cvt_pk_bf16_f32 v163, v114, v115
    s_mov_b32 s3, 3145728
    buffer_store_dwordx4 v[160:163], v152, s[24:27], s3 offen
    s_nop 3
    v_cvt_pk_bf16_f32 v156, v100, v101
    v_cvt_pk_bf16_f32 v157, v102, v103
    v_cvt_pk_bf16_f32 v158, v104, v105
    v_cvt_pk_bf16_f32 v159, v106, v107
    s_mov_b32 s3, 4194304
    buffer_store_dwordx4 v[156:159], v152, s[24:27], s3 offen
L2_end:
    s_endpgm
.section .rodata,"a"
.p2align 6
.amdhsa_kernel tfn_bin_kernel
  .amdhsa_next_free_vgpr 56
  .amdhsa_next_free_sgpr 80
  .amdhsa_accum_offset 56
  .amdhsa_group_segment_fixed_size 0
  .amdhsa_kernarg_size 88
  .amdhsa_user_sgpr_count 2
  .amdhsa_user_sgpr_kernarg_segment_ptr 1
  .amdhsa_system_sgpr_workgroup_id_x 1
  .amdhsa_float_denorm_mode_32 3
.end_amdhsa_kernel
.section .rodata,"a"
.p2align 6
.amdhsa_kernel standalone__tensor_product_equiv_tfn__graph_kernel
  .amdhsa_next_free_vgpr 244
  .amdhsa_next_free_sgpr 100
  .amdhsa_accum_offset 244
  .amdhsa_group_segment_fixed_size 0
  .amdhsa_kernarg_size 88
  .amdhsa_user_sgpr_count 2
  .amdhsa_user_sgpr_kernarg_segment_ptr 1
  .amdhsa_system_sgpr_workgroup_id_x 1
  .amdhsa_float_denorm_mode_32 3
.end_amdhsa_kernel
```

```asm
; @launch kernel=tfn_bin_kernel grid=(256,1,1) block=(640,1,1) lds=83968
; @launch kernel=standalone__tensor_product_equiv_tfn__graph_kernel grid=(256,1,1) block=(512,1,1) lds=161536
.amdgcn_target "amdgcn-amd-amdhsa--gfx950"
.text
.globl tfn_bin_kernel
.p2align 8
.type tfn_bin_kernel,@function
tfn_bin_kernel:
    s_load_dwordx16 s[4:19], s[0:1], 0
    s_load_dwordx2 s[20:21], s[0:1], 80
    s_cmp_ge_u32 s2, 256
    s_cbranch_scc1 L1_end
    s_mul_i32 s34, s2, 5000
    v_lshl_add_u32 v4, v0, 3, s34
    v_lshlrev_b32 v5, 1, v4
    v_cmp_gt_u32 vcc, 625, v0
    s_mov_b64 s[40:41], vcc
    s_mov_b64 exec, vcc
    s_waitcnt lgkmcnt(0)
    global_load_dwordx2 v[8:9], v4, s[8:9]
    s_mov_b64 exec, -1
    v_lshrrev_b32 v1, 6, v0
    v_and_b32 v2, 255, v0
    v_lshlrev_b32 v2, 2, v2
    v_mov_b32 v3, 0
    v_readfirstlane_b32 s22, v1
    ds_write_b32 v2, v3 offset:61440
    s_mov_b64 exec, s[40:41]
    s_barrier
    global_load_dwordx2 v[10:11], v4, s[6:7]
    global_load_dwordx4 v[12:15], v5, s[10:11]
    s_mov_b64 exec, -1
    s_lshl_b32 s36, s34, 3
    v_lshlrev_b32 v6, 4, v0
    v_and_b32 v30, 63, v0
    s_lshl_b32 s37, s22, 10
    s_mov_b32 s24, s12
    s_mov_b32 s25, s13
    s_mov_b32 s26, 10240000
    s_mov_b32 s27, 0x00020000
    s_waitcnt lgkmcnt(0)
    s_barrier
    s_add_u32 m0, s37, 0
    s_add_u32 s38, s36, 0
    buffer_load_dwordx4 v6, s[24:27], s38 offen lds
    s_mov_b32 s39, 0
    v_mov_b32 v40, 0
    s_lshl_b32 s3, s2, 6
    v_add_u32 v31, s3, v30
    s_mov_b64 s[42:43], s[18:19]
    v_mov_b32 v32, 0
    s_cmp_eq_u32 s22, 4
    s_cbranch_scc0 L1_nomix
    v_bfe_u32 v32, v31, 10, 2
    v_lshlrev_b32 v32, 5, v32
    v_bfe_u32 v33, v31, 7, 2
    v_lshl_add_u32 v32, v33, 3, v32
    v_and_b32 v33, 7, v31
    v_add_u32 v32, v32, v33
    v_bfe_u32 v33, v31, 12, 2
    v_lshlrev_b32 v33, 5, v33
    v_bfe_u32 v34, v31, 3, 4
    v_lshl_add_u32 v33, v34, 1, v33
    v_bfe_u32 v34, v31, 9, 1
    v_add_u32 v33, v33, v34
    v_lshl_add_u32 v32, v32, 7, v33
    v_lshlrev_b32 v40, 1, v31
    v_add_u32 v40, 266240, v40
    s_mov_b32 s39, 1
L1_nomix:
    s_cmp_eq_u32 s22, 5
    s_cbranch_scc0 L1_now
    s_cmp_lt_u32 s2, 33
    s_cbranch_scc0 L1_now
    s_cmp_eq_u32 s2, 32
    s_cbranch_scc1 L1_cg
    v_bfe_u32 v32, v31, 8, 1
    v_and_b32 v33, 7, v31
    v_lshl_add_u32 v32, v32, 3, v33
    v_bfe_u32 v33, v31, 9, 1
    v_bfe_u32 v34, v31, 3, 5
    v_lshl_add_u32 v33, v33, 5, v34
    v_bfe_u32 v34, v31, 10, 1
    v_lshl_add_u32 v33, v33, 1, v34
    v_lshl_add_u32 v32, v32, 7, v33
    v_lshlrev_b32 v40, 1, v31
    v_add_u32 v40, 262144, v40
    s_mov_b32 s39, 2
    s_mov_b64 s[42:43], s[14:15]
    s_branch L1_now
L1_cg:
    v_and_b32 v32, 15, v30
    v_lshrrev_b32 v33, 4, v30
    v_lshl_add_u32 v32, v32, 2, v33
    v_lshlrev_b32 v40, 1, v30
    v_add_u32 v40, 299008, v40
    s_mov_b32 s39, 1
    s_mov_b64 s[42:43], s[16:17]
L1_now:
    v_lshlrev_b32 v32, 1, v32
    global_load_ushort v41, v32, s[42:43]
    v_mov_b32 v3, 1
    s_mov_b64 exec, s[40:41]
    s_waitcnt vmcnt(4)
    v_and_b32 v16, 7, v8
    v_bfe_u32 v18, v8, 3, 5
    v_lshl_add_u32 v16, v16, 5, v18
    v_lshlrev_b32 v16, 2, v16
    ds_add_rtn_u32 v18, v16, v3 offset:61440
    v_and_b32 v17, 7, v9
    v_bfe_u32 v19, v9, 3, 5
    v_lshl_add_u32 v17, v17, 5, v19
    v_lshlrev_b32 v17, 2, v17
    ds_add_rtn_u32 v19, v17, v3 offset:61440
    s_mov_b64 exec, -1
    v_lshlrev_b32 v31, 4, v30
    s_add_u32 m0, s37, 10240
    s_add_u32 s38, s36, 10240
    buffer_load_dwordx4 v6, s[24:27], s38 offen lds
    s_add_u32 m0, s37, 20480
    s_add_u32 s38, s36, 20480
    buffer_load_dwordx4 v6, s[24:27], s38 offen lds
    s_waitcnt lgkmcnt(0)
    s_barrier
    ds_read_b128 v[32:35], v31 offset:61440
    s_waitcnt vmcnt(4)
    v_lshlrev_b32 v20, 10, v10
    v_mul_u32_u24 v22, 157, v10
    v_lshrrev_b32 v21, 8, v8
    v_lshrrev_b32 v22, 17, v22
    s_waitcnt lgkmcnt(0)
    v_add_u32 v36, v32, v33
    v_add3_u32 v36, v36, v34, v35
    v_mov_b32 v37, v36
    v_mul_u32_u24 v21, 3407924, v21
    v_lshl_add_u32 v21, v22, 2, v21
    v_add_u32_dpp v37, v37, v37 row_shr:1 row_mask:0xf bank_mask:0xf
    v_add_u32 v21, 1060126464, v21
    v_mov_b64 v[22:23], v[12:13]
    v_add_u32_dpp v37, v37, v37 row_shr:2 row_mask:0xf bank_mask:0xf
    v_lshlrev_b32 v24, 10, v11
    v_mul_u32_u24 v26, 157, v11
    v_add_u32_dpp v37, v37, v37 row_shr:4 row_mask:0xf bank_mask:0xf
    v_lshrrev_b32 v25, 8, v9
    v_lshrrev_b32 v26, 17, v26
    v_add_u32_dpp v37, v37, v37 row_shr:8 row_mask:0xf bank_mask:0xf
    v_mul_u32_u24 v25, 3407924, v25
    v_lshl_add_u32 v25, v26, 2, v25
    v_add_u32_dpp v37, v37, v37 row_bcast:15 row_mask:0xa bank_mask:0xf
    v_add_u32 v25, 1060126464, v25
    v_mov_b64 v[26:27], v[14:15]
    v_add_u32_dpp v37, v37, v37 row_bcast:31 row_mask:0xc bank_mask:0xf
    v_sub_u32 v48, v37, v36
    v_add_u32 v49, v48, v32
    v_add_u32 v50, v49, v33
    v_add_u32 v51, v50, v34
    ds_write_b128 v31, v[48:51] offset:62464
    s_mov_b64 exec, s[40:41]
    ds_read_b32 v28, v16 offset:62464
    ds_read_b32 v29, v17 offset:62464
    v_lshlrev_b32 v36, 6, v0
    v_add_u32 v37, 32, v36
    s_waitcnt lgkmcnt(1)
    v_add_lshl_u32 v38, v28, v18, 4
    v_add_lshl_u32 v28, v28, v18, 1
    ds_write_b128 v38, v[20:23] offset:40960
    ds_write_b16 v28, v36 offset:63488
    s_waitcnt lgkmcnt(2)
    v_add_lshl_u32 v39, v29, v19, 4
    v_add_lshl_u32 v29, v29, v19, 1
    ds_write_b128 v39, v[24:27] offset:40960
    ds_write_b16 v29, v37 offset:63488
    s_mov_b64 exec, -1
    s_add_u32 m0, s37, 30720
    s_add_u32 s38, s36, 30720
    buffer_load_dwordx4 v6, s[24:27], s38 offen lds
    v_mov_b32 v46, 0
    s_cmp_lt_u32 s22, 4
    s_cbranch_scc0 L1_notab
    s_set_gpr_idx_on s22, gpr_idx(SRC0)
    v_mov_b32 v44, v32
    v_mov_b32 v52, v48
    s_set_gpr_idx_off
    s_mul_i32 s3, s2, 1280
    v_add_u32 v52, s3, v52
    v_lshl_add_u32 v47, v44, 19, v52
    v_lshl_add_u32 v46, v30, 2, s22
    v_and_b32 v53, 31, v46
    v_lshrrev_b32 v46, 5, v46
    v_lshl_add_u32 v46, v53, 3, v46
    s_and_b32 s3, s2, 7
    s_lshl_b32 s3, s3, 5
    s_lshr_b32 s38, s2, 3
    s_add_u32 s3, s3, s38
    s_lshl_b32 s3, s3, 2
    v_lshl_add_u32 v46, v46, 10, s3
    global_store_dword v46, v47, s[20:21]
L1_notab:
    v_and_b32 v7, -2, v0
    v_add_u32 v7, 63488, v7
    s_mul_i32 s3, s2, 20480
    s_add_u32 s38, s3, 1048576
    v_add_u32 v4, s38, v6
    v_add_u32 v5, 10240, v4
    v_and_b32 v20, 16, v6
    s_waitcnt lgkmcnt(0)
    s_barrier
    ds_read_b128 v[8:11], v6 offset:40960
    ds_read_b128 v[12:15], v6 offset:51200
    ds_read_u16 v16, v7 offset:0
    ds_read_u16 v17, v7 offset:640
    ds_read_u16 v18, v7 offset:1280
    ds_read_u16 v19, v7 offset:1920
    s_waitcnt lgkmcnt(5)
    global_store_dwordx4 v4, v[8:11], s[20:21] sc0 sc1
    s_waitcnt lgkmcnt(4)
    global_store_dwordx4 v5, v[12:15], s[20:21] sc0 sc1
    s_lshl_b32 s3, s3, 1
    s_add_u32 s3, s3, 8388608
    v_add_u32 v4, s3, v6
    s_waitcnt lgkmcnt(0)
    v_and_or_b32 v16, v16, -16, v20
    v_and_or_b32 v17, v17, -16, v20
    v_and_or_b32 v18, v18, -16, v20
    v_and_or_b32 v19, v19, -16, v20
    s_waitcnt vmcnt(2)
L1_tabd:
    s_barrier
    ds_read_b128 v[24:27], v16 offset:0
    ds_read_b128 v[28:31], v17 offset:0
    ds_read_b128 v[32:35], v18 offset:0
    ds_read_b128 v[36:39], v19 offset:0
    s_cmp_lt_u32 s22, 2
    s_cbranch_scc0 L1_nocpf
    s_cmp_lt_u32 s2, 16
    s_cbranch_scc0 L1_nocpf
    s_getpc_b64 s[44:45]
L1_pc:
    s_add_u32 s44, s44, standalone__tensor_product_equiv_tfn__graph_kernel-L1_pc
    s_addc_u32 s45, s45, 0
    v_min_u32 v50, 75, v0
    v_lshlrev_b32 v50, 7, v50
    v_mov_b32 v49, s45
    v_add_co_u32 v48, vcc, s44, v50
    s_nop 1
    v_addc_co_u32 v49, vcc, 0, v49, vcc
    global_load_dword v45, v[48:49], off
L1_nocpf:
    s_waitcnt lgkmcnt(3)
    global_store_dwordx4 v4, v[24:27], s[20:21] sc0 sc1
    v_add_u32 v4, 10240, v4
    s_waitcnt lgkmcnt(2)
    global_store_dwordx4 v4, v[28:31], s[20:21] sc0 sc1
    v_add_u32 v4, 10240, v4
    s_waitcnt lgkmcnt(1)
    global_store_dwordx4 v4, v[32:35], s[20:21] sc0 sc1
    v_add_u32 v4, 10240, v4
    s_waitcnt lgkmcnt(0)
    global_store_dwordx4 v4, v[36:39], s[20:21] sc0 sc1
    s_cmp_eq_u32 s39, 0
    s_cbranch_scc1 L1_nost
    s_cmp_eq_u32 s39, 1
    s_cbranch_scc1 L1_st1
    v_lshlrev_b32 v42, 16, v41
    v_mul_f32 v42, 0xbfb8aa3b, v42
    v_cvt_pk_bf16_f32 v41, v42, v42
L1_st1:
    global_store_short v40, v41, s[20:21]
L1_nost:
L1_end:
    s_endpgm
.globl standalone__tensor_product_equiv_tfn__graph_kernel
.p2align 8
.type standalone__tensor_product_equiv_tfn__graph_kernel,@function
standalone__tensor_product_equiv_tfn__graph_kernel:
    s_load_dwordx2 s[8:9], s[0:1], 80
    s_load_dwordx2 s[4:5], s[0:1], 0
    s_load_dwordx2 s[6:7], s[0:1], 64
    s_cmp_ge_u32 s2, 256
    s_cbranch_scc1 L2_end
    v_and_b32 v11, 63, v0
    s_lshl_b32 s3, s2, 10
    v_lshlrev_b32 v1, 4, v11
    v_lshrrev_b32 v12, 6, v0
    v_add_u32 v13, s3, v1
    v_readfirstlane_b32 s10, v12
    s_mov_b32 s28, 0
    s_waitcnt lgkmcnt(0)
L2_round:
    global_load_dwordx4 v[140:143], v13, s[8:9]
    v_lshlrev_b32 v194, 2, v0
    v_lshlrev_b32 v14, 3, v0
    v_mov_b32 v16, 0
    v_mov_b32 v17, 0
    v_mov_b32 v15, 0x03000000
    ds_write_b64 v14, v[16:17] offset:16128
    ds_write_b32 v194, v15 offset:20224
    ds_write_b32 v194, v15 offset:22272
    ds_write_b32 v194, v15 offset:24320
    v_lshlrev_b32 v132, 4, v0
    s_lshl_b32 s30, s10, 10
    s_add_u32 s64, s8, 262144
    s_addc_u32 s65, s9, 0
    s_mov_b32 s66, 36992
    s_mov_b32 s67, 0x00020000
    s_waitcnt lgkmcnt(0)
    s_barrier
    s_add_u32 m0, s30, 26368
    s_mov_b32 s3, 0
    buffer_load_dwordx4 v132, s[64:67], s3 offen lds
    s_add_u32 m0, s30, 34560
    s_mov_b32 s3, 8192
    buffer_load_dwordx4 v132, s[64:67], s3 offen lds
    s_add_u32 m0, s30, 42752
    s_mov_b32 s3, 16384
    buffer_load_dwordx4 v132, s[64:67], s3 offen lds
    s_add_u32 m0, s30, 50944
    s_mov_b32 s3, 24576
    buffer_load_dwordx4 v132, s[64:67], s3 offen lds
    v_and_b32 v14, 15, v11
    v_lshlrev_b32 v14, 3, v14
    s_mov_b32 s3, 36864
    buffer_load_dwordx2 v[192:193], v14, s[64:67], s3 offen
    v_add_u32 v133, 8192, v132
    v_add_u32 v134, 16384, v132
    v_add_u32 v135, 24576, v132
    v_add_u32 v136, 32768, v132
    v_add_u32 v137, 40960, v132
    v_lshrrev_b32 v195, 1, v0
    v_lshlrev_b32 v195, 2, v195
    s_add_u32 s16, s8, 1048576
    s_addc_u32 s17, s9, 0
    s_mov_b32 s18, 5242880
    s_mov_b32 s19, 0x00020000
    s_add_u32 s20, s8, 8388608
    s_addc_u32 s21, s9, 0
    s_mov_b32 s22, 10485760
    s_mov_b32 s23, 0x00020000
    s_and_b32 s31, s10, 3
    s_lshr_b32 s101, s10, 2
    v_mov_b32 v148, 0
    s_waitcnt vmcnt(5)
    v_lshrrev_b32 v144, 19, v140
    v_lshrrev_b32 v145, 19, v141
    v_lshrrev_b32 v146, 19, v142
    v_lshrrev_b32 v147, 19, v143
    v_add_u32 v150, v144, v145
    v_add3_u32 v12, v150, v146, v147
    v_add_u32 v13, s28, v12
    v_mov_b32 v149, v144
    v_add_u32_dpp v12, v12, v12 row_shr:1 row_mask:0xf bank_mask:0xf
    v_add_u32 v151, v150, v146
    s_set_gpr_idx_on s31, gpr_idx(SRC0)
    v_mov_b32 v14, v140
    v_mov_b32 v15, v144
    v_mov_b32 v16, v148
    s_set_gpr_idx_off
    v_add_u32_dpp v12, v12, v12 row_shr:2 row_mask:0xf bank_mask:0xf
    v_and_b32 v14, 0x7ffff, v14
    v_sub_u32 v16, v16, v13
    v_add_u32_dpp v12, v12, v12 row_shr:4 row_mask:0xf bank_mask:0xf
    v_subrev_u32 v17, s101, v15
    s_mov_b32 s31, s101
    v_add_u32_dpp v12, v12, v12 row_shr:8 row_mask:0xf bank_mask:0xf
    s_nop 1
    v_add_u32_dpp v12, v12, v12 row_bcast:15 row_mask:0xa bank_mask:0xf
    s_nop 1
    v_add_u32_dpp v12, v12, v12 row_bcast:31 row_mask:0xc bank_mask:0xf
    v_add_u32 v16, v16, v12
    v_readlane_b32 s11, v12, 63
    v_sub_u32 v14, v14, v16
    v_add_lshl_u32 v18, v16, s101, 2
    s_cmp_gt_u32 s11, 1536
    s_cbranch_scc1 L2_exp
    v_cmpx_lt_i32 vcc, 0, v17
    ds_write_b32 v18, v14 offset:20224
    v_cmpx_lt_i32 vcc, 2, v17
    ds_write_b32 v18, v14 offset:20232
    v_cmpx_lt_i32 vcc, 4, v17
    ds_write_b32 v18, v14 offset:20240
    v_cmpx_lt_i32 vcc, 6, v17
    ds_write_b32 v18, v14 offset:20248
    v_cmpx_lt_i32 vcc, 8, v17
    ds_write_b32 v18, v14 offset:20256
    v_cmpx_lt_i32 vcc, 10, v17
    ds_write_b32 v18, v14 offset:20264
    v_cmpx_lt_i32 vcc, 12, v17
    s_cbranch_execz L2_expd
    s_add_u32 s31, s31, 12
L2_exp:
    s_mov_b64 exec, -1
    v_cmp_lt_u32 vcc, s31, v15
    s_cbranch_vccz L2_expd
    v_add_u32 v19, s31, v16
    s_movk_i32 s3, 1536
    v_cmp_gt_u32 s[68:69], s3, v19
    v_lshlrev_b32 v19, 2, v19
    s_and_b64 exec, vcc, s[68:69]
    ds_write_b32 v19, v14 offset:20224
    s_add_u32 s31, s31, 2
    s_branch L2_exp
L2_expd:
    s_mov_b64 exec, -1
    s_waitcnt lgkmcnt(0)
    s_barrier
    ds_read_b32 v12, v194 offset:20224
    ds_read_b32 v13, v194 offset:22272
    ds_read_b32 v14, v194 offset:24320
    ds_read_b32 v152, v195 offset:20224
    ds_read_b32 v153, v195 offset:21248
    ds_read_b32 v154, v195 offset:22272
    ds_read_b32 v155, v195 offset:23296
    ds_read_b32 v156, v195 offset:24320
    ds_read_b32 v157, v195 offset:25344
    s_waitcnt lgkmcnt(8)
    v_lshl_add_u32 v12, v12, 4, v132
    buffer_load_dwordx4 v[140:143], v12, s[16:19], 0 offen
    s_waitcnt lgkmcnt(7)
    v_lshl_add_u32 v13, v13, 4, v133
    buffer_load_dwordx4 v[144:147], v13, s[16:19], 0 offen
    s_waitcnt lgkmcnt(6)
    v_lshl_add_u32 v14, v14, 4, v134
    buffer_load_dwordx4 v[148:151], v14, s[16:19], 0 offen
    s_waitcnt lgkmcnt(0)
    v_lshl_add_u32 v152, v152, 5, v132
    v_lshl_add_u32 v153, v153, 5, v133
    v_lshl_add_u32 v154, v154, 5, v134
    v_lshl_add_u32 v155, v155, 5, v135
    v_lshl_add_u32 v156, v156, 5, v136
    v_lshl_add_u32 v157, v157, 5, v137
    s_barrier
    s_add_u32 m0, s30, 63232
    s_nop 0
    buffer_load_dwordx4 v152, s[20:23], 0 offen lds
    s_add_u32 m0, s30, 71424
    s_nop 0
    buffer_load_dwordx4 v153, s[20:23], 0 offen lds
    s_sub_u32 s29, s11, s28
    s_min_u32 s29, s29, 1536
    s_lshl_b32 s3, s29, 4
    v_cmp_gt_u32 s[56:57], s3, v132
    v_lshlrev_b32 v163, 1, v132
    v_cmp_gt_u32 s[58:59], s3, v133
    v_lshlrev_b32 v165, 1, v133
    v_cmp_gt_u32 s[60:61], s3, v134
    v_lshlrev_b32 v167, 1, v134
    s_cmp_lg_u32 s28, 0
    s_cbranch_scc1 L2_noinit
    v_mov_b64 v[84:85], 0
    v_mov_b64 v[86:87], 0
    v_mov_b64 v[88:89], 0
    v_mov_b64 v[90:91], 0
    v_mov_b64 v[92:93], 0
    v_mov_b64 v[94:95], 0
    v_mov_b64 v[96:97], 0
    v_mov_b64 v[98:99], 0
    v_mov_b64 v[100:101], 0
    v_mov_b64 v[102:103], 0
    v_mov_b64 v[104:105], 0
    v_mov_b64 v[106:107], 0
    v_mov_b64 v[108:109], 0
    v_mov_b64 v[110:111], 0
    v_mov_b64 v[112:113], 0
    v_mov_b64 v[114:115], 0
    v_mov_b64 v[116:117], 0
    v_mov_b64 v[118:119], 0
    v_mov_b64 v[120:121], 0
    v_mov_b64 v[122:123], 0
    v_mov_b64 v[124:125], 0
    v_mov_b64 v[126:127], 0
    v_mov_b64 v[128:129], 0
    v_mov_b64 v[130:131], 0
    v_mov_b64 v[24:25], 0
    v_mov_b64 v[26:27], 0
    v_mov_b64 v[28:29], 0
    v_mov_b64 v[30:31], 0
    s_mov_b32 s32, 0x0f0f0f0f
    s_mov_b32 s33, s32
    s_not_b64 s[34:35], s[32:33]
    v_lshrrev_b32 v2, 5, v11
    v_lshlrev_b32 v2, 4, v2
    v_and_b32 v3, 3, v11
    v_lshlrev_b32 v3, 3, v3
    v_add_u32 v3, 112384, v3
    s_mov_b32 s12, s4
    s_mov_b32 s13, s5
    s_mov_b32 s14, 10240000
    s_mov_b32 s15, 0x00020000
    s_mov_b32 s24, s6
    s_mov_b32 s25, s7
    s_mov_b32 s26, 10240000
    s_mov_b32 s27, 0x00020000
L2_noinit:
    v_and_b32 v4, 15, v11
    v_lshlrev_b32 v4, 3, v4
    v_bfe_u32 v5, v11, 3, 2
    v_and_b32 v12, 3, v11
    v_lshl_add_u32 v5, v5, 2, v12
    v_lshlrev_b32 v5, 3, v5
    v_lshrrev_b32 v6, 2, v11
    v_lshlrev_b32 v6, 3, v6
    s_mov_b32 s68, 0
    s_cmp_lt_u32 s2, 16
    s_cbranch_scc1 L2_r40
    s_cmp_eq_u32 s10, 0
    s_cselect_b32 s68, 0x274090c0, s68
    s_cmp_eq_u32 s10, 1
    s_cselect_b32 s68, 0x24798441, s68
    s_cmp_eq_u32 s10, 2
    s_cselect_b32 s68, 0x26657302, s68
    s_cmp_eq_u32 s10, 3
    s_cselect_b32 s68, 0x257522c4, s68
    s_cmp_eq_u32 s10, 4
    s_cselect_b32 s68, 0x236d33c5, s68
    s_cmp_eq_u32 s10, 5
    s_cselect_b32 s68, 0x217d6286, s68
    s_cmp_eq_u32 s10, 6
    s_cselect_b32 s68, 0x22695347, s68
    s_cmp_eq_u32 s10, 7
    s_cselect_b32 s68, 0x20714388, s68
    s_branch L2_rd
L2_r40:
    s_cmp_eq_u32 s10, 0
    s_cselect_b32 s68, 0x278d5200, s68
    s_cmp_eq_u32 s10, 1
    s_cselect_b32 s68, 0x266143c1, s68
    s_cmp_eq_u32 s10, 2
    s_cselect_b32 s68, 0x25693342, s68
    s_cmp_eq_u32 s10, 3
    s_cselect_b32 s68, 0x24792243, s68
    s_cmp_eq_u32 s10, 4
    s_cselect_b32 s68, 0x22751304, s68
    s_cmp_eq_u32 s10, 5
    s_cselect_b32 s68, 0x216572c5, s68
    s_cmp_eq_u32 s10, 6
    s_cselect_b32 s68, 0x20710386, s68
    s_cmp_eq_u32 s10, 7
    s_cselect_b32 s68, 0x1f6d6287, s68
L2_rd:
    v_mul_u32_u24 v16, 52, v11
    v_lshrrev_b32 v16, 8, v16
    v_mul_u32_u24 v17, 5, v16
    v_sub_u32 v17, v11, v17
    v_mul_u32_u24 v15, 6, v17
    v_bfe_u32 v15, s68, v15, 6
    v_lshlrev_b32 v15, 2, v15
    v_lshlrev_b32 v16, 2, v16
    v_lshlrev_b32 v17, 19, v17
    s_mul_i32 s3, s10, 5
    v_min_u32 v18, 43, v11
    v_mul_u32_u24 v18, 52, v18
    v_add_u32 v21, s3, v11
    v_min_u32 v19, 43, v21
    v_mul_u32_u24 v19, 52, v19
    v_cmp_gt_u32 vcc, 40, v11
    v_add_u32 v20, 1, v11
    v_add_u32 v21, 1, v21
    v_cndmask_b32 v20, 0, v20, vcc
    s_cmp_gt_u32 s11, 1536
    s_cselect_b32 s69, 0, 8
    v_mov_b32 v22, 8
    s_cmp_lt_u32 s10, 4
    s_cselect_b32 s70, 1, 0
    s_waitcnt vmcnt(4)
    s_mov_b64 exec, s[56:57]
    v_lshrrev_b32 v12, 16, v141
    v_and_b32 v141, 0xffff, v141
    ds_add_u32 v12, v22
    ds_add_rtn_u32 v158, v141, v22
    s_waitcnt vmcnt(3)
    s_mov_b64 exec, s[58:59]
    v_lshrrev_b32 v13, 16, v145
    v_and_b32 v145, 0xffff, v145
    ds_add_u32 v13, v22
    ds_add_rtn_u32 v159, v145, v22
    s_waitcnt vmcnt(2)
    s_mov_b64 exec, s[60:61]
    v_lshrrev_b32 v14, 16, v149
    v_and_b32 v149, 0xffff, v149
    ds_add_u32 v14, v22
    ds_add_rtn_u32 v160, v149, v22
    s_mov_b64 exec, -1
    s_add_u32 m0, s30, 79616
    s_nop 0
    buffer_load_dwordx4 v154, s[20:23], 0 offen lds
    v_mfma_f32_4x4x4_16b_bf16 v[168:171], v[192:193], v[142:143], 0 cbsz:4 abid:0
    v_mfma_f32_4x4x4_16b_bf16 v[172:175], v[192:193], v[142:143], 0 cbsz:4 abid:1
    v_mfma_f32_4x4x4_16b_bf16 v[176:179], v[192:193], v[142:143], 0 cbsz:4 abid:2
    v_mfma_f32_4x4x4_16b_bf16 v[180:183], v[192:193], v[142:143], 0 cbsz:4 abid:3
    v_add_u32 v23, 112384, v163
    s_nop 0
    v_cvt_pk_bf16_f32 v184, v168, v169
    v_cvt_pk_bf16_f32 v185, v170, v171
    v_cvt_pk_bf16_f32 v186, v172, v173
    v_cvt_pk_bf16_f32 v187, v174, v175
    v_cvt_pk_bf16_f32 v188, v176, v177
    v_cvt_pk_bf16_f32 v189, v178, v179
    v_cvt_pk_bf16_f32 v190, v180, v181
    v_cvt_pk_bf16_f32 v191, v182, v183
    s_waitcnt lgkmcnt(0)
    s_barrier
    ds_read_b32 v12, v18 offset:16176
    ds_read_b32 v13, v19 offset:16176
    ds_write_b128 v23, v[184:187]
    ds_write_b128 v23, v[188:191] offset:16
    s_waitcnt lgkmcnt(2)
    v_mad_u32_u24 v21, v13, s69, v21
    v_mad_u32_u24 v20, v12, s69, v20
    v_readlane_b32 s96, v21, 0
    v_readlane_b32 s97, v21, 1
    v_readlane_b32 s98, v21, 2
    v_readlane_b32 s99, v21, 3
    v_readlane_b32 s100, v21, 4
    v_lshl_add_u32 v19, v13, 16, v19
    v_cmp_lt_u32 s[36:37], s96, v20
    v_cmp_lt_u32 s[38:39], s97, v20
    v_cmp_lt_u32 s[40:41], s98, v20
    v_cmp_lt_u32 s[42:43], s99, v20
    v_cmp_lt_u32 s[44:45], s100, v20
    s_bcnt1_i32_b64 s96, s[36:37]
    v_writelane_b32 v12, s96, 0
    s_bcnt1_i32_b64 s97, s[38:39]
    v_writelane_b32 v12, s97, 1
    s_bcnt1_i32_b64 s98, s[40:41]
    v_writelane_b32 v12, s98, 2
    s_bcnt1_i32_b64 s99, s[42:43]
    v_writelane_b32 v12, s99, 3
    s_bcnt1_i32_b64 s100, s[44:45]
    v_writelane_b32 v12, s100, 4
    s_mov_b64 exec, 31
    v_lshlrev_b32 v12, 2, v12
    ds_write_b32 v12, v19 offset:18432
    s_mov_b64 exec, -1
    s_add_u32 m0, s30, 87808
    s_nop 0
    buffer_load_dwordx4 v155, s[20:23], 0 offen lds
    s_waitcnt lgkmcnt(0)
    s_barrier
    ds_read_b32 v12, v15 offset:18432
    v_mfma_f32_4x4x4_16b_bf16 v[168:171], v[192:193], v[146:147], 0 cbsz:4 abid:0
    v_mfma_f32_4x4x4_16b_bf16 v[172:175], v[192:193], v[146:147], 0 cbsz:4 abid:1
    v_mfma_f32_4x4x4_16b_bf16 v[176:179], v[192:193], v[146:147], 0 cbsz:4 abid:2
    v_mfma_f32_4x4x4_16b_bf16 v[180:183], v[192:193], v[146:147], 0 cbsz:4 abid:3
    v_add_u32 v23, 112384, v165
    s_nop 0
    v_cvt_pk_bf16_f32 v184, v168, v169
    v_cvt_pk_bf16_f32 v185, v170, v171
    v_cvt_pk_bf16_f32 v186, v172, v173
    v_cvt_pk_bf16_f32 v187, v174, v175
    v_cvt_pk_bf16_f32 v188, v176, v177
    v_cvt_pk_bf16_f32 v189, v178, v179
    v_cvt_pk_bf16_f32 v190, v180, v181
    v_cvt_pk_bf16_f32 v191, v182, v183
    s_waitcnt lgkmcnt(0)
    v_add_u32_sdwa v16, v12, v16 dst_sel:DWORD dst_unused:UNUSED_PAD src0_sel:WORD_0 src1_sel:DWORD
    ds_read_b32 v13, v16 offset:16128
    v_readlane_b32 s96, v12, 0
    v_readlane_b32 s97, v12, 1
    v_readlane_b32 s98, v12, 2
    v_readlane_b32 s99, v12, 3
    v_readlane_b32 s100, v12, 4
    s_add_u32 s3, s96, s97
    s_add_u32 s3, s3, s98
    s_add_u32 s3, s3, s99
    s_add_u32 s3, s3, s100
    s_lshr_b32 s29, s3, 16
    s_add_u32 s3, s29, 480
    v_mov_b32 v14, s3
    v_mov_b32 v18, 0
    s_mov_b64 exec, 1
    ds_add_rtn_u32 v14, v18, v14 offset:18688
    s_mov_b64 exec, -1
    s_waitcnt lgkmcnt(1)
    v_sub_u32 v17, v17, v13
    s_nop 0
    v_add_u32_dpp v13, v13, v13 row_shr:1 row_mask:0xf bank_mask:0xf
    s_nop 1
    v_add_u32_dpp v13, v13, v13 row_shr:2 row_mask:0xf bank_mask:0xf
    v_mov_b32 v20, 2147482664
    v_mov_b32 v21, 0
    v_add_u32_dpp v13, v13, v13 row_shr:4 row_mask:0xf bank_mask:0xf
    s_nop 1
    v_add_u32_dpp v13, v13, v13 row_shr:8 row_mask:0xf bank_mask:0xf
    s_waitcnt lgkmcnt(0)
    v_readfirstlane_b32 s71, v14
    v_add_u32_dpp v13, v13, v13 row_bcast:15 row_mask:0xa bank_mask:0xf
    s_add_u32 s3, s71, s29
    v_lshl_add_u32 v18, v11, 3, s3
    v_add_u32_dpp v13, v13, v13 row_bcast:31 row_mask:0xc bank_mask:0xf
    s_mov_b32 exec_hi, 0x0fffffff
    v_add3_u32 v13, v13, v17, s71
    ds_write_b32 v16, v13 offset:16128
    ds_write_b64 v18, v[20:21] offset:0
    s_mov_b64 exec, -1
    ds_write_b128 v23, v[184:187]
    ds_write_b128 v23, v[188:191] offset:16
    s_add_u32 m0, s30, 96000
    s_nop 0
    buffer_load_dwordx4 v156, s[20:23], 0 offen lds
    s_waitcnt lgkmcnt(2)
    s_barrier
    ds_read_b32 v12, v141
    ds_read_b32 v13, v145
    ds_read_b32 v14, v149
    v_add_u32 v4, s71, v4
    v_add_u32 v5, s71, v5
    v_add_u32 v6, s71, v6
    s_lshr_b32 s29, s29, 3
    s_mov_b64 exec, s[56:57]
    s_waitcnt lgkmcnt(2)
    v_add_u32_sdwa v158, v12, v158 dst_sel:DWORD dst_unused:UNUSED_PAD src0_sel:WORD_0 src1_sel:DWORD
    v_or_b32_sdwa v162, v12, v140 dst_sel:DWORD dst_unused:UNUSED_PAD src0_sel:WORD_1 src1_sel:DWORD
    ds_write_b64 v158, v[162:163] offset:0
    s_mov_b64 exec, s[58:59]
    s_waitcnt lgkmcnt(2)
    v_add_u32_sdwa v159, v13, v159 dst_sel:DWORD dst_unused:UNUSED_PAD src0_sel:WORD_0 src1_sel:DWORD
    v_or_b32_sdwa v164, v13, v144 dst_sel:DWORD dst_unused:UNUSED_PAD src0_sel:WORD_1 src1_sel:DWORD
    ds_write_b64 v159, v[164:165] offset:0
    s_mov_b64 exec, s[60:61]
    s_waitcnt lgkmcnt(2)
    v_add_u32_sdwa v160, v14, v160 dst_sel:DWORD dst_unused:UNUSED_PAD src0_sel:WORD_0 src1_sel:DWORD
    v_or_b32_sdwa v166, v14, v148 dst_sel:DWORD dst_unused:UNUSED_PAD src0_sel:WORD_1 src1_sel:DWORD
    ds_write_b64 v160, v[166:167] offset:0
    s_mov_b64 exec, -1
    s_add_u32 m0, s30, 104192
    s_nop 0
    buffer_load_dwordx4 v157, s[20:23], 0 offen lds
    s_cmp_eq_u32 s70, 0
    s_cbranch_scc1 L2_nowb
    s_add_u32 m0, s30, 59136
    s_mov_b32 s3, 32768
    buffer_load_dwordx4 v132, s[64:67], s3 offen lds
L2_nowb:
    s_waitcnt lgkmcnt(0)
    s_barrier
    ds_read_b32 v12, v4
    ds_read_b32 v7, v4 offset:64
    ds_read_b32 v9, v5 offset:4
    ds_read_b32 v10, v6 offset:4
    s_cmp_eq_u64 s[60:61], 0
    s_cbranch_scc1 L2_not3
    v_mfma_f32_4x4x4_16b_bf16 v[168:171], v[192:193], v[150:151], 0 cbsz:4 abid:0
    v_mfma_f32_4x4x4_16b_bf16 v[172:175], v[192:193], v[150:151], 0 cbsz:4 abid:1
    v_mfma_f32_4x4x4_16b_bf16 v[176:179], v[192:193], v[150:151], 0 cbsz:4 abid:2
    v_mfma_f32_4x4x4_16b_bf16 v[180:183], v[192:193], v[150:151], 0 cbsz:4 abid:3
    v_add_u32 v23, 112384, v167
    s_nop 0
    v_cvt_pk_bf16_f32 v184, v168, v169
    v_cvt_pk_bf16_f32 v185, v170, v171
    v_cvt_pk_bf16_f32 v186, v172, v173
    v_cvt_pk_bf16_f32 v187, v174, v175
    v_cvt_pk_bf16_f32 v188, v176, v177
    v_cvt_pk_bf16_f32 v189, v178, v179
    v_cvt_pk_bf16_f32 v190, v180, v181
    v_cvt_pk_bf16_f32 v191, v182, v183
    ds_write_b128 v23, v[184:187]
    ds_write_b128 v23, v[188:191] offset:16
L2_not3:
    ds_read_b128 v[36:39], v1 offset:26368
    ds_read_b128 v[40:43], v1 offset:27392
    ds_read_b128 v[44:47], v1 offset:28416
    ds_read_b128 v[48:51], v1 offset:29440
    s_waitcnt lgkmcnt(4)
    v_readlane_b32 s36, v12, 0
    s_and_b32 s68, s36, 0xfffffc00
    buffer_load_dwordx4 v[196:199], v1, s[12:15], s68 offen
    v_readlane_b32 s37, v12, 1
    s_and_b32 s69, s37, 0xfffffc00
    buffer_load_dwordx4 v[200:203], v1, s[12:15], s69 offen
    v_readlane_b32 s38, v12, 2
    s_and_b32 s68, s38, 0xfffffc00
    buffer_load_dwordx4 v[204:207], v1, s[12:15], s68 offen
    v_readlane_b32 s39, v12, 3
    s_and_b32 s69, s39, 0xfffffc00
    buffer_load_dwordx4 v[208:211], v1, s[12:15], s69 offen
    v_readlane_b32 s40, v12, 4
    s_and_b32 s68, s40, 0xfffffc00
    buffer_load_dwordx4 v[212:215], v1, s[12:15], s68 offen
    v_readlane_b32 s41, v12, 5
    s_and_b32 s69, s41, 0xfffffc00
    buffer_load_dwordx4 v[216:219], v1, s[12:15], s69 offen
    v_readlane_b32 s42, v12, 6
    s_and_b32 s68, s42, 0xfffffc00
    buffer_load_dwordx4 v[220:223], v1, s[12:15], s68 offen
    v_readlane_b32 s43, v12, 7
    s_and_b32 s69, s43, 0xfffffc00
    buffer_load_dwordx4 v[224:227], v1, s[12:15], s69 offen
    v_add_u32 v9, v9, v2
    v_add_u32 v10, v10, v3
    s_and_b32 s3, s10, 3
    s_lshl_b32 s3, s3, 13
    v_add_u32 v16, s3, v1
    v_readlane_b32 s44, v7, 0
    s_and_b32 s31, s44, 0xfffffc00
    s_waitcnt vmcnt(8) lgkmcnt(0)
    s_barrier
    s_mov_b64 exec, s[32:33]
    ds_read_b128 v[24:27], v9 offset:63232
    s_mov_b64 exec, s[34:35]
    ds_read_b128 v[28:31], v9 offset:63232
    s_mov_b64 exec, -1
    ds_read_b64 v[32:33], v10
    ds_read_b128 v[52:55], v16 offset:30464
    ds_read_b128 v[56:59], v16 offset:31488
    ds_read_b128 v[60:63], v16 offset:32512
    ds_read_b128 v[64:67], v16 offset:33536
    ds_read_b128 v[68:71], v16 offset:34560
    ds_read_b128 v[72:75], v16 offset:35584
    ds_read_b128 v[76:79], v16 offset:36608
    ds_read_b128 v[80:83], v16 offset:37632
    s_waitcnt lgkmcnt(9)
    v_mfma_f32_32x32x16_bf16 v[132:147], v[24:27], v[36:39], 0
    v_mfma_f32_32x32x16_bf16 v[132:147], v[28:31], v[40:43], v[132:147]
    v_mfma_f32_32x32x16_bf16 v[148:163], v[24:27], v[44:47], 0
    v_mfma_f32_32x32x16_bf16 v[148:163], v[28:31], v[48:51], v[148:163]
    s_waitcnt lgkmcnt(0)
    s_barrier
    s_cmp_eq_u32 s29, 0
    s_cbranch_scc1 L2_exit
    s_sub_u32 s29, s29, 1
    s_nop 6
    v_exp_f32 v12, v132
    v_exp_f32 v13, v133
    v_exp_f32 v14, v148
    v_exp_f32 v15, v149
    v_pk_add_f32 v[12:13], v[12:13], 1.0 op_sel_hi:[1,0]
    v_pk_add_f32 v[14:15], v[14:15], 1.0 op_sel_hi:[1,0]
    v_rcp_f32 v12, v12
    v_rcp_f32 v13, v13
    s_nop 0
    v_pk_mul_f32 v[132:133], v[132:133], v[12:13]
L2_loop:
    s_setprio 3
    ds_read_b32 v9, v5 offset:132
    ds_read_b32 v10, v6 offset:132
    ds_read_b32 v8, v4 offset:192
    v_exp_f32 v12, v134
    s_waitcnt vmcnt(7)
    v_mfma_f32_4x4x4_16b_bf16 v[16:19], v[32:33], v[196:197], 0 cbsz:4 abid:0
    v_exp_f32 v13, v135
    v_mfma_f32_4x4x4_16b_bf16 v[20:23], v[32:33], v[198:199], 0 cbsz:4 abid:0
    v_readlane_b32 s45, v7, 1
    v_rcp_f32 v14, v14
    buffer_load_dwordx4 v[196:199], v1, s[12:15], s31 offen
    v_rcp_f32 v15, v15
    v_pk_add_f32 v[12:13], v[12:13], 1.0 op_sel_hi:[1,0]
    v_pk_mul_f32 v[148:149], v[148:149], v[14:15]
    s_set_gpr_idx_on s36, gpr_idx(SRC2,DST)
    v_pk_fma_f32 v[84:85], v[132:133], v[16:17], v[84:85] op_sel_hi:[0,1,1]
    v_pk_fma_f32 v[86:87], v[132:133], v[18:19], v[86:87] op_sel_hi:[0,1,1]
    v_pk_fma_f32 v[88:89], v[148:149], v[20:21], v[88:89] op_sel_hi:[0,1,1]
    v_pk_fma_f32 v[90:91], v[148:149], v[22:23], v[90:91] op_sel_hi:[0,1,1]
    s_set_gpr_idx_off
    s_and_b32 s31, s45, 0xfffffc00
    v_exp_f32 v14, v150
    s_waitcnt vmcnt(7)
    v_mfma_f32_4x4x4_16b_bf16 v[16:19], v[32:33], v[200:201], 0 cbsz:4 abid:1
    v_exp_f32 v15, v151
    v_mfma_f32_4x4x4_16b_bf16 v[20:23], v[32:33], v[202:203], 0 cbsz:4 abid:1
    v_readlane_b32 s46, v7, 2
    v_rcp_f32 v12, v12
    buffer_load_dwordx4 v[200:203], v1, s[12:15], s31 offen
    v_rcp_f32 v13, v13
    v_pk_add_f32 v[14:15], v[14:15], 1.0 op_sel_hi:[1,0]
    v_pk_mul_f32 v[134:135], v[134:135], v[12:13]
    s_set_gpr_idx_on s37, gpr_idx(SRC2,DST)
    v_pk_fma_f32 v[84:85], v[132:133], v[16:17], v[84:85] op_sel:[1,0,0]
    v_pk_fma_f32 v[86:87], v[132:133], v[18:19], v[86:87] op_sel:[1,0,0]
    v_pk_fma_f32 v[88:89], v[148:149], v[20:21], v[88:89] op_sel:[1,0,0]
    v_pk_fma_f32 v[90:91], v[148:149], v[22:23], v[90:91] op_sel:[1,0,0]
    s_set_gpr_idx_off
    s_and_b32 s31, s46, 0xfffffc00
    s_waitcnt lgkmcnt(0)
    v_add_u32 v9, v9, v2
    v_add_u32 v10, v10, v3
    s_mov_b64 exec, s[32:33]
    ds_read_b128 v[24:27], v9 offset:63232
    s_mov_b64 exec, s[34:35]
    ds_read_b128 v[28:31], v9 offset:63232
    s_mov_b64 exec, -1
    ds_read_b64 v[34:35], v10
    v_exp_f32 v12, v136
    s_waitcnt vmcnt(7)
    v_mfma_f32_4x4x4_16b_bf16 v[16:19], v[32:33], v[204:205], 0 cbsz:4 abid:2
    v_exp_f32 v13, v137
    v_mfma_f32_4x4x4_16b_bf16 v[20:23], v[32:33], v[206:207], 0 cbsz:4 abid:2
    v_readlane_b32 s47, v7, 3
    v_rcp_f32 v14, v14
    buffer_load_dwordx4 v[204:207], v1, s[12:15], s31 offen
    v_rcp_f32 v15, v15
    v_pk_add_f32 v[12:13], v[12:13], 1.0 op_sel_hi:[1,0]
    v_pk_mul_f32 v[150:151], v[150:151], v[14:15]
    s_set_gpr_idx_on s38, gpr_idx(SRC2,DST)
    v_pk_fma_f32 v[84:85], v[134:135], v[16:17], v[84:85] op_sel_hi:[0,1,1]
    v_pk_fma_f32 v[86:87], v[134:135], v[18:19], v[86:87] op_sel_hi:[0,1,1]
    v_pk_fma_f32 v[88:89], v[150:151], v[20:21], v[88:89] op_sel_hi:[0,1,1]
    v_pk_fma_f32 v[90:91], v[150:151], v[22:23], v[90:91] op_sel_hi:[0,1,1]
    s_set_gpr_idx_off
    s_and_b32 s31, s47, 0xfffffc00
    v_exp_f32 v14, v152
    s_waitcnt vmcnt(7)
    v_mfma_f32_4x4x4_16b_bf16 v[16:19], v[32:33], v[208:209], 0 cbsz:4 abid:3
    v_exp_f32 v15, v153
    v_mfma_f32_4x4x4_16b_bf16 v[20:23], v[32:33], v[210:211], 0 cbsz:4 abid:3
    v_readlane_b32 s48, v7, 4
    v_rcp_f32 v12, v12
    buffer_load_dwordx4 v[208:211], v1, s[12:15], s31 offen
    v_rcp_f32 v13, v13
    v_pk_add_f32 v[14:15], v[14:15], 1.0 op_sel_hi:[1,0]
    v_pk_mul_f32 v[136:137], v[136:137], v[12:13]
    s_set_gpr_idx_on s39, gpr_idx(SRC2,DST)
    v_pk_fma_f32 v[84:85], v[134:135], v[16:17], v[84:85] op_sel:[1,0,0]
    v_pk_fma_f32 v[86:87], v[134:135], v[18:19], v[86:87] op_sel:[1,0,0]
    v_pk_fma_f32 v[88:89], v[150:151], v[20:21], v[88:89] op_sel:[1,0,0]
    v_pk_fma_f32 v[90:91], v[150:151], v[22:23], v[90:91] op_sel:[1,0,0]
    s_set_gpr_idx_off
    s_and_b32 s31, s48, 0xfffffc00
    s_sub_u32 s29, s29, 4
    s_cbranch_scc1 L2_exit
    s_setprio 2
    v_exp_f32 v12, v138
    s_waitcnt vmcnt(7)
    v_mfma_f32_4x4x4_16b_bf16 v[16:19], v[32:33], v[212:213], 0 cbsz:4 abid:4
    v_exp_f32 v13, v139
    v_mfma_f32_4x4x4_16b_bf16 v[20:23], v[32:33], v[214:215], 0 cbsz:4 abid:4
    v_readlane_b32 s49, v7, 5
    v_rcp_f32 v14, v14
    buffer_load_dwordx4 v[212:215], v1, s[12:15], s31 offen
    v_rcp_f32 v15, v15
    v_pk_add_f32 v[12:13], v[12:13], 1.0 op_sel_hi:[1,0]
    v_pk_mul_f32 v[152:153], v[152:153], v[14:15]
    s_set_gpr_idx_on s40, gpr_idx(SRC2,DST)
    v_pk_fma_f32 v[84:85], v[136:137], v[16:17], v[84:85] op_sel_hi:[0,1,1]
    v_pk_fma_f32 v[86:87], v[136:137], v[18:19], v[86:87] op_sel_hi:[0,1,1]
    v_pk_fma_f32 v[88:89], v[152:153], v[20:21], v[88:89] op_sel_hi:[0,1,1]
    v_pk_fma_f32 v[90:91], v[152:153], v[22:23], v[90:91] op_sel_hi:[0,1,1]
    s_set_gpr_idx_off
    s_and_b32 s31, s49, 0xfffffc00
    s_waitcnt lgkmcnt(0)
    s_waitcnt vmcnt(7)
    v_mfma_f32_4x4x4_16b_bf16 v[16:19], v[32:33], v[216:217], 0 cbsz:4 abid:5
    v_readlane_b32 s50, v7, 6
    v_mfma_f32_4x4x4_16b_bf16 v[20:23], v[32:33], v[218:219], 0 cbsz:4 abid:5
    v_mfma_f32_32x32x16_bf16 v[164:179], v[24:27], v[36:39], 0
    v_exp_f32 v14, v154
    v_exp_f32 v15, v155
    v_rcp_f32 v12, v12
    v_rcp_f32 v13, v13
    buffer_load_dwordx4 v[216:219], v1, s[12:15], s31 offen
    v_pk_add_f32 v[14:15], v[14:15], 1.0 op_sel_hi:[1,0]
    v_pk_mul_f32 v[138:139], v[138:139], v[12:13]
    s_set_gpr_idx_on s41, gpr_idx(SRC2,DST)
    v_pk_fma_f32 v[84:85], v[136:137], v[16:17], v[84:85] op_sel:[1,0,0]
    v_pk_fma_f32 v[86:87], v[136:137], v[18:19], v[86:87] op_sel:[1,0,0]
    v_pk_fma_f32 v[88:89], v[152:153], v[20:21], v[88:89] op_sel:[1,0,0]
    v_pk_fma_f32 v[90:91], v[152:153], v[22:23], v[90:91] op_sel:[1,0,0]
    s_set_gpr_idx_off
    s_and_b32 s31, s50, 0xfffffc00
    v_exp_f32 v12, v140
    s_waitcnt vmcnt(7)
    v_mfma_f32_4x4x4_16b_bf16 v[16:19], v[32:33], v[220:221], 0 cbsz:4 abid:6
    v_exp_f32 v13, v141
    v_mfma_f32_4x4x4_16b_bf16 v[20:23], v[32:33], v[222:223], 0 cbsz:4 abid:6
    v_readlane_b32 s51, v7, 7
    v_rcp_f32 v14, v14
    buffer_load_dwordx4 v[220:223], v1, s[12:15], s31 offen
    v_rcp_f32 v15, v15
    v_pk_add_f32 v[12:13], v[12:13], 1.0 op_sel_hi:[1,0]
    v_pk_mul_f32 v[154:155], v[154:155], v[14:15]
    s_set_gpr_idx_on s42, gpr_idx(SRC2,DST)
    v_pk_fma_f32 v[84:85], v[138:139], v[16:17], v[84:85] op_sel_hi:[0,1,1]
    v_pk_fma_f32 v[86:87], v[138:139], v[18:19], v[86:87] op_sel_hi:[0,1,1]
    v_pk_fma_f32 v[88:89], v[154:155], v[20:21], v[88:89] op_sel_hi:[0,1,1]
    v_pk_fma_f32 v[90:91], v[154:155], v[22:23], v[90:91] op_sel_hi:[0,1,1]
    s_set_gpr_idx_off
    s_and_b32 s31, s51, 0xfffffc00
    s_waitcnt vmcnt(7)
    v_mfma_f32_4x4x4_16b_bf16 v[16:19], v[32:33], v[224:225], 0 cbsz:4 abid:7
    v_readlane_b32 s52, v7, 8
    v_mfma_f32_4x4x4_16b_bf16 v[20:23], v[32:33], v[226:227], 0 cbsz:4 abid:7
    v_mfma_f32_32x32x16_bf16 v[164:179], v[28:31], v[40:43], v[164:179]
    v_exp_f32 v14, v156
    v_exp_f32 v15, v157
    v_rcp_f32 v12, v12
    v_rcp_f32 v13, v13
    buffer_load_dwordx4 v[224:227], v1, s[12:15], s31 offen
    v_pk_add_f32 v[14:15], v[14:15], 1.0 op_sel_hi:[1,0]
    v_pk_mul_f32 v[140:141], v[140:141], v[12:13]
    s_set_gpr_idx_on s43, gpr_idx(SRC2,DST)
    v_pk_fma_f32 v[84:85], v[138:139], v[16:17], v[84:85] op_sel:[1,0,0]
    v_pk_fma_f32 v[86:87], v[138:139], v[18:19], v[86:87] op_sel:[1,0,0]
    v_pk_fma_f32 v[88:89], v[154:155], v[20:21], v[88:89] op_sel:[1,0,0]
    v_pk_fma_f32 v[90:91], v[154:155], v[22:23], v[90:91] op_sel:[1,0,0]
    s_set_gpr_idx_off
    s_and_b32 s31, s52, 0xfffffc00
    s_sub_u32 s29, s29, 4
    s_cbranch_scc1 L2_exit
    s_setprio 1
    v_exp_f32 v12, v142
    s_waitcnt vmcnt(7)
    v_mfma_f32_4x4x4_16b_bf16 v[16:19], v[32:33], v[196:197], 0 cbsz:4 abid:8
    v_exp_f32 v13, v143
    v_mfma_f32_4x4x4_16b_bf16 v[20:23], v[32:33], v[198:199], 0 cbsz:4 abid:8
    v_readlane_b32 s53, v7, 9
    v_rcp_f32 v14, v14
    buffer_load_dwordx4 v[196:199], v1, s[12:15], s31 offen
    v_rcp_f32 v15, v15
    v_pk_add_f32 v[12:13], v[12:13], 1.0 op_sel_hi:[1,0]
    v_pk_mul_f32 v[156:157], v[156:157], v[14:15]
    s_set_gpr_idx_on s44, gpr_idx(SRC2,DST)
    v_pk_fma_f32 v[84:85], v[140:141], v[16:17], v[84:85] op_sel_hi:[0,1,1]
    v_pk_fma_f32 v[86:87], v[140:141], v[18:19], v[86:87] op_sel_hi:[0,1,1]
    v_pk_fma_f32 v[88:89], v[156:157], v[20:21], v[88:89] op_sel_hi:[0,1,1]
    v_pk_fma_f32 v[90:91], v[156:157], v[22:23], v[90:91] op_sel_hi:[0,1,1]
    s_set_gpr_idx_off
    s_and_b32 s31, s53, 0xfffffc00
    s_waitcnt vmcnt(7)
    v_mfma_f32_4x4x4_16b_bf16 v[16:19], v[32:33], v[200:201], 0 cbsz:4 abid:9
    v_readlane_b32 s54, v7, 10
    v_mfma_f32_4x4x4_16b_bf16 v[20:23], v[32:33], v[202:203], 0 cbsz:4 abid:9
    v_mfma_f32_32x32x16_bf16 v[180:195], v[24:27], v[44:47], 0
    v_exp_f32 v14, v158
    v_exp_f32 v15, v159
    v_rcp_f32 v12, v12
    v_rcp_f32 v13, v13
    buffer_load_dwordx4 v[200:203], v1, s[12:15], s31 offen
    v_pk_add_f32 v[14:15], v[14:15], 1.0 op_sel_hi:[1,0]
    v_pk_mul_f32 v[142:143], v[142:143], v[12:13]
    s_set_gpr_idx_on s45, gpr_idx(SRC2,DST)
    v_pk_fma_f32 v[84:85], v[140:141], v[16:17], v[84:85] op_sel:[1,0,0]
    v_pk_fma_f32 v[86:87], v[140:141], v[18:19], v[86:87] op_sel:[1,0,0]
    v_pk_fma_f32 v[88:89], v[156:157], v[20:21], v[88:89] op_sel:[1,0,0]
    v_pk_fma_f32 v[90:91], v[156:157], v[22:23], v[90:91] op_sel:[1,0,0]
    s_set_gpr_idx_off
    s_and_b32 s31, s54, 0xfffffc00
    v_exp_f32 v12, v144
    s_waitcnt vmcnt(7)
    v_mfma_f32_4x4x4_16b_bf16 v[16:19], v[32:33], v[204:205], 0 cbsz:4 abid:10
    v_exp_f32 v13, v145
    v_mfma_f32_4x4x4_16b_bf16 v[20:23], v[32:33], v[206:207], 0 cbsz:4 abid:10
    v_readlane_b32 s55, v7, 11
    v_rcp_f32 v14, v14
    buffer_load_dwordx4 v[204:207], v1, s[12:15], s31 offen
    v_rcp_f32 v15, v15
    v_pk_add_f32 v[12:13], v[12:13], 1.0 op_sel_hi:[1,0]
    v_pk_mul_f32 v[158:159], v[158:159], v[14:15]
    s_set_gpr_idx_on s46, gpr_idx(SRC2,DST)
    v_pk_fma_f32 v[84:85], v[142:143], v[16:17], v[84:85] op_sel_hi:[0,1,1]
    v_pk_fma_f32 v[86:87], v[142:143], v[18:19], v[86:87] op_sel_hi:[0,1,1]
    v_pk_fma_f32 v[88:89], v[158:159], v[20:21], v[88:89] op_sel_hi:[0,1,1]
    v_pk_fma_f32 v[90:91], v[158:159], v[22:23], v[90:91] op_sel_hi:[0,1,1]
    s_set_gpr_idx_off
    s_and_b32 s31, s55, 0xfffffc00
    s_waitcnt vmcnt(7)
    v_mfma_f32_4x4x4_16b_bf16 v[16:19], v[32:33], v[208:209], 0 cbsz:4 abid:11
    v_readlane_b32 s56, v7, 12
    v_mfma_f32_4x4x4_16b_bf16 v[20:23], v[32:33], v[210:211], 0 cbsz:4 abid:11
    v_mfma_f32_32x32x16_bf16 v[180:195], v[28:31], v[48:51], v[180:195]
    v_exp_f32 v14, v160
    v_exp_f32 v15, v161
    v_rcp_f32 v12, v12
    v_rcp_f32 v13, v13
    buffer_load_dwordx4 v[208:211], v1, s[12:15], s31 offen
    v_pk_add_f32 v[14:15], v[14:15], 1.0 op_sel_hi:[1,0]
    v_pk_mul_f32 v[144:145], v[144:145], v[12:13]
    s_set_gpr_idx_on s47, gpr_idx(SRC2,DST)
    v_pk_fma_f32 v[84:85], v[142:143], v[16:17], v[84:85] op_sel:[1,0,0]
    v_pk_fma_f32 v[86:87], v[142:143], v[18:19], v[86:87] op_sel:[1,0,0]
    v_pk_fma_f32 v[88:89], v[158:159], v[20:21], v[88:89] op_sel:[1,0,0]
    v_pk_fma_f32 v[90:91], v[158:159], v[22:23], v[90:91] op_sel:[1,0,0]
    s_set_gpr_idx_off
    s_and_b32 s31, s56, 0xfffffc00
    s_sub_u32 s29, s29, 4
    s_cbranch_scc1 L2_exit
    s_setprio 0
    v_exp_f32 v12, v146
    s_waitcnt vmcnt(7)
    v_mfma_f32_4x4x4_16b_bf16 v[16:19], v[32:33], v[212:213], 0 cbsz:4 abid:12
    v_exp_f32 v13, v147
    v_mfma_f32_4x4x4_16b_bf16 v[20:23], v[32:33], v[214:215], 0 cbsz:4 abid:12
    v_readlane_b32 s57, v7, 13
    v_rcp_f32 v14, v14
    buffer_load_dwordx4 v[212:215], v1, s[12:15], s31 offen
    v_rcp_f32 v15, v15
    v_pk_add_f32 v[12:13], v[12:13], 1.0 op_sel_hi:[1,0]
    v_pk_mul_f32 v[160:161], v[160:161], v[14:15]
    s_set_gpr_idx_on s48, gpr_idx(SRC2,DST)
    v_pk_fma_f32 v[84:85], v[144:145], v[16:17], v[84:85] op_sel_hi:[0,1,1]
    v_pk_fma_f32 v[86:87], v[144:145], v[18:19], v[86:87] op_sel_hi:[0,1,1]
    v_pk_fma_f32 v[88:89], v[160:161], v[20:21], v[88:89] op_sel_hi:[0,1,1]
    v_pk_fma_f32 v[90:91], v[160:161], v[22:23], v[90:91] op_sel_hi:[0,1,1]
    s_set_gpr_idx_off
    s_and_b32 s31, s57, 0xfffffc00
    v_exp_f32 v14, v162
    s_waitcnt vmcnt(7)
    v_mfma_f32_4x4x4_16b_bf16 v[16:19], v[32:33], v[216:217], 0 cbsz:4 abid:13
    v_exp_f32 v15, v163
    v_mfma_f32_4x4x4_16b_bf16 v[20:23], v[32:33], v[218:219], 0 cbsz:4 abid:13
    v_readlane_b32 s58, v7, 14
    v_rcp_f32 v12, v12
    buffer_load_dwordx4 v[216:219], v1, s[12:15], s31 offen
    v_rcp_f32 v13, v13
    v_pk_add_f32 v[14:15], v[14:15], 1.0 op_sel_hi:[1,0]
    v_pk_mul_f32 v[146:147], v[146:147], v[12:13]
    s_set_gpr_idx_on s49, gpr_idx(SRC2,DST)
    v_pk_fma_f32 v[84:85], v[144:145], v[16:17], v[84:85] op_sel:[1,0,0]
    v_pk_fma_f32 v[86:87], v[144:145], v[18:19], v[86:87] op_sel:[1,0,0]
    v_pk_fma_f32 v[88:89], v[160:161], v[20:21], v[88:89] op_sel:[1,0,0]
    v_pk_fma_f32 v[90:91], v[160:161], v[22:23], v[90:91] op_sel:[1,0,0]
    s_set_gpr_idx_off
    s_and_b32 s31, s58, 0xfffffc00
    v_exp_f32 v12, v164
    s_waitcnt vmcnt(7)
    v_mfma_f32_4x4x4_16b_bf16 v[16:19], v[32:33], v[220:221], 0 cbsz:4 abid:14
    v_exp_f32 v13, v165
    v_mfma_f32_4x4x4_16b_bf16 v[20:23], v[32:33], v[222:223], 0 cbsz:4 abid:14
    v_readlane_b32 s59, v7, 15
    v_rcp_f32 v14, v14
    buffer_load_dwordx4 v[220:223], v1, s[12:15], s31 offen
    v_rcp_f32 v15, v15
    v_pk_add_f32 v[12:13], v[12:13], 1.0 op_sel_hi:[1,0]
    v_pk_mul_f32 v[162:163], v[162:163], v[14:15]
    s_set_gpr_idx_on s50, gpr_idx(SRC2,DST)
    v_pk_fma_f32 v[84:85], v[146:147], v[16:17], v[84:85] op_sel_hi:[0,1,1]
    v_pk_fma_f32 v[86:87], v[146:147], v[18:19], v[86:87] op_sel_hi:[0,1,1]
    v_pk_fma_f32 v[88:89], v[162:163], v[20:21], v[88:89] op_sel_hi:[0,1,1]
    v_pk_fma_f32 v[90:91], v[162:163], v[22:23], v[90:91] op_sel_hi:[0,1,1]
    s_set_gpr_idx_off
    s_and_b32 s31, s59, 0xfffffc00
    v_exp_f32 v14, v180
    s_waitcnt vmcnt(7)
    v_mfma_f32_4x4x4_16b_bf16 v[16:19], v[32:33], v[224:225], 0 cbsz:4 abid:15
    v_exp_f32 v15, v181
    v_mfma_f32_4x4x4_16b_bf16 v[20:23], v[32:33], v[226:227], 0 cbsz:4 abid:15
    v_readlane_b32 s60, v8, 0
    v_rcp_f32 v12, v12
    buffer_load_dwordx4 v[224:227], v1, s[12:15], s31 offen
    v_rcp_f32 v13, v13
    v_pk_add_f32 v[14:15], v[14:15], 1.0 op_sel_hi:[1,0]
    v_pk_mul_f32 v[164:165], v[164:165], v[12:13]
    s_set_gpr_idx_on s51, gpr_idx(SRC2,DST)
    v_pk_fma_f32 v[84:85], v[146:147], v[16:17], v[84:85] op_sel:[1,0,0]
    v_pk_fma_f32 v[86:87], v[146:147], v[18:19], v[86:87] op_sel:[1,0,0]
    v_pk_fma_f32 v[88:89], v[162:163], v[20:21], v[88:89] op_sel:[1,0,0]
    v_pk_fma_f32 v[90:91], v[162:163], v[22:23], v[90:91] op_sel:[1,0,0]
    s_set_gpr_idx_off
    s_and_b32 s31, s60, 0xfffffc00
    s_sub_u32 s29, s29, 4
    s_cbranch_scc1 L2_exit
    s_setprio 3
    ds_read_b32 v9, v5 offset:260
    ds_read_b32 v10, v6 offset:260
    ds_read_b32 v7, v4 offset:320
    v_exp_f32 v12, v166
    s_waitcnt vmcnt(7)
    v_mfma_f32_4x4x4_16b_bf16 v[16:19], v[34:35], v[196:197], 0 cbsz:4 abid:0
    v_exp_f32 v13, v167
    v_mfma_f32_4x4x4_16b_bf16 v[20:23], v[34:35], v[198:199], 0 cbsz:4 abid:0
    v_readlane_b32 s61, v8, 1
    v_rcp_f32 v14, v14
    buffer_load_dwordx4 v[196:199], v1, s[12:15], s31 offen
    v_rcp_f32 v15, v15
    v_pk_add_f32 v[12:13], v[12:13], 1.0 op_sel_hi:[1,0]
    v_pk_mul_f32 v[180:181], v[180:181], v[14:15]
    s_set_gpr_idx_on s52, gpr_idx(SRC2,DST)
    v_pk_fma_f32 v[84:85], v[164:165], v[16:17], v[84:85] op_sel_hi:[0,1,1]
    v_pk_fma_f32 v[86:87], v[164:165], v[18:19], v[86:87] op_sel_hi:[0,1,1]
    v_pk_fma_f32 v[88:89], v[180:181], v[20:21], v[88:89] op_sel_hi:[0,1,1]
    v_pk_fma_f32 v[90:91], v[180:181], v[22:23], v[90:91] op_sel_hi:[0,1,1]
    s_set_gpr_idx_off
    s_and_b32 s31, s61, 0xfffffc00
    v_exp_f32 v14, v182
    s_waitcnt vmcnt(7)
    v_mfma_f32_4x4x4_16b_bf16 v[16:19], v[34:35], v[200:201], 0 cbsz:4 abid:1
    v_exp_f32 v15, v183
    v_mfma_f32_4x4x4_16b_bf16 v[20:23], v[34:35], v[202:203], 0 cbsz:4 abid:1
    v_readlane_b32 s62, v8, 2
    v_rcp_f32 v12, v12
    buffer_load_dwordx4 v[200:203], v1, s[12:15], s31 offen
    v_rcp_f32 v13, v13
    v_pk_add_f32 v[14:15], v[14:15], 1.0 op_sel_hi:[1,0]
    v_pk_mul_f32 v[166:167], v[166:167], v[12:13]
    s_set_gpr_idx_on s53, gpr_idx(SRC2,DST)
    v_pk_fma_f32 v[84:85], v[164:165], v[16:17], v[84:85] op_sel:[1,0,0]
    v_pk_fma_f32 v[86:87], v[164:165], v[18:19], v[86:87] op_sel:[1,0,0]
    v_pk_fma_f32 v[88:89], v[180:181], v[20:21], v[88:89] op_sel:[1,0,0]
    v_pk_fma_f32 v[90:91], v[180:181], v[22:23], v[90:91] op_sel:[1,0,0]
    s_set_gpr_idx_off
    s_and_b32 s31, s62, 0xfffffc00
    s_waitcnt lgkmcnt(0)
    v_add_u32 v9, v9, v2
    v_add_u32 v10, v10, v3
    s_mov_b64 exec, s[32:33]
    ds_read_b128 v[24:27], v9 offset:63232
    s_mov_b64 exec, s[34:35]
    ds_read_b128 v[28:31], v9 offset:63232
    s_mov_b64 exec, -1
    ds_read_b64 v[32:33], v10
    v_exp_f32 v12, v168
    s_waitcnt vmcnt(7)
    v_mfma_f32_4x4x4_16b_bf16 v[16:19], v[34:35], v[204:205], 0 cbsz:4 abid:2
    v_exp_f32 v13, v169
    v_mfma_f32_4x4x4_16b_bf16 v[20:23], v[34:35], v[206:207], 0 cbsz:4 abid:2
    v_readlane_b32 s63, v8, 3
    v_rcp_f32 v14, v14
    buffer_load_dwordx4 v[204:207], v1, s[12:15], s31 offen
    v_rcp_f32 v15, v15
    v_pk_add_f32 v[12:13], v[12:13], 1.0 op_sel_hi:[1,0]
    v_pk_mul_f32 v[182:183], v[182:183], v[14:15]
    s_set_gpr_idx_on s54, gpr_idx(SRC2,DST)
    v_pk_fma_f32 v[84:85], v[166:167], v[16:17], v[84:85] op_sel_hi:[0,1,1]
    v_pk_fma_f32 v[86:87], v[166:167], v[18:19], v[86:87] op_sel_hi:[0,1,1]
    v_pk_fma_f32 v[88:89], v[182:183], v[20:21], v[88:89] op_sel_hi:[0,1,1]
    v_pk_fma_f32 v[90:91], v[182:183], v[22:23], v[90:91] op_sel_hi:[0,1,1]
    s_set_gpr_idx_off
    s_and_b32 s31, s63, 0xfffffc00
    v_exp_f32 v14, v184
    s_waitcnt vmcnt(7)
    v_mfma_f32_4x4x4_16b_bf16 v[16:19], v[34:35], v[208:209], 0 cbsz:4 abid:3
    v_exp_f32 v15, v185
    v_mfma_f32_4x4x4_16b_bf16 v[20:23], v[34:35], v[210:211], 0 cbsz:4 abid:3
    v_readlane_b32 s64, v8, 4
    v_rcp_f32 v12, v12
    buffer_load_dwordx4 v[208:211], v1, s[12:15], s31 offen
    v_rcp_f32 v13, v13
    v_pk_add_f32 v[14:15], v[14:15], 1.0 op_sel_hi:[1,0]
    v_pk_mul_f32 v[168:169], v[168:169], v[12:13]
    s_set_gpr_idx_on s55, gpr_idx(SRC2,DST)
    v_pk_fma_f32 v[84:85], v[166:167], v[16:17], v[84:85] op_sel:[1,0,0]
    v_pk_fma_f32 v[86:87], v[166:167], v[18:19], v[86:87] op_sel:[1,0,0]
    v_pk_fma_f32 v[88:89], v[182:183], v[20:21], v[88:89] op_sel:[1,0,0]
    v_pk_fma_f32 v[90:91], v[182:183], v[22:23], v[90:91] op_sel:[1,0,0]
    s_set_gpr_idx_off
    s_and_b32 s31, s64, 0xfffffc00
    s_sub_u32 s29, s29, 4
    s_cbranch_scc1 L2_exit
    s_setprio 2
    v_exp_f32 v12, v170
    s_waitcnt vmcnt(7)
    v_mfma_f32_4x4x4_16b_bf16 v[16:19], v[34:35], v[212:213], 0 cbsz:4 abid:4
    v_exp_f32 v13, v171
    v_mfma_f32_4x4x4_16b_bf16 v[20:23], v[34:35], v[214:215], 0 cbsz:4 abid:4
    v_readlane_b32 s65, v8, 5
    v_rcp_f32 v14, v14
    buffer_load_dwordx4 v[212:215], v1, s[12:15], s31 offen
    v_rcp_f32 v15, v15
    v_pk_add_f32 v[12:13], v[12:13], 1.0 op_sel_hi:[1,0]
    v_pk_mul_f32 v[184:185], v[184:185], v[14:15]
    s_set_gpr_idx_on s56, gpr_idx(SRC2,DST)
    v_pk_fma_f32 v[84:85], v[168:169], v[16:17], v[84:85] op_sel_hi:[0,1,1]
    v_pk_fma_f32 v[86:87], v[168:169], v[18:19], v[86:87] op_sel_hi:[0,1,1]
    v_pk_fma_f32 v[88:89], v[184:185], v[20:21], v[88:89] op_sel_hi:[0,1,1]
    v_pk_fma_f32 v[90:91], v[184:185], v[22:23], v[90:91] op_sel_hi:[0,1,1]
    s_set_gpr_idx_off
    s_and_b32 s31, s65, 0xfffffc00
    s_waitcnt lgkmcnt(0)
    s_waitcnt vmcnt(7)
    v_mfma_f32_4x4x4_16b_bf16 v[16:19], v[34:35], v[216:217], 0 cbsz:4 abid:5
    v_readlane_b32 s66, v8, 6
    v_mfma_f32_4x4x4_16b_bf16 v[20:23], v[34:35], v[218:219], 0 cbsz:4 abid:5
    v_mfma_f32_32x32x16_bf16 v[132:147], v[24:27], v[36:39], 0
    v_exp_f32 v14, v186
    v_exp_f32 v15, v187
    v_rcp_f32 v12, v12
    v_rcp_f32 v13, v13
    buffer_load_dwordx4 v[216:219], v1, s[12:15], s31 offen
    v_pk_add_f32 v[14:15], v[14:15], 1.0 op_sel_hi:[1,0]
    v_pk_mul_f32 v[170:171], v[170:171], v[12:13]
    s_set_gpr_idx_on s57, gpr_idx(SRC2,DST)
    v_pk_fma_f32 v[84:85], v[168:169], v[16:17], v[84:85] op_sel:[1,0,0]
    v_pk_fma_f32 v[86:87], v[168:169], v[18:19], v[86:87] op_sel:[1,0,0]
    v_pk_fma_f32 v[88:89], v[184:185], v[20:21], v[88:89] op_sel:[1,0,0]
    v_pk_fma_f32 v[90:91], v[184:185], v[22:23], v[90:91] op_sel:[1,0,0]
    s_set_gpr_idx_off
    s_and_b32 s31, s66, 0xfffffc00
    v_exp_f32 v12, v172
    s_waitcnt vmcnt(7)
    v_mfma_f32_4x4x4_16b_bf16 v[16:19], v[34:35], v[220:221], 0 cbsz:4 abid:6
    v_exp_f32 v13, v173
    v_mfma_f32_4x4x4_16b_bf16 v[20:23], v[34:35], v[222:223], 0 cbsz:4 abid:6
    v_readlane_b32 s67, v8, 7
    v_rcp_f32 v14, v14
    buffer_load_dwordx4 v[220:223], v1, s[12:15], s31 offen
    v_rcp_f32 v15, v15
    v_pk_add_f32 v[12:13], v[12:13], 1.0 op_sel_hi:[1,0]
    v_pk_mul_f32 v[186:187], v[186:187], v[14:15]
    s_set_gpr_idx_on s58, gpr_idx(SRC2,DST)
    v_pk_fma_f32 v[84:85], v[170:171], v[16:17], v[84:85] op_sel_hi:[0,1,1]
    v_pk_fma_f32 v[86:87], v[170:171], v[18:19], v[86:87] op_sel_hi:[0,1,1]
    v_pk_fma_f32 v[88:89], v[186:187], v[20:21], v[88:89] op_sel_hi:[0,1,1]
    v_pk_fma_f32 v[90:91], v[186:187], v[22:23], v[90:91] op_sel_hi:[0,1,1]
    s_set_gpr_idx_off
    s_and_b32 s31, s67, 0xfffffc00
    s_waitcnt vmcnt(7)
    v_mfma_f32_4x4x4_16b_bf16 v[16:19], v[34:35], v[224:225], 0 cbsz:4 abid:7
    v_readlane_b32 s36, v8, 8
    v_mfma_f32_4x4x4_16b_bf16 v[20:23], v[34:35], v[226:227], 0 cbsz:4 abid:7
    v_mfma_f32_32x32x16_bf16 v[132:147], v[28:31], v[40:43], v[132:147]
    v_exp_f32 v14, v188
    v_exp_f32 v15, v189
    v_rcp_f32 v12, v12
    v_rcp_f32 v13, v13
    buffer_load_dwordx4 v[224:227], v1, s[12:15], s31 offen
    v_pk_add_f32 v[14:15], v[14:15], 1.0 op_sel_hi:[1,0]
    v_pk_mul_f32 v[172:173], v[172:173], v[12:13]
    s_set_gpr_idx_on s59, gpr_idx(SRC2,DST)
    v_pk_fma_f32 v[84:85], v[170:171], v[16:17], v[84:85] op_sel:[1,0,0]
    v_pk_fma_f32 v[86:87], v[170:171], v[18:19], v[86:87] op_sel:[1,0,0]
    v_pk_fma_f32 v[88:89], v[186:187], v[20:21], v[88:89] op_sel:[1,0,0]
    v_pk_fma_f32 v[90:91], v[186:187], v[22:23], v[90:91] op_sel:[1,0,0]
    s_set_gpr_idx_off
    s_and_b32 s31, s36, 0xfffffc00
    s_sub_u32 s29, s29, 4
    s_cbranch_scc1 L2_exit
    s_setprio 1
    v_exp_f32 v12, v174
    s_waitcnt vmcnt(7)
    v_mfma_f32_4x4x4_16b_bf16 v[16:19], v[34:35], v[196:197], 0 cbsz:4 abid:8
    v_exp_f32 v13, v175
    v_mfma_f32_4x4x4_16b_bf16 v[20:23], v[34:35], v[198:199], 0 cbsz:4 abid:8
    v_readlane_b32 s37, v8, 9
    v_rcp_f32 v14, v14
    buffer_load_dwordx4 v[196:199], v1, s[12:15], s31 offen
    v_rcp_f32 v15, v15
    v_pk_add_f32 v[12:13], v[12:13], 1.0 op_sel_hi:[1,0]
    v_pk_mul_f32 v[188:189], v[188:189], v[14:15]
    s_set_gpr_idx_on s60, gpr_idx(SRC2,DST)
    v_pk_fma_f32 v[84:85], v[172:173], v[16:17], v[84:85] op_sel_hi:[0,1,1]
    v_pk_fma_f32 v[86:87], v[172:173], v[18:19], v[86:87] op_sel_hi:[0,1,1]
    v_pk_fma_f32 v[88:89], v[188:189], v[20:21], v[88:89] op_sel_hi:[0,1,1]
    v_pk_fma_f32 v[90:91], v[188:189], v[22:23], v[90:91] op_sel_hi:[0,1,1]
    s_set_gpr_idx_off
    s_and_b32 s31, s37, 0xfffffc00
    s_waitcnt vmcnt(7)
    v_mfma_f32_4x4x4_16b_bf16 v[16:19], v[34:35], v[200:201], 0 cbsz:4 abid:9
    v_readlane_b32 s38, v8, 10
    v_mfma_f32_4x4x4_16b_bf16 v[20:23], v[34:35], v[202:203], 0 cbsz:4 abid:9
    v_mfma_f32_32x32x16_bf16 v[148:163], v[24:27], v[44:47], 0
    v_exp_f32 v14, v190
    v_exp_f32 v15, v191
    v_rcp_f32 v12, v12
    v_rcp_f32 v13, v13
    buffer_load_dwordx4 v[200:203], v1, s[12:15], s31 offen
    v_pk_add_f32 v[14:15], v[14:15], 1.0 op_sel_hi:[1,0]
    v_pk_mul_f32 v[174:175], v[174:175], v[12:13]
    s_set_gpr_idx_on s61, gpr_idx(SRC2,DST)
    v_pk_fma_f32 v[84:85], v[172:173], v[16:17], v[84:85] op_sel:[1,0,0]
    v_pk_fma_f32 v[86:87], v[172:173], v[18:19], v[86:87] op_sel:[1,0,0]
    v_pk_fma_f32 v[88:89], v[188:189], v[20:21], v[88:89] op_sel:[1,0,0]
    v_pk_fma_f32 v[90:91], v[188:189], v[22:23], v[90:91] op_sel:[1,0,0]
    s_set_gpr_idx_off
    s_and_b32 s31, s38, 0xfffffc00
    v_exp_f32 v12, v176
    s_waitcnt vmcnt(7)
    v_mfma_f32_4x4x4_16b_bf16 v[16:19], v[34:35], v[204:205], 0 cbsz:4 abid:10
    v_exp_f32 v13, v177
    v_mfma_f32_4x4x4_16b_bf16 v[20:23], v[34:35], v[206:207], 0 cbsz:4 abid:10
    v_readlane_b32 s39, v8, 11
    v_rcp_f32 v14, v14
    buffer_load_dwordx4 v[204:207], v1, s[12:15], s31 offen
    v_rcp_f32 v15, v15
    v_pk_add_f32 v[12:13], v[12:13], 1.0 op_sel_hi:[1,0]
    v_pk_mul_f32 v[190:191], v[190:191], v[14:15]
    s_set_gpr_idx_on s62, gpr_idx(SRC2,DST)
    v_pk_fma_f32 v[84:85], v[174:175], v[16:17], v[84:85] op_sel_hi:[0,1,1]
    v_pk_fma_f32 v[86:87], v[174:175], v[18:19], v[86:87] op_sel_hi:[0,1,1]
    v_pk_fma_f32 v[88:89], v[190:191], v[20:21], v[88:89] op_sel_hi:[0,1,1]
    v_pk_fma_f32 v[90:91], v[190:191], v[22:23], v[90:91] op_sel_hi:[0,1,1]
    s_set_gpr_idx_off
    s_and_b32 s31, s39, 0xfffffc00
    s_waitcnt vmcnt(7)
    v_mfma_f32_4x4x4_16b_bf16 v[16:19], v[34:35], v[208:209], 0 cbsz:4 abid:11
    v_readlane_b32 s40, v8, 12
    v_mfma_f32_4x4x4_16b_bf16 v[20:23], v[34:35], v[210:211], 0 cbsz:4 abid:11
    v_mfma_f32_32x32x16_bf16 v[148:163], v[28:31], v[48:51], v[148:163]
    v_exp_f32 v14, v192
    v_exp_f32 v15, v193
    v_rcp_f32 v12, v12
    v_rcp_f32 v13, v13
    buffer_load_dwordx4 v[208:211], v1, s[12:15], s31 offen
    v_pk_add_f32 v[14:15], v[14:15], 1.0 op_sel_hi:[1,0]
    v_pk_mul_f32 v[176:177], v[176:177], v[12:13]
    s_set_gpr_idx_on s63, gpr_idx(SRC2,DST)
    v_pk_fma_f32 v[84:85], v[174:175], v[16:17], v[84:85] op_sel:[1,0,0]
    v_pk_fma_f32 v[86:87], v[174:175], v[18:19], v[86:87] op_sel:[1,0,0]
    v_pk_fma_f32 v[88:89], v[190:191], v[20:21], v[88:89] op_sel:[1,0,0]
    v_pk_fma_f32 v[90:91], v[190:191], v[22:23], v[90:91] op_sel:[1,0,0]
    s_set_gpr_idx_off
    s_and_b32 s31, s40, 0xfffffc00
    s_sub_u32 s29, s29, 4
    s_cbranch_scc1 L2_exit
    s_setprio 0
    v_exp_f32 v12, v178
    s_waitcnt vmcnt(7)
    v_mfma_f32_4x4x4_16b_bf16 v[16:19], v[34:35], v[212:213], 0 cbsz:4 abid:12
    v_exp_f32 v13, v179
    v_mfma_f32_4x4x4_16b_bf16 v[20:23], v[34:35], v[214:215], 0 cbsz:4 abid:12
    v_readlane_b32 s41, v8, 13
    v_rcp_f32 v14, v14
    buffer_load_dwordx4 v[212:215], v1, s[12:15], s31 offen
    v_rcp_f32 v15, v15
    v_pk_add_f32 v[12:13], v[12:13], 1.0 op_sel_hi:[1,0]
    v_pk_mul_f32 v[192:193], v[192:193], v[14:15]
    s_set_gpr_idx_on s64, gpr_idx(SRC2,DST)
    v_pk_fma_f32 v[84:85], v[176:177], v[16:17], v[84:85] op_sel_hi:[0,1,1]
    v_pk_fma_f32 v[86:87], v[176:177], v[18:19], v[86:87] op_sel_hi:[0,1,1]
    v_pk_fma_f32 v[88:89], v[192:193], v[20:21], v[88:89] op_sel_hi:[0,1,1]
    v_pk_fma_f32 v[90:91], v[192:193], v[22:23], v[90:91] op_sel_hi:[0,1,1]
    s_set_gpr_idx_off
    s_and_b32 s31, s41, 0xfffffc00
    v_exp_f32 v14, v194
    s_waitcnt vmcnt(7)
    v_mfma_f32_4x4x4_16b_bf16 v[16:19], v[34:35], v[216:217], 0 cbsz:4 abid:13
    v_exp_f32 v15, v195
    v_mfma_f32_4x4x4_16b_bf16 v[20:23], v[34:35], v[218:219], 0 cbsz:4 abid:13
    v_readlane_b32 s42, v8, 14
    v_rcp_f32 v12, v12
    buffer_load_dwordx4 v[216:219], v1, s[12:15], s31 offen
    v_rcp_f32 v13, v13
    v_pk_add_f32 v[14:15], v[14:15], 1.0 op_sel_hi:[1,0]
    v_pk_mul_f32 v[178:179], v[178:179], v[12:13]
    s_set_gpr_idx_on s65, gpr_idx(SRC2,DST)
    v_pk_fma_f32 v[84:85], v[176:177], v[16:17], v[84:85] op_sel:[1,0,0]
    v_pk_fma_f32 v[86:87], v[176:177], v[18:19], v[86:87] op_sel:[1,0,0]
    v_pk_fma_f32 v[88:89], v[192:193], v[20:21], v[88:89] op_sel:[1,0,0]
    v_pk_fma_f32 v[90:91], v[192:193], v[22:23], v[90:91] op_sel:[1,0,0]
    s_set_gpr_idx_off
    s_and_b32 s31, s42, 0xfffffc00
    v_exp_f32 v12, v132
    s_waitcnt vmcnt(7)
    v_mfma_f32_4x4x4_16b_bf16 v[16:19], v[34:35], v[220:221], 0 cbsz:4 abid:14
    v_exp_f32 v13, v133
    v_mfma_f32_4x4x4_16b_bf16 v[20:23], v[34:35], v[222:223], 0 cbsz:4 abid:14
    v_readlane_b32 s43, v8, 15
    v_rcp_f32 v14, v14
    buffer_load_dwordx4 v[220:223], v1, s[12:15], s31 offen
    v_rcp_f32 v15, v15
    v_pk_add_f32 v[12:13], v[12:13], 1.0 op_sel_hi:[1,0]
    v_pk_mul_f32 v[194:195], v[194:195], v[14:15]
    s_set_gpr_idx_on s66, gpr_idx(SRC2,DST)
    v_pk_fma_f32 v[84:85], v[178:179], v[16:17], v[84:85] op_sel_hi:[0,1,1]
    v_pk_fma_f32 v[86:87], v[178:179], v[18:19], v[86:87] op_sel_hi:[0,1,1]
    v_pk_fma_f32 v[88:89], v[194:195], v[20:21], v[88:89] op_sel_hi:[0,1,1]
    v_pk_fma_f32 v[90:91], v[194:195], v[22:23], v[90:91] op_sel_hi:[0,1,1]
    s_set_gpr_idx_off
    s_and_b32 s31, s43, 0xfffffc00
    v_exp_f32 v14, v148
    s_waitcnt vmcnt(7)
    v_mfma_f32_4x4x4_16b_bf16 v[16:19], v[34:35], v[224:225], 0 cbsz:4 abid:15
    v_exp_f32 v15, v149
    v_mfma_f32_4x4x4_16b_bf16 v[20:23], v[34:35], v[226:227], 0 cbsz:4 abid:15
    v_readlane_b32 s44, v7, 0
    v_rcp_f32 v12, v12
    buffer_load_dwordx4 v[224:227], v1, s[12:15], s31 offen
    v_rcp_f32 v13, v13
    v_pk_add_f32 v[14:15], v[14:15], 1.0 op_sel_hi:[1,0]
    v_pk_mul_f32 v[132:133], v[132:133], v[12:13]
    s_set_gpr_idx_on s67, gpr_idx(SRC2,DST)
    v_pk_fma_f32 v[84:85], v[178:179], v[16:17], v[84:85] op_sel:[1,0,0]
    v_pk_fma_f32 v[86:87], v[178:179], v[18:19], v[86:87] op_sel:[1,0,0]
    v_pk_fma_f32 v[88:89], v[194:195], v[20:21], v[88:89] op_sel:[1,0,0]
    v_pk_fma_f32 v[90:91], v[194:195], v[22:23], v[90:91] op_sel:[1,0,0]
    s_set_gpr_idx_off
    s_and_b32 s31, s44, 0xfffffc00
    s_sub_u32 s29, s29, 4
    s_cbranch_scc1 L2_exit
    v_add_u32 v4, 256, v4
    v_add_u32 v5, 256, v5
    v_add_u32 v6, 256, v6
    s_branch L2_loop
L2_more:
    s_lshl_b32 s3, s2, 10
    s_waitcnt vmcnt(0) lgkmcnt(0)
    v_add_u32 v13, s3, v1
    s_barrier
    s_branch L2_round
L2_exit:
    s_add_u32 s28, s28, 1536
    s_cmp_lt_u32 s28, s11
    s_cbranch_scc1 L2_more
    s_mov_b32 s68, 0xbf317218
    s_mov_b32 s69, s68
    v_lshlrev_b32 v38, 2, v11
    s_and_b32 s3, s96, 0xffff
    s_mul_i32 s3, s3, 1261
    s_lshr_b32 s3, s3, 16
    s_mul_i32 s3, s3, 1152
    v_add_u32 v44, s3, v38
    v_pk_mul_f32 v[84:85], v[84:85], s[68:69]
    v_pk_mul_f32 v[86:87], v[86:87], s[68:69]
    v_pk_mul_f32 v[88:89], v[88:89], s[68:69]
    v_pk_mul_f32 v[90:91], v[90:91], s[68:69]
    v_cvt_pk_bf16_f32 v84, v84, v88
    v_cvt_pk_bf16_f32 v85, v85, v89
    v_cvt_pk_bf16_f32 v86, v86, v90
    v_cvt_pk_bf16_f32 v87, v87, v91
    ds_write_b32 v44, v84 offset:16128
    ds_write_b32 v44, v85 offset:16416
    ds_write_b32 v44, v86 offset:16704
    ds_write_b32 v44, v87 offset:16992
    s_and_b32 s3, s97, 0xffff
    s_mul_i32 s3, s3, 1261
    s_lshr_b32 s3, s3, 16
    s_mul_i32 s3, s3, 1152
    v_add_u32 v45, s3, v38
    v_pk_mul_f32 v[92:93], v[92:93], s[68:69]
    v_pk_mul_f32 v[94:95], v[94:95], s[68:69]
    v_pk_mul_f32 v[96:97], v[96:97], s[68:69]
    v_pk_mul_f32 v[98:99], v[98:99], s[68:69]
    v_cvt_pk_bf16_f32 v92, v92, v96
    v_cvt_pk_bf16_f32 v93, v93, v97
    v_cvt_pk_bf16_f32 v94, v94, v98
    v_cvt_pk_bf16_f32 v95, v95, v99
    ds_write_b32 v45, v92 offset:16128
    ds_write_b32 v45, v93 offset:16416
    ds_write_b32 v45, v94 offset:16704
    ds_write_b32 v45, v95 offset:16992
    s_and_b32 s3, s98, 0xffff
    s_mul_i32 s3, s3, 1261
    s_lshr_b32 s3, s3, 16
    s_mul_i32 s3, s3, 1152
    v_add_u32 v46, s3, v38
    v_pk_mul_f32 v[100:101], v[100:101], s[68:69]
    v_pk_mul_f32 v[102:103], v[102:103], s[68:69]
    v_pk_mul_f32 v[104:105], v[104:105], s[68:69]
    v_pk_mul_f32 v[106:107], v[106:107], s[68:69]
    v_cvt_pk_bf16_f32 v100, v100, v104
    v_cvt_pk_bf16_f32 v101, v101, v105
    v_cvt_pk_bf16_f32 v102, v102, v106
    v_cvt_pk_bf16_f32 v103, v103, v107
    ds_write_b32 v46, v100 offset:16128
    ds_write_b32 v46, v101 offset:16416
    ds_write_b32 v46, v102 offset:16704
    ds_write_b32 v46, v103 offset:16992
    s_and_b32 s3, s99, 0xffff
    s_mul_i32 s3, s3, 1261
    s_lshr_b32 s3, s3, 16
    s_mul_i32 s3, s3, 1152
    v_add_u32 v47, s3, v38
    v_pk_mul_f32 v[108:109], v[108:109], s[68:69]
    v_pk_mul_f32 v[110:111], v[110:111], s[68:69]
    v_pk_mul_f32 v[112:113], v[112:113], s[68:69]
    v_pk_mul_f32 v[114:115], v[114:115], s[68:69]
    v_cvt_pk_bf16_f32 v108, v108, v112
    v_cvt_pk_bf16_f32 v109, v109, v113
    v_cvt_pk_bf16_f32 v110, v110, v114
    v_cvt_pk_bf16_f32 v111, v111, v115
    ds_write_b32 v47, v108 offset:16128
    ds_write_b32 v47, v109 offset:16416
    ds_write_b32 v47, v110 offset:16704
    ds_write_b32 v47, v111 offset:16992
    s_and_b32 s3, s100, 0xffff
    s_mul_i32 s3, s3, 1261
    s_lshr_b32 s3, s3, 16
    s_mul_i32 s3, s3, 1152
    v_add_u32 v48, s3, v38
    v_pk_mul_f32 v[116:117], v[116:117], s[68:69]
    v_pk_mul_f32 v[118:119], v[118:119], s[68:69]
    v_pk_mul_f32 v[120:121], v[120:121], s[68:69]
    v_pk_mul_f32 v[122:123], v[122:123], s[68:69]
    v_cvt_pk_bf16_f32 v116, v116, v120
    v_cvt_pk_bf16_f32 v117, v117, v121
    v_cvt_pk_bf16_f32 v118, v118, v122
    v_cvt_pk_bf16_f32 v119, v119, v123
    ds_write_b32 v48, v116 offset:16128
    ds_write_b32 v48, v117 offset:16416
    ds_write_b32 v48, v118 offset:16704
    ds_write_b32 v48, v119 offset:16992
    s_mul_i32 s31, s101, 23040
    v_and_b32 v39, 15, v11
    v_lshrrev_b32 v40, 4, v11
    v_mul_u32_u24 v41, 288, v39
    v_lshl_add_u32 v41, v40, 4, v41
    v_add_u32 v41, s31, v41
    s_mul_i32 s68, s101, 5120
    s_add_u32 s68, s68, s2
    s_lshl_b32 s68, s68, 10
    s_and_b32 s3, s10, 3
    s_lshl_b32 s3, s3, 8
    s_add_u32 s68, s68, s3
    v_lshlrev_b32 v40, 18, v40
    v_lshl_add_u32 v40, v39, 4, v40
    v_add_u32 v40, s68, v40
    s_waitcnt lgkmcnt(0)
    s_barrier
    ds_read_b128 v[84:87], v41 offset:16128
    ds_read_b128 v[88:91], v41 offset:16192
    ds_read_b128 v[92:95], v41 offset:16256
    ds_read_b128 v[96:99], v41 offset:16320
    ds_read_b128 v[100:103], v41 offset:20736
    ds_read_b128 v[104:107], v41 offset:20800
    ds_read_b128 v[108:111], v41 offset:20864
    ds_read_b128 v[112:115], v41 offset:20928
    s_waitcnt lgkmcnt(7)
    v_mfma_f32_16x16x32_bf16 v[116:119], v[84:87], v[52:55], 0
    v_mfma_f32_16x16x32_bf16 v[120:123], v[84:87], v[56:59], 0
    s_waitcnt lgkmcnt(6)
    v_mfma_f32_16x16x32_bf16 v[116:119], v[88:91], v[60:63], v[116:119]
    v_mfma_f32_16x16x32_bf16 v[120:123], v[88:91], v[64:67], v[120:123]
    s_waitcnt lgkmcnt(5)
    v_mfma_f32_16x16x32_bf16 v[116:119], v[92:95], v[68:71], v[116:119]
    v_mfma_f32_16x16x32_bf16 v[120:123], v[92:95], v[72:75], v[120:123]
    s_waitcnt lgkmcnt(4)
    v_mfma_f32_16x16x32_bf16 v[116:119], v[96:99], v[76:79], v[116:119]
    v_mfma_f32_16x16x32_bf16 v[120:123], v[96:99], v[80:83], v[120:123]
    ds_read_b128 v[84:87], v41 offset:25344
    ds_read_b128 v[88:91], v41 offset:25408
    ds_read_b128 v[92:95], v41 offset:25472
    ds_read_b128 v[96:99], v41 offset:25536
    s_waitcnt lgkmcnt(7)
    v_mfma_f32_16x16x32_bf16 v[124:127], v[100:103], v[52:55], 0
    v_mfma_f32_16x16x32_bf16 v[128:131], v[100:103], v[56:59], 0
    s_waitcnt lgkmcnt(6)
    v_mfma_f32_16x16x32_bf16 v[124:127], v[104:107], v[60:63], v[124:127]
    v_mfma_f32_16x16x32_bf16 v[128:131], v[104:107], v[64:67], v[128:131]
    s_waitcnt lgkmcnt(5)
    v_mfma_f32_16x16x32_bf16 v[124:127], v[108:111], v[68:71], v[124:127]
    v_mfma_f32_16x16x32_bf16 v[128:131], v[108:111], v[72:75], v[128:131]
    s_waitcnt lgkmcnt(4)
    v_mfma_f32_16x16x32_bf16 v[124:127], v[112:115], v[76:79], v[124:127]
    v_mfma_f32_16x16x32_bf16 v[128:131], v[112:115], v[80:83], v[128:131]
    v_cvt_pk_bf16_f32 v44, v116, v117
    v_cvt_pk_bf16_f32 v45, v118, v119
    v_cvt_pk_bf16_f32 v46, v120, v121
    v_cvt_pk_bf16_f32 v47, v122, v123
    s_mov_b32 s3, 0
    buffer_store_dwordx4 v[44:47], v40, s[24:27], s3 offen sc0 sc1
    ds_read_b128 v[100:103], v41 offset:29952
    ds_read_b128 v[104:107], v41 offset:30016
    ds_read_b128 v[108:111], v41 offset:30080
    ds_read_b128 v[112:115], v41 offset:30144
    s_waitcnt lgkmcnt(7)
    v_mfma_f32_16x16x32_bf16 v[116:119], v[84:87], v[52:55], 0
    v_mfma_f32_16x16x32_bf16 v[120:123], v[84:87], v[56:59], 0
    s_waitcnt lgkmcnt(6)
    v_mfma_f32_16x16x32_bf16 v[116:119], v[88:91], v[60:63], v[116:119]
    v_mfma_f32_16x16x32_bf16 v[120:123], v[88:91], v[64:67], v[120:123]
    s_waitcnt lgkmcnt(5)
    v_mfma_f32_16x16x32_bf16 v[116:119], v[92:95], v[68:71], v[116:119]
    v_mfma_f32_16x16x32_bf16 v[120:123], v[92:95], v[72:75], v[120:123]
    s_waitcnt lgkmcnt(4)
    v_mfma_f32_16x16x32_bf16 v[116:119], v[96:99], v[76:79], v[116:119]
    v_mfma_f32_16x16x32_bf16 v[120:123], v[96:99], v[80:83], v[120:123]
    v_cvt_pk_bf16_f32 v48, v124, v125
    v_cvt_pk_bf16_f32 v49, v126, v127
    v_cvt_pk_bf16_f32 v50, v128, v129
    v_cvt_pk_bf16_f32 v51, v130, v131
    s_mov_b32 s3, 1048576
    buffer_store_dwordx4 v[48:51], v40, s[24:27], s3 offen sc0 sc1
    ds_read_b128 v[84:87], v41 offset:34560
    ds_read_b128 v[88:91], v41 offset:34624
    ds_read_b128 v[92:95], v41 offset:34688
    ds_read_b128 v[96:99], v41 offset:34752
    s_waitcnt lgkmcnt(7)
    v_mfma_f32_16x16x32_bf16 v[124:127], v[100:103], v[52:55], 0
    v_mfma_f32_16x16x32_bf16 v[128:131], v[100:103], v[56:59], 0
    s_waitcnt lgkmcnt(6)
    v_mfma_f32_16x16x32_bf16 v[124:127], v[104:107], v[60:63], v[124:127]
    v_mfma_f32_16x16x32_bf16 v[128:131], v[104:107], v[64:67], v[128:131]
    s_waitcnt lgkmcnt(5)
    v_mfma_f32_16x16x32_bf16 v[124:127], v[108:111], v[68:71], v[124:127]
    v_mfma_f32_16x16x32_bf16 v[128:131], v[108:111], v[72:75], v[128:131]
    s_waitcnt lgkmcnt(4)
    v_mfma_f32_16x16x32_bf16 v[124:127], v[112:115], v[76:79], v[124:127]
    v_mfma_f32_16x16x32_bf16 v[128:131], v[112:115], v[80:83], v[128:131]
    v_cvt_pk_bf16_f32 v44, v116, v117
    v_cvt_pk_bf16_f32 v45, v118, v119
    v_cvt_pk_bf16_f32 v46, v120, v121
    v_cvt_pk_bf16_f32 v47, v122, v123
    s_mov_b32 s3, 2097152
    buffer_store_dwordx4 v[44:47], v40, s[24:27], s3 offen sc0 sc1
    s_waitcnt lgkmcnt(3)
    v_mfma_f32_16x16x32_bf16 v[116:119], v[84:87], v[52:55], 0
    v_mfma_f32_16x16x32_bf16 v[120:123], v[84:87], v[56:59], 0
    s_waitcnt lgkmcnt(2)
    v_mfma_f32_16x16x32_bf16 v[116:119], v[88:91], v[60:63], v[116:119]
    v_mfma_f32_16x16x32_bf16 v[120:123], v[88:91], v[64:67], v[120:123]
    s_waitcnt lgkmcnt(1)
    v_mfma_f32_16x16x32_bf16 v[116:119], v[92:95], v[68:71], v[116:119]
    v_mfma_f32_16x16x32_bf16 v[120:123], v[92:95], v[72:75], v[120:123]
    s_waitcnt lgkmcnt(0)
    v_mfma_f32_16x16x32_bf16 v[116:119], v[96:99], v[76:79], v[116:119]
    v_mfma_f32_16x16x32_bf16 v[120:123], v[96:99], v[80:83], v[120:123]
    v_cvt_pk_bf16_f32 v48, v124, v125
    v_cvt_pk_bf16_f32 v49, v126, v127
    v_cvt_pk_bf16_f32 v50, v128, v129
    v_cvt_pk_bf16_f32 v51, v130, v131
    s_mov_b32 s3, 3145728
    buffer_store_dwordx4 v[48:51], v40, s[24:27], s3 offen sc0 sc1
    s_nop 3
    v_cvt_pk_bf16_f32 v44, v116, v117
    v_cvt_pk_bf16_f32 v45, v118, v119
    v_cvt_pk_bf16_f32 v46, v120, v121
    v_cvt_pk_bf16_f32 v47, v122, v123
    s_mov_b32 s3, 4194304
    buffer_store_dwordx4 v[44:47], v40, s[24:27], s3 offen sc0 sc1
L2_fin:
L2_end:
    s_endpgm
.section .rodata,"a"
.p2align 6
.amdhsa_kernel tfn_bin_kernel
  .amdhsa_next_free_vgpr 56
  .amdhsa_next_free_sgpr 80
  .amdhsa_accum_offset 56
  .amdhsa_group_segment_fixed_size 0
  .amdhsa_kernarg_size 88
  .amdhsa_user_sgpr_count 2
  .amdhsa_user_sgpr_kernarg_segment_ptr 1
  .amdhsa_system_sgpr_workgroup_id_x 1
  .amdhsa_float_denorm_mode_32 3
.end_amdhsa_kernel
.section .rodata,"a"
.p2align 6
.amdhsa_kernel standalone__tensor_product_equiv_tfn__graph_kernel
  .amdhsa_next_free_vgpr 228
  .amdhsa_next_free_sgpr 102
  .amdhsa_accum_offset 228
  .amdhsa_group_segment_fixed_size 0
  .amdhsa_kernarg_size 88
  .amdhsa_user_sgpr_count 2
  .amdhsa_user_sgpr_kernarg_segment_ptr 1
  .amdhsa_system_sgpr_workgroup_id_x 1
  .amdhsa_float_denorm_mode_32 3
.end_amdhsa_kernel
```

```asm
; @launch kernel=tfn_bin_kernel grid=(256,1,1) block=(640,1,1) lds=83968
; @launch kernel=standalone__tensor_product_equiv_tfn__graph_kernel grid=(256,1,1) block=(512,1,1) lds=161536
.amdgcn_target "amdgcn-amd-amdhsa--gfx950"
.text
.globl tfn_bin_kernel
.p2align 8
.type tfn_bin_kernel,@function
tfn_bin_kernel:
    s_load_dwordx16 s[4:19], s[0:1], 0
    s_load_dwordx2 s[20:21], s[0:1], 80
    s_cmp_ge_u32 s2, 256
    s_cbranch_scc1 L1_end
    s_mul_i32 s34, s2, 5000
    v_lshl_add_u32 v4, v0, 3, s34
    v_lshlrev_b32 v5, 1, v4
    v_cmp_gt_u32 vcc, 625, v0
    s_mov_b64 s[40:41], vcc
    s_mov_b64 exec, vcc
    s_waitcnt lgkmcnt(0)
    global_load_dwordx2 v[8:9], v4, s[8:9]
    s_mov_b64 exec, -1
    v_lshrrev_b32 v1, 6, v0
    v_and_b32 v2, 255, v0
    v_lshlrev_b32 v2, 2, v2
    v_mov_b32 v3, 0
    v_readfirstlane_b32 s22, v1
    ds_write_b32 v2, v3 offset:61440
    s_mov_b64 exec, s[40:41]
    s_barrier
    global_load_dwordx2 v[10:11], v4, s[6:7]
    global_load_dwordx4 v[12:15], v5, s[10:11]
    s_mov_b64 exec, -1
    s_lshl_b32 s36, s34, 3
    v_lshlrev_b32 v6, 4, v0
    v_and_b32 v30, 63, v0
    s_lshl_b32 s37, s22, 10
    s_mov_b32 s24, s12
    s_mov_b32 s25, s13
    s_mov_b32 s26, 10240000
    s_mov_b32 s27, 0x00020000
    s_waitcnt lgkmcnt(0)
    s_barrier
    s_add_u32 m0, s37, 0
    s_add_u32 s38, s36, 0
    buffer_load_dwordx4 v6, s[24:27], s38 offen lds
    s_add_u32 m0, s37, 10240
    s_add_u32 s38, s36, 10240
    buffer_load_dwordx4 v6, s[24:27], s38 offen lds
    s_mov_b32 s39, 0
    v_mov_b32 v40, 0
    s_lshl_b32 s3, s2, 6
    v_add_u32 v31, s3, v30
    s_mov_b64 s[42:43], s[18:19]
    v_mov_b32 v32, 0
    s_cmp_eq_u32 s22, 4
    s_cbranch_scc0 L1_nomix
    v_bfe_u32 v32, v31, 10, 2
    v_lshlrev_b32 v32, 5, v32
    v_bfe_u32 v33, v31, 7, 2
    v_lshl_add_u32 v32, v33, 3, v32
    v_and_b32 v33, 7, v31
    v_add_u32 v32, v32, v33
    v_bfe_u32 v33, v31, 12, 2
    v_lshlrev_b32 v33, 5, v33
    v_bfe_u32 v34, v31, 3, 4
    v_lshl_add_u32 v33, v34, 1, v33
    v_bfe_u32 v34, v31, 9, 1
    v_add_u32 v33, v33, v34
    v_lshl_add_u32 v32, v32, 7, v33
    v_lshlrev_b32 v40, 1, v31
    v_add_u32 v40, 266240, v40
    s_mov_b32 s39, 1
L1_nomix:
    s_cmp_eq_u32 s22, 5
    s_cbranch_scc0 L1_now
    s_cmp_lt_u32 s2, 33
    s_cbranch_scc0 L1_now
    s_cmp_eq_u32 s2, 32
    s_cbranch_scc1 L1_cg
    v_bfe_u32 v32, v31, 8, 1
    v_and_b32 v33, 7, v31
    v_lshl_add_u32 v32, v32, 3, v33
    v_bfe_u32 v33, v31, 9, 1
    v_bfe_u32 v34, v31, 3, 5
    v_lshl_add_u32 v33, v33, 5, v34
    v_bfe_u32 v34, v31, 10, 1
    v_lshl_add_u32 v33, v33, 1, v34
    v_lshl_add_u32 v32, v32, 7, v33
    v_lshlrev_b32 v40, 1, v31
    v_add_u32 v40, 262144, v40
    s_mov_b32 s39, 2
    s_mov_b64 s[42:43], s[14:15]
    s_branch L1_now
L1_cg:
    v_and_b32 v32, 15, v30
    v_lshrrev_b32 v33, 4, v30
    v_lshl_add_u32 v32, v32, 2, v33
    v_lshlrev_b32 v40, 1, v30
    v_add_u32 v40, 299008, v40
    s_mov_b32 s39, 1
    s_mov_b64 s[42:43], s[16:17]
L1_now:
    s_cmp_lt_u32 s22, 2
    s_cbranch_scc0 L1_nocpf
    s_cmp_lt_u32 s2, 8
    s_cbranch_scc0 L1_nocpf
    s_getpc_b64 s[44:45]
L1_pc:
    s_add_u32 s44, s44, standalone__tensor_product_equiv_tfn__graph_kernel-L1_pc
    s_addc_u32 s45, s45, 0
    v_min_u32 v50, 75, v0
    v_lshlrev_b32 v50, 7, v50
    v_mov_b32 v49, s45
    v_add_co_u32 v48, vcc, s44, v50
    s_nop 1
    v_addc_co_u32 v49, vcc, 0, v49, vcc
    global_load_dword v41, v[48:49], off
    s_branch L1_xd
L1_nocpf:
    v_lshlrev_b32 v32, 1, v32
    global_load_ushort v41, v32, s[42:43]
L1_xd:
    v_mov_b32 v3, 1
    s_mov_b64 exec, s[40:41]
    s_waitcnt vmcnt(5)
    v_and_b32 v16, 7, v8
    v_bfe_u32 v18, v8, 3, 5
    v_lshl_add_u32 v16, v16, 5, v18
    v_lshlrev_b32 v16, 2, v16
    ds_add_rtn_u32 v18, v16, v3 offset:61440
    v_and_b32 v17, 7, v9
    v_bfe_u32 v19, v9, 3, 5
    v_lshl_add_u32 v17, v17, 5, v19
    v_lshlrev_b32 v17, 2, v17
    ds_add_rtn_u32 v19, v17, v3 offset:61440
    s_mov_b64 exec, -1
    v_lshlrev_b32 v31, 4, v30
    s_add_u32 m0, s37, 20480
    s_add_u32 s38, s36, 20480
    buffer_load_dwordx4 v6, s[24:27], s38 offen lds
    s_add_u32 m0, s37, 30720
    s_add_u32 s38, s36, 30720
    buffer_load_dwordx4 v6, s[24:27], s38 offen lds
    s_waitcnt lgkmcnt(0)
    s_barrier
    ds_read_b128 v[32:35], v31 offset:61440
    s_waitcnt vmcnt(5)
    s_movk_i32 s46, 1250
    v_and_b32 v54, 7, v8
    v_mad_u32_u24 v54, v54, s46, v10
    v_subrev_u32 v53, 10000, v54
    v_min_u32 v54, v54, v53
    v_and_b32 v55, 7, v9
    v_mad_u32_u24 v55, v55, s46, v11
    v_subrev_u32 v53, 10000, v55
    v_min_u32 v55, v55, v53
    v_lshlrev_b32 v20, 10, v10
    v_mul_u32_u24 v22, 157, v54
    v_lshrrev_b32 v21, 8, v8
    v_lshrrev_b32 v22, 17, v22
    s_waitcnt lgkmcnt(0)
    v_add_u32 v36, v32, v33
    v_add3_u32 v36, v36, v34, v35
    v_mov_b32 v37, v36
    v_mul_u32_u24 v21, 3407924, v21
    v_lshl_add_u32 v21, v22, 2, v21
    v_add_u32_dpp v37, v37, v37 row_shr:1 row_mask:0xf bank_mask:0xf
    v_add_u32 v21, 1060126464, v21
    v_mov_b64 v[22:23], v[12:13]
    v_add_u32_dpp v37, v37, v37 row_shr:2 row_mask:0xf bank_mask:0xf
    v_lshlrev_b32 v24, 10, v11
    v_mul_u32_u24 v26, 157, v55
    v_add_u32_dpp v37, v37, v37 row_shr:4 row_mask:0xf bank_mask:0xf
    v_lshrrev_b32 v25, 8, v9
    v_lshrrev_b32 v26, 17, v26
    v_add_u32_dpp v37, v37, v37 row_shr:8 row_mask:0xf bank_mask:0xf
    v_mul_u32_u24 v25, 3407924, v25
    v_lshl_add_u32 v25, v26, 2, v25
    v_add_u32_dpp v37, v37, v37 row_bcast:15 row_mask:0xa bank_mask:0xf
    v_add_u32 v25, 1060126464, v25
    v_mov_b64 v[26:27], v[14:15]
    v_add_u32_dpp v37, v37, v37 row_bcast:31 row_mask:0xc bank_mask:0xf
    v_sub_u32 v48, v37, v36
    v_add_u32 v49, v48, v32
    v_add_u32 v50, v49, v33
    v_add_u32 v51, v50, v34
    ds_write_b128 v31, v[48:51] offset:62464
    s_mov_b64 exec, s[40:41]
    ds_read_b32 v28, v16 offset:62464
    ds_read_b32 v29, v17 offset:62464
    v_lshlrev_b32 v36, 6, v0
    v_add_u32 v37, 32, v36
    s_waitcnt lgkmcnt(1)
    v_add_lshl_u32 v38, v28, v18, 4
    v_add_lshl_u32 v28, v28, v18, 1
    ds_write_b128 v38, v[20:23] offset:40960
    ds_write_b16 v28, v36 offset:63488
    s_waitcnt lgkmcnt(2)
    v_add_lshl_u32 v39, v29, v19, 4
    v_add_lshl_u32 v29, v29, v19, 1
    ds_write_b128 v39, v[24:27] offset:40960
    ds_write_b16 v29, v37 offset:63488
    s_mov_b64 exec, -1
    v_mov_b32 v46, 0
    s_cmp_lt_u32 s22, 4
    s_cbranch_scc0 L1_notab
    s_set_gpr_idx_on s22, gpr_idx(SRC0)
    v_mov_b32 v44, v32
    v_mov_b32 v52, v48
    s_set_gpr_idx_off
    s_mul_i32 s3, s2, 1280
    v_add_u32 v52, s3, v52
    v_lshl_add_u32 v47, v44, 19, v52
    v_lshl_add_u32 v46, v30, 2, s22
    v_and_b32 v53, 31, v46
    v_lshrrev_b32 v46, 5, v46
    v_lshl_add_u32 v46, v53, 3, v46
    s_and_b32 s3, s2, 7
    s_lshl_b32 s3, s3, 5
    s_lshr_b32 s38, s2, 3
    s_add_u32 s3, s3, s38
    s_lshl_b32 s3, s3, 2
    v_lshl_add_u32 v46, v46, 10, s3
    global_store_dword v46, v47, s[20:21]
L1_notab:
    v_and_b32 v7, -2, v0
    v_add_u32 v7, 63488, v7
    s_mul_i32 s3, s2, 20480
    s_add_u32 s38, s3, 1048576
    v_add_u32 v4, s38, v6
    v_add_u32 v5, 10240, v4
    v_and_b32 v20, 16, v6
    s_waitcnt lgkmcnt(0)
    s_barrier
    ds_read_b128 v[8:11], v6 offset:40960
    ds_read_b128 v[12:15], v6 offset:51200
    ds_read_u16 v16, v7 offset:0
    ds_read_u16 v17, v7 offset:640
    ds_read_u16 v18, v7 offset:1280
    ds_read_u16 v19, v7 offset:1920
    v_mov_b32 v21, v4
    s_waitcnt lgkmcnt(5)
    global_store_dwordx4 v21, v[8:11], s[20:21] sc0 sc1
    s_waitcnt lgkmcnt(4)
    global_store_dwordx4 v5, v[12:15], s[20:21] sc0 sc1
    s_lshl_b32 s3, s3, 1
    s_add_u32 s3, s3, 8388608
    v_add_u32 v4, s3, v6
    s_waitcnt lgkmcnt(0)
    v_and_or_b32 v16, v16, -16, v20
    v_and_or_b32 v17, v17, -16, v20
    v_and_or_b32 v18, v18, -16, v20
    v_and_or_b32 v19, v19, -16, v20
    s_waitcnt vmcnt(2)
L1_tabd:
    s_barrier
    ds_read_b128 v[24:27], v16 offset:0
    ds_read_b128 v[28:31], v17 offset:0
    ds_read_b128 v[32:35], v18 offset:0
    ds_read_b128 v[36:39], v19 offset:0
    s_waitcnt lgkmcnt(3)
    global_store_dwordx4 v4, v[24:27], s[20:21] sc0 sc1
    v_add_u32 v4, 10240, v4
    s_waitcnt lgkmcnt(2)
    global_store_dwordx4 v4, v[28:31], s[20:21] sc0 sc1
    v_add_u32 v4, 10240, v4
    s_waitcnt lgkmcnt(1)
    global_store_dwordx4 v4, v[32:35], s[20:21] sc0 sc1
    v_add_u32 v4, 10240, v4
    s_waitcnt lgkmcnt(0)
    global_store_dwordx4 v4, v[36:39], s[20:21] sc0 sc1
    s_cmp_eq_u32 s39, 0
    s_cbranch_scc1 L1_nost
    s_cmp_eq_u32 s39, 1
    s_cbranch_scc1 L1_st1
    v_lshlrev_b32 v42, 16, v41
    v_mul_f32 v42, 0xbfb8aa3b, v42
    v_cvt_pk_bf16_f32 v41, v42, v42
L1_st1:
    global_store_short v40, v41, s[20:21]
L1_nost:
L1_end:
    s_endpgm
.globl standalone__tensor_product_equiv_tfn__graph_kernel
.p2align 8
.type standalone__tensor_product_equiv_tfn__graph_kernel,@function
standalone__tensor_product_equiv_tfn__graph_kernel:
    s_load_dwordx2 s[8:9], s[0:1], 80
    s_load_dwordx2 s[4:5], s[0:1], 0
    s_load_dwordx2 s[6:7], s[0:1], 64
    s_cmp_ge_u32 s2, 256
    s_cbranch_scc1 L2_end
    v_and_b32 v11, 63, v0
    s_lshl_b32 s3, s2, 10
    v_lshlrev_b32 v1, 4, v11
    v_lshrrev_b32 v12, 6, v0
    v_add_u32 v13, s3, v1
    v_readfirstlane_b32 s10, v12
    s_mov_b32 s28, 0
    s_waitcnt lgkmcnt(0)
L2_round:
    global_load_dwordx4 v[140:143], v13, s[8:9]
    v_lshlrev_b32 v194, 2, v0
    v_lshlrev_b32 v14, 3, v0
    v_mov_b32 v16, 0
    v_mov_b32 v17, 0
    v_mov_b32 v15, 0x03000000
    ds_write_b64 v14, v[16:17] offset:16128
    ds_write_b32 v194, v15 offset:20224
    ds_write_b32 v194, v15 offset:22272
    ds_write_b32 v194, v15 offset:24320
    v_lshlrev_b32 v132, 4, v0
    s_lshl_b32 s30, s10, 10
    s_add_u32 s64, s8, 262144
    s_addc_u32 s65, s9, 0
    s_mov_b32 s66, 36992
    s_mov_b32 s67, 0x00020000
    s_waitcnt lgkmcnt(0)
    s_barrier
    s_add_u32 m0, s30, 26368
    s_mov_b32 s3, 0
    buffer_load_dwordx4 v132, s[64:67], s3 offen lds
    s_add_u32 m0, s30, 34560
    s_mov_b32 s3, 8192
    buffer_load_dwordx4 v132, s[64:67], s3 offen lds
    s_add_u32 m0, s30, 42752
    s_mov_b32 s3, 16384
    buffer_load_dwordx4 v132, s[64:67], s3 offen lds
    s_add_u32 m0, s30, 50944
    s_mov_b32 s3, 24576
    buffer_load_dwordx4 v132, s[64:67], s3 offen lds
    v_and_b32 v14, 15, v11
    v_lshlrev_b32 v14, 3, v14
    s_mov_b32 s3, 36864
    buffer_load_dwordx2 v[192:193], v14, s[64:67], s3 offen
    v_add_u32 v133, 8192, v132
    v_add_u32 v134, 16384, v132
    v_add_u32 v135, 24576, v132
    v_add_u32 v136, 32768, v132
    v_add_u32 v137, 40960, v132
    v_lshrrev_b32 v195, 1, v0
    v_lshlrev_b32 v195, 2, v195
    s_add_u32 s16, s8, 1048576
    s_addc_u32 s17, s9, 0
    s_mov_b32 s18, 5242880
    s_mov_b32 s19, 0x00020000
    s_add_u32 s20, s8, 8388608
    s_addc_u32 s21, s9, 0
    s_mov_b32 s22, 10485760
    s_mov_b32 s23, 0x00020000
    s_and_b32 s31, s10, 3
    s_lshr_b32 s101, s10, 2
    v_mov_b32 v148, 0
    s_waitcnt vmcnt(5)
    v_lshrrev_b32 v144, 19, v140
    v_lshrrev_b32 v145, 19, v141
    v_lshrrev_b32 v146, 19, v142
    v_lshrrev_b32 v147, 19, v143
    v_add_u32 v150, v144, v145
    v_add3_u32 v12, v150, v146, v147
    v_add_u32 v13, s28, v12
    v_mov_b32 v149, v144
    v_add_u32_dpp v12, v12, v12 row_shr:1 row_mask:0xf bank_mask:0xf
    v_add_u32 v151, v150, v146
    s_set_gpr_idx_on s31, gpr_idx(SRC0)
    v_mov_b32 v14, v140
    v_mov_b32 v15, v144
    v_mov_b32 v16, v148
    s_set_gpr_idx_off
    v_add_u32_dpp v12, v12, v12 row_shr:2 row_mask:0xf bank_mask:0xf
    v_and_b32 v14, 0x7ffff, v14
    v_sub_u32 v16, v16, v13
    v_add_u32_dpp v12, v12, v12 row_shr:4 row_mask:0xf bank_mask:0xf
    v_subrev_u32 v17, s101, v15
    s_mov_b32 s31, s101
    v_add_u32_dpp v12, v12, v12 row_shr:8 row_mask:0xf bank_mask:0xf
    s_nop 1
    v_add_u32_dpp v12, v12, v12 row_bcast:15 row_mask:0xa bank_mask:0xf
    s_nop 1
    v_add_u32_dpp v12, v12, v12 row_bcast:31 row_mask:0xc bank_mask:0xf
    v_add_u32 v16, v16, v12
    v_readlane_b32 s11, v12, 63
    v_sub_u32 v14, v14, v16
    v_add_lshl_u32 v18, v16, s101, 2
    s_cmp_gt_u32 s11, 1536
    s_cbranch_scc1 L2_exp
    v_cmpx_lt_i32 vcc, 0, v17
    ds_write_b32 v18, v14 offset:20224
    v_cmpx_lt_i32 vcc, 2, v17
    ds_write_b32 v18, v14 offset:20232
    v_cmpx_lt_i32 vcc, 4, v17
    ds_write_b32 v18, v14 offset:20240
    v_cmpx_lt_i32 vcc, 6, v17
    ds_write_b32 v18, v14 offset:20248
    v_cmpx_lt_i32 vcc, 8, v17
    ds_write_b32 v18, v14 offset:20256
    v_cmpx_lt_i32 vcc, 10, v17
    ds_write_b32 v18, v14 offset:20264
    v_cmpx_lt_i32 vcc, 12, v17
    s_cbranch_execz L2_expd
    s_add_u32 s31, s31, 12
L2_exp:
    s_mov_b64 exec, -1
    v_cmp_lt_u32 vcc, s31, v15
    s_cbranch_vccz L2_expd
    v_add_u32 v19, s31, v16
    s_movk_i32 s3, 1536
    v_cmp_gt_u32 s[68:69], s3, v19
    v_lshlrev_b32 v19, 2, v19
    s_and_b64 exec, vcc, s[68:69]
    ds_write_b32 v19, v14 offset:20224
    s_add_u32 s31, s31, 2
    s_branch L2_exp
L2_expd:
    s_mov_b64 exec, -1
    s_waitcnt lgkmcnt(0)
    s_barrier
    ds_read_b32 v12, v194 offset:20224
    ds_read_b32 v13, v194 offset:22272
    ds_read_b32 v14, v194 offset:24320
    ds_read_b32 v152, v195 offset:20224
    ds_read_b32 v153, v195 offset:21248
    ds_read_b32 v154, v195 offset:22272
    ds_read_b32 v155, v195 offset:23296
    ds_read_b32 v156, v195 offset:24320
    ds_read_b32 v157, v195 offset:25344
    s_waitcnt lgkmcnt(8)
    v_lshl_add_u32 v12, v12, 4, v132
    buffer_load_dwordx4 v[140:143], v12, s[16:19], 0 offen
    s_waitcnt lgkmcnt(7)
    v_lshl_add_u32 v13, v13, 4, v133
    buffer_load_dwordx4 v[144:147], v13, s[16:19], 0 offen
    s_waitcnt lgkmcnt(6)
    v_lshl_add_u32 v14, v14, 4, v134
    buffer_load_dwordx4 v[148:151], v14, s[16:19], 0 offen
    s_waitcnt lgkmcnt(0)
    v_lshl_add_u32 v152, v152, 5, v132
    v_lshl_add_u32 v153, v153, 5, v133
    v_lshl_add_u32 v154, v154, 5, v134
    v_lshl_add_u32 v155, v155, 5, v135
    v_lshl_add_u32 v156, v156, 5, v136
    v_lshl_add_u32 v157, v157, 5, v137
    s_barrier
    s_add_u32 m0, s30, 63232
    s_nop 0
    buffer_load_dwordx4 v152, s[20:23], 0 offen lds
    s_add_u32 m0, s30, 71424
    s_nop 0
    buffer_load_dwordx4 v153, s[20:23], 0 offen lds
    s_sub_u32 s29, s11, s28
    s_min_u32 s29, s29, 1536
    s_lshl_b32 s3, s29, 4
    v_cmp_gt_u32 s[56:57], s3, v132
    v_lshlrev_b32 v163, 1, v132
    v_cmp_gt_u32 s[58:59], s3, v133
    v_lshlrev_b32 v165, 1, v133
    v_cmp_gt_u32 s[60:61], s3, v134
    v_lshlrev_b32 v167, 1, v134
    s_cmp_lg_u32 s28, 0
    s_cbranch_scc1 L2_noinit
    v_mov_b64 v[84:85], 0
    v_mov_b64 v[86:87], 0
    v_mov_b64 v[88:89], 0
    v_mov_b64 v[90:91], 0
    v_mov_b64 v[92:93], 0
    v_mov_b64 v[94:95], 0
    v_mov_b64 v[96:97], 0
    v_mov_b64 v[98:99], 0
    v_mov_b64 v[100:101], 0
    v_mov_b64 v[102:103], 0
    v_mov_b64 v[104:105], 0
    v_mov_b64 v[106:107], 0
    v_mov_b64 v[108:109], 0
    v_mov_b64 v[110:111], 0
    v_mov_b64 v[112:113], 0
    v_mov_b64 v[114:115], 0
    v_mov_b64 v[116:117], 0
    v_mov_b64 v[118:119], 0
    v_mov_b64 v[120:121], 0
    v_mov_b64 v[122:123], 0
    v_mov_b64 v[124:125], 0
    v_mov_b64 v[126:127], 0
    v_mov_b64 v[128:129], 0
    v_mov_b64 v[130:131], 0
    v_mov_b64 v[24:25], 0
    v_mov_b64 v[26:27], 0
    v_mov_b64 v[28:29], 0
    v_mov_b64 v[30:31], 0
    s_mov_b32 s32, 0x0f0f0f0f
    s_mov_b32 s33, s32
    s_not_b64 s[34:35], s[32:33]
    v_lshrrev_b32 v2, 5, v11
    v_lshlrev_b32 v2, 4, v2
    v_and_b32 v3, 3, v11
    v_lshlrev_b32 v3, 3, v3
    v_add_u32 v3, 112384, v3
    s_mov_b32 s12, s4
    s_mov_b32 s13, s5
    s_mov_b32 s14, 10240000
    s_mov_b32 s15, 0x00020000
    s_mov_b32 s24, s6
    s_mov_b32 s25, s7
    s_mov_b32 s26, 10240000
    s_mov_b32 s27, 0x00020000
L2_noinit:
    v_and_b32 v4, 15, v11
    v_lshlrev_b32 v4, 3, v4
    v_bfe_u32 v5, v11, 3, 2
    v_and_b32 v12, 3, v11
    v_lshl_add_u32 v5, v5, 2, v12
    v_lshlrev_b32 v5, 3, v5
    v_lshrrev_b32 v6, 2, v11
    v_lshlrev_b32 v6, 3, v6
    s_mov_b32 s68, 0
    s_cmp_lt_u32 s2, 16
    s_cbranch_scc1 L2_r40
    s_cmp_eq_u32 s10, 0
    s_cselect_b32 s68, 0x274090c0, s68
    s_cmp_eq_u32 s10, 1
    s_cselect_b32 s68, 0x24798441, s68
    s_cmp_eq_u32 s10, 2
    s_cselect_b32 s68, 0x26657302, s68
    s_cmp_eq_u32 s10, 3
    s_cselect_b32 s68, 0x257522c4, s68
    s_cmp_eq_u32 s10, 4
    s_cselect_b32 s68, 0x236d33c5, s68
    s_cmp_eq_u32 s10, 5
    s_cselect_b32 s68, 0x217d6286, s68
    s_cmp_eq_u32 s10, 6
    s_cselect_b32 s68, 0x22695347, s68
    s_cmp_eq_u32 s10, 7
    s_cselect_b32 s68, 0x20714388, s68
    s_branch L2_rd
L2_r40:
    s_cmp_eq_u32 s10, 0
    s_cselect_b32 s68, 0x278d5200, s68
    s_cmp_eq_u32 s10, 1
    s_cselect_b32 s68, 0x266143c1, s68
    s_cmp_eq_u32 s10, 2
    s_cselect_b32 s68, 0x25693342, s68
    s_cmp_eq_u32 s10, 3
    s_cselect_b32 s68, 0x24792243, s68
    s_cmp_eq_u32 s10, 4
    s_cselect_b32 s68, 0x22751304, s68
    s_cmp_eq_u32 s10, 5
    s_cselect_b32 s68, 0x216572c5, s68
    s_cmp_eq_u32 s10, 6
    s_cselect_b32 s68, 0x20710386, s68
    s_cmp_eq_u32 s10, 7
    s_cselect_b32 s68, 0x1f6d6287, s68
L2_rd:
    v_mul_u32_u24 v16, 52, v11
    v_lshrrev_b32 v16, 8, v16
    v_mul_u32_u24 v17, 5, v16
    v_sub_u32 v17, v11, v17
    v_mul_u32_u24 v15, 6, v17
    v_bfe_u32 v15, s68, v15, 6
    v_lshlrev_b32 v15, 2, v15
    v_lshlrev_b32 v16, 2, v16
    v_lshlrev_b32 v17, 19, v17
    s_mul_i32 s3, s10, 5
    v_min_u32 v18, 43, v11
    v_mul_u32_u24 v18, 52, v18
    v_add_u32 v21, s3, v11
    v_min_u32 v19, 43, v21
    v_mul_u32_u24 v19, 52, v19
    v_cmp_gt_u32 vcc, 40, v11
    v_add_u32 v20, 1, v11
    v_add_u32 v21, 1, v21
    v_cndmask_b32 v20, 0, v20, vcc
    s_cmp_gt_u32 s11, 1536
    s_cselect_b32 s69, 0, 8
    v_mov_b32 v22, 8
    s_cmp_lt_u32 s10, 4
    s_cselect_b32 s70, 1, 0
    s_waitcnt vmcnt(4)
    s_mov_b64 exec, s[56:57]
    v_lshrrev_b32 v12, 16, v141
    v_and_b32 v141, 0xffff, v141
    ds_add_u32 v12, v22
    ds_add_rtn_u32 v158, v141, v22
    s_waitcnt vmcnt(3)
    s_mov_b64 exec, s[58:59]
    v_lshrrev_b32 v13, 16, v145
    v_and_b32 v145, 0xffff, v145
    ds_add_u32 v13, v22
    ds_add_rtn_u32 v159, v145, v22
    s_waitcnt vmcnt(2)
    s_mov_b64 exec, s[60:61]
    v_lshrrev_b32 v14, 16, v149
    v_and_b32 v149, 0xffff, v149
    ds_add_u32 v14, v22
    ds_add_rtn_u32 v160, v149, v22
    s_mov_b64 exec, -1
    s_add_u32 m0, s30, 79616
    s_nop 0
    buffer_load_dwordx4 v154, s[20:23], 0 offen lds
    v_mfma_f32_4x4x4_16b_bf16 v[168:171], v[192:193], v[142:143], 0 cbsz:4 abid:0
    v_mfma_f32_4x4x4_16b_bf16 v[172:175], v[192:193], v[142:143], 0 cbsz:4 abid:1
    v_mfma_f32_4x4x4_16b_bf16 v[176:179], v[192:193], v[142:143], 0 cbsz:4 abid:2
    v_mfma_f32_4x4x4_16b_bf16 v[180:183], v[192:193], v[142:143], 0 cbsz:4 abid:3
    v_add_u32 v23, 112384, v163
    s_nop 0
    v_cvt_pk_bf16_f32 v184, v168, v169
    v_cvt_pk_bf16_f32 v185, v170, v171
    v_cvt_pk_bf16_f32 v186, v172, v173
    v_cvt_pk_bf16_f32 v187, v174, v175
    v_cvt_pk_bf16_f32 v188, v176, v177
    v_cvt_pk_bf16_f32 v189, v178, v179
    v_cvt_pk_bf16_f32 v190, v180, v181
    v_cvt_pk_bf16_f32 v191, v182, v183
    s_waitcnt lgkmcnt(0)
    s_barrier
    ds_read_b32 v12, v18 offset:16176
    ds_read_b32 v13, v19 offset:16176
    ds_write_b128 v23, v[184:187]
    ds_write_b128 v23, v[188:191] offset:16
    s_waitcnt lgkmcnt(2)
    v_mad_u32_u24 v21, v13, s69, v21
    v_mad_u32_u24 v20, v12, s69, v20
    v_readlane_b32 s96, v21, 0
    v_readlane_b32 s97, v21, 1
    v_readlane_b32 s98, v21, 2
    v_readlane_b32 s99, v21, 3
    v_readlane_b32 s100, v21, 4
    v_lshl_add_u32 v19, v13, 16, v19
    v_cmp_lt_u32 s[36:37], s96, v20
    v_cmp_lt_u32 s[38:39], s97, v20
    v_cmp_lt_u32 s[40:41], s98, v20
    v_cmp_lt_u32 s[42:43], s99, v20
    v_cmp_lt_u32 s[44:45], s100, v20
    s_bcnt1_i32_b64 s96, s[36:37]
    v_writelane_b32 v12, s96, 0
    s_bcnt1_i32_b64 s97, s[38:39]
    v_writelane_b32 v12, s97, 1
    s_bcnt1_i32_b64 s98, s[40:41]
    v_writelane_b32 v12, s98, 2
    s_bcnt1_i32_b64 s99, s[42:43]
    v_writelane_b32 v12, s99, 3
    s_bcnt1_i32_b64 s100, s[44:45]
    v_writelane_b32 v12, s100, 4
    s_mov_b64 exec, 31
    v_lshlrev_b32 v12, 2, v12
    ds_write_b32 v12, v19 offset:18432
    s_mov_b64 exec, -1
    s_add_u32 m0, s30, 87808
    s_nop 0
    buffer_load_dwordx4 v155, s[20:23], 0 offen lds
    s_waitcnt lgkmcnt(0)
    s_barrier
    ds_read_b32 v12, v15 offset:18432
    v_mfma_f32_4x4x4_16b_bf16 v[168:171], v[192:193], v[146:147], 0 cbsz:4 abid:0
    v_mfma_f32_4x4x4_16b_bf16 v[172:175], v[192:193], v[146:147], 0 cbsz:4 abid:1
    v_mfma_f32_4x4x4_16b_bf16 v[176:179], v[192:193], v[146:147], 0 cbsz:4 abid:2
    v_mfma_f32_4x4x4_16b_bf16 v[180:183], v[192:193], v[146:147], 0 cbsz:4 abid:3
    v_add_u32 v23, 112384, v165
    s_nop 0
    v_cvt_pk_bf16_f32 v184, v168, v169
    v_cvt_pk_bf16_f32 v185, v170, v171
    v_cvt_pk_bf16_f32 v186, v172, v173
    v_cvt_pk_bf16_f32 v187, v174, v175
    v_cvt_pk_bf16_f32 v188, v176, v177
    v_cvt_pk_bf16_f32 v189, v178, v179
    v_cvt_pk_bf16_f32 v190, v180, v181
    v_cvt_pk_bf16_f32 v191, v182, v183
    s_waitcnt lgkmcnt(0)
    v_add_u32_sdwa v16, v12, v16 dst_sel:DWORD dst_unused:UNUSED_PAD src0_sel:WORD_0 src1_sel:DWORD
    ds_read_b32 v13, v16 offset:16128
    v_readlane_b32 s96, v12, 0
    v_readlane_b32 s97, v12, 1
    v_readlane_b32 s98, v12, 2
    v_readlane_b32 s99, v12, 3
    v_readlane_b32 s100, v12, 4
    s_add_u32 s3, s96, s97
    s_add_u32 s3, s3, s98
    s_add_u32 s3, s3, s99
    s_add_u32 s3, s3, s100
    s_lshr_b32 s29, s3, 16
    s_add_u32 s3, s29, 480
    v_mov_b32 v14, s3
    v_mov_b32 v18, 0
    s_mov_b64 exec, 1
    ds_add_rtn_u32 v14, v18, v14 offset:18688
    s_mov_b64 exec, -1
    s_waitcnt lgkmcnt(1)
    v_sub_u32 v17, v17, v13
    s_nop 0
    v_add_u32_dpp v13, v13, v13 row_shr:1 row_mask:0xf bank_mask:0xf
    s_nop 1
    v_add_u32_dpp v13, v13, v13 row_shr:2 row_mask:0xf bank_mask:0xf
    v_mov_b32 v20, 2147482664
    v_mov_b32 v21, 0
    v_add_u32_dpp v13, v13, v13 row_shr:4 row_mask:0xf bank_mask:0xf
    s_nop 1
    v_add_u32_dpp v13, v13, v13 row_shr:8 row_mask:0xf bank_mask:0xf
    s_waitcnt lgkmcnt(0)
    v_readfirstlane_b32 s71, v14
    v_add_u32_dpp v13, v13, v13 row_bcast:15 row_mask:0xa bank_mask:0xf
    s_add_u32 s3, s71, s29
    v_lshl_add_u32 v18, v11, 3, s3
    v_add_u32_dpp v13, v13, v13 row_bcast:31 row_mask:0xc bank_mask:0xf
    s_mov_b32 exec_hi, 0x0fffffff
    v_add3_u32 v13, v13, v17, s71
    ds_write_b32 v16, v13 offset:16128
    ds_write_b64 v18, v[20:21] offset:0
    s_mov_b64 exec, -1
    ds_write_b128 v23, v[184:187]
    ds_write_b128 v23, v[188:191] offset:16
    s_add_u32 m0, s30, 96000
    s_nop 0
    buffer_load_dwordx4 v156, s[20:23], 0 offen lds
    s_waitcnt lgkmcnt(2)
    s_barrier
    ds_read_b32 v12, v141
    ds_read_b32 v13, v145
    ds_read_b32 v14, v149
    v_add_u32 v4, s71, v4
    v_add_u32 v5, s71, v5
    v_add_u32 v6, s71, v6
    s_lshr_b32 s29, s29, 3
    s_mov_b64 exec, s[56:57]
    s_waitcnt lgkmcnt(2)
    v_add_u32_sdwa v158, v12, v158 dst_sel:DWORD dst_unused:UNUSED_PAD src0_sel:WORD_0 src1_sel:DWORD
    v_or_b32_sdwa v162, v12, v140 dst_sel:DWORD dst_unused:UNUSED_PAD src0_sel:WORD_1 src1_sel:DWORD
    ds_write_b64 v158, v[162:163] offset:0
    s_mov_b64 exec, s[58:59]
    s_waitcnt lgkmcnt(2)
    v_add_u32_sdwa v159, v13, v159 dst_sel:DWORD dst_unused:UNUSED_PAD src0_sel:WORD_0 src1_sel:DWORD
    v_or_b32_sdwa v164, v13, v144 dst_sel:DWORD dst_unused:UNUSED_PAD src0_sel:WORD_1 src1_sel:DWORD
    ds_write_b64 v159, v[164:165] offset:0
    s_mov_b64 exec, s[60:61]
    s_waitcnt lgkmcnt(2)
    v_add_u32_sdwa v160, v14, v160 dst_sel:DWORD dst_unused:UNUSED_PAD src0_sel:WORD_0 src1_sel:DWORD
    v_or_b32_sdwa v166, v14, v148 dst_sel:DWORD dst_unused:UNUSED_PAD src0_sel:WORD_1 src1_sel:DWORD
    ds_write_b64 v160, v[166:167] offset:0
    s_mov_b64 exec, -1
    s_add_u32 m0, s30, 104192
    s_nop 0
    buffer_load_dwordx4 v157, s[20:23], 0 offen lds
    s_cmp_eq_u32 s70, 0
    s_cbranch_scc1 L2_nowb
    s_add_u32 m0, s30, 59136
    s_mov_b32 s3, 32768
    buffer_load_dwordx4 v132, s[64:67], s3 offen lds
L2_nowb:
    s_waitcnt lgkmcnt(0)
    s_barrier
    ds_read_b32 v12, v4
    ds_read_b32 v7, v4 offset:64
    ds_read_b32 v9, v5 offset:4
    ds_read_b32 v10, v6 offset:4
    s_cmp_eq_u64 s[60:61], 0
    s_cbranch_scc1 L2_not3
    v_mfma_f32_4x4x4_16b_bf16 v[168:171], v[192:193], v[150:151], 0 cbsz:4 abid:0
    v_mfma_f32_4x4x4_16b_bf16 v[172:175], v[192:193], v[150:151], 0 cbsz:4 abid:1
    v_mfma_f32_4x4x4_16b_bf16 v[176:179], v[192:193], v[150:151], 0 cbsz:4 abid:2
    v_mfma_f32_4x4x4_16b_bf16 v[180:183], v[192:193], v[150:151], 0 cbsz:4 abid:3
    v_add_u32 v23, 112384, v167
    s_nop 0
    v_cvt_pk_bf16_f32 v184, v168, v169
    v_cvt_pk_bf16_f32 v185, v170, v171
    v_cvt_pk_bf16_f32 v186, v172, v173
    v_cvt_pk_bf16_f32 v187, v174, v175
    v_cvt_pk_bf16_f32 v188, v176, v177
    v_cvt_pk_bf16_f32 v189, v178, v179
    v_cvt_pk_bf16_f32 v190, v180, v181
    v_cvt_pk_bf16_f32 v191, v182, v183
    ds_write_b128 v23, v[184:187]
    ds_write_b128 v23, v[188:191] offset:16
L2_not3:
    ds_read_b128 v[36:39], v1 offset:26368
    ds_read_b128 v[40:43], v1 offset:27392
    ds_read_b128 v[44:47], v1 offset:28416
    ds_read_b128 v[48:51], v1 offset:29440
    s_waitcnt lgkmcnt(4)
    v_readlane_b32 s36, v12, 0
    s_and_b32 s68, s36, 0xfffffc00
    buffer_load_dwordx4 v[196:199], v1, s[12:15], s68 offen
    v_readlane_b32 s37, v12, 1
    s_and_b32 s69, s37, 0xfffffc00
    buffer_load_dwordx4 v[200:203], v1, s[12:15], s69 offen
    v_readlane_b32 s38, v12, 2
    s_and_b32 s68, s38, 0xfffffc00
    buffer_load_dwordx4 v[204:207], v1, s[12:15], s68 offen
    v_readlane_b32 s39, v12, 3
    s_and_b32 s69, s39, 0xfffffc00
    buffer_load_dwordx4 v[208:211], v1, s[12:15], s69 offen
    v_readlane_b32 s40, v12, 4
    s_and_b32 s68, s40, 0xfffffc00
    buffer_load_dwordx4 v[212:215], v1, s[12:15], s68 offen
    v_readlane_b32 s41, v12, 5
    s_and_b32 s69, s41, 0xfffffc00
    buffer_load_dwordx4 v[216:219], v1, s[12:15], s69 offen
    v_readlane_b32 s42, v12, 6
    s_and_b32 s68, s42, 0xfffffc00
    buffer_load_dwordx4 v[220:223], v1, s[12:15], s68 offen
    v_readlane_b32 s43, v12, 7
    s_and_b32 s69, s43, 0xfffffc00
    buffer_load_dwordx4 v[224:227], v1, s[12:15], s69 offen
    v_add_u32 v9, v9, v2
    v_add_u32 v10, v10, v3
    s_and_b32 s3, s10, 3
    s_lshl_b32 s3, s3, 13
    v_add_u32 v16, s3, v1
    v_readlane_b32 s44, v7, 0
    s_and_b32 s31, s44, 0xfffffc00
    s_waitcnt vmcnt(8) lgkmcnt(0)
    s_barrier
    s_mov_b64 exec, s[32:33]
    ds_read_b128 v[24:27], v9 offset:63232
    s_mov_b64 exec, s[34:35]
    ds_read_b128 v[28:31], v9 offset:63232
    s_mov_b64 exec, -1
    ds_read_b64 v[32:33], v10
    ds_read_b128 v[52:55], v16 offset:30464
    ds_read_b128 v[56:59], v16 offset:31488
    ds_read_b128 v[60:63], v16 offset:32512
    ds_read_b128 v[64:67], v16 offset:33536
    ds_read_b128 v[68:71], v16 offset:34560
    ds_read_b128 v[72:75], v16 offset:35584
    ds_read_b128 v[76:79], v16 offset:36608
    ds_read_b128 v[80:83], v16 offset:37632
    s_waitcnt lgkmcnt(9)
    v_mfma_f32_32x32x16_bf16 v[132:147], v[24:27], v[36:39], 0
    v_mfma_f32_32x32x16_bf16 v[132:147], v[28:31], v[40:43], v[132:147]
    v_mfma_f32_32x32x16_bf16 v[148:163], v[24:27], v[44:47], 0
    v_mfma_f32_32x32x16_bf16 v[148:163], v[28:31], v[48:51], v[148:163]
    s_waitcnt lgkmcnt(0)
    s_barrier
    s_cmp_eq_u32 s29, 0
    s_cbranch_scc1 L2_exit
    s_sub_u32 s29, s29, 1
    s_nop 6
    v_exp_f32 v12, v132
    v_exp_f32 v13, v133
    v_exp_f32 v14, v148
    v_exp_f32 v15, v149
    v_pk_add_f32 v[12:13], v[12:13], 1.0 op_sel_hi:[1,0]
    v_pk_add_f32 v[14:15], v[14:15], 1.0 op_sel_hi:[1,0]
    v_rcp_f32 v12, v12
    v_rcp_f32 v13, v13
    s_nop 0
    v_pk_mul_f32 v[132:133], v[132:133], v[12:13]
L2_loop:
    s_setprio 3
    ds_read_b32 v9, v5 offset:132
    ds_read_b32 v10, v6 offset:132
    ds_read_b32 v8, v4 offset:192
    v_exp_f32 v12, v134
    s_waitcnt vmcnt(7)
    v_mfma_f32_4x4x4_16b_bf16 v[16:19], v[32:33], v[196:197], 0 cbsz:4 abid:0
    v_exp_f32 v13, v135
    v_mfma_f32_4x4x4_16b_bf16 v[20:23], v[32:33], v[198:199], 0 cbsz:4 abid:0
    v_readlane_b32 s45, v7, 1
    v_rcp_f32 v14, v14
    buffer_load_dwordx4 v[196:199], v1, s[12:15], s31 offen
    v_rcp_f32 v15, v15
    v_pk_add_f32 v[12:13], v[12:13], 1.0 op_sel_hi:[1,0]
    v_pk_mul_f32 v[148:149], v[148:149], v[14:15]
    s_set_gpr_idx_on s36, gpr_idx(SRC2,DST)
    v_pk_fma_f32 v[84:85], v[132:133], v[16:17], v[84:85] op_sel_hi:[0,1,1]
    v_pk_fma_f32 v[86:87], v[132:133], v[18:19], v[86:87] op_sel_hi:[0,1,1]
    v_pk_fma_f32 v[88:89], v[148:149], v[20:21], v[88:89] op_sel_hi:[0,1,1]
    v_pk_fma_f32 v[90:91], v[148:149], v[22:23], v[90:91] op_sel_hi:[0,1,1]
    s_set_gpr_idx_off
    s_and_b32 s31, s45, 0xfffffc00
    v_exp_f32 v14, v150
    s_waitcnt vmcnt(7)
    v_mfma_f32_4x4x4_16b_bf16 v[16:19], v[32:33], v[200:201], 0 cbsz:4 abid:1
    v_exp_f32 v15, v151
    v_mfma_f32_4x4x4_16b_bf16 v[20:23], v[32:33], v[202:203], 0 cbsz:4 abid:1
    v_readlane_b32 s46, v7, 2
    v_rcp_f32 v12, v12
    buffer_load_dwordx4 v[200:203], v1, s[12:15], s31 offen
    v_rcp_f32 v13, v13
    v_pk_add_f32 v[14:15], v[14:15], 1.0 op_sel_hi:[1,0]
    v_pk_mul_f32 v[134:135], v[134:135], v[12:13]
    s_set_gpr_idx_on s37, gpr_idx(SRC2,DST)
    v_pk_fma_f32 v[84:85], v[132:133], v[16:17], v[84:85] op_sel:[1,0,0]
    v_pk_fma_f32 v[86:87], v[132:133], v[18:19], v[86:87] op_sel:[1,0,0]
    v_pk_fma_f32 v[88:89], v[148:149], v[20:21], v[88:89] op_sel:[1,0,0]
    v_pk_fma_f32 v[90:91], v[148:149], v[22:23], v[90:91] op_sel:[1,0,0]
    s_set_gpr_idx_off
    s_and_b32 s31, s46, 0xfffffc00
    s_waitcnt lgkmcnt(0)
    v_add_u32 v9, v9, v2
    v_add_u32 v10, v10, v3
    s_mov_b64 exec, s[32:33]
    ds_read_b128 v[24:27], v9 offset:63232
    s_mov_b64 exec, s[34:35]
    ds_read_b128 v[28:31], v9 offset:63232
    s_mov_b64 exec, -1
    ds_read_b64 v[34:35], v10
    v_exp_f32 v12, v136
    s_waitcnt vmcnt(7)
    v_mfma_f32_4x4x4_16b_bf16 v[16:19], v[32:33], v[204:205], 0 cbsz:4 abid:2
    v_exp_f32 v13, v137
    v_mfma_f32_4x4x4_16b_bf16 v[20:23], v[32:33], v[206:207], 0 cbsz:4 abid:2
    v_readlane_b32 s47, v7, 3
    v_rcp_f32 v14, v14
    buffer_load_dwordx4 v[204:207], v1, s[12:15], s31 offen
    v_rcp_f32 v15, v15
    v_pk_add_f32 v[12:13], v[12:13], 1.0 op_sel_hi:[1,0]
    v_pk_mul_f32 v[150:151], v[150:151], v[14:15]
    s_set_gpr_idx_on s38, gpr_idx(SRC2,DST)
    v_pk_fma_f32 v[84:85], v[134:135], v[16:17], v[84:85] op_sel_hi:[0,1,1]
    v_pk_fma_f32 v[86:87], v[134:135], v[18:19], v[86:87] op_sel_hi:[0,1,1]
    v_pk_fma_f32 v[88:89], v[150:151], v[20:21], v[88:89] op_sel_hi:[0,1,1]
    v_pk_fma_f32 v[90:91], v[150:151], v[22:23], v[90:91] op_sel_hi:[0,1,1]
    s_set_gpr_idx_off
    s_and_b32 s31, s47, 0xfffffc00
    v_exp_f32 v14, v152
    s_waitcnt vmcnt(7)
    v_mfma_f32_4x4x4_16b_bf16 v[16:19], v[32:33], v[208:209], 0 cbsz:4 abid:3
    v_exp_f32 v15, v153
    v_mfma_f32_4x4x4_16b_bf16 v[20:23], v[32:33], v[210:211], 0 cbsz:4 abid:3
    v_readlane_b32 s48, v7, 4
    v_rcp_f32 v12, v12
    buffer_load_dwordx4 v[208:211], v1, s[12:15], s31 offen
    v_rcp_f32 v13, v13
    v_pk_add_f32 v[14:15], v[14:15], 1.0 op_sel_hi:[1,0]
    v_pk_mul_f32 v[136:137], v[136:137], v[12:13]
    s_set_gpr_idx_on s39, gpr_idx(SRC2,DST)
    v_pk_fma_f32 v[84:85], v[134:135], v[16:17], v[84:85] op_sel:[1,0,0]
    v_pk_fma_f32 v[86:87], v[134:135], v[18:19], v[86:87] op_sel:[1,0,0]
    v_pk_fma_f32 v[88:89], v[150:151], v[20:21], v[88:89] op_sel:[1,0,0]
    v_pk_fma_f32 v[90:91], v[150:151], v[22:23], v[90:91] op_sel:[1,0,0]
    s_set_gpr_idx_off
    s_and_b32 s31, s48, 0xfffffc00
    s_sub_u32 s29, s29, 4
    s_cbranch_scc1 L2_exit
    s_setprio 2
    v_exp_f32 v12, v138
    s_waitcnt vmcnt(7)
    v_mfma_f32_4x4x4_16b_bf16 v[16:19], v[32:33], v[212:213], 0 cbsz:4 abid:4
    v_exp_f32 v13, v139
    v_mfma_f32_4x4x4_16b_bf16 v[20:23], v[32:33], v[214:215], 0 cbsz:4 abid:4
    v_readlane_b32 s49, v7, 5
    v_rcp_f32 v14, v14
    buffer_load_dwordx4 v[212:215], v1, s[12:15], s31 offen
    v_rcp_f32 v15, v15
    v_pk_add_f32 v[12:13], v[12:13], 1.0 op_sel_hi:[1,0]
    v_pk_mul_f32 v[152:153], v[152:153], v[14:15]
    s_set_gpr_idx_on s40, gpr_idx(SRC2,DST)
    v_pk_fma_f32 v[84:85], v[136:137], v[16:17], v[84:85] op_sel_hi:[0,1,1]
    v_pk_fma_f32 v[86:87], v[136:137], v[18:19], v[86:87] op_sel_hi:[0,1,1]
    v_pk_fma_f32 v[88:89], v[152:153], v[20:21], v[88:89] op_sel_hi:[0,1,1]
    v_pk_fma_f32 v[90:91], v[152:153], v[22:23], v[90:91] op_sel_hi:[0,1,1]
    s_set_gpr_idx_off
    s_and_b32 s31, s49, 0xfffffc00
    s_waitcnt lgkmcnt(0)
    s_waitcnt vmcnt(7)
    v_mfma_f32_4x4x4_16b_bf16 v[16:19], v[32:33], v[216:217], 0 cbsz:4 abid:5
    v_readlane_b32 s50, v7, 6
    v_mfma_f32_4x4x4_16b_bf16 v[20:23], v[32:33], v[218:219], 0 cbsz:4 abid:5
    v_mfma_f32_32x32x16_bf16 v[164:179], v[24:27], v[36:39], 0
    v_exp_f32 v14, v154
    v_exp_f32 v15, v155
    v_rcp_f32 v12, v12
    v_rcp_f32 v13, v13
    buffer_load_dwordx4 v[216:219], v1, s[12:15], s31 offen
    v_pk_add_f32 v[14:15], v[14:15], 1.0 op_sel_hi:[1,0]
    v_pk_mul_f32 v[138:139], v[138:139], v[12:13]
    s_set_gpr_idx_on s41, gpr_idx(SRC2,DST)
    v_pk_fma_f32 v[84:85], v[136:137], v[16:17], v[84:85] op_sel:[1,0,0]
    v_pk_fma_f32 v[86:87], v[136:137], v[18:19], v[86:87] op_sel:[1,0,0]
    v_pk_fma_f32 v[88:89], v[152:153], v[20:21], v[88:89] op_sel:[1,0,0]
    v_pk_fma_f32 v[90:91], v[152:153], v[22:23], v[90:91] op_sel:[1,0,0]
    s_set_gpr_idx_off
    s_and_b32 s31, s50, 0xfffffc00
    v_exp_f32 v12, v140
    s_waitcnt vmcnt(7)
    v_mfma_f32_4x4x4_16b_bf16 v[16:19], v[32:33], v[220:221], 0 cbsz:4 abid:6
    v_exp_f32 v13, v141
    v_mfma_f32_4x4x4_16b_bf16 v[20:23], v[32:33], v[222:223], 0 cbsz:4 abid:6
    v_readlane_b32 s51, v7, 7
    v_rcp_f32 v14, v14
    buffer_load_dwordx4 v[220:223], v1, s[12:15], s31 offen
    v_rcp_f32 v15, v15
    v_pk_add_f32 v[12:13], v[12:13], 1.0 op_sel_hi:[1,0]
    v_pk_mul_f32 v[154:155], v[154:155], v[14:15]
    s_set_gpr_idx_on s42, gpr_idx(SRC2,DST)
    v_pk_fma_f32 v[84:85], v[138:139], v[16:17], v[84:85] op_sel_hi:[0,1,1]
    v_pk_fma_f32 v[86:87], v[138:139], v[18:19], v[86:87] op_sel_hi:[0,1,1]
    v_pk_fma_f32 v[88:89], v[154:155], v[20:21], v[88:89] op_sel_hi:[0,1,1]
    v_pk_fma_f32 v[90:91], v[154:155], v[22:23], v[90:91] op_sel_hi:[0,1,1]
    s_set_gpr_idx_off
    s_and_b32 s31, s51, 0xfffffc00
    s_waitcnt vmcnt(7)
    v_mfma_f32_4x4x4_16b_bf16 v[16:19], v[32:33], v[224:225], 0 cbsz:4 abid:7
    v_readlane_b32 s52, v7, 8
    v_mfma_f32_4x4x4_16b_bf16 v[20:23], v[32:33], v[226:227], 0 cbsz:4 abid:7
    v_mfma_f32_32x32x16_bf16 v[164:179], v[28:31], v[40:43], v[164:179]
    v_exp_f32 v14, v156
    v_exp_f32 v15, v157
    v_rcp_f32 v12, v12
    v_rcp_f32 v13, v13
    buffer_load_dwordx4 v[224:227], v1, s[12:15], s31 offen
    v_pk_add_f32 v[14:15], v[14:15], 1.0 op_sel_hi:[1,0]
    v_pk_mul_f32 v[140:141], v[140:141], v[12:13]
    s_set_gpr_idx_on s43, gpr_idx(SRC2,DST)
    v_pk_fma_f32 v[84:85], v[138:139], v[16:17], v[84:85] op_sel:[1,0,0]
    v_pk_fma_f32 v[86:87], v[138:139], v[18:19], v[86:87] op_sel:[1,0,0]
    v_pk_fma_f32 v[88:89], v[154:155], v[20:21], v[88:89] op_sel:[1,0,0]
    v_pk_fma_f32 v[90:91], v[154:155], v[22:23], v[90:91] op_sel:[1,0,0]
    s_set_gpr_idx_off
    s_and_b32 s31, s52, 0xfffffc00
    s_sub_u32 s29, s29, 4
    s_cbranch_scc1 L2_exit
    s_setprio 1
    v_exp_f32 v12, v142
    s_waitcnt vmcnt(7)
    v_mfma_f32_4x4x4_16b_bf16 v[16:19], v[32:33], v[196:197], 0 cbsz:4 abid:8
    v_exp_f32 v13, v143
    v_mfma_f32_4x4x4_16b_bf16 v[20:23], v[32:33], v[198:199], 0 cbsz:4 abid:8
    v_readlane_b32 s53, v7, 9
    v_rcp_f32 v14, v14
    buffer_load_dwordx4 v[196:199], v1, s[12:15], s31 offen
    v_rcp_f32 v15, v15
    v_pk_add_f32 v[12:13], v[12:13], 1.0 op_sel_hi:[1,0]
    v_pk_mul_f32 v[156:157], v[156:157], v[14:15]
    s_set_gpr_idx_on s44, gpr_idx(SRC2,DST)
    v_pk_fma_f32 v[84:85], v[140:141], v[16:17], v[84:85] op_sel_hi:[0,1,1]
    v_pk_fma_f32 v[86:87], v[140:141], v[18:19], v[86:87] op_sel_hi:[0,1,1]
    v_pk_fma_f32 v[88:89], v[156:157], v[20:21], v[88:89] op_sel_hi:[0,1,1]
    v_pk_fma_f32 v[90:91], v[156:157], v[22:23], v[90:91] op_sel_hi:[0,1,1]
    s_set_gpr_idx_off
    s_and_b32 s31, s53, 0xfffffc00
    s_waitcnt vmcnt(7)
    v_mfma_f32_4x4x4_16b_bf16 v[16:19], v[32:33], v[200:201], 0 cbsz:4 abid:9
    v_readlane_b32 s54, v7, 10
    v_mfma_f32_4x4x4_16b_bf16 v[20:23], v[32:33], v[202:203], 0 cbsz:4 abid:9
    v_mfma_f32_32x32x16_bf16 v[180:195], v[24:27], v[44:47], 0
    v_exp_f32 v14, v158
    v_exp_f32 v15, v159
    v_rcp_f32 v12, v12
    v_rcp_f32 v13, v13
    buffer_load_dwordx4 v[200:203], v1, s[12:15], s31 offen
    v_pk_add_f32 v[14:15], v[14:15], 1.0 op_sel_hi:[1,0]
    v_pk_mul_f32 v[142:143], v[142:143], v[12:13]
    s_set_gpr_idx_on s45, gpr_idx(SRC2,DST)
    v_pk_fma_f32 v[84:85], v[140:141], v[16:17], v[84:85] op_sel:[1,0,0]
    v_pk_fma_f32 v[86:87], v[140:141], v[18:19], v[86:87] op_sel:[1,0,0]
    v_pk_fma_f32 v[88:89], v[156:157], v[20:21], v[88:89] op_sel:[1,0,0]
    v_pk_fma_f32 v[90:91], v[156:157], v[22:23], v[90:91] op_sel:[1,0,0]
    s_set_gpr_idx_off
    s_and_b32 s31, s54, 0xfffffc00
    v_exp_f32 v12, v144
    s_waitcnt vmcnt(7)
    v_mfma_f32_4x4x4_16b_bf16 v[16:19], v[32:33], v[204:205], 0 cbsz:4 abid:10
    v_exp_f32 v13, v145
    v_mfma_f32_4x4x4_16b_bf16 v[20:23], v[32:33], v[206:207], 0 cbsz:4 abid:10
    v_readlane_b32 s55, v7, 11
    v_rcp_f32 v14, v14
    buffer_load_dwordx4 v[204:207], v1, s[12:15], s31 offen
    v_rcp_f32 v15, v15
    v_pk_add_f32 v[12:13], v[12:13], 1.0 op_sel_hi:[1,0]
    v_pk_mul_f32 v[158:159], v[158:159], v[14:15]
    s_set_gpr_idx_on s46, gpr_idx(SRC2,DST)
    v_pk_fma_f32 v[84:85], v[142:143], v[16:17], v[84:85] op_sel_hi:[0,1,1]
    v_pk_fma_f32 v[86:87], v[142:143], v[18:19], v[86:87] op_sel_hi:[0,1,1]
    v_pk_fma_f32 v[88:89], v[158:159], v[20:21], v[88:89] op_sel_hi:[0,1,1]
    v_pk_fma_f32 v[90:91], v[158:159], v[22:23], v[90:91] op_sel_hi:[0,1,1]
    s_set_gpr_idx_off
    s_and_b32 s31, s55, 0xfffffc00
    s_waitcnt vmcnt(7)
    v_mfma_f32_4x4x4_16b_bf16 v[16:19], v[32:33], v[208:209], 0 cbsz:4 abid:11
    v_readlane_b32 s56, v7, 12
    v_mfma_f32_4x4x4_16b_bf16 v[20:23], v[32:33], v[210:211], 0 cbsz:4 abid:11
    v_mfma_f32_32x32x16_bf16 v[180:195], v[28:31], v[48:51], v[180:195]
    v_exp_f32 v14, v160
    v_exp_f32 v15, v161
    v_rcp_f32 v12, v12
    v_rcp_f32 v13, v13
    buffer_load_dwordx4 v[208:211], v1, s[12:15], s31 offen
    v_pk_add_f32 v[14:15], v[14:15], 1.0 op_sel_hi:[1,0]
    v_pk_mul_f32 v[144:145], v[144:145], v[12:13]
    s_set_gpr_idx_on s47, gpr_idx(SRC2,DST)
    v_pk_fma_f32 v[84:85], v[142:143], v[16:17], v[84:85] op_sel:[1,0,0]
    v_pk_fma_f32 v[86:87], v[142:143], v[18:19], v[86:87] op_sel:[1,0,0]
    v_pk_fma_f32 v[88:89], v[158:159], v[20:21], v[88:89] op_sel:[1,0,0]
    v_pk_fma_f32 v[90:91], v[158:159], v[22:23], v[90:91] op_sel:[1,0,0]
    s_set_gpr_idx_off
    s_and_b32 s31, s56, 0xfffffc00
    s_sub_u32 s29, s29, 4
    s_cbranch_scc1 L2_exit
    s_setprio 0
    v_exp_f32 v12, v146
    s_waitcnt vmcnt(7)
    v_mfma_f32_4x4x4_16b_bf16 v[16:19], v[32:33], v[212:213], 0 cbsz:4 abid:12
    v_exp_f32 v13, v147
    v_mfma_f32_4x4x4_16b_bf16 v[20:23], v[32:33], v[214:215], 0 cbsz:4 abid:12
    v_readlane_b32 s57, v7, 13
    v_rcp_f32 v14, v14
    buffer_load_dwordx4 v[212:215], v1, s[12:15], s31 offen
    v_rcp_f32 v15, v15
    v_pk_add_f32 v[12:13], v[12:13], 1.0 op_sel_hi:[1,0]
    v_pk_mul_f32 v[160:161], v[160:161], v[14:15]
    s_set_gpr_idx_on s48, gpr_idx(SRC2,DST)
    v_pk_fma_f32 v[84:85], v[144:145], v[16:17], v[84:85] op_sel_hi:[0,1,1]
    v_pk_fma_f32 v[86:87], v[144:145], v[18:19], v[86:87] op_sel_hi:[0,1,1]
    v_pk_fma_f32 v[88:89], v[160:161], v[20:21], v[88:89] op_sel_hi:[0,1,1]
    v_pk_fma_f32 v[90:91], v[160:161], v[22:23], v[90:91] op_sel_hi:[0,1,1]
    s_set_gpr_idx_off
    s_and_b32 s31, s57, 0xfffffc00
    v_exp_f32 v14, v162
    s_waitcnt vmcnt(7)
    v_mfma_f32_4x4x4_16b_bf16 v[16:19], v[32:33], v[216:217], 0 cbsz:4 abid:13
    v_exp_f32 v15, v163
    v_mfma_f32_4x4x4_16b_bf16 v[20:23], v[32:33], v[218:219], 0 cbsz:4 abid:13
    v_readlane_b32 s58, v7, 14
    v_rcp_f32 v12, v12
    buffer_load_dwordx4 v[216:219], v1, s[12:15], s31 offen
    v_rcp_f32 v13, v13
    v_pk_add_f32 v[14:15], v[14:15], 1.0 op_sel_hi:[1,0]
    v_pk_mul_f32 v[146:147], v[146:147], v[12:13]
    s_set_gpr_idx_on s49, gpr_idx(SRC2,DST)
    v_pk_fma_f32 v[84:85], v[144:145], v[16:17], v[84:85] op_sel:[1,0,0]
    v_pk_fma_f32 v[86:87], v[144:145], v[18:19], v[86:87] op_sel:[1,0,0]
    v_pk_fma_f32 v[88:89], v[160:161], v[20:21], v[88:89] op_sel:[1,0,0]
    v_pk_fma_f32 v[90:91], v[160:161], v[22:23], v[90:91] op_sel:[1,0,0]
    s_set_gpr_idx_off
    s_and_b32 s31, s58, 0xfffffc00
    v_exp_f32 v12, v164
    s_waitcnt vmcnt(7)
    v_mfma_f32_4x4x4_16b_bf16 v[16:19], v[32:33], v[220:221], 0 cbsz:4 abid:14
    v_exp_f32 v13, v165
    v_mfma_f32_4x4x4_16b_bf16 v[20:23], v[32:33], v[222:223], 0 cbsz:4 abid:14
    v_readlane_b32 s59, v7, 15
    v_rcp_f32 v14, v14
    buffer_load_dwordx4 v[220:223], v1, s[12:15], s31 offen
    v_rcp_f32 v15, v15
    v_pk_add_f32 v[12:13], v[12:13], 1.0 op_sel_hi:[1,0]
    v_pk_mul_f32 v[162:163], v[162:163], v[14:15]
    s_set_gpr_idx_on s50, gpr_idx(SRC2,DST)
    v_pk_fma_f32 v[84:85], v[146:147], v[16:17], v[84:85] op_sel_hi:[0,1,1]
    v_pk_fma_f32 v[86:87], v[146:147], v[18:19], v[86:87] op_sel_hi:[0,1,1]
    v_pk_fma_f32 v[88:89], v[162:163], v[20:21], v[88:89] op_sel_hi:[0,1,1]
    v_pk_fma_f32 v[90:91], v[162:163], v[22:23], v[90:91] op_sel_hi:[0,1,1]
    s_set_gpr_idx_off
    s_and_b32 s31, s59, 0xfffffc00
    v_exp_f32 v14, v180
    s_waitcnt vmcnt(7)
    v_mfma_f32_4x4x4_16b_bf16 v[16:19], v[32:33], v[224:225], 0 cbsz:4 abid:15
    v_exp_f32 v15, v181
    v_mfma_f32_4x4x4_16b_bf16 v[20:23], v[32:33], v[226:227], 0 cbsz:4 abid:15
    v_readlane_b32 s60, v8, 0
    v_rcp_f32 v12, v12
    buffer_load_dwordx4 v[224:227], v1, s[12:15], s31 offen
    v_rcp_f32 v13, v13
    v_pk_add_f32 v[14:15], v[14:15], 1.0 op_sel_hi:[1,0]
    v_pk_mul_f32 v[164:165], v[164:165], v[12:13]
    s_set_gpr_idx_on s51, gpr_idx(SRC2,DST)
    v_pk_fma_f32 v[84:85], v[146:147], v[16:17], v[84:85] op_sel:[1,0,0]
    v_pk_fma_f32 v[86:87], v[146:147], v[18:19], v[86:87] op_sel:[1,0,0]
    v_pk_fma_f32 v[88:89], v[162:163], v[20:21], v[88:89] op_sel:[1,0,0]
    v_pk_fma_f32 v[90:91], v[162:163], v[22:23], v[90:91] op_sel:[1,0,0]
    s_set_gpr_idx_off
    s_and_b32 s31, s60, 0xfffffc00
    s_sub_u32 s29, s29, 4
    s_cbranch_scc1 L2_exit
    s_setprio 3
    ds_read_b32 v9, v5 offset:260
    ds_read_b32 v10, v6 offset:260
    ds_read_b32 v7, v4 offset:320
    v_exp_f32 v12, v166
    s_waitcnt vmcnt(7)
    v_mfma_f32_4x4x4_16b_bf16 v[16:19], v[34:35], v[196:197], 0 cbsz:4 abid:0
    v_exp_f32 v13, v167
    v_mfma_f32_4x4x4_16b_bf16 v[20:23], v[34:35], v[198:199], 0 cbsz:4 abid:0
    v_readlane_b32 s61, v8, 1
    v_rcp_f32 v14, v14
    buffer_load_dwordx4 v[196:199], v1, s[12:15], s31 offen
    v_rcp_f32 v15, v15
    v_pk_add_f32 v[12:13], v[12:13], 1.0 op_sel_hi:[1,0]
    v_pk_mul_f32 v[180:181], v[180:181], v[14:15]
    s_set_gpr_idx_on s52, gpr_idx(SRC2,DST)
    v_pk_fma_f32 v[84:85], v[164:165], v[16:17], v[84:85] op_sel_hi:[0,1,1]
    v_pk_fma_f32 v[86:87], v[164:165], v[18:19], v[86:87] op_sel_hi:[0,1,1]
    v_pk_fma_f32 v[88:89], v[180:181], v[20:21], v[88:89] op_sel_hi:[0,1,1]
    v_pk_fma_f32 v[90:91], v[180:181], v[22:23], v[90:91] op_sel_hi:[0,1,1]
    s_set_gpr_idx_off
    s_and_b32 s31, s61, 0xfffffc00
    v_exp_f32 v14, v182
    s_waitcnt vmcnt(7)
    v_mfma_f32_4x4x4_16b_bf16 v[16:19], v[34:35], v[200:201], 0 cbsz:4 abid:1
    v_exp_f32 v15, v183
    v_mfma_f32_4x4x4_16b_bf16 v[20:23], v[34:35], v[202:203], 0 cbsz:4 abid:1
    v_readlane_b32 s62, v8, 2
    v_rcp_f32 v12, v12
    buffer_load_dwordx4 v[200:203], v1, s[12:15], s31 offen
    v_rcp_f32 v13, v13
    v_pk_add_f32 v[14:15], v[14:15], 1.0 op_sel_hi:[1,0]
    v_pk_mul_f32 v[166:167], v[166:167], v[12:13]
    s_set_gpr_idx_on s53, gpr_idx(SRC2,DST)
    v_pk_fma_f32 v[84:85], v[164:165], v[16:17], v[84:85] op_sel:[1,0,0]
    v_pk_fma_f32 v[86:87], v[164:165], v[18:19], v[86:87] op_sel:[1,0,0]
    v_pk_fma_f32 v[88:89], v[180:181], v[20:21], v[88:89] op_sel:[1,0,0]
    v_pk_fma_f32 v[90:91], v[180:181], v[22:23], v[90:91] op_sel:[1,0,0]
    s_set_gpr_idx_off
    s_and_b32 s31, s62, 0xfffffc00
    s_waitcnt lgkmcnt(0)
    v_add_u32 v9, v9, v2
    v_add_u32 v10, v10, v3
    s_mov_b64 exec, s[32:33]
    ds_read_b128 v[24:27], v9 offset:63232
    s_mov_b64 exec, s[34:35]
    ds_read_b128 v[28:31], v9 offset:63232
    s_mov_b64 exec, -1
    ds_read_b64 v[32:33], v10
    v_exp_f32 v12, v168
    s_waitcnt vmcnt(7)
    v_mfma_f32_4x4x4_16b_bf16 v[16:19], v[34:35], v[204:205], 0 cbsz:4 abid:2
    v_exp_f32 v13, v169
    v_mfma_f32_4x4x4_16b_bf16 v[20:23], v[34:35], v[206:207], 0 cbsz:4 abid:2
    v_readlane_b32 s63, v8, 3
    v_rcp_f32 v14, v14
    buffer_load_dwordx4 v[204:207], v1, s[12:15], s31 offen
    v_rcp_f32 v15, v15
    v_pk_add_f32 v[12:13], v[12:13], 1.0 op_sel_hi:[1,0]
    v_pk_mul_f32 v[182:183], v[182:183], v[14:15]
    s_set_gpr_idx_on s54, gpr_idx(SRC2,DST)
    v_pk_fma_f32 v[84:85], v[166:167], v[16:17], v[84:85] op_sel_hi:[0,1,1]
    v_pk_fma_f32 v[86:87], v[166:167], v[18:19], v[86:87] op_sel_hi:[0,1,1]
    v_pk_fma_f32 v[88:89], v[182:183], v[20:21], v[88:89] op_sel_hi:[0,1,1]
    v_pk_fma_f32 v[90:91], v[182:183], v[22:23], v[90:91] op_sel_hi:[0,1,1]
    s_set_gpr_idx_off
    s_and_b32 s31, s63, 0xfffffc00
    v_exp_f32 v14, v184
    s_waitcnt vmcnt(7)
    v_mfma_f32_4x4x4_16b_bf16 v[16:19], v[34:35], v[208:209], 0 cbsz:4 abid:3
    v_exp_f32 v15, v185
    v_mfma_f32_4x4x4_16b_bf16 v[20:23], v[34:35], v[210:211], 0 cbsz:4 abid:3
    v_readlane_b32 s64, v8, 4
    v_rcp_f32 v12, v12
    buffer_load_dwordx4 v[208:211], v1, s[12:15], s31 offen
    v_rcp_f32 v13, v13
    v_pk_add_f32 v[14:15], v[14:15], 1.0 op_sel_hi:[1,0]
    v_pk_mul_f32 v[168:169], v[168:169], v[12:13]
    s_set_gpr_idx_on s55, gpr_idx(SRC2,DST)
    v_pk_fma_f32 v[84:85], v[166:167], v[16:17], v[84:85] op_sel:[1,0,0]
    v_pk_fma_f32 v[86:87], v[166:167], v[18:19], v[86:87] op_sel:[1,0,0]
    v_pk_fma_f32 v[88:89], v[182:183], v[20:21], v[88:89] op_sel:[1,0,0]
    v_pk_fma_f32 v[90:91], v[182:183], v[22:23], v[90:91] op_sel:[1,0,0]
    s_set_gpr_idx_off
    s_and_b32 s31, s64, 0xfffffc00
    s_sub_u32 s29, s29, 4
    s_cbranch_scc1 L2_exit
    s_setprio 2
    v_exp_f32 v12, v170
    s_waitcnt vmcnt(7)
    v_mfma_f32_4x4x4_16b_bf16 v[16:19], v[34:35], v[212:213], 0 cbsz:4 abid:4
    v_exp_f32 v13, v171
    v_mfma_f32_4x4x4_16b_bf16 v[20:23], v[34:35], v[214:215], 0 cbsz:4 abid:4
    v_readlane_b32 s65, v8, 5
    v_rcp_f32 v14, v14
    buffer_load_dwordx4 v[212:215], v1, s[12:15], s31 offen
    v_rcp_f32 v15, v15
    v_pk_add_f32 v[12:13], v[12:13], 1.0 op_sel_hi:[1,0]
    v_pk_mul_f32 v[184:185], v[184:185], v[14:15]
    s_set_gpr_idx_on s56, gpr_idx(SRC2,DST)
    v_pk_fma_f32 v[84:85], v[168:169], v[16:17], v[84:85] op_sel_hi:[0,1,1]
    v_pk_fma_f32 v[86:87], v[168:169], v[18:19], v[86:87] op_sel_hi:[0,1,1]
    v_pk_fma_f32 v[88:89], v[184:185], v[20:21], v[88:89] op_sel_hi:[0,1,1]
    v_pk_fma_f32 v[90:91], v[184:185], v[22:23], v[90:91] op_sel_hi:[0,1,1]
    s_set_gpr_idx_off
    s_and_b32 s31, s65, 0xfffffc00
    s_waitcnt lgkmcnt(0)
    s_waitcnt vmcnt(7)
    v_mfma_f32_4x4x4_16b_bf16 v[16:19], v[34:35], v[216:217], 0 cbsz:4 abid:5
    v_readlane_b32 s66, v8, 6
    v_mfma_f32_4x4x4_16b_bf16 v[20:23], v[34:35], v[218:219], 0 cbsz:4 abid:5
    v_mfma_f32_32x32x16_bf16 v[132:147], v[24:27], v[36:39], 0
    v_exp_f32 v14, v186
    v_exp_f32 v15, v187
    v_rcp_f32 v12, v12
    v_rcp_f32 v13, v13
    buffer_load_dwordx4 v[216:219], v1, s[12:15], s31 offen
    v_pk_add_f32 v[14:15], v[14:15], 1.0 op_sel_hi:[1,0]
    v_pk_mul_f32 v[170:171], v[170:171], v[12:13]
    s_set_gpr_idx_on s57, gpr_idx(SRC2,DST)
    v_pk_fma_f32 v[84:85], v[168:169], v[16:17], v[84:85] op_sel:[1,0,0]
    v_pk_fma_f32 v[86:87], v[168:169], v[18:19], v[86:87] op_sel:[1,0,0]
    v_pk_fma_f32 v[88:89], v[184:185], v[20:21], v[88:89] op_sel:[1,0,0]
    v_pk_fma_f32 v[90:91], v[184:185], v[22:23], v[90:91] op_sel:[1,0,0]
    s_set_gpr_idx_off
    s_and_b32 s31, s66, 0xfffffc00
    v_exp_f32 v12, v172
    s_waitcnt vmcnt(7)
    v_mfma_f32_4x4x4_16b_bf16 v[16:19], v[34:35], v[220:221], 0 cbsz:4 abid:6
    v_exp_f32 v13, v173
    v_mfma_f32_4x4x4_16b_bf16 v[20:23], v[34:35], v[222:223], 0 cbsz:4 abid:6
    v_readlane_b32 s67, v8, 7
    v_rcp_f32 v14, v14
    buffer_load_dwordx4 v[220:223], v1, s[12:15], s31 offen
    v_rcp_f32 v15, v15
    v_pk_add_f32 v[12:13], v[12:13], 1.0 op_sel_hi:[1,0]
    v_pk_mul_f32 v[186:187], v[186:187], v[14:15]
    s_set_gpr_idx_on s58, gpr_idx(SRC2,DST)
    v_pk_fma_f32 v[84:85], v[170:171], v[16:17], v[84:85] op_sel_hi:[0,1,1]
    v_pk_fma_f32 v[86:87], v[170:171], v[18:19], v[86:87] op_sel_hi:[0,1,1]
    v_pk_fma_f32 v[88:89], v[186:187], v[20:21], v[88:89] op_sel_hi:[0,1,1]
    v_pk_fma_f32 v[90:91], v[186:187], v[22:23], v[90:91] op_sel_hi:[0,1,1]
    s_set_gpr_idx_off
    s_and_b32 s31, s67, 0xfffffc00
    s_waitcnt vmcnt(7)
    v_mfma_f32_4x4x4_16b_bf16 v[16:19], v[34:35], v[224:225], 0 cbsz:4 abid:7
    v_readlane_b32 s36, v8, 8
    v_mfma_f32_4x4x4_16b_bf16 v[20:23], v[34:35], v[226:227], 0 cbsz:4 abid:7
    v_mfma_f32_32x32x16_bf16 v[132:147], v[28:31], v[40:43], v[132:147]
    v_exp_f32 v14, v188
    v_exp_f32 v15, v189
    v_rcp_f32 v12, v12
    v_rcp_f32 v13, v13
    buffer_load_dwordx4 v[224:227], v1, s[12:15], s31 offen
    v_pk_add_f32 v[14:15], v[14:15], 1.0 op_sel_hi:[1,0]
    v_pk_mul_f32 v[172:173], v[172:173], v[12:13]
    s_set_gpr_idx_on s59, gpr_idx(SRC2,DST)
    v_pk_fma_f32 v[84:85], v[170:171], v[16:17], v[84:85] op_sel:[1,0,0]
    v_pk_fma_f32 v[86:87], v[170:171], v[18:19], v[86:87] op_sel:[1,0,0]
    v_pk_fma_f32 v[88:89], v[186:187], v[20:21], v[88:89] op_sel:[1,0,0]
    v_pk_fma_f32 v[90:91], v[186:187], v[22:23], v[90:91] op_sel:[1,0,0]
    s_set_gpr_idx_off
    s_and_b32 s31, s36, 0xfffffc00
    s_sub_u32 s29, s29, 4
    s_cbranch_scc1 L2_exit
    s_setprio 1
    v_exp_f32 v12, v174
    s_waitcnt vmcnt(7)
    v_mfma_f32_4x4x4_16b_bf16 v[16:19], v[34:35], v[196:197], 0 cbsz:4 abid:8
    v_exp_f32 v13, v175
    v_mfma_f32_4x4x4_16b_bf16 v[20:23], v[34:35], v[198:199], 0 cbsz:4 abid:8
    v_readlane_b32 s37, v8, 9
    v_rcp_f32 v14, v14
    buffer_load_dwordx4 v[196:199], v1, s[12:15], s31 offen
    v_rcp_f32 v15, v15
    v_pk_add_f32 v[12:13], v[12:13], 1.0 op_sel_hi:[1,0]
    v_pk_mul_f32 v[188:189], v[188:189], v[14:15]
    s_set_gpr_idx_on s60, gpr_idx(SRC2,DST)
    v_pk_fma_f32 v[84:85], v[172:173], v[16:17], v[84:85] op_sel_hi:[0,1,1]
    v_pk_fma_f32 v[86:87], v[172:173], v[18:19], v[86:87] op_sel_hi:[0,1,1]
    v_pk_fma_f32 v[88:89], v[188:189], v[20:21], v[88:89] op_sel_hi:[0,1,1]
    v_pk_fma_f32 v[90:91], v[188:189], v[22:23], v[90:91] op_sel_hi:[0,1,1]
    s_set_gpr_idx_off
    s_and_b32 s31, s37, 0xfffffc00
    s_waitcnt vmcnt(7)
    v_mfma_f32_4x4x4_16b_bf16 v[16:19], v[34:35], v[200:201], 0 cbsz:4 abid:9
    v_readlane_b32 s38, v8, 10
    v_mfma_f32_4x4x4_16b_bf16 v[20:23], v[34:35], v[202:203], 0 cbsz:4 abid:9
    v_mfma_f32_32x32x16_bf16 v[148:163], v[24:27], v[44:47], 0
    v_exp_f32 v14, v190
    v_exp_f32 v15, v191
    v_rcp_f32 v12, v12
    v_rcp_f32 v13, v13
    buffer_load_dwordx4 v[200:203], v1, s[12:15], s31 offen
    v_pk_add_f32 v[14:15], v[14:15], 1.0 op_sel_hi:[1,0]
    v_pk_mul_f32 v[174:175], v[174:175], v[12:13]
    s_set_gpr_idx_on s61, gpr_idx(SRC2,DST)
    v_pk_fma_f32 v[84:85], v[172:173], v[16:17], v[84:85] op_sel:[1,0,0]
    v_pk_fma_f32 v[86:87], v[172:173], v[18:19], v[86:87] op_sel:[1,0,0]
    v_pk_fma_f32 v[88:89], v[188:189], v[20:21], v[88:89] op_sel:[1,0,0]
    v_pk_fma_f32 v[90:91], v[188:189], v[22:23], v[90:91] op_sel:[1,0,0]
    s_set_gpr_idx_off
    s_and_b32 s31, s38, 0xfffffc00
    v_exp_f32 v12, v176
    s_waitcnt vmcnt(7)
    v_mfma_f32_4x4x4_16b_bf16 v[16:19], v[34:35], v[204:205], 0 cbsz:4 abid:10
    v_exp_f32 v13, v177
    v_mfma_f32_4x4x4_16b_bf16 v[20:23], v[34:35], v[206:207], 0 cbsz:4 abid:10
    v_readlane_b32 s39, v8, 11
    v_rcp_f32 v14, v14
    buffer_load_dwordx4 v[204:207], v1, s[12:15], s31 offen
    v_rcp_f32 v15, v15
    v_pk_add_f32 v[12:13], v[12:13], 1.0 op_sel_hi:[1,0]
    v_pk_mul_f32 v[190:191], v[190:191], v[14:15]
    s_set_gpr_idx_on s62, gpr_idx(SRC2,DST)
    v_pk_fma_f32 v[84:85], v[174:175], v[16:17], v[84:85] op_sel_hi:[0,1,1]
    v_pk_fma_f32 v[86:87], v[174:175], v[18:19], v[86:87] op_sel_hi:[0,1,1]
    v_pk_fma_f32 v[88:89], v[190:191], v[20:21], v[88:89] op_sel_hi:[0,1,1]
    v_pk_fma_f32 v[90:91], v[190:191], v[22:23], v[90:91] op_sel_hi:[0,1,1]
    s_set_gpr_idx_off
    s_and_b32 s31, s39, 0xfffffc00
    s_waitcnt vmcnt(7)
    v_mfma_f32_4x4x4_16b_bf16 v[16:19], v[34:35], v[208:209], 0 cbsz:4 abid:11
    v_readlane_b32 s40, v8, 12
    v_mfma_f32_4x4x4_16b_bf16 v[20:23], v[34:35], v[210:211], 0 cbsz:4 abid:11
    v_mfma_f32_32x32x16_bf16 v[148:163], v[28:31], v[48:51], v[148:163]
    v_exp_f32 v14, v192
    v_exp_f32 v15, v193
    v_rcp_f32 v12, v12
    v_rcp_f32 v13, v13
    buffer_load_dwordx4 v[208:211], v1, s[12:15], s31 offen
    v_pk_add_f32 v[14:15], v[14:15], 1.0 op_sel_hi:[1,0]
    v_pk_mul_f32 v[176:177], v[176:177], v[12:13]
    s_set_gpr_idx_on s63, gpr_idx(SRC2,DST)
    v_pk_fma_f32 v[84:85], v[174:175], v[16:17], v[84:85] op_sel:[1,0,0]
    v_pk_fma_f32 v[86:87], v[174:175], v[18:19], v[86:87] op_sel:[1,0,0]
    v_pk_fma_f32 v[88:89], v[190:191], v[20:21], v[88:89] op_sel:[1,0,0]
    v_pk_fma_f32 v[90:91], v[190:191], v[22:23], v[90:91] op_sel:[1,0,0]
    s_set_gpr_idx_off
    s_and_b32 s31, s40, 0xfffffc00
    s_sub_u32 s29, s29, 4
    s_cbranch_scc1 L2_exit
    s_setprio 0
    v_exp_f32 v12, v178
    s_waitcnt vmcnt(7)
    v_mfma_f32_4x4x4_16b_bf16 v[16:19], v[34:35], v[212:213], 0 cbsz:4 abid:12
    v_exp_f32 v13, v179
    v_mfma_f32_4x4x4_16b_bf16 v[20:23], v[34:35], v[214:215], 0 cbsz:4 abid:12
    v_readlane_b32 s41, v8, 13
    v_rcp_f32 v14, v14
    buffer_load_dwordx4 v[212:215], v1, s[12:15], s31 offen
    v_rcp_f32 v15, v15
    v_pk_add_f32 v[12:13], v[12:13], 1.0 op_sel_hi:[1,0]
    v_pk_mul_f32 v[192:193], v[192:193], v[14:15]
    s_set_gpr_idx_on s64, gpr_idx(SRC2,DST)
    v_pk_fma_f32 v[84:85], v[176:177], v[16:17], v[84:85] op_sel_hi:[0,1,1]
    v_pk_fma_f32 v[86:87], v[176:177], v[18:19], v[86:87] op_sel_hi:[0,1,1]
    v_pk_fma_f32 v[88:89], v[192:193], v[20:21], v[88:89] op_sel_hi:[0,1,1]
    v_pk_fma_f32 v[90:91], v[192:193], v[22:23], v[90:91] op_sel_hi:[0,1,1]
    s_set_gpr_idx_off
    s_and_b32 s31, s41, 0xfffffc00
    v_exp_f32 v14, v194
    s_waitcnt vmcnt(7)
    v_mfma_f32_4x4x4_16b_bf16 v[16:19], v[34:35], v[216:217], 0 cbsz:4 abid:13
    v_exp_f32 v15, v195
    v_mfma_f32_4x4x4_16b_bf16 v[20:23], v[34:35], v[218:219], 0 cbsz:4 abid:13
    v_readlane_b32 s42, v8, 14
    v_rcp_f32 v12, v12
    buffer_load_dwordx4 v[216:219], v1, s[12:15], s31 offen
    v_rcp_f32 v13, v13
    v_pk_add_f32 v[14:15], v[14:15], 1.0 op_sel_hi:[1,0]
    v_pk_mul_f32 v[178:179], v[178:179], v[12:13]
    s_set_gpr_idx_on s65, gpr_idx(SRC2,DST)
    v_pk_fma_f32 v[84:85], v[176:177], v[16:17], v[84:85] op_sel:[1,0,0]
    v_pk_fma_f32 v[86:87], v[176:177], v[18:19], v[86:87] op_sel:[1,0,0]
    v_pk_fma_f32 v[88:89], v[192:193], v[20:21], v[88:89] op_sel:[1,0,0]
    v_pk_fma_f32 v[90:91], v[192:193], v[22:23], v[90:91] op_sel:[1,0,0]
    s_set_gpr_idx_off
    s_and_b32 s31, s42, 0xfffffc00
    v_exp_f32 v12, v132
    s_waitcnt vmcnt(7)
    v_mfma_f32_4x4x4_16b_bf16 v[16:19], v[34:35], v[220:221], 0 cbsz:4 abid:14
    v_exp_f32 v13, v133
    v_mfma_f32_4x4x4_16b_bf16 v[20:23], v[34:35], v[222:223], 0 cbsz:4 abid:14
    v_readlane_b32 s43, v8, 15
    v_rcp_f32 v14, v14
    buffer_load_dwordx4 v[220:223], v1, s[12:15], s31 offen
    v_rcp_f32 v15, v15
    v_pk_add_f32 v[12:13], v[12:13], 1.0 op_sel_hi:[1,0]
    v_pk_mul_f32 v[194:195], v[194:195], v[14:15]
    s_set_gpr_idx_on s66, gpr_idx(SRC2,DST)
    v_pk_fma_f32 v[84:85], v[178:179], v[16:17], v[84:85] op_sel_hi:[0,1,1]
    v_pk_fma_f32 v[86:87], v[178:179], v[18:19], v[86:87] op_sel_hi:[0,1,1]
    v_pk_fma_f32 v[88:89], v[194:195], v[20:21], v[88:89] op_sel_hi:[0,1,1]
    v_pk_fma_f32 v[90:91], v[194:195], v[22:23], v[90:91] op_sel_hi:[0,1,1]
    s_set_gpr_idx_off
    s_and_b32 s31, s43, 0xfffffc00
    v_exp_f32 v14, v148
    s_waitcnt vmcnt(7)
    v_mfma_f32_4x4x4_16b_bf16 v[16:19], v[34:35], v[224:225], 0 cbsz:4 abid:15
    v_exp_f32 v15, v149
    v_mfma_f32_4x4x4_16b_bf16 v[20:23], v[34:35], v[226:227], 0 cbsz:4 abid:15
    v_readlane_b32 s44, v7, 0
    v_rcp_f32 v12, v12
    buffer_load_dwordx4 v[224:227], v1, s[12:15], s31 offen
    v_rcp_f32 v13, v13
    v_pk_add_f32 v[14:15], v[14:15], 1.0 op_sel_hi:[1,0]
    v_pk_mul_f32 v[132:133], v[132:133], v[12:13]
    s_set_gpr_idx_on s67, gpr_idx(SRC2,DST)
    v_pk_fma_f32 v[84:85], v[178:179], v[16:17], v[84:85] op_sel:[1,0,0]
    v_pk_fma_f32 v[86:87], v[178:179], v[18:19], v[86:87] op_sel:[1,0,0]
    v_pk_fma_f32 v[88:89], v[194:195], v[20:21], v[88:89] op_sel:[1,0,0]
    v_pk_fma_f32 v[90:91], v[194:195], v[22:23], v[90:91] op_sel:[1,0,0]
    s_set_gpr_idx_off
    s_and_b32 s31, s44, 0xfffffc00
    s_sub_u32 s29, s29, 4
    s_cbranch_scc1 L2_exit
    v_add_u32 v4, 256, v4
    v_add_u32 v5, 256, v5
    v_add_u32 v6, 256, v6
    s_branch L2_loop
L2_more:
    s_lshl_b32 s3, s2, 10
    s_waitcnt vmcnt(0) lgkmcnt(0)
    v_add_u32 v13, s3, v1
    s_barrier
    s_branch L2_round
L2_exit:
    s_add_u32 s28, s28, 1536
    s_cmp_lt_u32 s28, s11
    s_cbranch_scc1 L2_more
    s_mov_b32 s68, 0xbf317218
    s_mov_b32 s69, s68
    v_lshlrev_b32 v38, 2, v11
    s_and_b32 s3, s96, 0xffff
    s_mul_i32 s3, s3, 1261
    s_lshr_b32 s3, s3, 16
    s_mul_i32 s3, s3, 1152
    v_add_u32 v44, s3, v38
    v_pk_mul_f32 v[84:85], v[84:85], s[68:69]
    v_pk_mul_f32 v[86:87], v[86:87], s[68:69]
    v_pk_mul_f32 v[88:89], v[88:89], s[68:69]
    v_pk_mul_f32 v[90:91], v[90:91], s[68:69]
    v_cvt_pk_bf16_f32 v84, v84, v88
    v_cvt_pk_bf16_f32 v85, v85, v89
    v_cvt_pk_bf16_f32 v86, v86, v90
    v_cvt_pk_bf16_f32 v87, v87, v91
    ds_write_b32 v44, v84 offset:16128
    ds_write_b32 v44, v85 offset:16416
    ds_write_b32 v44, v86 offset:16704
    ds_write_b32 v44, v87 offset:16992
    s_and_b32 s3, s97, 0xffff
    s_mul_i32 s3, s3, 1261
    s_lshr_b32 s3, s3, 16
    s_mul_i32 s3, s3, 1152
    v_add_u32 v45, s3, v38
    v_pk_mul_f32 v[92:93], v[92:93], s[68:69]
    v_pk_mul_f32 v[94:95], v[94:95], s[68:69]
    v_pk_mul_f32 v[96:97], v[96:97], s[68:69]
    v_pk_mul_f32 v[98:99], v[98:99], s[68:69]
    v_cvt_pk_bf16_f32 v92, v92, v96
    v_cvt_pk_bf16_f32 v93, v93, v97
    v_cvt_pk_bf16_f32 v94, v94, v98
    v_cvt_pk_bf16_f32 v95, v95, v99
    ds_write_b32 v45, v92 offset:16128
    ds_write_b32 v45, v93 offset:16416
    ds_write_b32 v45, v94 offset:16704
    ds_write_b32 v45, v95 offset:16992
    s_and_b32 s3, s98, 0xffff
    s_mul_i32 s3, s3, 1261
    s_lshr_b32 s3, s3, 16
    s_mul_i32 s3, s3, 1152
    v_add_u32 v46, s3, v38
    v_pk_mul_f32 v[100:101], v[100:101], s[68:69]
    v_pk_mul_f32 v[102:103], v[102:103], s[68:69]
    v_pk_mul_f32 v[104:105], v[104:105], s[68:69]
    v_pk_mul_f32 v[106:107], v[106:107], s[68:69]
    v_cvt_pk_bf16_f32 v100, v100, v104
    v_cvt_pk_bf16_f32 v101, v101, v105
    v_cvt_pk_bf16_f32 v102, v102, v106
    v_cvt_pk_bf16_f32 v103, v103, v107
    ds_write_b32 v46, v100 offset:16128
    ds_write_b32 v46, v101 offset:16416
    ds_write_b32 v46, v102 offset:16704
    ds_write_b32 v46, v103 offset:16992
    s_and_b32 s3, s99, 0xffff
    s_mul_i32 s3, s3, 1261
    s_lshr_b32 s3, s3, 16
    s_mul_i32 s3, s3, 1152
    v_add_u32 v47, s3, v38
    v_pk_mul_f32 v[108:109], v[108:109], s[68:69]
    v_pk_mul_f32 v[110:111], v[110:111], s[68:69]
    v_pk_mul_f32 v[112:113], v[112:113], s[68:69]
    v_pk_mul_f32 v[114:115], v[114:115], s[68:69]
    v_cvt_pk_bf16_f32 v108, v108, v112
    v_cvt_pk_bf16_f32 v109, v109, v113
    v_cvt_pk_bf16_f32 v110, v110, v114
    v_cvt_pk_bf16_f32 v111, v111, v115
    ds_write_b32 v47, v108 offset:16128
    ds_write_b32 v47, v109 offset:16416
    ds_write_b32 v47, v110 offset:16704
    ds_write_b32 v47, v111 offset:16992
    s_and_b32 s3, s100, 0xffff
    s_mul_i32 s3, s3, 1261
    s_lshr_b32 s3, s3, 16
    s_mul_i32 s3, s3, 1152
    v_add_u32 v48, s3, v38
    v_pk_mul_f32 v[116:117], v[116:117], s[68:69]
    v_pk_mul_f32 v[118:119], v[118:119], s[68:69]
    v_pk_mul_f32 v[120:121], v[120:121], s[68:69]
    v_pk_mul_f32 v[122:123], v[122:123], s[68:69]
    v_cvt_pk_bf16_f32 v116, v116, v120
    v_cvt_pk_bf16_f32 v117, v117, v121
    v_cvt_pk_bf16_f32 v118, v118, v122
    v_cvt_pk_bf16_f32 v119, v119, v123
    ds_write_b32 v48, v116 offset:16128
    ds_write_b32 v48, v117 offset:16416
    ds_write_b32 v48, v118 offset:16704
    ds_write_b32 v48, v119 offset:16992
    s_mul_i32 s31, s101, 23040
    v_and_b32 v39, 15, v11
    v_lshrrev_b32 v40, 4, v11
    v_mul_u32_u24 v41, 288, v39
    v_lshl_add_u32 v41, v40, 4, v41
    v_add_u32 v41, s31, v41
    s_mul_i32 s68, s101, 5120
    s_add_u32 s68, s68, s2
    s_lshl_b32 s68, s68, 10
    s_and_b32 s3, s10, 3
    s_lshl_b32 s3, s3, 8
    s_add_u32 s68, s68, s3
    v_lshlrev_b32 v40, 18, v40
    v_lshl_add_u32 v40, v39, 4, v40
    v_add_u32 v40, s68, v40
    s_waitcnt lgkmcnt(0)
    s_barrier
    ds_read_b128 v[84:87], v41 offset:16128
    ds_read_b128 v[88:91], v41 offset:16192
    ds_read_b128 v[92:95], v41 offset:16256
    ds_read_b128 v[96:99], v41 offset:16320
    ds_read_b128 v[100:103], v41 offset:20736
    ds_read_b128 v[104:107], v41 offset:20800
    ds_read_b128 v[108:111], v41 offset:20864
    ds_read_b128 v[112:115], v41 offset:20928
    s_waitcnt lgkmcnt(7)
    v_mfma_f32_16x16x32_bf16 v[116:119], v[84:87], v[52:55], 0
    v_mfma_f32_16x16x32_bf16 v[120:123], v[84:87], v[56:59], 0
    s_waitcnt lgkmcnt(6)
    v_mfma_f32_16x16x32_bf16 v[116:119], v[88:91], v[60:63], v[116:119]
    v_mfma_f32_16x16x32_bf16 v[120:123], v[88:91], v[64:67], v[120:123]
    s_waitcnt lgkmcnt(5)
    v_mfma_f32_16x16x32_bf16 v[116:119], v[92:95], v[68:71], v[116:119]
    v_mfma_f32_16x16x32_bf16 v[120:123], v[92:95], v[72:75], v[120:123]
    s_waitcnt lgkmcnt(4)
    v_mfma_f32_16x16x32_bf16 v[116:119], v[96:99], v[76:79], v[116:119]
    v_mfma_f32_16x16x32_bf16 v[120:123], v[96:99], v[80:83], v[120:123]
    ds_read_b128 v[84:87], v41 offset:25344
    ds_read_b128 v[88:91], v41 offset:25408
    ds_read_b128 v[92:95], v41 offset:25472
    ds_read_b128 v[96:99], v41 offset:25536
    s_waitcnt lgkmcnt(7)
    v_mfma_f32_16x16x32_bf16 v[124:127], v[100:103], v[52:55], 0
    v_mfma_f32_16x16x32_bf16 v[128:131], v[100:103], v[56:59], 0
    s_waitcnt lgkmcnt(6)
    v_mfma_f32_16x16x32_bf16 v[124:127], v[104:107], v[60:63], v[124:127]
    v_mfma_f32_16x16x32_bf16 v[128:131], v[104:107], v[64:67], v[128:131]
    s_waitcnt lgkmcnt(5)
    v_mfma_f32_16x16x32_bf16 v[124:127], v[108:111], v[68:71], v[124:127]
    v_mfma_f32_16x16x32_bf16 v[128:131], v[108:111], v[72:75], v[128:131]
    s_waitcnt lgkmcnt(4)
    v_mfma_f32_16x16x32_bf16 v[124:127], v[112:115], v[76:79], v[124:127]
    v_mfma_f32_16x16x32_bf16 v[128:131], v[112:115], v[80:83], v[128:131]
    v_cvt_pk_bf16_f32 v44, v116, v117
    v_cvt_pk_bf16_f32 v45, v118, v119
    v_cvt_pk_bf16_f32 v46, v120, v121
    v_cvt_pk_bf16_f32 v47, v122, v123
    s_mov_b32 s3, 0
    buffer_store_dwordx4 v[44:47], v40, s[24:27], s3 offen sc0 sc1
    ds_read_b128 v[100:103], v41 offset:29952
    ds_read_b128 v[104:107], v41 offset:30016
    ds_read_b128 v[108:111], v41 offset:30080
    ds_read_b128 v[112:115], v41 offset:30144
    s_waitcnt lgkmcnt(7)
    v_mfma_f32_16x16x32_bf16 v[116:119], v[84:87], v[52:55], 0
    v_mfma_f32_16x16x32_bf16 v[120:123], v[84:87], v[56:59], 0
    s_waitcnt lgkmcnt(6)
    v_mfma_f32_16x16x32_bf16 v[116:119], v[88:91], v[60:63], v[116:119]
    v_mfma_f32_16x16x32_bf16 v[120:123], v[88:91], v[64:67], v[120:123]
    s_waitcnt lgkmcnt(5)
    v_mfma_f32_16x16x32_bf16 v[116:119], v[92:95], v[68:71], v[116:119]
    v_mfma_f32_16x16x32_bf16 v[120:123], v[92:95], v[72:75], v[120:123]
    s_waitcnt lgkmcnt(4)
    v_mfma_f32_16x16x32_bf16 v[116:119], v[96:99], v[76:79], v[116:119]
    v_mfma_f32_16x16x32_bf16 v[120:123], v[96:99], v[80:83], v[120:123]
    v_cvt_pk_bf16_f32 v48, v124, v125
    v_cvt_pk_bf16_f32 v49, v126, v127
    v_cvt_pk_bf16_f32 v50, v128, v129
    v_cvt_pk_bf16_f32 v51, v130, v131
    s_mov_b32 s3, 1048576
    buffer_store_dwordx4 v[48:51], v40, s[24:27], s3 offen sc0 sc1
    ds_read_b128 v[84:87], v41 offset:34560
    ds_read_b128 v[88:91], v41 offset:34624
    ds_read_b128 v[92:95], v41 offset:34688
    ds_read_b128 v[96:99], v41 offset:34752
    s_waitcnt lgkmcnt(7)
    v_mfma_f32_16x16x32_bf16 v[124:127], v[100:103], v[52:55], 0
    v_mfma_f32_16x16x32_bf16 v[128:131], v[100:103], v[56:59], 0
    s_waitcnt lgkmcnt(6)
    v_mfma_f32_16x16x32_bf16 v[124:127], v[104:107], v[60:63], v[124:127]
    v_mfma_f32_16x16x32_bf16 v[128:131], v[104:107], v[64:67], v[128:131]
    s_waitcnt lgkmcnt(5)
    v_mfma_f32_16x16x32_bf16 v[124:127], v[108:111], v[68:71], v[124:127]
    v_mfma_f32_16x16x32_bf16 v[128:131], v[108:111], v[72:75], v[128:131]
    s_waitcnt lgkmcnt(4)
    v_mfma_f32_16x16x32_bf16 v[124:127], v[112:115], v[76:79], v[124:127]
    v_mfma_f32_16x16x32_bf16 v[128:131], v[112:115], v[80:83], v[128:131]
    v_cvt_pk_bf16_f32 v44, v116, v117
    v_cvt_pk_bf16_f32 v45, v118, v119
    v_cvt_pk_bf16_f32 v46, v120, v121
    v_cvt_pk_bf16_f32 v47, v122, v123
    s_mov_b32 s3, 2097152
    buffer_store_dwordx4 v[44:47], v40, s[24:27], s3 offen sc0 sc1
    s_waitcnt lgkmcnt(3)
    v_mfma_f32_16x16x32_bf16 v[116:119], v[84:87], v[52:55], 0
    v_mfma_f32_16x16x32_bf16 v[120:123], v[84:87], v[56:59], 0
    s_waitcnt lgkmcnt(2)
    v_mfma_f32_16x16x32_bf16 v[116:119], v[88:91], v[60:63], v[116:119]
    v_mfma_f32_16x16x32_bf16 v[120:123], v[88:91], v[64:67], v[120:123]
    s_waitcnt lgkmcnt(1)
    v_mfma_f32_16x16x32_bf16 v[116:119], v[92:95], v[68:71], v[116:119]
    v_mfma_f32_16x16x32_bf16 v[120:123], v[92:95], v[72:75], v[120:123]
    s_waitcnt lgkmcnt(0)
    v_mfma_f32_16x16x32_bf16 v[116:119], v[96:99], v[76:79], v[116:119]
    v_mfma_f32_16x16x32_bf16 v[120:123], v[96:99], v[80:83], v[120:123]
    v_cvt_pk_bf16_f32 v48, v124, v125
    v_cvt_pk_bf16_f32 v49, v126, v127
    v_cvt_pk_bf16_f32 v50, v128, v129
    v_cvt_pk_bf16_f32 v51, v130, v131
    s_mov_b32 s3, 3145728
    buffer_store_dwordx4 v[48:51], v40, s[24:27], s3 offen sc0 sc1
    s_nop 3
    v_cvt_pk_bf16_f32 v44, v116, v117
    v_cvt_pk_bf16_f32 v45, v118, v119
    v_cvt_pk_bf16_f32 v46, v120, v121
    v_cvt_pk_bf16_f32 v47, v122, v123
    s_mov_b32 s3, 4194304
    buffer_store_dwordx4 v[44:47], v40, s[24:27], s3 offen sc0 sc1
L2_fin:
L2_end:
    s_endpgm
.section .rodata,"a"
.p2align 6
.amdhsa_kernel tfn_bin_kernel
  .amdhsa_next_free_vgpr 56
  .amdhsa_next_free_sgpr 80
  .amdhsa_accum_offset 56
  .amdhsa_group_segment_fixed_size 0
  .amdhsa_kernarg_size 88
  .amdhsa_user_sgpr_count 2
  .amdhsa_user_sgpr_kernarg_segment_ptr 1
  .amdhsa_system_sgpr_workgroup_id_x 1
  .amdhsa_float_denorm_mode_32 3
.end_amdhsa_kernel
.section .rodata,"a"
.p2align 6
.amdhsa_kernel standalone__tensor_product_equiv_tfn__graph_kernel
  .amdhsa_next_free_vgpr 228
  .amdhsa_next_free_sgpr 102
  .amdhsa_accum_offset 228
  .amdhsa_group_segment_fixed_size 0
  .amdhsa_kernarg_size 88
  .amdhsa_user_sgpr_count 2
  .amdhsa_user_sgpr_kernarg_segment_ptr 1
  .amdhsa_system_sgpr_workgroup_id_x 1
  .amdhsa_float_denorm_mode_32 3
.end_amdhsa_kernel
```

```asm
; @launch grid=(256,1,1) block=(512,1,1) lds=163584
.amdgcn_target "amdgcn-amd-amdhsa--gfx950"
.text
.globl standalone__tensor_product_equiv_tfn__graph_kernel
.p2align 8
.type standalone__tensor_product_equiv_tfn__graph_kernel,@function
standalone__tensor_product_equiv_tfn__graph_kernel:
    s_load_dwordx16 s[4:19], s[0:1], 0
    s_load_dwordx2 s[22:23], s[0:1], 80
    s_load_dwordx2 s[20:21], s[0:1], 64
    s_cmp_ge_u32 s2, 256
    s_cbranch_scc1 L_end
    v_mul_u32_u24 v172, 3, v0
    s_mul_i32 s3, s2, 1250
    v_min_u32 v172, 1247, v172
    v_add_lshl_u32 v173, v172, s3, 2
    v_lshrrev_b32 v12, 6, v0
    v_and_b32 v13, 255, v0
    v_lshlrev_b32 v13, 2, v13
    v_mov_b32 v16, 0
    v_readfirstlane_b32 s24, v12
    ds_write_b32 v13, v16 offset:0
    v_lshlrev_b32 v174, 1, v173
    s_waitcnt lgkmcnt(0)
    global_load_dwordx3 v[132:134], v173, s[8:9]
    s_load_dword s26, s[22:23], 0
    s_barrier
    global_load_dwordx3 v[136:138], v173, s[6:7]
    global_load_dwordx4 v[140:143], v174, s[10:11]
    global_load_dwordx2 v[144:145], v174, s[10:11] offset:16
    s_cmp_eq_u32 s24, 7
    s_cbranch_scc0 L_nocpf
    s_cmp_lt_u32 s2, 8
    s_cbranch_scc0 L_nocpf
    s_getpc_b64 s[68:69]
L_pc:
    v_and_b32 v17, 63, v0
    v_lshlrev_b32 v17, 7, v17
    v_mov_b32 v19, s69
    v_add_co_u32 v18, vcc, s68, v17
    s_nop 1
    v_addc_co_u32 v19, vcc, 0, v19, vcc
    global_load_dword v204, v[18:19], off
    v_min_u32 v17, L_end-L_pc-8192, v17
    v_add_u32 v17, 8192, v17
    v_mov_b32 v21, s69
    v_add_co_u32 v20, vcc, s68, v17
    s_nop 1
    v_addc_co_u32 v21, vcc, 0, v21, vcc
    global_load_dword v205, v[20:21], off
L_nocpf:
    v_lshlrev_b32 v188, 4, v0
    v_and_b32 v11, 63, v0
    s_lshl_b32 s30, s24, 10
    s_lshl_b32 s3, s3, 5
    s_add_u32 s12, s12, s3
    s_addc_u32 s13, s13, 0
    v_add_u32 v189, 8192, v188
    v_add_u32 v190, 16384, v188
    v_add_u32 v191, 24576, v188
    v_add_u32 v192, 32768, v188
    v_add_u32 v193, 40960, v188
    v_min_u32 v175, 39984, v192
    v_lshlrev_b32 v1, 4, v11
    s_barrier
    s_add_u32 m0, s30, 112384
    s_nop 0
    global_load_lds_dwordx4 v188, s[12:13]
    s_add_u32 m0, s30, 120576
    s_nop 0
    global_load_lds_dwordx4 v189, s[12:13]
    v_lshlrev_b32 v194, 2, v0
    v_lshlrev_b32 v14, 3, v0
    v_mov_b32 v16, 0
    v_mov_b32 v17, 0
    v_mov_b32 v15, 0x03000000
    ds_write_b64 v14, v[16:17] offset:16128
    ds_write_b32 v194, v15 offset:20224
    ds_write_b32 v194, v15 offset:22272
    ds_write_b32 v194, v15 offset:24320
    v_lshrrev_b32 v195, 1, v0
    v_lshlrev_b32 v195, 2, v195
    v_cmp_gt_u32 vcc, 416, v0
    s_mov_b64 s[36:37], vcc
    v_cmp_gt_u32 vcc, 417, v0
    s_mov_b64 s[38:39], vcc
    v_mov_b32 v12, 1
    s_movk_i32 s40, 1250
    s_lshr_b32 s27, s24, 2
    s_mov_b32 s28, 0
    s_waitcnt vmcnt(5)
    s_mov_b64 exec, s[38:39]
    v_and_b32 v159, 7, v133
    v_bfe_u32 v150, v133, 3, 5
    v_lshl_add_u32 v147, v159, 5, v150
    v_lshlrev_b32 v147, 2, v147
    ds_add_rtn_u32 v150, v147, v12 offset:0
    v_and_b32 v163, 7, v134
    v_bfe_u32 v151, v134, 3, 5
    v_lshl_add_u32 v148, v163, 5, v151
    v_lshlrev_b32 v148, 2, v148
    ds_add_rtn_u32 v151, v148, v12 offset:0
    s_mov_b64 exec, s[36:37]
    v_and_b32 v155, 7, v132
    v_bfe_u32 v149, v132, 3, 5
    v_lshl_add_u32 v146, v155, 5, v149
    v_lshlrev_b32 v146, 2, v146
    ds_add_rtn_u32 v149, v146, v12 offset:0
    s_mov_b64 exec, -1
    s_add_u32 m0, s30, 128768
    s_nop 0
    global_load_lds_dwordx4 v190, s[12:13]
    s_add_u32 m0, s30, 136960
    s_nop 0
    global_load_lds_dwordx4 v191, s[12:13]
    s_add_u32 m0, s30, 145152
    s_nop 0
    global_load_lds_dwordx4 v175, s[12:13]
    s_waitcnt lgkmcnt(0)
    s_barrier
    ds_read_b128 v[164:167], v1 offset:0
    s_mul_i32 s3, s2, 1256
    s_add_u32 s26, s26, 1
    s_waitcnt lgkmcnt(0)
    v_add_u32 v180, v164, v165
    v_add3_u32 v180, v180, v166, v167
    v_mov_b32 v181, v180
    v_lshrrev_b32 v132, 8, v132
    v_mul_u32_u24 v132, 3407924, v132
    v_add_u32_dpp v181, v181, v181 row_shr:1 row_mask:0xf bank_mask:0xf
    v_add_u32 v132, 1060126464, v132
    v_add_lshl_u32 v177, v172, 0, 5
    v_add_u32_dpp v181, v181, v181 row_shr:2 row_mask:0xf bank_mask:0xf
    v_lshrrev_b32 v133, 8, v133
    v_mul_u32_u24 v133, 3407924, v133
    v_add_u32_dpp v181, v181, v181 row_shr:4 row_mask:0xf bank_mask:0xf
    v_add_u32 v133, 1060126464, v133
    v_add_lshl_u32 v178, v172, 1, 5
    v_add_u32_dpp v181, v181, v181 row_shr:8 row_mask:0xf bank_mask:0xf
    v_lshrrev_b32 v134, 8, v134
    v_mul_u32_u24 v134, 3407924, v134
    v_add_u32_dpp v181, v181, v181 row_bcast:15 row_mask:0xa bank_mask:0xf
    v_add_u32 v134, 1060126464, v134
    v_add_lshl_u32 v179, v172, 2, 5
    v_add_u32_dpp v181, v181, v181 row_bcast:31 row_mask:0xc bank_mask:0xf
    v_sub_u32 v168, v181, v180
    v_add_u32 v169, v168, v164
    v_add_u32 v170, v169, v165
    v_add_u32 v171, v170, v166
    ds_write_b128 v1, v[168:171] offset:1024
    s_mov_b64 exec, s[38:39]
    ds_read_b32 v147, v147 offset:1024
    ds_read_b32 v148, v148 offset:1024
    s_mov_b64 exec, s[36:37]
    ds_read_b32 v146, v146 offset:1024
    s_mov_b64 exec, -1
    s_waitcnt vmcnt(5)
    v_mad_u32_u24 v155, v155, s40, v136
    v_lshlrev_b32 v152, 10, v136
    v_subrev_u32 v154, 10000, v155
    v_min_u32 v155, v155, v154
    v_mul_u32_u24 v155, 157, v155
    v_lshrrev_b32 v155, 17, v155
    v_lshl_add_u32 v153, v155, 2, v132
    v_mov_b64 v[154:155], v[140:141]
    v_mad_u32_u24 v159, v159, s40, v137
    v_lshlrev_b32 v156, 10, v137
    v_subrev_u32 v158, 10000, v159
    v_min_u32 v159, v159, v158
    v_mul_u32_u24 v159, 157, v159
    v_lshrrev_b32 v159, 17, v159
    v_lshl_add_u32 v157, v159, 2, v133
    v_mov_b64 v[158:159], v[142:143]
    v_mad_u32_u24 v163, v163, s40, v138
    v_lshlrev_b32 v160, 10, v138
    v_subrev_u32 v162, 10000, v163
    v_min_u32 v163, v163, v162
    v_mul_u32_u24 v163, 157, v163
    v_lshrrev_b32 v163, 17, v163
    v_lshl_add_u32 v161, v163, 2, v134
    v_mov_b64 v[162:163], v[144:145]
    s_mov_b64 exec, s[38:39]
    s_waitcnt lgkmcnt(0)
    v_add_lshl_u32 v183, v147, v150, 4
    v_add_lshl_u32 v147, v147, v150, 1
    ds_write_b128 v183, v[156:159] offset:63232
    ds_write_b16 v147, v178 offset:2048
    v_add_lshl_u32 v184, v148, v151, 4
    v_add_lshl_u32 v148, v148, v151, 1
    ds_write_b128 v184, v[160:163] offset:63232
    ds_write_b16 v148, v179 offset:2048
    s_mov_b64 exec, s[36:37]
    v_add_lshl_u32 v182, v146, v149, 4
    v_add_lshl_u32 v146, v146, v149, 1
    ds_write_b128 v182, v[152:155] offset:63232
    ds_write_b16 v146, v177 offset:2048
    s_mov_b64 exec, -1
L_recd:
    s_add_u32 m0, s30, 26368
    s_nop 0
    global_load_lds_dwordx4 v188, s[18:19]
    s_add_u32 m0, s30, 34560
    s_nop 0
    global_load_lds_dwordx4 v189, s[18:19]
    s_add_u32 m0, s30, 42752
    s_nop 0
    global_load_lds_dwordx4 v190, s[18:19]
    s_add_u32 m0, s30, 50944
    s_nop 0
    global_load_lds_dwordx4 v191, s[18:19]
    s_add_u32 s70, s30, 59136
    v_min_u32 v185, 112, v1
    s_cmp_lt_u32 s24, 4
    s_cselect_b64 vcc, -1, 0
    s_cselect_b32 m0, s70, 162560
    s_cselect_b64 s[68:69], s[14:15], s[16:17]
    v_cndmask_b32 v185, v185, v188, vcc
    global_load_lds_dwordx4 v185, s[68:69]
    v_add_u32 v168, s3, v168
    v_lshl_add_u32 v196, v164, 19, v168
    v_mov_b32 v197, s26
    v_add_u32 v169, s3, v169
    v_lshl_add_u32 v198, v165, 19, v169
    v_mov_b32 v199, s26
    v_add_u32 v170, s3, v170
    v_lshl_add_u32 v200, v166, 19, v170
    v_mov_b32 v201, s26
    v_add_u32 v171, s3, v171
    v_lshl_add_u32 v202, v167, 19, v171
    v_mov_b32 v203, s26
    s_lshl_b32 s31, s2, 11
    s_add_u32 s31, s31, 4096
    v_add_u32 v186, s31, v1
    s_lshl_b32 s3, s3, 4
    s_add_u32 s31, s3, 1048576
    s_add_u32 s48, s22, s31
    s_addc_u32 s49, s23, 0
    s_mov_b32 s50, 20096
    s_mov_b32 s51, 0x00020000
    s_lshl_b32 s3, s3, 1
    s_add_u32 s31, s3, 8388608
    s_add_u32 s52, s22, s31
    s_addc_u32 s53, s23, 0
    s_mov_b32 s54, 40192
    s_mov_b32 s55, 0x00020000
    v_and_b32 v172, -2, v0
    v_and_b32 v173, 16, v188
    v_add_u32 v173, 112384, v173
    s_waitcnt lgkmcnt(0)
    s_barrier
    ds_read_b128 v[132:135], v188 offset:63232
    ds_read_b128 v[136:139], v189 offset:63232
    ds_read_b128 v[140:143], v190 offset:63232
    ds_read_u16 v174, v172 offset:2048
    ds_read_u16 v175, v172 offset:2560
    ds_read_u16 v176, v172 offset:3072
    ds_read_u16 v177, v172 offset:3584
    ds_read_u16 v178, v172 offset:4096
    s_waitcnt lgkmcnt(7)
    buffer_store_dwordx4 v[132:135], v188, s[48:51], 0 offen sc0 sc1
    s_waitcnt lgkmcnt(6)
    buffer_store_dwordx4 v[136:139], v189, s[48:51], 0 offen sc0 sc1
    s_waitcnt lgkmcnt(5)
    buffer_store_dwordx4 v[140:143], v190, s[48:51], 0 offen sc0 sc1
    s_waitcnt lgkmcnt(0)
    v_add_u32 v174, v174, v173
    v_add_u32 v175, v175, v173
    v_add_u32 v176, v176, v173
    v_add_u32 v177, v177, v173
    v_min_u32 v178, 39968, v178
    v_and_b32 v178, -16, v178
    v_add_u32 v178, v178, v173
    v_mov_b64 v[84:85], 0
    v_mov_b64 v[86:87], 0
    v_mov_b64 v[88:89], 0
    v_mov_b64 v[90:91], 0
    v_mov_b64 v[92:93], 0
    v_mov_b64 v[94:95], 0
    v_mov_b64 v[96:97], 0
    v_mov_b64 v[98:99], 0
    v_mov_b64 v[100:101], 0
    v_mov_b64 v[102:103], 0
    v_mov_b64 v[104:105], 0
    v_mov_b64 v[106:107], 0
    v_mov_b64 v[108:109], 0
    v_mov_b64 v[110:111], 0
    v_mov_b64 v[112:113], 0
    v_mov_b64 v[114:115], 0
    v_mov_b64 v[116:117], 0
    v_mov_b64 v[118:119], 0
    v_mov_b64 v[120:121], 0
    v_mov_b64 v[122:123], 0
    v_mov_b64 v[124:125], 0
    v_mov_b64 v[126:127], 0
    v_mov_b64 v[128:129], 0
    v_mov_b64 v[130:131], 0
    v_mov_b64 v[24:25], 0
    v_mov_b64 v[26:27], 0
    v_mov_b64 v[28:29], 0
    v_mov_b64 v[30:31], 0
    s_mov_b32 s32, 0x0f0f0f0f
    s_mov_b32 s33, s32
    s_not_b64 s[34:35], s[32:33]
    v_lshrrev_b32 v2, 5, v11
    v_lshlrev_b32 v2, 4, v2
    v_and_b32 v3, 3, v11
    v_lshlrev_b32 v3, 3, v3
    v_add_u32 v3, 112384, v3
    s_mov_b32 s6, 10240000
    s_mov_b32 s7, 0x00020000
    s_add_u32 s8, s22, 1048576
    s_addc_u32 s9, s23, 0
    s_mov_b32 s10, 5144576
    s_mov_b32 s11, 0x00020000
    s_add_u32 s12, s22, 8388608
    s_addc_u32 s13, s23, 0
    s_mov_b32 s14, 10289152
    s_mov_b32 s15, 0x00020000
    s_mov_b32 s16, s20
    s_mov_b32 s17, s21
    s_mov_b32 s18, 10240000
    s_mov_b32 s19, 0x00020000
    s_mov_b32 s101, 0
    s_cmp_lt_u32 s2, 16
    s_cbranch_scc1 L_r40
    s_cmp_eq_u32 s24, 0
    s_cselect_b32 s101, 0x274090c0, s101
    s_cmp_eq_u32 s24, 1
    s_cselect_b32 s101, 0x24798441, s101
    s_cmp_eq_u32 s24, 2
    s_cselect_b32 s101, 0x26657302, s101
    s_cmp_eq_u32 s24, 3
    s_cselect_b32 s101, 0x257522c4, s101
    s_cmp_eq_u32 s24, 4
    s_cselect_b32 s101, 0x236d33c5, s101
    s_cmp_eq_u32 s24, 5
    s_cselect_b32 s101, 0x217d6286, s101
    s_cmp_eq_u32 s24, 6
    s_cselect_b32 s101, 0x22695347, s101
    s_cmp_eq_u32 s24, 7
    s_cselect_b32 s101, 0x20714388, s101
    s_branch L_rd
L_r40:
    s_cmp_eq_u32 s24, 0
    s_cselect_b32 s101, 0x278d5200, s101
    s_cmp_eq_u32 s24, 1
    s_cselect_b32 s101, 0x266143c1, s101
    s_cmp_eq_u32 s24, 2
    s_cselect_b32 s101, 0x25693342, s101
    s_cmp_eq_u32 s24, 3
    s_cselect_b32 s101, 0x24792243, s101
    s_cmp_eq_u32 s24, 4
    s_cselect_b32 s101, 0x22751304, s101
    s_cmp_eq_u32 s24, 5
    s_cselect_b32 s101, 0x216572c5, s101
    s_cmp_eq_u32 s24, 6
    s_cselect_b32 s101, 0x20710386, s101
    s_cmp_eq_u32 s24, 7
    s_cselect_b32 s101, 0x1f6d6287, s101
L_rd:
    s_and_b32 s3, s2, 7
    s_lshl_b32 s3, s3, 7
    s_bfe_u32 s31, s2, 196613
    s_lshl_b32 s31, s31, 4
    s_add_u32 s3, s3, s31
    s_and_b32 s31, s2, 8
    s_add_u32 s3, s3, s31
    s_and_b32 s31, s2, 16
    s_lshl_b32 s31, s31, 6
    s_add_u32 s3, s3, s31
    s_add_u32 s3, s3, 4096
    v_and_b32 v230, 255, v0
    v_lshl_add_u32 v187, v230, 11, s3
    v_mul_u32_u24 v230, 128, v230
    v_add_u32 v230, 589824, v230
    s_waitcnt vmcnt(8)
    s_barrier
    ds_read_b128 v[144:147], v174
    ds_read_b128 v[148:151], v175
    ds_read_b128 v[152:155], v176
    ds_read_b128 v[156:159], v177
    ds_read_b128 v[160:163], v178
    s_waitcnt lgkmcnt(4)
    buffer_store_dwordx4 v[144:147], v188, s[52:55], 0 offen sc0 sc1
    s_waitcnt lgkmcnt(3)
    buffer_store_dwordx4 v[148:151], v189, s[52:55], 0 offen sc0 sc1
    s_waitcnt lgkmcnt(2)
    buffer_store_dwordx4 v[152:155], v190, s[52:55], 0 offen sc0 sc1
    s_waitcnt lgkmcnt(1)
    buffer_store_dwordx4 v[156:159], v191, s[52:55], 0 offen sc0 sc1
    s_waitcnt lgkmcnt(0)
    buffer_store_dwordx4 v[160:163], v192, s[52:55], 0 offen sc0 sc1
    s_waitcnt vmcnt(0)
    s_barrier
    s_cmp_eq_u32 s24, 7
    s_cbranch_scc0 L_nopub
    global_store_dwordx4 v186, v[196:199], s[22:23] sc0 sc1
    global_store_dwordx4 v186, v[200:203], s[22:23] offset:1024 sc0 sc1
L_nopub:
    v_lshrrev_b32 v12, 5, v11
    v_and_b32 v13, 31, v11
    v_lshlrev_b32 v13, 2, v13
    v_lshl_add_u32 v12, v12, 11, v13
    ds_read_b32 v132, v12 offset:59136
    ds_read_b32 v133, v12 offset:59392
    ds_read_b32 v134, v12 offset:59648
    ds_read_b32 v135, v12 offset:59904
    ds_read_b32 v136, v12 offset:60160
    ds_read_b32 v137, v12 offset:60416
    ds_read_b32 v138, v12 offset:60672
    ds_read_b32 v139, v12 offset:60928
    s_waitcnt lgkmcnt(7)
    ds_read_b32 v140, v12 offset:59264
    ds_read_b32 v141, v12 offset:59520
    ds_read_b32 v142, v12 offset:59776
    ds_read_b32 v143, v12 offset:60032
    ds_read_b32 v144, v12 offset:60288
    ds_read_b32 v145, v12 offset:60544
    ds_read_b32 v146, v12 offset:60800
    ds_read_b32 v147, v12 offset:61056
    v_and_b32 v14, 3, v11
    v_bfe_u32 v15, v11, 2, 2
    v_lshlrev_b32 v15, 1, v15
    v_lshl_add_u32 v14, v14, 5, v15
    v_add_u32 v14, 162560, v14
    s_mov_b32 s68, 0xbfb8aa3b
    s_mov_b32 s69, s68
    s_mov_b32 s70, 0x05040100
    s_mov_b32 s71, 0x07060302
    s_and_b32 s3, s24, 3
    s_lshl_b32 s3, s3, 6
    v_lshrrev_b32 v16, 4, v11
    v_and_b32 v17, 15, v11
    v_lshl_add_u32 v17, v17, 2, s3
    v_lshl_add_u32 v16, v16, 11, v17
    s_waitcnt lgkmcnt(0)
    ds_read_u16 v18, v14 offset:0
    ds_read_u16 v19, v14 offset:8
    ds_read_u16 v20, v14 offset:16
    ds_read_u16 v21, v14 offset:24
    ds_read_b32 v148, v16 offset:26368
    ds_read_b32 v149, v16 offset:26624
    ds_read_b32 v150, v16 offset:26880
    ds_read_b32 v151, v16 offset:27136
    ds_read_b32 v152, v16 offset:27392
    ds_read_b32 v153, v16 offset:27648
    ds_read_b32 v154, v16 offset:27904
    ds_read_b32 v155, v16 offset:28160
    v_lshlrev_b32 v22, 16, v132
    v_lshlrev_b32 v23, 16, v133
    v_and_b32 v132, 0xffff0000, v132
    v_and_b32 v133, 0xffff0000, v133
    v_pk_mul_f32 v[22:23], v[22:23], s[68:69]
    v_pk_mul_f32 v[132:133], v[132:133], s[68:69]
    v_cvt_pk_bf16_f32 v36, v22, v23
    v_cvt_pk_bf16_f32 v44, v132, v133
    v_lshlrev_b32 v22, 16, v134
    v_lshlrev_b32 v23, 16, v135
    v_and_b32 v134, 0xffff0000, v134
    v_and_b32 v135, 0xffff0000, v135
    v_pk_mul_f32 v[22:23], v[22:23], s[68:69]
    v_pk_mul_f32 v[134:135], v[134:135], s[68:69]
    v_cvt_pk_bf16_f32 v37, v22, v23
    v_cvt_pk_bf16_f32 v45, v134, v135
    v_lshlrev_b32 v22, 16, v136
    v_lshlrev_b32 v23, 16, v137
    v_and_b32 v136, 0xffff0000, v136
    v_and_b32 v137, 0xffff0000, v137
    v_pk_mul_f32 v[22:23], v[22:23], s[68:69]
    v_pk_mul_f32 v[136:137], v[136:137], s[68:69]
    v_cvt_pk_bf16_f32 v38, v22, v23
    v_cvt_pk_bf16_f32 v46, v136, v137
    v_lshlrev_b32 v22, 16, v138
    v_lshlrev_b32 v23, 16, v139
    v_and_b32 v138, 0xffff0000, v138
    v_and_b32 v139, 0xffff0000, v139
    v_pk_mul_f32 v[22:23], v[22:23], s[68:69]
    v_pk_mul_f32 v[138:139], v[138:139], s[68:69]
    v_cvt_pk_bf16_f32 v39, v22, v23
    v_cvt_pk_bf16_f32 v47, v138, v139
    v_lshlrev_b32 v22, 16, v140
    v_lshlrev_b32 v23, 16, v141
    v_and_b32 v140, 0xffff0000, v140
    v_and_b32 v141, 0xffff0000, v141
    v_pk_mul_f32 v[22:23], v[22:23], s[68:69]
    v_pk_mul_f32 v[140:141], v[140:141], s[68:69]
    v_cvt_pk_bf16_f32 v40, v22, v23
    v_cvt_pk_bf16_f32 v48, v140, v141
    v_lshlrev_b32 v22, 16, v142
    v_lshlrev_b32 v23, 16, v143
    v_and_b32 v142, 0xffff0000, v142
    v_and_b32 v143, 0xffff0000, v143
    v_pk_mul_f32 v[22:23], v[22:23], s[68:69]
    v_pk_mul_f32 v[142:143], v[142:143], s[68:69]
    v_cvt_pk_bf16_f32 v41, v22, v23
    v_cvt_pk_bf16_f32 v49, v142, v143
    v_lshlrev_b32 v22, 16, v144
    v_lshlrev_b32 v23, 16, v145
    v_and_b32 v144, 0xffff0000, v144
    v_and_b32 v145, 0xffff0000, v145
    v_pk_mul_f32 v[22:23], v[22:23], s[68:69]
    v_pk_mul_f32 v[144:145], v[144:145], s[68:69]
    v_cvt_pk_bf16_f32 v42, v22, v23
    v_cvt_pk_bf16_f32 v50, v144, v145
    v_lshlrev_b32 v22, 16, v146
    v_lshlrev_b32 v23, 16, v147
    v_and_b32 v146, 0xffff0000, v146
    v_and_b32 v147, 0xffff0000, v147
    v_pk_mul_f32 v[22:23], v[22:23], s[68:69]
    v_pk_mul_f32 v[146:147], v[146:147], s[68:69]
    v_cvt_pk_bf16_f32 v43, v22, v23
    v_cvt_pk_bf16_f32 v51, v146, v147
    s_waitcnt lgkmcnt(0)
    v_lshl_or_b32 v228, v19, 16, v18
    v_lshl_or_b32 v229, v21, 16, v20
    ds_read_b32 v156, v16 offset:34560
    ds_read_b32 v157, v16 offset:34816
    ds_read_b32 v158, v16 offset:35072
    ds_read_b32 v159, v16 offset:35328
    ds_read_b32 v160, v16 offset:35584
    ds_read_b32 v161, v16 offset:35840
    ds_read_b32 v162, v16 offset:36096
    ds_read_b32 v163, v16 offset:36352
    v_perm_b32 v52, v149, v148, s70
    v_perm_b32 v56, v149, v148, s71
    v_perm_b32 v53, v151, v150, s70
    v_perm_b32 v57, v151, v150, s71
    v_perm_b32 v54, v153, v152, s70
    v_perm_b32 v58, v153, v152, s71
    v_perm_b32 v55, v155, v154, s70
    v_perm_b32 v59, v155, v154, s71
    s_waitcnt lgkmcnt(7)
    ds_read_b32 v148, v16 offset:42752
    ds_read_b32 v149, v16 offset:43008
    ds_read_b32 v150, v16 offset:43264
    ds_read_b32 v151, v16 offset:43520
    ds_read_b32 v152, v16 offset:43776
    ds_read_b32 v153, v16 offset:44032
    ds_read_b32 v154, v16 offset:44288
    ds_read_b32 v155, v16 offset:44544
    s_waitcnt lgkmcnt(8)
    v_perm_b32 v60, v157, v156, s70
    v_perm_b32 v64, v157, v156, s71
    v_perm_b32 v61, v159, v158, s70
    v_perm_b32 v65, v159, v158, s71
    v_perm_b32 v62, v161, v160, s70
    v_perm_b32 v66, v161, v160, s71
    v_perm_b32 v63, v163, v162, s70
    v_perm_b32 v67, v163, v162, s71
    s_waitcnt lgkmcnt(7)
    ds_read_b32 v156, v16 offset:50944
    ds_read_b32 v157, v16 offset:51200
    ds_read_b32 v158, v16 offset:51456
    ds_read_b32 v159, v16 offset:51712
    ds_read_b32 v160, v16 offset:51968
    ds_read_b32 v161, v16 offset:52224
    ds_read_b32 v162, v16 offset:52480
    ds_read_b32 v163, v16 offset:52736
    s_waitcnt lgkmcnt(8)
    v_perm_b32 v68, v149, v148, s70
    v_perm_b32 v72, v149, v148, s71
    v_perm_b32 v69, v151, v150, s70
    v_perm_b32 v73, v151, v150, s71
    v_perm_b32 v70, v153, v152, s70
    v_perm_b32 v74, v153, v152, s71
    v_perm_b32 v71, v155, v154, s70
    v_perm_b32 v75, v155, v154, s71
    s_waitcnt lgkmcnt(0)
    v_perm_b32 v76, v157, v156, s70
    v_perm_b32 v80, v157, v156, s71
    v_perm_b32 v77, v159, v158, s70
    v_perm_b32 v81, v159, v158, s71
    v_perm_b32 v78, v161, v160, s70
    v_perm_b32 v82, v161, v160, s71
    v_perm_b32 v79, v163, v162, s70
    v_perm_b32 v83, v163, v162, s71
    s_cmp_eq_u32 s27, 0
    s_cbranch_scc0 L_polled
    s_mov_b32 s3, 0
L_poll:
    global_load_dwordx2 v[206:207], v187, s[22:23] sc1
L_poll1:
    s_add_u32 s3, s3, 1
    s_waitcnt vmcnt(0)
    v_cmpx_ne_u32 vcc, s26, v207
    s_cbranch_execz L_pok
    s_cmp_lt_u32 s3, 400000
    s_cbranch_scc1 L_poll
    v_mov_b32 v206, 0
L_pok:
    s_mov_b64 exec, -1
    v_add_u32 v14, 161536, v194
    ds_write_b32 v14, v206
L_polled:
L_round:
    v_add_u32 v15, 161536, v1
    s_and_b32 s31, s24, 3
    v_mov_b32 v148, 0
    s_waitcnt lgkmcnt(0)
    s_barrier
    ds_read_b128 v[140:143], v15
    s_waitcnt lgkmcnt(0)
    v_lshrrev_b32 v144, 19, v140
    v_lshrrev_b32 v145, 19, v141
    v_lshrrev_b32 v146, 19, v142
    v_lshrrev_b32 v147, 19, v143
    v_add_u32 v150, v144, v145
    v_add3_u32 v12, v150, v146, v147
    v_add_u32 v13, s28, v12
    v_mov_b32 v149, v144
    v_add_u32_dpp v12, v12, v12 row_shr:1 row_mask:0xf bank_mask:0xf
    v_add_u32 v151, v150, v146
    s_set_gpr_idx_on s31, gpr_idx(SRC0)
    v_mov_b32 v14, v140
    v_mov_b32 v15, v144
    v_mov_b32 v16, v148
    s_set_gpr_idx_off
    v_add_u32_dpp v12, v12, v12 row_shr:2 row_mask:0xf bank_mask:0xf
    v_and_b32 v14, 0x7ffff, v14
    v_sub_u32 v16, v16, v13
    v_add_u32_dpp v12, v12, v12 row_shr:4 row_mask:0xf bank_mask:0xf
    v_subrev_u32 v17, s27, v15
    s_mov_b32 s31, s27
    v_add_u32_dpp v12, v12, v12 row_shr:8 row_mask:0xf bank_mask:0xf
    s_nop 1
    v_add_u32_dpp v12, v12, v12 row_bcast:15 row_mask:0xa bank_mask:0xf
    s_nop 1
    v_add_u32_dpp v12, v12, v12 row_bcast:31 row_mask:0xc bank_mask:0xf
    v_add_u32 v16, v16, v12
    v_readlane_b32 s25, v12, 63
    v_sub_u32 v14, v14, v16
    v_add_lshl_u32 v18, v16, s27, 2
    s_cmp_gt_u32 s25, 1536
    s_cbranch_scc1 L_exp
    v_cmpx_lt_i32 vcc, 0, v17
    ds_write_b32 v18, v14 offset:20224
    v_cmpx_lt_i32 vcc, 2, v17
    ds_write_b32 v18, v14 offset:20232
    v_cmpx_lt_i32 vcc, 4, v17
    ds_write_b32 v18, v14 offset:20240
    v_cmpx_lt_i32 vcc, 6, v17
    ds_write_b32 v18, v14 offset:20248
    v_cmpx_lt_i32 vcc, 8, v17
    ds_write_b32 v18, v14 offset:20256
    v_cmpx_lt_i32 vcc, 10, v17
    ds_write_b32 v18, v14 offset:20264
    v_cmpx_lt_i32 vcc, 12, v17
    s_cbranch_execz L_expd
    s_add_u32 s31, s31, 12
L_exp:
    s_mov_b64 exec, -1
    v_cmp_lt_u32 vcc, s31, v15
    s_cbranch_vccz L_expd
    v_add_u32 v19, s31, v16
    s_movk_i32 s3, 1536
    v_cmp_gt_u32 s[68:69], s3, v19
    v_lshlrev_b32 v19, 2, v19
    s_and_b64 exec, vcc, s[68:69]
    ds_write_b32 v19, v14 offset:20224
    s_add_u32 s31, s31, 2
    s_branch L_exp
L_expd:
    s_mov_b64 exec, -1
    s_waitcnt lgkmcnt(0)
    s_barrier
    ds_read_b32 v12, v194 offset:20224
    ds_read_b32 v13, v194 offset:22272
    ds_read_b32 v14, v194 offset:24320
    ds_read_b32 v152, v195 offset:20224
    ds_read_b32 v153, v195 offset:21248
    ds_read_b32 v154, v195 offset:22272
    ds_read_b32 v155, v195 offset:23296
    ds_read_b32 v156, v195 offset:24320
    ds_read_b32 v157, v195 offset:25344
    s_waitcnt lgkmcnt(8)
    v_lshl_add_u32 v132, v12, 4, v188
    buffer_load_dwordx4 v[140:143], v132, s[8:11], 0 offen sc1
    s_waitcnt lgkmcnt(7)
    v_lshl_add_u32 v133, v13, 4, v189
    buffer_load_dwordx4 v[144:147], v133, s[8:11], 0 offen sc1
    s_waitcnt lgkmcnt(6)
    v_lshl_add_u32 v134, v14, 4, v190
    buffer_load_dwordx4 v[148:151], v134, s[8:11], 0 offen sc1
    s_waitcnt lgkmcnt(0)
    v_lshl_add_u32 v152, v152, 5, v188
    v_lshl_add_u32 v153, v153, 5, v189
    v_lshl_add_u32 v154, v154, 5, v190
    v_lshl_add_u32 v155, v155, 5, v191
    v_lshl_add_u32 v156, v156, 5, v192
    v_lshl_add_u32 v157, v157, 5, v193
    s_barrier
    s_add_u32 m0, s30, 63232
    s_nop 0
    buffer_load_dwordx4 v152, s[12:15], 0 offen sc1 lds
    s_add_u32 m0, s30, 71424
    s_nop 0
    buffer_load_dwordx4 v153, s[12:15], 0 offen sc1 lds
    s_sub_u32 s29, s25, s28
    s_min_u32 s29, s29, 1536
    s_lshl_b32 s3, s29, 4
    v_cmp_gt_u32 s[56:57], s3, v188
    v_lshlrev_b32 v159, 1, v188
    v_cmp_gt_u32 s[58:59], s3, v189
    v_lshlrev_b32 v161, 1, v189
    v_cmp_gt_u32 s[60:61], s3, v190
    v_lshlrev_b32 v163, 1, v190
    v_and_b32 v4, 15, v11
    v_lshlrev_b32 v4, 3, v4
    v_bfe_u32 v5, v11, 3, 2
    v_and_b32 v12, 3, v11
    v_lshl_add_u32 v5, v5, 2, v12
    v_lshlrev_b32 v5, 3, v5
    v_lshrrev_b32 v6, 2, v11
    v_lshlrev_b32 v6, 3, v6
    v_mul_u32_u24 v16, 52, v11
    v_lshrrev_b32 v16, 8, v16
    v_mul_u32_u24 v17, 5, v16
    v_sub_u32 v17, v11, v17
    v_mul_u32_u24 v15, 6, v17
    v_bfe_u32 v15, s101, v15, 6
    v_lshlrev_b32 v15, 2, v15
    v_lshlrev_b32 v16, 2, v16
    v_lshlrev_b32 v17, 19, v17
    s_mul_i32 s3, s24, 5
    v_min_u32 v18, 43, v11
    v_mul_u32_u24 v18, 52, v18
    v_add_u32 v21, s3, v11
    v_min_u32 v19, 43, v21
    v_mul_u32_u24 v19, 52, v19
    v_cmp_gt_u32 vcc, 40, v11
    v_add_u32 v20, 1, v11
    v_add_u32 v21, 1, v21
    v_cndmask_b32 v20, 0, v20, vcc
    v_mov_b32 v22, 8
    s_cmp_gt_u32 s25, 1536
    s_cselect_b32 s69, 0, 8
    s_waitcnt vmcnt(4)
    s_mov_b64 exec, s[56:57]
    v_lshrrev_b32 v12, 16, v141
    v_and_b32 v141, 0xffff, v141
    ds_add_u32 v12, v22
    ds_add_rtn_u32 v132, v141, v22
    s_waitcnt vmcnt(3)
    s_mov_b64 exec, s[58:59]
    v_lshrrev_b32 v13, 16, v145
    v_and_b32 v145, 0xffff, v145
    ds_add_u32 v13, v22
    ds_add_rtn_u32 v133, v145, v22
    s_waitcnt vmcnt(2)
    s_mov_b64 exec, s[60:61]
    v_lshrrev_b32 v14, 16, v149
    v_and_b32 v149, 0xffff, v149
    ds_add_u32 v14, v22
    ds_add_rtn_u32 v134, v149, v22
    s_mov_b64 exec, -1
    s_add_u32 m0, s30, 79616
    s_nop 0
    buffer_load_dwordx4 v154, s[12:15], 0 offen sc1 lds
    v_mfma_f32_4x4x4_16b_bf16 v[164:167], v[228:229], v[142:143], 0 cbsz:4 abid:0
    v_mfma_f32_4x4x4_16b_bf16 v[168:171], v[228:229], v[142:143], 0 cbsz:4 abid:1
    v_mfma_f32_4x4x4_16b_bf16 v[172:175], v[228:229], v[142:143], 0 cbsz:4 abid:2
    v_mfma_f32_4x4x4_16b_bf16 v[176:179], v[228:229], v[142:143], 0 cbsz:4 abid:3
    v_add_u32 v23, 112384, v159
    s_nop 0
    v_cvt_pk_bf16_f32 v180, v164, v165
    v_cvt_pk_bf16_f32 v181, v166, v167
    v_cvt_pk_bf16_f32 v182, v168, v169
    v_cvt_pk_bf16_f32 v183, v170, v171
    v_cvt_pk_bf16_f32 v184, v172, v173
    v_cvt_pk_bf16_f32 v185, v174, v175
    v_cvt_pk_bf16_f32 v186, v176, v177
    v_cvt_pk_bf16_f32 v187, v178, v179
    s_waitcnt lgkmcnt(0)
    s_barrier
    ds_read_b32 v12, v18 offset:16176
    ds_read_b32 v13, v19 offset:16176
    ds_write_b128 v23, v[180:183]
    ds_write_b128 v23, v[184:187] offset:16
    s_waitcnt lgkmcnt(2)
    v_mad_u32_u24 v21, v13, s69, v21
    v_mad_u32_u24 v20, v12, s69, v20
    v_readlane_b32 s96, v21, 0
    v_readlane_b32 s97, v21, 1
    v_readlane_b32 s98, v21, 2
    v_readlane_b32 s99, v21, 3
    v_readlane_b32 s100, v21, 4
    v_lshl_add_u32 v19, v13, 16, v19
    v_cmp_lt_u32 s[36:37], s96, v20
    v_cmp_lt_u32 s[38:39], s97, v20
    v_cmp_lt_u32 s[40:41], s98, v20
    v_cmp_lt_u32 s[42:43], s99, v20
    v_cmp_lt_u32 s[44:45], s100, v20
    s_bcnt1_i32_b64 s96, s[36:37]
    v_writelane_b32 v12, s96, 0
    s_bcnt1_i32_b64 s97, s[38:39]
    v_writelane_b32 v12, s97, 1
    s_bcnt1_i32_b64 s98, s[40:41]
    v_writelane_b32 v12, s98, 2
    s_bcnt1_i32_b64 s99, s[42:43]
    v_writelane_b32 v12, s99, 3
    s_bcnt1_i32_b64 s100, s[44:45]
    v_writelane_b32 v12, s100, 4
    s_mov_b64 exec, 31
    v_lshlrev_b32 v12, 2, v12
    ds_write_b32 v12, v19 offset:18432
    s_mov_b64 exec, -1
    s_add_u32 m0, s30, 87808
    s_nop 0
    buffer_load_dwordx4 v155, s[12:15], 0 offen sc1 lds
    s_waitcnt lgkmcnt(0)
    s_barrier
    ds_read_b32 v12, v15 offset:18432
    v_mfma_f32_4x4x4_16b_bf16 v[164:167], v[228:229], v[146:147], 0 cbsz:4 abid:0
    v_mfma_f32_4x4x4_16b_bf16 v[168:171], v[228:229], v[146:147], 0 cbsz:4 abid:1
    v_mfma_f32_4x4x4_16b_bf16 v[172:175], v[228:229], v[146:147], 0 cbsz:4 abid:2
    v_mfma_f32_4x4x4_16b_bf16 v[176:179], v[228:229], v[146:147], 0 cbsz:4 abid:3
    v_add_u32 v23, 112384, v161
    s_nop 0
    v_cvt_pk_bf16_f32 v180, v164, v165
    v_cvt_pk_bf16_f32 v181, v166, v167
    v_cvt_pk_bf16_f32 v182, v168, v169
    v_cvt_pk_bf16_f32 v183, v170, v171
    v_cvt_pk_bf16_f32 v184, v172, v173
    v_cvt_pk_bf16_f32 v185, v174, v175
    v_cvt_pk_bf16_f32 v186, v176, v177
    v_cvt_pk_bf16_f32 v187, v178, v179
    s_waitcnt lgkmcnt(0)
    v_add_u32_sdwa v16, v12, v16 dst_sel:DWORD dst_unused:UNUSED_PAD src0_sel:WORD_0 src1_sel:DWORD
    ds_read_b32 v13, v16 offset:16128
    v_readlane_b32 s96, v12, 0
    v_readlane_b32 s97, v12, 1
    v_readlane_b32 s98, v12, 2
    v_readlane_b32 s99, v12, 3
    v_readlane_b32 s100, v12, 4
    s_add_u32 s3, s96, s97
    s_add_u32 s3, s3, s98
    s_add_u32 s3, s3, s99
    s_add_u32 s3, s3, s100
    s_lshr_b32 s29, s3, 16
    s_add_u32 s3, s29, 480
    v_mov_b32 v14, s3
    v_mov_b32 v18, 0
    s_mov_b64 exec, 1
    ds_add_rtn_u32 v14, v18, v14 offset:18688
    s_mov_b64 exec, -1
    s_waitcnt lgkmcnt(1)
    v_sub_u32 v17, v17, v13
    s_nop 0
    v_add_u32_dpp v13, v13, v13 row_shr:1 row_mask:0xf bank_mask:0xf
    s_nop 1
    v_add_u32_dpp v13, v13, v13 row_shr:2 row_mask:0xf bank_mask:0xf
    v_mov_b32 v20, 2147482664
    v_mov_b32 v21, 0
    v_add_u32_dpp v13, v13, v13 row_shr:4 row_mask:0xf bank_mask:0xf
    s_nop 1
    v_add_u32_dpp v13, v13, v13 row_shr:8 row_mask:0xf bank_mask:0xf
    s_waitcnt lgkmcnt(0)
    v_readfirstlane_b32 s71, v14
    v_add_u32_dpp v13, v13, v13 row_bcast:15 row_mask:0xa bank_mask:0xf
    s_add_u32 s3, s71, s29
    v_lshl_add_u32 v18, v11, 3, s3
    v_add_u32_dpp v13, v13, v13 row_bcast:31 row_mask:0xc bank_mask:0xf
    s_mov_b32 exec_hi, 0x0fffffff
    v_add3_u32 v13, v13, v17, s71
    ds_write_b32 v16, v13 offset:16128
    ds_write_b64 v18, v[20:21] offset:0
    s_mov_b64 exec, -1
    ds_write_b128 v23, v[180:183]
    ds_write_b128 v23, v[184:187] offset:16
    s_add_u32 m0, s30, 96000
    s_nop 0
    buffer_load_dwordx4 v156, s[12:15], 0 offen sc1 lds
    s_waitcnt lgkmcnt(2)
    s_barrier
    ds_read_b32 v12, v141
    ds_read_b32 v13, v145
    ds_read_b32 v14, v149
    v_add_u32 v4, s71, v4
    v_add_u32 v5, s71, v5
    v_add_u32 v6, s71, v6
    s_lshr_b32 s29, s29, 3
    s_mov_b64 exec, s[56:57]
    s_waitcnt lgkmcnt(2)
    v_add_u32_sdwa v132, v12, v132 dst_sel:DWORD dst_unused:UNUSED_PAD src0_sel:WORD_0 src1_sel:DWORD
    v_or_b32_sdwa v158, v12, v140 dst_sel:DWORD dst_unused:UNUSED_PAD src0_sel:WORD_1 src1_sel:DWORD
    ds_write_b64 v132, v[158:159] offset:0
    s_mov_b64 exec, s[58:59]
    s_waitcnt lgkmcnt(2)
    v_add_u32_sdwa v133, v13, v133 dst_sel:DWORD dst_unused:UNUSED_PAD src0_sel:WORD_0 src1_sel:DWORD
    v_or_b32_sdwa v160, v13, v144 dst_sel:DWORD dst_unused:UNUSED_PAD src0_sel:WORD_1 src1_sel:DWORD
    ds_write_b64 v133, v[160:161] offset:0
    s_mov_b64 exec, s[60:61]
    s_waitcnt lgkmcnt(2)
    v_add_u32_sdwa v134, v14, v134 dst_sel:DWORD dst_unused:UNUSED_PAD src0_sel:WORD_0 src1_sel:DWORD
    v_or_b32_sdwa v162, v14, v148 dst_sel:DWORD dst_unused:UNUSED_PAD src0_sel:WORD_1 src1_sel:DWORD
    ds_write_b64 v134, v[162:163] offset:0
    s_mov_b64 exec, -1
    s_add_u32 m0, s30, 104192
    s_nop 0
    buffer_load_dwordx4 v157, s[12:15], 0 offen sc1 lds
    s_waitcnt lgkmcnt(0)
    s_barrier
    ds_read_b32 v12, v4
    ds_read_b32 v7, v4 offset:64
    ds_read_b32 v9, v5 offset:4
    ds_read_b32 v10, v6 offset:4
    s_cmp_eq_u64 s[60:61], 0
    s_cbranch_scc1 L_not3
    v_mfma_f32_4x4x4_16b_bf16 v[164:167], v[228:229], v[150:151], 0 cbsz:4 abid:0
    v_mfma_f32_4x4x4_16b_bf16 v[168:171], v[228:229], v[150:151], 0 cbsz:4 abid:1
    v_mfma_f32_4x4x4_16b_bf16 v[172:175], v[228:229], v[150:151], 0 cbsz:4 abid:2
    v_mfma_f32_4x4x4_16b_bf16 v[176:179], v[228:229], v[150:151], 0 cbsz:4 abid:3
    v_add_u32 v23, 112384, v163
    s_nop 0
    v_cvt_pk_bf16_f32 v180, v164, v165
    v_cvt_pk_bf16_f32 v181, v166, v167
    v_cvt_pk_bf16_f32 v182, v168, v169
    v_cvt_pk_bf16_f32 v183, v170, v171
    v_cvt_pk_bf16_f32 v184, v172, v173
    v_cvt_pk_bf16_f32 v185, v174, v175
    v_cvt_pk_bf16_f32 v186, v176, v177
    v_cvt_pk_bf16_f32 v187, v178, v179
    ds_write_b128 v23, v[180:183]
    ds_write_b128 v23, v[184:187] offset:16
    s_waitcnt lgkmcnt(2)
    s_branch L_t3
L_not3:
    s_waitcnt lgkmcnt(0)
L_t3:
    v_readlane_b32 s36, v12, 0
    s_and_b32 s68, s36, 0xfffffc00
    buffer_load_dwordx4 v[196:199], v1, s[4:7], s68 offen
    v_readlane_b32 s37, v12, 1
    s_and_b32 s69, s37, 0xfffffc00
    buffer_load_dwordx4 v[200:203], v1, s[4:7], s69 offen
    v_readlane_b32 s38, v12, 2
    s_and_b32 s68, s38, 0xfffffc00
    buffer_load_dwordx4 v[204:207], v1, s[4:7], s68 offen
    v_readlane_b32 s39, v12, 3
    s_and_b32 s69, s39, 0xfffffc00
    buffer_load_dwordx4 v[208:211], v1, s[4:7], s69 offen
    v_readlane_b32 s40, v12, 4
    s_and_b32 s68, s40, 0xfffffc00
    buffer_load_dwordx4 v[212:215], v1, s[4:7], s68 offen
    v_readlane_b32 s41, v12, 5
    s_and_b32 s69, s41, 0xfffffc00
    buffer_load_dwordx4 v[216:219], v1, s[4:7], s69 offen
    v_readlane_b32 s42, v12, 6
    s_and_b32 s68, s42, 0xfffffc00
    buffer_load_dwordx4 v[220:223], v1, s[4:7], s68 offen
    v_readlane_b32 s43, v12, 7
    s_and_b32 s69, s43, 0xfffffc00
    buffer_load_dwordx4 v[224:227], v1, s[4:7], s69 offen
    v_add_u32 v9, v9, v2
    v_add_u32 v10, v10, v3
    v_readlane_b32 s44, v7, 0
    s_and_b32 s31, s44, 0xfffffc00
    s_waitcnt vmcnt(8) lgkmcnt(0)
    s_barrier
    s_cmp_eq_u32 s29, 0
    s_cbranch_scc1 L_exit
    s_sub_u32 s29, s29, 1
    s_mov_b64 exec, s[32:33]
    ds_read_b128 v[24:27], v9 offset:63232
    s_mov_b64 exec, s[34:35]
    ds_read_b128 v[28:31], v9 offset:63232
    s_mov_b64 exec, -1
    ds_read_b64 v[32:33], v10
    s_waitcnt lgkmcnt(1)
    v_mfma_f32_32x32x16_bf16 v[132:147], v[24:27], v[36:39], 0
    v_mfma_f32_32x32x16_bf16 v[132:147], v[28:31], v[40:43], v[132:147]
    v_mfma_f32_32x32x16_bf16 v[148:163], v[24:27], v[44:47], 0
    v_mfma_f32_32x32x16_bf16 v[148:163], v[28:31], v[48:51], v[148:163]
    s_waitcnt lgkmcnt(0)
    s_nop 7
    s_nop 2
    v_exp_f32 v12, v132
    v_exp_f32 v13, v133
    v_exp_f32 v14, v148
    v_exp_f32 v15, v149
    v_pk_add_f32 v[12:13], v[12:13], 1.0 op_sel_hi:[1,0]
    v_pk_add_f32 v[14:15], v[14:15], 1.0 op_sel_hi:[1,0]
    v_rcp_f32 v12, v12
    v_rcp_f32 v13, v13
    s_nop 0
    v_pk_mul_f32 v[132:133], v[132:133], v[12:13]
L_loop:
    s_setprio 3
    ds_read_b32 v9, v5 offset:132
    ds_read_b32 v10, v6 offset:132
    ds_read_b32 v8, v4 offset:192
    v_exp_f32 v12, v134
    s_waitcnt vmcnt(7)
    v_mfma_f32_4x4x4_16b_bf16 v[16:19], v[32:33], v[196:197], 0 cbsz:4 abid:0
    v_exp_f32 v13, v135
    v_mfma_f32_4x4x4_16b_bf16 v[20:23], v[32:33], v[198:199], 0 cbsz:4 abid:0
    v_readlane_b32 s45, v7, 1
    v_rcp_f32 v14, v14
    buffer_load_dwordx4 v[196:199], v1, s[4:7], s31 offen
    v_rcp_f32 v15, v15
    v_pk_add_f32 v[12:13], v[12:13], 1.0 op_sel_hi:[1,0]
    v_pk_mul_f32 v[148:149], v[148:149], v[14:15]
    s_set_gpr_idx_on s36, gpr_idx(SRC2,DST)
    v_pk_fma_f32 v[84:85], v[132:133], v[16:17], v[84:85] op_sel_hi:[0,1,1]
    v_pk_fma_f32 v[86:87], v[132:133], v[18:19], v[86:87] op_sel_hi:[0,1,1]
    v_pk_fma_f32 v[88:89], v[148:149], v[20:21], v[88:89] op_sel_hi:[0,1,1]
    v_pk_fma_f32 v[90:91], v[148:149], v[22:23], v[90:91] op_sel_hi:[0,1,1]
    s_set_gpr_idx_off
    s_and_b32 s31, s45, 0xfffffc00
    v_exp_f32 v14, v150
    s_waitcnt vmcnt(7)
    v_mfma_f32_4x4x4_16b_bf16 v[16:19], v[32:33], v[200:201], 0 cbsz:4 abid:1
    v_exp_f32 v15, v151
    v_mfma_f32_4x4x4_16b_bf16 v[20:23], v[32:33], v[202:203], 0 cbsz:4 abid:1
    v_readlane_b32 s46, v7, 2
    v_rcp_f32 v12, v12
    buffer_load_dwordx4 v[200:203], v1, s[4:7], s31 offen
    v_rcp_f32 v13, v13
    v_pk_add_f32 v[14:15], v[14:15], 1.0 op_sel_hi:[1,0]
    v_pk_mul_f32 v[134:135], v[134:135], v[12:13]
    s_set_gpr_idx_on s37, gpr_idx(SRC2,DST)
    v_pk_fma_f32 v[84:85], v[132:133], v[16:17], v[84:85] op_sel:[1,0,0]
    v_pk_fma_f32 v[86:87], v[132:133], v[18:19], v[86:87] op_sel:[1,0,0]
    v_pk_fma_f32 v[88:89], v[148:149], v[20:21], v[88:89] op_sel:[1,0,0]
    v_pk_fma_f32 v[90:91], v[148:149], v[22:23], v[90:91] op_sel:[1,0,0]
    s_set_gpr_idx_off
    s_and_b32 s31, s46, 0xfffffc00
    s_waitcnt lgkmcnt(0)
    v_add_u32 v9, v9, v2
    v_add_u32 v10, v10, v3
    s_mov_b64 exec, s[32:33]
    ds_read_b128 v[24:27], v9 offset:63232
    s_mov_b64 exec, s[34:35]
    ds_read_b128 v[28:31], v9 offset:63232
    s_mov_b64 exec, -1
    ds_read_b64 v[34:35], v10
    v_exp_f32 v12, v136
    s_waitcnt vmcnt(7)
    v_mfma_f32_4x4x4_16b_bf16 v[16:19], v[32:33], v[204:205], 0 cbsz:4 abid:2
    v_exp_f32 v13, v137
    v_mfma_f32_4x4x4_16b_bf16 v[20:23], v[32:33], v[206:207], 0 cbsz:4 abid:2
    v_readlane_b32 s47, v7, 3
    v_rcp_f32 v14, v14
    buffer_load_dwordx4 v[204:207], v1, s[4:7], s31 offen
    v_rcp_f32 v15, v15
    v_pk_add_f32 v[12:13], v[12:13], 1.0 op_sel_hi:[1,0]
    v_pk_mul_f32 v[150:151], v[150:151], v[14:15]
    s_set_gpr_idx_on s38, gpr_idx(SRC2,DST)
    v_pk_fma_f32 v[84:85], v[134:135], v[16:17], v[84:85] op_sel_hi:[0,1,1]
    v_pk_fma_f32 v[86:87], v[134:135], v[18:19], v[86:87] op_sel_hi:[0,1,1]
    v_pk_fma_f32 v[88:89], v[150:151], v[20:21], v[88:89] op_sel_hi:[0,1,1]
    v_pk_fma_f32 v[90:91], v[150:151], v[22:23], v[90:91] op_sel_hi:[0,1,1]
    s_set_gpr_idx_off
    s_and_b32 s31, s47, 0xfffffc00
    v_exp_f32 v14, v152
    s_waitcnt vmcnt(7)
    v_mfma_f32_4x4x4_16b_bf16 v[16:19], v[32:33], v[208:209], 0 cbsz:4 abid:3
    v_exp_f32 v15, v153
    v_mfma_f32_4x4x4_16b_bf16 v[20:23], v[32:33], v[210:211], 0 cbsz:4 abid:3
    v_readlane_b32 s48, v7, 4
    v_rcp_f32 v12, v12
    buffer_load_dwordx4 v[208:211], v1, s[4:7], s31 offen
    v_rcp_f32 v13, v13
    v_pk_add_f32 v[14:15], v[14:15], 1.0 op_sel_hi:[1,0]
    v_pk_mul_f32 v[136:137], v[136:137], v[12:13]
    s_set_gpr_idx_on s39, gpr_idx(SRC2,DST)
    v_pk_fma_f32 v[84:85], v[134:135], v[16:17], v[84:85] op_sel:[1,0,0]
    v_pk_fma_f32 v[86:87], v[134:135], v[18:19], v[86:87] op_sel:[1,0,0]
    v_pk_fma_f32 v[88:89], v[150:151], v[20:21], v[88:89] op_sel:[1,0,0]
    v_pk_fma_f32 v[90:91], v[150:151], v[22:23], v[90:91] op_sel:[1,0,0]
    s_set_gpr_idx_off
    s_and_b32 s31, s48, 0xfffffc00
    s_sub_u32 s29, s29, 4
    s_cbranch_scc1 L_exit
    s_setprio 2
    v_exp_f32 v12, v138
    s_waitcnt vmcnt(7)
    v_mfma_f32_4x4x4_16b_bf16 v[16:19], v[32:33], v[212:213], 0 cbsz:4 abid:4
    v_exp_f32 v13, v139
    v_mfma_f32_4x4x4_16b_bf16 v[20:23], v[32:33], v[214:215], 0 cbsz:4 abid:4
    v_readlane_b32 s49, v7, 5
    v_rcp_f32 v14, v14
    buffer_load_dwordx4 v[212:215], v1, s[4:7], s31 offen
    v_rcp_f32 v15, v15
    v_pk_add_f32 v[12:13], v[12:13], 1.0 op_sel_hi:[1,0]
    v_pk_mul_f32 v[152:153], v[152:153], v[14:15]
    s_set_gpr_idx_on s40, gpr_idx(SRC2,DST)
    v_pk_fma_f32 v[84:85], v[136:137], v[16:17], v[84:85] op_sel_hi:[0,1,1]
    v_pk_fma_f32 v[86:87], v[136:137], v[18:19], v[86:87] op_sel_hi:[0,1,1]
    v_pk_fma_f32 v[88:89], v[152:153], v[20:21], v[88:89] op_sel_hi:[0,1,1]
    v_pk_fma_f32 v[90:91], v[152:153], v[22:23], v[90:91] op_sel_hi:[0,1,1]
    s_set_gpr_idx_off
    s_and_b32 s31, s49, 0xfffffc00
    s_waitcnt lgkmcnt(0)
    s_waitcnt vmcnt(7)
    v_mfma_f32_4x4x4_16b_bf16 v[16:19], v[32:33], v[216:217], 0 cbsz:4 abid:5
    v_readlane_b32 s50, v7, 6
    v_mfma_f32_4x4x4_16b_bf16 v[20:23], v[32:33], v[218:219], 0 cbsz:4 abid:5
    v_mfma_f32_32x32x16_bf16 v[164:179], v[24:27], v[36:39], 0
    v_exp_f32 v14, v154
    v_exp_f32 v15, v155
    v_rcp_f32 v12, v12
    v_rcp_f32 v13, v13
    buffer_load_dwordx4 v[216:219], v1, s[4:7], s31 offen
    v_pk_add_f32 v[14:15], v[14:15], 1.0 op_sel_hi:[1,0]
    v_pk_mul_f32 v[138:139], v[138:139], v[12:13]
    s_set_gpr_idx_on s41, gpr_idx(SRC2,DST)
    v_pk_fma_f32 v[84:85], v[136:137], v[16:17], v[84:85] op_sel:[1,0,0]
    v_pk_fma_f32 v[86:87], v[136:137], v[18:19], v[86:87] op_sel:[1,0,0]
    v_pk_fma_f32 v[88:89], v[152:153], v[20:21], v[88:89] op_sel:[1,0,0]
    v_pk_fma_f32 v[90:91], v[152:153], v[22:23], v[90:91] op_sel:[1,0,0]
    s_set_gpr_idx_off
    s_and_b32 s31, s50, 0xfffffc00
    v_exp_f32 v12, v140
    s_waitcnt vmcnt(7)
    v_mfma_f32_4x4x4_16b_bf16 v[16:19], v[32:33], v[220:221], 0 cbsz:4 abid:6
    v_exp_f32 v13, v141
    v_mfma_f32_4x4x4_16b_bf16 v[20:23], v[32:33], v[222:223], 0 cbsz:4 abid:6
    v_readlane_b32 s51, v7, 7
    v_rcp_f32 v14, v14
    buffer_load_dwordx4 v[220:223], v1, s[4:7], s31 offen
    v_rcp_f32 v15, v15
    v_pk_add_f32 v[12:13], v[12:13], 1.0 op_sel_hi:[1,0]
    v_pk_mul_f32 v[154:155], v[154:155], v[14:15]
    s_set_gpr_idx_on s42, gpr_idx(SRC2,DST)
    v_pk_fma_f32 v[84:85], v[138:139], v[16:17], v[84:85] op_sel_hi:[0,1,1]
    v_pk_fma_f32 v[86:87], v[138:139], v[18:19], v[86:87] op_sel_hi:[0,1,1]
    v_pk_fma_f32 v[88:89], v[154:155], v[20:21], v[88:89] op_sel_hi:[0,1,1]
    v_pk_fma_f32 v[90:91], v[154:155], v[22:23], v[90:91] op_sel_hi:[0,1,1]
    s_set_gpr_idx_off
    s_and_b32 s31, s51, 0xfffffc00
    s_waitcnt vmcnt(7)
    v_mfma_f32_4x4x4_16b_bf16 v[16:19], v[32:33], v[224:225], 0 cbsz:4 abid:7
    v_readlane_b32 s52, v7, 8
    v_mfma_f32_4x4x4_16b_bf16 v[20:23], v[32:33], v[226:227], 0 cbsz:4 abid:7
    v_mfma_f32_32x32x16_bf16 v[164:179], v[28:31], v[40:43], v[164:179]
    v_exp_f32 v14, v156
    v_exp_f32 v15, v157
    v_rcp_f32 v12, v12
    v_rcp_f32 v13, v13
    buffer_load_dwordx4 v[224:227], v1, s[4:7], s31 offen
    v_pk_add_f32 v[14:15], v[14:15], 1.0 op_sel_hi:[1,0]
    v_pk_mul_f32 v[140:141], v[140:141], v[12:13]
    s_set_gpr_idx_on s43, gpr_idx(SRC2,DST)
    v_pk_fma_f32 v[84:85], v[138:139], v[16:17], v[84:85] op_sel:[1,0,0]
    v_pk_fma_f32 v[86:87], v[138:139], v[18:19], v[86:87] op_sel:[1,0,0]
    v_pk_fma_f32 v[88:89], v[154:155], v[20:21], v[88:89] op_sel:[1,0,0]
    v_pk_fma_f32 v[90:91], v[154:155], v[22:23], v[90:91] op_sel:[1,0,0]
    s_set_gpr_idx_off
    s_and_b32 s31, s52, 0xfffffc00
    s_sub_u32 s29, s29, 4
    s_cbranch_scc1 L_exit
    s_setprio 1
    v_exp_f32 v12, v142
    s_waitcnt vmcnt(7)
    v_mfma_f32_4x4x4_16b_bf16 v[16:19], v[32:33], v[196:197], 0 cbsz:4 abid:8
    v_exp_f32 v13, v143
    v_mfma_f32_4x4x4_16b_bf16 v[20:23], v[32:33], v[198:199], 0 cbsz:4 abid:8
    v_readlane_b32 s53, v7, 9
    v_rcp_f32 v14, v14
    buffer_load_dwordx4 v[196:199], v1, s[4:7], s31 offen
    v_rcp_f32 v15, v15
    v_pk_add_f32 v[12:13], v[12:13], 1.0 op_sel_hi:[1,0]
    v_pk_mul_f32 v[156:157], v[156:157], v[14:15]
    s_set_gpr_idx_on s44, gpr_idx(SRC2,DST)
    v_pk_fma_f32 v[84:85], v[140:141], v[16:17], v[84:85] op_sel_hi:[0,1,1]
    v_pk_fma_f32 v[86:87], v[140:141], v[18:19], v[86:87] op_sel_hi:[0,1,1]
    v_pk_fma_f32 v[88:89], v[156:157], v[20:21], v[88:89] op_sel_hi:[0,1,1]
    v_pk_fma_f32 v[90:91], v[156:157], v[22:23], v[90:91] op_sel_hi:[0,1,1]
    s_set_gpr_idx_off
    s_and_b32 s31, s53, 0xfffffc00
    s_waitcnt vmcnt(7)
    v_mfma_f32_4x4x4_16b_bf16 v[16:19], v[32:33], v[200:201], 0 cbsz:4 abid:9
    v_readlane_b32 s54, v7, 10
    v_mfma_f32_4x4x4_16b_bf16 v[20:23], v[32:33], v[202:203], 0 cbsz:4 abid:9
    v_mfma_f32_32x32x16_bf16 v[180:195], v[24:27], v[44:47], 0
    v_exp_f32 v14, v158
    v_exp_f32 v15, v159
    v_rcp_f32 v12, v12
    v_rcp_f32 v13, v13
    buffer_load_dwordx4 v[200:203], v1, s[4:7], s31 offen
    v_pk_add_f32 v[14:15], v[14:15], 1.0 op_sel_hi:[1,0]
    v_pk_mul_f32 v[142:143], v[142:143], v[12:13]
    s_set_gpr_idx_on s45, gpr_idx(SRC2,DST)
    v_pk_fma_f32 v[84:85], v[140:141], v[16:17], v[84:85] op_sel:[1,0,0]
    v_pk_fma_f32 v[86:87], v[140:141], v[18:19], v[86:87] op_sel:[1,0,0]
    v_pk_fma_f32 v[88:89], v[156:157], v[20:21], v[88:89] op_sel:[1,0,0]
    v_pk_fma_f32 v[90:91], v[156:157], v[22:23], v[90:91] op_sel:[1,0,0]
    s_set_gpr_idx_off
    s_and_b32 s31, s54, 0xfffffc00
    v_exp_f32 v12, v144
    s_waitcnt vmcnt(7)
    v_mfma_f32_4x4x4_16b_bf16 v[16:19], v[32:33], v[204:205], 0 cbsz:4 abid:10
    v_exp_f32 v13, v145
    v_mfma_f32_4x4x4_16b_bf16 v[20:23], v[32:33], v[206:207], 0 cbsz:4 abid:10
    v_readlane_b32 s55, v7, 11
    v_rcp_f32 v14, v14
    buffer_load_dwordx4 v[204:207], v1, s[4:7], s31 offen
    v_rcp_f32 v15, v15
    v_pk_add_f32 v[12:13], v[12:13], 1.0 op_sel_hi:[1,0]
    v_pk_mul_f32 v[158:159], v[158:159], v[14:15]
    s_set_gpr_idx_on s46, gpr_idx(SRC2,DST)
    v_pk_fma_f32 v[84:85], v[142:143], v[16:17], v[84:85] op_sel_hi:[0,1,1]
    v_pk_fma_f32 v[86:87], v[142:143], v[18:19], v[86:87] op_sel_hi:[0,1,1]
    v_pk_fma_f32 v[88:89], v[158:159], v[20:21], v[88:89] op_sel_hi:[0,1,1]
    v_pk_fma_f32 v[90:91], v[158:159], v[22:23], v[90:91] op_sel_hi:[0,1,1]
    s_set_gpr_idx_off
    s_and_b32 s31, s55, 0xfffffc00
    s_waitcnt vmcnt(7)
    v_mfma_f32_4x4x4_16b_bf16 v[16:19], v[32:33], v[208:209], 0 cbsz:4 abid:11
    v_readlane_b32 s56, v7, 12
    v_mfma_f32_4x4x4_16b_bf16 v[20:23], v[32:33], v[210:211], 0 cbsz:4 abid:11
    v_mfma_f32_32x32x16_bf16 v[180:195], v[28:31], v[48:51], v[180:195]
    v_exp_f32 v14, v160
    v_exp_f32 v15, v161
    v_rcp_f32 v12, v12
    v_rcp_f32 v13, v13
    buffer_load_dwordx4 v[208:211], v1, s[4:7], s31 offen
    v_pk_add_f32 v[14:15], v[14:15], 1.0 op_sel_hi:[1,0]
    v_pk_mul_f32 v[144:145], v[144:145], v[12:13]
    s_set_gpr_idx_on s47, gpr_idx(SRC2,DST)
    v_pk_fma_f32 v[84:85], v[142:143], v[16:17], v[84:85] op_sel:[1,0,0]
    v_pk_fma_f32 v[86:87], v[142:143], v[18:19], v[86:87] op_sel:[1,0,0]
    v_pk_fma_f32 v[88:89], v[158:159], v[20:21], v[88:89] op_sel:[1,0,0]
    v_pk_fma_f32 v[90:91], v[158:159], v[22:23], v[90:91] op_sel:[1,0,0]
    s_set_gpr_idx_off
    s_and_b32 s31, s56, 0xfffffc00
    s_sub_u32 s29, s29, 4
    s_cbranch_scc1 L_exit
    s_setprio 0
    v_exp_f32 v12, v146
    s_waitcnt vmcnt(7)
    v_mfma_f32_4x4x4_16b_bf16 v[16:19], v[32:33], v[212:213], 0 cbsz:4 abid:12
    v_exp_f32 v13, v147
    v_mfma_f32_4x4x4_16b_bf16 v[20:23], v[32:33], v[214:215], 0 cbsz:4 abid:12
    v_readlane_b32 s57, v7, 13
    v_rcp_f32 v14, v14
    buffer_load_dwordx4 v[212:215], v1, s[4:7], s31 offen
    v_rcp_f32 v15, v15
    v_pk_add_f32 v[12:13], v[12:13], 1.0 op_sel_hi:[1,0]
    v_pk_mul_f32 v[160:161], v[160:161], v[14:15]
    s_set_gpr_idx_on s48, gpr_idx(SRC2,DST)
    v_pk_fma_f32 v[84:85], v[144:145], v[16:17], v[84:85] op_sel_hi:[0,1,1]
    v_pk_fma_f32 v[86:87], v[144:145], v[18:19], v[86:87] op_sel_hi:[0,1,1]
    v_pk_fma_f32 v[88:89], v[160:161], v[20:21], v[88:89] op_sel_hi:[0,1,1]
    v_pk_fma_f32 v[90:91], v[160:161], v[22:23], v[90:91] op_sel_hi:[0,1,1]
    s_set_gpr_idx_off
    s_and_b32 s31, s57, 0xfffffc00
    v_exp_f32 v14, v162
    s_waitcnt vmcnt(7)
    v_mfma_f32_4x4x4_16b_bf16 v[16:19], v[32:33], v[216:217], 0 cbsz:4 abid:13
    v_exp_f32 v15, v163
    v_mfma_f32_4x4x4_16b_bf16 v[20:23], v[32:33], v[218:219], 0 cbsz:4 abid:13
    v_readlane_b32 s58, v7, 14
    v_rcp_f32 v12, v12
    buffer_load_dwordx4 v[216:219], v1, s[4:7], s31 offen
    v_rcp_f32 v13, v13
    v_pk_add_f32 v[14:15], v[14:15], 1.0 op_sel_hi:[1,0]
    v_pk_mul_f32 v[146:147], v[146:147], v[12:13]
    s_set_gpr_idx_on s49, gpr_idx(SRC2,DST)
    v_pk_fma_f32 v[84:85], v[144:145], v[16:17], v[84:85] op_sel:[1,0,0]
    v_pk_fma_f32 v[86:87], v[144:145], v[18:19], v[86:87] op_sel:[1,0,0]
    v_pk_fma_f32 v[88:89], v[160:161], v[20:21], v[88:89] op_sel:[1,0,0]
    v_pk_fma_f32 v[90:91], v[160:161], v[22:23], v[90:91] op_sel:[1,0,0]
    s_set_gpr_idx_off
    s_and_b32 s31, s58, 0xfffffc00
    v_exp_f32 v12, v164
    s_waitcnt vmcnt(7)
    v_mfma_f32_4x4x4_16b_bf16 v[16:19], v[32:33], v[220:221], 0 cbsz:4 abid:14
    v_exp_f32 v13, v165
    v_mfma_f32_4x4x4_16b_bf16 v[20:23], v[32:33], v[222:223], 0 cbsz:4 abid:14
    v_readlane_b32 s59, v7, 15
    v_rcp_f32 v14, v14
    buffer_load_dwordx4 v[220:223], v1, s[4:7], s31 offen
    v_rcp_f32 v15, v15
    v_pk_add_f32 v[12:13], v[12:13], 1.0 op_sel_hi:[1,0]
    v_pk_mul_f32 v[162:163], v[162:163], v[14:15]
    s_set_gpr_idx_on s50, gpr_idx(SRC2,DST)
    v_pk_fma_f32 v[84:85], v[146:147], v[16:17], v[84:85] op_sel_hi:[0,1,1]
    v_pk_fma_f32 v[86:87], v[146:147], v[18:19], v[86:87] op_sel_hi:[0,1,1]
    v_pk_fma_f32 v[88:89], v[162:163], v[20:21], v[88:89] op_sel_hi:[0,1,1]
    v_pk_fma_f32 v[90:91], v[162:163], v[22:23], v[90:91] op_sel_hi:[0,1,1]
    s_set_gpr_idx_off
    s_and_b32 s31, s59, 0xfffffc00
    v_exp_f32 v14, v180
    s_waitcnt vmcnt(7)
    v_mfma_f32_4x4x4_16b_bf16 v[16:19], v[32:33], v[224:225], 0 cbsz:4 abid:15
    v_exp_f32 v15, v181
    v_mfma_f32_4x4x4_16b_bf16 v[20:23], v[32:33], v[226:227], 0 cbsz:4 abid:15
    v_readlane_b32 s60, v8, 0
    v_rcp_f32 v12, v12
    buffer_load_dwordx4 v[224:227], v1, s[4:7], s31 offen
    v_rcp_f32 v13, v13
    v_pk_add_f32 v[14:15], v[14:15], 1.0 op_sel_hi:[1,0]
    v_pk_mul_f32 v[164:165], v[164:165], v[12:13]
    s_set_gpr_idx_on s51, gpr_idx(SRC2,DST)
    v_pk_fma_f32 v[84:85], v[146:147], v[16:17], v[84:85] op_sel:[1,0,0]
    v_pk_fma_f32 v[86:87], v[146:147], v[18:19], v[86:87] op_sel:[1,0,0]
    v_pk_fma_f32 v[88:89], v[162:163], v[20:21], v[88:89] op_sel:[1,0,0]
    v_pk_fma_f32 v[90:91], v[162:163], v[22:23], v[90:91] op_sel:[1,0,0]
    s_set_gpr_idx_off
    s_and_b32 s31, s60, 0xfffffc00
    s_sub_u32 s29, s29, 4
    s_cbranch_scc1 L_exit
    s_setprio 3
    ds_read_b32 v9, v5 offset:260
    ds_read_b32 v10, v6 offset:260
    ds_read_b32 v7, v4 offset:320
    v_exp_f32 v12, v166
    s_waitcnt vmcnt(7)
    v_mfma_f32_4x4x4_16b_bf16 v[16:19], v[34:35], v[196:197], 0 cbsz:4 abid:0
    v_exp_f32 v13, v167
    v_mfma_f32_4x4x4_16b_bf16 v[20:23], v[34:35], v[198:199], 0 cbsz:4 abid:0
    v_readlane_b32 s61, v8, 1
    v_rcp_f32 v14, v14
    buffer_load_dwordx4 v[196:199], v1, s[4:7], s31 offen
    v_rcp_f32 v15, v15
    v_pk_add_f32 v[12:13], v[12:13], 1.0 op_sel_hi:[1,0]
    v_pk_mul_f32 v[180:181], v[180:181], v[14:15]
    s_set_gpr_idx_on s52, gpr_idx(SRC2,DST)
    v_pk_fma_f32 v[84:85], v[164:165], v[16:17], v[84:85] op_sel_hi:[0,1,1]
    v_pk_fma_f32 v[86:87], v[164:165], v[18:19], v[86:87] op_sel_hi:[0,1,1]
    v_pk_fma_f32 v[88:89], v[180:181], v[20:21], v[88:89] op_sel_hi:[0,1,1]
    v_pk_fma_f32 v[90:91], v[180:181], v[22:23], v[90:91] op_sel_hi:[0,1,1]
    s_set_gpr_idx_off
    s_and_b32 s31, s61, 0xfffffc00
    v_exp_f32 v14, v182
    s_waitcnt vmcnt(7)
    v_mfma_f32_4x4x4_16b_bf16 v[16:19], v[34:35], v[200:201], 0 cbsz:4 abid:1
    v_exp_f32 v15, v183
    v_mfma_f32_4x4x4_16b_bf16 v[20:23], v[34:35], v[202:203], 0 cbsz:4 abid:1
    v_readlane_b32 s62, v8, 2
    v_rcp_f32 v12, v12
    buffer_load_dwordx4 v[200:203], v1, s[4:7], s31 offen
    v_rcp_f32 v13, v13
    v_pk_add_f32 v[14:15], v[14:15], 1.0 op_sel_hi:[1,0]
    v_pk_mul_f32 v[166:167], v[166:167], v[12:13]
    s_set_gpr_idx_on s53, gpr_idx(SRC2,DST)
    v_pk_fma_f32 v[84:85], v[164:165], v[16:17], v[84:85] op_sel:[1,0,0]
    v_pk_fma_f32 v[86:87], v[164:165], v[18:19], v[86:87] op_sel:[1,0,0]
    v_pk_fma_f32 v[88:89], v[180:181], v[20:21], v[88:89] op_sel:[1,0,0]
    v_pk_fma_f32 v[90:91], v[180:181], v[22:23], v[90:91] op_sel:[1,0,0]
    s_set_gpr_idx_off
    s_and_b32 s31, s62, 0xfffffc00
    s_waitcnt lgkmcnt(0)
    v_add_u32 v9, v9, v2
    v_add_u32 v10, v10, v3
    s_mov_b64 exec, s[32:33]
    ds_read_b128 v[24:27], v9 offset:63232
    s_mov_b64 exec, s[34:35]
    ds_read_b128 v[28:31], v9 offset:63232
    s_mov_b64 exec, -1
    ds_read_b64 v[32:33], v10
    v_exp_f32 v12, v168
    s_waitcnt vmcnt(7)
    v_mfma_f32_4x4x4_16b_bf16 v[16:19], v[34:35], v[204:205], 0 cbsz:4 abid:2
    v_exp_f32 v13, v169
    v_mfma_f32_4x4x4_16b_bf16 v[20:23], v[34:35], v[206:207], 0 cbsz:4 abid:2
    v_readlane_b32 s63, v8, 3
    v_rcp_f32 v14, v14
    buffer_load_dwordx4 v[204:207], v1, s[4:7], s31 offen
    v_rcp_f32 v15, v15
    v_pk_add_f32 v[12:13], v[12:13], 1.0 op_sel_hi:[1,0]
    v_pk_mul_f32 v[182:183], v[182:183], v[14:15]
    s_set_gpr_idx_on s54, gpr_idx(SRC2,DST)
    v_pk_fma_f32 v[84:85], v[166:167], v[16:17], v[84:85] op_sel_hi:[0,1,1]
    v_pk_fma_f32 v[86:87], v[166:167], v[18:19], v[86:87] op_sel_hi:[0,1,1]
    v_pk_fma_f32 v[88:89], v[182:183], v[20:21], v[88:89] op_sel_hi:[0,1,1]
    v_pk_fma_f32 v[90:91], v[182:183], v[22:23], v[90:91] op_sel_hi:[0,1,1]
    s_set_gpr_idx_off
    s_and_b32 s31, s63, 0xfffffc00
    v_exp_f32 v14, v184
    s_waitcnt vmcnt(7)
    v_mfma_f32_4x4x4_16b_bf16 v[16:19], v[34:35], v[208:209], 0 cbsz:4 abid:3
    v_exp_f32 v15, v185
    v_mfma_f32_4x4x4_16b_bf16 v[20:23], v[34:35], v[210:211], 0 cbsz:4 abid:3
    v_readlane_b32 s64, v8, 4
    v_rcp_f32 v12, v12
    buffer_load_dwordx4 v[208:211], v1, s[4:7], s31 offen
    v_rcp_f32 v13, v13
    v_pk_add_f32 v[14:15], v[14:15], 1.0 op_sel_hi:[1,0]
    v_pk_mul_f32 v[168:169], v[168:169], v[12:13]
    s_set_gpr_idx_on s55, gpr_idx(SRC2,DST)
    v_pk_fma_f32 v[84:85], v[166:167], v[16:17], v[84:85] op_sel:[1,0,0]
    v_pk_fma_f32 v[86:87], v[166:167], v[18:19], v[86:87] op_sel:[1,0,0]
    v_pk_fma_f32 v[88:89], v[182:183], v[20:21], v[88:89] op_sel:[1,0,0]
    v_pk_fma_f32 v[90:91], v[182:183], v[22:23], v[90:91] op_sel:[1,0,0]
    s_set_gpr_idx_off
    s_and_b32 s31, s64, 0xfffffc00
    s_sub_u32 s29, s29, 4
    s_cbranch_scc1 L_exit
    s_setprio 2
    v_exp_f32 v12, v170
    s_waitcnt vmcnt(7)
    v_mfma_f32_4x4x4_16b_bf16 v[16:19], v[34:35], v[212:213], 0 cbsz:4 abid:4
    v_exp_f32 v13, v171
    v_mfma_f32_4x4x4_16b_bf16 v[20:23], v[34:35], v[214:215], 0 cbsz:4 abid:4
    v_readlane_b32 s65, v8, 5
    v_rcp_f32 v14, v14
    buffer_load_dwordx4 v[212:215], v1, s[4:7], s31 offen
    v_rcp_f32 v15, v15
    v_pk_add_f32 v[12:13], v[12:13], 1.0 op_sel_hi:[1,0]
    v_pk_mul_f32 v[184:185], v[184:185], v[14:15]
    s_set_gpr_idx_on s56, gpr_idx(SRC2,DST)
    v_pk_fma_f32 v[84:85], v[168:169], v[16:17], v[84:85] op_sel_hi:[0,1,1]
    v_pk_fma_f32 v[86:87], v[168:169], v[18:19], v[86:87] op_sel_hi:[0,1,1]
    v_pk_fma_f32 v[88:89], v[184:185], v[20:21], v[88:89] op_sel_hi:[0,1,1]
    v_pk_fma_f32 v[90:91], v[184:185], v[22:23], v[90:91] op_sel_hi:[0,1,1]
    s_set_gpr_idx_off
    s_and_b32 s31, s65, 0xfffffc00
    s_waitcnt lgkmcnt(0)
    s_waitcnt vmcnt(7)
    v_mfma_f32_4x4x4_16b_bf16 v[16:19], v[34:35], v[216:217], 0 cbsz:4 abid:5
    v_readlane_b32 s66, v8, 6
    v_mfma_f32_4x4x4_16b_bf16 v[20:23], v[34:35], v[218:219], 0 cbsz:4 abid:5
    v_mfma_f32_32x32x16_bf16 v[132:147], v[24:27], v[36:39], 0
    v_exp_f32 v14, v186
    v_exp_f32 v15, v187
    v_rcp_f32 v12, v12
    v_rcp_f32 v13, v13
    buffer_load_dwordx4 v[216:219], v1, s[4:7], s31 offen
    v_pk_add_f32 v[14:15], v[14:15], 1.0 op_sel_hi:[1,0]
    v_pk_mul_f32 v[170:171], v[170:171], v[12:13]
    s_set_gpr_idx_on s57, gpr_idx(SRC2,DST)
    v_pk_fma_f32 v[84:85], v[168:169], v[16:17], v[84:85] op_sel:[1,0,0]
    v_pk_fma_f32 v[86:87], v[168:169], v[18:19], v[86:87] op_sel:[1,0,0]
    v_pk_fma_f32 v[88:89], v[184:185], v[20:21], v[88:89] op_sel:[1,0,0]
    v_pk_fma_f32 v[90:91], v[184:185], v[22:23], v[90:91] op_sel:[1,0,0]
    s_set_gpr_idx_off
    s_and_b32 s31, s66, 0xfffffc00
    v_exp_f32 v12, v172
    s_waitcnt vmcnt(7)
    v_mfma_f32_4x4x4_16b_bf16 v[16:19], v[34:35], v[220:221], 0 cbsz:4 abid:6
    v_exp_f32 v13, v173
    v_mfma_f32_4x4x4_16b_bf16 v[20:23], v[34:35], v[222:223], 0 cbsz:4 abid:6
    v_readlane_b32 s67, v8, 7
    v_rcp_f32 v14, v14
    buffer_load_dwordx4 v[220:223], v1, s[4:7], s31 offen
    v_rcp_f32 v15, v15
    v_pk_add_f32 v[12:13], v[12:13], 1.0 op_sel_hi:[1,0]
    v_pk_mul_f32 v[186:187], v[186:187], v[14:15]
    s_set_gpr_idx_on s58, gpr_idx(SRC2,DST)
    v_pk_fma_f32 v[84:85], v[170:171], v[16:17], v[84:85] op_sel_hi:[0,1,1]
    v_pk_fma_f32 v[86:87], v[170:171], v[18:19], v[86:87] op_sel_hi:[0,1,1]
    v_pk_fma_f32 v[88:89], v[186:187], v[20:21], v[88:89] op_sel_hi:[0,1,1]
    v_pk_fma_f32 v[90:91], v[186:187], v[22:23], v[90:91] op_sel_hi:[0,1,1]
    s_set_gpr_idx_off
    s_and_b32 s31, s67, 0xfffffc00
    s_waitcnt vmcnt(7)
    v_mfma_f32_4x4x4_16b_bf16 v[16:19], v[34:35], v[224:225], 0 cbsz:4 abid:7
    v_readlane_b32 s36, v8, 8
    v_mfma_f32_4x4x4_16b_bf16 v[20:23], v[34:35], v[226:227], 0 cbsz:4 abid:7
    v_mfma_f32_32x32x16_bf16 v[132:147], v[28:31], v[40:43], v[132:147]
    v_exp_f32 v14, v188
    v_exp_f32 v15, v189
    v_rcp_f32 v12, v12
    v_rcp_f32 v13, v13
    buffer_load_dwordx4 v[224:227], v1, s[4:7], s31 offen
    v_pk_add_f32 v[14:15], v[14:15], 1.0 op_sel_hi:[1,0]
    v_pk_mul_f32 v[172:173], v[172:173], v[12:13]
    s_set_gpr_idx_on s59, gpr_idx(SRC2,DST)
    v_pk_fma_f32 v[84:85], v[170:171], v[16:17], v[84:85] op_sel:[1,0,0]
    v_pk_fma_f32 v[86:87], v[170:171], v[18:19], v[86:87] op_sel:[1,0,0]
    v_pk_fma_f32 v[88:89], v[186:187], v[20:21], v[88:89] op_sel:[1,0,0]
    v_pk_fma_f32 v[90:91], v[186:187], v[22:23], v[90:91] op_sel:[1,0,0]
    s_set_gpr_idx_off
    s_and_b32 s31, s36, 0xfffffc00
    s_sub_u32 s29, s29, 4
    s_cbranch_scc1 L_exit
    s_setprio 1
    v_exp_f32 v12, v174
    s_waitcnt vmcnt(7)
    v_mfma_f32_4x4x4_16b_bf16 v[16:19], v[34:35], v[196:197], 0 cbsz:4 abid:8
    v_exp_f32 v13, v175
    v_mfma_f32_4x4x4_16b_bf16 v[20:23], v[34:35], v[198:199], 0 cbsz:4 abid:8
    v_readlane_b32 s37, v8, 9
    v_rcp_f32 v14, v14
    buffer_load_dwordx4 v[196:199], v1, s[4:7], s31 offen
    v_rcp_f32 v15, v15
    v_pk_add_f32 v[12:13], v[12:13], 1.0 op_sel_hi:[1,0]
    v_pk_mul_f32 v[188:189], v[188:189], v[14:15]
    s_set_gpr_idx_on s60, gpr_idx(SRC2,DST)
    v_pk_fma_f32 v[84:85], v[172:173], v[16:17], v[84:85] op_sel_hi:[0,1,1]
    v_pk_fma_f32 v[86:87], v[172:173], v[18:19], v[86:87] op_sel_hi:[0,1,1]
    v_pk_fma_f32 v[88:89], v[188:189], v[20:21], v[88:89] op_sel_hi:[0,1,1]
    v_pk_fma_f32 v[90:91], v[188:189], v[22:23], v[90:91] op_sel_hi:[0,1,1]
    s_set_gpr_idx_off
    s_and_b32 s31, s37, 0xfffffc00
    s_waitcnt vmcnt(7)
    v_mfma_f32_4x4x4_16b_bf16 v[16:19], v[34:35], v[200:201], 0 cbsz:4 abid:9
    v_readlane_b32 s38, v8, 10
    v_mfma_f32_4x4x4_16b_bf16 v[20:23], v[34:35], v[202:203], 0 cbsz:4 abid:9
    v_mfma_f32_32x32x16_bf16 v[148:163], v[24:27], v[44:47], 0
    v_exp_f32 v14, v190
    v_exp_f32 v15, v191
    v_rcp_f32 v12, v12
    v_rcp_f32 v13, v13
    buffer_load_dwordx4 v[200:203], v1, s[4:7], s31 offen
    v_pk_add_f32 v[14:15], v[14:15], 1.0 op_sel_hi:[1,0]
    v_pk_mul_f32 v[174:175], v[174:175], v[12:13]
    s_set_gpr_idx_on s61, gpr_idx(SRC2,DST)
    v_pk_fma_f32 v[84:85], v[172:173], v[16:17], v[84:85] op_sel:[1,0,0]
    v_pk_fma_f32 v[86:87], v[172:173], v[18:19], v[86:87] op_sel:[1,0,0]
    v_pk_fma_f32 v[88:89], v[188:189], v[20:21], v[88:89] op_sel:[1,0,0]
    v_pk_fma_f32 v[90:91], v[188:189], v[22:23], v[90:91] op_sel:[1,0,0]
    s_set_gpr_idx_off
    s_and_b32 s31, s38, 0xfffffc00
    v_exp_f32 v12, v176
    s_waitcnt vmcnt(7)
    v_mfma_f32_4x4x4_16b_bf16 v[16:19], v[34:35], v[204:205], 0 cbsz:4 abid:10
    v_exp_f32 v13, v177
    v_mfma_f32_4x4x4_16b_bf16 v[20:23], v[34:35], v[206:207], 0 cbsz:4 abid:10
    v_readlane_b32 s39, v8, 11
    v_rcp_f32 v14, v14
    buffer_load_dwordx4 v[204:207], v1, s[4:7], s31 offen
    v_rcp_f32 v15, v15
    v_pk_add_f32 v[12:13], v[12:13], 1.0 op_sel_hi:[1,0]
    v_pk_mul_f32 v[190:191], v[190:191], v[14:15]
    s_set_gpr_idx_on s62, gpr_idx(SRC2,DST)
    v_pk_fma_f32 v[84:85], v[174:175], v[16:17], v[84:85] op_sel_hi:[0,1,1]
    v_pk_fma_f32 v[86:87], v[174:175], v[18:19], v[86:87] op_sel_hi:[0,1,1]
    v_pk_fma_f32 v[88:89], v[190:191], v[20:21], v[88:89] op_sel_hi:[0,1,1]
    v_pk_fma_f32 v[90:91], v[190:191], v[22:23], v[90:91] op_sel_hi:[0,1,1]
    s_set_gpr_idx_off
    s_and_b32 s31, s39, 0xfffffc00
    s_waitcnt vmcnt(7)
    v_mfma_f32_4x4x4_16b_bf16 v[16:19], v[34:35], v[208:209], 0 cbsz:4 abid:11
    v_readlane_b32 s40, v8, 12
    v_mfma_f32_4x4x4_16b_bf16 v[20:23], v[34:35], v[210:211], 0 cbsz:4 abid:11
    v_mfma_f32_32x32x16_bf16 v[148:163], v[28:31], v[48:51], v[148:163]
    v_exp_f32 v14, v192
    v_exp_f32 v15, v193
    v_rcp_f32 v12, v12
    v_rcp_f32 v13, v13
    buffer_load_dwordx4 v[208:211], v1, s[4:7], s31 offen
    v_pk_add_f32 v[14:15], v[14:15], 1.0 op_sel_hi:[1,0]
    v_pk_mul_f32 v[176:177], v[176:177], v[12:13]
    s_set_gpr_idx_on s63, gpr_idx(SRC2,DST)
    v_pk_fma_f32 v[84:85], v[174:175], v[16:17], v[84:85] op_sel:[1,0,0]
    v_pk_fma_f32 v[86:87], v[174:175], v[18:19], v[86:87] op_sel:[1,0,0]
    v_pk_fma_f32 v[88:89], v[190:191], v[20:21], v[88:89] op_sel:[1,0,0]
    v_pk_fma_f32 v[90:91], v[190:191], v[22:23], v[90:91] op_sel:[1,0,0]
    s_set_gpr_idx_off
    s_and_b32 s31, s40, 0xfffffc00
    s_sub_u32 s29, s29, 4
    s_cbranch_scc1 L_exit
    s_setprio 0
    v_exp_f32 v12, v178
    s_waitcnt vmcnt(7)
    v_mfma_f32_4x4x4_16b_bf16 v[16:19], v[34:35], v[212:213], 0 cbsz:4 abid:12
    v_exp_f32 v13, v179
    v_mfma_f32_4x4x4_16b_bf16 v[20:23], v[34:35], v[214:215], 0 cbsz:4 abid:12
    v_readlane_b32 s41, v8, 13
    v_rcp_f32 v14, v14
    buffer_load_dwordx4 v[212:215], v1, s[4:7], s31 offen
    v_rcp_f32 v15, v15
    v_pk_add_f32 v[12:13], v[12:13], 1.0 op_sel_hi:[1,0]
    v_pk_mul_f32 v[192:193], v[192:193], v[14:15]
    s_set_gpr_idx_on s64, gpr_idx(SRC2,DST)
    v_pk_fma_f32 v[84:85], v[176:177], v[16:17], v[84:85] op_sel_hi:[0,1,1]
    v_pk_fma_f32 v[86:87], v[176:177], v[18:19], v[86:87] op_sel_hi:[0,1,1]
    v_pk_fma_f32 v[88:89], v[192:193], v[20:21], v[88:89] op_sel_hi:[0,1,1]
    v_pk_fma_f32 v[90:91], v[192:193], v[22:23], v[90:91] op_sel_hi:[0,1,1]
    s_set_gpr_idx_off
    s_and_b32 s31, s41, 0xfffffc00
    v_exp_f32 v14, v194
    s_waitcnt vmcnt(7)
    v_mfma_f32_4x4x4_16b_bf16 v[16:19], v[34:35], v[216:217], 0 cbsz:4 abid:13
    v_exp_f32 v15, v195
    v_mfma_f32_4x4x4_16b_bf16 v[20:23], v[34:35], v[218:219], 0 cbsz:4 abid:13
    v_readlane_b32 s42, v8, 14
    v_rcp_f32 v12, v12
    buffer_load_dwordx4 v[216:219], v1, s[4:7], s31 offen
    v_rcp_f32 v13, v13
    v_pk_add_f32 v[14:15], v[14:15], 1.0 op_sel_hi:[1,0]
    v_pk_mul_f32 v[178:179], v[178:179], v[12:13]
    s_set_gpr_idx_on s65, gpr_idx(SRC2,DST)
    v_pk_fma_f32 v[84:85], v[176:177], v[16:17], v[84:85] op_sel:[1,0,0]
    v_pk_fma_f32 v[86:87], v[176:177], v[18:19], v[86:87] op_sel:[1,0,0]
    v_pk_fma_f32 v[88:89], v[192:193], v[20:21], v[88:89] op_sel:[1,0,0]
    v_pk_fma_f32 v[90:91], v[192:193], v[22:23], v[90:91] op_sel:[1,0,0]
    s_set_gpr_idx_off
    s_and_b32 s31, s42, 0xfffffc00
    v_exp_f32 v12, v132
    s_waitcnt vmcnt(7)
    v_mfma_f32_4x4x4_16b_bf16 v[16:19], v[34:35], v[220:221], 0 cbsz:4 abid:14
    v_exp_f32 v13, v133
    v_mfma_f32_4x4x4_16b_bf16 v[20:23], v[34:35], v[222:223], 0 cbsz:4 abid:14
    v_readlane_b32 s43, v8, 15
    v_rcp_f32 v14, v14
    buffer_load_dwordx4 v[220:223], v1, s[4:7], s31 offen
    v_rcp_f32 v15, v15
    v_pk_add_f32 v[12:13], v[12:13], 1.0 op_sel_hi:[1,0]
    v_pk_mul_f32 v[194:195], v[194:195], v[14:15]
    s_set_gpr_idx_on s66, gpr_idx(SRC2,DST)
    v_pk_fma_f32 v[84:85], v[178:179], v[16:17], v[84:85] op_sel_hi:[0,1,1]
    v_pk_fma_f32 v[86:87], v[178:179], v[18:19], v[86:87] op_sel_hi:[0,1,1]
    v_pk_fma_f32 v[88:89], v[194:195], v[20:21], v[88:89] op_sel_hi:[0,1,1]
    v_pk_fma_f32 v[90:91], v[194:195], v[22:23], v[90:91] op_sel_hi:[0,1,1]
    s_set_gpr_idx_off
    s_and_b32 s31, s43, 0xfffffc00
    v_exp_f32 v14, v148
    s_waitcnt vmcnt(7)
    v_mfma_f32_4x4x4_16b_bf16 v[16:19], v[34:35], v[224:225], 0 cbsz:4 abid:15
    v_exp_f32 v15, v149
    v_mfma_f32_4x4x4_16b_bf16 v[20:23], v[34:35], v[226:227], 0 cbsz:4 abid:15
    v_readlane_b32 s44, v7, 0
    v_rcp_f32 v12, v12
    buffer_load_dwordx4 v[224:227], v1, s[4:7], s31 offen
    v_rcp_f32 v13, v13
    v_pk_add_f32 v[14:15], v[14:15], 1.0 op_sel_hi:[1,0]
    v_pk_mul_f32 v[132:133], v[132:133], v[12:13]
    s_set_gpr_idx_on s67, gpr_idx(SRC2,DST)
    v_pk_fma_f32 v[84:85], v[178:179], v[16:17], v[84:85] op_sel:[1,0,0]
    v_pk_fma_f32 v[86:87], v[178:179], v[18:19], v[86:87] op_sel:[1,0,0]
    v_pk_fma_f32 v[88:89], v[194:195], v[20:21], v[88:89] op_sel:[1,0,0]
    v_pk_fma_f32 v[90:91], v[194:195], v[22:23], v[90:91] op_sel:[1,0,0]
    s_set_gpr_idx_off
    s_and_b32 s31, s44, 0xfffffc00
    s_sub_u32 s29, s29, 4
    s_cbranch_scc1 L_exit
    v_add_u32 v4, 256, v4
    v_add_u32 v5, 256, v5
    v_add_u32 v6, 256, v6
    s_branch L_loop
L_more:
    s_waitcnt vmcnt(0) lgkmcnt(0)
    s_barrier
    v_lshlrev_b32 v188, 4, v0
    v_add_u32 v189, 8192, v188
    v_add_u32 v190, 16384, v188
    v_add_u32 v191, 24576, v188
    v_add_u32 v192, 32768, v188
    v_add_u32 v193, 40960, v188
    v_lshlrev_b32 v194, 2, v0
    v_lshlrev_b32 v14, 3, v0
    v_mov_b32 v16, 0
    v_mov_b32 v17, 0
    v_mov_b32 v15, 0x03000000
    ds_write_b64 v14, v[16:17] offset:16128
    ds_write_b32 v194, v15 offset:20224
    ds_write_b32 v194, v15 offset:22272
    ds_write_b32 v194, v15 offset:24320
    v_lshrrev_b32 v195, 1, v0
    v_lshlrev_b32 v195, 2, v195
    s_branch L_round
L_exit:
    s_add_u32 s28, s28, 1536
    s_cmp_lt_u32 s28, s25
    s_cbranch_scc1 L_more
    s_mov_b32 s68, 0xbf317218
    s_mov_b32 s69, s68
    v_lshlrev_b32 v38, 2, v11
    s_and_b32 s3, s96, 0xffff
    s_mul_i32 s3, s3, 1261
    s_lshr_b32 s3, s3, 16
    s_mul_i32 s3, s3, 1152
    v_add_u32 v44, s3, v38
    v_pk_mul_f32 v[84:85], v[84:85], s[68:69]
    v_pk_mul_f32 v[86:87], v[86:87], s[68:69]
    v_pk_mul_f32 v[88:89], v[88:89], s[68:69]
    v_pk_mul_f32 v[90:91], v[90:91], s[68:69]
    v_cvt_pk_bf16_f32 v84, v84, v88
    v_cvt_pk_bf16_f32 v85, v85, v89
    v_cvt_pk_bf16_f32 v86, v86, v90
    v_cvt_pk_bf16_f32 v87, v87, v91
    ds_write_b32 v44, v84 offset:16128
    ds_write_b32 v44, v85 offset:16416
    ds_write_b32 v44, v86 offset:16704
    ds_write_b32 v44, v87 offset:16992
    s_and_b32 s3, s97, 0xffff
    s_mul_i32 s3, s3, 1261
    s_lshr_b32 s3, s3, 16
    s_mul_i32 s3, s3, 1152
    v_add_u32 v45, s3, v38
    v_pk_mul_f32 v[92:93], v[92:93], s[68:69]
    v_pk_mul_f32 v[94:95], v[94:95], s[68:69]
    v_pk_mul_f32 v[96:97], v[96:97], s[68:69]
    v_pk_mul_f32 v[98:99], v[98:99], s[68:69]
    v_cvt_pk_bf16_f32 v92, v92, v96
    v_cvt_pk_bf16_f32 v93, v93, v97
    v_cvt_pk_bf16_f32 v94, v94, v98
    v_cvt_pk_bf16_f32 v95, v95, v99
    ds_write_b32 v45, v92 offset:16128
    ds_write_b32 v45, v93 offset:16416
    ds_write_b32 v45, v94 offset:16704
    ds_write_b32 v45, v95 offset:16992
    s_and_b32 s3, s98, 0xffff
    s_mul_i32 s3, s3, 1261
    s_lshr_b32 s3, s3, 16
    s_mul_i32 s3, s3, 1152
    v_add_u32 v46, s3, v38
    v_pk_mul_f32 v[100:101], v[100:101], s[68:69]
    v_pk_mul_f32 v[102:103], v[102:103], s[68:69]
    v_pk_mul_f32 v[104:105], v[104:105], s[68:69]
    v_pk_mul_f32 v[106:107], v[106:107], s[68:69]
    v_cvt_pk_bf16_f32 v100, v100, v104
    v_cvt_pk_bf16_f32 v101, v101, v105
    v_cvt_pk_bf16_f32 v102, v102, v106
    v_cvt_pk_bf16_f32 v103, v103, v107
    ds_write_b32 v46, v100 offset:16128
    ds_write_b32 v46, v101 offset:16416
    ds_write_b32 v46, v102 offset:16704
    ds_write_b32 v46, v103 offset:16992
    s_and_b32 s3, s99, 0xffff
    s_mul_i32 s3, s3, 1261
    s_lshr_b32 s3, s3, 16
    s_mul_i32 s3, s3, 1152
    v_add_u32 v47, s3, v38
    v_pk_mul_f32 v[108:109], v[108:109], s[68:69]
    v_pk_mul_f32 v[110:111], v[110:111], s[68:69]
    v_pk_mul_f32 v[112:113], v[112:113], s[68:69]
    v_pk_mul_f32 v[114:115], v[114:115], s[68:69]
    v_cvt_pk_bf16_f32 v108, v108, v112
    v_cvt_pk_bf16_f32 v109, v109, v113
    v_cvt_pk_bf16_f32 v110, v110, v114
    v_cvt_pk_bf16_f32 v111, v111, v115
    ds_write_b32 v47, v108 offset:16128
    ds_write_b32 v47, v109 offset:16416
    ds_write_b32 v47, v110 offset:16704
    ds_write_b32 v47, v111 offset:16992
    s_and_b32 s3, s100, 0xffff
    s_mul_i32 s3, s3, 1261
    s_lshr_b32 s3, s3, 16
    s_mul_i32 s3, s3, 1152
    v_add_u32 v48, s3, v38
    v_pk_mul_f32 v[116:117], v[116:117], s[68:69]
    v_pk_mul_f32 v[118:119], v[118:119], s[68:69]
    v_pk_mul_f32 v[120:121], v[120:121], s[68:69]
    v_pk_mul_f32 v[122:123], v[122:123], s[68:69]
    v_cvt_pk_bf16_f32 v116, v116, v120
    v_cvt_pk_bf16_f32 v117, v117, v121
    v_cvt_pk_bf16_f32 v118, v118, v122
    v_cvt_pk_bf16_f32 v119, v119, v123
    ds_write_b32 v48, v116 offset:16128
    ds_write_b32 v48, v117 offset:16416
    ds_write_b32 v48, v118 offset:16704
    ds_write_b32 v48, v119 offset:16992
    s_mul_i32 s31, s27, 23040
    v_and_b32 v39, 15, v11
    v_lshrrev_b32 v40, 4, v11
    v_mul_u32_u24 v41, 288, v39
    v_lshl_add_u32 v41, v40, 4, v41
    v_add_u32 v41, s31, v41
    s_mul_i32 s68, s27, 5120
    s_add_u32 s68, s68, s2
    s_lshl_b32 s68, s68, 10
    s_and_b32 s3, s24, 3
    s_lshl_b32 s3, s3, 8
    s_add_u32 s68, s68, s3
    v_lshlrev_b32 v40, 18, v40
    v_lshl_add_u32 v40, v39, 4, v40
    v_add_u32 v40, s68, v40
    s_or_b32 s3, s2, s24
    s_cbranch_scc1 L_noep
    v_mov_b32 v42, s26
    global_store_dword v38, v42, s[22:23] offset:0 sc0 sc1
L_noep:
    s_waitcnt lgkmcnt(0)
    s_barrier
    ds_read_b128 v[84:87], v41 offset:16128
    ds_read_b128 v[88:91], v41 offset:16192
    ds_read_b128 v[92:95], v41 offset:16256
    ds_read_b128 v[96:99], v41 offset:16320
    ds_read_b128 v[100:103], v41 offset:20736
    ds_read_b128 v[104:107], v41 offset:20800
    ds_read_b128 v[108:111], v41 offset:20864
    ds_read_b128 v[112:115], v41 offset:20928
    s_waitcnt lgkmcnt(7)
    v_mfma_f32_16x16x32_bf16 v[116:119], v[84:87], v[52:55], 0
    v_mfma_f32_16x16x32_bf16 v[120:123], v[84:87], v[56:59], 0
    s_waitcnt lgkmcnt(6)
    v_mfma_f32_16x16x32_bf16 v[116:119], v[88:91], v[60:63], v[116:119]
    v_mfma_f32_16x16x32_bf16 v[120:123], v[88:91], v[64:67], v[120:123]
    s_waitcnt lgkmcnt(5)
    v_mfma_f32_16x16x32_bf16 v[116:119], v[92:95], v[68:71], v[116:119]
    v_mfma_f32_16x16x32_bf16 v[120:123], v[92:95], v[72:75], v[120:123]
    s_waitcnt lgkmcnt(4)
    v_mfma_f32_16x16x32_bf16 v[116:119], v[96:99], v[76:79], v[116:119]
    v_mfma_f32_16x16x32_bf16 v[120:123], v[96:99], v[80:83], v[120:123]
    ds_read_b128 v[84:87], v41 offset:25344
    ds_read_b128 v[88:91], v41 offset:25408
    ds_read_b128 v[92:95], v41 offset:25472
    ds_read_b128 v[96:99], v41 offset:25536
    s_waitcnt lgkmcnt(7)
    v_mfma_f32_16x16x32_bf16 v[124:127], v[100:103], v[52:55], 0
    v_mfma_f32_16x16x32_bf16 v[128:131], v[100:103], v[56:59], 0
    s_waitcnt lgkmcnt(6)
    v_mfma_f32_16x16x32_bf16 v[124:127], v[104:107], v[60:63], v[124:127]
    v_mfma_f32_16x16x32_bf16 v[128:131], v[104:107], v[64:67], v[128:131]
    s_waitcnt lgkmcnt(5)
    v_mfma_f32_16x16x32_bf16 v[124:127], v[108:111], v[68:71], v[124:127]
    v_mfma_f32_16x16x32_bf16 v[128:131], v[108:111], v[72:75], v[128:131]
    s_waitcnt lgkmcnt(4)
    v_mfma_f32_16x16x32_bf16 v[124:127], v[112:115], v[76:79], v[124:127]
    v_mfma_f32_16x16x32_bf16 v[128:131], v[112:115], v[80:83], v[128:131]
    v_cvt_pk_bf16_f32 v44, v116, v117
    v_cvt_pk_bf16_f32 v45, v118, v119
    v_cvt_pk_bf16_f32 v46, v120, v121
    v_cvt_pk_bf16_f32 v47, v122, v123
    s_mov_b32 s3, 0
    buffer_store_dwordx4 v[44:47], v40, s[16:19], s3 offen sc0 sc1
    ds_read_b128 v[100:103], v41 offset:29952
    ds_read_b128 v[104:107], v41 offset:30016
    ds_read_b128 v[108:111], v41 offset:30080
    ds_read_b128 v[112:115], v41 offset:30144
    s_waitcnt lgkmcnt(7)
    v_mfma_f32_16x16x32_bf16 v[116:119], v[84:87], v[52:55], 0
    v_mfma_f32_16x16x32_bf16 v[120:123], v[84:87], v[56:59], 0
    s_waitcnt lgkmcnt(6)
    v_mfma_f32_16x16x32_bf16 v[116:119], v[88:91], v[60:63], v[116:119]
    v_mfma_f32_16x16x32_bf16 v[120:123], v[88:91], v[64:67], v[120:123]
    s_waitcnt lgkmcnt(5)
    v_mfma_f32_16x16x32_bf16 v[116:119], v[92:95], v[68:71], v[116:119]
    v_mfma_f32_16x16x32_bf16 v[120:123], v[92:95], v[72:75], v[120:123]
    s_waitcnt lgkmcnt(4)
    v_mfma_f32_16x16x32_bf16 v[116:119], v[96:99], v[76:79], v[116:119]
    v_mfma_f32_16x16x32_bf16 v[120:123], v[96:99], v[80:83], v[120:123]
    v_cvt_pk_bf16_f32 v48, v124, v125
    v_cvt_pk_bf16_f32 v49, v126, v127
    v_cvt_pk_bf16_f32 v50, v128, v129
    v_cvt_pk_bf16_f32 v51, v130, v131
    s_mov_b32 s3, 1048576
    buffer_store_dwordx4 v[48:51], v40, s[16:19], s3 offen sc0 sc1
    ds_read_b128 v[84:87], v41 offset:34560
    ds_read_b128 v[88:91], v41 offset:34624
    ds_read_b128 v[92:95], v41 offset:34688
    ds_read_b128 v[96:99], v41 offset:34752
    s_waitcnt lgkmcnt(7)
    v_mfma_f32_16x16x32_bf16 v[124:127], v[100:103], v[52:55], 0
    v_mfma_f32_16x16x32_bf16 v[128:131], v[100:103], v[56:59], 0
    s_waitcnt lgkmcnt(6)
    v_mfma_f32_16x16x32_bf16 v[124:127], v[104:107], v[60:63], v[124:127]
    v_mfma_f32_16x16x32_bf16 v[128:131], v[104:107], v[64:67], v[128:131]
    s_waitcnt lgkmcnt(5)
    v_mfma_f32_16x16x32_bf16 v[124:127], v[108:111], v[68:71], v[124:127]
    v_mfma_f32_16x16x32_bf16 v[128:131], v[108:111], v[72:75], v[128:131]
    s_waitcnt lgkmcnt(4)
    v_mfma_f32_16x16x32_bf16 v[124:127], v[112:115], v[76:79], v[124:127]
    v_mfma_f32_16x16x32_bf16 v[128:131], v[112:115], v[80:83], v[128:131]
    v_cvt_pk_bf16_f32 v44, v116, v117
    v_cvt_pk_bf16_f32 v45, v118, v119
    v_cvt_pk_bf16_f32 v46, v120, v121
    v_cvt_pk_bf16_f32 v47, v122, v123
    s_mov_b32 s3, 2097152
    buffer_store_dwordx4 v[44:47], v40, s[16:19], s3 offen sc0 sc1
    s_waitcnt lgkmcnt(3)
    v_mfma_f32_16x16x32_bf16 v[116:119], v[84:87], v[52:55], 0
    v_mfma_f32_16x16x32_bf16 v[120:123], v[84:87], v[56:59], 0
    s_waitcnt lgkmcnt(2)
    v_mfma_f32_16x16x32_bf16 v[116:119], v[88:91], v[60:63], v[116:119]
    v_mfma_f32_16x16x32_bf16 v[120:123], v[88:91], v[64:67], v[120:123]
    s_waitcnt lgkmcnt(1)
    v_mfma_f32_16x16x32_bf16 v[116:119], v[92:95], v[68:71], v[116:119]
    v_mfma_f32_16x16x32_bf16 v[120:123], v[92:95], v[72:75], v[120:123]
    s_waitcnt lgkmcnt(0)
    v_mfma_f32_16x16x32_bf16 v[116:119], v[96:99], v[76:79], v[116:119]
    v_mfma_f32_16x16x32_bf16 v[120:123], v[96:99], v[80:83], v[120:123]
    v_cvt_pk_bf16_f32 v48, v124, v125
    v_cvt_pk_bf16_f32 v49, v126, v127
    v_cvt_pk_bf16_f32 v50, v128, v129
    v_cvt_pk_bf16_f32 v51, v130, v131
    s_mov_b32 s3, 3145728
    buffer_store_dwordx4 v[48:51], v40, s[16:19], s3 offen sc0 sc1
    s_nop 3
    v_cvt_pk_bf16_f32 v44, v116, v117
    v_cvt_pk_bf16_f32 v45, v118, v119
    v_cvt_pk_bf16_f32 v46, v120, v121
    v_cvt_pk_bf16_f32 v47, v122, v123
    s_mov_b32 s3, 4194304
    buffer_store_dwordx4 v[44:47], v40, s[16:19], s3 offen sc0 sc1
L_end:
    s_endpgm
.section .rodata,"a"
.p2align 6
.amdhsa_kernel standalone__tensor_product_equiv_tfn__graph_kernel
  .amdhsa_next_free_vgpr 231
  .amdhsa_next_free_sgpr 102
  .amdhsa_accum_offset 232
  .amdhsa_group_segment_fixed_size 0
  .amdhsa_kernarg_size 88
  .amdhsa_user_sgpr_count 2
  .amdhsa_user_sgpr_kernarg_segment_ptr 1
  .amdhsa_system_sgpr_workgroup_id_x 1
  .amdhsa_float_denorm_mode_32 3
.end_amdhsa_kernel
```

```asm
; @launch grid=(256,1,1) block=(512,1,1) lds=163584
.amdgcn_target "amdgcn-amd-amdhsa--gfx950"
.text
.globl standalone__tensor_product_equiv_tfn__graph_kernel
.p2align 8
.type standalone__tensor_product_equiv_tfn__graph_kernel,@function
standalone__tensor_product_equiv_tfn__graph_kernel:
    s_load_dwordx16 s[4:19], s[0:1], 0
    s_load_dwordx2 s[22:23], s[0:1], 80
    s_load_dwordx2 s[20:21], s[0:1], 64
    s_cmp_ge_u32 s2, 256
    s_cbranch_scc1 L_end
    v_mul_u32_u24 v172, 3, v0
    s_mul_i32 s3, s2, 1250
    v_min_u32 v172, 1247, v172
    v_add_lshl_u32 v173, v172, s3, 2
    v_lshrrev_b32 v12, 6, v0
    v_and_b32 v13, 255, v0
    v_lshlrev_b32 v13, 2, v13
    v_mov_b32 v16, 0
    v_readfirstlane_b32 s24, v12
    ds_write_b32 v13, v16 offset:0
    v_lshlrev_b32 v174, 1, v173
    s_waitcnt lgkmcnt(0)
    global_load_dwordx3 v[132:134], v173, s[8:9]
    s_load_dword s26, s[22:23], 0
    s_barrier
    global_load_dwordx3 v[136:138], v173, s[6:7]
    global_load_dwordx4 v[140:143], v174, s[10:11]
    global_load_dwordx2 v[144:145], v174, s[10:11] offset:16
    s_cmp_eq_u32 s24, 7
    s_cbranch_scc0 L_nocpf
    s_cmp_lt_u32 s2, 8
    s_cbranch_scc0 L_nocpf
    s_getpc_b64 s[68:69]
L_pc:
    v_and_b32 v18, 63, v0
    v_lshlrev_b32 v18, 7, v18
    v_mov_b32 v19, 0
    v_lshl_add_u64 v[20:21], v[18:19], 0, s[68:69]
    global_load_dword v204, v[20:21], off
    v_min_u32 v18, L_end-L_pc-8192, v18
    v_add_u32 v18, 8192, v18
    v_lshl_add_u64 v[20:21], v[18:19], 0, s[68:69]
    global_load_dword v205, v[20:21], off
L_nocpf:
    v_lshlrev_b32 v188, 4, v0
    v_and_b32 v11, 63, v0
    s_lshl_b32 s30, s24, 10
    s_lshl_b32 s3, s3, 5
    s_add_u32 s12, s12, s3
    s_addc_u32 s13, s13, 0
    v_add_u32 v189, 8192, v188
    v_add_u32 v190, 16384, v188
    v_add_u32 v191, 24576, v188
    v_add_u32 v192, 32768, v188
    v_add_u32 v193, 40960, v188
    v_min_u32 v175, 39984, v192
    v_lshlrev_b32 v1, 4, v11
    s_barrier
    s_add_u32 m0, s30, 112384
    s_nop 0
    global_load_lds_dwordx4 v188, s[12:13]
    s_add_u32 m0, s30, 120576
    s_nop 0
    global_load_lds_dwordx4 v189, s[12:13]
    v_lshlrev_b32 v194, 2, v0
    v_lshlrev_b32 v14, 3, v0
    v_mov_b32 v16, 0
    v_mov_b32 v17, 0
    v_mov_b32 v15, 0x00300000
    ds_write_b64 v14, v[16:17] offset:16128
    ds_write_b32 v194, v15 offset:20224
    ds_write_b32 v194, v15 offset:22272
    ds_write_b32 v194, v15 offset:24320
    v_lshrrev_b32 v195, 1, v0
    v_lshlrev_b32 v195, 2, v195
    v_cmp_gt_u32 vcc, 416, v0
    s_mov_b64 s[36:37], vcc
    v_cmp_gt_u32 vcc, 417, v0
    s_mov_b64 s[38:39], vcc
    v_mov_b32 v12, 1
    s_movk_i32 s40, 1250
    s_mov_b32 s41, 63232
    s_lshr_b32 s27, s24, 2
    s_mov_b32 s28, 0
    s_waitcnt vmcnt(5)
    s_mov_b64 exec, s[38:39]
    v_and_b32 v153, 7, v133
    v_bfe_u32 v150, v133, 3, 5
    v_lshl_add_u32 v147, v153, 5, v150
    v_lshlrev_b32 v147, 2, v147
    ds_add_rtn_u32 v150, v147, v12 offset:0
    v_and_b32 v154, 7, v134
    v_bfe_u32 v151, v134, 3, 5
    v_lshl_add_u32 v148, v154, 5, v151
    v_lshlrev_b32 v148, 2, v148
    ds_add_rtn_u32 v151, v148, v12 offset:0
    s_mov_b64 exec, s[36:37]
    v_and_b32 v152, 7, v132
    v_bfe_u32 v149, v132, 3, 5
    v_lshl_add_u32 v146, v152, 5, v149
    v_lshlrev_b32 v146, 2, v146
    ds_add_rtn_u32 v149, v146, v12 offset:0
    s_mov_b64 exec, -1
    s_add_u32 m0, s30, 128768
    s_nop 0
    global_load_lds_dwordx4 v190, s[12:13]
    s_add_u32 m0, s30, 136960
    s_nop 0
    global_load_lds_dwordx4 v191, s[12:13]
    s_add_u32 m0, s30, 145152
    s_nop 0
    global_load_lds_dwordx4 v175, s[12:13]
    s_waitcnt lgkmcnt(0)
    s_barrier
    ds_read_b128 v[164:167], v1 offset:0
    s_mul_i32 s3, s2, 1280
    s_add_u32 s26, s26, 1
    s_waitcnt lgkmcnt(0)
    v_add_u32 v180, v164, v165
    v_add3_u32 v180, v180, v166, v167
    v_mov_b32 v181, v180
    v_lshrrev_b32 v132, 8, v132
    v_lshlrev_b32 v156, 26, v132
    v_add_u32_dpp v181, v181, v181 row_shr:1 row_mask:0xf bank_mask:0xf
    v_lshl_add_u32 v132, v132, 4, v156
    v_add_lshl_u32 v177, v172, 0, 5
    v_add_u32_dpp v181, v181, v181 row_shr:2 row_mask:0xf bank_mask:0xf
    v_lshrrev_b32 v133, 8, v133
    v_lshlrev_b32 v157, 26, v133
    v_add_u32_dpp v181, v181, v181 row_shr:4 row_mask:0xf bank_mask:0xf
    v_lshl_add_u32 v133, v133, 4, v157
    v_add_lshl_u32 v178, v172, 1, 5
    v_add_u32_dpp v181, v181, v181 row_shr:8 row_mask:0xf bank_mask:0xf
    v_lshrrev_b32 v134, 8, v134
    v_lshlrev_b32 v158, 26, v134
    v_add_u32_dpp v181, v181, v181 row_bcast:15 row_mask:0xa bank_mask:0xf
    v_lshl_add_u32 v134, v134, 4, v158
    v_add_lshl_u32 v179, v172, 2, 5
    v_add_u32_dpp v181, v181, v181 row_bcast:31 row_mask:0xc bank_mask:0xf
    v_sub_u32 v168, v181, v180
    v_add_u32 v169, v168, v164
    v_add_u32 v170, v169, v165
    v_add_u32 v171, v170, v166
    ds_write_b128 v1, v[168:171] offset:1024
    s_mov_b64 exec, s[38:39]
    ds_read_b32 v147, v147 offset:1024
    ds_read_b32 v148, v148 offset:1024
    s_mov_b64 exec, s[36:37]
    ds_read_b32 v146, v146 offset:1024
    s_mov_b64 exec, -1
    s_waitcnt vmcnt(5)
    v_mad_u32_u24 v152, v152, s40, v136
    v_lshl_add_u32 v132, v136, 10, v132
    v_subrev_u32 v156, 10000, v152
    v_min_u32 v152, v152, v156
    v_mul_u32_u24 v152, 157, v152
    v_lshrrev_b32 v152, 17, v152
    v_add_u32 v152, v152, v132
    v_mad_u32_u24 v153, v153, s40, v137
    v_lshl_add_u32 v133, v137, 10, v133
    v_subrev_u32 v157, 10000, v153
    v_min_u32 v153, v153, v157
    v_mul_u32_u24 v153, 157, v153
    v_lshrrev_b32 v153, 17, v153
    v_add_u32 v153, v153, v133
    v_mad_u32_u24 v154, v154, s40, v138
    v_lshl_add_u32 v134, v138, 10, v134
    v_subrev_u32 v158, 10000, v154
    v_min_u32 v154, v154, v158
    v_mul_u32_u24 v154, 157, v154
    v_lshrrev_b32 v154, 17, v154
    v_add_u32 v154, v154, v134
    s_mov_b64 exec, s[38:39]
    s_waitcnt lgkmcnt(0)
    v_add_lshl_u32 v147, v147, v150, 1
    v_mad_u32_u24 v183, v147, 6, s41
    ds_write_b16 v147, v178 offset:2048
    ds_write2_b32 v183, v142, v143 offset1:1
    ds_write_b32 v183, v153 offset:8
    v_add_lshl_u32 v148, v148, v151, 1
    v_mad_u32_u24 v184, v148, 6, s41
    ds_write_b16 v148, v179 offset:2048
    ds_write2_b32 v184, v144, v145 offset1:1
    ds_write_b32 v184, v154 offset:8
    s_mov_b64 exec, s[36:37]
    v_add_lshl_u32 v146, v146, v149, 1
    v_mad_u32_u24 v182, v146, 6, s41
    ds_write_b16 v146, v177 offset:2048
    ds_write2_b32 v182, v140, v141 offset1:1
    ds_write_b32 v182, v152 offset:8
    s_mov_b64 exec, -1
    s_add_u32 m0, s30, 26368
    s_nop 0
    global_load_lds_dwordx4 v188, s[18:19]
    s_add_u32 m0, s30, 34560
    s_nop 0
    global_load_lds_dwordx4 v189, s[18:19]
    s_add_u32 m0, s30, 42752
    s_nop 0
    global_load_lds_dwordx4 v190, s[18:19]
    s_add_u32 m0, s30, 50944
    s_nop 0
    global_load_lds_dwordx4 v191, s[18:19]
    s_add_u32 s70, s30, 59136
    v_min_u32 v185, 112, v1
    s_cmp_lt_u32 s24, 4
    s_cselect_b64 vcc, -1, 0
    s_cselect_b32 m0, s70, 162560
    s_cselect_b64 s[68:69], s[14:15], s[16:17]
    v_cndmask_b32 v185, v185, v188, vcc
    global_load_lds_dwordx4 v185, s[68:69]
    v_add_u32 v168, s3, v168
    v_lshl_add_u32 v196, v164, 19, v168
    v_mov_b32 v197, s26
    v_add_u32 v169, s3, v169
    v_lshl_add_u32 v198, v165, 19, v169
    v_mov_b32 v199, s26
    v_add_u32 v170, s3, v170
    v_lshl_add_u32 v200, v166, 19, v170
    v_mov_b32 v201, s26
    v_add_u32 v171, s3, v171
    v_lshl_add_u32 v202, v167, 19, v171
    v_mov_b32 v203, s26
    s_lshl_b32 s31, s2, 11
    s_add_u32 s31, s31, 4096
    v_add_u32 v186, s31, v1
    s_mul_i32 s31, s3, 12
    s_add_u32 s31, s31, 1048576
    s_add_u32 s48, s22, s31
    s_addc_u32 s49, s23, 0
    s_mov_b32 s50, 15104
    s_mov_b32 s51, 0x00020000
    s_lshl_b32 s3, s3, 5
    s_add_u32 s31, s3, 8388608
    s_add_u32 s52, s22, s31
    s_addc_u32 s53, s23, 0
    s_mov_b32 s54, 40064
    s_mov_b32 s55, 0x00020000
    v_and_b32 v172, -2, v0
    v_and_b32 v173, 16, v188
    v_add_u32 v173, 112384, v173
    s_waitcnt lgkmcnt(0)
    s_barrier
    ds_read_b128 v[132:135], v188 offset:63232
    ds_read_b128 v[136:139], v189 offset:63232
    ds_read_u16 v174, v172 offset:2048
    ds_read_u16 v175, v172 offset:2560
    ds_read_u16 v176, v172 offset:3072
    ds_read_u16 v177, v172 offset:3584
    ds_read_u16 v178, v172 offset:4096
    s_waitcnt lgkmcnt(6)
    buffer_store_dwordx4 v[132:135], v188, s[48:51], 0 offen sc0 sc1
    s_waitcnt lgkmcnt(5)
    buffer_store_dwordx4 v[136:139], v189, s[48:51], 0 offen sc0 sc1
    s_waitcnt lgkmcnt(0)
    v_add_u32 v174, v174, v173
    v_add_u32 v175, v175, v173
    v_add_u32 v176, v176, v173
    v_add_u32 v177, v177, v173
    v_min_u32 v178, 39968, v178
    v_and_b32 v178, -16, v178
    v_add_u32 v178, v178, v173
    v_mov_b64 v[84:85], 0
    v_mov_b64 v[86:87], 0
    v_mov_b64 v[88:89], 0
    v_mov_b64 v[90:91], 0
    v_mov_b64 v[92:93], 0
    v_mov_b64 v[94:95], 0
    v_mov_b64 v[96:97], 0
    v_mov_b64 v[98:99], 0
    v_mov_b64 v[100:101], 0
    v_mov_b64 v[102:103], 0
    v_mov_b64 v[104:105], 0
    v_mov_b64 v[106:107], 0
    v_mov_b64 v[108:109], 0
    v_mov_b64 v[110:111], 0
    v_mov_b64 v[112:113], 0
    v_mov_b64 v[114:115], 0
    v_mov_b64 v[116:117], 0
    v_mov_b64 v[118:119], 0
    v_mov_b64 v[120:121], 0
    v_mov_b64 v[122:123], 0
    v_mov_b64 v[124:125], 0
    v_mov_b64 v[126:127], 0
    v_mov_b64 v[128:129], 0
    v_mov_b64 v[130:131], 0
    v_mov_b64 v[24:25], 0
    v_mov_b64 v[26:27], 0
    v_mov_b64 v[28:29], 0
    v_mov_b64 v[30:31], 0
    s_mov_b32 s32, 0x0f0f0f0f
    s_mov_b32 s33, s32
    s_not_b64 s[34:35], s[32:33]
    v_lshrrev_b32 v2, 5, v11
    v_lshlrev_b32 v2, 4, v2
    v_and_b32 v3, 3, v11
    v_lshlrev_b32 v3, 3, v3
    v_add_u32 v3, 112384, v3
    s_mov_b32 s6, 10240000
    s_mov_b32 s7, 0x00020000
    s_add_u32 s8, s22, 1048576
    s_addc_u32 s9, s23, 0
    s_mov_b32 s10, 3932160
    s_mov_b32 s11, 0x00020000
    s_mov_b32 s101, 0
    s_cmp_lt_u32 s2, 16
    s_cbranch_scc1 L_r40
    s_cmp_eq_u32 s24, 0
    s_cselect_b32 s101, 0x245d2388, s101
    s_cmp_eq_u32 s24, 1
    s_cselect_b32 s101, 0x25753343, s101
    s_cmp_eq_u32 s24, 2
    s_cselect_b32 s101, 0x27449100, s101
    s_cmp_eq_u32 s24, 3
    s_cselect_b32 s101, 0x267d5301, s101
    s_cmp_eq_u32 s24, 4
    s_cselect_b32 s101, 0x2179a402, s101
    s_cmp_eq_u32 s24, 5
    s_cselect_b32 s101, 0x227162c6, s101
    s_cmp_eq_u32 s24, 6
    s_cselect_b32 s101, 0x206543c7, s101
    s_cmp_eq_u32 s24, 7
    s_cselect_b32 s101, 0x236d8285, s101
    s_branch L_rd
L_r40:
    s_cmp_eq_u32 s24, 0
    s_cselect_b32 s101, 0x2271a3c1, s101
    s_cmp_eq_u32 s24, 1
    s_cselect_b32 s101, 0x20750307, s101
    s_cmp_eq_u32 s24, 2
    s_cselect_b32 s101, 0x236d5205, s101
    s_cmp_eq_u32 s24, 3
    s_cselect_b32 s101, 0x27797340, s101
    s_cmp_eq_u32 s24, 4
    s_cselect_b32 s101, 0x256112c4, s101
    s_cmp_eq_u32 s24, 5
    s_cselect_b32 s101, 0x26653243, s101
    s_cmp_eq_u32 s24, 6
    s_cselect_b32 s101, 0x217d4382, s101
    s_cmp_eq_u32 s24, 7
    s_cselect_b32 s101, 0x24592286, s101
L_rd:
    s_and_b32 s3, s2, 7
    s_lshl_b32 s3, s3, 7
    s_bfe_u32 s31, s2, 196613
    s_lshl_b32 s31, s31, 4
    s_add_u32 s3, s3, s31
    s_and_b32 s31, s2, 8
    s_add_u32 s3, s3, s31
    s_and_b32 s31, s2, 16
    s_lshl_b32 s31, s31, 6
    s_add_u32 s3, s3, s31
    s_add_u32 s3, s3, 4096
    v_and_b32 v187, 255, v0
    v_lshl_add_u32 v187, v187, 11, s3
    s_waitcnt vmcnt(7)
    s_barrier
    ds_read_b128 v[144:147], v174
    ds_read_b128 v[148:151], v175
    ds_read_b128 v[152:155], v176
    ds_read_b128 v[156:159], v177
    ds_read_b128 v[160:163], v178
    s_waitcnt lgkmcnt(4)
    buffer_store_dwordx4 v[144:147], v188, s[52:55], 0 offen sc0 sc1
    s_waitcnt lgkmcnt(3)
    buffer_store_dwordx4 v[148:151], v189, s[52:55], 0 offen sc0 sc1
    s_waitcnt lgkmcnt(2)
    buffer_store_dwordx4 v[152:155], v190, s[52:55], 0 offen sc0 sc1
    s_waitcnt lgkmcnt(1)
    buffer_store_dwordx4 v[156:159], v191, s[52:55], 0 offen sc0 sc1
    s_waitcnt lgkmcnt(0)
    buffer_store_dwordx4 v[160:163], v192, s[52:55], 0 offen sc0 sc1
    s_add_u32 s12, s22, 8388608
    s_addc_u32 s13, s23, 0
    s_mov_b32 s14, 10485760
    s_mov_b32 s15, 0x00020000
    s_mov_b32 s16, s20
    s_mov_b32 s17, s21
    s_mov_b32 s18, 10240000
    s_mov_b32 s19, 0x00020000
    s_waitcnt vmcnt(0)
    s_barrier
    s_cmp_eq_u32 s24, 7
    s_cbranch_scc0 L_nopub
    global_store_dwordx4 v186, v[196:199], s[22:23] sc0 sc1
    global_store_dwordx4 v186, v[200:203], s[22:23] offset:1024 sc0 sc1
L_nopub:
    s_cmp_eq_u32 s27, 0
    s_cbranch_scc1 L_pfa
    s_sub_u32 s3, 0, s2
    s_and_b32 s3, s3, 7
    s_mul_i32 s3, s3, 1280000
    s_lshr_b32 s31, s2, 3
    s_mul_i32 s31, s31, 12800
    s_add_u32 s3, s3, s31
    s_add_u32 s3, s3, 0
    v_and_b32 v208, 255, v0
    v_cmp_gt_u32 vcc, 100, v208
    v_lshlrev_b32 v208, 7, v208
    v_mov_b32 v209, 0x7fffff00
    v_cndmask_b32 v208, v209, v208, vcc
    buffer_load_dword v210, v208, s[4:7], s3 offen
L_pfa:
    v_lshrrev_b32 v12, 5, v11
    v_and_b32 v13, 31, v11
    v_lshlrev_b32 v13, 2, v13
    v_lshl_add_u32 v12, v12, 11, v13
    ds_read_b32 v132, v12 offset:59136
    ds_read_b32 v133, v12 offset:59392
    ds_read_b32 v134, v12 offset:59648
    ds_read_b32 v135, v12 offset:59904
    ds_read_b32 v136, v12 offset:60160
    ds_read_b32 v137, v12 offset:60416
    ds_read_b32 v138, v12 offset:60672
    ds_read_b32 v139, v12 offset:60928
    s_waitcnt lgkmcnt(7)
    ds_read_b32 v140, v12 offset:59264
    ds_read_b32 v141, v12 offset:59520
    ds_read_b32 v142, v12 offset:59776
    ds_read_b32 v143, v12 offset:60032
    ds_read_b32 v144, v12 offset:60288
    ds_read_b32 v145, v12 offset:60544
    ds_read_b32 v146, v12 offset:60800
    ds_read_b32 v147, v12 offset:61056
    v_and_b32 v14, 3, v11
    v_bfe_u32 v15, v11, 2, 2
    v_lshlrev_b32 v15, 1, v15
    v_lshl_add_u32 v14, v14, 5, v15
    v_add_u32 v14, 162560, v14
    s_mov_b32 s68, 0xbfb8aa3b
    s_mov_b32 s69, s68
    s_mov_b32 s70, 0x05040100
    s_mov_b32 s71, 0x07060302
    s_and_b32 s3, s24, 3
    s_lshl_b32 s3, s3, 6
    v_lshrrev_b32 v16, 4, v11
    v_and_b32 v17, 15, v11
    v_lshl_add_u32 v17, v17, 2, s3
    v_lshl_add_u32 v16, v16, 11, v17
    s_waitcnt lgkmcnt(0)
    ds_read_u16 v18, v14 offset:0
    ds_read_u16 v19, v14 offset:8
    ds_read_u16 v20, v14 offset:16
    ds_read_u16 v21, v14 offset:24
    ds_read_b32 v148, v16 offset:26368
    ds_read_b32 v149, v16 offset:26624
    ds_read_b32 v150, v16 offset:26880
    ds_read_b32 v151, v16 offset:27136
    ds_read_b32 v152, v16 offset:27392
    ds_read_b32 v153, v16 offset:27648
    ds_read_b32 v154, v16 offset:27904
    ds_read_b32 v155, v16 offset:28160
    v_lshlrev_b32 v22, 16, v132
    v_lshlrev_b32 v23, 16, v133
    v_and_b32 v132, 0xffff0000, v132
    v_and_b32 v133, 0xffff0000, v133
    v_pk_mul_f32 v[22:23], v[22:23], s[68:69]
    v_pk_mul_f32 v[132:133], v[132:133], s[68:69]
    v_cvt_pk_bf16_f32 v36, v22, v23
    v_cvt_pk_bf16_f32 v44, v132, v133
    v_lshlrev_b32 v22, 16, v134
    v_lshlrev_b32 v23, 16, v135
    v_and_b32 v134, 0xffff0000, v134
    v_and_b32 v135, 0xffff0000, v135
    v_pk_mul_f32 v[22:23], v[22:23], s[68:69]
    v_pk_mul_f32 v[134:135], v[134:135], s[68:69]
    v_cvt_pk_bf16_f32 v37, v22, v23
    v_cvt_pk_bf16_f32 v45, v134, v135
    v_lshlrev_b32 v22, 16, v136
    v_lshlrev_b32 v23, 16, v137
    v_and_b32 v136, 0xffff0000, v136
    v_and_b32 v137, 0xffff0000, v137
    v_pk_mul_f32 v[22:23], v[22:23], s[68:69]
    v_pk_mul_f32 v[136:137], v[136:137], s[68:69]
    v_cvt_pk_bf16_f32 v38, v22, v23
    v_cvt_pk_bf16_f32 v46, v136, v137
    v_lshlrev_b32 v22, 16, v138
    v_lshlrev_b32 v23, 16, v139
    v_and_b32 v138, 0xffff0000, v138
    v_and_b32 v139, 0xffff0000, v139
    v_pk_mul_f32 v[22:23], v[22:23], s[68:69]
    v_pk_mul_f32 v[138:139], v[138:139], s[68:69]
    v_cvt_pk_bf16_f32 v39, v22, v23
    v_cvt_pk_bf16_f32 v47, v138, v139
    v_lshlrev_b32 v22, 16, v140
    v_lshlrev_b32 v23, 16, v141
    v_and_b32 v140, 0xffff0000, v140
    v_and_b32 v141, 0xffff0000, v141
    v_pk_mul_f32 v[22:23], v[22:23], s[68:69]
    v_pk_mul_f32 v[140:141], v[140:141], s[68:69]
    v_cvt_pk_bf16_f32 v40, v22, v23
    v_cvt_pk_bf16_f32 v48, v140, v141
    v_lshlrev_b32 v22, 16, v142
    v_lshlrev_b32 v23, 16, v143
    v_and_b32 v142, 0xffff0000, v142
    v_and_b32 v143, 0xffff0000, v143
    v_pk_mul_f32 v[22:23], v[22:23], s[68:69]
    v_pk_mul_f32 v[142:143], v[142:143], s[68:69]
    v_cvt_pk_bf16_f32 v41, v22, v23
    v_cvt_pk_bf16_f32 v49, v142, v143
    v_lshlrev_b32 v22, 16, v144
    v_lshlrev_b32 v23, 16, v145
    v_and_b32 v144, 0xffff0000, v144
    v_and_b32 v145, 0xffff0000, v145
    v_pk_mul_f32 v[22:23], v[22:23], s[68:69]
    v_pk_mul_f32 v[144:145], v[144:145], s[68:69]
    v_cvt_pk_bf16_f32 v42, v22, v23
    v_cvt_pk_bf16_f32 v50, v144, v145
    v_lshlrev_b32 v22, 16, v146
    v_lshlrev_b32 v23, 16, v147
    v_and_b32 v146, 0xffff0000, v146
    v_and_b32 v147, 0xffff0000, v147
    v_pk_mul_f32 v[22:23], v[22:23], s[68:69]
    v_pk_mul_f32 v[146:147], v[146:147], s[68:69]
    v_cvt_pk_bf16_f32 v43, v22, v23
    v_cvt_pk_bf16_f32 v51, v146, v147
    s_waitcnt lgkmcnt(0)
    v_lshl_or_b32 v228, v19, 16, v18
    v_lshl_or_b32 v229, v21, 16, v20
    ds_read_b32 v156, v16 offset:34560
    ds_read_b32 v157, v16 offset:34816
    ds_read_b32 v158, v16 offset:35072
    ds_read_b32 v159, v16 offset:35328
    ds_read_b32 v160, v16 offset:35584
    ds_read_b32 v161, v16 offset:35840
    ds_read_b32 v162, v16 offset:36096
    ds_read_b32 v163, v16 offset:36352
    v_perm_b32 v52, v149, v148, s70
    v_perm_b32 v56, v149, v148, s71
    v_perm_b32 v53, v151, v150, s70
    v_perm_b32 v57, v151, v150, s71
    v_perm_b32 v54, v153, v152, s70
    v_perm_b32 v58, v153, v152, s71
    v_perm_b32 v55, v155, v154, s70
    v_perm_b32 v59, v155, v154, s71
    s_waitcnt lgkmcnt(7)
    ds_read_b32 v148, v16 offset:42752
    ds_read_b32 v149, v16 offset:43008
    ds_read_b32 v150, v16 offset:43264
    ds_read_b32 v151, v16 offset:43520
    ds_read_b32 v152, v16 offset:43776
    ds_read_b32 v153, v16 offset:44032
    ds_read_b32 v154, v16 offset:44288
    ds_read_b32 v155, v16 offset:44544
    s_waitcnt lgkmcnt(8)
    v_perm_b32 v60, v157, v156, s70
    v_perm_b32 v64, v157, v156, s71
    v_perm_b32 v61, v159, v158, s70
    v_perm_b32 v65, v159, v158, s71
    v_perm_b32 v62, v161, v160, s70
    v_perm_b32 v66, v161, v160, s71
    v_perm_b32 v63, v163, v162, s70
    v_perm_b32 v67, v163, v162, s71
    s_waitcnt lgkmcnt(7)
    ds_read_b32 v156, v16 offset:50944
    ds_read_b32 v157, v16 offset:51200
    ds_read_b32 v158, v16 offset:51456
    ds_read_b32 v159, v16 offset:51712
    ds_read_b32 v160, v16 offset:51968
    ds_read_b32 v161, v16 offset:52224
    ds_read_b32 v162, v16 offset:52480
    ds_read_b32 v163, v16 offset:52736
    s_waitcnt lgkmcnt(8)
    v_perm_b32 v68, v149, v148, s70
    v_perm_b32 v72, v149, v148, s71
    v_perm_b32 v69, v151, v150, s70
    v_perm_b32 v73, v151, v150, s71
    v_perm_b32 v70, v153, v152, s70
    v_perm_b32 v74, v153, v152, s71
    v_perm_b32 v71, v155, v154, s70
    v_perm_b32 v75, v155, v154, s71
    s_waitcnt lgkmcnt(0)
    v_perm_b32 v76, v157, v156, s70
    v_perm_b32 v80, v157, v156, s71
    v_perm_b32 v77, v159, v158, s70
    v_perm_b32 v81, v159, v158, s71
    v_perm_b32 v78, v161, v160, s70
    v_perm_b32 v82, v161, v160, s71
    v_perm_b32 v79, v163, v162, s70
    v_perm_b32 v83, v163, v162, s71
    s_cmp_eq_u32 s27, 0
    s_cbranch_scc1 L_pfb
    s_sub_u32 s3, 0, s2
    s_and_b32 s3, s3, 7
    s_mul_i32 s3, s3, 1280000
    s_lshr_b32 s31, s2, 3
    s_mul_i32 s31, s31, 13824
    s_add_u32 s3, s3, s31
    s_add_u32 s3, s3, 409600
    v_and_b32 v208, 255, v0
    v_cmp_gt_u32 vcc, 108, v208
    v_lshlrev_b32 v208, 7, v208
    v_mov_b32 v209, 0x7fffff00
    v_cndmask_b32 v208, v209, v208, vcc
    buffer_load_dword v210, v208, s[4:7], s3 offen
L_pfb:
    s_cmp_eq_u32 s27, 0
    s_cbranch_scc0 L_round
    s_mov_b32 s3, 0
L_poll:
    global_load_dwordx2 v[206:207], v187, s[22:23] sc1
L_poll1:
    s_add_u32 s3, s3, 1
    s_waitcnt vmcnt(0)
    v_cmpx_ne_u32 vcc, s26, v207
    s_cbranch_execz L_pok
    s_cmp_lt_u32 s3, 400000
    s_cbranch_scc1 L_poll
    v_mov_b32 v206, 0
L_pok:
    s_mov_b64 exec, -1
    v_add_u32 v14, 161536, v194
    ds_write_b32 v14, v206
L_round:
    v_add_u32 v15, 161536, v1
    s_and_b32 s31, s24, 3
    v_mov_b32 v148, 0
    s_waitcnt lgkmcnt(0)
    s_barrier
    ds_read_b128 v[140:143], v15
    v_mul_u32_u24 v135, 12, v0
    v_add_u32 v136, 6144, v135
    v_add_u32 v137, 12288, v135
    s_waitcnt lgkmcnt(0)
    v_lshrrev_b32 v144, 19, v140
    v_lshrrev_b32 v145, 19, v141
    v_lshrrev_b32 v146, 19, v142
    v_lshrrev_b32 v147, 19, v143
    v_add_u32 v150, v144, v145
    v_add3_u32 v12, v150, v146, v147
    v_add_u32 v13, s28, v12
    v_mov_b32 v149, v144
    v_add_u32_dpp v12, v12, v12 row_shr:1 row_mask:0xf bank_mask:0xf
    v_add_u32 v151, v150, v146
    s_set_gpr_idx_on s31, gpr_idx(SRC0)
    v_mov_b32 v14, v140
    v_mov_b32 v15, v144
    v_mov_b32 v16, v148
    s_set_gpr_idx_off
    v_add_u32_dpp v12, v12, v12 row_shr:2 row_mask:0xf bank_mask:0xf
    v_and_b32 v14, 0x7ffff, v14
    v_sub_u32 v16, v16, v13
    v_add_u32_dpp v12, v12, v12 row_shr:4 row_mask:0xf bank_mask:0xf
    v_subrev_u32 v17, s27, v15
    s_mov_b32 s31, s27
    v_add_u32_dpp v12, v12, v12 row_shr:8 row_mask:0xf bank_mask:0xf
    s_nop 1
    v_add_u32_dpp v12, v12, v12 row_bcast:15 row_mask:0xa bank_mask:0xf
    s_nop 1
    v_add_u32_dpp v12, v12, v12 row_bcast:31 row_mask:0xc bank_mask:0xf
    v_add_u32 v16, v16, v12
    v_readlane_b32 s25, v12, 63
    v_sub_u32 v14, v14, v16
    v_add_lshl_u32 v18, v16, s27, 2
    s_cmp_gt_u32 s25, 1536
    s_cbranch_scc1 L_exp
    v_cmpx_lt_i32 vcc, 0, v17
    ds_write_b32 v18, v14 offset:20224
    v_cmpx_lt_i32 vcc, 2, v17
    ds_write_b32 v18, v14 offset:20232
    v_cmpx_lt_i32 vcc, 4, v17
    ds_write_b32 v18, v14 offset:20240
    v_cmpx_lt_i32 vcc, 6, v17
    ds_write_b32 v18, v14 offset:20248
    v_cmpx_lt_i32 vcc, 8, v17
    ds_write_b32 v18, v14 offset:20256
    v_cmpx_lt_i32 vcc, 10, v17
    ds_write_b32 v18, v14 offset:20264
    v_cmpx_lt_i32 vcc, 12, v17
    s_cbranch_execz L_expd
    s_add_u32 s31, s31, 12
L_exp:
    s_mov_b64 exec, -1
    v_cmp_lt_u32 vcc, s31, v15
    s_cbranch_vccz L_expd
    v_add_u32 v19, s31, v16
    s_movk_i32 s3, 1536
    v_cmp_gt_u32 s[68:69], s3, v19
    v_lshlrev_b32 v19, 2, v19
    s_and_b64 exec, vcc, s[68:69]
    ds_write_b32 v19, v14 offset:20224
    s_add_u32 s31, s31, 2
    s_branch L_exp
L_expd:
    s_mov_b64 exec, -1
    s_waitcnt lgkmcnt(0)
    s_barrier
    ds_read_b32 v12, v194 offset:20224
    ds_read_b32 v13, v194 offset:22272
    ds_read_b32 v14, v194 offset:24320
    ds_read_b32 v152, v195 offset:20224
    ds_read_b32 v153, v195 offset:21248
    ds_read_b32 v154, v195 offset:22272
    ds_read_b32 v155, v195 offset:23296
    ds_read_b32 v156, v195 offset:24320
    ds_read_b32 v157, v195 offset:25344
    s_waitcnt lgkmcnt(8)
    v_mad_i32_i24 v12, v12, 12, v135
    buffer_load_dwordx3 v[140:142], v12, s[8:11], 0 offen sc1
    s_waitcnt lgkmcnt(7)
    v_mad_i32_i24 v13, v13, 12, v136
    buffer_load_dwordx3 v[144:146], v13, s[8:11], 0 offen sc1
    s_waitcnt lgkmcnt(6)
    v_mad_i32_i24 v14, v14, 12, v137
    buffer_load_dwordx3 v[148:150], v14, s[8:11], 0 offen sc1
    s_waitcnt lgkmcnt(0)
    v_lshl_add_u32 v152, v152, 5, v188
    v_lshl_add_u32 v153, v153, 5, v189
    v_lshl_add_u32 v154, v154, 5, v190
    v_lshl_add_u32 v155, v155, 5, v191
    v_lshl_add_u32 v156, v156, 5, v192
    v_lshl_add_u32 v157, v157, 5, v193
    s_barrier
    s_add_u32 m0, s30, 63232
    s_nop 0
    buffer_load_dwordx4 v152, s[12:15], 0 offen sc1 lds
    s_add_u32 m0, s30, 71424
    s_nop 0
    buffer_load_dwordx4 v153, s[12:15], 0 offen sc1 lds
    s_sub_u32 s29, s25, s28
    s_min_u32 s29, s29, 1536
    s_lshl_b32 s3, s29, 4
    v_cmp_gt_u32 s[56:57], s3, v188
    v_lshlrev_b32 v159, 1, v188
    v_mov_b32 v143, 0
    v_cmp_gt_u32 s[58:59], s3, v189
    v_lshlrev_b32 v161, 1, v189
    v_mov_b32 v147, 0
    v_cmp_gt_u32 s[60:61], s3, v190
    v_lshlrev_b32 v163, 1, v190
    v_mov_b32 v151, 0
    v_and_b32 v4, 15, v11
    v_lshrrev_b32 v13, 4, v11
    s_mul_i32 s3, s27, 23040
    v_mul_u32_u24 v230, 288, v4
    v_lshl_add_u32 v230, v13, 4, v230
    v_add_u32 v230, s3, v230
    s_mul_i32 s68, s27, 5120
    s_add_u32 s68, s68, s2
    s_lshl_b32 s68, s68, 10
    s_and_b32 s3, s24, 3
    s_lshl_b32 s3, s3, 8
    s_add_u32 s68, s68, s3
    v_lshl_add_u32 v231, v13, 18, s68
    v_lshl_add_u32 v231, v4, 4, v231
    v_lshlrev_b32 v4, 3, v4
    v_bfe_u32 v5, v11, 3, 2
    v_and_b32 v12, 3, v11
    v_lshl_add_u32 v5, v5, 2, v12
    v_lshlrev_b32 v5, 3, v5
    v_lshrrev_b32 v6, 2, v11
    v_lshlrev_b32 v6, 3, v6
    v_mul_u32_u24 v16, 52, v11
    v_lshrrev_b32 v16, 8, v16
    v_mul_u32_u24 v17, 5, v16
    v_sub_u32 v17, v11, v17
    v_mul_u32_u24 v15, 6, v17
    v_bfe_u32 v15, s101, v15, 6
    v_lshlrev_b32 v15, 2, v15
    v_lshlrev_b32 v16, 2, v16
    v_lshlrev_b32 v17, 19, v17
    s_mul_i32 s3, s24, 5
    v_lshlrev_b32 v18, 2, v11
    v_add_u32 v21, s3, v11
    v_lshlrev_b32 v19, 2, v21
    v_cmp_gt_u32 vcc, 40, v11
    v_add_u32 v20, 1, v11
    v_add_u32 v21, 1, v21
    v_cndmask_b32 v20, 0, v20, vcc
    s_cmp_gt_u32 s25, 1536
    s_cselect_b32 s69, 0, 8
    v_mov_b32 v22, 8
    s_waitcnt vmcnt(4)
    s_mov_b64 exec, s[56:57]
    v_and_b32 v143, 0x3ff, v142
    v_lshrrev_b32 v12, 24, v142
    v_lshlrev_b32 v143, 2, v143
    ds_add_u32 v12, v22 offset:18688
    ds_add_rtn_u32 v132, v143, v22 offset:16128
    s_waitcnt vmcnt(3)
    s_mov_b64 exec, s[58:59]
    v_and_b32 v147, 0x3ff, v146
    v_lshrrev_b32 v13, 24, v146
    v_lshlrev_b32 v147, 2, v147
    ds_add_u32 v13, v22 offset:18688
    ds_add_rtn_u32 v133, v147, v22 offset:16128
    s_waitcnt vmcnt(2)
    s_mov_b64 exec, s[60:61]
    v_and_b32 v151, 0x3ff, v150
    v_lshrrev_b32 v14, 24, v150
    v_lshlrev_b32 v151, 2, v151
    ds_add_u32 v14, v22 offset:18688
    ds_add_rtn_u32 v134, v151, v22 offset:16128
    s_mov_b64 exec, -1
    s_add_u32 m0, s30, 79616
    s_nop 0
    buffer_load_dwordx4 v154, s[12:15], 0 offen sc1 lds
    v_mfma_f32_4x4x4_16b_bf16 v[164:167], v[228:229], v[140:141], 0 cbsz:4 abid:0
    v_mfma_f32_4x4x4_16b_bf16 v[168:171], v[228:229], v[140:141], 0 cbsz:4 abid:1
    v_mfma_f32_4x4x4_16b_bf16 v[172:175], v[228:229], v[140:141], 0 cbsz:4 abid:2
    v_mfma_f32_4x4x4_16b_bf16 v[176:179], v[228:229], v[140:141], 0 cbsz:4 abid:3
    v_add_u32 v23, 112384, v159
    s_nop 0
    v_cvt_pk_bf16_f32 v180, v164, v165
    v_cvt_pk_bf16_f32 v181, v166, v167
    v_cvt_pk_bf16_f32 v182, v168, v169
    v_cvt_pk_bf16_f32 v183, v170, v171
    v_cvt_pk_bf16_f32 v184, v172, v173
    v_cvt_pk_bf16_f32 v185, v174, v175
    v_cvt_pk_bf16_f32 v186, v176, v177
    v_cvt_pk_bf16_f32 v187, v178, v179
    s_waitcnt lgkmcnt(0)
    s_barrier
    ds_read_b32 v12, v18 offset:18688
    ds_read_b32 v13, v19 offset:18688
    ds_write_b128 v23, v[180:183]
    ds_write_b128 v23, v[184:187] offset:16
    v_lshlrev_b32 v19, 4, v19
    v_and_b32 v142, 0xfffc00, v142
    v_and_b32 v146, 0xfffc00, v146
    v_and_b32 v150, 0xfffc00, v150
    s_waitcnt lgkmcnt(2)
    v_mad_u32_u24 v21, v13, s69, v21
    v_mad_u32_u24 v20, v12, s69, v20
    v_readlane_b32 s96, v21, 0
    v_readlane_b32 s97, v21, 1
    v_readlane_b32 s98, v21, 2
    v_readlane_b32 s99, v21, 3
    v_readlane_b32 s100, v21, 4
    v_lshl_add_u32 v19, v13, 16, v19
    v_cmp_lt_u32 s[36:37], s96, v20
    v_cmp_lt_u32 s[38:39], s97, v20
    v_cmp_lt_u32 s[40:41], s98, v20
    v_cmp_lt_u32 s[42:43], s99, v20
    v_cmp_lt_u32 s[44:45], s100, v20
    s_bcnt1_i32_b64 s96, s[36:37]
    v_writelane_b32 v12, s96, 0
    s_bcnt1_i32_b64 s97, s[38:39]
    v_writelane_b32 v12, s97, 1
    s_bcnt1_i32_b64 s98, s[40:41]
    v_writelane_b32 v12, s98, 2
    s_bcnt1_i32_b64 s99, s[42:43]
    v_writelane_b32 v12, s99, 3
    s_bcnt1_i32_b64 s100, s[44:45]
    v_writelane_b32 v12, s100, 4
    s_mov_b64 exec, 31
    v_lshlrev_b32 v12, 2, v12
    ds_write_b32 v12, v19 offset:19200
    s_mov_b64 exec, -1
    s_add_u32 m0, s30, 87808
    s_nop 0
    buffer_load_dwordx4 v155, s[12:15], 0 offen sc1 lds
    s_waitcnt lgkmcnt(0)
    s_barrier
    ds_read_b32 v12, v15 offset:19200
    v_mfma_f32_4x4x4_16b_bf16 v[164:167], v[228:229], v[144:145], 0 cbsz:4 abid:0
    v_mfma_f32_4x4x4_16b_bf16 v[168:171], v[228:229], v[144:145], 0 cbsz:4 abid:1
    v_mfma_f32_4x4x4_16b_bf16 v[172:175], v[228:229], v[144:145], 0 cbsz:4 abid:2
    v_mfma_f32_4x4x4_16b_bf16 v[176:179], v[228:229], v[144:145], 0 cbsz:4 abid:3
    v_add_u32 v23, 112384, v161
    s_nop 0
    v_cvt_pk_bf16_f32 v180, v164, v165
    v_cvt_pk_bf16_f32 v181, v166, v167
    v_cvt_pk_bf16_f32 v182, v168, v169
    v_cvt_pk_bf16_f32 v183, v170, v171
    v_cvt_pk_bf16_f32 v184, v172, v173
    v_cvt_pk_bf16_f32 v185, v174, v175
    v_cvt_pk_bf16_f32 v186, v176, v177
    v_cvt_pk_bf16_f32 v187, v178, v179
    s_waitcnt lgkmcnt(0)
    v_add_u32_sdwa v16, v12, v16 dst_sel:DWORD dst_unused:UNUSED_PAD src0_sel:WORD_0 src1_sel:DWORD
    ds_read_b32 v13, v16 offset:16128
    v_readlane_b32 s96, v12, 0
    v_readlane_b32 s97, v12, 1
    v_readlane_b32 s98, v12, 2
    v_readlane_b32 s99, v12, 3
    v_readlane_b32 s100, v12, 4
    s_add_u32 s3, s96, s97
    s_add_u32 s3, s3, s98
    s_add_u32 s3, s3, s99
    s_add_u32 s3, s3, s100
    s_lshr_b32 s29, s3, 16
    s_add_u32 s3, s29, 480
    v_mov_b32 v14, s3
    v_mov_b32 v18, 0
    s_mov_b64 exec, 1
    ds_add_rtn_u32 v14, v18, v14 offset:19456
    s_mov_b64 exec, -1
    s_waitcnt lgkmcnt(1)
    v_sub_u32 v17, v17, v13
    s_nop 0
    v_add_u32_dpp v13, v13, v13 row_shr:1 row_mask:0xf bank_mask:0xf
    s_nop 1
    v_add_u32_dpp v13, v13, v13 row_shr:2 row_mask:0xf bank_mask:0xf
    v_mov_b32 v20, 2147482664
    v_mov_b32 v21, 0
    v_add_u32_dpp v13, v13, v13 row_shr:4 row_mask:0xf bank_mask:0xf
    s_nop 1
    v_add_u32_dpp v13, v13, v13 row_shr:8 row_mask:0xf bank_mask:0xf
    s_waitcnt lgkmcnt(0)
    v_readfirstlane_b32 s71, v14
    v_add_u32_dpp v13, v13, v13 row_bcast:15 row_mask:0xa bank_mask:0xf
    s_add_u32 s3, s71, s29
    v_lshl_add_u32 v18, v11, 3, s3
    v_add_u32_dpp v13, v13, v13 row_bcast:31 row_mask:0xc bank_mask:0xf
    s_mov_b32 exec_hi, 0x0fffffff
    v_add3_u32 v13, v13, v17, s71
    ds_write_b32 v16, v13 offset:16128
    ds_write_b64 v18, v[20:21] offset:0
    s_mov_b64 exec, -1
    ds_write_b128 v23, v[180:183]
    ds_write_b128 v23, v[184:187] offset:16
    s_add_u32 m0, s30, 96000
    s_nop 0
    buffer_load_dwordx4 v156, s[12:15], 0 offen sc1 lds
    s_waitcnt lgkmcnt(2)
    s_barrier
    ds_read_b32 v12, v143 offset:16128
    ds_read_b32 v13, v147 offset:16128
    ds_read_b32 v14, v151 offset:16128
    v_add_u32 v4, s71, v4
    v_add_u32 v5, s71, v5
    v_add_u32 v6, s71, v6
    s_lshr_b32 s29, s29, 3
    s_mov_b64 exec, s[56:57]
    s_waitcnt lgkmcnt(2)
    v_add_u32_sdwa v132, v12, v132 dst_sel:DWORD dst_unused:UNUSED_PAD src0_sel:WORD_0 src1_sel:DWORD
    v_or_b32_sdwa v158, v12, v142 dst_sel:DWORD dst_unused:UNUSED_PAD src0_sel:WORD_1 src1_sel:DWORD
    ds_write_b64 v132, v[158:159] offset:0
    s_mov_b64 exec, s[58:59]
    s_waitcnt lgkmcnt(2)
    v_add_u32_sdwa v133, v13, v133 dst_sel:DWORD dst_unused:UNUSED_PAD src0_sel:WORD_0 src1_sel:DWORD
    v_or_b32_sdwa v160, v13, v146 dst_sel:DWORD dst_unused:UNUSED_PAD src0_sel:WORD_1 src1_sel:DWORD
    ds_write_b64 v133, v[160:161] offset:0
    s_mov_b64 exec, s[60:61]
    s_waitcnt lgkmcnt(2)
    v_add_u32_sdwa v134, v14, v134 dst_sel:DWORD dst_unused:UNUSED_PAD src0_sel:WORD_0 src1_sel:DWORD
    v_or_b32_sdwa v162, v14, v150 dst_sel:DWORD dst_unused:UNUSED_PAD src0_sel:WORD_1 src1_sel:DWORD
    ds_write_b64 v134, v[162:163] offset:0
    s_mov_b64 exec, -1
    s_add_u32 m0, s30, 104192
    s_nop 0
    buffer_load_dwordx4 v157, s[12:15], 0 offen sc1 lds
    s_waitcnt lgkmcnt(0)
    s_barrier
    ds_read_b32 v12, v4
    ds_read_b32 v7, v4 offset:64
    ds_read_b32 v9, v5 offset:4
    ds_read_b32 v10, v6 offset:4
    s_cmp_eq_u64 s[60:61], 0
    s_cbranch_scc1 L_not3
    v_mfma_f32_4x4x4_16b_bf16 v[164:167], v[228:229], v[148:149], 0 cbsz:4 abid:0
    v_mfma_f32_4x4x4_16b_bf16 v[168:171], v[228:229], v[148:149], 0 cbsz:4 abid:1
    v_mfma_f32_4x4x4_16b_bf16 v[172:175], v[228:229], v[148:149], 0 cbsz:4 abid:2
    v_mfma_f32_4x4x4_16b_bf16 v[176:179], v[228:229], v[148:149], 0 cbsz:4 abid:3
    v_add_u32 v23, 112384, v163
    s_nop 0
    v_cvt_pk_bf16_f32 v180, v164, v165
    v_cvt_pk_bf16_f32 v181, v166, v167
    v_cvt_pk_bf16_f32 v182, v168, v169
    v_cvt_pk_bf16_f32 v183, v170, v171
    v_cvt_pk_bf16_f32 v184, v172, v173
    v_cvt_pk_bf16_f32 v185, v174, v175
    v_cvt_pk_bf16_f32 v186, v176, v177
    v_cvt_pk_bf16_f32 v187, v178, v179
    ds_write_b128 v23, v[180:183]
    ds_write_b128 v23, v[184:187] offset:16
    s_waitcnt lgkmcnt(2)
    s_branch L_t3
L_not3:
    s_waitcnt lgkmcnt(0)
L_t3:
    v_readlane_b32 s36, v12, 0
    v_readlane_b32 s37, v12, 1
    v_readlane_b32 s38, v12, 2
    v_readlane_b32 s39, v12, 3
    s_and_b32 s70, s36, 0xfffffc00
    buffer_load_dwordx4 v[196:199], v1, s[4:7], s70 offen
    s_and_b32 s71, s37, 0xfffffc00
    buffer_load_dwordx4 v[200:203], v1, s[4:7], s71 offen
    s_and_b32 s70, s38, 0xfffffc00
    buffer_load_dwordx4 v[204:207], v1, s[4:7], s70 offen
    s_and_b32 s71, s39, 0xfffffc00
    buffer_load_dwordx4 v[208:211], v1, s[4:7], s71 offen
    v_readlane_b32 s40, v12, 4
    v_readlane_b32 s41, v12, 5
    v_readlane_b32 s42, v12, 6
    v_readlane_b32 s43, v12, 7
    v_add_u32 v9, v9, v2
    v_add_u32 v10, v10, v3
    v_readlane_b32 s44, v7, 0
    s_and_b32 s96, s96, 0xffff
    s_mulk_i32 s96, 18
    s_and_b32 s97, s97, 0xffff
    s_mulk_i32 s97, 18
    s_and_b32 s98, s98, 0xffff
    s_mulk_i32 s98, 18
    s_and_b32 s99, s99, 0xffff
    s_mulk_i32 s99, 18
    s_and_b32 s100, s100, 0xffff
    s_mulk_i32 s100, 18
    s_and_b32 s68, s44, 0xfffffc00
    s_waitcnt vmcnt(4) lgkmcnt(0)
    s_barrier
    s_cmp_eq_u32 s29, 0
    s_cbranch_scc1 L_exit
    s_sub_u32 s29, s29, 1
    s_mov_b64 exec, s[32:33]
    ds_read_b128 v[24:27], v9 offset:63232
    s_mov_b64 exec, s[34:35]
    ds_read_b128 v[28:31], v9 offset:63232
    s_mov_b64 exec, -1
    ds_read_b64 v[32:33], v10
    s_and_b32 s70, s40, 0xfffffc00
    buffer_load_dwordx4 v[212:215], v1, s[4:7], s70 offen
    s_and_b32 s71, s41, 0xfffffc00
    buffer_load_dwordx4 v[216:219], v1, s[4:7], s71 offen
    s_waitcnt lgkmcnt(1)
    v_mfma_f32_32x32x16_bf16 v[132:147], v[24:27], v[36:39], 0
    v_mfma_f32_32x32x16_bf16 v[132:147], v[28:31], v[40:43], v[132:147]
    v_mfma_f32_32x32x16_bf16 v[148:163], v[24:27], v[44:47], 0
    v_mfma_f32_32x32x16_bf16 v[148:163], v[28:31], v[48:51], v[148:163]
    s_and_b32 s70, s42, 0xfffffc00
    buffer_load_dwordx4 v[220:223], v1, s[4:7], s70 offen
    s_and_b32 s71, s43, 0xfffffc00
    buffer_load_dwordx4 v[224:227], v1, s[4:7], s71 offen
    s_waitcnt lgkmcnt(0)
    s_nop 6
    v_exp_f32 v12, v132
    v_exp_f32 v13, v133
    v_exp_f32 v14, v148
    v_exp_f32 v15, v149
    v_pk_add_f32 v[12:13], v[12:13], 1.0 op_sel_hi:[1,0]
    v_pk_add_f32 v[14:15], v[14:15], 1.0 op_sel_hi:[1,0]
    v_rcp_f32 v12, v12
    v_rcp_f32 v13, v13
    s_nop 0
    v_pk_mul_f32 v[132:133], v[132:133], v[12:13]
L_loop:
    s_setprio 3
    ds_read_b32 v9, v5 offset:132
    ds_read_b32 v10, v6 offset:132
    ds_read_b32 v8, v4 offset:192
    s_waitcnt vmcnt(7)
    v_rcp_f32 v14, v14
    v_mfma_f32_4x4x4_16b_bf16 v[16:19], v[32:33], v[196:197], 0 cbsz:4 abid:0
    v_exp_f32 v13, v135
    v_mfma_f32_4x4x4_16b_bf16 v[20:23], v[32:33], v[198:199], 0 cbsz:4 abid:0
    v_exp_f32 v12, v134
    v_readlane_b32 s45, v7, 1
    v_rcp_f32 v15, v15
    v_pk_add_f32 v[12:13], v[12:13], 1.0 op_sel_hi:[1,0]
    v_pk_mul_f32 v[148:149], v[148:149], v[14:15]
    s_and_b32 s69, s45, 0xfffffc00
    s_set_gpr_idx_on s36, gpr_idx(SRC2,DST)
    buffer_load_dwordx4 v[196:199], v1, s[4:7], s68 offen
    v_pk_fma_f32 v[84:85], v[132:133], v[16:17], v[84:85] op_sel_hi:[0,1,1]
    v_pk_fma_f32 v[86:87], v[132:133], v[18:19], v[86:87] op_sel_hi:[0,1,1]
    v_pk_fma_f32 v[88:89], v[148:149], v[20:21], v[88:89] op_sel_hi:[0,1,1]
    v_pk_fma_f32 v[90:91], v[148:149], v[22:23], v[90:91] op_sel_hi:[0,1,1]
    s_set_gpr_idx_off
    s_waitcnt vmcnt(7)
    v_rcp_f32 v12, v12
    v_mfma_f32_4x4x4_16b_bf16 v[16:19], v[32:33], v[200:201], 0 cbsz:4 abid:1
    v_exp_f32 v15, v151
    v_mfma_f32_4x4x4_16b_bf16 v[20:23], v[32:33], v[202:203], 0 cbsz:4 abid:1
    v_exp_f32 v14, v150
    v_readlane_b32 s46, v7, 2
    v_rcp_f32 v13, v13
    v_pk_add_f32 v[14:15], v[14:15], 1.0 op_sel_hi:[1,0]
    v_pk_mul_f32 v[134:135], v[134:135], v[12:13]
    s_and_b32 s68, s46, 0xfffffc00
    s_set_gpr_idx_on s37, gpr_idx(SRC2,DST)
    buffer_load_dwordx4 v[200:203], v1, s[4:7], s69 offen
    v_pk_fma_f32 v[84:85], v[132:133], v[16:17], v[84:85] op_sel:[1,0,0]
    v_pk_fma_f32 v[86:87], v[132:133], v[18:19], v[86:87] op_sel:[1,0,0]
    v_pk_fma_f32 v[88:89], v[148:149], v[20:21], v[88:89] op_sel:[1,0,0]
    v_pk_fma_f32 v[90:91], v[148:149], v[22:23], v[90:91] op_sel:[1,0,0]
    s_set_gpr_idx_off
    s_waitcnt lgkmcnt(0)
    v_add_u32 v9, v9, v2
    v_add_u32 v10, v10, v3
    s_mov_b64 exec, s[32:33]
    ds_read_b128 v[24:27], v9 offset:63232
    s_mov_b64 exec, s[34:35]
    ds_read_b128 v[28:31], v9 offset:63232
    s_mov_b64 exec, -1
    ds_read_b64 v[34:35], v10
    s_waitcnt vmcnt(7)
    v_rcp_f32 v14, v14
    v_mfma_f32_4x4x4_16b_bf16 v[16:19], v[32:33], v[204:205], 0 cbsz:4 abid:2
    v_exp_f32 v13, v137
    v_mfma_f32_4x4x4_16b_bf16 v[20:23], v[32:33], v[206:207], 0 cbsz:4 abid:2
    v_exp_f32 v12, v136
    v_readlane_b32 s47, v7, 3
    v_rcp_f32 v15, v15
    v_pk_add_f32 v[12:13], v[12:13], 1.0 op_sel_hi:[1,0]
    v_pk_mul_f32 v[150:151], v[150:151], v[14:15]
    s_and_b32 s69, s47, 0xfffffc00
    s_set_gpr_idx_on s38, gpr_idx(SRC2,DST)
    buffer_load_dwordx4 v[204:207], v1, s[4:7], s68 offen
    v_pk_fma_f32 v[84:85], v[134:135], v[16:17], v[84:85] op_sel_hi:[0,1,1]
    v_pk_fma_f32 v[86:87], v[134:135], v[18:19], v[86:87] op_sel_hi:[0,1,1]
    v_pk_fma_f32 v[88:89], v[150:151], v[20:21], v[88:89] op_sel_hi:[0,1,1]
    v_pk_fma_f32 v[90:91], v[150:151], v[22:23], v[90:91] op_sel_hi:[0,1,1]
    s_set_gpr_idx_off
    s_waitcnt vmcnt(7)
    v_rcp_f32 v12, v12
    v_mfma_f32_4x4x4_16b_bf16 v[16:19], v[32:33], v[208:209], 0 cbsz:4 abid:3
    v_exp_f32 v15, v153
    v_mfma_f32_4x4x4_16b_bf16 v[20:23], v[32:33], v[210:211], 0 cbsz:4 abid:3
    v_exp_f32 v14, v152
    v_readlane_b32 s48, v7, 4
    v_rcp_f32 v13, v13
    v_pk_add_f32 v[14:15], v[14:15], 1.0 op_sel_hi:[1,0]
    v_pk_mul_f32 v[136:137], v[136:137], v[12:13]
    s_and_b32 s68, s48, 0xfffffc00
    s_set_gpr_idx_on s39, gpr_idx(SRC2,DST)
    buffer_load_dwordx4 v[208:211], v1, s[4:7], s69 offen
    v_pk_fma_f32 v[84:85], v[134:135], v[16:17], v[84:85] op_sel:[1,0,0]
    v_pk_fma_f32 v[86:87], v[134:135], v[18:19], v[86:87] op_sel:[1,0,0]
    v_pk_fma_f32 v[88:89], v[150:151], v[20:21], v[88:89] op_sel:[1,0,0]
    v_pk_fma_f32 v[90:91], v[150:151], v[22:23], v[90:91] op_sel:[1,0,0]
    s_set_gpr_idx_off
    s_sub_u32 s29, s29, 4
    s_cbranch_scc1 L_exit
    s_setprio 2
    s_waitcnt vmcnt(7)
    v_rcp_f32 v14, v14
    v_mfma_f32_4x4x4_16b_bf16 v[16:19], v[32:33], v[212:213], 0 cbsz:4 abid:4
    v_exp_f32 v13, v139
    v_mfma_f32_4x4x4_16b_bf16 v[20:23], v[32:33], v[214:215], 0 cbsz:4 abid:4
    v_exp_f32 v12, v138
    v_readlane_b32 s49, v7, 5
    v_rcp_f32 v15, v15
    v_pk_add_f32 v[12:13], v[12:13], 1.0 op_sel_hi:[1,0]
    v_pk_mul_f32 v[152:153], v[152:153], v[14:15]
    s_and_b32 s69, s49, 0xfffffc00
    s_set_gpr_idx_on s40, gpr_idx(SRC2,DST)
    buffer_load_dwordx4 v[212:215], v1, s[4:7], s68 offen
    v_pk_fma_f32 v[84:85], v[136:137], v[16:17], v[84:85] op_sel_hi:[0,1,1]
    v_pk_fma_f32 v[86:87], v[136:137], v[18:19], v[86:87] op_sel_hi:[0,1,1]
    v_pk_fma_f32 v[88:89], v[152:153], v[20:21], v[88:89] op_sel_hi:[0,1,1]
    v_pk_fma_f32 v[90:91], v[152:153], v[22:23], v[90:91] op_sel_hi:[0,1,1]
    s_set_gpr_idx_off
    s_waitcnt vmcnt(7) lgkmcnt(0)
    v_mfma_f32_4x4x4_16b_bf16 v[20:23], v[32:33], v[218:219], 0 cbsz:4 abid:5
    v_mfma_f32_4x4x4_16b_bf16 v[16:19], v[32:33], v[216:217], 0 cbsz:4 abid:5
    v_rcp_f32 v13, v13
    v_mfma_f32_32x32x16_bf16 v[164:179], v[24:27], v[36:39], 0
    v_exp_f32 v14, v154
    v_exp_f32 v15, v155
    v_readlane_b32 s50, v7, 6
    v_rcp_f32 v12, v12
    v_pk_add_f32 v[14:15], v[14:15], 1.0 op_sel_hi:[1,0]
    v_pk_mul_f32 v[138:139], v[138:139], v[12:13]
    s_and_b32 s68, s50, 0xfffffc00
    s_set_gpr_idx_on s41, gpr_idx(SRC2,DST)
    buffer_load_dwordx4 v[216:219], v1, s[4:7], s69 offen
    v_pk_fma_f32 v[84:85], v[136:137], v[16:17], v[84:85] op_sel:[1,0,0]
    v_pk_fma_f32 v[86:87], v[136:137], v[18:19], v[86:87] op_sel:[1,0,0]
    v_pk_fma_f32 v[88:89], v[152:153], v[20:21], v[88:89] op_sel:[1,0,0]
    v_pk_fma_f32 v[90:91], v[152:153], v[22:23], v[90:91] op_sel:[1,0,0]
    s_set_gpr_idx_off
    s_waitcnt vmcnt(7)
    v_rcp_f32 v14, v14
    v_mfma_f32_4x4x4_16b_bf16 v[16:19], v[32:33], v[220:221], 0 cbsz:4 abid:6
    v_exp_f32 v13, v141
    v_mfma_f32_4x4x4_16b_bf16 v[20:23], v[32:33], v[222:223], 0 cbsz:4 abid:6
    v_exp_f32 v12, v140
    v_readlane_b32 s51, v7, 7
    v_rcp_f32 v15, v15
    v_pk_add_f32 v[12:13], v[12:13], 1.0 op_sel_hi:[1,0]
    v_pk_mul_f32 v[154:155], v[154:155], v[14:15]
    s_and_b32 s69, s51, 0xfffffc00
    s_set_gpr_idx_on s42, gpr_idx(SRC2,DST)
    buffer_load_dwordx4 v[220:223], v1, s[4:7], s68 offen
    v_pk_fma_f32 v[84:85], v[138:139], v[16:17], v[84:85] op_sel_hi:[0,1,1]
    v_pk_fma_f32 v[86:87], v[138:139], v[18:19], v[86:87] op_sel_hi:[0,1,1]
    v_pk_fma_f32 v[88:89], v[154:155], v[20:21], v[88:89] op_sel_hi:[0,1,1]
    v_pk_fma_f32 v[90:91], v[154:155], v[22:23], v[90:91] op_sel_hi:[0,1,1]
    s_set_gpr_idx_off
    s_waitcnt vmcnt(7)
    v_mfma_f32_4x4x4_16b_bf16 v[20:23], v[32:33], v[226:227], 0 cbsz:4 abid:7
    v_mfma_f32_4x4x4_16b_bf16 v[16:19], v[32:33], v[224:225], 0 cbsz:4 abid:7
    v_rcp_f32 v13, v13
    v_mfma_f32_32x32x16_bf16 v[164:179], v[28:31], v[40:43], v[164:179]
    v_exp_f32 v14, v156
    v_exp_f32 v15, v157
    v_readlane_b32 s52, v7, 8
    v_rcp_f32 v12, v12
    v_pk_add_f32 v[14:15], v[14:15], 1.0 op_sel_hi:[1,0]
    v_pk_mul_f32 v[140:141], v[140:141], v[12:13]
    s_and_b32 s68, s52, 0xfffffc00
    s_set_gpr_idx_on s43, gpr_idx(SRC2,DST)
    buffer_load_dwordx4 v[224:227], v1, s[4:7], s69 offen
    v_pk_fma_f32 v[84:85], v[138:139], v[16:17], v[84:85] op_sel:[1,0,0]
    v_pk_fma_f32 v[86:87], v[138:139], v[18:19], v[86:87] op_sel:[1,0,0]
    v_pk_fma_f32 v[88:89], v[154:155], v[20:21], v[88:89] op_sel:[1,0,0]
    v_pk_fma_f32 v[90:91], v[154:155], v[22:23], v[90:91] op_sel:[1,0,0]
    s_set_gpr_idx_off
    s_sub_u32 s29, s29, 4
    s_cbranch_scc1 L_exit
    s_setprio 1
    s_waitcnt vmcnt(7)
    v_rcp_f32 v14, v14
    v_mfma_f32_4x4x4_16b_bf16 v[16:19], v[32:33], v[196:197], 0 cbsz:4 abid:8
    v_exp_f32 v13, v143
    v_mfma_f32_4x4x4_16b_bf16 v[20:23], v[32:33], v[198:199], 0 cbsz:4 abid:8
    v_exp_f32 v12, v142
    v_readlane_b32 s53, v7, 9
    v_rcp_f32 v15, v15
    v_pk_add_f32 v[12:13], v[12:13], 1.0 op_sel_hi:[1,0]
    v_pk_mul_f32 v[156:157], v[156:157], v[14:15]
    s_and_b32 s69, s53, 0xfffffc00
    s_set_gpr_idx_on s44, gpr_idx(SRC2,DST)
    buffer_load_dwordx4 v[196:199], v1, s[4:7], s68 offen
    v_pk_fma_f32 v[84:85], v[140:141], v[16:17], v[84:85] op_sel_hi:[0,1,1]
    v_pk_fma_f32 v[86:87], v[140:141], v[18:19], v[86:87] op_sel_hi:[0,1,1]
    v_pk_fma_f32 v[88:89], v[156:157], v[20:21], v[88:89] op_sel_hi:[0,1,1]
    v_pk_fma_f32 v[90:91], v[156:157], v[22:23], v[90:91] op_sel_hi:[0,1,1]
    s_set_gpr_idx_off
    s_waitcnt vmcnt(7)
    v_mfma_f32_4x4x4_16b_bf16 v[20:23], v[32:33], v[202:203], 0 cbsz:4 abid:9
    v_mfma_f32_4x4x4_16b_bf16 v[16:19], v[32:33], v[200:201], 0 cbsz:4 abid:9
    v_rcp_f32 v13, v13
    v_mfma_f32_32x32x16_bf16 v[180:195], v[24:27], v[44:47], 0
    v_exp_f32 v14, v158
    v_exp_f32 v15, v159
    v_readlane_b32 s54, v7, 10
    v_rcp_f32 v12, v12
    v_pk_add_f32 v[14:15], v[14:15], 1.0 op_sel_hi:[1,0]
    v_pk_mul_f32 v[142:143], v[142:143], v[12:13]
    s_and_b32 s68, s54, 0xfffffc00
    s_set_gpr_idx_on s45, gpr_idx(SRC2,DST)
    buffer_load_dwordx4 v[200:203], v1, s[4:7], s69 offen
    v_pk_fma_f32 v[84:85], v[140:141], v[16:17], v[84:85] op_sel:[1,0,0]
    v_pk_fma_f32 v[86:87], v[140:141], v[18:19], v[86:87] op_sel:[1,0,0]
    v_pk_fma_f32 v[88:89], v[156:157], v[20:21], v[88:89] op_sel:[1,0,0]
    v_pk_fma_f32 v[90:91], v[156:157], v[22:23], v[90:91] op_sel:[1,0,0]
    s_set_gpr_idx_off
    s_waitcnt vmcnt(7)
    v_rcp_f32 v14, v14
    v_mfma_f32_4x4x4_16b_bf16 v[16:19], v[32:33], v[204:205], 0 cbsz:4 abid:10
    v_exp_f32 v13, v145
    v_mfma_f32_4x4x4_16b_bf16 v[20:23], v[32:33], v[206:207], 0 cbsz:4 abid:10
    v_exp_f32 v12, v144
    v_readlane_b32 s55, v7, 11
    v_rcp_f32 v15, v15
    v_pk_add_f32 v[12:13], v[12:13], 1.0 op_sel_hi:[1,0]
    v_pk_mul_f32 v[158:159], v[158:159], v[14:15]
    s_and_b32 s69, s55, 0xfffffc00
    s_set_gpr_idx_on s46, gpr_idx(SRC2,DST)
    buffer_load_dwordx4 v[204:207], v1, s[4:7], s68 offen
    v_pk_fma_f32 v[84:85], v[142:143], v[16:17], v[84:85] op_sel_hi:[0,1,1]
    v_pk_fma_f32 v[86:87], v[142:143], v[18:19], v[86:87] op_sel_hi:[0,1,1]
    v_pk_fma_f32 v[88:89], v[158:159], v[20:21], v[88:89] op_sel_hi:[0,1,1]
    v_pk_fma_f32 v[90:91], v[158:159], v[22:23], v[90:91] op_sel_hi:[0,1,1]
    s_set_gpr_idx_off
    s_waitcnt vmcnt(7)
    v_mfma_f32_4x4x4_16b_bf16 v[20:23], v[32:33], v[210:211], 0 cbsz:4 abid:11
    v_mfma_f32_4x4x4_16b_bf16 v[16:19], v[32:33], v[208:209], 0 cbsz:4 abid:11
    v_rcp_f32 v13, v13
    v_mfma_f32_32x32x16_bf16 v[180:195], v[28:31], v[48:51], v[180:195]
    v_exp_f32 v14, v160
    v_exp_f32 v15, v161
    v_readlane_b32 s56, v7, 12
    v_rcp_f32 v12, v12
    v_pk_add_f32 v[14:15], v[14:15], 1.0 op_sel_hi:[1,0]
    v_pk_mul_f32 v[144:145], v[144:145], v[12:13]
    s_and_b32 s68, s56, 0xfffffc00
    s_set_gpr_idx_on s47, gpr_idx(SRC2,DST)
    buffer_load_dwordx4 v[208:211], v1, s[4:7], s69 offen
    v_pk_fma_f32 v[84:85], v[142:143], v[16:17], v[84:85] op_sel:[1,0,0]
    v_pk_fma_f32 v[86:87], v[142:143], v[18:19], v[86:87] op_sel:[1,0,0]
    v_pk_fma_f32 v[88:89], v[158:159], v[20:21], v[88:89] op_sel:[1,0,0]
    v_pk_fma_f32 v[90:91], v[158:159], v[22:23], v[90:91] op_sel:[1,0,0]
    s_set_gpr_idx_off
    s_sub_u32 s29, s29, 4
    s_cbranch_scc1 L_exit
    s_setprio 0
    s_waitcnt vmcnt(7)
    v_rcp_f32 v14, v14
    v_mfma_f32_4x4x4_16b_bf16 v[16:19], v[32:33], v[212:213], 0 cbsz:4 abid:12
    v_exp_f32 v13, v147
    v_mfma_f32_4x4x4_16b_bf16 v[20:23], v[32:33], v[214:215], 0 cbsz:4 abid:12
    v_exp_f32 v12, v146
    v_readlane_b32 s57, v7, 13
    v_rcp_f32 v15, v15
    v_pk_add_f32 v[12:13], v[12:13], 1.0 op_sel_hi:[1,0]
    v_pk_mul_f32 v[160:161], v[160:161], v[14:15]
    s_and_b32 s69, s57, 0xfffffc00
    s_set_gpr_idx_on s48, gpr_idx(SRC2,DST)
    buffer_load_dwordx4 v[212:215], v1, s[4:7], s68 offen
    v_pk_fma_f32 v[84:85], v[144:145], v[16:17], v[84:85] op_sel_hi:[0,1,1]
    v_pk_fma_f32 v[86:87], v[144:145], v[18:19], v[86:87] op_sel_hi:[0,1,1]
    v_pk_fma_f32 v[88:89], v[160:161], v[20:21], v[88:89] op_sel_hi:[0,1,1]
    v_pk_fma_f32 v[90:91], v[160:161], v[22:23], v[90:91] op_sel_hi:[0,1,1]
    s_set_gpr_idx_off
    s_waitcnt vmcnt(7)
    v_rcp_f32 v12, v12
    v_mfma_f32_4x4x4_16b_bf16 v[16:19], v[32:33], v[216:217], 0 cbsz:4 abid:13
    v_exp_f32 v15, v163
    v_mfma_f32_4x4x4_16b_bf16 v[20:23], v[32:33], v[218:219], 0 cbsz:4 abid:13
    v_exp_f32 v14, v162
    v_readlane_b32 s58, v7, 14
    v_rcp_f32 v13, v13
    v_pk_add_f32 v[14:15], v[14:15], 1.0 op_sel_hi:[1,0]
    v_pk_mul_f32 v[146:147], v[146:147], v[12:13]
    s_and_b32 s68, s58, 0xfffffc00
    s_set_gpr_idx_on s49, gpr_idx(SRC2,DST)
    buffer_load_dwordx4 v[216:219], v1, s[4:7], s69 offen
    v_pk_fma_f32 v[84:85], v[144:145], v[16:17], v[84:85] op_sel:[1,0,0]
    v_pk_fma_f32 v[86:87], v[144:145], v[18:19], v[86:87] op_sel:[1,0,0]
    v_pk_fma_f32 v[88:89], v[160:161], v[20:21], v[88:89] op_sel:[1,0,0]
    v_pk_fma_f32 v[90:91], v[160:161], v[22:23], v[90:91] op_sel:[1,0,0]
    s_set_gpr_idx_off
    s_waitcnt vmcnt(7)
    v_rcp_f32 v14, v14
    v_mfma_f32_4x4x4_16b_bf16 v[16:19], v[32:33], v[220:221], 0 cbsz:4 abid:14
    v_exp_f32 v13, v165
    v_mfma_f32_4x4x4_16b_bf16 v[20:23], v[32:33], v[222:223], 0 cbsz:4 abid:14
    v_exp_f32 v12, v164
    v_readlane_b32 s59, v7, 15
    v_rcp_f32 v15, v15
    v_pk_add_f32 v[12:13], v[12:13], 1.0 op_sel_hi:[1,0]
    v_pk_mul_f32 v[162:163], v[162:163], v[14:15]
    s_and_b32 s69, s59, 0xfffffc00
    s_set_gpr_idx_on s50, gpr_idx(SRC2,DST)
    buffer_load_dwordx4 v[220:223], v1, s[4:7], s68 offen
    v_pk_fma_f32 v[84:85], v[146:147], v[16:17], v[84:85] op_sel_hi:[0,1,1]
    v_pk_fma_f32 v[86:87], v[146:147], v[18:19], v[86:87] op_sel_hi:[0,1,1]
    v_pk_fma_f32 v[88:89], v[162:163], v[20:21], v[88:89] op_sel_hi:[0,1,1]
    v_pk_fma_f32 v[90:91], v[162:163], v[22:23], v[90:91] op_sel_hi:[0,1,1]
    s_set_gpr_idx_off
    s_waitcnt vmcnt(7)
    v_rcp_f32 v12, v12
    v_mfma_f32_4x4x4_16b_bf16 v[16:19], v[32:33], v[224:225], 0 cbsz:4 abid:15
    v_exp_f32 v15, v181
    v_mfma_f32_4x4x4_16b_bf16 v[20:23], v[32:33], v[226:227], 0 cbsz:4 abid:15
    v_exp_f32 v14, v180
    v_readlane_b32 s60, v8, 0
    v_rcp_f32 v13, v13
    v_pk_add_f32 v[14:15], v[14:15], 1.0 op_sel_hi:[1,0]
    v_pk_mul_f32 v[164:165], v[164:165], v[12:13]
    s_and_b32 s68, s60, 0xfffffc00
    s_set_gpr_idx_on s51, gpr_idx(SRC2,DST)
    buffer_load_dwordx4 v[224:227], v1, s[4:7], s69 offen
    v_pk_fma_f32 v[84:85], v[146:147], v[16:17], v[84:85] op_sel:[1,0,0]
    v_pk_fma_f32 v[86:87], v[146:147], v[18:19], v[86:87] op_sel:[1,0,0]
    v_pk_fma_f32 v[88:89], v[162:163], v[20:21], v[88:89] op_sel:[1,0,0]
    v_pk_fma_f32 v[90:91], v[162:163], v[22:23], v[90:91] op_sel:[1,0,0]
    s_set_gpr_idx_off
    s_sub_u32 s29, s29, 4
    s_cbranch_scc1 L_exit
    s_setprio 3
    ds_read_b32 v9, v5 offset:260
    ds_read_b32 v10, v6 offset:260
    ds_read_b32 v7, v4 offset:320
    s_waitcnt vmcnt(7)
    v_rcp_f32 v14, v14
    v_mfma_f32_4x4x4_16b_bf16 v[16:19], v[34:35], v[196:197], 0 cbsz:4 abid:0
    v_exp_f32 v13, v167
    v_mfma_f32_4x4x4_16b_bf16 v[20:23], v[34:35], v[198:199], 0 cbsz:4 abid:0
    v_exp_f32 v12, v166
    v_readlane_b32 s61, v8, 1
    v_rcp_f32 v15, v15
    v_pk_add_f32 v[12:13], v[12:13], 1.0 op_sel_hi:[1,0]
    v_pk_mul_f32 v[180:181], v[180:181], v[14:15]
    s_and_b32 s69, s61, 0xfffffc00
    s_set_gpr_idx_on s52, gpr_idx(SRC2,DST)
    buffer_load_dwordx4 v[196:199], v1, s[4:7], s68 offen
    v_pk_fma_f32 v[84:85], v[164:165], v[16:17], v[84:85] op_sel_hi:[0,1,1]
    v_pk_fma_f32 v[86:87], v[164:165], v[18:19], v[86:87] op_sel_hi:[0,1,1]
    v_pk_fma_f32 v[88:89], v[180:181], v[20:21], v[88:89] op_sel_hi:[0,1,1]
    v_pk_fma_f32 v[90:91], v[180:181], v[22:23], v[90:91] op_sel_hi:[0,1,1]
    s_set_gpr_idx_off
    s_waitcnt vmcnt(7)
    v_rcp_f32 v12, v12
    v_mfma_f32_4x4x4_16b_bf16 v[16:19], v[34:35], v[200:201], 0 cbsz:4 abid:1
    v_exp_f32 v15, v183
    v_mfma_f32_4x4x4_16b_bf16 v[20:23], v[34:35], v[202:203], 0 cbsz:4 abid:1
    v_exp_f32 v14, v182
    v_readlane_b32 s62, v8, 2
    v_rcp_f32 v13, v13
    v_pk_add_f32 v[14:15], v[14:15], 1.0 op_sel_hi:[1,0]
    v_pk_mul_f32 v[166:167], v[166:167], v[12:13]
    s_and_b32 s68, s62, 0xfffffc00
    s_set_gpr_idx_on s53, gpr_idx(SRC2,DST)
    buffer_load_dwordx4 v[200:203], v1, s[4:7], s69 offen
    v_pk_fma_f32 v[84:85], v[164:165], v[16:17], v[84:85] op_sel:[1,0,0]
    v_pk_fma_f32 v[86:87], v[164:165], v[18:19], v[86:87] op_sel:[1,0,0]
    v_pk_fma_f32 v[88:89], v[180:181], v[20:21], v[88:89] op_sel:[1,0,0]
    v_pk_fma_f32 v[90:91], v[180:181], v[22:23], v[90:91] op_sel:[1,0,0]
    s_set_gpr_idx_off
    s_waitcnt lgkmcnt(0)
    v_add_u32 v9, v9, v2
    v_add_u32 v10, v10, v3
    s_mov_b64 exec, s[32:33]
    ds_read_b128 v[24:27], v9 offset:63232
    s_mov_b64 exec, s[34:35]
    ds_read_b128 v[28:31], v9 offset:63232
    s_mov_b64 exec, -1
    ds_read_b64 v[32:33], v10
    s_waitcnt vmcnt(7)
    v_rcp_f32 v14, v14
    v_mfma_f32_4x4x4_16b_bf16 v[16:19], v[34:35], v[204:205], 0 cbsz:4 abid:2
    v_exp_f32 v13, v169
    v_mfma_f32_4x4x4_16b_bf16 v[20:23], v[34:35], v[206:207], 0 cbsz:4 abid:2
    v_exp_f32 v12, v168
    v_readlane_b32 s63, v8, 3
    v_rcp_f32 v15, v15
    v_pk_add_f32 v[12:13], v[12:13], 1.0 op_sel_hi:[1,0]
    v_pk_mul_f32 v[182:183], v[182:183], v[14:15]
    s_and_b32 s69, s63, 0xfffffc00
    s_set_gpr_idx_on s54, gpr_idx(SRC2,DST)
    buffer_load_dwordx4 v[204:207], v1, s[4:7], s68 offen
    v_pk_fma_f32 v[84:85], v[166:167], v[16:17], v[84:85] op_sel_hi:[0,1,1]
    v_pk_fma_f32 v[86:87], v[166:167], v[18:19], v[86:87] op_sel_hi:[0,1,1]
    v_pk_fma_f32 v[88:89], v[182:183], v[20:21], v[88:89] op_sel_hi:[0,1,1]
    v_pk_fma_f32 v[90:91], v[182:183], v[22:23], v[90:91] op_sel_hi:[0,1,1]
    s_set_gpr_idx_off
    s_waitcnt vmcnt(7)
    v_rcp_f32 v12, v12
    v_mfma_f32_4x4x4_16b_bf16 v[16:19], v[34:35], v[208:209], 0 cbsz:4 abid:3
    v_exp_f32 v15, v185
    v_mfma_f32_4x4x4_16b_bf16 v[20:23], v[34:35], v[210:211], 0 cbsz:4 abid:3
    v_exp_f32 v14, v184
    v_readlane_b32 s64, v8, 4
    v_rcp_f32 v13, v13
    v_pk_add_f32 v[14:15], v[14:15], 1.0 op_sel_hi:[1,0]
    v_pk_mul_f32 v[168:169], v[168:169], v[12:13]
    s_and_b32 s68, s64, 0xfffffc00
    s_set_gpr_idx_on s55, gpr_idx(SRC2,DST)
    buffer_load_dwordx4 v[208:211], v1, s[4:7], s69 offen
    v_pk_fma_f32 v[84:85], v[166:167], v[16:17], v[84:85] op_sel:[1,0,0]
    v_pk_fma_f32 v[86:87], v[166:167], v[18:19], v[86:87] op_sel:[1,0,0]
    v_pk_fma_f32 v[88:89], v[182:183], v[20:21], v[88:89] op_sel:[1,0,0]
    v_pk_fma_f32 v[90:91], v[182:183], v[22:23], v[90:91] op_sel:[1,0,0]
    s_set_gpr_idx_off
    s_sub_u32 s29, s29, 4
    s_cbranch_scc1 L_exit
    s_setprio 2
    s_waitcnt vmcnt(7)
    v_rcp_f32 v14, v14
    v_mfma_f32_4x4x4_16b_bf16 v[16:19], v[34:35], v[212:213], 0 cbsz:4 abid:4
    v_exp_f32 v13, v171
    v_mfma_f32_4x4x4_16b_bf16 v[20:23], v[34:35], v[214:215], 0 cbsz:4 abid:4
    v_exp_f32 v12, v170
    v_readlane_b32 s65, v8, 5
    v_rcp_f32 v15, v15
    v_pk_add_f32 v[12:13], v[12:13], 1.0 op_sel_hi:[1,0]
    v_pk_mul_f32 v[184:185], v[184:185], v[14:15]
    s_and_b32 s69, s65, 0xfffffc00
    s_set_gpr_idx_on s56, gpr_idx(SRC2,DST)
    buffer_load_dwordx4 v[212:215], v1, s[4:7], s68 offen
    v_pk_fma_f32 v[84:85], v[168:169], v[16:17], v[84:85] op_sel_hi:[0,1,1]
    v_pk_fma_f32 v[86:87], v[168:169], v[18:19], v[86:87] op_sel_hi:[0,1,1]
    v_pk_fma_f32 v[88:89], v[184:185], v[20:21], v[88:89] op_sel_hi:[0,1,1]
    v_pk_fma_f32 v[90:91], v[184:185], v[22:23], v[90:91] op_sel_hi:[0,1,1]
    s_set_gpr_idx_off
    s_waitcnt vmcnt(7) lgkmcnt(0)
    v_mfma_f32_4x4x4_16b_bf16 v[20:23], v[34:35], v[218:219], 0 cbsz:4 abid:5
    v_mfma_f32_4x4x4_16b_bf16 v[16:19], v[34:35], v[216:217], 0 cbsz:4 abid:5
    v_rcp_f32 v13, v13
    v_mfma_f32_32x32x16_bf16 v[132:147], v[24:27], v[36:39], 0
    v_exp_f32 v14, v186
    v_exp_f32 v15, v187
    v_readlane_b32 s66, v8, 6
    v_rcp_f32 v12, v12
    v_pk_add_f32 v[14:15], v[14:15], 1.0 op_sel_hi:[1,0]
    v_pk_mul_f32 v[170:171], v[170:171], v[12:13]
    s_and_b32 s68, s66, 0xfffffc00
    s_set_gpr_idx_on s57, gpr_idx(SRC2,DST)
    buffer_load_dwordx4 v[216:219], v1, s[4:7], s69 offen
    v_pk_fma_f32 v[84:85], v[168:169], v[16:17], v[84:85] op_sel:[1,0,0]
    v_pk_fma_f32 v[86:87], v[168:169], v[18:19], v[86:87] op_sel:[1,0,0]
    v_pk_fma_f32 v[88:89], v[184:185], v[20:21], v[88:89] op_sel:[1,0,0]
    v_pk_fma_f32 v[90:91], v[184:185], v[22:23], v[90:91] op_sel:[1,0,0]
    s_set_gpr_idx_off
    s_waitcnt vmcnt(7)
    v_rcp_f32 v14, v14
    v_mfma_f32_4x4x4_16b_bf16 v[16:19], v[34:35], v[220:221], 0 cbsz:4 abid:6
    v_exp_f32 v13, v173
    v_mfma_f32_4x4x4_16b_bf16 v[20:23], v[34:35], v[222:223], 0 cbsz:4 abid:6
    v_exp_f32 v12, v172
    v_readlane_b32 s67, v8, 7
    v_rcp_f32 v15, v15
    v_pk_add_f32 v[12:13], v[12:13], 1.0 op_sel_hi:[1,0]
    v_pk_mul_f32 v[186:187], v[186:187], v[14:15]
    s_and_b32 s69, s67, 0xfffffc00
    s_set_gpr_idx_on s58, gpr_idx(SRC2,DST)
    buffer_load_dwordx4 v[220:223], v1, s[4:7], s68 offen
    v_pk_fma_f32 v[84:85], v[170:171], v[16:17], v[84:85] op_sel_hi:[0,1,1]
    v_pk_fma_f32 v[86:87], v[170:171], v[18:19], v[86:87] op_sel_hi:[0,1,1]
    v_pk_fma_f32 v[88:89], v[186:187], v[20:21], v[88:89] op_sel_hi:[0,1,1]
    v_pk_fma_f32 v[90:91], v[186:187], v[22:23], v[90:91] op_sel_hi:[0,1,1]
    s_set_gpr_idx_off
    s_waitcnt vmcnt(7)
    v_mfma_f32_4x4x4_16b_bf16 v[20:23], v[34:35], v[226:227], 0 cbsz:4 abid:7
    v_mfma_f32_4x4x4_16b_bf16 v[16:19], v[34:35], v[224:225], 0 cbsz:4 abid:7
    v_rcp_f32 v13, v13
    v_mfma_f32_32x32x16_bf16 v[132:147], v[28:31], v[40:43], v[132:147]
    v_exp_f32 v14, v188
    v_exp_f32 v15, v189
    v_readlane_b32 s36, v8, 8
    v_rcp_f32 v12, v12
    v_pk_add_f32 v[14:15], v[14:15], 1.0 op_sel_hi:[1,0]
    v_pk_mul_f32 v[172:173], v[172:173], v[12:13]
    s_and_b32 s68, s36, 0xfffffc00
    s_set_gpr_idx_on s59, gpr_idx(SRC2,DST)
    buffer_load_dwordx4 v[224:227], v1, s[4:7], s69 offen
    v_pk_fma_f32 v[84:85], v[170:171], v[16:17], v[84:85] op_sel:[1,0,0]
    v_pk_fma_f32 v[86:87], v[170:171], v[18:19], v[86:87] op_sel:[1,0,0]
    v_pk_fma_f32 v[88:89], v[186:187], v[20:21], v[88:89] op_sel:[1,0,0]
    v_pk_fma_f32 v[90:91], v[186:187], v[22:23], v[90:91] op_sel:[1,0,0]
    s_set_gpr_idx_off
    s_sub_u32 s29, s29, 4
    s_cbranch_scc1 L_exit
    s_setprio 1
    s_waitcnt vmcnt(7)
    v_rcp_f32 v14, v14
    v_mfma_f32_4x4x4_16b_bf16 v[16:19], v[34:35], v[196:197], 0 cbsz:4 abid:8
    v_exp_f32 v13, v175
    v_mfma_f32_4x4x4_16b_bf16 v[20:23], v[34:35], v[198:199], 0 cbsz:4 abid:8
    v_exp_f32 v12, v174
    v_readlane_b32 s37, v8, 9
    v_rcp_f32 v15, v15
    v_pk_add_f32 v[12:13], v[12:13], 1.0 op_sel_hi:[1,0]
    v_pk_mul_f32 v[188:189], v[188:189], v[14:15]
    s_and_b32 s69, s37, 0xfffffc00
    s_set_gpr_idx_on s60, gpr_idx(SRC2,DST)
    buffer_load_dwordx4 v[196:199], v1, s[4:7], s68 offen
    v_pk_fma_f32 v[84:85], v[172:173], v[16:17], v[84:85] op_sel_hi:[0,1,1]
    v_pk_fma_f32 v[86:87], v[172:173], v[18:19], v[86:87] op_sel_hi:[0,1,1]
    v_pk_fma_f32 v[88:89], v[188:189], v[20:21], v[88:89] op_sel_hi:[0,1,1]
    v_pk_fma_f32 v[90:91], v[188:189], v[22:23], v[90:91] op_sel_hi:[0,1,1]
    s_set_gpr_idx_off
    s_waitcnt vmcnt(7)
    v_mfma_f32_4x4x4_16b_bf16 v[20:23], v[34:35], v[202:203], 0 cbsz:4 abid:9
    v_mfma_f32_4x4x4_16b_bf16 v[16:19], v[34:35], v[200:201], 0 cbsz:4 abid:9
    v_rcp_f32 v13, v13
    v_mfma_f32_32x32x16_bf16 v[148:163], v[24:27], v[44:47], 0
    v_exp_f32 v14, v190
    v_exp_f32 v15, v191
    v_readlane_b32 s38, v8, 10
    v_rcp_f32 v12, v12
    v_pk_add_f32 v[14:15], v[14:15], 1.0 op_sel_hi:[1,0]
    v_pk_mul_f32 v[174:175], v[174:175], v[12:13]
    s_and_b32 s68, s38, 0xfffffc00
    s_set_gpr_idx_on s61, gpr_idx(SRC2,DST)
    buffer_load_dwordx4 v[200:203], v1, s[4:7], s69 offen
    v_pk_fma_f32 v[84:85], v[172:173], v[16:17], v[84:85] op_sel:[1,0,0]
    v_pk_fma_f32 v[86:87], v[172:173], v[18:19], v[86:87] op_sel:[1,0,0]
    v_pk_fma_f32 v[88:89], v[188:189], v[20:21], v[88:89] op_sel:[1,0,0]
    v_pk_fma_f32 v[90:91], v[188:189], v[22:23], v[90:91] op_sel:[1,0,0]
    s_set_gpr_idx_off
    s_waitcnt vmcnt(7)
    v_rcp_f32 v14, v14
    v_mfma_f32_4x4x4_16b_bf16 v[16:19], v[34:35], v[204:205], 0 cbsz:4 abid:10
    v_exp_f32 v13, v177
    v_mfma_f32_4x4x4_16b_bf16 v[20:23], v[34:35], v[206:207], 0 cbsz:4 abid:10
    v_exp_f32 v12, v176
    v_readlane_b32 s39, v8, 11
    v_rcp_f32 v15, v15
    v_pk_add_f32 v[12:13], v[12:13], 1.0 op_sel_hi:[1,0]
    v_pk_mul_f32 v[190:191], v[190:191], v[14:15]
    s_and_b32 s69, s39, 0xfffffc00
    s_set_gpr_idx_on s62, gpr_idx(SRC2,DST)
    buffer_load_dwordx4 v[204:207], v1, s[4:7], s68 offen
    v_pk_fma_f32 v[84:85], v[174:175], v[16:17], v[84:85] op_sel_hi:[0,1,1]
    v_pk_fma_f32 v[86:87], v[174:175], v[18:19], v[86:87] op_sel_hi:[0,1,1]
    v_pk_fma_f32 v[88:89], v[190:191], v[20:21], v[88:89] op_sel_hi:[0,1,1]
    v_pk_fma_f32 v[90:91], v[190:191], v[22:23], v[90:91] op_sel_hi:[0,1,1]
    s_set_gpr_idx_off
    s_waitcnt vmcnt(7)
    v_mfma_f32_4x4x4_16b_bf16 v[20:23], v[34:35], v[210:211], 0 cbsz:4 abid:11
    v_mfma_f32_4x4x4_16b_bf16 v[16:19], v[34:35], v[208:209], 0 cbsz:4 abid:11
    v_rcp_f32 v13, v13
    v_mfma_f32_32x32x16_bf16 v[148:163], v[28:31], v[48:51], v[148:163]
    v_exp_f32 v14, v192
    v_exp_f32 v15, v193
    v_readlane_b32 s40, v8, 12
    v_rcp_f32 v12, v12
    v_pk_add_f32 v[14:15], v[14:15], 1.0 op_sel_hi:[1,0]
    v_pk_mul_f32 v[176:177], v[176:177], v[12:13]
    s_and_b32 s68, s40, 0xfffffc00
    s_set_gpr_idx_on s63, gpr_idx(SRC2,DST)
    buffer_load_dwordx4 v[208:211], v1, s[4:7], s69 offen
    v_pk_fma_f32 v[84:85], v[174:175], v[16:17], v[84:85] op_sel:[1,0,0]
    v_pk_fma_f32 v[86:87], v[174:175], v[18:19], v[86:87] op_sel:[1,0,0]
    v_pk_fma_f32 v[88:89], v[190:191], v[20:21], v[88:89] op_sel:[1,0,0]
    v_pk_fma_f32 v[90:91], v[190:191], v[22:23], v[90:91] op_sel:[1,0,0]
    s_set_gpr_idx_off
    s_sub_u32 s29, s29, 4
    s_cbranch_scc1 L_exit
    s_setprio 0
    s_waitcnt vmcnt(7)
    v_rcp_f32 v14, v14
    v_mfma_f32_4x4x4_16b_bf16 v[16:19], v[34:35], v[212:213], 0 cbsz:4 abid:12
    v_exp_f32 v13, v179
    v_mfma_f32_4x4x4_16b_bf16 v[20:23], v[34:35], v[214:215], 0 cbsz:4 abid:12
    v_exp_f32 v12, v178
    v_readlane_b32 s41, v8, 13
    v_rcp_f32 v15, v15
    v_pk_add_f32 v[12:13], v[12:13], 1.0 op_sel_hi:[1,0]
    v_pk_mul_f32 v[192:193], v[192:193], v[14:15]
    s_and_b32 s69, s41, 0xfffffc00
    s_set_gpr_idx_on s64, gpr_idx(SRC2,DST)
    buffer_load_dwordx4 v[212:215], v1, s[4:7], s68 offen
    v_pk_fma_f32 v[84:85], v[176:177], v[16:17], v[84:85] op_sel_hi:[0,1,1]
    v_pk_fma_f32 v[86:87], v[176:177], v[18:19], v[86:87] op_sel_hi:[0,1,1]
    v_pk_fma_f32 v[88:89], v[192:193], v[20:21], v[88:89] op_sel_hi:[0,1,1]
    v_pk_fma_f32 v[90:91], v[192:193], v[22:23], v[90:91] op_sel_hi:[0,1,1]
    s_set_gpr_idx_off
    s_waitcnt vmcnt(7)
    v_rcp_f32 v12, v12
    v_mfma_f32_4x4x4_16b_bf16 v[16:19], v[34:35], v[216:217], 0 cbsz:4 abid:13
    v_exp_f32 v15, v195
    v_mfma_f32_4x4x4_16b_bf16 v[20:23], v[34:35], v[218:219], 0 cbsz:4 abid:13
    v_exp_f32 v14, v194
    v_readlane_b32 s42, v8, 14
    v_rcp_f32 v13, v13
    v_pk_add_f32 v[14:15], v[14:15], 1.0 op_sel_hi:[1,0]
    v_pk_mul_f32 v[178:179], v[178:179], v[12:13]
    s_and_b32 s68, s42, 0xfffffc00
    s_set_gpr_idx_on s65, gpr_idx(SRC2,DST)
    buffer_load_dwordx4 v[216:219], v1, s[4:7], s69 offen
    v_pk_fma_f32 v[84:85], v[176:177], v[16:17], v[84:85] op_sel:[1,0,0]
    v_pk_fma_f32 v[86:87], v[176:177], v[18:19], v[86:87] op_sel:[1,0,0]
    v_pk_fma_f32 v[88:89], v[192:193], v[20:21], v[88:89] op_sel:[1,0,0]
    v_pk_fma_f32 v[90:91], v[192:193], v[22:23], v[90:91] op_sel:[1,0,0]
    s_set_gpr_idx_off
    s_waitcnt vmcnt(7)
    v_rcp_f32 v14, v14
    v_mfma_f32_4x4x4_16b_bf16 v[16:19], v[34:35], v[220:221], 0 cbsz:4 abid:14
    v_exp_f32 v13, v133
    v_mfma_f32_4x4x4_16b_bf16 v[20:23], v[34:35], v[222:223], 0 cbsz:4 abid:14
    v_exp_f32 v12, v132
    v_readlane_b32 s43, v8, 15
    v_rcp_f32 v15, v15
    v_pk_add_f32 v[12:13], v[12:13], 1.0 op_sel_hi:[1,0]
    v_pk_mul_f32 v[194:195], v[194:195], v[14:15]
    s_and_b32 s69, s43, 0xfffffc00
    s_set_gpr_idx_on s66, gpr_idx(SRC2,DST)
    buffer_load_dwordx4 v[220:223], v1, s[4:7], s68 offen
    v_pk_fma_f32 v[84:85], v[178:179], v[16:17], v[84:85] op_sel_hi:[0,1,1]
    v_pk_fma_f32 v[86:87], v[178:179], v[18:19], v[86:87] op_sel_hi:[0,1,1]
    v_pk_fma_f32 v[88:89], v[194:195], v[20:21], v[88:89] op_sel_hi:[0,1,1]
    v_pk_fma_f32 v[90:91], v[194:195], v[22:23], v[90:91] op_sel_hi:[0,1,1]
    s_set_gpr_idx_off
    s_waitcnt vmcnt(7)
    v_rcp_f32 v12, v12
    v_mfma_f32_4x4x4_16b_bf16 v[16:19], v[34:35], v[224:225], 0 cbsz:4 abid:15
    v_exp_f32 v15, v149
    v_mfma_f32_4x4x4_16b_bf16 v[20:23], v[34:35], v[226:227], 0 cbsz:4 abid:15
    v_exp_f32 v14, v148
    v_readlane_b32 s44, v7, 0
    v_rcp_f32 v13, v13
    v_pk_add_f32 v[14:15], v[14:15], 1.0 op_sel_hi:[1,0]
    v_pk_mul_f32 v[132:133], v[132:133], v[12:13]
    s_and_b32 s68, s44, 0xfffffc00
    s_set_gpr_idx_on s67, gpr_idx(SRC2,DST)
    buffer_load_dwordx4 v[224:227], v1, s[4:7], s69 offen
    v_pk_fma_f32 v[84:85], v[178:179], v[16:17], v[84:85] op_sel:[1,0,0]
    v_pk_fma_f32 v[86:87], v[178:179], v[18:19], v[86:87] op_sel:[1,0,0]
    v_pk_fma_f32 v[88:89], v[194:195], v[20:21], v[88:89] op_sel:[1,0,0]
    v_pk_fma_f32 v[90:91], v[194:195], v[22:23], v[90:91] op_sel:[1,0,0]
    s_set_gpr_idx_off
    s_sub_u32 s29, s29, 4
    s_cbranch_scc1 L_exit
    v_add_u32 v4, 256, v4
    v_add_u32 v5, 256, v5
    v_add_u32 v6, 256, v6
    s_branch L_loop
L_more:
    s_waitcnt vmcnt(0) lgkmcnt(0)
    s_barrier
    v_lshlrev_b32 v188, 4, v0
    v_add_u32 v189, 8192, v188
    v_add_u32 v190, 16384, v188
    v_add_u32 v191, 24576, v188
    v_add_u32 v192, 32768, v188
    v_add_u32 v193, 40960, v188
    v_lshlrev_b32 v194, 2, v0
    v_lshlrev_b32 v14, 3, v0
    v_mov_b32 v16, 0
    v_mov_b32 v17, 0
    v_mov_b32 v15, 0x00300000
    ds_write_b64 v14, v[16:17] offset:16128
    ds_write_b32 v194, v15 offset:20224
    ds_write_b32 v194, v15 offset:22272
    ds_write_b32 v194, v15 offset:24320
    v_lshrrev_b32 v195, 1, v0
    v_lshlrev_b32 v195, 2, v195
    s_branch L_round
L_exit:
    s_add_u32 s28, s28, 1536
    s_cmp_lt_u32 s28, s25
    s_cbranch_scc1 L_more
    s_mov_b32 m0, s96
    v_cvt_pk_bf16_f32 v84, v84, v88
    v_cvt_pk_bf16_f32 v85, v85, v89
    v_cvt_pk_bf16_f32 v86, v86, v90
    v_cvt_pk_bf16_f32 v87, v87, v91
    ds_write_addtid_b32 v84 offset:16128
    ds_write_addtid_b32 v85 offset:16416
    ds_write_addtid_b32 v86 offset:16704
    ds_write_addtid_b32 v87 offset:16992
    s_mov_b32 m0, s97
    v_cvt_pk_bf16_f32 v92, v92, v96
    v_cvt_pk_bf16_f32 v93, v93, v97
    v_cvt_pk_bf16_f32 v94, v94, v98
    v_cvt_pk_bf16_f32 v95, v95, v99
    ds_write_addtid_b32 v92 offset:16128
    ds_write_addtid_b32 v93 offset:16416
    ds_write_addtid_b32 v94 offset:16704
    ds_write_addtid_b32 v95 offset:16992
    s_mov_b32 m0, s98
    v_cvt_pk_bf16_f32 v100, v100, v104
    v_cvt_pk_bf16_f32 v101, v101, v105
    v_cvt_pk_bf16_f32 v102, v102, v106
    v_cvt_pk_bf16_f32 v103, v103, v107
    ds_write_addtid_b32 v100 offset:16128
    ds_write_addtid_b32 v101 offset:16416
    ds_write_addtid_b32 v102 offset:16704
    ds_write_addtid_b32 v103 offset:16992
    s_mov_b32 m0, s99
    v_cvt_pk_bf16_f32 v108, v108, v112
    v_cvt_pk_bf16_f32 v109, v109, v113
    v_cvt_pk_bf16_f32 v110, v110, v114
    v_cvt_pk_bf16_f32 v111, v111, v115
    ds_write_addtid_b32 v108 offset:16128
    ds_write_addtid_b32 v109 offset:16416
    ds_write_addtid_b32 v110 offset:16704
    ds_write_addtid_b32 v111 offset:16992
    s_mov_b32 m0, s100
    v_cvt_pk_bf16_f32 v116, v116, v120
    v_cvt_pk_bf16_f32 v117, v117, v121
    v_cvt_pk_bf16_f32 v118, v118, v122
    v_cvt_pk_bf16_f32 v119, v119, v123
    ds_write_addtid_b32 v116 offset:16128
    ds_write_addtid_b32 v117 offset:16416
    ds_write_addtid_b32 v118 offset:16704
    ds_write_addtid_b32 v119 offset:16992
    s_mov_b32 s68, 0xbf317218
    s_waitcnt lgkmcnt(0)
    s_barrier
    ds_read_b128 v[84:87], v230 offset:16128
    ds_read_b128 v[88:91], v230 offset:16192
    ds_read_b128 v[92:95], v230 offset:16256
    ds_read_b128 v[96:99], v230 offset:16320
    ds_read_b128 v[100:103], v230 offset:20736
    ds_read_b128 v[104:107], v230 offset:20800
    ds_read_b128 v[108:111], v230 offset:20864
    ds_read_b128 v[112:115], v230 offset:20928
    s_waitcnt lgkmcnt(7)
    v_mfma_f32_16x16x32_bf16 v[116:119], v[84:87], v[52:55], 0
    v_mfma_f32_16x16x32_bf16 v[120:123], v[84:87], v[56:59], 0
    s_waitcnt lgkmcnt(6)
    v_mfma_f32_16x16x32_bf16 v[116:119], v[88:91], v[60:63], v[116:119]
    v_mfma_f32_16x16x32_bf16 v[120:123], v[88:91], v[64:67], v[120:123]
    s_waitcnt lgkmcnt(5)
    v_mfma_f32_16x16x32_bf16 v[116:119], v[92:95], v[68:71], v[116:119]
    v_mfma_f32_16x16x32_bf16 v[120:123], v[92:95], v[72:75], v[120:123]
    s_waitcnt lgkmcnt(4)
    v_mfma_f32_16x16x32_bf16 v[116:119], v[96:99], v[76:79], v[116:119]
    v_mfma_f32_16x16x32_bf16 v[120:123], v[96:99], v[80:83], v[120:123]
    ds_read_b128 v[84:87], v230 offset:25344
    ds_read_b128 v[88:91], v230 offset:25408
    ds_read_b128 v[92:95], v230 offset:25472
    ds_read_b128 v[96:99], v230 offset:25536
    s_waitcnt lgkmcnt(7)
    v_mfma_f32_16x16x32_bf16 v[124:127], v[100:103], v[52:55], 0
    v_mfma_f32_16x16x32_bf16 v[128:131], v[100:103], v[56:59], 0
    s_waitcnt lgkmcnt(6)
    v_mfma_f32_16x16x32_bf16 v[124:127], v[104:107], v[60:63], v[124:127]
    v_mul_f32 v116, s68, v116
    v_mul_f32 v117, s68, v117
    v_mfma_f32_16x16x32_bf16 v[128:131], v[104:107], v[64:67], v[128:131]
    v_mul_f32 v118, s68, v118
    v_mul_f32 v119, s68, v119
    s_waitcnt lgkmcnt(5)
    v_mfma_f32_16x16x32_bf16 v[124:127], v[108:111], v[68:71], v[124:127]
    v_mul_f32 v120, s68, v120
    v_mul_f32 v121, s68, v121
    v_mfma_f32_16x16x32_bf16 v[128:131], v[108:111], v[72:75], v[128:131]
    v_mul_f32 v122, s68, v122
    v_mul_f32 v123, s68, v123
    s_waitcnt lgkmcnt(4)
    v_mfma_f32_16x16x32_bf16 v[124:127], v[112:115], v[76:79], v[124:127]
    v_cvt_pk_bf16_f32 v44, v116, v117
    v_cvt_pk_bf16_f32 v45, v118, v119
    v_mfma_f32_16x16x32_bf16 v[128:131], v[112:115], v[80:83], v[128:131]
    v_cvt_pk_bf16_f32 v46, v120, v121
    v_cvt_pk_bf16_f32 v47, v122, v123
    s_mov_b32 s3, 0
    buffer_store_dwordx4 v[44:47], v231, s[16:19], s3 offen sc0 sc1
    ds_read_b128 v[100:103], v230 offset:29952
    ds_read_b128 v[104:107], v230 offset:30016
    ds_read_b128 v[108:111], v230 offset:30080
    ds_read_b128 v[112:115], v230 offset:30144
    s_waitcnt lgkmcnt(7)
    v_mfma_f32_16x16x32_bf16 v[116:119], v[84:87], v[52:55], 0
    v_mfma_f32_16x16x32_bf16 v[120:123], v[84:87], v[56:59], 0
    s_waitcnt lgkmcnt(6)
    v_mfma_f32_16x16x32_bf16 v[116:119], v[88:91], v[60:63], v[116:119]
    v_mul_f32 v124, s68, v124
    v_mul_f32 v125, s68, v125
    v_mfma_f32_16x16x32_bf16 v[120:123], v[88:91], v[64:67], v[120:123]
    v_mul_f32 v126, s68, v126
    v_mul_f32 v127, s68, v127
    s_waitcnt lgkmcnt(5)
    v_mfma_f32_16x16x32_bf16 v[116:119], v[92:95], v[68:71], v[116:119]
    v_mul_f32 v128, s68, v128
    v_mul_f32 v129, s68, v129
    v_mfma_f32_16x16x32_bf16 v[120:123], v[92:95], v[72:75], v[120:123]
    v_mul_f32 v130, s68, v130
    v_mul_f32 v131, s68, v131
    s_waitcnt lgkmcnt(4)
    v_mfma_f32_16x16x32_bf16 v[116:119], v[96:99], v[76:79], v[116:119]
    v_cvt_pk_bf16_f32 v48, v124, v125
    v_cvt_pk_bf16_f32 v49, v126, v127
    v_mfma_f32_16x16x32_bf16 v[120:123], v[96:99], v[80:83], v[120:123]
    v_cvt_pk_bf16_f32 v50, v128, v129
    v_cvt_pk_bf16_f32 v51, v130, v131
    s_mov_b32 s3, 1048576
    buffer_store_dwordx4 v[48:51], v231, s[16:19], s3 offen sc0 sc1
    ds_read_b128 v[84:87], v230 offset:34560
    ds_read_b128 v[88:91], v230 offset:34624
    ds_read_b128 v[92:95], v230 offset:34688
    ds_read_b128 v[96:99], v230 offset:34752
    s_waitcnt lgkmcnt(7)
    v_mfma_f32_16x16x32_bf16 v[124:127], v[100:103], v[52:55], 0
    v_mfma_f32_16x16x32_bf16 v[128:131], v[100:103], v[56:59], 0
    s_waitcnt lgkmcnt(6)
    v_mfma_f32_16x16x32_bf16 v[124:127], v[104:107], v[60:63], v[124:127]
    v_mul_f32 v116, s68, v116
    v_mul_f32 v117, s68, v117
    v_mfma_f32_16x16x32_bf16 v[128:131], v[104:107], v[64:67], v[128:131]
    v_mul_f32 v118, s68, v118
    v_mul_f32 v119, s68, v119
    s_waitcnt lgkmcnt(5)
    v_mfma_f32_16x16x32_bf16 v[124:127], v[108:111], v[68:71], v[124:127]
    v_mul_f32 v120, s68, v120
    v_mul_f32 v121, s68, v121
    v_mfma_f32_16x16x32_bf16 v[128:131], v[108:111], v[72:75], v[128:131]
    v_mul_f32 v122, s68, v122
    v_mul_f32 v123, s68, v123
    s_waitcnt lgkmcnt(4)
    v_mfma_f32_16x16x32_bf16 v[124:127], v[112:115], v[76:79], v[124:127]
    v_cvt_pk_bf16_f32 v44, v116, v117
    v_cvt_pk_bf16_f32 v45, v118, v119
    v_mfma_f32_16x16x32_bf16 v[128:131], v[112:115], v[80:83], v[128:131]
    v_cvt_pk_bf16_f32 v46, v120, v121
    v_cvt_pk_bf16_f32 v47, v122, v123
    s_mov_b32 s3, 2097152
    buffer_store_dwordx4 v[44:47], v231, s[16:19], s3 offen sc0 sc1
    s_nop 3
    s_waitcnt lgkmcnt(3)
    v_mfma_f32_16x16x32_bf16 v[116:119], v[84:87], v[52:55], 0
    v_mfma_f32_16x16x32_bf16 v[120:123], v[84:87], v[56:59], 0
    s_waitcnt lgkmcnt(2)
    v_mfma_f32_16x16x32_bf16 v[116:119], v[88:91], v[60:63], v[116:119]
    v_mul_f32 v124, s68, v124
    v_mul_f32 v125, s68, v125
    v_mfma_f32_16x16x32_bf16 v[120:123], v[88:91], v[64:67], v[120:123]
    v_mul_f32 v126, s68, v126
    v_mul_f32 v127, s68, v127
    s_waitcnt lgkmcnt(1)
    v_mfma_f32_16x16x32_bf16 v[116:119], v[92:95], v[68:71], v[116:119]
    v_mul_f32 v128, s68, v128
    v_mul_f32 v129, s68, v129
    v_mfma_f32_16x16x32_bf16 v[120:123], v[92:95], v[72:75], v[120:123]
    v_mul_f32 v130, s68, v130
    v_mul_f32 v131, s68, v131
    s_waitcnt lgkmcnt(0)
    v_mfma_f32_16x16x32_bf16 v[116:119], v[96:99], v[76:79], v[116:119]
    v_cvt_pk_bf16_f32 v48, v124, v125
    v_cvt_pk_bf16_f32 v49, v126, v127
    v_mfma_f32_16x16x32_bf16 v[120:123], v[96:99], v[80:83], v[120:123]
    v_cvt_pk_bf16_f32 v50, v128, v129
    v_cvt_pk_bf16_f32 v51, v130, v131
    s_mov_b32 s3, 3145728
    buffer_store_dwordx4 v[48:51], v231, s[16:19], s3 offen sc0 sc1
    s_or_b32 s31, s2, s24
    s_cbranch_scc1 L_noep
    v_lshlrev_b32 v36, 2, v11
    v_mov_b32 v37, s26
    global_store_dword v36, v37, s[22:23] offset:0 sc0 sc1
L_noep:
    s_nop 3
    v_mul_f32 v116, s68, v116
    v_mul_f32 v117, s68, v117
    v_mul_f32 v118, s68, v118
    v_mul_f32 v119, s68, v119
    v_mul_f32 v120, s68, v120
    v_mul_f32 v121, s68, v121
    v_mul_f32 v122, s68, v122
    v_mul_f32 v123, s68, v123
    v_cvt_pk_bf16_f32 v44, v116, v117
    v_cvt_pk_bf16_f32 v45, v118, v119
    v_cvt_pk_bf16_f32 v46, v120, v121
    v_cvt_pk_bf16_f32 v47, v122, v123
    s_mov_b32 s3, 4194304
    buffer_store_dwordx4 v[44:47], v231, s[16:19], s3 offen sc0 sc1
L_end:
    s_endpgm
.section .rodata,"a"
.p2align 6
.amdhsa_kernel standalone__tensor_product_equiv_tfn__graph_kernel
  .amdhsa_next_free_vgpr 232
  .amdhsa_next_free_sgpr 102
  .amdhsa_accum_offset 232
  .amdhsa_group_segment_fixed_size 0
  .amdhsa_kernarg_size 88
  .amdhsa_user_sgpr_count 2
  .amdhsa_user_sgpr_kernarg_segment_ptr 1
  .amdhsa_system_sgpr_workgroup_id_x 1
  .amdhsa_float_denorm_mode_32 3
.end_amdhsa_kernel
```

```asm
; @launch grid=(256,1,1) block=(512,1,1) lds=163584
.amdgcn_target "amdgcn-amd-amdhsa--gfx950"
.text
.globl standalone__tensor_product_equiv_tfn__graph_kernel
.p2align 8
.type standalone__tensor_product_equiv_tfn__graph_kernel,@function
standalone__tensor_product_equiv_tfn__graph_kernel:
    s_load_dwordx16 s[4:19], s[0:1], 0
    s_load_dwordx2 s[22:23], s[0:1], 80
    s_load_dwordx2 s[20:21], s[0:1], 64
    s_cmp_ge_u32 s2, 256
    s_cbranch_scc1 L_end
    v_mul_u32_u24 v172, 3, v0
    s_mul_i32 s3, s2, 1250
    v_min_u32 v172, 1247, v172
    v_add_lshl_u32 v173, v172, s3, 2
    v_lshrrev_b32 v12, 6, v0
    v_and_b32 v13, 255, v0
    v_lshlrev_b32 v13, 2, v13
    v_mov_b32 v16, 0
    v_readfirstlane_b32 s24, v12
    ds_write_b32 v13, v16 offset:0
    v_lshlrev_b32 v174, 1, v173
    s_waitcnt lgkmcnt(0)
    global_load_dwordx3 v[132:134], v173, s[8:9]
    s_load_dword s26, s[22:23], 0
    s_barrier
    global_load_dwordx3 v[136:138], v173, s[6:7]
    global_load_dwordx4 v[140:143], v174, s[10:11]
    global_load_dwordx2 v[144:145], v174, s[10:11] offset:16
    v_lshlrev_b32 v188, 4, v0
    v_and_b32 v11, 63, v0
    s_lshl_b32 s30, s24, 10
    s_lshl_b32 s3, s3, 5
    s_add_u32 s12, s12, s3
    s_addc_u32 s13, s13, 0
    v_add_u32 v189, 8192, v188
    v_add_u32 v190, 16384, v188
    v_add_u32 v191, 24576, v188
    v_add_u32 v192, 32768, v188
    v_add_u32 v193, 40960, v188
    v_min_u32 v175, 39984, v192
    v_lshlrev_b32 v1, 4, v11
    s_barrier
    s_add_u32 m0, s30, 112384
    s_nop 0
    global_load_lds_dwordx4 v188, s[12:13]
    s_add_u32 m0, s30, 120576
    s_nop 0
    global_load_lds_dwordx4 v189, s[12:13]
    s_cmp_eq_u32 s24, 7
    s_cbranch_scc0 L_nocpf
    s_cmp_lt_u32 s2, 8
    s_cbranch_scc0 L_nocpf
    s_getpc_b64 s[68:69]
L_pc:
    v_and_b32 v18, 63, v0
    v_lshlrev_b32 v18, 7, v18
    v_mov_b32 v19, 0
    v_lshl_add_u64 v[20:21], v[18:19], 0, s[68:69]
    global_load_dword v204, v[20:21], off
    v_min_u32 v18, L_end-L_pc-8192, v18
    v_add_u32 v18, 8192, v18
    v_lshl_add_u64 v[20:21], v[18:19], 0, s[68:69]
    global_load_dword v205, v[20:21], off
L_nocpf:
    v_lshlrev_b32 v194, 2, v0
    v_lshlrev_b32 v14, 3, v0
    v_mov_b32 v16, 0
    v_mov_b32 v17, 0
    v_mov_b32 v15, 0x00300000
    ds_write_b64 v14, v[16:17] offset:16128
    ds_write_b32 v194, v15 offset:20224
    ds_write_b32 v194, v15 offset:22272
    ds_write_b32 v194, v15 offset:24320
    v_lshrrev_b32 v195, 1, v0
    v_lshlrev_b32 v195, 2, v195
    v_cmp_gt_u32 vcc, 416, v0
    s_mov_b64 s[36:37], vcc
    v_cmp_gt_u32 vcc, 417, v0
    s_mov_b64 s[38:39], vcc
    v_mov_b32 v12, 1
    s_movk_i32 s40, 1250
    s_mov_b32 s41, 63232
    s_lshr_b32 s27, s24, 2
    s_mov_b32 s28, 0
    s_waitcnt vmcnt(5)
    s_mov_b64 exec, s[38:39]
    v_and_b32 v153, 7, v133
    v_bfe_u32 v150, v133, 3, 5
    v_lshl_add_u32 v147, v153, 5, v150
    v_lshlrev_b32 v147, 2, v147
    ds_add_rtn_u32 v150, v147, v12 offset:0
    v_and_b32 v154, 7, v134
    v_bfe_u32 v151, v134, 3, 5
    v_lshl_add_u32 v148, v154, 5, v151
    v_lshlrev_b32 v148, 2, v148
    ds_add_rtn_u32 v151, v148, v12 offset:0
    s_mov_b64 exec, s[36:37]
    v_and_b32 v152, 7, v132
    v_bfe_u32 v149, v132, 3, 5
    v_lshl_add_u32 v146, v152, 5, v149
    v_lshlrev_b32 v146, 2, v146
    ds_add_rtn_u32 v149, v146, v12 offset:0
    s_mov_b64 exec, -1
    s_add_u32 m0, s30, 128768
    s_nop 0
    global_load_lds_dwordx4 v190, s[12:13]
    s_add_u32 m0, s30, 136960
    s_nop 0
    global_load_lds_dwordx4 v191, s[12:13]
    s_add_u32 m0, s30, 145152
    s_nop 0
    global_load_lds_dwordx4 v175, s[12:13]
    s_waitcnt lgkmcnt(0)
    s_barrier
    ds_read_b128 v[164:167], v1 offset:0
    s_mul_i32 s3, s2, 1280
    s_add_u32 s26, s26, 1
    s_waitcnt lgkmcnt(0)
    v_add_u32 v180, v164, v165
    v_add3_u32 v180, v180, v166, v167
    v_mov_b32 v181, v180
    v_lshrrev_b32 v132, 8, v132
    v_lshlrev_b32 v156, 26, v132
    v_add_u32_dpp v181, v181, v181 row_shr:1 row_mask:0xf bank_mask:0xf
    v_lshl_add_u32 v132, v132, 4, v156
    v_add_lshl_u32 v177, v172, 0, 5
    v_add_u32_dpp v181, v181, v181 row_shr:2 row_mask:0xf bank_mask:0xf
    v_lshrrev_b32 v133, 8, v133
    v_lshlrev_b32 v157, 26, v133
    v_add_u32_dpp v181, v181, v181 row_shr:4 row_mask:0xf bank_mask:0xf
    v_lshl_add_u32 v133, v133, 4, v157
    v_add_lshl_u32 v178, v172, 1, 5
    v_add_u32_dpp v181, v181, v181 row_shr:8 row_mask:0xf bank_mask:0xf
    v_lshrrev_b32 v134, 8, v134
    v_lshlrev_b32 v158, 26, v134
    v_add_u32_dpp v181, v181, v181 row_bcast:15 row_mask:0xa bank_mask:0xf
    v_lshl_add_u32 v134, v134, 4, v158
    v_add_lshl_u32 v179, v172, 2, 5
    v_add_u32_dpp v181, v181, v181 row_bcast:31 row_mask:0xc bank_mask:0xf
    v_sub_u32 v168, v181, v180
    v_add_u32 v169, v168, v164
    v_add_u32 v170, v169, v165
    v_add_u32 v171, v170, v166
    ds_write_b128 v1, v[168:171] offset:1024
    s_mov_b64 exec, s[38:39]
    ds_read_b32 v147, v147 offset:1024
    ds_read_b32 v148, v148 offset:1024
    s_mov_b64 exec, s[36:37]
    ds_read_b32 v146, v146 offset:1024
    s_mov_b64 exec, -1
    s_waitcnt vmcnt(5)
    v_mad_u32_u24 v152, v152, s40, v136
    v_lshl_add_u32 v132, v136, 10, v132
    v_subrev_u32 v156, 10000, v152
    v_min_u32 v152, v152, v156
    v_mul_u32_u24 v152, 157, v152
    v_lshrrev_b32 v152, 17, v152
    v_add_u32 v152, v152, v132
    v_mad_u32_u24 v153, v153, s40, v137
    v_lshl_add_u32 v133, v137, 10, v133
    v_subrev_u32 v157, 10000, v153
    v_min_u32 v153, v153, v157
    v_mul_u32_u24 v153, 157, v153
    v_lshrrev_b32 v153, 17, v153
    v_add_u32 v153, v153, v133
    v_mad_u32_u24 v154, v154, s40, v138
    v_lshl_add_u32 v134, v138, 10, v134
    v_subrev_u32 v158, 10000, v154
    v_min_u32 v154, v154, v158
    v_mul_u32_u24 v154, 157, v154
    v_lshrrev_b32 v154, 17, v154
    v_add_u32 v154, v154, v134
    s_mov_b64 exec, s[38:39]
    s_waitcnt lgkmcnt(0)
    v_add_lshl_u32 v147, v147, v150, 1
    v_mad_u32_u24 v183, v147, 6, s41
    ds_write_b16 v147, v178 offset:2048
    ds_write2_b32 v183, v142, v143 offset1:1
    ds_write_b32 v183, v153 offset:8
    v_add_lshl_u32 v148, v148, v151, 1
    v_mad_u32_u24 v184, v148, 6, s41
    ds_write_b16 v148, v179 offset:2048
    ds_write2_b32 v184, v144, v145 offset1:1
    ds_write_b32 v184, v154 offset:8
    s_mov_b64 exec, s[36:37]
    v_add_lshl_u32 v146, v146, v149, 1
    v_mad_u32_u24 v182, v146, 6, s41
    ds_write_b16 v146, v177 offset:2048
    ds_write2_b32 v182, v140, v141 offset1:1
    ds_write_b32 v182, v152 offset:8
    s_mov_b64 exec, -1
    s_add_u32 m0, s30, 26368
    s_nop 0
    global_load_lds_dwordx4 v188, s[18:19]
    s_add_u32 m0, s30, 34560
    s_nop 0
    global_load_lds_dwordx4 v189, s[18:19]
    s_add_u32 m0, s30, 42752
    s_nop 0
    global_load_lds_dwordx4 v190, s[18:19]
    s_add_u32 m0, s30, 50944
    s_nop 0
    global_load_lds_dwordx4 v191, s[18:19]
    s_add_u32 s70, s30, 59136
    v_min_u32 v185, 112, v1
    s_cmp_lt_u32 s24, 4
    s_cselect_b64 vcc, -1, 0
    s_cselect_b32 m0, s70, 162560
    s_cselect_b64 s[68:69], s[14:15], s[16:17]
    v_cndmask_b32 v185, v185, v188, vcc
    global_load_lds_dwordx4 v185, s[68:69]
    v_add_u32 v168, s3, v168
    v_lshl_add_u32 v196, v164, 19, v168
    v_mov_b32 v197, s26
    v_add_u32 v169, s3, v169
    v_lshl_add_u32 v198, v165, 19, v169
    v_mov_b32 v199, s26
    v_add_u32 v170, s3, v170
    v_lshl_add_u32 v200, v166, 19, v170
    v_mov_b32 v201, s26
    v_add_u32 v171, s3, v171
    v_lshl_add_u32 v202, v167, 19, v171
    v_mov_b32 v203, s26
    s_lshl_b32 s31, s2, 11
    s_add_u32 s31, s31, 4096
    v_add_u32 v186, s31, v1
    s_mul_i32 s31, s3, 12
    s_add_u32 s31, s31, 1048576
    s_add_u32 s48, s22, s31
    s_addc_u32 s49, s23, 0
    s_mov_b32 s50, 15104
    s_mov_b32 s51, 0x00020000
    s_lshl_b32 s3, s3, 5
    s_add_u32 s31, s3, 8388608
    s_add_u32 s52, s22, s31
    s_addc_u32 s53, s23, 0
    s_mov_b32 s54, 40064
    s_mov_b32 s55, 0x00020000
    v_and_b32 v172, -2, v0
    v_and_b32 v173, 16, v188
    v_add_u32 v173, 112384, v173
    s_waitcnt lgkmcnt(0)
    s_barrier
    ds_read_b128 v[132:135], v188 offset:63232
    ds_read_b128 v[136:139], v189 offset:63232
    ds_read_u16 v174, v172 offset:2048
    ds_read_u16 v175, v172 offset:2560
    ds_read_u16 v176, v172 offset:3072
    ds_read_u16 v177, v172 offset:3584
    ds_read_u16 v178, v172 offset:4096
    s_waitcnt lgkmcnt(6)
    buffer_store_dwordx4 v[132:135], v188, s[48:51], 0 offen sc0 sc1
    s_waitcnt lgkmcnt(5)
    buffer_store_dwordx4 v[136:139], v189, s[48:51], 0 offen sc0 sc1
    s_waitcnt lgkmcnt(0)
    v_add_u32 v174, v174, v173
    v_add_u32 v175, v175, v173
    v_add_u32 v176, v176, v173
    v_add_u32 v177, v177, v173
    v_min_u32 v178, 39968, v178
    v_and_b32 v178, -16, v178
    v_add_u32 v178, v178, v173
    v_mov_b64 v[84:85], 0
    v_mov_b64 v[86:87], 0
    v_mov_b64 v[88:89], 0
    v_mov_b64 v[90:91], 0
    v_mov_b64 v[92:93], 0
    v_mov_b64 v[94:95], 0
    v_mov_b64 v[96:97], 0
    v_mov_b64 v[98:99], 0
    v_mov_b64 v[100:101], 0
    v_mov_b64 v[102:103], 0
    v_mov_b64 v[104:105], 0
    v_mov_b64 v[106:107], 0
    v_mov_b64 v[108:109], 0
    v_mov_b64 v[110:111], 0
    v_mov_b64 v[112:113], 0
    v_mov_b64 v[114:115], 0
    v_mov_b64 v[116:117], 0
    v_mov_b64 v[118:119], 0
    v_mov_b64 v[120:121], 0
    v_mov_b64 v[122:123], 0
    v_mov_b64 v[124:125], 0
    v_mov_b64 v[126:127], 0
    v_mov_b64 v[128:129], 0
    v_mov_b64 v[130:131], 0
    v_mov_b64 v[24:25], 0
    v_mov_b64 v[26:27], 0
    v_mov_b64 v[28:29], 0
    v_mov_b64 v[30:31], 0
    s_mov_b32 s32, 0x0f0f0f0f
    s_mov_b32 s33, s32
    s_not_b64 s[34:35], s[32:33]
    v_lshrrev_b32 v2, 5, v11
    v_lshlrev_b32 v2, 4, v2
    v_and_b32 v3, 3, v11
    v_lshlrev_b32 v3, 3, v3
    v_add_u32 v3, 112384, v3
    s_mov_b32 s6, 10240000
    s_mov_b32 s7, 0x00020000
    s_add_u32 s8, s22, 1048576
    s_addc_u32 s9, s23, 0
    s_mov_b32 s10, 3932160
    s_mov_b32 s11, 0x00020000
    s_mov_b32 s101, 0
    s_cmp_lt_u32 s2, 16
    s_cbranch_scc1 L_r40
    s_cmp_eq_u32 s24, 0
    s_cselect_b32 s101, 0x245d2388, s101
    s_cmp_eq_u32 s24, 1
    s_cselect_b32 s101, 0x25753343, s101
    s_cmp_eq_u32 s24, 2
    s_cselect_b32 s101, 0x27449100, s101
    s_cmp_eq_u32 s24, 3
    s_cselect_b32 s101, 0x267d5301, s101
    s_cmp_eq_u32 s24, 4
    s_cselect_b32 s101, 0x2179a402, s101
    s_cmp_eq_u32 s24, 5
    s_cselect_b32 s101, 0x227162c6, s101
    s_cmp_eq_u32 s24, 6
    s_cselect_b32 s101, 0x206543c7, s101
    s_cmp_eq_u32 s24, 7
    s_cselect_b32 s101, 0x236d8285, s101
    s_branch L_rd
L_r40:
    s_cmp_eq_u32 s24, 0
    s_cselect_b32 s101, 0x2271a3c1, s101
    s_cmp_eq_u32 s24, 1
    s_cselect_b32 s101, 0x20750307, s101
    s_cmp_eq_u32 s24, 2
    s_cselect_b32 s101, 0x236d5205, s101
    s_cmp_eq_u32 s24, 3
    s_cselect_b32 s101, 0x27797340, s101
    s_cmp_eq_u32 s24, 4
    s_cselect_b32 s101, 0x256112c4, s101
    s_cmp_eq_u32 s24, 5
    s_cselect_b32 s101, 0x26653243, s101
    s_cmp_eq_u32 s24, 6
    s_cselect_b32 s101, 0x217d4382, s101
    s_cmp_eq_u32 s24, 7
    s_cselect_b32 s101, 0x24592286, s101
L_rd:
    s_and_b32 s3, s2, 7
    s_lshl_b32 s3, s3, 7
    s_bfe_u32 s31, s2, 196613
    s_lshl_b32 s31, s31, 4
    s_add_u32 s3, s3, s31
    s_and_b32 s31, s2, 8
    s_add_u32 s3, s3, s31
    s_and_b32 s31, s2, 16
    s_lshl_b32 s31, s31, 6
    s_add_u32 s3, s3, s31
    s_add_u32 s3, s3, 4096
    v_and_b32 v187, 255, v0
    v_lshl_add_u32 v187, v187, 11, s3
    s_waitcnt vmcnt(7)
    s_barrier
    ds_read_b128 v[144:147], v174
    ds_read_b128 v[148:151], v175
    ds_read_b128 v[152:155], v176
    ds_read_b128 v[156:159], v177
    ds_read_b128 v[160:163], v178
    s_waitcnt lgkmcnt(4)
    buffer_store_dwordx4 v[144:147], v188, s[52:55], 0 offen sc0 sc1
    s_waitcnt lgkmcnt(3)
    buffer_store_dwordx4 v[148:151], v189, s[52:55], 0 offen sc0 sc1
    s_waitcnt lgkmcnt(2)
    buffer_store_dwordx4 v[152:155], v190, s[52:55], 0 offen sc0 sc1
    s_waitcnt lgkmcnt(1)
    buffer_store_dwordx4 v[156:159], v191, s[52:55], 0 offen sc0 sc1
    s_waitcnt lgkmcnt(0)
    buffer_store_dwordx4 v[160:163], v192, s[52:55], 0 offen sc0 sc1
    s_add_u32 s12, s22, 8388608
    s_addc_u32 s13, s23, 0
    s_mov_b32 s14, 10485760
    s_mov_b32 s15, 0x00020000
    s_mov_b32 s16, s20
    s_mov_b32 s17, s21
    s_mov_b32 s18, 10240000
    s_mov_b32 s19, 0x00020000
    s_waitcnt vmcnt(0)
    s_barrier
    s_cmp_eq_u32 s24, 7
    s_cbranch_scc0 L_nopub
    global_store_dwordx4 v186, v[196:199], s[22:23] sc0 sc1
    global_store_dwordx4 v186, v[200:203], s[22:23] offset:1024 sc0 sc1
L_nopub:
    s_cmp_eq_u32 s27, 0
    s_cbranch_scc1 L_pfa
    s_sub_u32 s3, 0, s2
    s_and_b32 s3, s3, 7
    s_mul_i32 s3, s3, 1280000
    s_lshr_b32 s31, s2, 3
    s_mul_i32 s31, s31, 26624
    s_add_u32 s3, s3, s31
    s_add_u32 s3, s3, 0
    v_and_b32 v208, 255, v0
    v_cmp_gt_u32 vcc, 208, v208
    v_lshlrev_b32 v208, 7, v208
    v_mov_b32 v209, 0x7fffff00
    v_cndmask_b32 v208, v209, v208, vcc
    buffer_load_dword v210, v208, s[4:7], s3 offen
L_pfa:
    v_lshrrev_b32 v12, 5, v11
    v_and_b32 v13, 31, v11
    v_lshlrev_b32 v13, 2, v13
    v_lshl_add_u32 v12, v12, 11, v13
    ds_read_b32 v132, v12 offset:59136
    ds_read_b32 v133, v12 offset:59392
    ds_read_b32 v134, v12 offset:59648
    ds_read_b32 v135, v12 offset:59904
    ds_read_b32 v136, v12 offset:60160
    ds_read_b32 v137, v12 offset:60416
    ds_read_b32 v138, v12 offset:60672
    ds_read_b32 v139, v12 offset:60928
    s_waitcnt lgkmcnt(7)
    ds_read_b32 v140, v12 offset:59264
    ds_read_b32 v141, v12 offset:59520
    ds_read_b32 v142, v12 offset:59776
    ds_read_b32 v143, v12 offset:60032
    ds_read_b32 v144, v12 offset:60288
    ds_read_b32 v145, v12 offset:60544
    ds_read_b32 v146, v12 offset:60800
    ds_read_b32 v147, v12 offset:61056
    v_and_b32 v14, 3, v11
    v_bfe_u32 v15, v11, 2, 2
    v_lshlrev_b32 v15, 1, v15
    v_lshl_add_u32 v14, v14, 5, v15
    v_add_u32 v14, 162560, v14
    s_mov_b32 s68, 0xbfb8aa3b
    s_mov_b32 s69, s68
    s_mov_b32 s70, 0x05040100
    s_mov_b32 s71, 0x07060302
    s_and_b32 s3, s24, 3
    s_lshl_b32 s3, s3, 6
    v_lshrrev_b32 v16, 4, v11
    v_and_b32 v17, 15, v11
    v_lshl_add_u32 v17, v17, 2, s3
    v_lshl_add_u32 v16, v16, 11, v17
    s_waitcnt lgkmcnt(0)
    ds_read_u16 v18, v14 offset:0
    ds_read_u16 v19, v14 offset:8
    ds_read_u16 v20, v14 offset:16
    ds_read_u16 v21, v14 offset:24
    ds_read_b32 v148, v16 offset:26368
    ds_read_b32 v149, v16 offset:26624
    ds_read_b32 v150, v16 offset:26880
    ds_read_b32 v151, v16 offset:27136
    ds_read_b32 v152, v16 offset:27392
    ds_read_b32 v153, v16 offset:27648
    ds_read_b32 v154, v16 offset:27904
    ds_read_b32 v155, v16 offset:28160
    v_lshlrev_b32 v22, 16, v132
    v_lshlrev_b32 v23, 16, v133
    v_and_b32 v132, 0xffff0000, v132
    v_and_b32 v133, 0xffff0000, v133
    v_pk_mul_f32 v[22:23], v[22:23], s[68:69]
    v_pk_mul_f32 v[132:133], v[132:133], s[68:69]
    v_cvt_pk_bf16_f32 v36, v22, v23
    v_cvt_pk_bf16_f32 v44, v132, v133
    v_lshlrev_b32 v22, 16, v134
    v_lshlrev_b32 v23, 16, v135
    v_and_b32 v134, 0xffff0000, v134
    v_and_b32 v135, 0xffff0000, v135
    v_pk_mul_f32 v[22:23], v[22:23], s[68:69]
    v_pk_mul_f32 v[134:135], v[134:135], s[68:69]
    v_cvt_pk_bf16_f32 v37, v22, v23
    v_cvt_pk_bf16_f32 v45, v134, v135
    v_lshlrev_b32 v22, 16, v136
    v_lshlrev_b32 v23, 16, v137
    v_and_b32 v136, 0xffff0000, v136
    v_and_b32 v137, 0xffff0000, v137
    v_pk_mul_f32 v[22:23], v[22:23], s[68:69]
    v_pk_mul_f32 v[136:137], v[136:137], s[68:69]
    v_cvt_pk_bf16_f32 v38, v22, v23
    v_cvt_pk_bf16_f32 v46, v136, v137
    v_lshlrev_b32 v22, 16, v138
    v_lshlrev_b32 v23, 16, v139
    v_and_b32 v138, 0xffff0000, v138
    v_and_b32 v139, 0xffff0000, v139
    v_pk_mul_f32 v[22:23], v[22:23], s[68:69]
    v_pk_mul_f32 v[138:139], v[138:139], s[68:69]
    v_cvt_pk_bf16_f32 v39, v22, v23
    v_cvt_pk_bf16_f32 v47, v138, v139
    v_lshlrev_b32 v22, 16, v140
    v_lshlrev_b32 v23, 16, v141
    v_and_b32 v140, 0xffff0000, v140
    v_and_b32 v141, 0xffff0000, v141
    v_pk_mul_f32 v[22:23], v[22:23], s[68:69]
    v_pk_mul_f32 v[140:141], v[140:141], s[68:69]
    v_cvt_pk_bf16_f32 v40, v22, v23
    v_cvt_pk_bf16_f32 v48, v140, v141
    v_lshlrev_b32 v22, 16, v142
    v_lshlrev_b32 v23, 16, v143
    v_and_b32 v142, 0xffff0000, v142
    v_and_b32 v143, 0xffff0000, v143
    v_pk_mul_f32 v[22:23], v[22:23], s[68:69]
    v_pk_mul_f32 v[142:143], v[142:143], s[68:69]
    v_cvt_pk_bf16_f32 v41, v22, v23
    v_cvt_pk_bf16_f32 v49, v142, v143
    v_lshlrev_b32 v22, 16, v144
    v_lshlrev_b32 v23, 16, v145
    v_and_b32 v144, 0xffff0000, v144
    v_and_b32 v145, 0xffff0000, v145
    v_pk_mul_f32 v[22:23], v[22:23], s[68:69]
    v_pk_mul_f32 v[144:145], v[144:145], s[68:69]
    v_cvt_pk_bf16_f32 v42, v22, v23
    v_cvt_pk_bf16_f32 v50, v144, v145
    v_lshlrev_b32 v22, 16, v146
    v_lshlrev_b32 v23, 16, v147
    v_and_b32 v146, 0xffff0000, v146
    v_and_b32 v147, 0xffff0000, v147
    v_pk_mul_f32 v[22:23], v[22:23], s[68:69]
    v_pk_mul_f32 v[146:147], v[146:147], s[68:69]
    v_cvt_pk_bf16_f32 v43, v22, v23
    v_cvt_pk_bf16_f32 v51, v146, v147
    s_waitcnt lgkmcnt(0)
    v_lshl_or_b32 v228, v19, 16, v18
    v_lshl_or_b32 v229, v21, 16, v20
    ds_read_b32 v156, v16 offset:34560
    ds_read_b32 v157, v16 offset:34816
    ds_read_b32 v158, v16 offset:35072
    ds_read_b32 v159, v16 offset:35328
    ds_read_b32 v160, v16 offset:35584
    ds_read_b32 v161, v16 offset:35840
    ds_read_b32 v162, v16 offset:36096
    ds_read_b32 v163, v16 offset:36352
    v_perm_b32 v52, v149, v148, s70
    v_perm_b32 v56, v149, v148, s71
    v_perm_b32 v53, v151, v150, s70
    v_perm_b32 v57, v151, v150, s71
    v_perm_b32 v54, v153, v152, s70
    v_perm_b32 v58, v153, v152, s71
    v_perm_b32 v55, v155, v154, s70
    v_perm_b32 v59, v155, v154, s71
    s_waitcnt lgkmcnt(7)
    ds_read_b32 v148, v16 offset:42752
    ds_read_b32 v149, v16 offset:43008
    ds_read_b32 v150, v16 offset:43264
    ds_read_b32 v151, v16 offset:43520
    ds_read_b32 v152, v16 offset:43776
    ds_read_b32 v153, v16 offset:44032
    ds_read_b32 v154, v16 offset:44288
    ds_read_b32 v155, v16 offset:44544
    s_waitcnt lgkmcnt(8)
    v_perm_b32 v60, v157, v156, s70
    v_perm_b32 v64, v157, v156, s71
    v_perm_b32 v61, v159, v158, s70
    v_perm_b32 v65, v159, v158, s71
    v_perm_b32 v62, v161, v160, s70
    v_perm_b32 v66, v161, v160, s71
    v_perm_b32 v63, v163, v162, s70
    v_perm_b32 v67, v163, v162, s71
    s_waitcnt lgkmcnt(7)
    ds_read_b32 v156, v16 offset:50944
    ds_read_b32 v157, v16 offset:51200
    ds_read_b32 v158, v16 offset:51456
    ds_read_b32 v159, v16 offset:51712
    ds_read_b32 v160, v16 offset:51968
    ds_read_b32 v161, v16 offset:52224
    ds_read_b32 v162, v16 offset:52480
    ds_read_b32 v163, v16 offset:52736
    s_waitcnt lgkmcnt(8)
    v_perm_b32 v68, v149, v148, s70
    v_perm_b32 v72, v149, v148, s71
    v_perm_b32 v69, v151, v150, s70
    v_perm_b32 v73, v151, v150, s71
    v_perm_b32 v70, v153, v152, s70
    v_perm_b32 v74, v153, v152, s71
    v_perm_b32 v71, v155, v154, s70
    v_perm_b32 v75, v155, v154, s71
    s_waitcnt lgkmcnt(0)
    v_perm_b32 v76, v157, v156, s70
    v_perm_b32 v80, v157, v156, s71
    v_perm_b32 v77, v159, v158, s70
    v_perm_b32 v81, v159, v158, s71
    v_perm_b32 v78, v161, v160, s70
    v_perm_b32 v82, v161, v160, s71
    v_perm_b32 v79, v163, v162, s70
    v_perm_b32 v83, v163, v162, s71
    s_cmp_eq_u32 s27, 0
    s_cbranch_scc0 L_round
    s_mov_b32 s3, 0
L_poll:
    global_load_dwordx2 v[206:207], v187, s[22:23] sc1
L_poll1:
    s_add_u32 s3, s3, 1
    s_waitcnt vmcnt(0)
    v_cmpx_ne_u32 vcc, s26, v207
    s_cbranch_execz L_pok
    s_cmp_lt_u32 s3, 400000
    s_cbranch_scc1 L_poll
    v_mov_b32 v206, 0
L_pok:
    s_mov_b64 exec, -1
    v_add_u32 v14, 161536, v194
    ds_write_b32 v14, v206
L_round:
    v_add_u32 v15, 161536, v1
    s_and_b32 s31, s24, 3
    v_mov_b32 v148, 0
    s_waitcnt lgkmcnt(0)
    s_barrier
    ds_read_b128 v[140:143], v15
    v_mul_u32_u24 v135, 12, v0
    v_add_u32 v136, 6144, v135
    v_add_u32 v137, 12288, v135
    s_waitcnt lgkmcnt(0)
    v_lshrrev_b32 v144, 19, v140
    v_lshrrev_b32 v145, 19, v141
    v_lshrrev_b32 v146, 19, v142
    v_lshrrev_b32 v147, 19, v143
    v_add_u32 v150, v144, v145
    v_add3_u32 v12, v150, v146, v147
    v_add_u32 v13, s28, v12
    v_mov_b32 v149, v144
    v_add_u32_dpp v12, v12, v12 row_shr:1 row_mask:0xf bank_mask:0xf
    v_add_u32 v151, v150, v146
    s_set_gpr_idx_on s31, gpr_idx(SRC0)
    v_mov_b32 v14, v140
    v_mov_b32 v15, v144
    v_mov_b32 v16, v148
    s_set_gpr_idx_off
    v_add_u32_dpp v12, v12, v12 row_shr:2 row_mask:0xf bank_mask:0xf
    v_and_b32 v14, 0x7ffff, v14
    v_sub_u32 v16, v16, v13
    v_add_u32_dpp v12, v12, v12 row_shr:4 row_mask:0xf bank_mask:0xf
    v_subrev_u32 v17, s27, v15
    s_mov_b32 s31, s27
    v_add_u32_dpp v12, v12, v12 row_shr:8 row_mask:0xf bank_mask:0xf
    s_nop 1
    v_add_u32_dpp v12, v12, v12 row_bcast:15 row_mask:0xa bank_mask:0xf
    s_nop 1
    v_add_u32_dpp v12, v12, v12 row_bcast:31 row_mask:0xc bank_mask:0xf
    v_add_u32 v16, v16, v12
    v_readlane_b32 s25, v12, 63
    v_sub_u32 v14, v14, v16
    v_add_lshl_u32 v18, v16, s27, 2
    s_cmp_gt_u32 s25, 1536
    s_cbranch_scc1 L_exp
    v_cmpx_lt_i32 vcc, 0, v17
    ds_write_b32 v18, v14 offset:20224
    v_cmpx_lt_i32 vcc, 2, v17
    ds_write_b32 v18, v14 offset:20232
    v_cmpx_lt_i32 vcc, 4, v17
    ds_write_b32 v18, v14 offset:20240
    v_cmpx_lt_i32 vcc, 6, v17
    ds_write_b32 v18, v14 offset:20248
    v_cmpx_lt_i32 vcc, 8, v17
    ds_write_b32 v18, v14 offset:20256
    v_cmpx_lt_i32 vcc, 10, v17
    ds_write_b32 v18, v14 offset:20264
    v_cmpx_lt_i32 vcc, 12, v17
    s_cbranch_execz L_expd
    s_add_u32 s31, s31, 12
L_exp:
    s_mov_b64 exec, -1
    v_cmp_lt_u32 vcc, s31, v15
    s_cbranch_vccz L_expd
    v_add_u32 v19, s31, v16
    s_movk_i32 s3, 1536
    v_cmp_gt_u32 s[68:69], s3, v19
    v_lshlrev_b32 v19, 2, v19
    s_and_b64 exec, vcc, s[68:69]
    ds_write_b32 v19, v14 offset:20224
    s_add_u32 s31, s31, 2
    s_branch L_exp
L_expd:
    s_mov_b64 exec, -1
    s_waitcnt lgkmcnt(0)
    s_barrier
    ds_read_b32 v12, v194 offset:20224
    ds_read_b32 v13, v194 offset:22272
    ds_read_b32 v14, v194 offset:24320
    ds_read_b32 v152, v195 offset:20224
    ds_read_b32 v153, v195 offset:21248
    ds_read_b32 v154, v195 offset:22272
    ds_read_b32 v155, v195 offset:23296
    ds_read_b32 v156, v195 offset:24320
    ds_read_b32 v157, v195 offset:25344
    s_waitcnt lgkmcnt(8)
    v_mad_i32_i24 v12, v12, 12, v135
    buffer_load_dwordx3 v[140:142], v12, s[8:11], 0 offen sc1
    s_waitcnt lgkmcnt(7)
    v_mad_i32_i24 v13, v13, 12, v136
    buffer_load_dwordx3 v[144:146], v13, s[8:11], 0 offen sc1
    s_waitcnt lgkmcnt(6)
    v_mad_i32_i24 v14, v14, 12, v137
    buffer_load_dwordx3 v[148:150], v14, s[8:11], 0 offen sc1
    s_waitcnt lgkmcnt(0)
    v_lshl_add_u32 v152, v152, 5, v188
    v_lshl_add_u32 v153, v153, 5, v189
    v_lshl_add_u32 v154, v154, 5, v190
    v_lshl_add_u32 v155, v155, 5, v191
    v_lshl_add_u32 v156, v156, 5, v192
    v_lshl_add_u32 v157, v157, 5, v193
    s_barrier
    s_add_u32 m0, s30, 63232
    s_nop 0
    buffer_load_dwordx4 v152, s[12:15], 0 offen sc1 lds
    s_add_u32 m0, s30, 71424
    s_nop 0
    buffer_load_dwordx4 v153, s[12:15], 0 offen sc1 lds
    s_sub_u32 s29, s25, s28
    s_min_u32 s29, s29, 1536
    s_lshl_b32 s3, s29, 4
    v_cmp_gt_u32 s[56:57], s3, v188
    v_lshlrev_b32 v159, 1, v188
    v_mov_b32 v143, 0
    v_cmp_gt_u32 s[58:59], s3, v189
    v_lshlrev_b32 v161, 1, v189
    v_mov_b32 v147, 0
    v_cmp_gt_u32 s[60:61], s3, v190
    v_lshlrev_b32 v163, 1, v190
    v_mov_b32 v151, 0
    v_and_b32 v4, 15, v11
    v_lshrrev_b32 v13, 4, v11
    s_mul_i32 s3, s27, 23040
    v_mul_u32_u24 v230, 288, v4
    v_lshl_add_u32 v230, v13, 4, v230
    v_add_u32 v230, s3, v230
    s_mul_i32 s68, s27, 5120
    s_add_u32 s68, s68, s2
    s_lshl_b32 s68, s68, 10
    s_and_b32 s3, s24, 3
    s_lshl_b32 s3, s3, 8
    s_add_u32 s68, s68, s3
    v_lshl_add_u32 v231, v13, 18, s68
    v_lshl_add_u32 v231, v4, 4, v231
    v_lshlrev_b32 v4, 3, v4
    v_bfe_u32 v5, v11, 3, 2
    v_and_b32 v12, 3, v11
    v_lshl_add_u32 v5, v5, 2, v12
    v_lshlrev_b32 v5, 3, v5
    v_lshrrev_b32 v6, 2, v11
    v_lshlrev_b32 v6, 3, v6
    v_mul_u32_u24 v16, 52, v11
    v_lshrrev_b32 v16, 8, v16
    v_mul_u32_u24 v17, 5, v16
    v_sub_u32 v17, v11, v17
    v_mul_u32_u24 v15, 6, v17
    v_bfe_u32 v15, s101, v15, 6
    v_lshlrev_b32 v15, 2, v15
    v_lshlrev_b32 v16, 2, v16
    v_lshlrev_b32 v17, 19, v17
    s_mul_i32 s3, s24, 5
    v_lshlrev_b32 v18, 2, v11
    v_add_u32 v21, s3, v11
    v_lshlrev_b32 v19, 2, v21
    v_cmp_gt_u32 vcc, 40, v11
    v_add_u32 v20, 1, v11
    v_add_u32 v21, 1, v21
    v_cndmask_b32 v20, 0, v20, vcc
    s_cmp_gt_u32 s25, 1536
    s_cselect_b32 s69, 0, 8
    v_mov_b32 v22, 8
    s_waitcnt vmcnt(4)
    s_mov_b64 exec, s[56:57]
    v_and_b32 v143, 0x3ff, v142
    v_lshrrev_b32 v12, 24, v142
    v_lshlrev_b32 v143, 2, v143
    ds_add_u32 v12, v22 offset:18688
    ds_add_rtn_u32 v132, v143, v22 offset:16128
    s_waitcnt vmcnt(3)
    s_mov_b64 exec, s[58:59]
    v_and_b32 v147, 0x3ff, v146
    v_lshrrev_b32 v13, 24, v146
    v_lshlrev_b32 v147, 2, v147
    ds_add_u32 v13, v22 offset:18688
    ds_add_rtn_u32 v133, v147, v22 offset:16128
    s_waitcnt vmcnt(2)
    s_mov_b64 exec, s[60:61]
    v_and_b32 v151, 0x3ff, v150
    v_lshrrev_b32 v14, 24, v150
    v_lshlrev_b32 v151, 2, v151
    ds_add_u32 v14, v22 offset:18688
    ds_add_rtn_u32 v134, v151, v22 offset:16128
    s_mov_b64 exec, -1
    s_add_u32 m0, s30, 79616
    s_nop 0
    buffer_load_dwordx4 v154, s[12:15], 0 offen sc1 lds
    v_mfma_f32_4x4x4_16b_bf16 v[164:167], v[228:229], v[140:141], 0 cbsz:4 abid:0
    v_mfma_f32_4x4x4_16b_bf16 v[168:171], v[228:229], v[140:141], 0 cbsz:4 abid:1
    v_mfma_f32_4x4x4_16b_bf16 v[172:175], v[228:229], v[140:141], 0 cbsz:4 abid:2
    v_mfma_f32_4x4x4_16b_bf16 v[176:179], v[228:229], v[140:141], 0 cbsz:4 abid:3
    v_add_u32 v23, 112384, v159
    s_nop 0
    v_cvt_pk_bf16_f32 v180, v164, v165
    v_cvt_pk_bf16_f32 v181, v166, v167
    v_cvt_pk_bf16_f32 v182, v168, v169
    v_cvt_pk_bf16_f32 v183, v170, v171
    v_cvt_pk_bf16_f32 v184, v172, v173
    v_cvt_pk_bf16_f32 v185, v174, v175
    v_cvt_pk_bf16_f32 v186, v176, v177
    v_cvt_pk_bf16_f32 v187, v178, v179
    s_waitcnt lgkmcnt(0)
    s_barrier
    ds_read_b32 v12, v18 offset:18688
    ds_read_b32 v13, v19 offset:18688
    ds_write_b128 v23, v[180:183]
    ds_write_b128 v23, v[184:187] offset:16
    v_lshlrev_b32 v19, 4, v19
    v_and_b32 v142, 0xfffc00, v142
    v_and_b32 v146, 0xfffc00, v146
    v_and_b32 v150, 0xfffc00, v150
    s_waitcnt lgkmcnt(2)
    v_mad_u32_u24 v21, v13, s69, v21
    v_mad_u32_u24 v20, v12, s69, v20
    v_readlane_b32 s96, v21, 0
    v_readlane_b32 s97, v21, 1
    v_readlane_b32 s98, v21, 2
    v_readlane_b32 s99, v21, 3
    v_readlane_b32 s100, v21, 4
    v_lshl_add_u32 v19, v13, 16, v19
    v_cmp_lt_u32 s[36:37], s96, v20
    v_cmp_lt_u32 s[38:39], s97, v20
    v_cmp_lt_u32 s[40:41], s98, v20
    v_cmp_lt_u32 s[42:43], s99, v20
    v_cmp_lt_u32 s[44:45], s100, v20
    s_bcnt1_i32_b64 s96, s[36:37]
    v_writelane_b32 v12, s96, 0
    s_bcnt1_i32_b64 s97, s[38:39]
    v_writelane_b32 v12, s97, 1
    s_bcnt1_i32_b64 s98, s[40:41]
    v_writelane_b32 v12, s98, 2
    s_bcnt1_i32_b64 s99, s[42:43]
    v_writelane_b32 v12, s99, 3
    s_bcnt1_i32_b64 s100, s[44:45]
    v_writelane_b32 v12, s100, 4
    s_mov_b64 exec, 31
    v_lshlrev_b32 v12, 2, v12
    ds_write_b32 v12, v19 offset:19200
    s_mov_b64 exec, -1
    s_add_u32 m0, s30, 87808
    s_nop 0
    buffer_load_dwordx4 v155, s[12:15], 0 offen sc1 lds
    s_waitcnt lgkmcnt(0)
    s_barrier
    ds_read_b32 v12, v15 offset:19200
    v_mfma_f32_4x4x4_16b_bf16 v[164:167], v[228:229], v[144:145], 0 cbsz:4 abid:0
    v_mfma_f32_4x4x4_16b_bf16 v[168:171], v[228:229], v[144:145], 0 cbsz:4 abid:1
    v_mfma_f32_4x4x4_16b_bf16 v[172:175], v[228:229], v[144:145], 0 cbsz:4 abid:2
    v_mfma_f32_4x4x4_16b_bf16 v[176:179], v[228:229], v[144:145], 0 cbsz:4 abid:3
    v_add_u32 v23, 112384, v161
    s_nop 0
    v_cvt_pk_bf16_f32 v180, v164, v165
    v_cvt_pk_bf16_f32 v181, v166, v167
    v_cvt_pk_bf16_f32 v182, v168, v169
    v_cvt_pk_bf16_f32 v183, v170, v171
    v_cvt_pk_bf16_f32 v184, v172, v173
    v_cvt_pk_bf16_f32 v185, v174, v175
    v_cvt_pk_bf16_f32 v186, v176, v177
    v_cvt_pk_bf16_f32 v187, v178, v179
    s_waitcnt lgkmcnt(0)
    v_add_u32_sdwa v16, v12, v16 dst_sel:DWORD dst_unused:UNUSED_PAD src0_sel:WORD_0 src1_sel:DWORD
    ds_read_b32 v13, v16 offset:16128
    v_readlane_b32 s96, v12, 0
    v_readlane_b32 s97, v12, 1
    v_readlane_b32 s98, v12, 2
    v_readlane_b32 s99, v12, 3
    v_readlane_b32 s100, v12, 4
    s_add_u32 s3, s96, s97
    s_add_u32 s3, s3, s98
    s_add_u32 s3, s3, s99
    s_add_u32 s3, s3, s100
    s_lshr_b32 s29, s3, 16
    s_add_u32 s3, s29, 480
    v_mov_b32 v14, s3
    v_mov_b32 v18, 0
    s_mov_b64 exec, 1
    ds_add_rtn_u32 v14, v18, v14 offset:19456
    s_mov_b64 exec, -1
    s_waitcnt lgkmcnt(1)
    v_sub_u32 v17, v17, v13
    s_nop 0
    v_add_u32_dpp v13, v13, v13 row_shr:1 row_mask:0xf bank_mask:0xf
    s_nop 1
    v_add_u32_dpp v13, v13, v13 row_shr:2 row_mask:0xf bank_mask:0xf
    v_mov_b32 v20, 2147482664
    v_mov_b32 v21, 0
    v_add_u32_dpp v13, v13, v13 row_shr:4 row_mask:0xf bank_mask:0xf
    s_nop 1
    v_add_u32_dpp v13, v13, v13 row_shr:8 row_mask:0xf bank_mask:0xf
    s_waitcnt lgkmcnt(0)
    v_readfirstlane_b32 s71, v14
    v_add_u32_dpp v13, v13, v13 row_bcast:15 row_mask:0xa bank_mask:0xf
    s_add_u32 s3, s71, s29
    v_lshl_add_u32 v18, v11, 3, s3
    v_add_u32_dpp v13, v13, v13 row_bcast:31 row_mask:0xc bank_mask:0xf
    s_mov_b32 exec_hi, 0x0fffffff
    v_add3_u32 v13, v13, v17, s71
    ds_write_b32 v16, v13 offset:16128
    ds_write_b64 v18, v[20:21] offset:0
    s_mov_b64 exec, -1
    ds_write_b128 v23, v[180:183]
    ds_write_b128 v23, v[184:187] offset:16
    s_add_u32 m0, s30, 96000
    s_nop 0
    buffer_load_dwordx4 v156, s[12:15], 0 offen sc1 lds
    s_waitcnt lgkmcnt(2)
    s_barrier
    ds_read_b32 v12, v143 offset:16128
    ds_read_b32 v13, v147 offset:16128
    ds_read_b32 v14, v151 offset:16128
    v_add_u32 v4, s71, v4
    v_add_u32 v5, s71, v5
    v_add_u32 v6, s71, v6
    s_lshr_b32 s29, s29, 3
    s_mov_b64 exec, s[56:57]
    s_waitcnt lgkmcnt(2)
    v_add_u32_sdwa v132, v12, v132 dst_sel:DWORD dst_unused:UNUSED_PAD src0_sel:WORD_0 src1_sel:DWORD
    v_or_b32_sdwa v158, v12, v142 dst_sel:DWORD dst_unused:UNUSED_PAD src0_sel:WORD_1 src1_sel:DWORD
    ds_write_b64 v132, v[158:159] offset:0
    s_mov_b64 exec, s[58:59]
    s_waitcnt lgkmcnt(2)
    v_add_u32_sdwa v133, v13, v133 dst_sel:DWORD dst_unused:UNUSED_PAD src0_sel:WORD_0 src1_sel:DWORD
    v_or_b32_sdwa v160, v13, v146 dst_sel:DWORD dst_unused:UNUSED_PAD src0_sel:WORD_1 src1_sel:DWORD
    ds_write_b64 v133, v[160:161] offset:0
    s_mov_b64 exec, s[60:61]
    s_waitcnt lgkmcnt(2)
    v_add_u32_sdwa v134, v14, v134 dst_sel:DWORD dst_unused:UNUSED_PAD src0_sel:WORD_0 src1_sel:DWORD
    v_or_b32_sdwa v162, v14, v150 dst_sel:DWORD dst_unused:UNUSED_PAD src0_sel:WORD_1 src1_sel:DWORD
    ds_write_b64 v134, v[162:163] offset:0
    s_mov_b64 exec, -1
    s_add_u32 m0, s30, 104192
    s_nop 0
    buffer_load_dwordx4 v157, s[12:15], 0 offen sc1 lds
    s_waitcnt lgkmcnt(0)
    s_barrier
    ds_read_b32 v12, v4
    ds_read_b32 v7, v4 offset:64
    ds_read_b32 v9, v5 offset:4
    ds_read_b32 v10, v6 offset:4
    s_cmp_eq_u64 s[60:61], 0
    s_cbranch_scc1 L_not3
    v_mfma_f32_4x4x4_16b_bf16 v[164:167], v[228:229], v[148:149], 0 cbsz:4 abid:0
    v_mfma_f32_4x4x4_16b_bf16 v[168:171], v[228:229], v[148:149], 0 cbsz:4 abid:1
    v_mfma_f32_4x4x4_16b_bf16 v[172:175], v[228:229], v[148:149], 0 cbsz:4 abid:2
    v_mfma_f32_4x4x4_16b_bf16 v[176:179], v[228:229], v[148:149], 0 cbsz:4 abid:3
    v_add_u32 v23, 112384, v163
    s_nop 0
    v_cvt_pk_bf16_f32 v180, v164, v165
    v_cvt_pk_bf16_f32 v181, v166, v167
    v_cvt_pk_bf16_f32 v182, v168, v169
    v_cvt_pk_bf16_f32 v183, v170, v171
    v_cvt_pk_bf16_f32 v184, v172, v173
    v_cvt_pk_bf16_f32 v185, v174, v175
    v_cvt_pk_bf16_f32 v186, v176, v177
    v_cvt_pk_bf16_f32 v187, v178, v179
    ds_write_b128 v23, v[180:183]
    ds_write_b128 v23, v[184:187] offset:16
    s_waitcnt lgkmcnt(2)
    s_branch L_t3
L_not3:
    s_waitcnt lgkmcnt(0)
L_t3:
    v_readlane_b32 s36, v12, 0
    v_readlane_b32 s37, v12, 1
    v_readlane_b32 s38, v12, 2
    v_readlane_b32 s39, v12, 3
    s_and_b32 s70, s36, 0xfffffc00
    buffer_load_dwordx4 v[196:199], v1, s[4:7], s70 offen
    s_and_b32 s71, s37, 0xfffffc00
    buffer_load_dwordx4 v[200:203], v1, s[4:7], s71 offen
    s_and_b32 s70, s38, 0xfffffc00
    buffer_load_dwordx4 v[204:207], v1, s[4:7], s70 offen
    s_and_b32 s71, s39, 0xfffffc00
    buffer_load_dwordx4 v[208:211], v1, s[4:7], s71 offen
    v_readlane_b32 s40, v12, 4
    v_readlane_b32 s41, v12, 5
    v_readlane_b32 s42, v12, 6
    v_readlane_b32 s43, v12, 7
    v_add_u32 v9, v9, v2
    v_add_u32 v10, v10, v3
    v_readlane_b32 s44, v7, 0
    s_and_b32 s96, s96, 0xffff
    s_mulk_i32 s96, 18
    s_and_b32 s97, s97, 0xffff
    s_mulk_i32 s97, 18
    s_and_b32 s98, s98, 0xffff
    s_mulk_i32 s98, 18
    s_and_b32 s99, s99, 0xffff
    s_mulk_i32 s99, 18
    s_and_b32 s100, s100, 0xffff
    s_mulk_i32 s100, 18
    s_and_b32 s68, s44, 0xfffffc00
    s_waitcnt vmcnt(4) lgkmcnt(0)
    s_barrier
    s_cmp_eq_u32 s29, 0
    s_cbranch_scc1 L_exit
    s_sub_u32 s29, s29, 1
    s_mov_b64 exec, s[32:33]
    ds_read_b128 v[24:27], v9 offset:63232
    s_mov_b64 exec, s[34:35]
    ds_read_b128 v[28:31], v9 offset:63232
    s_mov_b64 exec, -1
    ds_read_b64 v[32:33], v10
    s_and_b32 s70, s40, 0xfffffc00
    buffer_load_dwordx4 v[212:215], v1, s[4:7], s70 offen
    s_and_b32 s71, s41, 0xfffffc00
    buffer_load_dwordx4 v[216:219], v1, s[4:7], s71 offen
    s_waitcnt lgkmcnt(1)
    v_mfma_f32_32x32x16_bf16 v[132:147], v[24:27], v[36:39], 0
    v_mfma_f32_32x32x16_bf16 v[132:147], v[28:31], v[40:43], v[132:147]
    v_mfma_f32_32x32x16_bf16 v[148:163], v[24:27], v[44:47], 0
    v_mfma_f32_32x32x16_bf16 v[148:163], v[28:31], v[48:51], v[148:163]
    s_and_b32 s70, s42, 0xfffffc00
    buffer_load_dwordx4 v[220:223], v1, s[4:7], s70 offen
    s_and_b32 s71, s43, 0xfffffc00
    buffer_load_dwordx4 v[224:227], v1, s[4:7], s71 offen
    s_waitcnt lgkmcnt(0)
    s_nop 6
    v_exp_f32 v12, v132
    v_exp_f32 v13, v133
    v_exp_f32 v14, v148
    v_exp_f32 v15, v149
    v_pk_add_f32 v[12:13], v[12:13], 1.0 op_sel_hi:[1,0]
    v_pk_add_f32 v[14:15], v[14:15], 1.0 op_sel_hi:[1,0]
    v_rcp_f32 v12, v12
    v_rcp_f32 v13, v13
    s_nop 0
    v_pk_mul_f32 v[132:133], v[132:133], v[12:13]
L_loop:
    s_setprio 3
    ds_read_b32 v9, v5 offset:132
    ds_read_b32 v10, v6 offset:132
    ds_read_b32 v8, v4 offset:192
    s_waitcnt vmcnt(7)
    v_rcp_f32 v14, v14
    v_mfma_f32_4x4x4_16b_bf16 v[16:19], v[32:33], v[196:197], 0 cbsz:4 abid:0
    v_exp_f32 v13, v135
    v_mfma_f32_4x4x4_16b_bf16 v[20:23], v[32:33], v[198:199], 0 cbsz:4 abid:0
    v_exp_f32 v12, v134
    v_readlane_b32 s45, v7, 1
    v_rcp_f32 v15, v15
    v_pk_add_f32 v[12:13], v[12:13], 1.0 op_sel_hi:[1,0]
    v_pk_mul_f32 v[148:149], v[148:149], v[14:15]
    s_and_b32 s69, s45, 0xfffffc00
    s_set_gpr_idx_on s36, gpr_idx(SRC2,DST)
    buffer_load_dwordx4 v[196:199], v1, s[4:7], s68 offen
    v_pk_fma_f32 v[84:85], v[132:133], v[16:17], v[84:85] op_sel_hi:[0,1,1]
    v_pk_fma_f32 v[86:87], v[132:133], v[18:19], v[86:87] op_sel_hi:[0,1,1]
    v_pk_fma_f32 v[88:89], v[148:149], v[20:21], v[88:89] op_sel_hi:[0,1,1]
    v_pk_fma_f32 v[90:91], v[148:149], v[22:23], v[90:91] op_sel_hi:[0,1,1]
    s_set_gpr_idx_off
    s_waitcnt vmcnt(7)
    v_rcp_f32 v12, v12
    v_mfma_f32_4x4x4_16b_bf16 v[16:19], v[32:33], v[200:201], 0 cbsz:4 abid:1
    v_exp_f32 v15, v151
    v_mfma_f32_4x4x4_16b_bf16 v[20:23], v[32:33], v[202:203], 0 cbsz:4 abid:1
    v_exp_f32 v14, v150
    v_readlane_b32 s46, v7, 2
    v_rcp_f32 v13, v13
    v_pk_add_f32 v[14:15], v[14:15], 1.0 op_sel_hi:[1,0]
    v_pk_mul_f32 v[134:135], v[134:135], v[12:13]
    s_and_b32 s68, s46, 0xfffffc00
    s_set_gpr_idx_on s37, gpr_idx(SRC2,DST)
    buffer_load_dwordx4 v[200:203], v1, s[4:7], s69 offen
    v_pk_fma_f32 v[84:85], v[132:133], v[16:17], v[84:85] op_sel:[1,0,0]
    v_pk_fma_f32 v[86:87], v[132:133], v[18:19], v[86:87] op_sel:[1,0,0]
    v_pk_fma_f32 v[88:89], v[148:149], v[20:21], v[88:89] op_sel:[1,0,0]
    v_pk_fma_f32 v[90:91], v[148:149], v[22:23], v[90:91] op_sel:[1,0,0]
    s_set_gpr_idx_off
    s_waitcnt lgkmcnt(0)
    v_add_u32 v9, v9, v2
    v_add_u32 v10, v10, v3
    s_mov_b64 exec, s[32:33]
    ds_read_b128 v[24:27], v9 offset:63232
    s_mov_b64 exec, s[34:35]
    ds_read_b128 v[28:31], v9 offset:63232
    s_mov_b64 exec, -1
    ds_read_b64 v[34:35], v10
    s_waitcnt vmcnt(7)
    v_rcp_f32 v14, v14
    v_mfma_f32_4x4x4_16b_bf16 v[16:19], v[32:33], v[204:205], 0 cbsz:4 abid:2
    v_exp_f32 v13, v137
    v_mfma_f32_4x4x4_16b_bf16 v[20:23], v[32:33], v[206:207], 0 cbsz:4 abid:2
    v_exp_f32 v12, v136
    v_readlane_b32 s47, v7, 3
    v_rcp_f32 v15, v15
    v_pk_add_f32 v[12:13], v[12:13], 1.0 op_sel_hi:[1,0]
    v_pk_mul_f32 v[150:151], v[150:151], v[14:15]
    s_and_b32 s69, s47, 0xfffffc00
    s_set_gpr_idx_on s38, gpr_idx(SRC2,DST)
    buffer_load_dwordx4 v[204:207], v1, s[4:7], s68 offen
    v_pk_fma_f32 v[84:85], v[134:135], v[16:17], v[84:85] op_sel_hi:[0,1,1]
    v_pk_fma_f32 v[86:87], v[134:135], v[18:19], v[86:87] op_sel_hi:[0,1,1]
    v_pk_fma_f32 v[88:89], v[150:151], v[20:21], v[88:89] op_sel_hi:[0,1,1]
    v_pk_fma_f32 v[90:91], v[150:151], v[22:23], v[90:91] op_sel_hi:[0,1,1]
    s_set_gpr_idx_off
    s_waitcnt vmcnt(7)
    v_rcp_f32 v12, v12
    v_mfma_f32_4x4x4_16b_bf16 v[16:19], v[32:33], v[208:209], 0 cbsz:4 abid:3
    v_exp_f32 v15, v153
    v_mfma_f32_4x4x4_16b_bf16 v[20:23], v[32:33], v[210:211], 0 cbsz:4 abid:3
    v_exp_f32 v14, v152
    v_readlane_b32 s48, v7, 4
    v_rcp_f32 v13, v13
    v_pk_add_f32 v[14:15], v[14:15], 1.0 op_sel_hi:[1,0]
    v_pk_mul_f32 v[136:137], v[136:137], v[12:13]
    s_and_b32 s68, s48, 0xfffffc00
    s_set_gpr_idx_on s39, gpr_idx(SRC2,DST)
    buffer_load_dwordx4 v[208:211], v1, s[4:7], s69 offen
    v_pk_fma_f32 v[84:85], v[134:135], v[16:17], v[84:85] op_sel:[1,0,0]
    v_pk_fma_f32 v[86:87], v[134:135], v[18:19], v[86:87] op_sel:[1,0,0]
    v_pk_fma_f32 v[88:89], v[150:151], v[20:21], v[88:89] op_sel:[1,0,0]
    v_pk_fma_f32 v[90:91], v[150:151], v[22:23], v[90:91] op_sel:[1,0,0]
    s_set_gpr_idx_off
    s_sub_u32 s29, s29, 4
    s_cbranch_scc1 L_exit
    s_setprio 2
    s_waitcnt vmcnt(7)
    v_rcp_f32 v14, v14
    v_mfma_f32_4x4x4_16b_bf16 v[16:19], v[32:33], v[212:213], 0 cbsz:4 abid:4
    v_exp_f32 v13, v139
    v_mfma_f32_4x4x4_16b_bf16 v[20:23], v[32:33], v[214:215], 0 cbsz:4 abid:4
    v_exp_f32 v12, v138
    v_readlane_b32 s49, v7, 5
    v_rcp_f32 v15, v15
    v_pk_add_f32 v[12:13], v[12:13], 1.0 op_sel_hi:[1,0]
    v_pk_mul_f32 v[152:153], v[152:153], v[14:15]
    s_and_b32 s69, s49, 0xfffffc00
    s_set_gpr_idx_on s40, gpr_idx(SRC2,DST)
    buffer_load_dwordx4 v[212:215], v1, s[4:7], s68 offen
    v_pk_fma_f32 v[84:85], v[136:137], v[16:17], v[84:85] op_sel_hi:[0,1,1]
    v_pk_fma_f32 v[86:87], v[136:137], v[18:19], v[86:87] op_sel_hi:[0,1,1]
    v_pk_fma_f32 v[88:89], v[152:153], v[20:21], v[88:89] op_sel_hi:[0,1,1]
    v_pk_fma_f32 v[90:91], v[152:153], v[22:23], v[90:91] op_sel_hi:[0,1,1]
    s_set_gpr_idx_off
    s_waitcnt vmcnt(7) lgkmcnt(0)
    v_mfma_f32_4x4x4_16b_bf16 v[20:23], v[32:33], v[218:219], 0 cbsz:4 abid:5
    v_mfma_f32_4x4x4_16b_bf16 v[16:19], v[32:33], v[216:217], 0 cbsz:4 abid:5
    v_rcp_f32 v13, v13
    v_mfma_f32_32x32x16_bf16 v[164:179], v[24:27], v[36:39], 0
    v_exp_f32 v14, v154
    v_exp_f32 v15, v155
    v_readlane_b32 s50, v7, 6
    v_rcp_f32 v12, v12
    v_pk_add_f32 v[14:15], v[14:15], 1.0 op_sel_hi:[1,0]
    v_pk_mul_f32 v[138:139], v[138:139], v[12:13]
    s_and_b32 s68, s50, 0xfffffc00
    s_set_gpr_idx_on s41, gpr_idx(SRC2,DST)
    buffer_load_dwordx4 v[216:219], v1, s[4:7], s69 offen
    v_pk_fma_f32 v[84:85], v[136:137], v[16:17], v[84:85] op_sel:[1,0,0]
    v_pk_fma_f32 v[86:87], v[136:137], v[18:19], v[86:87] op_sel:[1,0,0]
    v_pk_fma_f32 v[88:89], v[152:153], v[20:21], v[88:89] op_sel:[1,0,0]
    v_pk_fma_f32 v[90:91], v[152:153], v[22:23], v[90:91] op_sel:[1,0,0]
    s_set_gpr_idx_off
    s_waitcnt vmcnt(7)
    v_rcp_f32 v14, v14
    v_mfma_f32_4x4x4_16b_bf16 v[16:19], v[32:33], v[220:221], 0 cbsz:4 abid:6
    v_exp_f32 v13, v141
    v_mfma_f32_4x4x4_16b_bf16 v[20:23], v[32:33], v[222:223], 0 cbsz:4 abid:6
    v_exp_f32 v12, v140
    v_readlane_b32 s51, v7, 7
    v_rcp_f32 v15, v15
    v_pk_add_f32 v[12:13], v[12:13], 1.0 op_sel_hi:[1,0]
    v_pk_mul_f32 v[154:155], v[154:155], v[14:15]
    s_and_b32 s69, s51, 0xfffffc00
    s_set_gpr_idx_on s42, gpr_idx(SRC2,DST)
    buffer_load_dwordx4 v[220:223], v1, s[4:7], s68 offen
    v_pk_fma_f32 v[84:85], v[138:139], v[16:17], v[84:85] op_sel_hi:[0,1,1]
    v_pk_fma_f32 v[86:87], v[138:139], v[18:19], v[86:87] op_sel_hi:[0,1,1]
    v_pk_fma_f32 v[88:89], v[154:155], v[20:21], v[88:89] op_sel_hi:[0,1,1]
    v_pk_fma_f32 v[90:91], v[154:155], v[22:23], v[90:91] op_sel_hi:[0,1,1]
    s_set_gpr_idx_off
    s_waitcnt vmcnt(7)
    v_mfma_f32_4x4x4_16b_bf16 v[20:23], v[32:33], v[226:227], 0 cbsz:4 abid:7
    v_mfma_f32_4x4x4_16b_bf16 v[16:19], v[32:33], v[224:225], 0 cbsz:4 abid:7
    v_rcp_f32 v13, v13
    v_mfma_f32_32x32x16_bf16 v[164:179], v[28:31], v[40:43], v[164:179]
    v_exp_f32 v14, v156
    v_exp_f32 v15, v157
    v_readlane_b32 s52, v7, 8
    v_rcp_f32 v12, v12
    v_pk_add_f32 v[14:15], v[14:15], 1.0 op_sel_hi:[1,0]
    v_pk_mul_f32 v[140:141], v[140:141], v[12:13]
    s_and_b32 s68, s52, 0xfffffc00
    s_set_gpr_idx_on s43, gpr_idx(SRC2,DST)
    buffer_load_dwordx4 v[224:227], v1, s[4:7], s69 offen
    v_pk_fma_f32 v[84:85], v[138:139], v[16:17], v[84:85] op_sel:[1,0,0]
    v_pk_fma_f32 v[86:87], v[138:139], v[18:19], v[86:87] op_sel:[1,0,0]
    v_pk_fma_f32 v[88:89], v[154:155], v[20:21], v[88:89] op_sel:[1,0,0]
    v_pk_fma_f32 v[90:91], v[154:155], v[22:23], v[90:91] op_sel:[1,0,0]
    s_set_gpr_idx_off
    s_sub_u32 s29, s29, 4
    s_cbranch_scc1 L_exit
    s_setprio 1
    s_waitcnt vmcnt(7)
    v_rcp_f32 v14, v14
    v_mfma_f32_4x4x4_16b_bf16 v[16:19], v[32:33], v[196:197], 0 cbsz:4 abid:8
    v_exp_f32 v13, v143
    v_mfma_f32_4x4x4_16b_bf16 v[20:23], v[32:33], v[198:199], 0 cbsz:4 abid:8
    v_exp_f32 v12, v142
    v_readlane_b32 s53, v7, 9
    v_rcp_f32 v15, v15
    v_pk_add_f32 v[12:13], v[12:13], 1.0 op_sel_hi:[1,0]
    v_pk_mul_f32 v[156:157], v[156:157], v[14:15]
    s_and_b32 s69, s53, 0xfffffc00
    s_set_gpr_idx_on s44, gpr_idx(SRC2,DST)
    buffer_load_dwordx4 v[196:199], v1, s[4:7], s68 offen
    v_pk_fma_f32 v[84:85], v[140:141], v[16:17], v[84:85] op_sel_hi:[0,1,1]
    v_pk_fma_f32 v[86:87], v[140:141], v[18:19], v[86:87] op_sel_hi:[0,1,1]
    v_pk_fma_f32 v[88:89], v[156:157], v[20:21], v[88:89] op_sel_hi:[0,1,1]
    v_pk_fma_f32 v[90:91], v[156:157], v[22:23], v[90:91] op_sel_hi:[0,1,1]
    s_set_gpr_idx_off
    s_waitcnt vmcnt(7)
    v_mfma_f32_4x4x4_16b_bf16 v[20:23], v[32:33], v[202:203], 0 cbsz:4 abid:9
    v_mfma_f32_4x4x4_16b_bf16 v[16:19], v[32:33], v[200:201], 0 cbsz:4 abid:9
    v_rcp_f32 v13, v13
    v_mfma_f32_32x32x16_bf16 v[180:195], v[24:27], v[44:47], 0
    v_exp_f32 v14, v158
    v_exp_f32 v15, v159
    v_readlane_b32 s54, v7, 10
    v_rcp_f32 v12, v12
    v_pk_add_f32 v[14:15], v[14:15], 1.0 op_sel_hi:[1,0]
    v_pk_mul_f32 v[142:143], v[142:143], v[12:13]
    s_and_b32 s68, s54, 0xfffffc00
    s_set_gpr_idx_on s45, gpr_idx(SRC2,DST)
    buffer_load_dwordx4 v[200:203], v1, s[4:7], s69 offen
    v_pk_fma_f32 v[84:85], v[140:141], v[16:17], v[84:85] op_sel:[1,0,0]
    v_pk_fma_f32 v[86:87], v[140:141], v[18:19], v[86:87] op_sel:[1,0,0]
    v_pk_fma_f32 v[88:89], v[156:157], v[20:21], v[88:89] op_sel:[1,0,0]
    v_pk_fma_f32 v[90:91], v[156:157], v[22:23], v[90:91] op_sel:[1,0,0]
    s_set_gpr_idx_off
    s_waitcnt vmcnt(7)
    v_rcp_f32 v14, v14
    v_mfma_f32_4x4x4_16b_bf16 v[16:19], v[32:33], v[204:205], 0 cbsz:4 abid:10
    v_exp_f32 v13, v145
    v_mfma_f32_4x4x4_16b_bf16 v[20:23], v[32:33], v[206:207], 0 cbsz:4 abid:10
    v_exp_f32 v12, v144
    v_readlane_b32 s55, v7, 11
    v_rcp_f32 v15, v15
    v_pk_add_f32 v[12:13], v[12:13], 1.0 op_sel_hi:[1,0]
    v_pk_mul_f32 v[158:159], v[158:159], v[14:15]
    s_and_b32 s69, s55, 0xfffffc00
    s_set_gpr_idx_on s46, gpr_idx(SRC2,DST)
    buffer_load_dwordx4 v[204:207], v1, s[4:7], s68 offen
    v_pk_fma_f32 v[84:85], v[142:143], v[16:17], v[84:85] op_sel_hi:[0,1,1]
    v_pk_fma_f32 v[86:87], v[142:143], v[18:19], v[86:87] op_sel_hi:[0,1,1]
    v_pk_fma_f32 v[88:89], v[158:159], v[20:21], v[88:89] op_sel_hi:[0,1,1]
    v_pk_fma_f32 v[90:91], v[158:159], v[22:23], v[90:91] op_sel_hi:[0,1,1]
    s_set_gpr_idx_off
    s_waitcnt vmcnt(7)
    v_mfma_f32_4x4x4_16b_bf16 v[20:23], v[32:33], v[210:211], 0 cbsz:4 abid:11
    v_mfma_f32_4x4x4_16b_bf16 v[16:19], v[32:33], v[208:209], 0 cbsz:4 abid:11
    v_rcp_f32 v13, v13
    v_mfma_f32_32x32x16_bf16 v[180:195], v[28:31], v[48:51], v[180:195]
    v_exp_f32 v14, v160
    v_exp_f32 v15, v161
    v_readlane_b32 s56, v7, 12
    v_rcp_f32 v12, v12
    v_pk_add_f32 v[14:15], v[14:15], 1.0 op_sel_hi:[1,0]
    v_pk_mul_f32 v[144:145], v[144:145], v[12:13]
    s_and_b32 s68, s56, 0xfffffc00
    s_set_gpr_idx_on s47, gpr_idx(SRC2,DST)
    buffer_load_dwordx4 v[208:211], v1, s[4:7], s69 offen
    v_pk_fma_f32 v[84:85], v[142:143], v[16:17], v[84:85] op_sel:[1,0,0]
    v_pk_fma_f32 v[86:87], v[142:143], v[18:19], v[86:87] op_sel:[1,0,0]
    v_pk_fma_f32 v[88:89], v[158:159], v[20:21], v[88:89] op_sel:[1,0,0]
    v_pk_fma_f32 v[90:91], v[158:159], v[22:23], v[90:91] op_sel:[1,0,0]
    s_set_gpr_idx_off
    s_sub_u32 s29, s29, 4
    s_cbranch_scc1 L_exit
    s_setprio 0
    s_waitcnt vmcnt(7)
    v_rcp_f32 v14, v14
    v_mfma_f32_4x4x4_16b_bf16 v[16:19], v[32:33], v[212:213], 0 cbsz:4 abid:12
    v_exp_f32 v13, v147
    v_mfma_f32_4x4x4_16b_bf16 v[20:23], v[32:33], v[214:215], 0 cbsz:4 abid:12
    v_exp_f32 v12, v146
    v_readlane_b32 s57, v7, 13
    v_rcp_f32 v15, v15
    v_pk_add_f32 v[12:13], v[12:13], 1.0 op_sel_hi:[1,0]
    v_pk_mul_f32 v[160:161], v[160:161], v[14:15]
    s_and_b32 s69, s57, 0xfffffc00
    s_set_gpr_idx_on s48, gpr_idx(SRC2,DST)
    buffer_load_dwordx4 v[212:215], v1, s[4:7], s68 offen
    v_pk_fma_f32 v[84:85], v[144:145], v[16:17], v[84:85] op_sel_hi:[0,1,1]
    v_pk_fma_f32 v[86:87], v[144:145], v[18:19], v[86:87] op_sel_hi:[0,1,1]
    v_pk_fma_f32 v[88:89], v[160:161], v[20:21], v[88:89] op_sel_hi:[0,1,1]
    v_pk_fma_f32 v[90:91], v[160:161], v[22:23], v[90:91] op_sel_hi:[0,1,1]
    s_set_gpr_idx_off
    s_waitcnt vmcnt(7)
    v_rcp_f32 v12, v12
    v_mfma_f32_4x4x4_16b_bf16 v[16:19], v[32:33], v[216:217], 0 cbsz:4 abid:13
    v_exp_f32 v15, v163
    v_mfma_f32_4x4x4_16b_bf16 v[20:23], v[32:33], v[218:219], 0 cbsz:4 abid:13
    v_exp_f32 v14, v162
    v_readlane_b32 s58, v7, 14
    v_rcp_f32 v13, v13
    v_pk_add_f32 v[14:15], v[14:15], 1.0 op_sel_hi:[1,0]
    v_pk_mul_f32 v[146:147], v[146:147], v[12:13]
    s_and_b32 s68, s58, 0xfffffc00
    s_set_gpr_idx_on s49, gpr_idx(SRC2,DST)
    buffer_load_dwordx4 v[216:219], v1, s[4:7], s69 offen
    v_pk_fma_f32 v[84:85], v[144:145], v[16:17], v[84:85] op_sel:[1,0,0]
    v_pk_fma_f32 v[86:87], v[144:145], v[18:19], v[86:87] op_sel:[1,0,0]
    v_pk_fma_f32 v[88:89], v[160:161], v[20:21], v[88:89] op_sel:[1,0,0]
    v_pk_fma_f32 v[90:91], v[160:161], v[22:23], v[90:91] op_sel:[1,0,0]
    s_set_gpr_idx_off
    s_waitcnt vmcnt(7)
    v_rcp_f32 v14, v14
    v_mfma_f32_4x4x4_16b_bf16 v[16:19], v[32:33], v[220:221], 0 cbsz:4 abid:14
    v_exp_f32 v13, v165
    v_mfma_f32_4x4x4_16b_bf16 v[20:23], v[32:33], v[222:223], 0 cbsz:4 abid:14
    v_exp_f32 v12, v164
    v_readlane_b32 s59, v7, 15
    v_rcp_f32 v15, v15
    v_pk_add_f32 v[12:13], v[12:13], 1.0 op_sel_hi:[1,0]
    v_pk_mul_f32 v[162:163], v[162:163], v[14:15]
    s_and_b32 s69, s59, 0xfffffc00
    s_set_gpr_idx_on s50, gpr_idx(SRC2,DST)
    buffer_load_dwordx4 v[220:223], v1, s[4:7], s68 offen
    v_pk_fma_f32 v[84:85], v[146:147], v[16:17], v[84:85] op_sel_hi:[0,1,1]
    v_pk_fma_f32 v[86:87], v[146:147], v[18:19], v[86:87] op_sel_hi:[0,1,1]
    v_pk_fma_f32 v[88:89], v[162:163], v[20:21], v[88:89] op_sel_hi:[0,1,1]
    v_pk_fma_f32 v[90:91], v[162:163], v[22:23], v[90:91] op_sel_hi:[0,1,1]
    s_set_gpr_idx_off
    s_waitcnt vmcnt(7)
    v_rcp_f32 v12, v12
    v_mfma_f32_4x4x4_16b_bf16 v[16:19], v[32:33], v[224:225], 0 cbsz:4 abid:15
    v_exp_f32 v15, v181
    v_mfma_f32_4x4x4_16b_bf16 v[20:23], v[32:33], v[226:227], 0 cbsz:4 abid:15
    v_exp_f32 v14, v180
    v_readlane_b32 s60, v8, 0
    v_rcp_f32 v13, v13
    v_pk_add_f32 v[14:15], v[14:15], 1.0 op_sel_hi:[1,0]
    v_pk_mul_f32 v[164:165], v[164:165], v[12:13]
    s_and_b32 s68, s60, 0xfffffc00
    s_set_gpr_idx_on s51, gpr_idx(SRC2,DST)
    buffer_load_dwordx4 v[224:227], v1, s[4:7], s69 offen
    v_pk_fma_f32 v[84:85], v[146:147], v[16:17], v[84:85] op_sel:[1,0,0]
    v_pk_fma_f32 v[86:87], v[146:147], v[18:19], v[86:87] op_sel:[1,0,0]
    v_pk_fma_f32 v[88:89], v[162:163], v[20:21], v[88:89] op_sel:[1,0,0]
    v_pk_fma_f32 v[90:91], v[162:163], v[22:23], v[90:91] op_sel:[1,0,0]
    s_set_gpr_idx_off
    s_sub_u32 s29, s29, 4
    s_cbranch_scc1 L_exit
    s_setprio 3
    ds_read_b32 v9, v5 offset:260
    ds_read_b32 v10, v6 offset:260
    ds_read_b32 v7, v4 offset:320
    s_waitcnt vmcnt(7)
    v_rcp_f32 v14, v14
    v_mfma_f32_4x4x4_16b_bf16 v[16:19], v[34:35], v[196:197], 0 cbsz:4 abid:0
    v_exp_f32 v13, v167
    v_mfma_f32_4x4x4_16b_bf16 v[20:23], v[34:35], v[198:199], 0 cbsz:4 abid:0
    v_exp_f32 v12, v166
    v_readlane_b32 s61, v8, 1
    v_rcp_f32 v15, v15
    v_pk_add_f32 v[12:13], v[12:13], 1.0 op_sel_hi:[1,0]
    v_pk_mul_f32 v[180:181], v[180:181], v[14:15]
    s_and_b32 s69, s61, 0xfffffc00
    s_set_gpr_idx_on s52, gpr_idx(SRC2,DST)
    buffer_load_dwordx4 v[196:199], v1, s[4:7], s68 offen
    v_pk_fma_f32 v[84:85], v[164:165], v[16:17], v[84:85] op_sel_hi:[0,1,1]
    v_pk_fma_f32 v[86:87], v[164:165], v[18:19], v[86:87] op_sel_hi:[0,1,1]
    v_pk_fma_f32 v[88:89], v[180:181], v[20:21], v[88:89] op_sel_hi:[0,1,1]
    v_pk_fma_f32 v[90:91], v[180:181], v[22:23], v[90:91] op_sel_hi:[0,1,1]
    s_set_gpr_idx_off
    s_waitcnt vmcnt(7)
    v_rcp_f32 v12, v12
    v_mfma_f32_4x4x4_16b_bf16 v[16:19], v[34:35], v[200:201], 0 cbsz:4 abid:1
    v_exp_f32 v15, v183
    v_mfma_f32_4x4x4_16b_bf16 v[20:23], v[34:35], v[202:203], 0 cbsz:4 abid:1
    v_exp_f32 v14, v182
    v_readlane_b32 s62, v8, 2
    v_rcp_f32 v13, v13
    v_pk_add_f32 v[14:15], v[14:15], 1.0 op_sel_hi:[1,0]
    v_pk_mul_f32 v[166:167], v[166:167], v[12:13]
    s_and_b32 s68, s62, 0xfffffc00
    s_set_gpr_idx_on s53, gpr_idx(SRC2,DST)
    buffer_load_dwordx4 v[200:203], v1, s[4:7], s69 offen
    v_pk_fma_f32 v[84:85], v[164:165], v[16:17], v[84:85] op_sel:[1,0,0]
    v_pk_fma_f32 v[86:87], v[164:165], v[18:19], v[86:87] op_sel:[1,0,0]
    v_pk_fma_f32 v[88:89], v[180:181], v[20:21], v[88:89] op_sel:[1,0,0]
    v_pk_fma_f32 v[90:91], v[180:181], v[22:23], v[90:91] op_sel:[1,0,0]
    s_set_gpr_idx_off
    s_waitcnt lgkmcnt(0)
    v_add_u32 v9, v9, v2
    v_add_u32 v10, v10, v3
    s_mov_b64 exec, s[32:33]
    ds_read_b128 v[24:27], v9 offset:63232
    s_mov_b64 exec, s[34:35]
    ds_read_b128 v[28:31], v9 offset:63232
    s_mov_b64 exec, -1
    ds_read_b64 v[32:33], v10
    s_waitcnt vmcnt(7)
    v_rcp_f32 v14, v14
    v_mfma_f32_4x4x4_16b_bf16 v[16:19], v[34:35], v[204:205], 0 cbsz:4 abid:2
    v_exp_f32 v13, v169
    v_mfma_f32_4x4x4_16b_bf16 v[20:23], v[34:35], v[206:207], 0 cbsz:4 abid:2
    v_exp_f32 v12, v168
    v_readlane_b32 s63, v8, 3
    v_rcp_f32 v15, v15
    v_pk_add_f32 v[12:13], v[12:13], 1.0 op_sel_hi:[1,0]
    v_pk_mul_f32 v[182:183], v[182:183], v[14:15]
    s_and_b32 s69, s63, 0xfffffc00
    s_set_gpr_idx_on s54, gpr_idx(SRC2,DST)
    buffer_load_dwordx4 v[204:207], v1, s[4:7], s68 offen
    v_pk_fma_f32 v[84:85], v[166:167], v[16:17], v[84:85] op_sel_hi:[0,1,1]
    v_pk_fma_f32 v[86:87], v[166:167], v[18:19], v[86:87] op_sel_hi:[0,1,1]
    v_pk_fma_f32 v[88:89], v[182:183], v[20:21], v[88:89] op_sel_hi:[0,1,1]
    v_pk_fma_f32 v[90:91], v[182:183], v[22:23], v[90:91] op_sel_hi:[0,1,1]
    s_set_gpr_idx_off
    s_waitcnt vmcnt(7)
    v_rcp_f32 v12, v12
    v_mfma_f32_4x4x4_16b_bf16 v[16:19], v[34:35], v[208:209], 0 cbsz:4 abid:3
    v_exp_f32 v15, v185
    v_mfma_f32_4x4x4_16b_bf16 v[20:23], v[34:35], v[210:211], 0 cbsz:4 abid:3
    v_exp_f32 v14, v184
    v_readlane_b32 s64, v8, 4
    v_rcp_f32 v13, v13
    v_pk_add_f32 v[14:15], v[14:15], 1.0 op_sel_hi:[1,0]
    v_pk_mul_f32 v[168:169], v[168:169], v[12:13]
    s_and_b32 s68, s64, 0xfffffc00
    s_set_gpr_idx_on s55, gpr_idx(SRC2,DST)
    buffer_load_dwordx4 v[208:211], v1, s[4:7], s69 offen
    v_pk_fma_f32 v[84:85], v[166:167], v[16:17], v[84:85] op_sel:[1,0,0]
    v_pk_fma_f32 v[86:87], v[166:167], v[18:19], v[86:87] op_sel:[1,0,0]
    v_pk_fma_f32 v[88:89], v[182:183], v[20:21], v[88:89] op_sel:[1,0,0]
    v_pk_fma_f32 v[90:91], v[182:183], v[22:23], v[90:91] op_sel:[1,0,0]
    s_set_gpr_idx_off
    s_sub_u32 s29, s29, 4
    s_cbranch_scc1 L_exit
    s_setprio 2
    s_waitcnt vmcnt(7)
    v_rcp_f32 v14, v14
    v_mfma_f32_4x4x4_16b_bf16 v[16:19], v[34:35], v[212:213], 0 cbsz:4 abid:4
    v_exp_f32 v13, v171
    v_mfma_f32_4x4x4_16b_bf16 v[20:23], v[34:35], v[214:215], 0 cbsz:4 abid:4
    v_exp_f32 v12, v170
    v_readlane_b32 s65, v8, 5
    v_rcp_f32 v15, v15
    v_pk_add_f32 v[12:13], v[12:13], 1.0 op_sel_hi:[1,0]
    v_pk_mul_f32 v[184:185], v[184:185], v[14:15]
    s_and_b32 s69, s65, 0xfffffc00
    s_set_gpr_idx_on s56, gpr_idx(SRC2,DST)
    buffer_load_dwordx4 v[212:215], v1, s[4:7], s68 offen
    v_pk_fma_f32 v[84:85], v[168:169], v[16:17], v[84:85] op_sel_hi:[0,1,1]
    v_pk_fma_f32 v[86:87], v[168:169], v[18:19], v[86:87] op_sel_hi:[0,1,1]
    v_pk_fma_f32 v[88:89], v[184:185], v[20:21], v[88:89] op_sel_hi:[0,1,1]
    v_pk_fma_f32 v[90:91], v[184:185], v[22:23], v[90:91] op_sel_hi:[0,1,1]
    s_set_gpr_idx_off
    s_waitcnt vmcnt(7) lgkmcnt(0)
    v_mfma_f32_4x4x4_16b_bf16 v[20:23], v[34:35], v[218:219], 0 cbsz:4 abid:5
    v_mfma_f32_4x4x4_16b_bf16 v[16:19], v[34:35], v[216:217], 0 cbsz:4 abid:5
    v_rcp_f32 v13, v13
    v_mfma_f32_32x32x16_bf16 v[132:147], v[24:27], v[36:39], 0
    v_exp_f32 v14, v186
    v_exp_f32 v15, v187
    v_readlane_b32 s66, v8, 6
    v_rcp_f32 v12, v12
    v_pk_add_f32 v[14:15], v[14:15], 1.0 op_sel_hi:[1,0]
    v_pk_mul_f32 v[170:171], v[170:171], v[12:13]
    s_and_b32 s68, s66, 0xfffffc00
    s_set_gpr_idx_on s57, gpr_idx(SRC2,DST)
    buffer_load_dwordx4 v[216:219], v1, s[4:7], s69 offen
    v_pk_fma_f32 v[84:85], v[168:169], v[16:17], v[84:85] op_sel:[1,0,0]
    v_pk_fma_f32 v[86:87], v[168:169], v[18:19], v[86:87] op_sel:[1,0,0]
    v_pk_fma_f32 v[88:89], v[184:185], v[20:21], v[88:89] op_sel:[1,0,0]
    v_pk_fma_f32 v[90:91], v[184:185], v[22:23], v[90:91] op_sel:[1,0,0]
    s_set_gpr_idx_off
    s_waitcnt vmcnt(7)
    v_rcp_f32 v14, v14
    v_mfma_f32_4x4x4_16b_bf16 v[16:19], v[34:35], v[220:221], 0 cbsz:4 abid:6
    v_exp_f32 v13, v173
    v_mfma_f32_4x4x4_16b_bf16 v[20:23], v[34:35], v[222:223], 0 cbsz:4 abid:6
    v_exp_f32 v12, v172
    v_readlane_b32 s67, v8, 7
    v_rcp_f32 v15, v15
    v_pk_add_f32 v[12:13], v[12:13], 1.0 op_sel_hi:[1,0]
    v_pk_mul_f32 v[186:187], v[186:187], v[14:15]
    s_and_b32 s69, s67, 0xfffffc00
    s_set_gpr_idx_on s58, gpr_idx(SRC2,DST)
    buffer_load_dwordx4 v[220:223], v1, s[4:7], s68 offen
    v_pk_fma_f32 v[84:85], v[170:171], v[16:17], v[84:85] op_sel_hi:[0,1,1]
    v_pk_fma_f32 v[86:87], v[170:171], v[18:19], v[86:87] op_sel_hi:[0,1,1]
    v_pk_fma_f32 v[88:89], v[186:187], v[20:21], v[88:89] op_sel_hi:[0,1,1]
    v_pk_fma_f32 v[90:91], v[186:187], v[22:23], v[90:91] op_sel_hi:[0,1,1]
    s_set_gpr_idx_off
    s_waitcnt vmcnt(7)
    v_mfma_f32_4x4x4_16b_bf16 v[20:23], v[34:35], v[226:227], 0 cbsz:4 abid:7
    v_mfma_f32_4x4x4_16b_bf16 v[16:19], v[34:35], v[224:225], 0 cbsz:4 abid:7
    v_rcp_f32 v13, v13
    v_mfma_f32_32x32x16_bf16 v[132:147], v[28:31], v[40:43], v[132:147]
    v_exp_f32 v14, v188
    v_exp_f32 v15, v189
    v_readlane_b32 s36, v8, 8
    v_rcp_f32 v12, v12
    v_pk_add_f32 v[14:15], v[14:15], 1.0 op_sel_hi:[1,0]
    v_pk_mul_f32 v[172:173], v[172:173], v[12:13]
    s_and_b32 s68, s36, 0xfffffc00
    s_set_gpr_idx_on s59, gpr_idx(SRC2,DST)
    buffer_load_dwordx4 v[224:227], v1, s[4:7], s69 offen
    v_pk_fma_f32 v[84:85], v[170:171], v[16:17], v[84:85] op_sel:[1,0,0]
    v_pk_fma_f32 v[86:87], v[170:171], v[18:19], v[86:87] op_sel:[1,0,0]
    v_pk_fma_f32 v[88:89], v[186:187], v[20:21], v[88:89] op_sel:[1,0,0]
    v_pk_fma_f32 v[90:91], v[186:187], v[22:23], v[90:91] op_sel:[1,0,0]
    s_set_gpr_idx_off
    s_sub_u32 s29, s29, 4
    s_cbranch_scc1 L_exit
    s_setprio 1
    s_waitcnt vmcnt(7)
    v_rcp_f32 v14, v14
    v_mfma_f32_4x4x4_16b_bf16 v[16:19], v[34:35], v[196:197], 0 cbsz:4 abid:8
    v_exp_f32 v13, v175
    v_mfma_f32_4x4x4_16b_bf16 v[20:23], v[34:35], v[198:199], 0 cbsz:4 abid:8
    v_exp_f32 v12, v174
    v_readlane_b32 s37, v8, 9
    v_rcp_f32 v15, v15
    v_pk_add_f32 v[12:13], v[12:13], 1.0 op_sel_hi:[1,0]
    v_pk_mul_f32 v[188:189], v[188:189], v[14:15]
    s_and_b32 s69, s37, 0xfffffc00
    s_set_gpr_idx_on s60, gpr_idx(SRC2,DST)
    buffer_load_dwordx4 v[196:199], v1, s[4:7], s68 offen
    v_pk_fma_f32 v[84:85], v[172:173], v[16:17], v[84:85] op_sel_hi:[0,1,1]
    v_pk_fma_f32 v[86:87], v[172:173], v[18:19], v[86:87] op_sel_hi:[0,1,1]
    v_pk_fma_f32 v[88:89], v[188:189], v[20:21], v[88:89] op_sel_hi:[0,1,1]
    v_pk_fma_f32 v[90:91], v[188:189], v[22:23], v[90:91] op_sel_hi:[0,1,1]
    s_set_gpr_idx_off
    s_waitcnt vmcnt(7)
    v_mfma_f32_4x4x4_16b_bf16 v[20:23], v[34:35], v[202:203], 0 cbsz:4 abid:9
    v_mfma_f32_4x4x4_16b_bf16 v[16:19], v[34:35], v[200:201], 0 cbsz:4 abid:9
    v_rcp_f32 v13, v13
    v_mfma_f32_32x32x16_bf16 v[148:163], v[24:27], v[44:47], 0
    v_exp_f32 v14, v190
    v_exp_f32 v15, v191
    v_readlane_b32 s38, v8, 10
    v_rcp_f32 v12, v12
    v_pk_add_f32 v[14:15], v[14:15], 1.0 op_sel_hi:[1,0]
    v_pk_mul_f32 v[174:175], v[174:175], v[12:13]
    s_and_b32 s68, s38, 0xfffffc00
    s_set_gpr_idx_on s61, gpr_idx(SRC2,DST)
    buffer_load_dwordx4 v[200:203], v1, s[4:7], s69 offen
    v_pk_fma_f32 v[84:85], v[172:173], v[16:17], v[84:85] op_sel:[1,0,0]
    v_pk_fma_f32 v[86:87], v[172:173], v[18:19], v[86:87] op_sel:[1,0,0]
    v_pk_fma_f32 v[88:89], v[188:189], v[20:21], v[88:89] op_sel:[1,0,0]
    v_pk_fma_f32 v[90:91], v[188:189], v[22:23], v[90:91] op_sel:[1,0,0]
    s_set_gpr_idx_off
    s_waitcnt vmcnt(7)
    v_rcp_f32 v14, v14
    v_mfma_f32_4x4x4_16b_bf16 v[16:19], v[34:35], v[204:205], 0 cbsz:4 abid:10
    v_exp_f32 v13, v177
    v_mfma_f32_4x4x4_16b_bf16 v[20:23], v[34:35], v[206:207], 0 cbsz:4 abid:10
    v_exp_f32 v12, v176
    v_readlane_b32 s39, v8, 11
    v_rcp_f32 v15, v15
    v_pk_add_f32 v[12:13], v[12:13], 1.0 op_sel_hi:[1,0]
    v_pk_mul_f32 v[190:191], v[190:191], v[14:15]
    s_and_b32 s69, s39, 0xfffffc00
    s_set_gpr_idx_on s62, gpr_idx(SRC2,DST)
    buffer_load_dwordx4 v[204:207], v1, s[4:7], s68 offen
    v_pk_fma_f32 v[84:85], v[174:175], v[16:17], v[84:85] op_sel_hi:[0,1,1]
    v_pk_fma_f32 v[86:87], v[174:175], v[18:19], v[86:87] op_sel_hi:[0,1,1]
    v_pk_fma_f32 v[88:89], v[190:191], v[20:21], v[88:89] op_sel_hi:[0,1,1]
    v_pk_fma_f32 v[90:91], v[190:191], v[22:23], v[90:91] op_sel_hi:[0,1,1]
    s_set_gpr_idx_off
    s_waitcnt vmcnt(7)
    v_mfma_f32_4x4x4_16b_bf16 v[20:23], v[34:35], v[210:211], 0 cbsz:4 abid:11
    v_mfma_f32_4x4x4_16b_bf16 v[16:19], v[34:35], v[208:209], 0 cbsz:4 abid:11
    v_rcp_f32 v13, v13
    v_mfma_f32_32x32x16_bf16 v[148:163], v[28:31], v[48:51], v[148:163]
    v_exp_f32 v14, v192
    v_exp_f32 v15, v193
    v_readlane_b32 s40, v8, 12
    v_rcp_f32 v12, v12
    v_pk_add_f32 v[14:15], v[14:15], 1.0 op_sel_hi:[1,0]
    v_pk_mul_f32 v[176:177], v[176:177], v[12:13]
    s_and_b32 s68, s40, 0xfffffc00
    s_set_gpr_idx_on s63, gpr_idx(SRC2,DST)
    buffer_load_dwordx4 v[208:211], v1, s[4:7], s69 offen
    v_pk_fma_f32 v[84:85], v[174:175], v[16:17], v[84:85] op_sel:[1,0,0]
    v_pk_fma_f32 v[86:87], v[174:175], v[18:19], v[86:87] op_sel:[1,0,0]
    v_pk_fma_f32 v[88:89], v[190:191], v[20:21], v[88:89] op_sel:[1,0,0]
    v_pk_fma_f32 v[90:91], v[190:191], v[22:23], v[90:91] op_sel:[1,0,0]
    s_set_gpr_idx_off
    s_sub_u32 s29, s29, 4
    s_cbranch_scc1 L_exit
    s_setprio 0
    s_waitcnt vmcnt(7)
    v_rcp_f32 v14, v14
    v_mfma_f32_4x4x4_16b_bf16 v[16:19], v[34:35], v[212:213], 0 cbsz:4 abid:12
    v_exp_f32 v13, v179
    v_mfma_f32_4x4x4_16b_bf16 v[20:23], v[34:35], v[214:215], 0 cbsz:4 abid:12
    v_exp_f32 v12, v178
    v_readlane_b32 s41, v8, 13
    v_rcp_f32 v15, v15
    v_pk_add_f32 v[12:13], v[12:13], 1.0 op_sel_hi:[1,0]
    v_pk_mul_f32 v[192:193], v[192:193], v[14:15]
    s_and_b32 s69, s41, 0xfffffc00
    s_set_gpr_idx_on s64, gpr_idx(SRC2,DST)
    buffer_load_dwordx4 v[212:215], v1, s[4:7], s68 offen
    v_pk_fma_f32 v[84:85], v[176:177], v[16:17], v[84:85] op_sel_hi:[0,1,1]
    v_pk_fma_f32 v[86:87], v[176:177], v[18:19], v[86:87] op_sel_hi:[0,1,1]
    v_pk_fma_f32 v[88:89], v[192:193], v[20:21], v[88:89] op_sel_hi:[0,1,1]
    v_pk_fma_f32 v[90:91], v[192:193], v[22:23], v[90:91] op_sel_hi:[0,1,1]
    s_set_gpr_idx_off
    s_waitcnt vmcnt(7)
    v_rcp_f32 v12, v12
    v_mfma_f32_4x4x4_16b_bf16 v[16:19], v[34:35], v[216:217], 0 cbsz:4 abid:13
    v_exp_f32 v15, v195
    v_mfma_f32_4x4x4_16b_bf16 v[20:23], v[34:35], v[218:219], 0 cbsz:4 abid:13
    v_exp_f32 v14, v194
    v_readlane_b32 s42, v8, 14
    v_rcp_f32 v13, v13
    v_pk_add_f32 v[14:15], v[14:15], 1.0 op_sel_hi:[1,0]
    v_pk_mul_f32 v[178:179], v[178:179], v[12:13]
    s_and_b32 s68, s42, 0xfffffc00
    s_set_gpr_idx_on s65, gpr_idx(SRC2,DST)
    buffer_load_dwordx4 v[216:219], v1, s[4:7], s69 offen
    v_pk_fma_f32 v[84:85], v[176:177], v[16:17], v[84:85] op_sel:[1,0,0]
    v_pk_fma_f32 v[86:87], v[176:177], v[18:19], v[86:87] op_sel:[1,0,0]
    v_pk_fma_f32 v[88:89], v[192:193], v[20:21], v[88:89] op_sel:[1,0,0]
    v_pk_fma_f32 v[90:91], v[192:193], v[22:23], v[90:91] op_sel:[1,0,0]
    s_set_gpr_idx_off
    s_waitcnt vmcnt(7)
    v_rcp_f32 v14, v14
    v_mfma_f32_4x4x4_16b_bf16 v[16:19], v[34:35], v[220:221], 0 cbsz:4 abid:14
    v_exp_f32 v13, v133
    v_mfma_f32_4x4x4_16b_bf16 v[20:23], v[34:35], v[222:223], 0 cbsz:4 abid:14
    v_exp_f32 v12, v132
    v_readlane_b32 s43, v8, 15
    v_rcp_f32 v15, v15
    v_pk_add_f32 v[12:13], v[12:13], 1.0 op_sel_hi:[1,0]
    v_pk_mul_f32 v[194:195], v[194:195], v[14:15]
    s_and_b32 s69, s43, 0xfffffc00
    s_set_gpr_idx_on s66, gpr_idx(SRC2,DST)
    buffer_load_dwordx4 v[220:223], v1, s[4:7], s68 offen
    v_pk_fma_f32 v[84:85], v[178:179], v[16:17], v[84:85] op_sel_hi:[0,1,1]
    v_pk_fma_f32 v[86:87], v[178:179], v[18:19], v[86:87] op_sel_hi:[0,1,1]
    v_pk_fma_f32 v[88:89], v[194:195], v[20:21], v[88:89] op_sel_hi:[0,1,1]
    v_pk_fma_f32 v[90:91], v[194:195], v[22:23], v[90:91] op_sel_hi:[0,1,1]
    s_set_gpr_idx_off
    s_waitcnt vmcnt(7)
    v_rcp_f32 v12, v12
    v_mfma_f32_4x4x4_16b_bf16 v[16:19], v[34:35], v[224:225], 0 cbsz:4 abid:15
    v_exp_f32 v15, v149
    v_mfma_f32_4x4x4_16b_bf16 v[20:23], v[34:35], v[226:227], 0 cbsz:4 abid:15
    v_exp_f32 v14, v148
    v_readlane_b32 s44, v7, 0
    v_rcp_f32 v13, v13
    v_pk_add_f32 v[14:15], v[14:15], 1.0 op_sel_hi:[1,0]
    v_pk_mul_f32 v[132:133], v[132:133], v[12:13]
    s_and_b32 s68, s44, 0xfffffc00
    s_set_gpr_idx_on s67, gpr_idx(SRC2,DST)
    buffer_load_dwordx4 v[224:227], v1, s[4:7], s69 offen
    v_pk_fma_f32 v[84:85], v[178:179], v[16:17], v[84:85] op_sel:[1,0,0]
    v_pk_fma_f32 v[86:87], v[178:179], v[18:19], v[86:87] op_sel:[1,0,0]
    v_pk_fma_f32 v[88:89], v[194:195], v[20:21], v[88:89] op_sel:[1,0,0]
    v_pk_fma_f32 v[90:91], v[194:195], v[22:23], v[90:91] op_sel:[1,0,0]
    s_set_gpr_idx_off
    s_sub_u32 s29, s29, 4
    s_cbranch_scc1 L_exit
    v_add_u32 v4, 256, v4
    v_add_u32 v5, 256, v5
    v_add_u32 v6, 256, v6
    s_branch L_loop
L_more:
    s_waitcnt vmcnt(0) lgkmcnt(0)
    s_barrier
    v_lshlrev_b32 v188, 4, v0
    v_add_u32 v189, 8192, v188
    v_add_u32 v190, 16384, v188
    v_add_u32 v191, 24576, v188
    v_add_u32 v192, 32768, v188
    v_add_u32 v193, 40960, v188
    v_lshlrev_b32 v194, 2, v0
    v_lshlrev_b32 v14, 3, v0
    v_mov_b32 v16, 0
    v_mov_b32 v17, 0
    v_mov_b32 v15, 0x00300000
    ds_write_b64 v14, v[16:17] offset:16128
    ds_write_b32 v194, v15 offset:20224
    ds_write_b32 v194, v15 offset:22272
    ds_write_b32 v194, v15 offset:24320
    v_lshrrev_b32 v195, 1, v0
    v_lshlrev_b32 v195, 2, v195
    s_branch L_round
L_exit:
    s_add_u32 s28, s28, 1536
    s_cmp_lt_u32 s28, s25
    s_cbranch_scc1 L_more
    s_mov_b32 m0, s96
    v_cvt_pk_bf16_f32 v84, v84, v88
    v_cvt_pk_bf16_f32 v85, v85, v89
    v_cvt_pk_bf16_f32 v86, v86, v90
    v_cvt_pk_bf16_f32 v87, v87, v91
    ds_write_addtid_b32 v84 offset:16128
    ds_write_addtid_b32 v85 offset:16416
    ds_write_addtid_b32 v86 offset:16704
    ds_write_addtid_b32 v87 offset:16992
    s_mov_b32 m0, s97
    v_cvt_pk_bf16_f32 v92, v92, v96
    v_cvt_pk_bf16_f32 v93, v93, v97
    v_cvt_pk_bf16_f32 v94, v94, v98
    v_cvt_pk_bf16_f32 v95, v95, v99
    ds_write_addtid_b32 v92 offset:16128
    ds_write_addtid_b32 v93 offset:16416
    ds_write_addtid_b32 v94 offset:16704
    ds_write_addtid_b32 v95 offset:16992
    s_mov_b32 m0, s98
    v_cvt_pk_bf16_f32 v100, v100, v104
    v_cvt_pk_bf16_f32 v101, v101, v105
    v_cvt_pk_bf16_f32 v102, v102, v106
    v_cvt_pk_bf16_f32 v103, v103, v107
    ds_write_addtid_b32 v100 offset:16128
    ds_write_addtid_b32 v101 offset:16416
    ds_write_addtid_b32 v102 offset:16704
    ds_write_addtid_b32 v103 offset:16992
    s_mov_b32 m0, s99
    v_cvt_pk_bf16_f32 v108, v108, v112
    v_cvt_pk_bf16_f32 v109, v109, v113
    v_cvt_pk_bf16_f32 v110, v110, v114
    v_cvt_pk_bf16_f32 v111, v111, v115
    ds_write_addtid_b32 v108 offset:16128
    ds_write_addtid_b32 v109 offset:16416
    ds_write_addtid_b32 v110 offset:16704
    ds_write_addtid_b32 v111 offset:16992
    s_mov_b32 m0, s100
    v_cvt_pk_bf16_f32 v116, v116, v120
    v_cvt_pk_bf16_f32 v117, v117, v121
    v_cvt_pk_bf16_f32 v118, v118, v122
    v_cvt_pk_bf16_f32 v119, v119, v123
    ds_write_addtid_b32 v116 offset:16128
    ds_write_addtid_b32 v117 offset:16416
    ds_write_addtid_b32 v118 offset:16704
    ds_write_addtid_b32 v119 offset:16992
    s_mov_b32 s68, 0xbf317218
    s_waitcnt lgkmcnt(0)
    s_barrier
    ds_read_b128 v[84:87], v230 offset:16128
    ds_read_b128 v[88:91], v230 offset:16192
    ds_read_b128 v[92:95], v230 offset:16256
    ds_read_b128 v[96:99], v230 offset:16320
    ds_read_b128 v[100:103], v230 offset:20736
    ds_read_b128 v[104:107], v230 offset:20800
    ds_read_b128 v[108:111], v230 offset:20864
    ds_read_b128 v[112:115], v230 offset:20928
    s_waitcnt lgkmcnt(7)
    v_mfma_f32_16x16x32_bf16 v[116:119], v[84:87], v[52:55], 0
    v_mfma_f32_16x16x32_bf16 v[120:123], v[84:87], v[56:59], 0
    s_waitcnt lgkmcnt(6)
    v_mfma_f32_16x16x32_bf16 v[116:119], v[88:91], v[60:63], v[116:119]
    v_mfma_f32_16x16x32_bf16 v[120:123], v[88:91], v[64:67], v[120:123]
    s_waitcnt lgkmcnt(5)
    v_mfma_f32_16x16x32_bf16 v[116:119], v[92:95], v[68:71], v[116:119]
    v_mfma_f32_16x16x32_bf16 v[120:123], v[92:95], v[72:75], v[120:123]
    s_waitcnt lgkmcnt(4)
    v_mfma_f32_16x16x32_bf16 v[116:119], v[96:99], v[76:79], v[116:119]
    v_mfma_f32_16x16x32_bf16 v[120:123], v[96:99], v[80:83], v[120:123]
    ds_read_b128 v[84:87], v230 offset:25344
    ds_read_b128 v[88:91], v230 offset:25408
    ds_read_b128 v[92:95], v230 offset:25472
    ds_read_b128 v[96:99], v230 offset:25536
    s_waitcnt lgkmcnt(7)
    v_mfma_f32_16x16x32_bf16 v[124:127], v[100:103], v[52:55], 0
    v_mfma_f32_16x16x32_bf16 v[128:131], v[100:103], v[56:59], 0
    s_waitcnt lgkmcnt(6)
    v_mfma_f32_16x16x32_bf16 v[124:127], v[104:107], v[60:63], v[124:127]
    v_mul_f32 v116, s68, v116
    v_mul_f32 v117, s68, v117
    v_mfma_f32_16x16x32_bf16 v[128:131], v[104:107], v[64:67], v[128:131]
    v_mul_f32 v118, s68, v118
    v_mul_f32 v119, s68, v119
    s_waitcnt lgkmcnt(5)
    v_mfma_f32_16x16x32_bf16 v[124:127], v[108:111], v[68:71], v[124:127]
    v_mul_f32 v120, s68, v120
    v_mul_f32 v121, s68, v121
    v_mfma_f32_16x16x32_bf16 v[128:131], v[108:111], v[72:75], v[128:131]
    v_mul_f32 v122, s68, v122
    v_mul_f32 v123, s68, v123
    s_waitcnt lgkmcnt(4)
    v_mfma_f32_16x16x32_bf16 v[124:127], v[112:115], v[76:79], v[124:127]
    v_cvt_pk_bf16_f32 v44, v116, v117
    v_cvt_pk_bf16_f32 v45, v118, v119
    v_mfma_f32_16x16x32_bf16 v[128:131], v[112:115], v[80:83], v[128:131]
    v_cvt_pk_bf16_f32 v46, v120, v121
    v_cvt_pk_bf16_f32 v47, v122, v123
    s_mov_b32 s3, 0
    buffer_store_dwordx4 v[44:47], v231, s[16:19], s3 offen sc0 sc1
    ds_read_b128 v[100:103], v230 offset:29952
    ds_read_b128 v[104:107], v230 offset:30016
    ds_read_b128 v[108:111], v230 offset:30080
    ds_read_b128 v[112:115], v230 offset:30144
    s_waitcnt lgkmcnt(7)
    v_mfma_f32_16x16x32_bf16 v[116:119], v[84:87], v[52:55], 0
    v_mfma_f32_16x16x32_bf16 v[120:123], v[84:87], v[56:59], 0
    s_waitcnt lgkmcnt(6)
    v_mfma_f32_16x16x32_bf16 v[116:119], v[88:91], v[60:63], v[116:119]
    v_mul_f32 v124, s68, v124
    v_mul_f32 v125, s68, v125
    v_mfma_f32_16x16x32_bf16 v[120:123], v[88:91], v[64:67], v[120:123]
    v_mul_f32 v126, s68, v126
    v_mul_f32 v127, s68, v127
    s_waitcnt lgkmcnt(5)
    v_mfma_f32_16x16x32_bf16 v[116:119], v[92:95], v[68:71], v[116:119]
    v_mul_f32 v128, s68, v128
    v_mul_f32 v129, s68, v129
    v_mfma_f32_16x16x32_bf16 v[120:123], v[92:95], v[72:75], v[120:123]
    v_mul_f32 v130, s68, v130
    v_mul_f32 v131, s68, v131
    s_waitcnt lgkmcnt(4)
    v_mfma_f32_16x16x32_bf16 v[116:119], v[96:99], v[76:79], v[116:119]
    v_cvt_pk_bf16_f32 v48, v124, v125
    v_cvt_pk_bf16_f32 v49, v126, v127
    v_mfma_f32_16x16x32_bf16 v[120:123], v[96:99], v[80:83], v[120:123]
    v_cvt_pk_bf16_f32 v50, v128, v129
    v_cvt_pk_bf16_f32 v51, v130, v131
    s_mov_b32 s3, 1048576
    buffer_store_dwordx4 v[48:51], v231, s[16:19], s3 offen sc0 sc1
    ds_read_b128 v[84:87], v230 offset:34560
    ds_read_b128 v[88:91], v230 offset:34624
    ds_read_b128 v[92:95], v230 offset:34688
    ds_read_b128 v[96:99], v230 offset:34752
    s_waitcnt lgkmcnt(7)
    v_mfma_f32_16x16x32_bf16 v[124:127], v[100:103], v[52:55], 0
    v_mfma_f32_16x16x32_bf16 v[128:131], v[100:103], v[56:59], 0
    s_waitcnt lgkmcnt(6)
    v_mfma_f32_16x16x32_bf16 v[124:127], v[104:107], v[60:63], v[124:127]
    v_mul_f32 v116, s68, v116
    v_mul_f32 v117, s68, v117
    v_mfma_f32_16x16x32_bf16 v[128:131], v[104:107], v[64:67], v[128:131]
    v_mul_f32 v118, s68, v118
    v_mul_f32 v119, s68, v119
    s_waitcnt lgkmcnt(5)
    v_mfma_f32_16x16x32_bf16 v[124:127], v[108:111], v[68:71], v[124:127]
    v_mul_f32 v120, s68, v120
    v_mul_f32 v121, s68, v121
    v_mfma_f32_16x16x32_bf16 v[128:131], v[108:111], v[72:75], v[128:131]
    v_mul_f32 v122, s68, v122
    v_mul_f32 v123, s68, v123
    s_waitcnt lgkmcnt(4)
    v_mfma_f32_16x16x32_bf16 v[124:127], v[112:115], v[76:79], v[124:127]
    v_cvt_pk_bf16_f32 v44, v116, v117
    v_cvt_pk_bf16_f32 v45, v118, v119
    v_mfma_f32_16x16x32_bf16 v[128:131], v[112:115], v[80:83], v[128:131]
    v_cvt_pk_bf16_f32 v46, v120, v121
    v_cvt_pk_bf16_f32 v47, v122, v123
    s_mov_b32 s3, 2097152
    buffer_store_dwordx4 v[44:47], v231, s[16:19], s3 offen sc0 sc1
    s_nop 3
    s_waitcnt lgkmcnt(3)
    v_mfma_f32_16x16x32_bf16 v[116:119], v[84:87], v[52:55], 0
    v_mfma_f32_16x16x32_bf16 v[120:123], v[84:87], v[56:59], 0
    s_waitcnt lgkmcnt(2)
    v_mfma_f32_16x16x32_bf16 v[116:119], v[88:91], v[60:63], v[116:119]
    v_mul_f32 v124, s68, v124
    v_mul_f32 v125, s68, v125
    v_mfma_f32_16x16x32_bf16 v[120:123], v[88:91], v[64:67], v[120:123]
    v_mul_f32 v126, s68, v126
    v_mul_f32 v127, s68, v127
    s_waitcnt lgkmcnt(1)
    v_mfma_f32_16x16x32_bf16 v[116:119], v[92:95], v[68:71], v[116:119]
    v_mul_f32 v128, s68, v128
    v_mul_f32 v129, s68, v129
    v_mfma_f32_16x16x32_bf16 v[120:123], v[92:95], v[72:75], v[120:123]
    v_mul_f32 v130, s68, v130
    v_mul_f32 v131, s68, v131
    s_waitcnt lgkmcnt(0)
    v_mfma_f32_16x16x32_bf16 v[116:119], v[96:99], v[76:79], v[116:119]
    v_cvt_pk_bf16_f32 v48, v124, v125
    v_cvt_pk_bf16_f32 v49, v126, v127
    v_mfma_f32_16x16x32_bf16 v[120:123], v[96:99], v[80:83], v[120:123]
    v_cvt_pk_bf16_f32 v50, v128, v129
    v_cvt_pk_bf16_f32 v51, v130, v131
    s_mov_b32 s3, 3145728
    buffer_store_dwordx4 v[48:51], v231, s[16:19], s3 offen sc0 sc1
    s_or_b32 s31, s2, s24
    s_cbranch_scc1 L_noep
    v_lshlrev_b32 v36, 2, v11
    v_mov_b32 v37, s26
    global_store_dword v36, v37, s[22:23] offset:0 sc0 sc1
L_noep:
    s_nop 3
    v_mul_f32 v116, s68, v116
    v_mul_f32 v117, s68, v117
    v_mul_f32 v118, s68, v118
    v_mul_f32 v119, s68, v119
    v_mul_f32 v120, s68, v120
    v_mul_f32 v121, s68, v121
    v_mul_f32 v122, s68, v122
    v_mul_f32 v123, s68, v123
    v_cvt_pk_bf16_f32 v44, v116, v117
    v_cvt_pk_bf16_f32 v45, v118, v119
    v_cvt_pk_bf16_f32 v46, v120, v121
    v_cvt_pk_bf16_f32 v47, v122, v123
    s_mov_b32 s3, 4194304
    buffer_store_dwordx4 v[44:47], v231, s[16:19], s3 offen sc0 sc1
L_end:
    s_endpgm
.section .rodata,"a"
.p2align 6
.amdhsa_kernel standalone__tensor_product_equiv_tfn__graph_kernel
  .amdhsa_next_free_vgpr 232
  .amdhsa_next_free_sgpr 102
  .amdhsa_accum_offset 232
  .amdhsa_group_segment_fixed_size 0
  .amdhsa_kernarg_size 88
  .amdhsa_user_sgpr_count 2
  .amdhsa_user_sgpr_kernarg_segment_ptr 1
  .amdhsa_system_sgpr_workgroup_id_x 1
  .amdhsa_float_denorm_mode_32 3
.end_amdhsa_kernel
```

```asm
; @launch grid=(256,1,1) block=(512,1,1) lds=163584
.amdgcn_target "amdgcn-amd-amdhsa--gfx950"
.text
.globl standalone__tensor_product_equiv_tfn__graph_kernel
.p2align 8
.type standalone__tensor_product_equiv_tfn__graph_kernel,@function
standalone__tensor_product_equiv_tfn__graph_kernel:
    s_load_dwordx16 s[4:19], s[0:1], 0
    s_load_dwordx2 s[22:23], s[0:1], 80
    s_load_dwordx2 s[20:21], s[0:1], 64
    s_cmp_ge_u32 s2, 256
    s_cbranch_scc1 L_end
    v_mul_u32_u24 v172, 3, v0
    s_mul_i32 s3, s2, 1250
    v_min_u32 v172, 1247, v172
    v_add_lshl_u32 v173, v172, s3, 2
    v_lshrrev_b32 v12, 6, v0
    v_and_b32 v13, 255, v0
    v_lshlrev_b32 v13, 2, v13
    v_mov_b32 v16, 0
    v_readfirstlane_b32 s24, v12
    ds_write_b32 v13, v16 offset:0
    v_lshlrev_b32 v174, 1, v173
    s_waitcnt lgkmcnt(0)
    global_load_dwordx3 v[132:134], v173, s[8:9]
    s_load_dword s26, s[22:23], 0
    s_barrier
    global_load_dwordx3 v[136:138], v173, s[6:7]
    global_load_dwordx4 v[140:143], v174, s[10:11]
    global_load_dwordx2 v[144:145], v174, s[10:11] offset:16
    v_lshlrev_b32 v188, 4, v0
    v_and_b32 v11, 63, v0
    s_lshl_b32 s30, s24, 10
    s_lshl_b32 s3, s3, 5
    s_add_u32 s12, s12, s3
    s_addc_u32 s13, s13, 0
    v_add_u32 v189, 8192, v188
    v_add_u32 v190, 16384, v188
    v_add_u32 v191, 24576, v188
    v_add_u32 v192, 32768, v188
    v_add_u32 v193, 40960, v188
    v_min_u32 v175, 39984, v192
    v_lshlrev_b32 v1, 4, v11
    s_barrier
    s_add_u32 m0, s30, 112384
    s_nop 0
    global_load_lds_dwordx4 v188, s[12:13]
    s_add_u32 m0, s30, 120576
    s_nop 0
    global_load_lds_dwordx4 v189, s[12:13]
    s_cmp_eq_u32 s24, 7
    s_cbranch_scc0 L_nocpf
    s_cmp_lt_u32 s2, 8
    s_cbranch_scc0 L_nocpf
    s_getpc_b64 s[68:69]
L_pc:
    v_and_b32 v18, 63, v0
    v_lshlrev_b32 v18, 7, v18
    v_mov_b32 v19, 0
    v_lshl_add_u64 v[20:21], v[18:19], 0, s[68:69]
    global_load_dword v204, v[20:21], off
    v_min_u32 v18, L_end-L_pc-8192, v18
    v_add_u32 v18, 8192, v18
    v_lshl_add_u64 v[20:21], v[18:19], 0, s[68:69]
    global_load_dword v205, v[20:21], off
L_nocpf:
    v_lshlrev_b32 v194, 2, v0
    v_lshlrev_b32 v14, 3, v0
    v_mov_b32 v16, 0
    v_mov_b32 v17, 0
    v_mov_b32 v15, 0x00300000
    ds_write_b64 v14, v[16:17] offset:16128
    ds_write_b32 v194, v15 offset:20224
    ds_write_b32 v194, v15 offset:22272
    ds_write_b32 v194, v15 offset:24320
    v_lshrrev_b32 v195, 1, v0
    v_lshlrev_b32 v195, 2, v195
    v_cmp_gt_u32 vcc, 416, v0
    s_mov_b64 s[36:37], vcc
    v_cmp_gt_u32 vcc, 417, v0
    s_mov_b64 s[38:39], vcc
    v_mov_b32 v12, 1
    s_movk_i32 s40, 1250
    s_mov_b32 s41, 63232
    s_lshr_b32 s27, s24, 2
    s_mov_b32 s28, 0
    s_waitcnt vmcnt(5)
    s_mov_b64 exec, s[38:39]
    v_and_b32 v153, 7, v133
    v_bfe_u32 v150, v133, 3, 5
    v_lshl_add_u32 v147, v153, 5, v150
    v_lshlrev_b32 v147, 2, v147
    ds_add_rtn_u32 v150, v147, v12 offset:0
    v_and_b32 v154, 7, v134
    v_bfe_u32 v151, v134, 3, 5
    v_lshl_add_u32 v148, v154, 5, v151
    v_lshlrev_b32 v148, 2, v148
    ds_add_rtn_u32 v151, v148, v12 offset:0
    s_mov_b64 exec, s[36:37]
    v_and_b32 v152, 7, v132
    v_bfe_u32 v149, v132, 3, 5
    v_lshl_add_u32 v146, v152, 5, v149
    v_lshlrev_b32 v146, 2, v146
    ds_add_rtn_u32 v149, v146, v12 offset:0
    s_mov_b64 exec, -1
    s_add_u32 m0, s30, 128768
    s_nop 0
    global_load_lds_dwordx4 v190, s[12:13]
    s_add_u32 m0, s30, 136960
    s_nop 0
    global_load_lds_dwordx4 v191, s[12:13]
    s_add_u32 m0, s30, 145152
    s_nop 0
    global_load_lds_dwordx4 v175, s[12:13]
    s_waitcnt lgkmcnt(0)
    s_barrier
    ds_read_b128 v[164:167], v1 offset:0
    s_mul_i32 s3, s2, 1280
    s_add_u32 s26, s26, 1
    s_waitcnt lgkmcnt(0)
    v_add_u32 v180, v164, v165
    v_add3_u32 v180, v180, v166, v167
    v_mov_b32 v181, v180
    v_lshrrev_b32 v132, 8, v132
    v_lshlrev_b32 v156, 26, v132
    v_add_u32_dpp v181, v181, v181 row_shr:1 row_mask:0xf bank_mask:0xf
    v_lshl_add_u32 v132, v132, 4, v156
    v_add_lshl_u32 v177, v172, 0, 5
    v_add_u32_dpp v181, v181, v181 row_shr:2 row_mask:0xf bank_mask:0xf
    v_lshrrev_b32 v133, 8, v133
    v_lshlrev_b32 v157, 26, v133
    v_add_u32_dpp v181, v181, v181 row_shr:4 row_mask:0xf bank_mask:0xf
    v_lshl_add_u32 v133, v133, 4, v157
    v_add_lshl_u32 v178, v172, 1, 5
    v_add_u32_dpp v181, v181, v181 row_shr:8 row_mask:0xf bank_mask:0xf
    v_lshrrev_b32 v134, 8, v134
    v_lshlrev_b32 v158, 26, v134
    v_add_u32_dpp v181, v181, v181 row_bcast:15 row_mask:0xa bank_mask:0xf
    v_lshl_add_u32 v134, v134, 4, v158
    v_add_lshl_u32 v179, v172, 2, 5
    v_add_u32_dpp v181, v181, v181 row_bcast:31 row_mask:0xc bank_mask:0xf
    v_sub_u32 v168, v181, v180
    v_add_u32 v169, v168, v164
    v_add_u32 v170, v169, v165
    v_add_u32 v171, v170, v166
    ds_write_b128 v1, v[168:171] offset:1024
    s_mov_b64 exec, s[38:39]
    ds_read_b32 v147, v147 offset:1024
    ds_read_b32 v148, v148 offset:1024
    s_mov_b64 exec, s[36:37]
    ds_read_b32 v146, v146 offset:1024
    s_mov_b64 exec, -1
    s_waitcnt vmcnt(5)
    v_mad_u32_u24 v152, v152, s40, v136
    v_lshl_add_u32 v132, v136, 10, v132
    v_subrev_u32 v156, 10000, v152
    v_min_u32 v152, v152, v156
    v_mul_u32_u24 v152, 157, v152
    v_lshrrev_b32 v152, 17, v152
    v_add_u32 v152, v152, v132
    v_mad_u32_u24 v153, v153, s40, v137
    v_lshl_add_u32 v133, v137, 10, v133
    v_subrev_u32 v157, 10000, v153
    v_min_u32 v153, v153, v157
    v_mul_u32_u24 v153, 157, v153
    v_lshrrev_b32 v153, 17, v153
    v_add_u32 v153, v153, v133
    v_mad_u32_u24 v154, v154, s40, v138
    v_lshl_add_u32 v134, v138, 10, v134
    v_subrev_u32 v158, 10000, v154
    v_min_u32 v154, v154, v158
    v_mul_u32_u24 v154, 157, v154
    v_lshrrev_b32 v154, 17, v154
    v_add_u32 v154, v154, v134
    s_mov_b64 exec, s[38:39]
    s_waitcnt lgkmcnt(0)
    v_add_lshl_u32 v147, v147, v150, 1
    v_mad_u32_u24 v183, v147, 6, s41
    ds_write_b16 v147, v178 offset:2048
    ds_write2_b32 v183, v142, v143 offset1:1
    ds_write_b32 v183, v153 offset:8
    v_add_lshl_u32 v148, v148, v151, 1
    v_mad_u32_u24 v184, v148, 6, s41
    ds_write_b16 v148, v179 offset:2048
    ds_write2_b32 v184, v144, v145 offset1:1
    ds_write_b32 v184, v154 offset:8
    s_mov_b64 exec, s[36:37]
    v_add_lshl_u32 v146, v146, v149, 1
    v_mad_u32_u24 v182, v146, 6, s41
    ds_write_b16 v146, v177 offset:2048
    ds_write2_b32 v182, v140, v141 offset1:1
    ds_write_b32 v182, v152 offset:8
    s_mov_b64 exec, -1
    s_add_u32 m0, s30, 26368
    s_nop 0
    global_load_lds_dwordx4 v188, s[18:19]
    s_add_u32 m0, s30, 34560
    s_nop 0
    global_load_lds_dwordx4 v189, s[18:19]
    s_add_u32 m0, s30, 42752
    s_nop 0
    global_load_lds_dwordx4 v190, s[18:19]
    s_add_u32 m0, s30, 50944
    s_nop 0
    global_load_lds_dwordx4 v191, s[18:19]
    s_add_u32 s70, s30, 59136
    v_min_u32 v185, 112, v1
    s_cmp_lt_u32 s24, 4
    s_cselect_b64 vcc, -1, 0
    s_cselect_b32 m0, s70, 162560
    s_cselect_b64 s[68:69], s[14:15], s[16:17]
    v_cndmask_b32 v185, v185, v188, vcc
    global_load_lds_dwordx4 v185, s[68:69]
    v_add_u32 v168, s3, v168
    v_lshl_add_u32 v196, v164, 19, v168
    v_mov_b32 v197, s26
    v_add_u32 v169, s3, v169
    v_lshl_add_u32 v198, v165, 19, v169
    v_mov_b32 v199, s26
    v_add_u32 v170, s3, v170
    v_lshl_add_u32 v200, v166, 19, v170
    v_mov_b32 v201, s26
    v_add_u32 v171, s3, v171
    v_lshl_add_u32 v202, v167, 19, v171
    v_mov_b32 v203, s26
    s_lshl_b32 s31, s2, 11
    s_add_u32 s31, s31, 4096
    v_add_u32 v186, s31, v1
    s_mul_i32 s31, s3, 12
    s_add_u32 s31, s31, 1048576
    s_add_u32 s48, s22, s31
    s_addc_u32 s49, s23, 0
    s_mov_b32 s50, 15104
    s_mov_b32 s51, 0x00020000
    s_lshl_b32 s3, s3, 5
    s_add_u32 s31, s3, 8388608
    s_add_u32 s52, s22, s31
    s_addc_u32 s53, s23, 0
    s_mov_b32 s54, 40064
    s_mov_b32 s55, 0x00020000
    v_and_b32 v172, -2, v0
    v_and_b32 v173, 16, v188
    v_add_u32 v173, 112384, v173
    s_waitcnt lgkmcnt(0)
    s_barrier
    ds_read_b128 v[132:135], v188 offset:63232
    ds_read_b128 v[136:139], v189 offset:63232
    ds_read_u16 v174, v172 offset:2048
    ds_read_u16 v175, v172 offset:2560
    ds_read_u16 v176, v172 offset:3072
    ds_read_u16 v177, v172 offset:3584
    ds_read_u16 v178, v172 offset:4096
    s_waitcnt lgkmcnt(6)
    buffer_store_dwordx4 v[132:135], v188, s[48:51], 0 offen sc0 sc1
    s_waitcnt lgkmcnt(5)
    buffer_store_dwordx4 v[136:139], v189, s[48:51], 0 offen sc0 sc1
    s_waitcnt lgkmcnt(0)
    v_add_u32 v174, v174, v173
    v_add_u32 v175, v175, v173
    v_add_u32 v176, v176, v173
    v_add_u32 v177, v177, v173
    v_min_u32 v178, 39968, v178
    v_and_b32 v178, -16, v178
    v_add_u32 v178, v178, v173
    v_mov_b64 v[84:85], 0
    v_mov_b64 v[86:87], 0
    v_mov_b64 v[88:89], 0
    v_mov_b64 v[90:91], 0
    v_mov_b64 v[92:93], 0
    v_mov_b64 v[94:95], 0
    v_mov_b64 v[96:97], 0
    v_mov_b64 v[98:99], 0
    v_mov_b64 v[100:101], 0
    v_mov_b64 v[102:103], 0
    v_mov_b64 v[104:105], 0
    v_mov_b64 v[106:107], 0
    v_mov_b64 v[108:109], 0
    v_mov_b64 v[110:111], 0
    v_mov_b64 v[112:113], 0
    v_mov_b64 v[114:115], 0
    v_mov_b64 v[116:117], 0
    v_mov_b64 v[118:119], 0
    v_mov_b64 v[120:121], 0
    v_mov_b64 v[122:123], 0
    v_mov_b64 v[124:125], 0
    v_mov_b64 v[126:127], 0
    v_mov_b64 v[128:129], 0
    v_mov_b64 v[130:131], 0
    v_mov_b64 v[24:25], 0
    v_mov_b64 v[26:27], 0
    v_mov_b64 v[28:29], 0
    v_mov_b64 v[30:31], 0
    s_mov_b32 s32, 0x0f0f0f0f
    s_mov_b32 s33, s32
    s_not_b64 s[34:35], s[32:33]
    v_lshrrev_b32 v2, 5, v11
    v_lshlrev_b32 v2, 4, v2
    v_and_b32 v3, 3, v11
    v_lshlrev_b32 v3, 3, v3
    v_add_u32 v3, 112384, v3
    s_mov_b32 s6, 10240000
    s_mov_b32 s7, 0x00020000
    s_add_u32 s8, s22, 1048576
    s_addc_u32 s9, s23, 0
    s_mov_b32 s10, 3932160
    s_mov_b32 s11, 0x00020000
    s_mov_b32 s101, 0
    s_cmp_lt_u32 s2, 16
    s_cbranch_scc1 L_r40
    s_cmp_eq_u32 s24, 0
    s_cselect_b32 s101, 0x245d2388, s101
    s_cmp_eq_u32 s24, 1
    s_cselect_b32 s101, 0x25753343, s101
    s_cmp_eq_u32 s24, 2
    s_cselect_b32 s101, 0x27449100, s101
    s_cmp_eq_u32 s24, 3
    s_cselect_b32 s101, 0x267d5301, s101
    s_cmp_eq_u32 s24, 4
    s_cselect_b32 s101, 0x2179a402, s101
    s_cmp_eq_u32 s24, 5
    s_cselect_b32 s101, 0x227162c6, s101
    s_cmp_eq_u32 s24, 6
    s_cselect_b32 s101, 0x206543c7, s101
    s_cmp_eq_u32 s24, 7
    s_cselect_b32 s101, 0x236d8285, s101
    s_branch L_rd
L_r40:
    s_cmp_eq_u32 s24, 0
    s_cselect_b32 s101, 0x2271a3c1, s101
    s_cmp_eq_u32 s24, 1
    s_cselect_b32 s101, 0x20750307, s101
    s_cmp_eq_u32 s24, 2
    s_cselect_b32 s101, 0x236d5205, s101
    s_cmp_eq_u32 s24, 3
    s_cselect_b32 s101, 0x27797340, s101
    s_cmp_eq_u32 s24, 4
    s_cselect_b32 s101, 0x256112c4, s101
    s_cmp_eq_u32 s24, 5
    s_cselect_b32 s101, 0x26653243, s101
    s_cmp_eq_u32 s24, 6
    s_cselect_b32 s101, 0x217d4382, s101
    s_cmp_eq_u32 s24, 7
    s_cselect_b32 s101, 0x24592286, s101
L_rd:
    s_and_b32 s3, s2, 7
    s_lshl_b32 s3, s3, 7
    s_bfe_u32 s31, s2, 196613
    s_lshl_b32 s31, s31, 4
    s_add_u32 s3, s3, s31
    s_and_b32 s31, s2, 8
    s_add_u32 s3, s3, s31
    s_and_b32 s31, s2, 16
    s_lshl_b32 s31, s31, 6
    s_add_u32 s3, s3, s31
    s_add_u32 s3, s3, 4096
    v_and_b32 v187, 255, v0
    v_lshl_add_u32 v187, v187, 11, s3
    s_waitcnt vmcnt(7)
    s_barrier
    ds_read_b128 v[144:147], v174
    ds_read_b128 v[148:151], v175
    ds_read_b128 v[152:155], v176
    ds_read_b128 v[156:159], v177
    ds_read_b128 v[160:163], v178
    s_waitcnt lgkmcnt(4)
    buffer_store_dwordx4 v[144:147], v188, s[52:55], 0 offen sc0 sc1
    s_waitcnt lgkmcnt(3)
    buffer_store_dwordx4 v[148:151], v189, s[52:55], 0 offen sc0 sc1
    s_waitcnt lgkmcnt(2)
    buffer_store_dwordx4 v[152:155], v190, s[52:55], 0 offen sc0 sc1
    s_waitcnt lgkmcnt(1)
    buffer_store_dwordx4 v[156:159], v191, s[52:55], 0 offen sc0 sc1
    s_waitcnt lgkmcnt(0)
    buffer_store_dwordx4 v[160:163], v192, s[52:55], 0 offen sc0 sc1
    s_add_u32 s12, s22, 8388608
    s_addc_u32 s13, s23, 0
    s_mov_b32 s14, 10485760
    s_mov_b32 s15, 0x00020000
    s_mov_b32 s16, s20
    s_mov_b32 s17, s21
    s_mov_b32 s18, 10240000
    s_mov_b32 s19, 0x00020000
    s_waitcnt vmcnt(0)
    s_barrier
    s_cmp_eq_u32 s24, 7
    s_cbranch_scc0 L_nopub
    global_store_dwordx4 v186, v[196:199], s[22:23] sc0 sc1
    global_store_dwordx4 v186, v[200:203], s[22:23] offset:1024 sc0 sc1
L_nopub:
    s_cmp_eq_u32 s27, 0
    s_cbranch_scc1 L_pfa
    s_sub_u32 s3, 0, s2
    s_and_b32 s3, s3, 7
    s_mul_i32 s3, s3, 1280000
    s_lshr_b32 s31, s2, 3
    s_mul_i32 s31, s31, 26624
    s_add_u32 s3, s3, s31
    s_add_u32 s3, s3, 0
    v_and_b32 v208, 255, v0
    v_cmp_gt_u32 vcc, 208, v208
    v_lshlrev_b32 v208, 7, v208
    v_mov_b32 v209, 0x7fffff00
    v_cndmask_b32 v208, v209, v208, vcc
    buffer_load_dword v210, v208, s[4:7], s3 offen
L_pfa:
    v_lshrrev_b32 v12, 5, v11
    v_and_b32 v13, 31, v11
    v_lshlrev_b32 v13, 2, v13
    v_lshl_add_u32 v12, v12, 11, v13
    ds_read_b32 v132, v12 offset:59136
    ds_read_b32 v133, v12 offset:59392
    ds_read_b32 v134, v12 offset:59648
    ds_read_b32 v135, v12 offset:59904
    ds_read_b32 v136, v12 offset:60160
    ds_read_b32 v137, v12 offset:60416
    ds_read_b32 v138, v12 offset:60672
    ds_read_b32 v139, v12 offset:60928
    s_waitcnt lgkmcnt(7)
    ds_read_b32 v140, v12 offset:59264
    ds_read_b32 v141, v12 offset:59520
    ds_read_b32 v142, v12 offset:59776
    ds_read_b32 v143, v12 offset:60032
    ds_read_b32 v144, v12 offset:60288
    ds_read_b32 v145, v12 offset:60544
    ds_read_b32 v146, v12 offset:60800
    ds_read_b32 v147, v12 offset:61056
    v_and_b32 v14, 3, v11
    v_bfe_u32 v15, v11, 2, 2
    v_lshlrev_b32 v15, 1, v15
    v_lshl_add_u32 v14, v14, 5, v15
    v_add_u32 v14, 162560, v14
    s_mov_b32 s68, 0xbfb8aa3b
    s_mov_b32 s69, s68
    s_mov_b32 s70, 0x05040100
    s_mov_b32 s71, 0x07060302
    s_and_b32 s3, s24, 3
    s_lshl_b32 s3, s3, 6
    v_lshrrev_b32 v16, 4, v11
    v_and_b32 v17, 15, v11
    v_lshl_add_u32 v17, v17, 2, s3
    v_lshl_add_u32 v16, v16, 11, v17
    s_waitcnt lgkmcnt(0)
    ds_read_u16 v18, v14 offset:0
    ds_read_u16 v19, v14 offset:8
    ds_read_u16 v20, v14 offset:16
    ds_read_u16 v21, v14 offset:24
    ds_read_b32 v148, v16 offset:26368
    ds_read_b32 v149, v16 offset:26624
    ds_read_b32 v150, v16 offset:26880
    ds_read_b32 v151, v16 offset:27136
    ds_read_b32 v152, v16 offset:27392
    ds_read_b32 v153, v16 offset:27648
    ds_read_b32 v154, v16 offset:27904
    ds_read_b32 v155, v16 offset:28160
    v_lshlrev_b32 v22, 16, v132
    v_lshlrev_b32 v23, 16, v133
    v_and_b32 v132, 0xffff0000, v132
    v_and_b32 v133, 0xffff0000, v133
    v_pk_mul_f32 v[22:23], v[22:23], s[68:69]
    v_pk_mul_f32 v[132:133], v[132:133], s[68:69]
    v_cvt_pk_bf16_f32 v36, v22, v23
    v_cvt_pk_bf16_f32 v44, v132, v133
    v_lshlrev_b32 v22, 16, v134
    v_lshlrev_b32 v23, 16, v135
    v_and_b32 v134, 0xffff0000, v134
    v_and_b32 v135, 0xffff0000, v135
    v_pk_mul_f32 v[22:23], v[22:23], s[68:69]
    v_pk_mul_f32 v[134:135], v[134:135], s[68:69]
    v_cvt_pk_bf16_f32 v37, v22, v23
    v_cvt_pk_bf16_f32 v45, v134, v135
    v_lshlrev_b32 v22, 16, v136
    v_lshlrev_b32 v23, 16, v137
    v_and_b32 v136, 0xffff0000, v136
    v_and_b32 v137, 0xffff0000, v137
    v_pk_mul_f32 v[22:23], v[22:23], s[68:69]
    v_pk_mul_f32 v[136:137], v[136:137], s[68:69]
    v_cvt_pk_bf16_f32 v38, v22, v23
    v_cvt_pk_bf16_f32 v46, v136, v137
    v_lshlrev_b32 v22, 16, v138
    v_lshlrev_b32 v23, 16, v139
    v_and_b32 v138, 0xffff0000, v138
    v_and_b32 v139, 0xffff0000, v139
    v_pk_mul_f32 v[22:23], v[22:23], s[68:69]
    v_pk_mul_f32 v[138:139], v[138:139], s[68:69]
    v_cvt_pk_bf16_f32 v39, v22, v23
    v_cvt_pk_bf16_f32 v47, v138, v139
    v_lshlrev_b32 v22, 16, v140
    v_lshlrev_b32 v23, 16, v141
    v_and_b32 v140, 0xffff0000, v140
    v_and_b32 v141, 0xffff0000, v141
    v_pk_mul_f32 v[22:23], v[22:23], s[68:69]
    v_pk_mul_f32 v[140:141], v[140:141], s[68:69]
    v_cvt_pk_bf16_f32 v40, v22, v23
    v_cvt_pk_bf16_f32 v48, v140, v141
    v_lshlrev_b32 v22, 16, v142
    v_lshlrev_b32 v23, 16, v143
    v_and_b32 v142, 0xffff0000, v142
    v_and_b32 v143, 0xffff0000, v143
    v_pk_mul_f32 v[22:23], v[22:23], s[68:69]
    v_pk_mul_f32 v[142:143], v[142:143], s[68:69]
    v_cvt_pk_bf16_f32 v41, v22, v23
    v_cvt_pk_bf16_f32 v49, v142, v143
    v_lshlrev_b32 v22, 16, v144
    v_lshlrev_b32 v23, 16, v145
    v_and_b32 v144, 0xffff0000, v144
    v_and_b32 v145, 0xffff0000, v145
    v_pk_mul_f32 v[22:23], v[22:23], s[68:69]
    v_pk_mul_f32 v[144:145], v[144:145], s[68:69]
    v_cvt_pk_bf16_f32 v42, v22, v23
    v_cvt_pk_bf16_f32 v50, v144, v145
    v_lshlrev_b32 v22, 16, v146
    v_lshlrev_b32 v23, 16, v147
    v_and_b32 v146, 0xffff0000, v146
    v_and_b32 v147, 0xffff0000, v147
    v_pk_mul_f32 v[22:23], v[22:23], s[68:69]
    v_pk_mul_f32 v[146:147], v[146:147], s[68:69]
    v_cvt_pk_bf16_f32 v43, v22, v23
    v_cvt_pk_bf16_f32 v51, v146, v147
    s_waitcnt lgkmcnt(0)
    v_lshl_or_b32 v228, v19, 16, v18
    v_lshl_or_b32 v229, v21, 16, v20
    ds_read_b32 v156, v16 offset:34560
    ds_read_b32 v157, v16 offset:34816
    ds_read_b32 v158, v16 offset:35072
    ds_read_b32 v159, v16 offset:35328
    ds_read_b32 v160, v16 offset:35584
    ds_read_b32 v161, v16 offset:35840
    ds_read_b32 v162, v16 offset:36096
    ds_read_b32 v163, v16 offset:36352
    v_perm_b32 v52, v149, v148, s70
    v_perm_b32 v56, v149, v148, s71
    v_perm_b32 v53, v151, v150, s70
    v_perm_b32 v57, v151, v150, s71
    v_perm_b32 v54, v153, v152, s70
    v_perm_b32 v58, v153, v152, s71
    v_perm_b32 v55, v155, v154, s70
    v_perm_b32 v59, v155, v154, s71
    s_waitcnt lgkmcnt(7)
    ds_read_b32 v148, v16 offset:42752
    ds_read_b32 v149, v16 offset:43008
    ds_read_b32 v150, v16 offset:43264
    ds_read_b32 v151, v16 offset:43520
    ds_read_b32 v152, v16 offset:43776
    ds_read_b32 v153, v16 offset:44032
    ds_read_b32 v154, v16 offset:44288
    ds_read_b32 v155, v16 offset:44544
    s_waitcnt lgkmcnt(8)
    v_perm_b32 v60, v157, v156, s70
    v_perm_b32 v64, v157, v156, s71
    v_perm_b32 v61, v159, v158, s70
    v_perm_b32 v65, v159, v158, s71
    v_perm_b32 v62, v161, v160, s70
    v_perm_b32 v66, v161, v160, s71
    v_perm_b32 v63, v163, v162, s70
    v_perm_b32 v67, v163, v162, s71
    s_waitcnt lgkmcnt(7)
    ds_read_b32 v156, v16 offset:50944
    ds_read_b32 v157, v16 offset:51200
    ds_read_b32 v158, v16 offset:51456
    ds_read_b32 v159, v16 offset:51712
    ds_read_b32 v160, v16 offset:51968
    ds_read_b32 v161, v16 offset:52224
    ds_read_b32 v162, v16 offset:52480
    ds_read_b32 v163, v16 offset:52736
    s_waitcnt lgkmcnt(8)
    v_perm_b32 v68, v149, v148, s70
    v_perm_b32 v72, v149, v148, s71
    v_perm_b32 v69, v151, v150, s70
    v_perm_b32 v73, v151, v150, s71
    v_perm_b32 v70, v153, v152, s70
    v_perm_b32 v74, v153, v152, s71
    v_perm_b32 v71, v155, v154, s70
    v_perm_b32 v75, v155, v154, s71
    s_waitcnt lgkmcnt(0)
    v_perm_b32 v76, v157, v156, s70
    v_perm_b32 v80, v157, v156, s71
    v_perm_b32 v77, v159, v158, s70
    v_perm_b32 v81, v159, v158, s71
    v_perm_b32 v78, v161, v160, s70
    v_perm_b32 v82, v161, v160, s71
    v_perm_b32 v79, v163, v162, s70
    v_perm_b32 v83, v163, v162, s71
    s_cmp_eq_u32 s27, 0
    s_cbranch_scc0 L_round
    s_mov_b32 s3, 0
L_poll:
    global_load_dwordx2 v[206:207], v187, s[22:23] sc1
L_poll1:
    s_add_u32 s3, s3, 1
    s_waitcnt vmcnt(0)
    v_cmpx_ne_u32 vcc, s26, v207
    s_cbranch_execz L_pok
    s_cmp_lt_u32 s3, 400000
    s_cbranch_scc1 L_poll
    v_mov_b32 v206, 0
L_pok:
    s_mov_b64 exec, -1
    v_add_u32 v14, 161536, v194
    ds_write_b32 v14, v206
L_round:
    v_add_u32 v15, 161536, v1
    s_and_b32 s31, s24, 3
    v_mov_b32 v148, 0
    s_waitcnt lgkmcnt(0)
    s_barrier
    ds_read_b128 v[140:143], v15
    v_mul_u32_u24 v135, 12, v0
    v_add_u32 v136, 6144, v135
    v_add_u32 v137, 12288, v135
    s_waitcnt lgkmcnt(0)
    v_lshrrev_b32 v144, 19, v140
    v_lshrrev_b32 v145, 19, v141
    v_lshrrev_b32 v146, 19, v142
    v_lshrrev_b32 v147, 19, v143
    v_add_u32 v150, v144, v145
    v_add3_u32 v12, v150, v146, v147
    v_add_u32 v13, s28, v12
    v_mov_b32 v149, v144
    v_add_u32_dpp v12, v12, v12 row_shr:1 row_mask:0xf bank_mask:0xf
    v_add_u32 v151, v150, v146
    s_set_gpr_idx_on s31, gpr_idx(SRC0)
    v_mov_b32 v14, v140
    v_mov_b32 v15, v144
    v_mov_b32 v16, v148
    s_set_gpr_idx_off
    v_add_u32_dpp v12, v12, v12 row_shr:2 row_mask:0xf bank_mask:0xf
    v_and_b32 v14, 0x7ffff, v14
    v_sub_u32 v16, v16, v13
    v_add_u32_dpp v12, v12, v12 row_shr:4 row_mask:0xf bank_mask:0xf
    v_subrev_u32 v17, s27, v15
    s_mov_b32 s31, s27
    v_add_u32_dpp v12, v12, v12 row_shr:8 row_mask:0xf bank_mask:0xf
    s_nop 1
    v_add_u32_dpp v12, v12, v12 row_bcast:15 row_mask:0xa bank_mask:0xf
    s_nop 1
    v_add_u32_dpp v12, v12, v12 row_bcast:31 row_mask:0xc bank_mask:0xf
    v_add_u32 v16, v16, v12
    v_readlane_b32 s25, v12, 63
    v_sub_u32 v14, v14, v16
    v_add_lshl_u32 v18, v16, s27, 2
    s_cmp_gt_u32 s25, 1536
    s_cbranch_scc1 L_exp
    v_cmpx_lt_i32 vcc, 0, v17
    ds_write_b32 v18, v14 offset:20224
    v_cmpx_lt_i32 vcc, 2, v17
    ds_write_b32 v18, v14 offset:20232
    v_cmpx_lt_i32 vcc, 4, v17
    ds_write_b32 v18, v14 offset:20240
    v_cmpx_lt_i32 vcc, 6, v17
    ds_write_b32 v18, v14 offset:20248
    v_cmpx_lt_i32 vcc, 8, v17
    ds_write_b32 v18, v14 offset:20256
    v_cmpx_lt_i32 vcc, 10, v17
    ds_write_b32 v18, v14 offset:20264
    v_cmpx_lt_i32 vcc, 12, v17
    s_cbranch_execz L_expd
    s_add_u32 s31, s31, 12
L_exp:
    s_mov_b64 exec, -1
    v_cmp_lt_u32 vcc, s31, v15
    s_cbranch_vccz L_expd
    v_add_u32 v19, s31, v16
    s_movk_i32 s3, 1536
    v_cmp_gt_u32 s[68:69], s3, v19
    v_lshlrev_b32 v19, 2, v19
    s_and_b64 exec, vcc, s[68:69]
    ds_write_b32 v19, v14 offset:20224
    s_add_u32 s31, s31, 2
    s_branch L_exp
L_expd:
    s_mov_b64 exec, -1
    s_waitcnt lgkmcnt(0)
    s_barrier
    ds_read_b32 v12, v194 offset:20224
    ds_read_b32 v13, v194 offset:22272
    ds_read_b32 v14, v194 offset:24320
    ds_read_b32 v152, v195 offset:20224
    ds_read_b32 v153, v195 offset:21248
    ds_read_b32 v154, v195 offset:22272
    ds_read_b32 v155, v195 offset:23296
    ds_read_b32 v156, v195 offset:24320
    ds_read_b32 v157, v195 offset:25344
    s_waitcnt lgkmcnt(8)
    v_mad_i32_i24 v12, v12, 12, v135
    buffer_load_dwordx3 v[140:142], v12, s[8:11], 0 offen sc1
    s_waitcnt lgkmcnt(7)
    v_mad_i32_i24 v13, v13, 12, v136
    buffer_load_dwordx3 v[144:146], v13, s[8:11], 0 offen sc1
    s_waitcnt lgkmcnt(6)
    v_mad_i32_i24 v14, v14, 12, v137
    buffer_load_dwordx3 v[148:150], v14, s[8:11], 0 offen sc1
    s_waitcnt lgkmcnt(0)
    v_lshl_add_u32 v152, v152, 5, v188
    v_lshl_add_u32 v153, v153, 5, v189
    v_lshl_add_u32 v154, v154, 5, v190
    v_lshl_add_u32 v155, v155, 5, v191
    v_lshl_add_u32 v156, v156, 5, v192
    v_lshl_add_u32 v157, v157, 5, v193
    s_barrier
    s_add_u32 m0, s30, 63232
    s_nop 0
    buffer_load_dwordx4 v152, s[12:15], 0 offen sc1 lds
    s_add_u32 m0, s30, 71424
    s_nop 0
    buffer_load_dwordx4 v153, s[12:15], 0 offen sc1 lds
    s_sub_u32 s29, s25, s28
    s_min_u32 s29, s29, 1536
    s_lshl_b32 s3, s29, 4
    v_cmp_gt_u32 s[56:57], s3, v188
    v_lshlrev_b32 v159, 1, v188
    v_mov_b32 v143, 0
    v_cmp_gt_u32 s[58:59], s3, v189
    v_lshlrev_b32 v161, 1, v189
    v_mov_b32 v147, 0
    v_cmp_gt_u32 s[60:61], s3, v190
    v_lshlrev_b32 v163, 1, v190
    v_mov_b32 v151, 0
    v_and_b32 v4, 15, v11
    v_lshrrev_b32 v13, 4, v11
    s_mul_i32 s3, s27, 23040
    v_mul_u32_u24 v230, 288, v4
    v_lshl_add_u32 v230, v13, 4, v230
    v_add_u32 v230, s3, v230
    s_mul_i32 s68, s27, 5120
    s_add_u32 s68, s68, s2
    s_lshl_b32 s68, s68, 10
    s_and_b32 s3, s24, 3
    s_lshl_b32 s3, s3, 8
    s_add_u32 s68, s68, s3
    v_lshl_add_u32 v231, v13, 18, s68
    v_lshl_add_u32 v231, v4, 4, v231
    v_lshlrev_b32 v4, 3, v4
    v_bfe_u32 v5, v11, 3, 2
    v_and_b32 v12, 3, v11
    v_lshl_add_u32 v5, v5, 2, v12
    v_lshlrev_b32 v5, 3, v5
    v_lshrrev_b32 v6, 2, v11
    v_lshlrev_b32 v6, 3, v6
    v_mul_u32_u24 v16, 52, v11
    v_lshrrev_b32 v16, 8, v16
    v_mul_u32_u24 v17, 5, v16
    v_sub_u32 v17, v11, v17
    v_mul_u32_u24 v15, 6, v17
    v_bfe_u32 v15, s101, v15, 6
    v_lshlrev_b32 v15, 2, v15
    v_lshlrev_b32 v16, 2, v16
    v_lshlrev_b32 v17, 19, v17
    s_mul_i32 s3, s24, 5
    v_lshlrev_b32 v18, 2, v11
    v_add_u32 v21, s3, v11
    v_lshlrev_b32 v19, 2, v21
    v_cmp_gt_u32 vcc, 40, v11
    v_add_u32 v20, 1, v11
    v_add_u32 v21, 1, v21
    v_cndmask_b32 v20, 0, v20, vcc
    s_cmp_gt_u32 s25, 1536
    s_cselect_b32 s69, 0, 8
    v_mov_b32 v22, 8
    s_waitcnt vmcnt(4)
    s_mov_b64 exec, s[56:57]
    v_and_b32 v143, 0x3ff, v142
    v_lshrrev_b32 v12, 24, v142
    v_lshlrev_b32 v143, 2, v143
    ds_add_u32 v12, v22 offset:18688
    ds_add_rtn_u32 v132, v143, v22 offset:16128
    s_waitcnt vmcnt(3)
    s_mov_b64 exec, s[58:59]
    v_and_b32 v147, 0x3ff, v146
    v_lshrrev_b32 v13, 24, v146
    v_lshlrev_b32 v147, 2, v147
    ds_add_u32 v13, v22 offset:18688
    ds_add_rtn_u32 v133, v147, v22 offset:16128
    s_waitcnt vmcnt(2)
    s_mov_b64 exec, s[60:61]
    v_and_b32 v151, 0x3ff, v150
    v_lshrrev_b32 v14, 24, v150
    v_lshlrev_b32 v151, 2, v151
    ds_add_u32 v14, v22 offset:18688
    ds_add_rtn_u32 v134, v151, v22 offset:16128
    s_mov_b64 exec, -1
    s_add_u32 m0, s30, 79616
    s_nop 0
    buffer_load_dwordx4 v154, s[12:15], 0 offen sc1 lds
    v_mfma_f32_4x4x4_16b_bf16 v[164:167], v[228:229], v[140:141], 0 cbsz:4 abid:0
    v_mfma_f32_4x4x4_16b_bf16 v[168:171], v[228:229], v[140:141], 0 cbsz:4 abid:1
    v_mfma_f32_4x4x4_16b_bf16 v[172:175], v[228:229], v[140:141], 0 cbsz:4 abid:2
    v_mfma_f32_4x4x4_16b_bf16 v[176:179], v[228:229], v[140:141], 0 cbsz:4 abid:3
    v_add_u32 v23, 112384, v159
    s_nop 0
    v_cvt_pk_bf16_f32 v180, v164, v165
    v_cvt_pk_bf16_f32 v181, v166, v167
    v_cvt_pk_bf16_f32 v182, v168, v169
    v_cvt_pk_bf16_f32 v183, v170, v171
    v_cvt_pk_bf16_f32 v184, v172, v173
    v_cvt_pk_bf16_f32 v185, v174, v175
    v_cvt_pk_bf16_f32 v186, v176, v177
    v_cvt_pk_bf16_f32 v187, v178, v179
    s_waitcnt lgkmcnt(0)
    s_barrier
    ds_read_b32 v12, v18 offset:18688
    ds_read_b32 v13, v19 offset:18688
    ds_write_b128 v23, v[180:183]
    ds_write_b128 v23, v[184:187] offset:16
    v_lshlrev_b32 v19, 4, v19
    v_and_b32 v142, 0xfffc00, v142
    v_and_b32 v146, 0xfffc00, v146
    v_and_b32 v150, 0xfffc00, v150
    s_waitcnt lgkmcnt(2)
    v_mad_u32_u24 v21, v13, s69, v21
    v_mad_u32_u24 v20, v12, s69, v20
    v_readlane_b32 s96, v21, 0
    v_readlane_b32 s97, v21, 1
    v_readlane_b32 s98, v21, 2
    v_readlane_b32 s99, v21, 3
    v_readlane_b32 s100, v21, 4
    v_lshl_add_u32 v19, v13, 16, v19
    v_cmp_lt_u32 s[36:37], s96, v20
    v_cmp_lt_u32 s[38:39], s97, v20
    v_cmp_lt_u32 s[40:41], s98, v20
    v_cmp_lt_u32 s[42:43], s99, v20
    v_cmp_lt_u32 s[44:45], s100, v20
    s_bcnt1_i32_b64 s96, s[36:37]
    v_writelane_b32 v12, s96, 0
    s_bcnt1_i32_b64 s97, s[38:39]
    v_writelane_b32 v12, s97, 1
    s_bcnt1_i32_b64 s98, s[40:41]
    v_writelane_b32 v12, s98, 2
    s_bcnt1_i32_b64 s99, s[42:43]
    v_writelane_b32 v12, s99, 3
    s_bcnt1_i32_b64 s100, s[44:45]
    v_writelane_b32 v12, s100, 4
    s_mov_b64 exec, 31
    v_lshlrev_b32 v12, 2, v12
    ds_write_b32 v12, v19 offset:19200
    s_mov_b64 exec, -1
    s_add_u32 m0, s30, 87808
    s_nop 0
    buffer_load_dwordx4 v155, s[12:15], 0 offen sc1 lds
    s_waitcnt lgkmcnt(0)
    s_barrier
    ds_read_b32 v12, v15 offset:19200
    v_mfma_f32_4x4x4_16b_bf16 v[164:167], v[228:229], v[144:145], 0 cbsz:4 abid:0
    v_mfma_f32_4x4x4_16b_bf16 v[168:171], v[228:229], v[144:145], 0 cbsz:4 abid:1
    v_mfma_f32_4x4x4_16b_bf16 v[172:175], v[228:229], v[144:145], 0 cbsz:4 abid:2
    v_mfma_f32_4x4x4_16b_bf16 v[176:179], v[228:229], v[144:145], 0 cbsz:4 abid:3
    v_add_u32 v23, 112384, v161
    s_nop 0
    v_cvt_pk_bf16_f32 v180, v164, v165
    v_cvt_pk_bf16_f32 v181, v166, v167
    v_cvt_pk_bf16_f32 v182, v168, v169
    v_cvt_pk_bf16_f32 v183, v170, v171
    v_cvt_pk_bf16_f32 v184, v172, v173
    v_cvt_pk_bf16_f32 v185, v174, v175
    v_cvt_pk_bf16_f32 v186, v176, v177
    v_cvt_pk_bf16_f32 v187, v178, v179
    s_waitcnt lgkmcnt(0)
    v_add_u32_sdwa v16, v12, v16 dst_sel:DWORD dst_unused:UNUSED_PAD src0_sel:WORD_0 src1_sel:DWORD
    ds_read_b32 v13, v16 offset:16128
    v_readlane_b32 s96, v12, 0
    v_readlane_b32 s97, v12, 1
    v_readlane_b32 s98, v12, 2
    v_readlane_b32 s99, v12, 3
    v_readlane_b32 s100, v12, 4
    s_add_u32 s3, s96, s97
    s_add_u32 s3, s3, s98
    s_add_u32 s3, s3, s99
    s_add_u32 s3, s3, s100
    s_lshr_b32 s29, s3, 16
    s_add_u32 s3, s29, 480
    v_mov_b32 v14, s3
    v_mov_b32 v18, 0
    s_mov_b64 exec, 1
    ds_add_rtn_u32 v14, v18, v14 offset:19456
    s_mov_b64 exec, -1
    s_waitcnt lgkmcnt(1)
    v_sub_u32 v17, v17, v13
    s_nop 0
    v_add_u32_dpp v13, v13, v13 row_shr:1 row_mask:0xf bank_mask:0xf
    s_nop 1
    v_add_u32_dpp v13, v13, v13 row_shr:2 row_mask:0xf bank_mask:0xf
    v_mov_b32 v20, 2147482664
    v_mov_b32 v21, 0
    v_add_u32_dpp v13, v13, v13 row_shr:4 row_mask:0xf bank_mask:0xf
    s_nop 1
    v_add_u32_dpp v13, v13, v13 row_shr:8 row_mask:0xf bank_mask:0xf
    s_waitcnt lgkmcnt(0)
    v_readfirstlane_b32 s71, v14
    v_add_u32_dpp v13, v13, v13 row_bcast:15 row_mask:0xa bank_mask:0xf
    s_add_u32 s3, s71, s29
    v_lshl_add_u32 v18, v11, 3, s3
    v_add_u32_dpp v13, v13, v13 row_bcast:31 row_mask:0xc bank_mask:0xf
    s_mov_b32 exec_hi, 0x0fffffff
    v_add3_u32 v13, v13, v17, s71
    ds_write_b32 v16, v13 offset:16128
    ds_write_b64 v18, v[20:21] offset:0
    s_mov_b64 exec, -1
    ds_write_b128 v23, v[180:183]
    ds_write_b128 v23, v[184:187] offset:16
    s_add_u32 m0, s30, 96000
    s_nop 0
    buffer_load_dwordx4 v156, s[12:15], 0 offen sc1 lds
    s_waitcnt lgkmcnt(2)
    s_barrier
    ds_read_b32 v12, v143 offset:16128
    ds_read_b32 v13, v147 offset:16128
    ds_read_b32 v14, v151 offset:16128
    v_add_u32 v4, s71, v4
    v_add_u32 v5, s71, v5
    v_add_u32 v6, s71, v6
    s_lshr_b32 s29, s29, 3
    s_mov_b64 exec, s[56:57]
    s_waitcnt lgkmcnt(2)
    v_add_u32_sdwa v132, v12, v132 dst_sel:DWORD dst_unused:UNUSED_PAD src0_sel:WORD_0 src1_sel:DWORD
    v_or_b32_sdwa v158, v12, v142 dst_sel:DWORD dst_unused:UNUSED_PAD src0_sel:WORD_1 src1_sel:DWORD
    ds_write_b64 v132, v[158:159] offset:0
    s_mov_b64 exec, s[58:59]
    s_waitcnt lgkmcnt(2)
    v_add_u32_sdwa v133, v13, v133 dst_sel:DWORD dst_unused:UNUSED_PAD src0_sel:WORD_0 src1_sel:DWORD
    v_or_b32_sdwa v160, v13, v146 dst_sel:DWORD dst_unused:UNUSED_PAD src0_sel:WORD_1 src1_sel:DWORD
    ds_write_b64 v133, v[160:161] offset:0
    s_mov_b64 exec, s[60:61]
    s_waitcnt lgkmcnt(2)
    v_add_u32_sdwa v134, v14, v134 dst_sel:DWORD dst_unused:UNUSED_PAD src0_sel:WORD_0 src1_sel:DWORD
    v_or_b32_sdwa v162, v14, v150 dst_sel:DWORD dst_unused:UNUSED_PAD src0_sel:WORD_1 src1_sel:DWORD
    ds_write_b64 v134, v[162:163] offset:0
    s_mov_b64 exec, -1
    s_add_u32 m0, s30, 104192
    s_nop 0
    buffer_load_dwordx4 v157, s[12:15], 0 offen sc1 lds
    s_waitcnt lgkmcnt(0)
    s_barrier
    ds_read_b32 v12, v4
    ds_read_b32 v7, v4 offset:64
    ds_read_b32 v9, v5 offset:4
    ds_read_b32 v10, v6 offset:4
    s_cmp_eq_u64 s[60:61], 0
    s_cbranch_scc1 L_not3
    v_mfma_f32_4x4x4_16b_bf16 v[164:167], v[228:229], v[148:149], 0 cbsz:4 abid:0
    v_mfma_f32_4x4x4_16b_bf16 v[168:171], v[228:229], v[148:149], 0 cbsz:4 abid:1
    v_mfma_f32_4x4x4_16b_bf16 v[172:175], v[228:229], v[148:149], 0 cbsz:4 abid:2
    v_mfma_f32_4x4x4_16b_bf16 v[176:179], v[228:229], v[148:149], 0 cbsz:4 abid:3
    v_add_u32 v23, 112384, v163
    s_nop 0
    v_cvt_pk_bf16_f32 v180, v164, v165
    v_cvt_pk_bf16_f32 v181, v166, v167
    v_cvt_pk_bf16_f32 v182, v168, v169
    v_cvt_pk_bf16_f32 v183, v170, v171
    v_cvt_pk_bf16_f32 v184, v172, v173
    v_cvt_pk_bf16_f32 v185, v174, v175
    v_cvt_pk_bf16_f32 v186, v176, v177
    v_cvt_pk_bf16_f32 v187, v178, v179
    ds_write_b128 v23, v[180:183]
    ds_write_b128 v23, v[184:187] offset:16
    s_waitcnt lgkmcnt(2)
    s_branch L_t3
L_not3:
    s_waitcnt lgkmcnt(0)
L_t3:
    v_readlane_b32 s36, v12, 0
    v_readlane_b32 s37, v12, 1
    v_readlane_b32 s38, v12, 2
    v_readlane_b32 s39, v12, 3
    s_and_b32 s70, s36, 4294966272
    buffer_load_dwordx4 v[196:199], v1, s[4:7], s70 offen
    s_and_b32 s71, s37, 4294966272
    buffer_load_dwordx4 v[200:203], v1, s[4:7], s71 offen
    s_and_b32 s70, s38, 4294966272
    buffer_load_dwordx4 v[204:207], v1, s[4:7], s70 offen
    s_and_b32 s71, s39, 4294966272
    buffer_load_dwordx4 v[208:211], v1, s[4:7], s71 offen
    v_readlane_b32 s40, v12, 4
    v_readlane_b32 s41, v12, 5
    v_readlane_b32 s42, v12, 6
    v_readlane_b32 s43, v12, 7
    v_add_u32 v9, v9, v2
    v_add_u32 v10, v10, v3
    v_readlane_b32 s44, v7, 0
    s_and_b32 s96, s96, 0xffff
    s_mulk_i32 s96, 18
    s_and_b32 s97, s97, 0xffff
    s_mulk_i32 s97, 18
    s_and_b32 s98, s98, 0xffff
    s_mulk_i32 s98, 18
    s_and_b32 s99, s99, 0xffff
    s_mulk_i32 s99, 18
    s_and_b32 s100, s100, 0xffff
    s_mulk_i32 s100, 18
    s_and_b32 s68, s44, 4294966272
    s_waitcnt vmcnt(4) lgkmcnt(0)
    s_barrier
    s_cmp_eq_u32 s29, 0
    s_cbranch_scc1 L_exit
    s_sub_u32 s29, s29, 1
    s_mov_b64 exec, s[32:33]
    ds_read_b128 v[24:27], v9 offset:63232
    s_mov_b64 exec, s[34:35]
    ds_read_b128 v[28:31], v9 offset:63232
    s_mov_b64 exec, -1
    ds_read_b64 v[32:33], v10
    s_and_b32 s70, s40, 4294966272
    buffer_load_dwordx4 v[212:215], v1, s[4:7], s70 offen
    s_and_b32 s71, s41, 4294966272
    buffer_load_dwordx4 v[216:219], v1, s[4:7], s71 offen
    s_waitcnt lgkmcnt(1)
    v_mfma_f32_32x32x16_bf16 v[132:147], v[24:27], v[36:39], 0
    v_mfma_f32_32x32x16_bf16 v[132:147], v[28:31], v[40:43], v[132:147]
    v_mfma_f32_32x32x16_bf16 v[148:163], v[24:27], v[44:47], 0
    v_mfma_f32_32x32x16_bf16 v[148:163], v[28:31], v[48:51], v[148:163]
    s_and_b32 s70, s42, 4294966272
    buffer_load_dwordx4 v[220:223], v1, s[4:7], s70 offen
    s_and_b32 s71, s43, 4294966272
    buffer_load_dwordx4 v[224:227], v1, s[4:7], s71 offen
    s_waitcnt lgkmcnt(0)
    s_nop 6
    v_exp_f32 v12, v132
    v_exp_f32 v13, v133
    v_exp_f32 v14, v148
    v_exp_f32 v15, v149
    v_pk_add_f32 v[12:13], v[12:13], 1.0 op_sel_hi:[1,0]
    v_pk_add_f32 v[14:15], v[14:15], 1.0 op_sel_hi:[1,0]
    v_rcp_f32 v12, v12
    v_rcp_f32 v13, v13
    s_nop 0
    v_pk_mul_f32 v[132:133], v[132:133], v[12:13]
L_loop:
    s_setprio 3
    ds_read_b32 v9, v5 offset:132
    ds_read_b32 v10, v6 offset:132
    ds_read_b32 v8, v4 offset:192
    s_waitcnt vmcnt(7)
    v_rcp_f32 v14, v14
    v_mfma_f32_4x4x4_16b_bf16 v[16:19], v[32:33], v[196:197], 0 cbsz:4 abid:0
    v_exp_f32 v13, v135
    v_mfma_f32_4x4x4_16b_bf16 v[20:23], v[32:33], v[198:199], 0 cbsz:4 abid:0
    v_exp_f32 v12, v134
    v_readlane_b32 s45, v7, 1
    v_rcp_f32 v15, v15
    v_pk_add_f32 v[12:13], v[12:13], 1.0 op_sel_hi:[1,0]
    v_pk_mul_f32 v[148:149], v[148:149], v[14:15]
    s_and_b32 s69, s45, 4294966272
    s_set_gpr_idx_on s36, gpr_idx(SRC2,DST)
    buffer_load_dwordx4 v[196:199], v1, s[4:7], s68 offen
    v_pk_fma_f32 v[84:85], v[132:133], v[16:17], v[84:85] op_sel_hi:[0,1,1]
    v_pk_fma_f32 v[86:87], v[132:133], v[18:19], v[86:87] op_sel_hi:[0,1,1]
    v_pk_fma_f32 v[88:89], v[148:149], v[20:21], v[88:89] op_sel_hi:[0,1,1]
    v_pk_fma_f32 v[90:91], v[148:149], v[22:23], v[90:91] op_sel_hi:[0,1,1]
    s_set_gpr_idx_off
    s_waitcnt vmcnt(7)
    v_rcp_f32 v12, v12
    v_mfma_f32_4x4x4_16b_bf16 v[16:19], v[32:33], v[200:201], 0 cbsz:4 abid:1
    v_exp_f32 v15, v151
    v_mfma_f32_4x4x4_16b_bf16 v[20:23], v[32:33], v[202:203], 0 cbsz:4 abid:1
    v_exp_f32 v14, v150
    v_readlane_b32 s46, v7, 2
    v_rcp_f32 v13, v13
    v_pk_add_f32 v[14:15], v[14:15], 1.0 op_sel_hi:[1,0]
    v_pk_mul_f32 v[134:135], v[134:135], v[12:13]
    s_and_b32 s68, s46, 4294966272
    s_set_gpr_idx_on s37, gpr_idx(SRC2,DST)
    buffer_load_dwordx4 v[200:203], v1, s[4:7], s69 offen
    v_pk_fma_f32 v[84:85], v[132:133], v[16:17], v[84:85] op_sel:[1,0,0]
    v_pk_fma_f32 v[86:87], v[132:133], v[18:19], v[86:87] op_sel:[1,0,0]
    v_pk_fma_f32 v[88:89], v[148:149], v[20:21], v[88:89] op_sel:[1,0,0]
    v_pk_fma_f32 v[90:91], v[148:149], v[22:23], v[90:91] op_sel:[1,0,0]
    s_set_gpr_idx_off
    s_waitcnt lgkmcnt(0)
    v_add_u32 v9, v9, v2
    v_add_u32 v10, v10, v3
    s_mov_b64 exec, s[32:33]
    ds_read_b128 v[24:27], v9 offset:63232
    s_mov_b64 exec, s[34:35]
    ds_read_b128 v[28:31], v9 offset:63232
    s_mov_b64 exec, -1
    ds_read_b64 v[34:35], v10
    s_waitcnt vmcnt(7)
    v_rcp_f32 v14, v14
    v_mfma_f32_4x4x4_16b_bf16 v[16:19], v[32:33], v[204:205], 0 cbsz:4 abid:2
    v_exp_f32 v13, v137
    v_mfma_f32_4x4x4_16b_bf16 v[20:23], v[32:33], v[206:207], 0 cbsz:4 abid:2
    v_exp_f32 v12, v136
    v_readlane_b32 s47, v7, 3
    v_rcp_f32 v15, v15
    v_pk_add_f32 v[12:13], v[12:13], 1.0 op_sel_hi:[1,0]
    v_pk_mul_f32 v[150:151], v[150:151], v[14:15]
    s_and_b32 s69, s47, 4294966272
    s_set_gpr_idx_on s38, gpr_idx(SRC2,DST)
    buffer_load_dwordx4 v[204:207], v1, s[4:7], s68 offen
    v_pk_fma_f32 v[84:85], v[134:135], v[16:17], v[84:85] op_sel_hi:[0,1,1]
    v_pk_fma_f32 v[86:87], v[134:135], v[18:19], v[86:87] op_sel_hi:[0,1,1]
    v_pk_fma_f32 v[88:89], v[150:151], v[20:21], v[88:89] op_sel_hi:[0,1,1]
    v_pk_fma_f32 v[90:91], v[150:151], v[22:23], v[90:91] op_sel_hi:[0,1,1]
    s_set_gpr_idx_off
    s_waitcnt vmcnt(7)
    v_rcp_f32 v12, v12
    v_mfma_f32_4x4x4_16b_bf16 v[16:19], v[32:33], v[208:209], 0 cbsz:4 abid:3
    v_exp_f32 v15, v153
    v_mfma_f32_4x4x4_16b_bf16 v[20:23], v[32:33], v[210:211], 0 cbsz:4 abid:3
    v_exp_f32 v14, v152
    v_readlane_b32 s48, v7, 4
    v_rcp_f32 v13, v13
    v_pk_add_f32 v[14:15], v[14:15], 1.0 op_sel_hi:[1,0]
    v_pk_mul_f32 v[136:137], v[136:137], v[12:13]
    s_and_b32 s68, s48, 4294966272
    s_set_gpr_idx_on s39, gpr_idx(SRC2,DST)
    buffer_load_dwordx4 v[208:211], v1, s[4:7], s69 offen
    v_pk_fma_f32 v[84:85], v[134:135], v[16:17], v[84:85] op_sel:[1,0,0]
    v_pk_fma_f32 v[86:87], v[134:135], v[18:19], v[86:87] op_sel:[1,0,0]
    v_pk_fma_f32 v[88:89], v[150:151], v[20:21], v[88:89] op_sel:[1,0,0]
    v_pk_fma_f32 v[90:91], v[150:151], v[22:23], v[90:91] op_sel:[1,0,0]
    s_set_gpr_idx_off
    s_sub_u32 s29, s29, 4
    s_cbranch_scc1 L_exit
    s_setprio 2
    s_waitcnt vmcnt(7)
    v_rcp_f32 v14, v14
    v_mfma_f32_4x4x4_16b_bf16 v[16:19], v[32:33], v[212:213], 0 cbsz:4 abid:4
    v_exp_f32 v13, v139
    v_mfma_f32_4x4x4_16b_bf16 v[20:23], v[32:33], v[214:215], 0 cbsz:4 abid:4
    v_exp_f32 v12, v138
    v_readlane_b32 s49, v7, 5
    v_rcp_f32 v15, v15
    v_pk_add_f32 v[12:13], v[12:13], 1.0 op_sel_hi:[1,0]
    v_pk_mul_f32 v[152:153], v[152:153], v[14:15]
    s_and_b32 s69, s49, 4294966272
    s_set_gpr_idx_on s40, gpr_idx(SRC2,DST)
    buffer_load_dwordx4 v[212:215], v1, s[4:7], s68 offen
    v_pk_fma_f32 v[84:85], v[136:137], v[16:17], v[84:85] op_sel_hi:[0,1,1]
    v_pk_fma_f32 v[86:87], v[136:137], v[18:19], v[86:87] op_sel_hi:[0,1,1]
    v_pk_fma_f32 v[88:89], v[152:153], v[20:21], v[88:89] op_sel_hi:[0,1,1]
    v_pk_fma_f32 v[90:91], v[152:153], v[22:23], v[90:91] op_sel_hi:[0,1,1]
    s_set_gpr_idx_off
    s_waitcnt vmcnt(7) lgkmcnt(0)
    v_mfma_f32_4x4x4_16b_bf16 v[20:23], v[32:33], v[218:219], 0 cbsz:4 abid:5
    v_mfma_f32_4x4x4_16b_bf16 v[16:19], v[32:33], v[216:217], 0 cbsz:4 abid:5
    v_rcp_f32 v13, v13
    v_mfma_f32_32x32x16_bf16 v[164:179], v[24:27], v[36:39], 0
    v_exp_f32 v14, v154
    v_exp_f32 v15, v155
    v_readlane_b32 s50, v7, 6
    v_rcp_f32 v12, v12
    v_pk_add_f32 v[14:15], v[14:15], 1.0 op_sel_hi:[1,0]
    v_pk_mul_f32 v[138:139], v[138:139], v[12:13]
    s_and_b32 s68, s50, 4294966272
    s_set_gpr_idx_on s41, gpr_idx(SRC2,DST)
    buffer_load_dwordx4 v[216:219], v1, s[4:7], s69 offen
    v_pk_fma_f32 v[84:85], v[136:137], v[16:17], v[84:85] op_sel:[1,0,0]
    v_pk_fma_f32 v[86:87], v[136:137], v[18:19], v[86:87] op_sel:[1,0,0]
    v_pk_fma_f32 v[88:89], v[152:153], v[20:21], v[88:89] op_sel:[1,0,0]
    v_pk_fma_f32 v[90:91], v[152:153], v[22:23], v[90:91] op_sel:[1,0,0]
    s_set_gpr_idx_off
    s_waitcnt vmcnt(7)
    v_rcp_f32 v14, v14
    v_mfma_f32_4x4x4_16b_bf16 v[16:19], v[32:33], v[220:221], 0 cbsz:4 abid:6
    v_exp_f32 v13, v141
    v_mfma_f32_4x4x4_16b_bf16 v[20:23], v[32:33], v[222:223], 0 cbsz:4 abid:6
    v_exp_f32 v12, v140
    v_readlane_b32 s51, v7, 7
    v_rcp_f32 v15, v15
    v_pk_add_f32 v[12:13], v[12:13], 1.0 op_sel_hi:[1,0]
    v_pk_mul_f32 v[154:155], v[154:155], v[14:15]
    s_and_b32 s69, s51, 4294966272
    s_set_gpr_idx_on s42, gpr_idx(SRC2,DST)
    buffer_load_dwordx4 v[220:223], v1, s[4:7], s68 offen
    v_pk_fma_f32 v[84:85], v[138:139], v[16:17], v[84:85] op_sel_hi:[0,1,1]
    v_pk_fma_f32 v[86:87], v[138:139], v[18:19], v[86:87] op_sel_hi:[0,1,1]
    v_pk_fma_f32 v[88:89], v[154:155], v[20:21], v[88:89] op_sel_hi:[0,1,1]
    v_pk_fma_f32 v[90:91], v[154:155], v[22:23], v[90:91] op_sel_hi:[0,1,1]
    s_set_gpr_idx_off
    s_waitcnt vmcnt(7)
    v_mfma_f32_4x4x4_16b_bf16 v[20:23], v[32:33], v[226:227], 0 cbsz:4 abid:7
    v_mfma_f32_4x4x4_16b_bf16 v[16:19], v[32:33], v[224:225], 0 cbsz:4 abid:7
    v_rcp_f32 v13, v13
    v_mfma_f32_32x32x16_bf16 v[164:179], v[28:31], v[40:43], v[164:179]
    v_exp_f32 v14, v156
    v_exp_f32 v15, v157
    v_readlane_b32 s52, v7, 8
    v_rcp_f32 v12, v12
    v_pk_add_f32 v[14:15], v[14:15], 1.0 op_sel_hi:[1,0]
    v_pk_mul_f32 v[140:141], v[140:141], v[12:13]
    s_and_b32 s68, s52, 4294966272
    s_set_gpr_idx_on s43, gpr_idx(SRC2,DST)
    buffer_load_dwordx4 v[224:227], v1, s[4:7], s69 offen
    v_pk_fma_f32 v[84:85], v[138:139], v[16:17], v[84:85] op_sel:[1,0,0]
    v_pk_fma_f32 v[86:87], v[138:139], v[18:19], v[86:87] op_sel:[1,0,0]
    v_pk_fma_f32 v[88:89], v[154:155], v[20:21], v[88:89] op_sel:[1,0,0]
    v_pk_fma_f32 v[90:91], v[154:155], v[22:23], v[90:91] op_sel:[1,0,0]
    s_set_gpr_idx_off
    s_sub_u32 s29, s29, 4
    s_cbranch_scc1 L_exit
    s_setprio 1
    s_waitcnt vmcnt(7)
    v_rcp_f32 v14, v14
    v_mfma_f32_4x4x4_16b_bf16 v[16:19], v[32:33], v[196:197], 0 cbsz:4 abid:8
    v_exp_f32 v13, v143
    v_mfma_f32_4x4x4_16b_bf16 v[20:23], v[32:33], v[198:199], 0 cbsz:4 abid:8
    v_exp_f32 v12, v142
    v_readlane_b32 s53, v7, 9
    v_rcp_f32 v15, v15
    v_pk_add_f32 v[12:13], v[12:13], 1.0 op_sel_hi:[1,0]
    v_pk_mul_f32 v[156:157], v[156:157], v[14:15]
    s_and_b32 s69, s53, 4294966272
    s_set_gpr_idx_on s44, gpr_idx(SRC2,DST)
    buffer_load_dwordx4 v[196:199], v1, s[4:7], s68 offen
    v_pk_fma_f32 v[84:85], v[140:141], v[16:17], v[84:85] op_sel_hi:[0,1,1]
    v_pk_fma_f32 v[86:87], v[140:141], v[18:19], v[86:87] op_sel_hi:[0,1,1]
    v_pk_fma_f32 v[88:89], v[156:157], v[20:21], v[88:89] op_sel_hi:[0,1,1]
    v_pk_fma_f32 v[90:91], v[156:157], v[22:23], v[90:91] op_sel_hi:[0,1,1]
    s_set_gpr_idx_off
    s_waitcnt vmcnt(7)
    v_mfma_f32_4x4x4_16b_bf16 v[20:23], v[32:33], v[202:203], 0 cbsz:4 abid:9
    v_mfma_f32_4x4x4_16b_bf16 v[16:19], v[32:33], v[200:201], 0 cbsz:4 abid:9
    v_rcp_f32 v13, v13
    v_mfma_f32_32x32x16_bf16 v[180:195], v[24:27], v[44:47], 0
    v_exp_f32 v14, v158
    v_exp_f32 v15, v159
    v_readlane_b32 s54, v7, 10
    v_rcp_f32 v12, v12
    v_pk_add_f32 v[14:15], v[14:15], 1.0 op_sel_hi:[1,0]
    v_pk_mul_f32 v[142:143], v[142:143], v[12:13]
    s_and_b32 s68, s54, 4294966272
    s_set_gpr_idx_on s45, gpr_idx(SRC2,DST)
    buffer_load_dwordx4 v[200:203], v1, s[4:7], s69 offen
    v_pk_fma_f32 v[84:85], v[140:141], v[16:17], v[84:85] op_sel:[1,0,0]
    v_pk_fma_f32 v[86:87], v[140:141], v[18:19], v[86:87] op_sel:[1,0,0]
    v_pk_fma_f32 v[88:89], v[156:157], v[20:21], v[88:89] op_sel:[1,0,0]
    v_pk_fma_f32 v[90:91], v[156:157], v[22:23], v[90:91] op_sel:[1,0,0]
    s_set_gpr_idx_off
    s_waitcnt vmcnt(7)
    v_rcp_f32 v14, v14
    v_mfma_f32_4x4x4_16b_bf16 v[16:19], v[32:33], v[204:205], 0 cbsz:4 abid:10
    v_exp_f32 v13, v145
    v_mfma_f32_4x4x4_16b_bf16 v[20:23], v[32:33], v[206:207], 0 cbsz:4 abid:10
    v_exp_f32 v12, v144
    v_readlane_b32 s55, v7, 11
    v_rcp_f32 v15, v15
    v_pk_add_f32 v[12:13], v[12:13], 1.0 op_sel_hi:[1,0]
    v_pk_mul_f32 v[158:159], v[158:159], v[14:15]
    s_and_b32 s69, s55, 4294966272
    s_set_gpr_idx_on s46, gpr_idx(SRC2,DST)
    buffer_load_dwordx4 v[204:207], v1, s[4:7], s68 offen
    v_pk_fma_f32 v[84:85], v[142:143], v[16:17], v[84:85] op_sel_hi:[0,1,1]
    v_pk_fma_f32 v[86:87], v[142:143], v[18:19], v[86:87] op_sel_hi:[0,1,1]
    v_pk_fma_f32 v[88:89], v[158:159], v[20:21], v[88:89] op_sel_hi:[0,1,1]
    v_pk_fma_f32 v[90:91], v[158:159], v[22:23], v[90:91] op_sel_hi:[0,1,1]
    s_set_gpr_idx_off
    s_waitcnt vmcnt(7)
    v_mfma_f32_4x4x4_16b_bf16 v[20:23], v[32:33], v[210:211], 0 cbsz:4 abid:11
    v_mfma_f32_4x4x4_16b_bf16 v[16:19], v[32:33], v[208:209], 0 cbsz:4 abid:11
    v_rcp_f32 v13, v13
    v_mfma_f32_32x32x16_bf16 v[180:195], v[28:31], v[48:51], v[180:195]
    v_exp_f32 v14, v160
    v_exp_f32 v15, v161
    v_readlane_b32 s56, v7, 12
    v_rcp_f32 v12, v12
    v_pk_add_f32 v[14:15], v[14:15], 1.0 op_sel_hi:[1,0]
    v_pk_mul_f32 v[144:145], v[144:145], v[12:13]
    s_and_b32 s68, s56, 4294966272
    s_set_gpr_idx_on s47, gpr_idx(SRC2,DST)
    buffer_load_dwordx4 v[208:211], v1, s[4:7], s69 offen
    v_pk_fma_f32 v[84:85], v[142:143], v[16:17], v[84:85] op_sel:[1,0,0]
    v_pk_fma_f32 v[86:87], v[142:143], v[18:19], v[86:87] op_sel:[1,0,0]
    v_pk_fma_f32 v[88:89], v[158:159], v[20:21], v[88:89] op_sel:[1,0,0]
    v_pk_fma_f32 v[90:91], v[158:159], v[22:23], v[90:91] op_sel:[1,0,0]
    s_set_gpr_idx_off
    s_sub_u32 s29, s29, 4
    s_cbranch_scc1 L_exit
    s_setprio 0
    s_waitcnt vmcnt(7)
    v_rcp_f32 v14, v14
    v_mfma_f32_4x4x4_16b_bf16 v[16:19], v[32:33], v[212:213], 0 cbsz:4 abid:12
    v_exp_f32 v13, v147
    v_mfma_f32_4x4x4_16b_bf16 v[20:23], v[32:33], v[214:215], 0 cbsz:4 abid:12
    v_exp_f32 v12, v146
    v_readlane_b32 s57, v7, 13
    v_rcp_f32 v15, v15
    v_pk_add_f32 v[12:13], v[12:13], 1.0 op_sel_hi:[1,0]
    v_pk_mul_f32 v[160:161], v[160:161], v[14:15]
    s_and_b32 s69, s57, 4294966272
    s_set_gpr_idx_on s48, gpr_idx(SRC2,DST)
    buffer_load_dwordx4 v[212:215], v1, s[4:7], s68 offen
    v_pk_fma_f32 v[84:85], v[144:145], v[16:17], v[84:85] op_sel_hi:[0,1,1]
    v_pk_fma_f32 v[86:87], v[144:145], v[18:19], v[86:87] op_sel_hi:[0,1,1]
    v_pk_fma_f32 v[88:89], v[160:161], v[20:21], v[88:89] op_sel_hi:[0,1,1]
    v_pk_fma_f32 v[90:91], v[160:161], v[22:23], v[90:91] op_sel_hi:[0,1,1]
    s_set_gpr_idx_off
    s_waitcnt vmcnt(7)
    v_rcp_f32 v12, v12
    v_mfma_f32_4x4x4_16b_bf16 v[16:19], v[32:33], v[216:217], 0 cbsz:4 abid:13
    v_exp_f32 v15, v163
    v_mfma_f32_4x4x4_16b_bf16 v[20:23], v[32:33], v[218:219], 0 cbsz:4 abid:13
    v_exp_f32 v14, v162
    v_readlane_b32 s58, v7, 14
    v_rcp_f32 v13, v13
    v_pk_add_f32 v[14:15], v[14:15], 1.0 op_sel_hi:[1,0]
    v_pk_mul_f32 v[146:147], v[146:147], v[12:13]
    s_and_b32 s68, s58, 4294966272
    s_set_gpr_idx_on s49, gpr_idx(SRC2,DST)
    buffer_load_dwordx4 v[216:219], v1, s[4:7], s69 offen
    v_pk_fma_f32 v[84:85], v[144:145], v[16:17], v[84:85] op_sel:[1,0,0]
    v_pk_fma_f32 v[86:87], v[144:145], v[18:19], v[86:87] op_sel:[1,0,0]
    v_pk_fma_f32 v[88:89], v[160:161], v[20:21], v[88:89] op_sel:[1,0,0]
    v_pk_fma_f32 v[90:91], v[160:161], v[22:23], v[90:91] op_sel:[1,0,0]
    s_set_gpr_idx_off
    s_waitcnt vmcnt(7)
    v_rcp_f32 v14, v14
    v_mfma_f32_4x4x4_16b_bf16 v[16:19], v[32:33], v[220:221], 0 cbsz:4 abid:14
    v_exp_f32 v13, v165
    v_mfma_f32_4x4x4_16b_bf16 v[20:23], v[32:33], v[222:223], 0 cbsz:4 abid:14
    v_exp_f32 v12, v164
    v_readlane_b32 s59, v7, 15
    v_rcp_f32 v15, v15
    v_pk_add_f32 v[12:13], v[12:13], 1.0 op_sel_hi:[1,0]
    v_pk_mul_f32 v[162:163], v[162:163], v[14:15]
    s_and_b32 s69, s59, 4294966272
    s_set_gpr_idx_on s50, gpr_idx(SRC2,DST)
    buffer_load_dwordx4 v[220:223], v1, s[4:7], s68 offen
    v_pk_fma_f32 v[84:85], v[146:147], v[16:17], v[84:85] op_sel_hi:[0,1,1]
    v_pk_fma_f32 v[86:87], v[146:147], v[18:19], v[86:87] op_sel_hi:[0,1,1]
    v_pk_fma_f32 v[88:89], v[162:163], v[20:21], v[88:89] op_sel_hi:[0,1,1]
    v_pk_fma_f32 v[90:91], v[162:163], v[22:23], v[90:91] op_sel_hi:[0,1,1]
    s_set_gpr_idx_off
    s_waitcnt vmcnt(7)
    v_rcp_f32 v12, v12
    v_mfma_f32_4x4x4_16b_bf16 v[16:19], v[32:33], v[224:225], 0 cbsz:4 abid:15
    v_exp_f32 v15, v181
    v_mfma_f32_4x4x4_16b_bf16 v[20:23], v[32:33], v[226:227], 0 cbsz:4 abid:15
    v_exp_f32 v14, v180
    v_readlane_b32 s60, v8, 0
    v_rcp_f32 v13, v13
    v_pk_add_f32 v[14:15], v[14:15], 1.0 op_sel_hi:[1,0]
    v_pk_mul_f32 v[164:165], v[164:165], v[12:13]
    s_and_b32 s68, s60, 4294966272
    s_set_gpr_idx_on s51, gpr_idx(SRC2,DST)
    buffer_load_dwordx4 v[224:227], v1, s[4:7], s69 offen
    v_pk_fma_f32 v[84:85], v[146:147], v[16:17], v[84:85] op_sel:[1,0,0]
    v_pk_fma_f32 v[86:87], v[146:147], v[18:19], v[86:87] op_sel:[1,0,0]
    v_pk_fma_f32 v[88:89], v[162:163], v[20:21], v[88:89] op_sel:[1,0,0]
    v_pk_fma_f32 v[90:91], v[162:163], v[22:23], v[90:91] op_sel:[1,0,0]
    s_set_gpr_idx_off
    s_sub_u32 s29, s29, 4
    s_cbranch_scc1 L_exit
    s_setprio 3
    ds_read_b32 v9, v5 offset:260
    ds_read_b32 v10, v6 offset:260
    ds_read_b32 v7, v4 offset:320
    s_waitcnt vmcnt(7)
    v_rcp_f32 v14, v14
    v_mfma_f32_4x4x4_16b_bf16 v[16:19], v[34:35], v[196:197], 0 cbsz:4 abid:0
    v_exp_f32 v13, v167
    v_mfma_f32_4x4x4_16b_bf16 v[20:23], v[34:35], v[198:199], 0 cbsz:4 abid:0
    v_exp_f32 v12, v166
    v_readlane_b32 s61, v8, 1
    v_rcp_f32 v15, v15
    v_pk_add_f32 v[12:13], v[12:13], 1.0 op_sel_hi:[1,0]
    v_pk_mul_f32 v[180:181], v[180:181], v[14:15]
    s_and_b32 s69, s61, 4294966272
    s_set_gpr_idx_on s52, gpr_idx(SRC2,DST)
    buffer_load_dwordx4 v[196:199], v1, s[4:7], s68 offen
    v_pk_fma_f32 v[84:85], v[164:165], v[16:17], v[84:85] op_sel_hi:[0,1,1]
    v_pk_fma_f32 v[86:87], v[164:165], v[18:19], v[86:87] op_sel_hi:[0,1,1]
    v_pk_fma_f32 v[88:89], v[180:181], v[20:21], v[88:89] op_sel_hi:[0,1,1]
    v_pk_fma_f32 v[90:91], v[180:181], v[22:23], v[90:91] op_sel_hi:[0,1,1]
    s_set_gpr_idx_off
    s_waitcnt vmcnt(7)
    v_rcp_f32 v12, v12
    v_mfma_f32_4x4x4_16b_bf16 v[16:19], v[34:35], v[200:201], 0 cbsz:4 abid:1
    v_exp_f32 v15, v183
    v_mfma_f32_4x4x4_16b_bf16 v[20:23], v[34:35], v[202:203], 0 cbsz:4 abid:1
    v_exp_f32 v14, v182
    v_readlane_b32 s62, v8, 2
    v_rcp_f32 v13, v13
    v_pk_add_f32 v[14:15], v[14:15], 1.0 op_sel_hi:[1,0]
    v_pk_mul_f32 v[166:167], v[166:167], v[12:13]
    s_and_b32 s68, s62, 4294966272
    s_set_gpr_idx_on s53, gpr_idx(SRC2,DST)
    buffer_load_dwordx4 v[200:203], v1, s[4:7], s69 offen
    v_pk_fma_f32 v[84:85], v[164:165], v[16:17], v[84:85] op_sel:[1,0,0]
    v_pk_fma_f32 v[86:87], v[164:165], v[18:19], v[86:87] op_sel:[1,0,0]
    v_pk_fma_f32 v[88:89], v[180:181], v[20:21], v[88:89] op_sel:[1,0,0]
    v_pk_fma_f32 v[90:91], v[180:181], v[22:23], v[90:91] op_sel:[1,0,0]
    s_set_gpr_idx_off
    s_waitcnt lgkmcnt(0)
    v_add_u32 v9, v9, v2
    v_add_u32 v10, v10, v3
    s_mov_b64 exec, s[32:33]
    ds_read_b128 v[24:27], v9 offset:63232
    s_mov_b64 exec, s[34:35]
    ds_read_b128 v[28:31], v9 offset:63232
    s_mov_b64 exec, -1
    ds_read_b64 v[32:33], v10
    s_waitcnt vmcnt(7)
    v_rcp_f32 v14, v14
    v_mfma_f32_4x4x4_16b_bf16 v[16:19], v[34:35], v[204:205], 0 cbsz:4 abid:2
    v_exp_f32 v13, v169
    v_mfma_f32_4x4x4_16b_bf16 v[20:23], v[34:35], v[206:207], 0 cbsz:4 abid:2
    v_exp_f32 v12, v168
    v_readlane_b32 s63, v8, 3
    v_rcp_f32 v15, v15
    v_pk_add_f32 v[12:13], v[12:13], 1.0 op_sel_hi:[1,0]
    v_pk_mul_f32 v[182:183], v[182:183], v[14:15]
    s_and_b32 s69, s63, 4294966272
    s_set_gpr_idx_on s54, gpr_idx(SRC2,DST)
    buffer_load_dwordx4 v[204:207], v1, s[4:7], s68 offen
    v_pk_fma_f32 v[84:85], v[166:167], v[16:17], v[84:85] op_sel_hi:[0,1,1]
    v_pk_fma_f32 v[86:87], v[166:167], v[18:19], v[86:87] op_sel_hi:[0,1,1]
    v_pk_fma_f32 v[88:89], v[182:183], v[20:21], v[88:89] op_sel_hi:[0,1,1]
    v_pk_fma_f32 v[90:91], v[182:183], v[22:23], v[90:91] op_sel_hi:[0,1,1]
    s_set_gpr_idx_off
    s_waitcnt vmcnt(7)
    v_rcp_f32 v12, v12
    v_mfma_f32_4x4x4_16b_bf16 v[16:19], v[34:35], v[208:209], 0 cbsz:4 abid:3
    v_exp_f32 v15, v185
    v_mfma_f32_4x4x4_16b_bf16 v[20:23], v[34:35], v[210:211], 0 cbsz:4 abid:3
    v_exp_f32 v14, v184
    v_readlane_b32 s64, v8, 4
    v_rcp_f32 v13, v13
    v_pk_add_f32 v[14:15], v[14:15], 1.0 op_sel_hi:[1,0]
    v_pk_mul_f32 v[168:169], v[168:169], v[12:13]
    s_and_b32 s68, s64, 4294966272
    s_set_gpr_idx_on s55, gpr_idx(SRC2,DST)
    buffer_load_dwordx4 v[208:211], v1, s[4:7], s69 offen
    v_pk_fma_f32 v[84:85], v[166:167], v[16:17], v[84:85] op_sel:[1,0,0]
    v_pk_fma_f32 v[86:87], v[166:167], v[18:19], v[86:87] op_sel:[1,0,0]
    v_pk_fma_f32 v[88:89], v[182:183], v[20:21], v[88:89] op_sel:[1,0,0]
    v_pk_fma_f32 v[90:91], v[182:183], v[22:23], v[90:91] op_sel:[1,0,0]
    s_set_gpr_idx_off
    s_sub_u32 s29, s29, 4
    s_cbranch_scc1 L_exit
    s_setprio 2
    s_waitcnt vmcnt(7)
    v_rcp_f32 v14, v14
    v_mfma_f32_4x4x4_16b_bf16 v[16:19], v[34:35], v[212:213], 0 cbsz:4 abid:4
    v_exp_f32 v13, v171
    v_mfma_f32_4x4x4_16b_bf16 v[20:23], v[34:35], v[214:215], 0 cbsz:4 abid:4
    v_exp_f32 v12, v170
    v_readlane_b32 s65, v8, 5
    v_rcp_f32 v15, v15
    v_pk_add_f32 v[12:13], v[12:13], 1.0 op_sel_hi:[1,0]
    v_pk_mul_f32 v[184:185], v[184:185], v[14:15]
    s_and_b32 s69, s65, 4294966272
    s_set_gpr_idx_on s56, gpr_idx(SRC2,DST)
    buffer_load_dwordx4 v[212:215], v1, s[4:7], s68 offen
    v_pk_fma_f32 v[84:85], v[168:169], v[16:17], v[84:85] op_sel_hi:[0,1,1]
    v_pk_fma_f32 v[86:87], v[168:169], v[18:19], v[86:87] op_sel_hi:[0,1,1]
    v_pk_fma_f32 v[88:89], v[184:185], v[20:21], v[88:89] op_sel_hi:[0,1,1]
    v_pk_fma_f32 v[90:91], v[184:185], v[22:23], v[90:91] op_sel_hi:[0,1,1]
    s_set_gpr_idx_off
    s_waitcnt vmcnt(7) lgkmcnt(0)
    v_mfma_f32_4x4x4_16b_bf16 v[20:23], v[34:35], v[218:219], 0 cbsz:4 abid:5
    v_mfma_f32_4x4x4_16b_bf16 v[16:19], v[34:35], v[216:217], 0 cbsz:4 abid:5
    v_rcp_f32 v13, v13
    v_mfma_f32_32x32x16_bf16 v[132:147], v[24:27], v[36:39], 0
    v_exp_f32 v14, v186
    v_exp_f32 v15, v187
    v_readlane_b32 s66, v8, 6
    v_rcp_f32 v12, v12
    v_pk_add_f32 v[14:15], v[14:15], 1.0 op_sel_hi:[1,0]
    v_pk_mul_f32 v[170:171], v[170:171], v[12:13]
    s_and_b32 s68, s66, 4294966272
    s_set_gpr_idx_on s57, gpr_idx(SRC2,DST)
    buffer_load_dwordx4 v[216:219], v1, s[4:7], s69 offen
    v_pk_fma_f32 v[84:85], v[168:169], v[16:17], v[84:85] op_sel:[1,0,0]
    v_pk_fma_f32 v[86:87], v[168:169], v[18:19], v[86:87] op_sel:[1,0,0]
    v_pk_fma_f32 v[88:89], v[184:185], v[20:21], v[88:89] op_sel:[1,0,0]
    v_pk_fma_f32 v[90:91], v[184:185], v[22:23], v[90:91] op_sel:[1,0,0]
    s_set_gpr_idx_off
    s_waitcnt vmcnt(7)
    v_rcp_f32 v14, v14
    v_mfma_f32_4x4x4_16b_bf16 v[16:19], v[34:35], v[220:221], 0 cbsz:4 abid:6
    v_exp_f32 v13, v173
    v_mfma_f32_4x4x4_16b_bf16 v[20:23], v[34:35], v[222:223], 0 cbsz:4 abid:6
    v_exp_f32 v12, v172
    v_readlane_b32 s67, v8, 7
    v_rcp_f32 v15, v15
    v_pk_add_f32 v[12:13], v[12:13], 1.0 op_sel_hi:[1,0]
    v_pk_mul_f32 v[186:187], v[186:187], v[14:15]
    s_and_b32 s69, s67, 4294966272
    s_set_gpr_idx_on s58, gpr_idx(SRC2,DST)
    buffer_load_dwordx4 v[220:223], v1, s[4:7], s68 offen
    v_pk_fma_f32 v[84:85], v[170:171], v[16:17], v[84:85] op_sel_hi:[0,1,1]
    v_pk_fma_f32 v[86:87], v[170:171], v[18:19], v[86:87] op_sel_hi:[0,1,1]
    v_pk_fma_f32 v[88:89], v[186:187], v[20:21], v[88:89] op_sel_hi:[0,1,1]
    v_pk_fma_f32 v[90:91], v[186:187], v[22:23], v[90:91] op_sel_hi:[0,1,1]
    s_set_gpr_idx_off
    s_waitcnt vmcnt(7)
    v_mfma_f32_4x4x4_16b_bf16 v[20:23], v[34:35], v[226:227], 0 cbsz:4 abid:7
    v_mfma_f32_4x4x4_16b_bf16 v[16:19], v[34:35], v[224:225], 0 cbsz:4 abid:7
    v_rcp_f32 v13, v13
    v_mfma_f32_32x32x16_bf16 v[132:147], v[28:31], v[40:43], v[132:147]
    v_exp_f32 v14, v188
    v_exp_f32 v15, v189
    v_readlane_b32 s36, v8, 8
    v_rcp_f32 v12, v12
    v_pk_add_f32 v[14:15], v[14:15], 1.0 op_sel_hi:[1,0]
    v_pk_mul_f32 v[172:173], v[172:173], v[12:13]
    s_and_b32 s68, s36, 4294966272
    s_set_gpr_idx_on s59, gpr_idx(SRC2,DST)
    buffer_load_dwordx4 v[224:227], v1, s[4:7], s69 offen
    v_pk_fma_f32 v[84:85], v[170:171], v[16:17], v[84:85] op_sel:[1,0,0]
    v_pk_fma_f32 v[86:87], v[170:171], v[18:19], v[86:87] op_sel:[1,0,0]
    v_pk_fma_f32 v[88:89], v[186:187], v[20:21], v[88:89] op_sel:[1,0,0]
    v_pk_fma_f32 v[90:91], v[186:187], v[22:23], v[90:91] op_sel:[1,0,0]
    s_set_gpr_idx_off
    s_sub_u32 s29, s29, 4
    s_cbranch_scc1 L_exit
    s_setprio 1
    s_waitcnt vmcnt(7)
    v_rcp_f32 v14, v14
    v_mfma_f32_4x4x4_16b_bf16 v[16:19], v[34:35], v[196:197], 0 cbsz:4 abid:8
    v_exp_f32 v13, v175
    v_mfma_f32_4x4x4_16b_bf16 v[20:23], v[34:35], v[198:199], 0 cbsz:4 abid:8
    v_exp_f32 v12, v174
    v_readlane_b32 s37, v8, 9
    v_rcp_f32 v15, v15
    v_pk_add_f32 v[12:13], v[12:13], 1.0 op_sel_hi:[1,0]
    v_pk_mul_f32 v[188:189], v[188:189], v[14:15]
    s_and_b32 s69, s37, 4294966272
    s_set_gpr_idx_on s60, gpr_idx(SRC2,DST)
    buffer_load_dwordx4 v[196:199], v1, s[4:7], s68 offen
    v_pk_fma_f32 v[84:85], v[172:173], v[16:17], v[84:85] op_sel_hi:[0,1,1]
    v_pk_fma_f32 v[86:87], v[172:173], v[18:19], v[86:87] op_sel_hi:[0,1,1]
    v_pk_fma_f32 v[88:89], v[188:189], v[20:21], v[88:89] op_sel_hi:[0,1,1]
    v_pk_fma_f32 v[90:91], v[188:189], v[22:23], v[90:91] op_sel_hi:[0,1,1]
    s_set_gpr_idx_off
    s_waitcnt vmcnt(7)
    v_mfma_f32_4x4x4_16b_bf16 v[20:23], v[34:35], v[202:203], 0 cbsz:4 abid:9
    v_mfma_f32_4x4x4_16b_bf16 v[16:19], v[34:35], v[200:201], 0 cbsz:4 abid:9
    v_rcp_f32 v13, v13
    v_mfma_f32_32x32x16_bf16 v[148:163], v[24:27], v[44:47], 0
    v_exp_f32 v14, v190
    v_exp_f32 v15, v191
    v_readlane_b32 s38, v8, 10
    v_rcp_f32 v12, v12
    v_pk_add_f32 v[14:15], v[14:15], 1.0 op_sel_hi:[1,0]
    v_pk_mul_f32 v[174:175], v[174:175], v[12:13]
    s_and_b32 s68, s38, 4294966272
    s_set_gpr_idx_on s61, gpr_idx(SRC2,DST)
    buffer_load_dwordx4 v[200:203], v1, s[4:7], s69 offen
    v_pk_fma_f32 v[84:85], v[172:173], v[16:17], v[84:85] op_sel:[1,0,0]
    v_pk_fma_f32 v[86:87], v[172:173], v[18:19], v[86:87] op_sel:[1,0,0]
    v_pk_fma_f32 v[88:89], v[188:189], v[20:21], v[88:89] op_sel:[1,0,0]
    v_pk_fma_f32 v[90:91], v[188:189], v[22:23], v[90:91] op_sel:[1,0,0]
    s_set_gpr_idx_off
    s_waitcnt vmcnt(7)
    v_rcp_f32 v14, v14
    v_mfma_f32_4x4x4_16b_bf16 v[16:19], v[34:35], v[204:205], 0 cbsz:4 abid:10
    v_exp_f32 v13, v177
    v_mfma_f32_4x4x4_16b_bf16 v[20:23], v[34:35], v[206:207], 0 cbsz:4 abid:10
    v_exp_f32 v12, v176
    v_readlane_b32 s39, v8, 11
    v_rcp_f32 v15, v15
    v_pk_add_f32 v[12:13], v[12:13], 1.0 op_sel_hi:[1,0]
    v_pk_mul_f32 v[190:191], v[190:191], v[14:15]
    s_and_b32 s69, s39, 4294966272
    s_set_gpr_idx_on s62, gpr_idx(SRC2,DST)
    buffer_load_dwordx4 v[204:207], v1, s[4:7], s68 offen
    v_pk_fma_f32 v[84:85], v[174:175], v[16:17], v[84:85] op_sel_hi:[0,1,1]
    v_pk_fma_f32 v[86:87], v[174:175], v[18:19], v[86:87] op_sel_hi:[0,1,1]
    v_pk_fma_f32 v[88:89], v[190:191], v[20:21], v[88:89] op_sel_hi:[0,1,1]
    v_pk_fma_f32 v[90:91], v[190:191], v[22:23], v[90:91] op_sel_hi:[0,1,1]
    s_set_gpr_idx_off
    s_waitcnt vmcnt(7)
    v_mfma_f32_4x4x4_16b_bf16 v[20:23], v[34:35], v[210:211], 0 cbsz:4 abid:11
    v_mfma_f32_4x4x4_16b_bf16 v[16:19], v[34:35], v[208:209], 0 cbsz:4 abid:11
    v_rcp_f32 v13, v13
    v_mfma_f32_32x32x16_bf16 v[148:163], v[28:31], v[48:51], v[148:163]
    v_exp_f32 v14, v192
    v_exp_f32 v15, v193
    v_readlane_b32 s40, v8, 12
    v_rcp_f32 v12, v12
    v_pk_add_f32 v[14:15], v[14:15], 1.0 op_sel_hi:[1,0]
    v_pk_mul_f32 v[176:177], v[176:177], v[12:13]
    s_and_b32 s68, s40, 4294966272
    s_set_gpr_idx_on s63, gpr_idx(SRC2,DST)
    buffer_load_dwordx4 v[208:211], v1, s[4:7], s69 offen
    v_pk_fma_f32 v[84:85], v[174:175], v[16:17], v[84:85] op_sel:[1,0,0]
    v_pk_fma_f32 v[86:87], v[174:175], v[18:19], v[86:87] op_sel:[1,0,0]
    v_pk_fma_f32 v[88:89], v[190:191], v[20:21], v[88:89] op_sel:[1,0,0]
    v_pk_fma_f32 v[90:91], v[190:191], v[22:23], v[90:91] op_sel:[1,0,0]
    s_set_gpr_idx_off
    s_sub_u32 s29, s29, 4
    s_cbranch_scc1 L_exit
    s_setprio 0
    s_waitcnt vmcnt(7)
    v_rcp_f32 v14, v14
    v_mfma_f32_4x4x4_16b_bf16 v[16:19], v[34:35], v[212:213], 0 cbsz:4 abid:12
    v_exp_f32 v13, v179
    v_mfma_f32_4x4x4_16b_bf16 v[20:23], v[34:35], v[214:215], 0 cbsz:4 abid:12
    v_exp_f32 v12, v178
    v_readlane_b32 s41, v8, 13
    v_rcp_f32 v15, v15
    v_pk_add_f32 v[12:13], v[12:13], 1.0 op_sel_hi:[1,0]
    v_pk_mul_f32 v[192:193], v[192:193], v[14:15]
    s_and_b32 s69, s41, 4294966272
    s_set_gpr_idx_on s64, gpr_idx(SRC2,DST)
    buffer_load_dwordx4 v[212:215], v1, s[4:7], s68 offen
    v_pk_fma_f32 v[84:85], v[176:177], v[16:17], v[84:85] op_sel_hi:[0,1,1]
    v_pk_fma_f32 v[86:87], v[176:177], v[18:19], v[86:87] op_sel_hi:[0,1,1]
    v_pk_fma_f32 v[88:89], v[192:193], v[20:21], v[88:89] op_sel_hi:[0,1,1]
    v_pk_fma_f32 v[90:91], v[192:193], v[22:23], v[90:91] op_sel_hi:[0,1,1]
    s_set_gpr_idx_off
    s_waitcnt vmcnt(7)
    v_rcp_f32 v12, v12
    v_mfma_f32_4x4x4_16b_bf16 v[16:19], v[34:35], v[216:217], 0 cbsz:4 abid:13
    v_exp_f32 v15, v195
    v_mfma_f32_4x4x4_16b_bf16 v[20:23], v[34:35], v[218:219], 0 cbsz:4 abid:13
    v_exp_f32 v14, v194
    v_readlane_b32 s42, v8, 14
    v_rcp_f32 v13, v13
    v_pk_add_f32 v[14:15], v[14:15], 1.0 op_sel_hi:[1,0]
    v_pk_mul_f32 v[178:179], v[178:179], v[12:13]
    s_and_b32 s68, s42, 4294966272
    s_set_gpr_idx_on s65, gpr_idx(SRC2,DST)
    buffer_load_dwordx4 v[216:219], v1, s[4:7], s69 offen
    v_pk_fma_f32 v[84:85], v[176:177], v[16:17], v[84:85] op_sel:[1,0,0]
    v_pk_fma_f32 v[86:87], v[176:177], v[18:19], v[86:87] op_sel:[1,0,0]
    v_pk_fma_f32 v[88:89], v[192:193], v[20:21], v[88:89] op_sel:[1,0,0]
    v_pk_fma_f32 v[90:91], v[192:193], v[22:23], v[90:91] op_sel:[1,0,0]
    s_set_gpr_idx_off
    s_waitcnt vmcnt(7)
    v_rcp_f32 v14, v14
    v_mfma_f32_4x4x4_16b_bf16 v[16:19], v[34:35], v[220:221], 0 cbsz:4 abid:14
    v_exp_f32 v13, v133
    v_mfma_f32_4x4x4_16b_bf16 v[20:23], v[34:35], v[222:223], 0 cbsz:4 abid:14
    v_exp_f32 v12, v132
    v_readlane_b32 s43, v8, 15
    v_rcp_f32 v15, v15
    v_pk_add_f32 v[12:13], v[12:13], 1.0 op_sel_hi:[1,0]
    v_pk_mul_f32 v[194:195], v[194:195], v[14:15]
    s_and_b32 s69, s43, 4294966272
    s_set_gpr_idx_on s66, gpr_idx(SRC2,DST)
    buffer_load_dwordx4 v[220:223], v1, s[4:7], s68 offen
    v_pk_fma_f32 v[84:85], v[178:179], v[16:17], v[84:85] op_sel_hi:[0,1,1]
    v_pk_fma_f32 v[86:87], v[178:179], v[18:19], v[86:87] op_sel_hi:[0,1,1]
    v_pk_fma_f32 v[88:89], v[194:195], v[20:21], v[88:89] op_sel_hi:[0,1,1]
    v_pk_fma_f32 v[90:91], v[194:195], v[22:23], v[90:91] op_sel_hi:[0,1,1]
    s_set_gpr_idx_off
    s_waitcnt vmcnt(7)
    v_rcp_f32 v12, v12
    v_mfma_f32_4x4x4_16b_bf16 v[16:19], v[34:35], v[224:225], 0 cbsz:4 abid:15
    v_exp_f32 v15, v149
    v_mfma_f32_4x4x4_16b_bf16 v[20:23], v[34:35], v[226:227], 0 cbsz:4 abid:15
    v_exp_f32 v14, v148
    v_readlane_b32 s44, v7, 0
    v_rcp_f32 v13, v13
    v_pk_add_f32 v[14:15], v[14:15], 1.0 op_sel_hi:[1,0]
    v_pk_mul_f32 v[132:133], v[132:133], v[12:13]
    s_and_b32 s68, s44, 4294966272
    s_set_gpr_idx_on s67, gpr_idx(SRC2,DST)
    buffer_load_dwordx4 v[224:227], v1, s[4:7], s69 offen
    v_pk_fma_f32 v[84:85], v[178:179], v[16:17], v[84:85] op_sel:[1,0,0]
    v_pk_fma_f32 v[86:87], v[178:179], v[18:19], v[86:87] op_sel:[1,0,0]
    v_pk_fma_f32 v[88:89], v[194:195], v[20:21], v[88:89] op_sel:[1,0,0]
    v_pk_fma_f32 v[90:91], v[194:195], v[22:23], v[90:91] op_sel:[1,0,0]
    s_set_gpr_idx_off
    s_sub_u32 s29, s29, 4
    s_cbranch_scc1 L_exit
    v_add_u32 v4, 256, v4
    v_add_u32 v5, 256, v5
    v_add_u32 v6, 256, v6
    s_branch L_loop
L_more:
    s_waitcnt vmcnt(0) lgkmcnt(0)
    s_barrier
    v_lshlrev_b32 v188, 4, v0
    v_add_u32 v189, 8192, v188
    v_add_u32 v190, 16384, v188
    v_add_u32 v191, 24576, v188
    v_add_u32 v192, 32768, v188
    v_add_u32 v193, 40960, v188
    v_lshlrev_b32 v194, 2, v0
    v_lshlrev_b32 v14, 3, v0
    v_mov_b32 v16, 0
    v_mov_b32 v17, 0
    v_mov_b32 v15, 0x00300000
    ds_write_b64 v14, v[16:17] offset:16128
    ds_write_b32 v194, v15 offset:20224
    ds_write_b32 v194, v15 offset:22272
    ds_write_b32 v194, v15 offset:24320
    v_lshrrev_b32 v195, 1, v0
    v_lshlrev_b32 v195, 2, v195
    s_branch L_round
L_exit:
    s_add_u32 s28, s28, 1536
    s_cmp_lt_u32 s28, s25
    s_cbranch_scc1 L_more
    s_mov_b32 m0, s96
    v_cvt_pk_bf16_f32 v84, v84, v88
    v_cvt_pk_bf16_f32 v85, v85, v89
    v_cvt_pk_bf16_f32 v86, v86, v90
    v_cvt_pk_bf16_f32 v87, v87, v91
    ds_write_addtid_b32 v84 offset:16128
    ds_write_addtid_b32 v85 offset:16416
    ds_write_addtid_b32 v86 offset:16704
    ds_write_addtid_b32 v87 offset:16992
    s_mov_b32 m0, s97
    v_cvt_pk_bf16_f32 v92, v92, v96
    v_cvt_pk_bf16_f32 v93, v93, v97
    v_cvt_pk_bf16_f32 v94, v94, v98
    v_cvt_pk_bf16_f32 v95, v95, v99
    ds_write_addtid_b32 v92 offset:16128
    ds_write_addtid_b32 v93 offset:16416
    ds_write_addtid_b32 v94 offset:16704
    ds_write_addtid_b32 v95 offset:16992
    s_mov_b32 m0, s98
    v_cvt_pk_bf16_f32 v100, v100, v104
    v_cvt_pk_bf16_f32 v101, v101, v105
    v_cvt_pk_bf16_f32 v102, v102, v106
    v_cvt_pk_bf16_f32 v103, v103, v107
    ds_write_addtid_b32 v100 offset:16128
    ds_write_addtid_b32 v101 offset:16416
    ds_write_addtid_b32 v102 offset:16704
    ds_write_addtid_b32 v103 offset:16992
    s_mov_b32 m0, s99
    v_cvt_pk_bf16_f32 v108, v108, v112
    v_cvt_pk_bf16_f32 v109, v109, v113
    v_cvt_pk_bf16_f32 v110, v110, v114
    v_cvt_pk_bf16_f32 v111, v111, v115
    ds_write_addtid_b32 v108 offset:16128
    ds_write_addtid_b32 v109 offset:16416
    ds_write_addtid_b32 v110 offset:16704
    ds_write_addtid_b32 v111 offset:16992
    s_mov_b32 m0, s100
    v_cvt_pk_bf16_f32 v116, v116, v120
    v_cvt_pk_bf16_f32 v117, v117, v121
    v_cvt_pk_bf16_f32 v118, v118, v122
    v_cvt_pk_bf16_f32 v119, v119, v123
    ds_write_addtid_b32 v116 offset:16128
    ds_write_addtid_b32 v117 offset:16416
    ds_write_addtid_b32 v118 offset:16704
    ds_write_addtid_b32 v119 offset:16992
    s_mov_b32 s68, 0xbf317218
    s_waitcnt lgkmcnt(0)
    s_barrier
    ds_read_b128 v[84:87], v230 offset:16128
    ds_read_b128 v[88:91], v230 offset:16192
    ds_read_b128 v[92:95], v230 offset:16256
    ds_read_b128 v[96:99], v230 offset:16320
    ds_read_b128 v[100:103], v230 offset:20736
    ds_read_b128 v[104:107], v230 offset:20800
    ds_read_b128 v[108:111], v230 offset:20864
    ds_read_b128 v[112:115], v230 offset:20928
    s_waitcnt lgkmcnt(7)
    v_mfma_f32_16x16x32_bf16 v[116:119], v[84:87], v[52:55], 0
    v_mfma_f32_16x16x32_bf16 v[120:123], v[84:87], v[56:59], 0
    s_waitcnt lgkmcnt(6)
    v_mfma_f32_16x16x32_bf16 v[116:119], v[88:91], v[60:63], v[116:119]
    v_mfma_f32_16x16x32_bf16 v[120:123], v[88:91], v[64:67], v[120:123]
    s_waitcnt lgkmcnt(5)
    v_mfma_f32_16x16x32_bf16 v[116:119], v[92:95], v[68:71], v[116:119]
    v_mfma_f32_16x16x32_bf16 v[120:123], v[92:95], v[72:75], v[120:123]
    s_waitcnt lgkmcnt(4)
    v_mfma_f32_16x16x32_bf16 v[116:119], v[96:99], v[76:79], v[116:119]
    v_mfma_f32_16x16x32_bf16 v[120:123], v[96:99], v[80:83], v[120:123]
    ds_read_b128 v[84:87], v230 offset:25344
    ds_read_b128 v[88:91], v230 offset:25408
    ds_read_b128 v[92:95], v230 offset:25472
    ds_read_b128 v[96:99], v230 offset:25536
    s_waitcnt lgkmcnt(7)
    v_mfma_f32_16x16x32_bf16 v[124:127], v[100:103], v[52:55], 0
    v_mfma_f32_16x16x32_bf16 v[128:131], v[100:103], v[56:59], 0
    s_waitcnt lgkmcnt(6)
    v_mfma_f32_16x16x32_bf16 v[124:127], v[104:107], v[60:63], v[124:127]
    v_mul_f32 v116, s68, v116
    v_mul_f32 v117, s68, v117
    v_mfma_f32_16x16x32_bf16 v[128:131], v[104:107], v[64:67], v[128:131]
    v_mul_f32 v118, s68, v118
    v_mul_f32 v119, s68, v119
    s_waitcnt lgkmcnt(5)
    v_mfma_f32_16x16x32_bf16 v[124:127], v[108:111], v[68:71], v[124:127]
    v_mul_f32 v120, s68, v120
    v_mul_f32 v121, s68, v121
    v_mfma_f32_16x16x32_bf16 v[128:131], v[108:111], v[72:75], v[128:131]
    v_mul_f32 v122, s68, v122
    v_mul_f32 v123, s68, v123
    s_waitcnt lgkmcnt(4)
    v_mfma_f32_16x16x32_bf16 v[124:127], v[112:115], v[76:79], v[124:127]
    v_cvt_pk_bf16_f32 v44, v116, v117
    v_cvt_pk_bf16_f32 v45, v118, v119
    v_mfma_f32_16x16x32_bf16 v[128:131], v[112:115], v[80:83], v[128:131]
    v_cvt_pk_bf16_f32 v46, v120, v121
    v_cvt_pk_bf16_f32 v47, v122, v123
    s_mov_b32 s3, 0
    buffer_store_dwordx4 v[44:47], v231, s[16:19], s3 offen sc0 sc1
    ds_read_b128 v[100:103], v230 offset:29952
    ds_read_b128 v[104:107], v230 offset:30016
    ds_read_b128 v[108:111], v230 offset:30080
    ds_read_b128 v[112:115], v230 offset:30144
    s_waitcnt lgkmcnt(7)
    v_mfma_f32_16x16x32_bf16 v[116:119], v[84:87], v[52:55], 0
    v_mfma_f32_16x16x32_bf16 v[120:123], v[84:87], v[56:59], 0
    s_waitcnt lgkmcnt(6)
    v_mfma_f32_16x16x32_bf16 v[116:119], v[88:91], v[60:63], v[116:119]
    v_mul_f32 v124, s68, v124
    v_mul_f32 v125, s68, v125
    v_mfma_f32_16x16x32_bf16 v[120:123], v[88:91], v[64:67], v[120:123]
    v_mul_f32 v126, s68, v126
    v_mul_f32 v127, s68, v127
    s_waitcnt lgkmcnt(5)
    v_mfma_f32_16x16x32_bf16 v[116:119], v[92:95], v[68:71], v[116:119]
    v_mul_f32 v128, s68, v128
    v_mul_f32 v129, s68, v129
    v_mfma_f32_16x16x32_bf16 v[120:123], v[92:95], v[72:75], v[120:123]
    v_mul_f32 v130, s68, v130
    v_mul_f32 v131, s68, v131
    s_waitcnt lgkmcnt(4)
    v_mfma_f32_16x16x32_bf16 v[116:119], v[96:99], v[76:79], v[116:119]
    v_cvt_pk_bf16_f32 v48, v124, v125
    v_cvt_pk_bf16_f32 v49, v126, v127
    v_mfma_f32_16x16x32_bf16 v[120:123], v[96:99], v[80:83], v[120:123]
    v_cvt_pk_bf16_f32 v50, v128, v129
    v_cvt_pk_bf16_f32 v51, v130, v131
    s_mov_b32 s3, 1048576
    buffer_store_dwordx4 v[48:51], v231, s[16:19], s3 offen sc0 sc1
    ds_read_b128 v[84:87], v230 offset:34560
    ds_read_b128 v[88:91], v230 offset:34624
    ds_read_b128 v[92:95], v230 offset:34688
    ds_read_b128 v[96:99], v230 offset:34752
    s_waitcnt lgkmcnt(7)
    v_mfma_f32_16x16x32_bf16 v[124:127], v[100:103], v[52:55], 0
    v_mfma_f32_16x16x32_bf16 v[128:131], v[100:103], v[56:59], 0
    s_waitcnt lgkmcnt(6)
    v_mfma_f32_16x16x32_bf16 v[124:127], v[104:107], v[60:63], v[124:127]
    v_mul_f32 v116, s68, v116
    v_mul_f32 v117, s68, v117
    v_mfma_f32_16x16x32_bf16 v[128:131], v[104:107], v[64:67], v[128:131]
    v_mul_f32 v118, s68, v118
    v_mul_f32 v119, s68, v119
    s_waitcnt lgkmcnt(5)
    v_mfma_f32_16x16x32_bf16 v[124:127], v[108:111], v[68:71], v[124:127]
    v_mul_f32 v120, s68, v120
    v_mul_f32 v121, s68, v121
    v_mfma_f32_16x16x32_bf16 v[128:131], v[108:111], v[72:75], v[128:131]
    v_mul_f32 v122, s68, v122
    v_mul_f32 v123, s68, v123
    s_waitcnt lgkmcnt(4)
    v_mfma_f32_16x16x32_bf16 v[124:127], v[112:115], v[76:79], v[124:127]
    v_cvt_pk_bf16_f32 v44, v116, v117
    v_cvt_pk_bf16_f32 v45, v118, v119
    v_mfma_f32_16x16x32_bf16 v[128:131], v[112:115], v[80:83], v[128:131]
    v_cvt_pk_bf16_f32 v46, v120, v121
    v_cvt_pk_bf16_f32 v47, v122, v123
    s_mov_b32 s3, 2097152
    buffer_store_dwordx4 v[44:47], v231, s[16:19], s3 offen sc0 sc1
    s_nop 3
    s_waitcnt lgkmcnt(3)
    v_mfma_f32_16x16x32_bf16 v[116:119], v[84:87], v[52:55], 0
    v_mfma_f32_16x16x32_bf16 v[120:123], v[84:87], v[56:59], 0
    s_waitcnt lgkmcnt(2)
    v_mfma_f32_16x16x32_bf16 v[116:119], v[88:91], v[60:63], v[116:119]
    v_mul_f32 v124, s68, v124
    v_mul_f32 v125, s68, v125
    v_mfma_f32_16x16x32_bf16 v[120:123], v[88:91], v[64:67], v[120:123]
    v_mul_f32 v126, s68, v126
    v_mul_f32 v127, s68, v127
    s_waitcnt lgkmcnt(1)
    v_mfma_f32_16x16x32_bf16 v[116:119], v[92:95], v[68:71], v[116:119]
    v_mul_f32 v128, s68, v128
    v_mul_f32 v129, s68, v129
    v_mfma_f32_16x16x32_bf16 v[120:123], v[92:95], v[72:75], v[120:123]
    v_mul_f32 v130, s68, v130
    v_mul_f32 v131, s68, v131
    s_waitcnt lgkmcnt(0)
    v_mfma_f32_16x16x32_bf16 v[116:119], v[96:99], v[76:79], v[116:119]
    v_cvt_pk_bf16_f32 v48, v124, v125
    v_cvt_pk_bf16_f32 v49, v126, v127
    v_mfma_f32_16x16x32_bf16 v[120:123], v[96:99], v[80:83], v[120:123]
    v_cvt_pk_bf16_f32 v50, v128, v129
    v_cvt_pk_bf16_f32 v51, v130, v131
    s_mov_b32 s3, 3145728
    buffer_store_dwordx4 v[48:51], v231, s[16:19], s3 offen sc0 sc1
    s_or_b32 s31, s2, s24
    s_cbranch_scc1 L_noep
    v_lshlrev_b32 v36, 2, v11
    v_mov_b32 v37, s26
    global_store_dword v36, v37, s[22:23] offset:0 sc0 sc1
L_noep:
    s_nop 3
    v_mul_f32 v116, s68, v116
    v_mul_f32 v117, s68, v117
    v_mul_f32 v118, s68, v118
    v_mul_f32 v119, s68, v119
    v_mul_f32 v120, s68, v120
    v_mul_f32 v121, s68, v121
    v_mul_f32 v122, s68, v122
    v_mul_f32 v123, s68, v123
    v_cvt_pk_bf16_f32 v44, v116, v117
    v_cvt_pk_bf16_f32 v45, v118, v119
    v_cvt_pk_bf16_f32 v46, v120, v121
    v_cvt_pk_bf16_f32 v47, v122, v123
    s_mov_b32 s3, 4194304
    buffer_store_dwordx4 v[44:47], v231, s[16:19], s3 offen sc0 sc1
L_end:
    s_endpgm
.section .rodata,"a"
.p2align 6
.amdhsa_kernel standalone__tensor_product_equiv_tfn__graph_kernel
  .amdhsa_next_free_vgpr 232
  .amdhsa_next_free_sgpr 102
  .amdhsa_accum_offset 232
  .amdhsa_group_segment_fixed_size 0
  .amdhsa_kernarg_size 88
  .amdhsa_user_sgpr_count 2
  .amdhsa_user_sgpr_kernarg_segment_ptr 1
  .amdhsa_system_sgpr_workgroup_id_x 1
  .amdhsa_float_denorm_mode_32 3
.end_amdhsa_kernel
```

```asm
; @launch grid=(256,1,1) block=(512,1,1) lds=163584
.amdgcn_target "amdgcn-amd-amdhsa--gfx950"
.text
.globl standalone__tensor_product_equiv_tfn__graph_kernel
.p2align 8
.type standalone__tensor_product_equiv_tfn__graph_kernel,@function
standalone__tensor_product_equiv_tfn__graph_kernel:
    s_load_dwordx16 s[4:19], s[0:1], 0
    s_load_dwordx2 s[22:23], s[0:1], 80
    s_load_dwordx2 s[20:21], s[0:1], 64
    s_cmp_ge_u32 s2, 256
    s_cbranch_scc1 L_end
    v_mul_u32_u24 v172, 3, v0
    s_mul_i32 s3, s2, 1250
    v_min_u32 v172, 1247, v172
    v_add_lshl_u32 v173, v172, s3, 2
    v_lshrrev_b32 v12, 6, v0
    v_and_b32 v13, 255, v0
    v_lshlrev_b32 v13, 2, v13
    v_mov_b32 v16, 0
    v_readfirstlane_b32 s24, v12
    ds_write_b32 v13, v16 offset:0
    v_lshlrev_b32 v174, 1, v173
    s_waitcnt lgkmcnt(0)
    global_load_dwordx3 v[132:134], v173, s[8:9]
    s_load_dword s26, s[22:23], 0
    s_barrier
    global_load_dwordx3 v[136:138], v173, s[6:7]
    global_load_dwordx4 v[140:143], v174, s[10:11]
    global_load_dwordx2 v[144:145], v174, s[10:11] offset:16
    v_lshlrev_b32 v188, 4, v0
    v_and_b32 v11, 63, v0
    s_lshl_b32 s30, s24, 10
    s_lshl_b32 s3, s3, 5
    s_add_u32 s12, s12, s3
    s_addc_u32 s13, s13, 0
    v_add_u32 v189, 8192, v188
    v_add_u32 v190, 16384, v188
    v_add_u32 v191, 24576, v188
    v_add_u32 v192, 32768, v188
    v_add_u32 v193, 40960, v188
    v_min_u32 v175, 39984, v192
    v_lshlrev_b32 v1, 4, v11
    s_barrier
    s_add_u32 m0, s30, 112384
    s_nop 0
    global_load_lds_dwordx4 v188, s[12:13]
    s_add_u32 m0, s30, 120576
    s_nop 0
    global_load_lds_dwordx4 v189, s[12:13]
    s_cmp_eq_u32 s24, 7
    s_cbranch_scc0 L_nocpf
    s_cmp_lt_u32 s2, 8
    s_cbranch_scc0 L_nocpf
    s_getpc_b64 s[68:69]
L_pc:
    v_and_b32 v18, 63, v0
    v_lshlrev_b32 v18, 7, v18
    v_mov_b32 v19, 0
    v_lshl_add_u64 v[20:21], v[18:19], 0, s[68:69]
    global_load_dword v204, v[20:21], off
    v_min_u32 v18, L_end-L_pc-8192, v18
    v_add_u32 v18, 8192, v18
    v_lshl_add_u64 v[20:21], v[18:19], 0, s[68:69]
    global_load_dword v205, v[20:21], off
L_nocpf:
    v_lshlrev_b32 v194, 2, v0
    v_lshlrev_b32 v14, 3, v0
    v_mov_b32 v16, 0
    v_mov_b32 v17, 0
    v_mov_b32 v15, 0x00300000
    ds_write_b64 v14, v[16:17] offset:16128
    ds_write_b32 v194, v15 offset:20224
    ds_write_b32 v194, v15 offset:22272
    ds_write_b32 v194, v15 offset:24320
    v_lshrrev_b32 v195, 1, v0
    v_lshlrev_b32 v195, 2, v195
    v_cmp_gt_u32 vcc, 416, v0
    s_mov_b64 s[36:37], vcc
    v_cmp_gt_u32 vcc, 417, v0
    s_mov_b64 s[38:39], vcc
    v_mov_b32 v12, 1
    s_movk_i32 s40, 1250
    s_mov_b32 s41, 63232
    s_lshr_b32 s27, s24, 2
    s_mov_b32 s28, 0
    s_waitcnt vmcnt(5)
    s_mov_b64 exec, s[38:39]
    v_and_b32 v153, 7, v133
    v_bfe_u32 v161, v133, 3, 5
    v_lshl_add_u32 v147, v153, 5, v161
    v_lshlrev_b32 v147, 2, v147
    ds_add_rtn_u32 v150, v147, v12 offset:0
    v_and_b32 v154, 7, v134
    v_bfe_u32 v162, v134, 3, 5
    v_lshl_add_u32 v148, v154, 5, v162
    v_lshlrev_b32 v148, 2, v148
    ds_add_rtn_u32 v151, v148, v12 offset:0
    s_mov_b64 exec, s[36:37]
    v_and_b32 v152, 7, v132
    v_bfe_u32 v160, v132, 3, 5
    v_lshl_add_u32 v146, v152, 5, v160
    v_lshlrev_b32 v146, 2, v146
    ds_add_rtn_u32 v149, v146, v12 offset:0
    s_mov_b64 exec, -1
    s_add_u32 m0, s30, 128768
    s_nop 0
    global_load_lds_dwordx4 v190, s[12:13]
    s_add_u32 m0, s30, 136960
    s_nop 0
    global_load_lds_dwordx4 v191, s[12:13]
    s_add_u32 m0, s30, 145152
    s_nop 0
    global_load_lds_dwordx4 v175, s[12:13]
    s_waitcnt lgkmcnt(0)
    s_barrier
    ds_read_b128 v[164:167], v1 offset:0
    s_mul_i32 s3, s2, 1280
    s_add_u32 s26, s26, 1
    s_waitcnt lgkmcnt(0)
    v_add_u32 v180, v164, v165
    v_add3_u32 v180, v180, v166, v167
    v_mov_b32 v181, v180
    v_lshrrev_b32 v132, 8, v132
    v_lshlrev_b32 v156, 26, v132
    v_add_u32_dpp v181, v181, v181 row_shr:1 row_mask:0xf bank_mask:0xf
    v_lshl_add_u32 v132, v132, 4, v156
    v_add_lshl_u32 v177, v172, 0, 5
    v_add_u32_dpp v181, v181, v181 row_shr:2 row_mask:0xf bank_mask:0xf
    v_lshrrev_b32 v133, 8, v133
    v_lshlrev_b32 v157, 26, v133
    v_add_u32_dpp v181, v181, v181 row_shr:4 row_mask:0xf bank_mask:0xf
    v_lshl_add_u32 v133, v133, 4, v157
    v_add_lshl_u32 v178, v172, 1, 5
    v_add_u32_dpp v181, v181, v181 row_shr:8 row_mask:0xf bank_mask:0xf
    v_lshrrev_b32 v134, 8, v134
    v_lshlrev_b32 v158, 26, v134
    v_add_u32_dpp v181, v181, v181 row_bcast:15 row_mask:0xa bank_mask:0xf
    v_lshl_add_u32 v134, v134, 4, v158
    v_add_lshl_u32 v179, v172, 2, 5
    v_add_u32_dpp v181, v181, v181 row_bcast:31 row_mask:0xc bank_mask:0xf
    v_sub_u32 v168, v181, v180
    v_add_u32 v169, v168, v164
    v_add_u32 v170, v169, v165
    v_add_u32 v171, v170, v166
    ds_write_b128 v1, v[168:171] offset:1024
    s_mov_b64 exec, s[38:39]
    ds_read_b32 v147, v147 offset:1024
    ds_read_b32 v148, v148 offset:1024
    s_mov_b64 exec, s[36:37]
    ds_read_b32 v146, v146 offset:1024
    s_mov_b64 exec, -1
    s_waitcnt vmcnt(5)
    v_mad_u32_u24 v152, v152, s40, v136
    v_lshl_add_u32 v132, v136, 10, v132
    v_subrev_u32 v156, 10000, v152
    v_min_u32 v152, v152, v156
    v_add_u32 v152, 350, v152
    v_mul_u32_u24 v152, 151, v152
    v_lshrrev_b32 v152, 17, v152
    v_add_u32 v152, v152, v132
    v_mad_u32_u24 v153, v153, s40, v137
    v_lshl_add_u32 v133, v137, 10, v133
    v_subrev_u32 v157, 10000, v153
    v_min_u32 v153, v153, v157
    v_add_u32 v153, 350, v153
    v_mul_u32_u24 v153, 151, v153
    v_lshrrev_b32 v153, 17, v153
    v_add_u32 v153, v153, v133
    v_mad_u32_u24 v154, v154, s40, v138
    v_lshl_add_u32 v134, v138, 10, v134
    v_subrev_u32 v158, 10000, v154
    v_min_u32 v154, v154, v158
    v_add_u32 v154, 350, v154
    v_mul_u32_u24 v154, 151, v154
    v_lshrrev_b32 v154, 17, v154
    v_add_u32 v154, v154, v134
    s_mov_b64 exec, s[38:39]
    s_waitcnt lgkmcnt(0)
    v_add_lshl_u32 v147, v147, v150, 1
    v_mad_u32_u24 v183, v147, 6, s41
    ds_write_b16 v147, v178 offset:2048
    ds_write2_b32 v183, v142, v143 offset1:1
    ds_write_b32 v183, v153 offset:8
    v_add_lshl_u32 v148, v148, v151, 1
    v_mad_u32_u24 v184, v148, 6, s41
    ds_write_b16 v148, v179 offset:2048
    ds_write2_b32 v184, v144, v145 offset1:1
    ds_write_b32 v184, v154 offset:8
    s_mov_b64 exec, s[36:37]
    v_add_lshl_u32 v146, v146, v149, 1
    v_mad_u32_u24 v182, v146, 6, s41
    ds_write_b16 v146, v177 offset:2048
    ds_write2_b32 v182, v140, v141 offset1:1
    ds_write_b32 v182, v152 offset:8
    s_mov_b64 exec, -1
    s_add_u32 m0, s30, 26368
    s_nop 0
    global_load_lds_dwordx4 v188, s[18:19]
    s_add_u32 m0, s30, 34560
    s_nop 0
    global_load_lds_dwordx4 v189, s[18:19]
    s_add_u32 m0, s30, 42752
    s_nop 0
    global_load_lds_dwordx4 v190, s[18:19]
    s_add_u32 m0, s30, 50944
    s_nop 0
    global_load_lds_dwordx4 v191, s[18:19]
    s_add_u32 s70, s30, 59136
    v_min_u32 v185, 112, v1
    s_cmp_lt_u32 s24, 4
    s_cselect_b64 vcc, -1, 0
    s_cselect_b32 m0, s70, 162560
    s_cselect_b64 s[68:69], s[14:15], s[16:17]
    v_cndmask_b32 v185, v185, v188, vcc
    global_load_lds_dwordx4 v185, s[68:69]
    v_add_u32 v168, s3, v168
    v_lshl_add_u32 v196, v164, 19, v168
    v_mov_b32 v197, s26
    v_add_u32 v169, s3, v169
    v_lshl_add_u32 v198, v165, 19, v169
    v_mov_b32 v199, s26
    v_add_u32 v170, s3, v170
    v_lshl_add_u32 v200, v166, 19, v170
    v_mov_b32 v201, s26
    v_add_u32 v171, s3, v171
    v_lshl_add_u32 v202, v167, 19, v171
    v_mov_b32 v203, s26
    s_lshl_b32 s31, s2, 11
    s_add_u32 s31, s31, 4096
    v_add_u32 v186, s31, v1
    s_mul_i32 s31, s3, 12
    s_add_u32 s31, s31, 1048576
    s_add_u32 s48, s22, s31
    s_addc_u32 s49, s23, 0
    s_mov_b32 s50, 15104
    s_mov_b32 s51, 0x00020000
    s_lshl_b32 s3, s3, 5
    s_add_u32 s31, s3, 8388608
    s_add_u32 s52, s22, s31
    s_addc_u32 s53, s23, 0
    s_mov_b32 s54, 40064
    s_mov_b32 s55, 0x00020000
    v_and_b32 v172, -2, v0
    v_and_b32 v173, 16, v188
    v_add_u32 v173, 112384, v173
    s_waitcnt lgkmcnt(0)
    s_barrier
    ds_read_b128 v[132:135], v188 offset:63232
    ds_read_b128 v[136:139], v189 offset:63232
    ds_read_u16 v174, v172 offset:2048
    ds_read_u16 v175, v172 offset:2560
    ds_read_u16 v176, v172 offset:3072
    ds_read_u16 v177, v172 offset:3584
    ds_read_u16 v178, v172 offset:4096
    s_waitcnt lgkmcnt(6)
    buffer_store_dwordx4 v[132:135], v188, s[48:51], 0 offen sc0 sc1
    s_waitcnt lgkmcnt(5)
    buffer_store_dwordx4 v[136:139], v189, s[48:51], 0 offen sc0 sc1
    s_waitcnt lgkmcnt(0)
    v_add_u32 v174, v174, v173
    v_add_u32 v175, v175, v173
    v_add_u32 v176, v176, v173
    v_add_u32 v177, v177, v173
    v_min_u32 v178, 39968, v178
    v_and_b32 v178, -16, v178
    v_add_u32 v178, v178, v173
    v_mov_b64 v[84:85], 0
    v_mov_b64 v[86:87], 0
    v_mov_b64 v[88:89], 0
    v_mov_b64 v[90:91], 0
    v_mov_b64 v[92:93], 0
    v_mov_b64 v[94:95], 0
    v_mov_b64 v[96:97], 0
    v_mov_b64 v[98:99], 0
    v_mov_b64 v[100:101], 0
    v_mov_b64 v[102:103], 0
    v_mov_b64 v[104:105], 0
    v_mov_b64 v[106:107], 0
    v_mov_b64 v[108:109], 0
    v_mov_b64 v[110:111], 0
    v_mov_b64 v[112:113], 0
    v_mov_b64 v[114:115], 0
    v_mov_b64 v[116:117], 0
    v_mov_b64 v[118:119], 0
    v_mov_b64 v[120:121], 0
    v_mov_b64 v[122:123], 0
    v_mov_b64 v[124:125], 0
    v_mov_b64 v[126:127], 0
    v_mov_b64 v[128:129], 0
    v_mov_b64 v[130:131], 0
    v_mov_b64 v[24:25], 0
    v_mov_b64 v[26:27], 0
    v_mov_b64 v[28:29], 0
    v_mov_b64 v[30:31], 0
    s_mov_b32 s32, 0x0f0f0f0f
    s_mov_b32 s33, s32
    s_not_b64 s[34:35], s[32:33]
    v_lshrrev_b32 v2, 5, v11
    v_lshlrev_b32 v2, 4, v2
    v_and_b32 v3, 3, v11
    v_lshlrev_b32 v3, 3, v3
    v_add_u32 v3, 112384, v3
    s_mov_b32 s6, 10240000
    s_mov_b32 s7, 0x00020000
    s_add_u32 s8, s22, 1048576
    s_addc_u32 s9, s23, 0
    s_mov_b32 s10, 3932160
    s_mov_b32 s11, 0x00020000
    s_mov_b32 s101, 0
    s_cmp_lt_u32 s2, 16
    s_cbranch_scc1 L_r40
    s_cmp_eq_u32 s24, 0
    s_cselect_b32 s101, 0x245d2388, s101
    s_cmp_eq_u32 s24, 1
    s_cselect_b32 s101, 0x25753343, s101
    s_cmp_eq_u32 s24, 2
    s_cselect_b32 s101, 0x27449100, s101
    s_cmp_eq_u32 s24, 3
    s_cselect_b32 s101, 0x267d5301, s101
    s_cmp_eq_u32 s24, 4
    s_cselect_b32 s101, 0x2179a402, s101
    s_cmp_eq_u32 s24, 5
    s_cselect_b32 s101, 0x227162c6, s101
    s_cmp_eq_u32 s24, 6
    s_cselect_b32 s101, 0x206543c7, s101
    s_cmp_eq_u32 s24, 7
    s_cselect_b32 s101, 0x236d8285, s101
    s_branch L_rd
L_r40:
    s_cmp_eq_u32 s24, 0
    s_cselect_b32 s101, 0x2271a3c1, s101
    s_cmp_eq_u32 s24, 1
    s_cselect_b32 s101, 0x20750307, s101
    s_cmp_eq_u32 s24, 2
    s_cselect_b32 s101, 0x236d5205, s101
    s_cmp_eq_u32 s24, 3
    s_cselect_b32 s101, 0x27797340, s101
    s_cmp_eq_u32 s24, 4
    s_cselect_b32 s101, 0x256112c4, s101
    s_cmp_eq_u32 s24, 5
    s_cselect_b32 s101, 0x26653243, s101
    s_cmp_eq_u32 s24, 6
    s_cselect_b32 s101, 0x217d4382, s101
    s_cmp_eq_u32 s24, 7
    s_cselect_b32 s101, 0x24592286, s101
L_rd:
    s_and_b32 s3, s2, 7
    s_lshl_b32 s3, s3, 7
    s_bfe_u32 s31, s2, 196613
    s_lshl_b32 s31, s31, 4
    s_add_u32 s3, s3, s31
    s_and_b32 s31, s2, 8
    s_add_u32 s3, s3, s31
    s_and_b32 s31, s2, 16
    s_lshl_b32 s31, s31, 6
    s_add_u32 s3, s3, s31
    s_add_u32 s3, s3, 4096
    v_and_b32 v232, 255, v0
    v_lshl_add_u32 v187, v232, 11, s3
    s_waitcnt vmcnt(7)
    s_barrier
    ds_read_b128 v[144:147], v174
    ds_read_b128 v[148:151], v175
    ds_read_b128 v[152:155], v176
    ds_read_b128 v[156:159], v177
    ds_read_b128 v[160:163], v178
    s_waitcnt lgkmcnt(4)
    buffer_store_dwordx4 v[144:147], v188, s[52:55], 0 offen sc0 sc1
    s_waitcnt lgkmcnt(3)
    buffer_store_dwordx4 v[148:151], v189, s[52:55], 0 offen sc0 sc1
    s_waitcnt lgkmcnt(2)
    buffer_store_dwordx4 v[152:155], v190, s[52:55], 0 offen sc0 sc1
    s_waitcnt lgkmcnt(1)
    buffer_store_dwordx4 v[156:159], v191, s[52:55], 0 offen sc0 sc1
    s_waitcnt lgkmcnt(0)
    buffer_store_dwordx4 v[160:163], v192, s[52:55], 0 offen sc0 sc1
    s_add_u32 s12, s22, 8388608
    s_addc_u32 s13, s23, 0
    s_mov_b32 s14, 10485760
    s_mov_b32 s15, 0x00020000
    s_mov_b32 s16, s20
    s_mov_b32 s17, s21
    s_mov_b32 s18, 10240000
    s_mov_b32 s19, 0x00020000
    s_waitcnt vmcnt(0)
    s_barrier
    s_cmp_eq_u32 s24, 7
    s_cbranch_scc0 L_nopub
    global_store_dwordx4 v186, v[196:199], s[22:23] sc0 sc1
    global_store_dwordx4 v186, v[200:203], s[22:23] offset:1024 sc0 sc1
L_nopub:
    s_cmp_eq_u32 s27, 0
    s_cbranch_scc1 L_pfa
    s_sub_u32 s3, 0, s2
    s_and_b32 s3, s3, 7
    s_mul_i32 s3, s3, 1280000
    s_lshr_b32 s31, s2, 3
    s_mul_i32 s31, s31, 16640
    s_add_u32 s3, s3, s31
    s_add_u32 s3, s3, 0
    v_and_b32 v208, 255, v0
    v_cmp_gt_u32 vcc, 130, v208
    v_lshlrev_b32 v208, 7, v208
    v_mov_b32 v209, 0x7fffff00
    v_cndmask_b32 v208, v209, v208, vcc
    buffer_load_dword v210, v208, s[4:7], s3 offen
L_pfa:
    v_lshrrev_b32 v12, 5, v11
    v_and_b32 v13, 31, v11
    v_lshlrev_b32 v13, 2, v13
    v_lshl_add_u32 v12, v12, 11, v13
    ds_read_b32 v132, v12 offset:59136
    ds_read_b32 v133, v12 offset:59392
    ds_read_b32 v134, v12 offset:59648
    ds_read_b32 v135, v12 offset:59904
    ds_read_b32 v136, v12 offset:60160
    ds_read_b32 v137, v12 offset:60416
    ds_read_b32 v138, v12 offset:60672
    ds_read_b32 v139, v12 offset:60928
    s_waitcnt lgkmcnt(7)
    ds_read_b32 v140, v12 offset:59264
    ds_read_b32 v141, v12 offset:59520
    ds_read_b32 v142, v12 offset:59776
    ds_read_b32 v143, v12 offset:60032
    ds_read_b32 v144, v12 offset:60288
    ds_read_b32 v145, v12 offset:60544
    ds_read_b32 v146, v12 offset:60800
    ds_read_b32 v147, v12 offset:61056
    v_and_b32 v14, 3, v11
    v_bfe_u32 v15, v11, 2, 2
    v_lshlrev_b32 v15, 1, v15
    v_lshl_add_u32 v14, v14, 5, v15
    v_add_u32 v14, 162560, v14
    s_mov_b32 s68, 0xbfb8aa3b
    s_mov_b32 s69, s68
    s_waitcnt lgkmcnt(0)
    ds_read_u16 v18, v14 offset:0
    ds_read_u16 v19, v14 offset:8
    ds_read_u16 v20, v14 offset:16
    ds_read_u16 v21, v14 offset:24
    v_lshlrev_b32 v22, 16, v132
    v_lshlrev_b32 v23, 16, v133
    v_and_b32 v132, 0xffff0000, v132
    v_and_b32 v133, 0xffff0000, v133
    v_pk_mul_f32 v[22:23], v[22:23], s[68:69]
    v_pk_mul_f32 v[132:133], v[132:133], s[68:69]
    v_cvt_pk_bf16_f32 v36, v22, v23
    v_cvt_pk_bf16_f32 v44, v132, v133
    v_lshlrev_b32 v22, 16, v134
    v_lshlrev_b32 v23, 16, v135
    v_and_b32 v134, 0xffff0000, v134
    v_and_b32 v135, 0xffff0000, v135
    v_pk_mul_f32 v[22:23], v[22:23], s[68:69]
    v_pk_mul_f32 v[134:135], v[134:135], s[68:69]
    v_cvt_pk_bf16_f32 v37, v22, v23
    v_cvt_pk_bf16_f32 v45, v134, v135
    v_lshlrev_b32 v22, 16, v136
    v_lshlrev_b32 v23, 16, v137
    v_and_b32 v136, 0xffff0000, v136
    v_and_b32 v137, 0xffff0000, v137
    v_pk_mul_f32 v[22:23], v[22:23], s[68:69]
    v_pk_mul_f32 v[136:137], v[136:137], s[68:69]
    v_cvt_pk_bf16_f32 v38, v22, v23
    v_cvt_pk_bf16_f32 v46, v136, v137
    v_lshlrev_b32 v22, 16, v138
    v_lshlrev_b32 v23, 16, v139
    v_and_b32 v138, 0xffff0000, v138
    v_and_b32 v139, 0xffff0000, v139
    v_pk_mul_f32 v[22:23], v[22:23], s[68:69]
    v_pk_mul_f32 v[138:139], v[138:139], s[68:69]
    v_cvt_pk_bf16_f32 v39, v22, v23
    v_cvt_pk_bf16_f32 v47, v138, v139
    v_lshlrev_b32 v22, 16, v140
    v_lshlrev_b32 v23, 16, v141
    v_and_b32 v140, 0xffff0000, v140
    v_and_b32 v141, 0xffff0000, v141
    v_pk_mul_f32 v[22:23], v[22:23], s[68:69]
    v_pk_mul_f32 v[140:141], v[140:141], s[68:69]
    v_cvt_pk_bf16_f32 v40, v22, v23
    v_cvt_pk_bf16_f32 v48, v140, v141
    v_lshlrev_b32 v22, 16, v142
    v_lshlrev_b32 v23, 16, v143
    v_and_b32 v142, 0xffff0000, v142
    v_and_b32 v143, 0xffff0000, v143
    v_pk_mul_f32 v[22:23], v[22:23], s[68:69]
    v_pk_mul_f32 v[142:143], v[142:143], s[68:69]
    v_cvt_pk_bf16_f32 v41, v22, v23
    v_cvt_pk_bf16_f32 v49, v142, v143
    v_lshlrev_b32 v22, 16, v144
    v_lshlrev_b32 v23, 16, v145
    v_and_b32 v144, 0xffff0000, v144
    v_and_b32 v145, 0xffff0000, v145
    v_pk_mul_f32 v[22:23], v[22:23], s[68:69]
    v_pk_mul_f32 v[144:145], v[144:145], s[68:69]
    v_cvt_pk_bf16_f32 v42, v22, v23
    v_cvt_pk_bf16_f32 v50, v144, v145
    v_lshlrev_b32 v22, 16, v146
    v_lshlrev_b32 v23, 16, v147
    v_and_b32 v146, 0xffff0000, v146
    v_and_b32 v147, 0xffff0000, v147
    v_pk_mul_f32 v[22:23], v[22:23], s[68:69]
    v_pk_mul_f32 v[146:147], v[146:147], s[68:69]
    v_cvt_pk_bf16_f32 v43, v22, v23
    v_cvt_pk_bf16_f32 v51, v146, v147
    s_waitcnt lgkmcnt(0)
    v_lshl_or_b32 v228, v19, 16, v18
    v_lshl_or_b32 v229, v21, 16, v20
    s_mov_b32 s70, 0x05040100
    s_mov_b32 s71, 0x07060302
    s_and_b32 s3, s24, 3
    s_lshl_b32 s3, s3, 6
    v_lshrrev_b32 v16, 4, v11
    v_and_b32 v17, 15, v11
    v_lshl_add_u32 v17, v17, 2, s3
    v_lshl_add_u32 v16, v16, 11, v17
    ds_read_b32 v148, v16 offset:26368
    ds_read_b32 v149, v16 offset:26624
    ds_read_b32 v150, v16 offset:26880
    ds_read_b32 v151, v16 offset:27136
    ds_read_b32 v152, v16 offset:27392
    ds_read_b32 v153, v16 offset:27648
    ds_read_b32 v154, v16 offset:27904
    ds_read_b32 v155, v16 offset:28160
    s_waitcnt lgkmcnt(7)
    ds_read_b32 v156, v16 offset:34560
    ds_read_b32 v157, v16 offset:34816
    ds_read_b32 v158, v16 offset:35072
    ds_read_b32 v159, v16 offset:35328
    ds_read_b32 v160, v16 offset:35584
    ds_read_b32 v161, v16 offset:35840
    ds_read_b32 v162, v16 offset:36096
    ds_read_b32 v163, v16 offset:36352
    s_waitcnt lgkmcnt(8)
    v_perm_b32 v52, v149, v148, s70
    v_perm_b32 v56, v149, v148, s71
    v_perm_b32 v53, v151, v150, s70
    v_perm_b32 v57, v151, v150, s71
    v_perm_b32 v54, v153, v152, s70
    v_perm_b32 v58, v153, v152, s71
    v_perm_b32 v55, v155, v154, s70
    v_perm_b32 v59, v155, v154, s71
    s_waitcnt lgkmcnt(7)
    ds_read_b32 v148, v16 offset:42752
    ds_read_b32 v149, v16 offset:43008
    ds_read_b32 v150, v16 offset:43264
    ds_read_b32 v151, v16 offset:43520
    ds_read_b32 v152, v16 offset:43776
    ds_read_b32 v153, v16 offset:44032
    ds_read_b32 v154, v16 offset:44288
    ds_read_b32 v155, v16 offset:44544
    s_waitcnt lgkmcnt(8)
    v_perm_b32 v60, v157, v156, s70
    v_perm_b32 v64, v157, v156, s71
    v_perm_b32 v61, v159, v158, s70
    v_perm_b32 v65, v159, v158, s71
    v_perm_b32 v62, v161, v160, s70
    v_perm_b32 v66, v161, v160, s71
    v_perm_b32 v63, v163, v162, s70
    v_perm_b32 v67, v163, v162, s71
    s_waitcnt lgkmcnt(7)
    ds_read_b32 v156, v16 offset:50944
    ds_read_b32 v157, v16 offset:51200
    ds_read_b32 v158, v16 offset:51456
    ds_read_b32 v159, v16 offset:51712
    ds_read_b32 v160, v16 offset:51968
    ds_read_b32 v161, v16 offset:52224
    ds_read_b32 v162, v16 offset:52480
    ds_read_b32 v163, v16 offset:52736
    s_waitcnt lgkmcnt(8)
    v_perm_b32 v68, v149, v148, s70
    v_perm_b32 v72, v149, v148, s71
    v_perm_b32 v69, v151, v150, s70
    v_perm_b32 v73, v151, v150, s71
    v_perm_b32 v70, v153, v152, s70
    v_perm_b32 v74, v153, v152, s71
    v_perm_b32 v71, v155, v154, s70
    v_perm_b32 v75, v155, v154, s71
    s_waitcnt lgkmcnt(0)
    v_perm_b32 v76, v157, v156, s70
    v_perm_b32 v80, v157, v156, s71
    v_perm_b32 v77, v159, v158, s70
    v_perm_b32 v81, v159, v158, s71
    v_perm_b32 v78, v161, v160, s70
    v_perm_b32 v82, v161, v160, s71
    v_perm_b32 v79, v163, v162, s70
    v_perm_b32 v83, v163, v162, s71
    s_cmp_eq_u32 s27, 0
    s_cbranch_scc0 L_round
    s_mov_b32 s3, 0
L_poll:
    global_load_dwordx2 v[206:207], v187, s[22:23] sc1
L_poll1:
    s_add_u32 s3, s3, 1
    s_waitcnt vmcnt(0)
    v_cmpx_ne_u32 vcc, s26, v207
    s_cbranch_execz L_pok
    s_cmp_lt_u32 s3, 400000
    s_cbranch_scc1 L_poll
    v_mov_b32 v206, 0
L_pok:
    s_mov_b64 exec, -1
    v_add_u32 v14, 161536, v194
    ds_write_b32 v14, v206
L_round:
    v_add_u32 v15, 161536, v1
    s_and_b32 s31, s24, 3
    v_mov_b32 v148, 0
    s_waitcnt lgkmcnt(0)
    s_barrier
    ds_read_b128 v[140:143], v15
    v_mul_u32_u24 v135, 12, v0
    v_add_u32 v136, 6144, v135
    v_add_u32 v137, 12288, v135
    s_waitcnt lgkmcnt(0)
    v_lshrrev_b32 v144, 19, v140
    v_lshrrev_b32 v145, 19, v141
    v_lshrrev_b32 v146, 19, v142
    v_lshrrev_b32 v147, 19, v143
    v_add_u32 v150, v144, v145
    v_add3_u32 v12, v150, v146, v147
    v_add_u32 v13, s28, v12
    v_mov_b32 v149, v144
    v_add_u32_dpp v12, v12, v12 row_shr:1 row_mask:0xf bank_mask:0xf
    v_add_u32 v151, v150, v146
    s_set_gpr_idx_on s31, gpr_idx(SRC0)
    v_mov_b32 v14, v140
    v_mov_b32 v15, v144
    v_mov_b32 v16, v148
    s_set_gpr_idx_off
    v_add_u32_dpp v12, v12, v12 row_shr:2 row_mask:0xf bank_mask:0xf
    v_and_b32 v14, 0x7ffff, v14
    v_sub_u32 v16, v16, v13
    v_add_u32_dpp v12, v12, v12 row_shr:4 row_mask:0xf bank_mask:0xf
    v_subrev_u32 v17, s27, v15
    s_mov_b32 s31, s27
    v_add_u32_dpp v12, v12, v12 row_shr:8 row_mask:0xf bank_mask:0xf
    s_nop 1
    v_add_u32_dpp v12, v12, v12 row_bcast:15 row_mask:0xa bank_mask:0xf
    s_nop 1
    v_add_u32_dpp v12, v12, v12 row_bcast:31 row_mask:0xc bank_mask:0xf
    v_add_u32 v16, v16, v12
    v_readlane_b32 s25, v12, 63
    v_sub_u32 v14, v14, v16
    v_add_lshl_u32 v18, v16, s27, 2
    s_cmp_gt_u32 s25, 1536
    s_cbranch_scc1 L_exp
    v_cmpx_lt_i32 vcc, 0, v17
    ds_write_b32 v18, v14 offset:20224
    v_cmpx_lt_i32 vcc, 2, v17
    ds_write_b32 v18, v14 offset:20232
    v_cmpx_lt_i32 vcc, 4, v17
    ds_write_b32 v18, v14 offset:20240
    v_cmpx_lt_i32 vcc, 6, v17
    ds_write_b32 v18, v14 offset:20248
    v_cmpx_lt_i32 vcc, 8, v17
    ds_write_b32 v18, v14 offset:20256
    v_cmpx_lt_i32 vcc, 10, v17
    ds_write_b32 v18, v14 offset:20264
    v_cmpx_lt_i32 vcc, 12, v17
    s_cbranch_execz L_expd
    s_add_u32 s31, s31, 12
L_exp:
    s_mov_b64 exec, -1
    v_cmp_lt_u32 vcc, s31, v15
    s_cbranch_vccz L_expd
    v_add_u32 v19, s31, v16
    s_movk_i32 s3, 1536
    v_cmp_gt_u32 s[68:69], s3, v19
    v_lshlrev_b32 v19, 2, v19
    s_and_b64 exec, vcc, s[68:69]
    ds_write_b32 v19, v14 offset:20224
    s_add_u32 s31, s31, 2
    s_branch L_exp
L_expd:
    s_mov_b64 exec, -1
    s_waitcnt lgkmcnt(0)
    s_barrier
    ds_read_b32 v12, v194 offset:20224
    ds_read_b32 v13, v194 offset:22272
    ds_read_b32 v14, v194 offset:24320
    ds_read_b32 v152, v195 offset:20224
    ds_read_b32 v153, v195 offset:21248
    ds_read_b32 v154, v195 offset:22272
    ds_read_b32 v155, v195 offset:23296
    ds_read_b32 v156, v195 offset:24320
    ds_read_b32 v157, v195 offset:25344
    s_waitcnt lgkmcnt(8)
    v_mad_i32_i24 v12, v12, 12, v135
    buffer_load_dwordx3 v[140:142], v12, s[8:11], 0 offen sc1
    s_waitcnt lgkmcnt(7)
    v_mad_i32_i24 v13, v13, 12, v136
    buffer_load_dwordx3 v[144:146], v13, s[8:11], 0 offen sc1
    s_waitcnt lgkmcnt(6)
    v_mad_i32_i24 v14, v14, 12, v137
    buffer_load_dwordx3 v[148:150], v14, s[8:11], 0 offen sc1
    s_waitcnt lgkmcnt(0)
    v_lshl_add_u32 v152, v152, 5, v188
    v_lshl_add_u32 v153, v153, 5, v189
    v_lshl_add_u32 v154, v154, 5, v190
    v_lshl_add_u32 v155, v155, 5, v191
    v_lshl_add_u32 v156, v156, 5, v192
    v_lshl_add_u32 v157, v157, 5, v193
    s_barrier
    s_add_u32 m0, s30, 63232
    s_nop 0
    buffer_load_dwordx4 v152, s[12:15], 0 offen sc1 lds
    s_add_u32 m0, s30, 71424
    s_nop 0
    buffer_load_dwordx4 v153, s[12:15], 0 offen sc1 lds
    s_sub_u32 s29, s25, s28
    s_min_u32 s29, s29, 1536
    s_lshl_b32 s3, s29, 4
    v_cmp_gt_u32 s[56:57], s3, v188
    v_lshlrev_b32 v159, 1, v188
    v_mov_b32 v143, 0
    v_cmp_gt_u32 s[58:59], s3, v189
    v_lshlrev_b32 v161, 1, v189
    v_mov_b32 v147, 0
    v_cmp_gt_u32 s[60:61], s3, v190
    v_lshlrev_b32 v163, 1, v190
    v_mov_b32 v151, 0
    v_and_b32 v4, 15, v11
    v_lshrrev_b32 v13, 4, v11
    s_mul_i32 s3, s27, 23040
    v_mul_u32_u24 v230, 288, v4
    v_lshl_add_u32 v230, v13, 4, v230
    v_add_u32 v230, s3, v230
    s_mul_i32 s68, s27, 5120
    s_add_u32 s68, s68, s2
    s_lshl_b32 s68, s68, 10
    s_and_b32 s3, s24, 3
    s_lshl_b32 s3, s3, 8
    s_add_u32 s68, s68, s3
    v_lshl_add_u32 v231, v13, 18, s68
    v_lshl_add_u32 v231, v4, 4, v231
    v_lshlrev_b32 v4, 3, v4
    v_bfe_u32 v5, v11, 3, 2
    v_and_b32 v12, 3, v11
    v_lshl_add_u32 v5, v5, 2, v12
    v_lshlrev_b32 v5, 3, v5
    v_lshrrev_b32 v6, 2, v11
    v_lshlrev_b32 v6, 3, v6
    v_mul_u32_u24 v16, 52, v11
    v_lshrrev_b32 v16, 8, v16
    v_mul_u32_u24 v17, 5, v16
    v_sub_u32 v17, v11, v17
    v_mul_u32_u24 v15, 6, v17
    v_bfe_u32 v15, s101, v15, 6
    v_lshlrev_b32 v15, 2, v15
    v_lshlrev_b32 v16, 2, v16
    v_lshlrev_b32 v17, 19, v17
    s_mul_i32 s3, s24, 5
    v_lshlrev_b32 v18, 2, v11
    v_add_u32 v21, s3, v11
    v_lshlrev_b32 v19, 2, v21
    v_cmp_gt_u32 vcc, 40, v11
    v_add_u32 v20, 1, v11
    v_add_u32 v21, 1, v21
    v_cndmask_b32 v20, 0, v20, vcc
    s_cmp_gt_u32 s25, 1536
    s_cselect_b32 s69, 0, 8
    v_mov_b32 v22, 8
    s_waitcnt vmcnt(4)
    s_mov_b64 exec, s[56:57]
    v_and_b32 v143, 0x3ff, v142
    v_lshrrev_b32 v12, 24, v142
    v_lshlrev_b32 v143, 2, v143
    ds_add_u32 v12, v22 offset:18688
    ds_add_rtn_u32 v132, v143, v22 offset:16128
    s_waitcnt vmcnt(3)
    s_mov_b64 exec, s[58:59]
    v_and_b32 v147, 0x3ff, v146
    v_lshrrev_b32 v13, 24, v146
    v_lshlrev_b32 v147, 2, v147
    ds_add_u32 v13, v22 offset:18688
    ds_add_rtn_u32 v133, v147, v22 offset:16128
    s_waitcnt vmcnt(2)
    s_mov_b64 exec, s[60:61]
    v_and_b32 v151, 0x3ff, v150
    v_lshrrev_b32 v14, 24, v150
    v_lshlrev_b32 v151, 2, v151
    ds_add_u32 v14, v22 offset:18688
    ds_add_rtn_u32 v134, v151, v22 offset:16128
    s_mov_b64 exec, -1
    s_add_u32 m0, s30, 79616
    s_nop 0
    buffer_load_dwordx4 v154, s[12:15], 0 offen sc1 lds
    v_mfma_f32_4x4x4_16b_bf16 v[164:167], v[228:229], v[140:141], 0 cbsz:4 abid:0
    v_mfma_f32_4x4x4_16b_bf16 v[168:171], v[228:229], v[140:141], 0 cbsz:4 abid:1
    v_mfma_f32_4x4x4_16b_bf16 v[172:175], v[228:229], v[140:141], 0 cbsz:4 abid:2
    v_mfma_f32_4x4x4_16b_bf16 v[176:179], v[228:229], v[140:141], 0 cbsz:4 abid:3
    v_add_u32 v23, 112384, v159
    s_nop 0
    v_cvt_pk_bf16_f32 v180, v164, v165
    v_cvt_pk_bf16_f32 v181, v166, v167
    v_cvt_pk_bf16_f32 v182, v168, v169
    v_cvt_pk_bf16_f32 v183, v170, v171
    v_cvt_pk_bf16_f32 v184, v172, v173
    v_cvt_pk_bf16_f32 v185, v174, v175
    v_cvt_pk_bf16_f32 v186, v176, v177
    v_cvt_pk_bf16_f32 v187, v178, v179
    s_waitcnt lgkmcnt(0)
    s_barrier
    ds_read_b32 v12, v18 offset:18688
    ds_read_b32 v13, v19 offset:18688
    ds_write_b128 v23, v[180:183]
    ds_write_b128 v23, v[184:187] offset:16
    v_lshlrev_b32 v19, 4, v19
    v_and_b32 v142, 0xfffc00, v142
    v_and_b32 v146, 0xfffc00, v146
    v_and_b32 v150, 0xfffc00, v150
    s_waitcnt lgkmcnt(2)
    v_mad_u32_u24 v21, v13, s69, v21
    v_mad_u32_u24 v20, v12, s69, v20
    v_readlane_b32 s96, v21, 0
    v_readlane_b32 s97, v21, 1
    v_readlane_b32 s98, v21, 2
    v_readlane_b32 s99, v21, 3
    v_readlane_b32 s100, v21, 4
    v_lshl_add_u32 v19, v13, 16, v19
    v_cmp_lt_u32 s[36:37], s96, v20
    v_cmp_lt_u32 s[38:39], s97, v20
    v_cmp_lt_u32 s[40:41], s98, v20
    v_cmp_lt_u32 s[42:43], s99, v20
    v_cmp_lt_u32 s[44:45], s100, v20
    s_bcnt1_i32_b64 s96, s[36:37]
    v_writelane_b32 v12, s96, 0
    s_bcnt1_i32_b64 s97, s[38:39]
    v_writelane_b32 v12, s97, 1
    s_bcnt1_i32_b64 s98, s[40:41]
    v_writelane_b32 v12, s98, 2
    s_bcnt1_i32_b64 s99, s[42:43]
    v_writelane_b32 v12, s99, 3
    s_bcnt1_i32_b64 s100, s[44:45]
    v_writelane_b32 v12, s100, 4
    s_mov_b64 exec, 31
    v_lshlrev_b32 v12, 2, v12
    ds_write_b32 v12, v19 offset:19200
    s_mov_b64 exec, -1
    s_add_u32 m0, s30, 87808
    s_nop 0
    buffer_load_dwordx4 v155, s[12:15], 0 offen sc1 lds
    s_waitcnt lgkmcnt(0)
    s_barrier
    ds_read_b32 v12, v15 offset:19200
    v_mfma_f32_4x4x4_16b_bf16 v[164:167], v[228:229], v[144:145], 0 cbsz:4 abid:0
    v_mfma_f32_4x4x4_16b_bf16 v[168:171], v[228:229], v[144:145], 0 cbsz:4 abid:1
    v_mfma_f32_4x4x4_16b_bf16 v[172:175], v[228:229], v[144:145], 0 cbsz:4 abid:2
    v_mfma_f32_4x4x4_16b_bf16 v[176:179], v[228:229], v[144:145], 0 cbsz:4 abid:3
    v_add_u32 v23, 112384, v161
    s_nop 0
    v_cvt_pk_bf16_f32 v180, v164, v165
    v_cvt_pk_bf16_f32 v181, v166, v167
    v_cvt_pk_bf16_f32 v182, v168, v169
    v_cvt_pk_bf16_f32 v183, v170, v171
    v_cvt_pk_bf16_f32 v184, v172, v173
    v_cvt_pk_bf16_f32 v185, v174, v175
    v_cvt_pk_bf16_f32 v186, v176, v177
    v_cvt_pk_bf16_f32 v187, v178, v179
    s_waitcnt lgkmcnt(0)
    v_add_u32_sdwa v16, v12, v16 dst_sel:DWORD dst_unused:UNUSED_PAD src0_sel:WORD_0 src1_sel:DWORD
    ds_read_b32 v13, v16 offset:16128
    v_readlane_b32 s96, v12, 0
    v_readlane_b32 s97, v12, 1
    v_readlane_b32 s98, v12, 2
    v_readlane_b32 s99, v12, 3
    v_readlane_b32 s100, v12, 4
    s_add_u32 s3, s96, s97
    s_add_u32 s3, s3, s98
    s_add_u32 s3, s3, s99
    s_add_u32 s3, s3, s100
    s_lshr_b32 s29, s3, 16
    s_add_u32 s3, s29, 480
    v_mov_b32 v14, s3
    v_mov_b32 v18, 0
    s_mov_b64 exec, 1
    ds_add_rtn_u32 v14, v18, v14 offset:19456
    s_mov_b64 exec, -1
    s_waitcnt lgkmcnt(1)
    v_sub_u32 v17, v17, v13
    s_nop 0
    v_add_u32_dpp v13, v13, v13 row_shr:1 row_mask:0xf bank_mask:0xf
    s_nop 1
    v_add_u32_dpp v13, v13, v13 row_shr:2 row_mask:0xf bank_mask:0xf
    v_mov_b32 v20, 2147482664
    v_mov_b32 v21, 0
    v_add_u32_dpp v13, v13, v13 row_shr:4 row_mask:0xf bank_mask:0xf
    s_nop 1
    v_add_u32_dpp v13, v13, v13 row_shr:8 row_mask:0xf bank_mask:0xf
    s_waitcnt lgkmcnt(0)
    v_readfirstlane_b32 s71, v14
    v_add_u32_dpp v13, v13, v13 row_bcast:15 row_mask:0xa bank_mask:0xf
    s_add_u32 s3, s71, s29
    v_lshl_add_u32 v18, v11, 3, s3
    v_add_u32_dpp v13, v13, v13 row_bcast:31 row_mask:0xc bank_mask:0xf
    s_mov_b32 exec_hi, 0x0fffffff
    v_add3_u32 v13, v13, v17, s71
    ds_write_b32 v16, v13 offset:16128
    ds_write_b64 v18, v[20:21] offset:0
    s_mov_b64 exec, -1
    ds_write_b128 v23, v[180:183]
    ds_write_b128 v23, v[184:187] offset:16
    s_add_u32 m0, s30, 96000
    s_nop 0
    buffer_load_dwordx4 v156, s[12:15], 0 offen sc1 lds
    s_waitcnt lgkmcnt(2)
    s_barrier
    ds_read_b32 v12, v143 offset:16128
    ds_read_b32 v13, v147 offset:16128
    ds_read_b32 v14, v151 offset:16128
    v_add_u32 v4, s71, v4
    v_add_u32 v5, s71, v5
    v_add_u32 v6, s71, v6
    s_lshr_b32 s29, s29, 3
    s_mov_b64 exec, s[56:57]
    s_waitcnt lgkmcnt(2)
    v_add_u32_sdwa v132, v12, v132 dst_sel:DWORD dst_unused:UNUSED_PAD src0_sel:WORD_0 src1_sel:DWORD
    v_or_b32_sdwa v158, v12, v142 dst_sel:DWORD dst_unused:UNUSED_PAD src0_sel:WORD_1 src1_sel:DWORD
    ds_write_b64 v132, v[158:159] offset:0
    s_mov_b64 exec, s[58:59]
    s_waitcnt lgkmcnt(2)
    v_add_u32_sdwa v133, v13, v133 dst_sel:DWORD dst_unused:UNUSED_PAD src0_sel:WORD_0 src1_sel:DWORD
    v_or_b32_sdwa v160, v13, v146 dst_sel:DWORD dst_unused:UNUSED_PAD src0_sel:WORD_1 src1_sel:DWORD
    ds_write_b64 v133, v[160:161] offset:0
    s_mov_b64 exec, s[60:61]
    s_waitcnt lgkmcnt(2)
    v_add_u32_sdwa v134, v14, v134 dst_sel:DWORD dst_unused:UNUSED_PAD src0_sel:WORD_0 src1_sel:DWORD
    v_or_b32_sdwa v162, v14, v150 dst_sel:DWORD dst_unused:UNUSED_PAD src0_sel:WORD_1 src1_sel:DWORD
    ds_write_b64 v134, v[162:163] offset:0
    s_mov_b64 exec, -1
    s_add_u32 m0, s30, 104192
    s_nop 0
    buffer_load_dwordx4 v157, s[12:15], 0 offen sc1 lds
    s_waitcnt lgkmcnt(0)
    s_barrier
    ds_read_b32 v12, v4
    ds_read_b32 v7, v4 offset:64
    ds_read_b32 v9, v5 offset:4
    ds_read_b32 v10, v6 offset:4
    s_cmp_eq_u64 s[60:61], 0
    s_cbranch_scc1 L_not3
    v_mfma_f32_4x4x4_16b_bf16 v[164:167], v[228:229], v[148:149], 0 cbsz:4 abid:0
    v_mfma_f32_4x4x4_16b_bf16 v[168:171], v[228:229], v[148:149], 0 cbsz:4 abid:1
    v_mfma_f32_4x4x4_16b_bf16 v[172:175], v[228:229], v[148:149], 0 cbsz:4 abid:2
    v_mfma_f32_4x4x4_16b_bf16 v[176:179], v[228:229], v[148:149], 0 cbsz:4 abid:3
    v_add_u32 v23, 112384, v163
    s_nop 0
    v_cvt_pk_bf16_f32 v180, v164, v165
    v_cvt_pk_bf16_f32 v181, v166, v167
    v_cvt_pk_bf16_f32 v182, v168, v169
    v_cvt_pk_bf16_f32 v183, v170, v171
    v_cvt_pk_bf16_f32 v184, v172, v173
    v_cvt_pk_bf16_f32 v185, v174, v175
    v_cvt_pk_bf16_f32 v186, v176, v177
    v_cvt_pk_bf16_f32 v187, v178, v179
    ds_write_b128 v23, v[180:183]
    ds_write_b128 v23, v[184:187] offset:16
    s_waitcnt lgkmcnt(2)
    s_branch L_t3
L_not3:
    s_waitcnt lgkmcnt(0)
L_t3:
    v_readlane_b32 s36, v12, 0
    v_readlane_b32 s37, v12, 1
    v_readlane_b32 s38, v12, 2
    v_readlane_b32 s39, v12, 3
    s_and_b32 s70, s36, 4294966272
    buffer_load_dwordx4 v[196:199], v1, s[4:7], s70 offen
    s_and_b32 s71, s37, 4294966272
    buffer_load_dwordx4 v[200:203], v1, s[4:7], s71 offen
    s_and_b32 s70, s38, 4294966272
    buffer_load_dwordx4 v[204:207], v1, s[4:7], s70 offen
    s_and_b32 s71, s39, 4294966272
    buffer_load_dwordx4 v[208:211], v1, s[4:7], s71 offen
    v_readlane_b32 s40, v12, 4
    v_readlane_b32 s41, v12, 5
    v_readlane_b32 s42, v12, 6
    v_readlane_b32 s43, v12, 7
    v_add_u32 v9, v9, v2
    v_add_u32 v10, v10, v3
    v_readlane_b32 s44, v7, 0
    s_and_b32 s96, s96, 0xffff
    s_mulk_i32 s96, 18
    s_and_b32 s97, s97, 0xffff
    s_mulk_i32 s97, 18
    s_and_b32 s98, s98, 0xffff
    s_mulk_i32 s98, 18
    s_and_b32 s99, s99, 0xffff
    s_mulk_i32 s99, 18
    s_and_b32 s100, s100, 0xffff
    s_mulk_i32 s100, 18
    s_and_b32 s68, s44, 4294966272
    s_waitcnt vmcnt(4) lgkmcnt(0)
    s_barrier
    s_cmp_eq_u32 s29, 0
    s_cbranch_scc1 L_exit
    s_sub_u32 s29, s29, 1
    s_mov_b64 exec, s[32:33]
    ds_read_b128 v[24:27], v9 offset:63232
    s_mov_b64 exec, s[34:35]
    ds_read_b128 v[28:31], v9 offset:63232
    s_mov_b64 exec, -1
    ds_read_b64 v[32:33], v10
    s_and_b32 s70, s40, 4294966272
    buffer_load_dwordx4 v[212:215], v1, s[4:7], s70 offen
    s_and_b32 s71, s41, 4294966272
    buffer_load_dwordx4 v[216:219], v1, s[4:7], s71 offen
    s_waitcnt lgkmcnt(1)
    v_mfma_f32_32x32x16_bf16 v[132:147], v[24:27], v[36:39], 0
    v_mfma_f32_32x32x16_bf16 v[132:147], v[28:31], v[40:43], v[132:147]
    v_mfma_f32_32x32x16_bf16 v[148:163], v[24:27], v[44:47], 0
    v_mfma_f32_32x32x16_bf16 v[148:163], v[28:31], v[48:51], v[148:163]
    s_and_b32 s70, s42, 4294966272
    buffer_load_dwordx4 v[220:223], v1, s[4:7], s70 offen
    s_and_b32 s71, s43, 4294966272
    buffer_load_dwordx4 v[224:227], v1, s[4:7], s71 offen
    s_waitcnt lgkmcnt(0)
    s_nop 6
    v_exp_f32 v12, v132
    v_exp_f32 v13, v133
    v_exp_f32 v14, v148
    v_exp_f32 v15, v149
    v_pk_add_f32 v[12:13], v[12:13], 1.0 op_sel_hi:[1,0]
    v_pk_add_f32 v[14:15], v[14:15], 1.0 op_sel_hi:[1,0]
    v_rcp_f32 v12, v12
    v_rcp_f32 v13, v13
    s_nop 0
    v_pk_mul_f32 v[132:133], v[132:133], v[12:13]
L_loop:
    s_setprio 3
    ds_read_b32 v9, v5 offset:132
    ds_read_b32 v10, v6 offset:132
    ds_read_b32 v8, v4 offset:192
    s_waitcnt vmcnt(7)
    v_rcp_f32 v14, v14
    v_mfma_f32_4x4x4_16b_bf16 v[16:19], v[32:33], v[196:197], 0 cbsz:4 abid:0
    v_exp_f32 v13, v135
    v_mfma_f32_4x4x4_16b_bf16 v[20:23], v[32:33], v[198:199], 0 cbsz:4 abid:0
    v_exp_f32 v12, v134
    v_readlane_b32 s45, v7, 1
    v_rcp_f32 v15, v15
    v_pk_add_f32 v[12:13], v[12:13], 1.0 op_sel_hi:[1,0]
    v_pk_mul_f32 v[148:149], v[148:149], v[14:15]
    s_and_b32 s69, s45, 4294966272
    s_set_gpr_idx_on s36, gpr_idx(SRC2,DST)
    buffer_load_dwordx4 v[196:199], v1, s[4:7], s68 offen
    v_pk_fma_f32 v[84:85], v[132:133], v[16:17], v[84:85] op_sel_hi:[0,1,1]
    v_pk_fma_f32 v[86:87], v[132:133], v[18:19], v[86:87] op_sel_hi:[0,1,1]
    v_pk_fma_f32 v[88:89], v[148:149], v[20:21], v[88:89] op_sel_hi:[0,1,1]
    v_pk_fma_f32 v[90:91], v[148:149], v[22:23], v[90:91] op_sel_hi:[0,1,1]
    s_set_gpr_idx_off
    s_waitcnt vmcnt(7)
    v_rcp_f32 v12, v12
    v_mfma_f32_4x4x4_16b_bf16 v[16:19], v[32:33], v[200:201], 0 cbsz:4 abid:1
    v_exp_f32 v15, v151
    v_mfma_f32_4x4x4_16b_bf16 v[20:23], v[32:33], v[202:203], 0 cbsz:4 abid:1
    v_exp_f32 v14, v150
    v_readlane_b32 s46, v7, 2
    v_rcp_f32 v13, v13
    v_pk_add_f32 v[14:15], v[14:15], 1.0 op_sel_hi:[1,0]
    v_pk_mul_f32 v[134:135], v[134:135], v[12:13]
    s_and_b32 s68, s46, 4294966272
    s_set_gpr_idx_on s37, gpr_idx(SRC2,DST)
    buffer_load_dwordx4 v[200:203], v1, s[4:7], s69 offen
    v_pk_fma_f32 v[84:85], v[132:133], v[16:17], v[84:85] op_sel:[1,0,0]
    v_pk_fma_f32 v[86:87], v[132:133], v[18:19], v[86:87] op_sel:[1,0,0]
    v_pk_fma_f32 v[88:89], v[148:149], v[20:21], v[88:89] op_sel:[1,0,0]
    v_pk_fma_f32 v[90:91], v[148:149], v[22:23], v[90:91] op_sel:[1,0,0]
    s_set_gpr_idx_off
    s_waitcnt lgkmcnt(0)
    v_add_u32 v9, v9, v2
    v_add_u32 v10, v10, v3
    s_mov_b64 exec, s[32:33]
    ds_read_b128 v[24:27], v9 offset:63232
    s_mov_b64 exec, s[34:35]
    ds_read_b128 v[28:31], v9 offset:63232
    s_mov_b64 exec, -1
    ds_read_b64 v[34:35], v10
    s_waitcnt vmcnt(7)
    v_rcp_f32 v14, v14
    v_mfma_f32_4x4x4_16b_bf16 v[16:19], v[32:33], v[204:205], 0 cbsz:4 abid:2
    v_exp_f32 v13, v137
    v_mfma_f32_4x4x4_16b_bf16 v[20:23], v[32:33], v[206:207], 0 cbsz:4 abid:2
    v_exp_f32 v12, v136
    v_readlane_b32 s47, v7, 3
    v_rcp_f32 v15, v15
    v_pk_add_f32 v[12:13], v[12:13], 1.0 op_sel_hi:[1,0]
    v_pk_mul_f32 v[150:151], v[150:151], v[14:15]
    s_and_b32 s69, s47, 4294966272
    s_set_gpr_idx_on s38, gpr_idx(SRC2,DST)
    buffer_load_dwordx4 v[204:207], v1, s[4:7], s68 offen
    v_pk_fma_f32 v[84:85], v[134:135], v[16:17], v[84:85] op_sel_hi:[0,1,1]
    v_pk_fma_f32 v[86:87], v[134:135], v[18:19], v[86:87] op_sel_hi:[0,1,1]
    v_pk_fma_f32 v[88:89], v[150:151], v[20:21], v[88:89] op_sel_hi:[0,1,1]
    v_pk_fma_f32 v[90:91], v[150:151], v[22:23], v[90:91] op_sel_hi:[0,1,1]
    s_set_gpr_idx_off
    s_waitcnt vmcnt(7)
    v_rcp_f32 v12, v12
    v_mfma_f32_4x4x4_16b_bf16 v[16:19], v[32:33], v[208:209], 0 cbsz:4 abid:3
    v_exp_f32 v15, v153
    v_mfma_f32_4x4x4_16b_bf16 v[20:23], v[32:33], v[210:211], 0 cbsz:4 abid:3
    v_exp_f32 v14, v152
    v_readlane_b32 s48, v7, 4
    v_rcp_f32 v13, v13
    v_pk_add_f32 v[14:15], v[14:15], 1.0 op_sel_hi:[1,0]
    v_pk_mul_f32 v[136:137], v[136:137], v[12:13]
    s_and_b32 s68, s48, 4294966272
    s_set_gpr_idx_on s39, gpr_idx(SRC2,DST)
    buffer_load_dwordx4 v[208:211], v1, s[4:7], s69 offen
    v_pk_fma_f32 v[84:85], v[134:135], v[16:17], v[84:85] op_sel:[1,0,0]
    v_pk_fma_f32 v[86:87], v[134:135], v[18:19], v[86:87] op_sel:[1,0,0]
    v_pk_fma_f32 v[88:89], v[150:151], v[20:21], v[88:89] op_sel:[1,0,0]
    v_pk_fma_f32 v[90:91], v[150:151], v[22:23], v[90:91] op_sel:[1,0,0]
    s_set_gpr_idx_off
    s_sub_u32 s29, s29, 4
    s_cbranch_scc1 L_exit
    s_setprio 2
    s_waitcnt vmcnt(7)
    v_rcp_f32 v14, v14
    v_mfma_f32_4x4x4_16b_bf16 v[16:19], v[32:33], v[212:213], 0 cbsz:4 abid:4
    v_exp_f32 v13, v139
    v_mfma_f32_4x4x4_16b_bf16 v[20:23], v[32:33], v[214:215], 0 cbsz:4 abid:4
    v_exp_f32 v12, v138
    v_readlane_b32 s49, v7, 5
    v_rcp_f32 v15, v15
    v_pk_add_f32 v[12:13], v[12:13], 1.0 op_sel_hi:[1,0]
    v_pk_mul_f32 v[152:153], v[152:153], v[14:15]
    s_and_b32 s69, s49, 4294966272
    s_set_gpr_idx_on s40, gpr_idx(SRC2,DST)
    buffer_load_dwordx4 v[212:215], v1, s[4:7], s68 offen
    v_pk_fma_f32 v[84:85], v[136:137], v[16:17], v[84:85] op_sel_hi:[0,1,1]
    v_pk_fma_f32 v[86:87], v[136:137], v[18:19], v[86:87] op_sel_hi:[0,1,1]
    v_pk_fma_f32 v[88:89], v[152:153], v[20:21], v[88:89] op_sel_hi:[0,1,1]
    v_pk_fma_f32 v[90:91], v[152:153], v[22:23], v[90:91] op_sel_hi:[0,1,1]
    s_set_gpr_idx_off
    s_waitcnt vmcnt(7) lgkmcnt(0)
    v_mfma_f32_4x4x4_16b_bf16 v[20:23], v[32:33], v[218:219], 0 cbsz:4 abid:5
    v_mfma_f32_4x4x4_16b_bf16 v[16:19], v[32:33], v[216:217], 0 cbsz:4 abid:5
    v_rcp_f32 v13, v13
    v_mfma_f32_32x32x16_bf16 v[164:179], v[24:27], v[36:39], 0
    v_exp_f32 v14, v154
    v_exp_f32 v15, v155
    v_readlane_b32 s50, v7, 6
    v_rcp_f32 v12, v12
    v_pk_add_f32 v[14:15], v[14:15], 1.0 op_sel_hi:[1,0]
    v_pk_mul_f32 v[138:139], v[138:139], v[12:13]
    s_and_b32 s68, s50, 4294966272
    s_set_gpr_idx_on s41, gpr_idx(SRC2,DST)
    buffer_load_dwordx4 v[216:219], v1, s[4:7], s69 offen
    v_pk_fma_f32 v[84:85], v[136:137], v[16:17], v[84:85] op_sel:[1,0,0]
    v_pk_fma_f32 v[86:87], v[136:137], v[18:19], v[86:87] op_sel:[1,0,0]
    v_pk_fma_f32 v[88:89], v[152:153], v[20:21], v[88:89] op_sel:[1,0,0]
    v_pk_fma_f32 v[90:91], v[152:153], v[22:23], v[90:91] op_sel:[1,0,0]
    s_set_gpr_idx_off
    s_waitcnt vmcnt(7)
    v_rcp_f32 v14, v14
    v_mfma_f32_4x4x4_16b_bf16 v[16:19], v[32:33], v[220:221], 0 cbsz:4 abid:6
    v_exp_f32 v13, v141
    v_mfma_f32_4x4x4_16b_bf16 v[20:23], v[32:33], v[222:223], 0 cbsz:4 abid:6
    v_exp_f32 v12, v140
    v_readlane_b32 s51, v7, 7
    v_rcp_f32 v15, v15
    v_pk_add_f32 v[12:13], v[12:13], 1.0 op_sel_hi:[1,0]
    v_pk_mul_f32 v[154:155], v[154:155], v[14:15]
    s_and_b32 s69, s51, 4294966272
    s_set_gpr_idx_on s42, gpr_idx(SRC2,DST)
    buffer_load_dwordx4 v[220:223], v1, s[4:7], s68 offen
    v_pk_fma_f32 v[84:85], v[138:139], v[16:17], v[84:85] op_sel_hi:[0,1,1]
    v_pk_fma_f32 v[86:87], v[138:139], v[18:19], v[86:87] op_sel_hi:[0,1,1]
    v_pk_fma_f32 v[88:89], v[154:155], v[20:21], v[88:89] op_sel_hi:[0,1,1]
    v_pk_fma_f32 v[90:91], v[154:155], v[22:23], v[90:91] op_sel_hi:[0,1,1]
    s_set_gpr_idx_off
    s_waitcnt vmcnt(7)
    v_mfma_f32_4x4x4_16b_bf16 v[20:23], v[32:33], v[226:227], 0 cbsz:4 abid:7
    v_mfma_f32_4x4x4_16b_bf16 v[16:19], v[32:33], v[224:225], 0 cbsz:4 abid:7
    v_rcp_f32 v13, v13
    v_mfma_f32_32x32x16_bf16 v[164:179], v[28:31], v[40:43], v[164:179]
    v_exp_f32 v14, v156
    v_exp_f32 v15, v157
    v_readlane_b32 s52, v7, 8
    v_rcp_f32 v12, v12
    v_pk_add_f32 v[14:15], v[14:15], 1.0 op_sel_hi:[1,0]
    v_pk_mul_f32 v[140:141], v[140:141], v[12:13]
    s_and_b32 s68, s52, 4294966272
    s_set_gpr_idx_on s43, gpr_idx(SRC2,DST)
    buffer_load_dwordx4 v[224:227], v1, s[4:7], s69 offen
    v_pk_fma_f32 v[84:85], v[138:139], v[16:17], v[84:85] op_sel:[1,0,0]
    v_pk_fma_f32 v[86:87], v[138:139], v[18:19], v[86:87] op_sel:[1,0,0]
    v_pk_fma_f32 v[88:89], v[154:155], v[20:21], v[88:89] op_sel:[1,0,0]
    v_pk_fma_f32 v[90:91], v[154:155], v[22:23], v[90:91] op_sel:[1,0,0]
    s_set_gpr_idx_off
    s_sub_u32 s29, s29, 4
    s_cbranch_scc1 L_exit
    s_setprio 1
    s_waitcnt vmcnt(7)
    v_rcp_f32 v14, v14
    v_mfma_f32_4x4x4_16b_bf16 v[16:19], v[32:33], v[196:197], 0 cbsz:4 abid:8
    v_exp_f32 v13, v143
    v_mfma_f32_4x4x4_16b_bf16 v[20:23], v[32:33], v[198:199], 0 cbsz:4 abid:8
    v_exp_f32 v12, v142
    v_readlane_b32 s53, v7, 9
    v_rcp_f32 v15, v15
    v_pk_add_f32 v[12:13], v[12:13], 1.0 op_sel_hi:[1,0]
    v_pk_mul_f32 v[156:157], v[156:157], v[14:15]
    s_and_b32 s69, s53, 4294966272
    s_set_gpr_idx_on s44, gpr_idx(SRC2,DST)
    buffer_load_dwordx4 v[196:199], v1, s[4:7], s68 offen
    v_pk_fma_f32 v[84:85], v[140:141], v[16:17], v[84:85] op_sel_hi:[0,1,1]
    v_pk_fma_f32 v[86:87], v[140:141], v[18:19], v[86:87] op_sel_hi:[0,1,1]
    v_pk_fma_f32 v[88:89], v[156:157], v[20:21], v[88:89] op_sel_hi:[0,1,1]
    v_pk_fma_f32 v[90:91], v[156:157], v[22:23], v[90:91] op_sel_hi:[0,1,1]
    s_set_gpr_idx_off
    s_waitcnt vmcnt(7)
    v_mfma_f32_4x4x4_16b_bf16 v[20:23], v[32:33], v[202:203], 0 cbsz:4 abid:9
    v_mfma_f32_4x4x4_16b_bf16 v[16:19], v[32:33], v[200:201], 0 cbsz:4 abid:9
    v_rcp_f32 v13, v13
    v_mfma_f32_32x32x16_bf16 v[180:195], v[24:27], v[44:47], 0
    v_exp_f32 v14, v158
    v_exp_f32 v15, v159
    v_readlane_b32 s54, v7, 10
    v_rcp_f32 v12, v12
    v_pk_add_f32 v[14:15], v[14:15], 1.0 op_sel_hi:[1,0]
    v_pk_mul_f32 v[142:143], v[142:143], v[12:13]
    s_and_b32 s68, s54, 4294966272
    s_set_gpr_idx_on s45, gpr_idx(SRC2,DST)
    buffer_load_dwordx4 v[200:203], v1, s[4:7], s69 offen
    v_pk_fma_f32 v[84:85], v[140:141], v[16:17], v[84:85] op_sel:[1,0,0]
    v_pk_fma_f32 v[86:87], v[140:141], v[18:19], v[86:87] op_sel:[1,0,0]
    v_pk_fma_f32 v[88:89], v[156:157], v[20:21], v[88:89] op_sel:[1,0,0]
    v_pk_fma_f32 v[90:91], v[156:157], v[22:23], v[90:91] op_sel:[1,0,0]
    s_set_gpr_idx_off
    s_waitcnt vmcnt(7)
    v_rcp_f32 v14, v14
    v_mfma_f32_4x4x4_16b_bf16 v[16:19], v[32:33], v[204:205], 0 cbsz:4 abid:10
    v_exp_f32 v13, v145
    v_mfma_f32_4x4x4_16b_bf16 v[20:23], v[32:33], v[206:207], 0 cbsz:4 abid:10
    v_exp_f32 v12, v144
    v_readlane_b32 s55, v7, 11
    v_rcp_f32 v15, v15
    v_pk_add_f32 v[12:13], v[12:13], 1.0 op_sel_hi:[1,0]
    v_pk_mul_f32 v[158:159], v[158:159], v[14:15]
    s_and_b32 s69, s55, 4294966272
    s_set_gpr_idx_on s46, gpr_idx(SRC2,DST)
    buffer_load_dwordx4 v[204:207], v1, s[4:7], s68 offen
    v_pk_fma_f32 v[84:85], v[142:143], v[16:17], v[84:85] op_sel_hi:[0,1,1]
    v_pk_fma_f32 v[86:87], v[142:143], v[18:19], v[86:87] op_sel_hi:[0,1,1]
    v_pk_fma_f32 v[88:89], v[158:159], v[20:21], v[88:89] op_sel_hi:[0,1,1]
    v_pk_fma_f32 v[90:91], v[158:159], v[22:23], v[90:91] op_sel_hi:[0,1,1]
    s_set_gpr_idx_off
    s_waitcnt vmcnt(7)
    v_mfma_f32_4x4x4_16b_bf16 v[20:23], v[32:33], v[210:211], 0 cbsz:4 abid:11
    v_mfma_f32_4x4x4_16b_bf16 v[16:19], v[32:33], v[208:209], 0 cbsz:4 abid:11
    v_rcp_f32 v13, v13
    v_mfma_f32_32x32x16_bf16 v[180:195], v[28:31], v[48:51], v[180:195]
    v_exp_f32 v14, v160
    v_exp_f32 v15, v161
    v_readlane_b32 s56, v7, 12
    v_rcp_f32 v12, v12
    v_pk_add_f32 v[14:15], v[14:15], 1.0 op_sel_hi:[1,0]
    v_pk_mul_f32 v[144:145], v[144:145], v[12:13]
    s_and_b32 s68, s56, 4294966272
    s_set_gpr_idx_on s47, gpr_idx(SRC2,DST)
    buffer_load_dwordx4 v[208:211], v1, s[4:7], s69 offen
    v_pk_fma_f32 v[84:85], v[142:143], v[16:17], v[84:85] op_sel:[1,0,0]
    v_pk_fma_f32 v[86:87], v[142:143], v[18:19], v[86:87] op_sel:[1,0,0]
    v_pk_fma_f32 v[88:89], v[158:159], v[20:21], v[88:89] op_sel:[1,0,0]
    v_pk_fma_f32 v[90:91], v[158:159], v[22:23], v[90:91] op_sel:[1,0,0]
    s_set_gpr_idx_off
    s_sub_u32 s29, s29, 4
    s_cbranch_scc1 L_exit
    s_setprio 0
    s_waitcnt vmcnt(7)
    v_rcp_f32 v14, v14
    v_mfma_f32_4x4x4_16b_bf16 v[16:19], v[32:33], v[212:213], 0 cbsz:4 abid:12
    v_exp_f32 v13, v147
    v_mfma_f32_4x4x4_16b_bf16 v[20:23], v[32:33], v[214:215], 0 cbsz:4 abid:12
    v_exp_f32 v12, v146
    v_readlane_b32 s57, v7, 13
    v_rcp_f32 v15, v15
    v_pk_add_f32 v[12:13], v[12:13], 1.0 op_sel_hi:[1,0]
    v_pk_mul_f32 v[160:161], v[160:161], v[14:15]
    s_and_b32 s69, s57, 4294966272
    s_set_gpr_idx_on s48, gpr_idx(SRC2,DST)
    buffer_load_dwordx4 v[212:215], v1, s[4:7], s68 offen
    v_pk_fma_f32 v[84:85], v[144:145], v[16:17], v[84:85] op_sel_hi:[0,1,1]
    v_pk_fma_f32 v[86:87], v[144:145], v[18:19], v[86:87] op_sel_hi:[0,1,1]
    v_pk_fma_f32 v[88:89], v[160:161], v[20:21], v[88:89] op_sel_hi:[0,1,1]
    v_pk_fma_f32 v[90:91], v[160:161], v[22:23], v[90:91] op_sel_hi:[0,1,1]
    s_set_gpr_idx_off
    s_waitcnt vmcnt(7)
    v_rcp_f32 v12, v12
    v_mfma_f32_4x4x4_16b_bf16 v[16:19], v[32:33], v[216:217], 0 cbsz:4 abid:13
    v_exp_f32 v15, v163
    v_mfma_f32_4x4x4_16b_bf16 v[20:23], v[32:33], v[218:219], 0 cbsz:4 abid:13
    v_exp_f32 v14, v162
    v_readlane_b32 s58, v7, 14
    v_rcp_f32 v13, v13
    v_pk_add_f32 v[14:15], v[14:15], 1.0 op_sel_hi:[1,0]
    v_pk_mul_f32 v[146:147], v[146:147], v[12:13]
    s_and_b32 s68, s58, 4294966272
    s_set_gpr_idx_on s49, gpr_idx(SRC2,DST)
    buffer_load_dwordx4 v[216:219], v1, s[4:7], s69 offen
    v_pk_fma_f32 v[84:85], v[144:145], v[16:17], v[84:85] op_sel:[1,0,0]
    v_pk_fma_f32 v[86:87], v[144:145], v[18:19], v[86:87] op_sel:[1,0,0]
    v_pk_fma_f32 v[88:89], v[160:161], v[20:21], v[88:89] op_sel:[1,0,0]
    v_pk_fma_f32 v[90:91], v[160:161], v[22:23], v[90:91] op_sel:[1,0,0]
    s_set_gpr_idx_off
    s_waitcnt vmcnt(7)
    v_rcp_f32 v14, v14
    v_mfma_f32_4x4x4_16b_bf16 v[16:19], v[32:33], v[220:221], 0 cbsz:4 abid:14
    v_exp_f32 v13, v165
    v_mfma_f32_4x4x4_16b_bf16 v[20:23], v[32:33], v[222:223], 0 cbsz:4 abid:14
    v_exp_f32 v12, v164
    v_readlane_b32 s59, v7, 15
    v_rcp_f32 v15, v15
    v_pk_add_f32 v[12:13], v[12:13], 1.0 op_sel_hi:[1,0]
    v_pk_mul_f32 v[162:163], v[162:163], v[14:15]
    s_and_b32 s69, s59, 4294966272
    s_set_gpr_idx_on s50, gpr_idx(SRC2,DST)
    buffer_load_dwordx4 v[220:223], v1, s[4:7], s68 offen
    v_pk_fma_f32 v[84:85], v[146:147], v[16:17], v[84:85] op_sel_hi:[0,1,1]
    v_pk_fma_f32 v[86:87], v[146:147], v[18:19], v[86:87] op_sel_hi:[0,1,1]
    v_pk_fma_f32 v[88:89], v[162:163], v[20:21], v[88:89] op_sel_hi:[0,1,1]
    v_pk_fma_f32 v[90:91], v[162:163], v[22:23], v[90:91] op_sel_hi:[0,1,1]
    s_set_gpr_idx_off
    s_waitcnt vmcnt(7)
    v_rcp_f32 v12, v12
    v_mfma_f32_4x4x4_16b_bf16 v[16:19], v[32:33], v[224:225], 0 cbsz:4 abid:15
    v_exp_f32 v15, v181
    v_mfma_f32_4x4x4_16b_bf16 v[20:23], v[32:33], v[226:227], 0 cbsz:4 abid:15
    v_exp_f32 v14, v180
    v_readlane_b32 s60, v8, 0
    v_rcp_f32 v13, v13
    v_pk_add_f32 v[14:15], v[14:15], 1.0 op_sel_hi:[1,0]
    v_pk_mul_f32 v[164:165], v[164:165], v[12:13]
    s_and_b32 s68, s60, 4294966272
    s_set_gpr_idx_on s51, gpr_idx(SRC2,DST)
    buffer_load_dwordx4 v[224:227], v1, s[4:7], s69 offen
    v_pk_fma_f32 v[84:85], v[146:147], v[16:17], v[84:85] op_sel:[1,0,0]
    v_pk_fma_f32 v[86:87], v[146:147], v[18:19], v[86:87] op_sel:[1,0,0]
    v_pk_fma_f32 v[88:89], v[162:163], v[20:21], v[88:89] op_sel:[1,0,0]
    v_pk_fma_f32 v[90:91], v[162:163], v[22:23], v[90:91] op_sel:[1,0,0]
    s_set_gpr_idx_off
    s_sub_u32 s29, s29, 4
    s_cbranch_scc1 L_exit
    s_setprio 3
    ds_read_b32 v9, v5 offset:260
    ds_read_b32 v10, v6 offset:260
    ds_read_b32 v7, v4 offset:320
    s_waitcnt vmcnt(7)
    v_rcp_f32 v14, v14
    v_mfma_f32_4x4x4_16b_bf16 v[16:19], v[34:35], v[196:197], 0 cbsz:4 abid:0
    v_exp_f32 v13, v167
    v_mfma_f32_4x4x4_16b_bf16 v[20:23], v[34:35], v[198:199], 0 cbsz:4 abid:0
    v_exp_f32 v12, v166
    v_readlane_b32 s61, v8, 1
    v_rcp_f32 v15, v15
    v_pk_add_f32 v[12:13], v[12:13], 1.0 op_sel_hi:[1,0]
    v_pk_mul_f32 v[180:181], v[180:181], v[14:15]
    s_and_b32 s69, s61, 4294966272
    s_set_gpr_idx_on s52, gpr_idx(SRC2,DST)
    buffer_load_dwordx4 v[196:199], v1, s[4:7], s68 offen
    v_pk_fma_f32 v[84:85], v[164:165], v[16:17], v[84:85] op_sel_hi:[0,1,1]
    v_pk_fma_f32 v[86:87], v[164:165], v[18:19], v[86:87] op_sel_hi:[0,1,1]
    v_pk_fma_f32 v[88:89], v[180:181], v[20:21], v[88:89] op_sel_hi:[0,1,1]
    v_pk_fma_f32 v[90:91], v[180:181], v[22:23], v[90:91] op_sel_hi:[0,1,1]
    s_set_gpr_idx_off
    s_waitcnt vmcnt(7)
    v_rcp_f32 v12, v12
    v_mfma_f32_4x4x4_16b_bf16 v[16:19], v[34:35], v[200:201], 0 cbsz:4 abid:1
    v_exp_f32 v15, v183
    v_mfma_f32_4x4x4_16b_bf16 v[20:23], v[34:35], v[202:203], 0 cbsz:4 abid:1
    v_exp_f32 v14, v182
    v_readlane_b32 s62, v8, 2
    v_rcp_f32 v13, v13
    v_pk_add_f32 v[14:15], v[14:15], 1.0 op_sel_hi:[1,0]
    v_pk_mul_f32 v[166:167], v[166:167], v[12:13]
    s_and_b32 s68, s62, 4294966272
    s_set_gpr_idx_on s53, gpr_idx(SRC2,DST)
    buffer_load_dwordx4 v[200:203], v1, s[4:7], s69 offen
    v_pk_fma_f32 v[84:85], v[164:165], v[16:17], v[84:85] op_sel:[1,0,0]
    v_pk_fma_f32 v[86:87], v[164:165], v[18:19], v[86:87] op_sel:[1,0,0]
    v_pk_fma_f32 v[88:89], v[180:181], v[20:21], v[88:89] op_sel:[1,0,0]
    v_pk_fma_f32 v[90:91], v[180:181], v[22:23], v[90:91] op_sel:[1,0,0]
    s_set_gpr_idx_off
    s_waitcnt lgkmcnt(0)
    v_add_u32 v9, v9, v2
    v_add_u32 v10, v10, v3
    s_mov_b64 exec, s[32:33]
    ds_read_b128 v[24:27], v9 offset:63232
    s_mov_b64 exec, s[34:35]
    ds_read_b128 v[28:31], v9 offset:63232
    s_mov_b64 exec, -1
    ds_read_b64 v[32:33], v10
    s_waitcnt vmcnt(7)
    v_rcp_f32 v14, v14
    v_mfma_f32_4x4x4_16b_bf16 v[16:19], v[34:35], v[204:205], 0 cbsz:4 abid:2
    v_exp_f32 v13, v169
    v_mfma_f32_4x4x4_16b_bf16 v[20:23], v[34:35], v[206:207], 0 cbsz:4 abid:2
    v_exp_f32 v12, v168
    v_readlane_b32 s63, v8, 3
    v_rcp_f32 v15, v15
    v_pk_add_f32 v[12:13], v[12:13], 1.0 op_sel_hi:[1,0]
    v_pk_mul_f32 v[182:183], v[182:183], v[14:15]
    s_and_b32 s69, s63, 4294966272
    s_set_gpr_idx_on s54, gpr_idx(SRC2,DST)
    buffer_load_dwordx4 v[204:207], v1, s[4:7], s68 offen
    v_pk_fma_f32 v[84:85], v[166:167], v[16:17], v[84:85] op_sel_hi:[0,1,1]
    v_pk_fma_f32 v[86:87], v[166:167], v[18:19], v[86:87] op_sel_hi:[0,1,1]
    v_pk_fma_f32 v[88:89], v[182:183], v[20:21], v[88:89] op_sel_hi:[0,1,1]
    v_pk_fma_f32 v[90:91], v[182:183], v[22:23], v[90:91] op_sel_hi:[0,1,1]
    s_set_gpr_idx_off
    s_waitcnt vmcnt(7)
    v_rcp_f32 v12, v12
    v_mfma_f32_4x4x4_16b_bf16 v[16:19], v[34:35], v[208:209], 0 cbsz:4 abid:3
    v_exp_f32 v15, v185
    v_mfma_f32_4x4x4_16b_bf16 v[20:23], v[34:35], v[210:211], 0 cbsz:4 abid:3
    v_exp_f32 v14, v184
    v_readlane_b32 s64, v8, 4
    v_rcp_f32 v13, v13
    v_pk_add_f32 v[14:15], v[14:15], 1.0 op_sel_hi:[1,0]
    v_pk_mul_f32 v[168:169], v[168:169], v[12:13]
    s_and_b32 s68, s64, 4294966272
    s_set_gpr_idx_on s55, gpr_idx(SRC2,DST)
    buffer_load_dwordx4 v[208:211], v1, s[4:7], s69 offen
    v_pk_fma_f32 v[84:85], v[166:167], v[16:17], v[84:85] op_sel:[1,0,0]
    v_pk_fma_f32 v[86:87], v[166:167], v[18:19], v[86:87] op_sel:[1,0,0]
    v_pk_fma_f32 v[88:89], v[182:183], v[20:21], v[88:89] op_sel:[1,0,0]
    v_pk_fma_f32 v[90:91], v[182:183], v[22:23], v[90:91] op_sel:[1,0,0]
    s_set_gpr_idx_off
    s_sub_u32 s29, s29, 4
    s_cbranch_scc1 L_exit
    s_setprio 2
    s_waitcnt vmcnt(7)
    v_rcp_f32 v14, v14
    v_mfma_f32_4x4x4_16b_bf16 v[16:19], v[34:35], v[212:213], 0 cbsz:4 abid:4
    v_exp_f32 v13, v171
    v_mfma_f32_4x4x4_16b_bf16 v[20:23], v[34:35], v[214:215], 0 cbsz:4 abid:4
    v_exp_f32 v12, v170
    v_readlane_b32 s65, v8, 5
    v_rcp_f32 v15, v15
    v_pk_add_f32 v[12:13], v[12:13], 1.0 op_sel_hi:[1,0]
    v_pk_mul_f32 v[184:185], v[184:185], v[14:15]
    s_and_b32 s69, s65, 4294966272
    s_set_gpr_idx_on s56, gpr_idx(SRC2,DST)
    buffer_load_dwordx4 v[212:215], v1, s[4:7], s68 offen
    v_pk_fma_f32 v[84:85], v[168:169], v[16:17], v[84:85] op_sel_hi:[0,1,1]
    v_pk_fma_f32 v[86:87], v[168:169], v[18:19], v[86:87] op_sel_hi:[0,1,1]
    v_pk_fma_f32 v[88:89], v[184:185], v[20:21], v[88:89] op_sel_hi:[0,1,1]
    v_pk_fma_f32 v[90:91], v[184:185], v[22:23], v[90:91] op_sel_hi:[0,1,1]
    s_set_gpr_idx_off
    s_waitcnt vmcnt(7) lgkmcnt(0)
    v_mfma_f32_4x4x4_16b_bf16 v[20:23], v[34:35], v[218:219], 0 cbsz:4 abid:5
    v_mfma_f32_4x4x4_16b_bf16 v[16:19], v[34:35], v[216:217], 0 cbsz:4 abid:5
    v_rcp_f32 v13, v13
    v_mfma_f32_32x32x16_bf16 v[132:147], v[24:27], v[36:39], 0
    v_exp_f32 v14, v186
    v_exp_f32 v15, v187
    v_readlane_b32 s66, v8, 6
    v_rcp_f32 v12, v12
    v_pk_add_f32 v[14:15], v[14:15], 1.0 op_sel_hi:[1,0]
    v_pk_mul_f32 v[170:171], v[170:171], v[12:13]
    s_and_b32 s68, s66, 4294966272
    s_set_gpr_idx_on s57, gpr_idx(SRC2,DST)
    buffer_load_dwordx4 v[216:219], v1, s[4:7], s69 offen
    v_pk_fma_f32 v[84:85], v[168:169], v[16:17], v[84:85] op_sel:[1,0,0]
    v_pk_fma_f32 v[86:87], v[168:169], v[18:19], v[86:87] op_sel:[1,0,0]
    v_pk_fma_f32 v[88:89], v[184:185], v[20:21], v[88:89] op_sel:[1,0,0]
    v_pk_fma_f32 v[90:91], v[184:185], v[22:23], v[90:91] op_sel:[1,0,0]
    s_set_gpr_idx_off
    s_waitcnt vmcnt(7)
    v_rcp_f32 v14, v14
    v_mfma_f32_4x4x4_16b_bf16 v[16:19], v[34:35], v[220:221], 0 cbsz:4 abid:6
    v_exp_f32 v13, v173
    v_mfma_f32_4x4x4_16b_bf16 v[20:23], v[34:35], v[222:223], 0 cbsz:4 abid:6
    v_exp_f32 v12, v172
    v_readlane_b32 s67, v8, 7
    v_rcp_f32 v15, v15
    v_pk_add_f32 v[12:13], v[12:13], 1.0 op_sel_hi:[1,0]
    v_pk_mul_f32 v[186:187], v[186:187], v[14:15]
    s_and_b32 s69, s67, 4294966272
    s_set_gpr_idx_on s58, gpr_idx(SRC2,DST)
    buffer_load_dwordx4 v[220:223], v1, s[4:7], s68 offen
    v_pk_fma_f32 v[84:85], v[170:171], v[16:17], v[84:85] op_sel_hi:[0,1,1]
    v_pk_fma_f32 v[86:87], v[170:171], v[18:19], v[86:87] op_sel_hi:[0,1,1]
    v_pk_fma_f32 v[88:89], v[186:187], v[20:21], v[88:89] op_sel_hi:[0,1,1]
    v_pk_fma_f32 v[90:91], v[186:187], v[22:23], v[90:91] op_sel_hi:[0,1,1]
    s_set_gpr_idx_off
    s_waitcnt vmcnt(7)
    v_mfma_f32_4x4x4_16b_bf16 v[20:23], v[34:35], v[226:227], 0 cbsz:4 abid:7
    v_mfma_f32_4x4x4_16b_bf16 v[16:19], v[34:35], v[224:225], 0 cbsz:4 abid:7
    v_rcp_f32 v13, v13
    v_mfma_f32_32x32x16_bf16 v[132:147], v[28:31], v[40:43], v[132:147]
    v_exp_f32 v14, v188
    v_exp_f32 v15, v189
    v_readlane_b32 s36, v8, 8
    v_rcp_f32 v12, v12
    v_pk_add_f32 v[14:15], v[14:15], 1.0 op_sel_hi:[1,0]
    v_pk_mul_f32 v[172:173], v[172:173], v[12:13]
    s_and_b32 s68, s36, 4294966272
    s_set_gpr_idx_on s59, gpr_idx(SRC2,DST)
    buffer_load_dwordx4 v[224:227], v1, s[4:7], s69 offen
    v_pk_fma_f32 v[84:85], v[170:171], v[16:17], v[84:85] op_sel:[1,0,0]
    v_pk_fma_f32 v[86:87], v[170:171], v[18:19], v[86:87] op_sel:[1,0,0]
    v_pk_fma_f32 v[88:89], v[186:187], v[20:21], v[88:89] op_sel:[1,0,0]
    v_pk_fma_f32 v[90:91], v[186:187], v[22:23], v[90:91] op_sel:[1,0,0]
    s_set_gpr_idx_off
    s_sub_u32 s29, s29, 4
    s_cbranch_scc1 L_exit
    s_setprio 1
    s_waitcnt vmcnt(7)
    v_rcp_f32 v14, v14
    v_mfma_f32_4x4x4_16b_bf16 v[16:19], v[34:35], v[196:197], 0 cbsz:4 abid:8
    v_exp_f32 v13, v175
    v_mfma_f32_4x4x4_16b_bf16 v[20:23], v[34:35], v[198:199], 0 cbsz:4 abid:8
    v_exp_f32 v12, v174
    v_readlane_b32 s37, v8, 9
    v_rcp_f32 v15, v15
    v_pk_add_f32 v[12:13], v[12:13], 1.0 op_sel_hi:[1,0]
    v_pk_mul_f32 v[188:189], v[188:189], v[14:15]
    s_and_b32 s69, s37, 4294966272
    s_set_gpr_idx_on s60, gpr_idx(SRC2,DST)
    buffer_load_dwordx4 v[196:199], v1, s[4:7], s68 offen
    v_pk_fma_f32 v[84:85], v[172:173], v[16:17], v[84:85] op_sel_hi:[0,1,1]
    v_pk_fma_f32 v[86:87], v[172:173], v[18:19], v[86:87] op_sel_hi:[0,1,1]
    v_pk_fma_f32 v[88:89], v[188:189], v[20:21], v[88:89] op_sel_hi:[0,1,1]
    v_pk_fma_f32 v[90:91], v[188:189], v[22:23], v[90:91] op_sel_hi:[0,1,1]
    s_set_gpr_idx_off
    s_waitcnt vmcnt(7)
    v_mfma_f32_4x4x4_16b_bf16 v[20:23], v[34:35], v[202:203], 0 cbsz:4 abid:9
    v_mfma_f32_4x4x4_16b_bf16 v[16:19], v[34:35], v[200:201], 0 cbsz:4 abid:9
    v_rcp_f32 v13, v13
    v_mfma_f32_32x32x16_bf16 v[148:163], v[24:27], v[44:47], 0
    v_exp_f32 v14, v190
    v_exp_f32 v15, v191
    v_readlane_b32 s38, v8, 10
    v_rcp_f32 v12, v12
    v_pk_add_f32 v[14:15], v[14:15], 1.0 op_sel_hi:[1,0]
    v_pk_mul_f32 v[174:175], v[174:175], v[12:13]
    s_and_b32 s68, s38, 4294966272
    s_set_gpr_idx_on s61, gpr_idx(SRC2,DST)
    buffer_load_dwordx4 v[200:203], v1, s[4:7], s69 offen
    v_pk_fma_f32 v[84:85], v[172:173], v[16:17], v[84:85] op_sel:[1,0,0]
    v_pk_fma_f32 v[86:87], v[172:173], v[18:19], v[86:87] op_sel:[1,0,0]
    v_pk_fma_f32 v[88:89], v[188:189], v[20:21], v[88:89] op_sel:[1,0,0]
    v_pk_fma_f32 v[90:91], v[188:189], v[22:23], v[90:91] op_sel:[1,0,0]
    s_set_gpr_idx_off
    s_waitcnt vmcnt(7)
    v_rcp_f32 v14, v14
    v_mfma_f32_4x4x4_16b_bf16 v[16:19], v[34:35], v[204:205], 0 cbsz:4 abid:10
    v_exp_f32 v13, v177
    v_mfma_f32_4x4x4_16b_bf16 v[20:23], v[34:35], v[206:207], 0 cbsz:4 abid:10
    v_exp_f32 v12, v176
    v_readlane_b32 s39, v8, 11
    v_rcp_f32 v15, v15
    v_pk_add_f32 v[12:13], v[12:13], 1.0 op_sel_hi:[1,0]
    v_pk_mul_f32 v[190:191], v[190:191], v[14:15]
    s_and_b32 s69, s39, 4294966272
    s_set_gpr_idx_on s62, gpr_idx(SRC2,DST)
    buffer_load_dwordx4 v[204:207], v1, s[4:7], s68 offen
    v_pk_fma_f32 v[84:85], v[174:175], v[16:17], v[84:85] op_sel_hi:[0,1,1]
    v_pk_fma_f32 v[86:87], v[174:175], v[18:19], v[86:87] op_sel_hi:[0,1,1]
    v_pk_fma_f32 v[88:89], v[190:191], v[20:21], v[88:89] op_sel_hi:[0,1,1]
    v_pk_fma_f32 v[90:91], v[190:191], v[22:23], v[90:91] op_sel_hi:[0,1,1]
    s_set_gpr_idx_off
    s_waitcnt vmcnt(7)
    v_mfma_f32_4x4x4_16b_bf16 v[20:23], v[34:35], v[210:211], 0 cbsz:4 abid:11
    v_mfma_f32_4x4x4_16b_bf16 v[16:19], v[34:35], v[208:209], 0 cbsz:4 abid:11
    v_rcp_f32 v13, v13
    v_mfma_f32_32x32x16_bf16 v[148:163], v[28:31], v[48:51], v[148:163]
    v_exp_f32 v14, v192
    v_exp_f32 v15, v193
    v_readlane_b32 s40, v8, 12
    v_rcp_f32 v12, v12
    v_pk_add_f32 v[14:15], v[14:15], 1.0 op_sel_hi:[1,0]
    v_pk_mul_f32 v[176:177], v[176:177], v[12:13]
    s_and_b32 s68, s40, 4294966272
    s_set_gpr_idx_on s63, gpr_idx(SRC2,DST)
    buffer_load_dwordx4 v[208:211], v1, s[4:7], s69 offen
    v_pk_fma_f32 v[84:85], v[174:175], v[16:17], v[84:85] op_sel:[1,0,0]
    v_pk_fma_f32 v[86:87], v[174:175], v[18:19], v[86:87] op_sel:[1,0,0]
    v_pk_fma_f32 v[88:89], v[190:191], v[20:21], v[88:89] op_sel:[1,0,0]
    v_pk_fma_f32 v[90:91], v[190:191], v[22:23], v[90:91] op_sel:[1,0,0]
    s_set_gpr_idx_off
    s_sub_u32 s29, s29, 4
    s_cbranch_scc1 L_exit
    s_setprio 0
    s_waitcnt vmcnt(7)
    v_rcp_f32 v14, v14
    v_mfma_f32_4x4x4_16b_bf16 v[16:19], v[34:35], v[212:213], 0 cbsz:4 abid:12
    v_exp_f32 v13, v179
    v_mfma_f32_4x4x4_16b_bf16 v[20:23], v[34:35], v[214:215], 0 cbsz:4 abid:12
    v_exp_f32 v12, v178
    v_readlane_b32 s41, v8, 13
    v_rcp_f32 v15, v15
    v_pk_add_f32 v[12:13], v[12:13], 1.0 op_sel_hi:[1,0]
    v_pk_mul_f32 v[192:193], v[192:193], v[14:15]
    s_and_b32 s69, s41, 4294966272
    s_set_gpr_idx_on s64, gpr_idx(SRC2,DST)
    buffer_load_dwordx4 v[212:215], v1, s[4:7], s68 offen
    v_pk_fma_f32 v[84:85], v[176:177], v[16:17], v[84:85] op_sel_hi:[0,1,1]
    v_pk_fma_f32 v[86:87], v[176:177], v[18:19], v[86:87] op_sel_hi:[0,1,1]
    v_pk_fma_f32 v[88:89], v[192:193], v[20:21], v[88:89] op_sel_hi:[0,1,1]
    v_pk_fma_f32 v[90:91], v[192:193], v[22:23], v[90:91] op_sel_hi:[0,1,1]
    s_set_gpr_idx_off
    s_waitcnt vmcnt(7)
    v_rcp_f32 v12, v12
    v_mfma_f32_4x4x4_16b_bf16 v[16:19], v[34:35], v[216:217], 0 cbsz:4 abid:13
    v_exp_f32 v15, v195
    v_mfma_f32_4x4x4_16b_bf16 v[20:23], v[34:35], v[218:219], 0 cbsz:4 abid:13
    v_exp_f32 v14, v194
    v_readlane_b32 s42, v8, 14
    v_rcp_f32 v13, v13
    v_pk_add_f32 v[14:15], v[14:15], 1.0 op_sel_hi:[1,0]
    v_pk_mul_f32 v[178:179], v[178:179], v[12:13]
    s_and_b32 s68, s42, 4294966272
    s_set_gpr_idx_on s65, gpr_idx(SRC2,DST)
    buffer_load_dwordx4 v[216:219], v1, s[4:7], s69 offen
    v_pk_fma_f32 v[84:85], v[176:177], v[16:17], v[84:85] op_sel:[1,0,0]
    v_pk_fma_f32 v[86:87], v[176:177], v[18:19], v[86:87] op_sel:[1,0,0]
    v_pk_fma_f32 v[88:89], v[192:193], v[20:21], v[88:89] op_sel:[1,0,0]
    v_pk_fma_f32 v[90:91], v[192:193], v[22:23], v[90:91] op_sel:[1,0,0]
    s_set_gpr_idx_off
    s_waitcnt vmcnt(7)
    v_rcp_f32 v14, v14
    v_mfma_f32_4x4x4_16b_bf16 v[16:19], v[34:35], v[220:221], 0 cbsz:4 abid:14
    v_exp_f32 v13, v133
    v_mfma_f32_4x4x4_16b_bf16 v[20:23], v[34:35], v[222:223], 0 cbsz:4 abid:14
    v_exp_f32 v12, v132
    v_readlane_b32 s43, v8, 15
    v_rcp_f32 v15, v15
    v_pk_add_f32 v[12:13], v[12:13], 1.0 op_sel_hi:[1,0]
    v_pk_mul_f32 v[194:195], v[194:195], v[14:15]
    s_and_b32 s69, s43, 4294966272
    s_set_gpr_idx_on s66, gpr_idx(SRC2,DST)
    buffer_load_dwordx4 v[220:223], v1, s[4:7], s68 offen
    v_pk_fma_f32 v[84:85], v[178:179], v[16:17], v[84:85] op_sel_hi:[0,1,1]
    v_pk_fma_f32 v[86:87], v[178:179], v[18:19], v[86:87] op_sel_hi:[0,1,1]
    v_pk_fma_f32 v[88:89], v[194:195], v[20:21], v[88:89] op_sel_hi:[0,1,1]
    v_pk_fma_f32 v[90:91], v[194:195], v[22:23], v[90:91] op_sel_hi:[0,1,1]
    s_set_gpr_idx_off
    s_waitcnt vmcnt(7)
    v_rcp_f32 v12, v12
    v_mfma_f32_4x4x4_16b_bf16 v[16:19], v[34:35], v[224:225], 0 cbsz:4 abid:15
    v_exp_f32 v15, v149
    v_mfma_f32_4x4x4_16b_bf16 v[20:23], v[34:35], v[226:227], 0 cbsz:4 abid:15
    v_exp_f32 v14, v148
    v_readlane_b32 s44, v7, 0
    v_rcp_f32 v13, v13
    v_pk_add_f32 v[14:15], v[14:15], 1.0 op_sel_hi:[1,0]
    v_pk_mul_f32 v[132:133], v[132:133], v[12:13]
    s_and_b32 s68, s44, 4294966272
    s_set_gpr_idx_on s67, gpr_idx(SRC2,DST)
    buffer_load_dwordx4 v[224:227], v1, s[4:7], s69 offen
    v_pk_fma_f32 v[84:85], v[178:179], v[16:17], v[84:85] op_sel:[1,0,0]
    v_pk_fma_f32 v[86:87], v[178:179], v[18:19], v[86:87] op_sel:[1,0,0]
    v_pk_fma_f32 v[88:89], v[194:195], v[20:21], v[88:89] op_sel:[1,0,0]
    v_pk_fma_f32 v[90:91], v[194:195], v[22:23], v[90:91] op_sel:[1,0,0]
    s_set_gpr_idx_off
    s_sub_u32 s29, s29, 4
    s_cbranch_scc1 L_exit
    v_add_u32 v4, 256, v4
    v_add_u32 v5, 256, v5
    v_add_u32 v6, 256, v6
    s_branch L_loop
L_more:
    s_waitcnt vmcnt(0) lgkmcnt(0)
    s_barrier
    v_lshlrev_b32 v188, 4, v0
    v_add_u32 v189, 8192, v188
    v_add_u32 v190, 16384, v188
    v_add_u32 v191, 24576, v188
    v_add_u32 v192, 32768, v188
    v_add_u32 v193, 40960, v188
    v_lshlrev_b32 v194, 2, v0
    v_lshlrev_b32 v14, 3, v0
    v_mov_b32 v16, 0
    v_mov_b32 v17, 0
    v_mov_b32 v15, 0x00300000
    ds_write_b64 v14, v[16:17] offset:16128
    ds_write_b32 v194, v15 offset:20224
    ds_write_b32 v194, v15 offset:22272
    ds_write_b32 v194, v15 offset:24320
    v_lshrrev_b32 v195, 1, v0
    v_lshlrev_b32 v195, 2, v195
    s_branch L_round
L_exit:
    s_add_u32 s28, s28, 1536
    s_cmp_lt_u32 s28, s25
    s_cbranch_scc1 L_more
    s_mov_b32 m0, s96
    v_cvt_pk_bf16_f32 v84, v84, v88
    v_cvt_pk_bf16_f32 v85, v85, v89
    v_cvt_pk_bf16_f32 v86, v86, v90
    v_cvt_pk_bf16_f32 v87, v87, v91
    ds_write_addtid_b32 v84 offset:16128
    ds_write_addtid_b32 v85 offset:16416
    ds_write_addtid_b32 v86 offset:16704
    ds_write_addtid_b32 v87 offset:16992
    s_mov_b32 m0, s97
    v_cvt_pk_bf16_f32 v92, v92, v96
    v_cvt_pk_bf16_f32 v93, v93, v97
    v_cvt_pk_bf16_f32 v94, v94, v98
    v_cvt_pk_bf16_f32 v95, v95, v99
    ds_write_addtid_b32 v92 offset:16128
    ds_write_addtid_b32 v93 offset:16416
    ds_write_addtid_b32 v94 offset:16704
    ds_write_addtid_b32 v95 offset:16992
    s_mov_b32 m0, s98
    v_cvt_pk_bf16_f32 v100, v100, v104
    v_cvt_pk_bf16_f32 v101, v101, v105
    v_cvt_pk_bf16_f32 v102, v102, v106
    v_cvt_pk_bf16_f32 v103, v103, v107
    ds_write_addtid_b32 v100 offset:16128
    ds_write_addtid_b32 v101 offset:16416
    ds_write_addtid_b32 v102 offset:16704
    ds_write_addtid_b32 v103 offset:16992
    s_mov_b32 m0, s99
    v_cvt_pk_bf16_f32 v108, v108, v112
    v_cvt_pk_bf16_f32 v109, v109, v113
    v_cvt_pk_bf16_f32 v110, v110, v114
    v_cvt_pk_bf16_f32 v111, v111, v115
    ds_write_addtid_b32 v108 offset:16128
    ds_write_addtid_b32 v109 offset:16416
    ds_write_addtid_b32 v110 offset:16704
    ds_write_addtid_b32 v111 offset:16992
    s_mov_b32 m0, s100
    v_cvt_pk_bf16_f32 v116, v116, v120
    v_cvt_pk_bf16_f32 v117, v117, v121
    v_cvt_pk_bf16_f32 v118, v118, v122
    v_cvt_pk_bf16_f32 v119, v119, v123
    ds_write_addtid_b32 v116 offset:16128
    ds_write_addtid_b32 v117 offset:16416
    ds_write_addtid_b32 v118 offset:16704
    ds_write_addtid_b32 v119 offset:16992
    s_mov_b32 s68, 0xbf317218
    s_waitcnt lgkmcnt(0)
    s_barrier
    ds_read_b128 v[84:87], v230 offset:16128
    ds_read_b128 v[88:91], v230 offset:16192
    ds_read_b128 v[92:95], v230 offset:16256
    ds_read_b128 v[96:99], v230 offset:16320
    ds_read_b128 v[100:103], v230 offset:20736
    ds_read_b128 v[104:107], v230 offset:20800
    ds_read_b128 v[108:111], v230 offset:20864
    ds_read_b128 v[112:115], v230 offset:20928
    s_waitcnt lgkmcnt(7)
    v_mfma_f32_16x16x32_bf16 v[116:119], v[84:87], v[52:55], 0
    v_mfma_f32_16x16x32_bf16 v[120:123], v[84:87], v[56:59], 0
    s_waitcnt lgkmcnt(6)
    v_mfma_f32_16x16x32_bf16 v[116:119], v[88:91], v[60:63], v[116:119]
    v_mfma_f32_16x16x32_bf16 v[120:123], v[88:91], v[64:67], v[120:123]
    s_waitcnt lgkmcnt(5)
    v_mfma_f32_16x16x32_bf16 v[116:119], v[92:95], v[68:71], v[116:119]
    v_mfma_f32_16x16x32_bf16 v[120:123], v[92:95], v[72:75], v[120:123]
    s_waitcnt lgkmcnt(4)
    v_mfma_f32_16x16x32_bf16 v[116:119], v[96:99], v[76:79], v[116:119]
    v_mfma_f32_16x16x32_bf16 v[120:123], v[96:99], v[80:83], v[120:123]
    ds_read_b128 v[84:87], v230 offset:25344
    ds_read_b128 v[88:91], v230 offset:25408
    ds_read_b128 v[92:95], v230 offset:25472
    ds_read_b128 v[96:99], v230 offset:25536
    s_waitcnt lgkmcnt(7)
    v_mfma_f32_16x16x32_bf16 v[124:127], v[100:103], v[52:55], 0
    v_mfma_f32_16x16x32_bf16 v[128:131], v[100:103], v[56:59], 0
    s_waitcnt lgkmcnt(6)
    v_mfma_f32_16x16x32_bf16 v[124:127], v[104:107], v[60:63], v[124:127]
    v_mul_f32 v116, s68, v116
    v_mul_f32 v117, s68, v117
    v_mfma_f32_16x16x32_bf16 v[128:131], v[104:107], v[64:67], v[128:131]
    v_mul_f32 v118, s68, v118
    v_mul_f32 v119, s68, v119
    s_waitcnt lgkmcnt(5)
    v_mfma_f32_16x16x32_bf16 v[124:127], v[108:111], v[68:71], v[124:127]
    v_mul_f32 v120, s68, v120
    v_mul_f32 v121, s68, v121
    v_mfma_f32_16x16x32_bf16 v[128:131], v[108:111], v[72:75], v[128:131]
    v_mul_f32 v122, s68, v122
    v_mul_f32 v123, s68, v123
    s_waitcnt lgkmcnt(4)
    v_mfma_f32_16x16x32_bf16 v[124:127], v[112:115], v[76:79], v[124:127]
    v_cvt_pk_bf16_f32 v44, v116, v117
    v_cvt_pk_bf16_f32 v45, v118, v119
    v_mfma_f32_16x16x32_bf16 v[128:131], v[112:115], v[80:83], v[128:131]
    v_cvt_pk_bf16_f32 v46, v120, v121
    v_cvt_pk_bf16_f32 v47, v122, v123
    s_mov_b32 s3, 0
    buffer_store_dwordx4 v[44:47], v231, s[16:19], s3 offen sc0 sc1
    ds_read_b128 v[100:103], v230 offset:29952
    ds_read_b128 v[104:107], v230 offset:30016
    ds_read_b128 v[108:111], v230 offset:30080
    ds_read_b128 v[112:115], v230 offset:30144
    s_waitcnt lgkmcnt(7)
    v_mfma_f32_16x16x32_bf16 v[116:119], v[84:87], v[52:55], 0
    v_mfma_f32_16x16x32_bf16 v[120:123], v[84:87], v[56:59], 0
    s_waitcnt lgkmcnt(6)
    v_mfma_f32_16x16x32_bf16 v[116:119], v[88:91], v[60:63], v[116:119]
    v_mul_f32 v124, s68, v124
    v_mul_f32 v125, s68, v125
    v_mfma_f32_16x16x32_bf16 v[120:123], v[88:91], v[64:67], v[120:123]
    v_mul_f32 v126, s68, v126
    v_mul_f32 v127, s68, v127
    s_waitcnt lgkmcnt(5)
    v_mfma_f32_16x16x32_bf16 v[116:119], v[92:95], v[68:71], v[116:119]
    v_mul_f32 v128, s68, v128
    v_mul_f32 v129, s68, v129
    v_mfma_f32_16x16x32_bf16 v[120:123], v[92:95], v[72:75], v[120:123]
    v_mul_f32 v130, s68, v130
    v_mul_f32 v131, s68, v131
    s_waitcnt lgkmcnt(4)
    v_mfma_f32_16x16x32_bf16 v[116:119], v[96:99], v[76:79], v[116:119]
    v_cvt_pk_bf16_f32 v48, v124, v125
    v_cvt_pk_bf16_f32 v49, v126, v127
    v_mfma_f32_16x16x32_bf16 v[120:123], v[96:99], v[80:83], v[120:123]
    v_cvt_pk_bf16_f32 v50, v128, v129
    v_cvt_pk_bf16_f32 v51, v130, v131
    s_mov_b32 s3, 1048576
    buffer_store_dwordx4 v[48:51], v231, s[16:19], s3 offen sc0 sc1
    ds_read_b128 v[84:87], v230 offset:34560
    ds_read_b128 v[88:91], v230 offset:34624
    ds_read_b128 v[92:95], v230 offset:34688
    ds_read_b128 v[96:99], v230 offset:34752
    s_waitcnt lgkmcnt(7)
    v_mfma_f32_16x16x32_bf16 v[124:127], v[100:103], v[52:55], 0
    v_mfma_f32_16x16x32_bf16 v[128:131], v[100:103], v[56:59], 0
    s_waitcnt lgkmcnt(6)
    v_mfma_f32_16x16x32_bf16 v[124:127], v[104:107], v[60:63], v[124:127]
    v_mul_f32 v116, s68, v116
    v_mul_f32 v117, s68, v117
    v_mfma_f32_16x16x32_bf16 v[128:131], v[104:107], v[64:67], v[128:131]
    v_mul_f32 v118, s68, v118
    v_mul_f32 v119, s68, v119
    s_waitcnt lgkmcnt(5)
    v_mfma_f32_16x16x32_bf16 v[124:127], v[108:111], v[68:71], v[124:127]
    v_mul_f32 v120, s68, v120
    v_mul_f32 v121, s68, v121
    v_mfma_f32_16x16x32_bf16 v[128:131], v[108:111], v[72:75], v[128:131]
    v_mul_f32 v122, s68, v122
    v_mul_f32 v123, s68, v123
    s_waitcnt lgkmcnt(4)
    v_mfma_f32_16x16x32_bf16 v[124:127], v[112:115], v[76:79], v[124:127]
    v_cvt_pk_bf16_f32 v44, v116, v117
    v_cvt_pk_bf16_f32 v45, v118, v119
    v_mfma_f32_16x16x32_bf16 v[128:131], v[112:115], v[80:83], v[128:131]
    v_cvt_pk_bf16_f32 v46, v120, v121
    v_cvt_pk_bf16_f32 v47, v122, v123
    s_mov_b32 s3, 2097152
    buffer_store_dwordx4 v[44:47], v231, s[16:19], s3 offen sc0 sc1
    s_nop 3
    s_waitcnt lgkmcnt(3)
    v_mfma_f32_16x16x32_bf16 v[116:119], v[84:87], v[52:55], 0
    v_mfma_f32_16x16x32_bf16 v[120:123], v[84:87], v[56:59], 0
    s_waitcnt lgkmcnt(2)
    v_mfma_f32_16x16x32_bf16 v[116:119], v[88:91], v[60:63], v[116:119]
    v_mul_f32 v124, s68, v124
    v_mul_f32 v125, s68, v125
    v_mfma_f32_16x16x32_bf16 v[120:123], v[88:91], v[64:67], v[120:123]
    v_mul_f32 v126, s68, v126
    v_mul_f32 v127, s68, v127
    s_waitcnt lgkmcnt(1)
    v_mfma_f32_16x16x32_bf16 v[116:119], v[92:95], v[68:71], v[116:119]
    v_mul_f32 v128, s68, v128
    v_mul_f32 v129, s68, v129
    v_mfma_f32_16x16x32_bf16 v[120:123], v[92:95], v[72:75], v[120:123]
    v_mul_f32 v130, s68, v130
    v_mul_f32 v131, s68, v131
    s_waitcnt lgkmcnt(0)
    v_mfma_f32_16x16x32_bf16 v[116:119], v[96:99], v[76:79], v[116:119]
    v_cvt_pk_bf16_f32 v48, v124, v125
    v_cvt_pk_bf16_f32 v49, v126, v127
    v_mfma_f32_16x16x32_bf16 v[120:123], v[96:99], v[80:83], v[120:123]
    v_cvt_pk_bf16_f32 v50, v128, v129
    v_cvt_pk_bf16_f32 v51, v130, v131
    s_mov_b32 s3, 3145728
    buffer_store_dwordx4 v[48:51], v231, s[16:19], s3 offen sc0 sc1
    s_or_b32 s31, s2, s24
    s_cbranch_scc1 L_noep
    v_lshlrev_b32 v36, 2, v11
    v_mov_b32 v37, s26
    global_store_dword v36, v37, s[22:23] offset:0 sc0 sc1
L_noep:
    s_nop 3
    v_mul_f32 v116, s68, v116
    v_mul_f32 v117, s68, v117
    v_mul_f32 v118, s68, v118
    v_mul_f32 v119, s68, v119
    v_mul_f32 v120, s68, v120
    v_mul_f32 v121, s68, v121
    v_mul_f32 v122, s68, v122
    v_mul_f32 v123, s68, v123
    v_cvt_pk_bf16_f32 v44, v116, v117
    v_cvt_pk_bf16_f32 v45, v118, v119
    v_cvt_pk_bf16_f32 v46, v120, v121
    v_cvt_pk_bf16_f32 v47, v122, v123
    s_mov_b32 s3, 4194304
    buffer_store_dwordx4 v[44:47], v231, s[16:19], s3 offen sc0 sc1
L_end:
    s_endpgm
.section .rodata,"a"
.p2align 6
.amdhsa_kernel standalone__tensor_product_equiv_tfn__graph_kernel
  .amdhsa_next_free_vgpr 233
  .amdhsa_next_free_sgpr 102
  .amdhsa_accum_offset 236
  .amdhsa_group_segment_fixed_size 0
  .amdhsa_kernarg_size 88
  .amdhsa_user_sgpr_count 2
  .amdhsa_user_sgpr_kernarg_segment_ptr 1
  .amdhsa_system_sgpr_workgroup_id_x 1
  .amdhsa_float_denorm_mode_32 3
.end_amdhsa_kernel
```

```asm
; @launch grid=(256,1,1) block=(512,1,1) lds=163584
.amdgcn_target "amdgcn-amd-amdhsa--gfx950"
.text
.globl standalone__tensor_product_equiv_tfn__graph_kernel
.p2align 8
.type standalone__tensor_product_equiv_tfn__graph_kernel,@function
standalone__tensor_product_equiv_tfn__graph_kernel:
    s_load_dwordx16 s[4:19], s[0:1], 0
    s_load_dwordx2 s[22:23], s[0:1], 80
    s_load_dwordx2 s[20:21], s[0:1], 64
    s_cmp_ge_u32 s2, 256
    s_cbranch_scc1 L_end
    v_mul_u32_u24 v172, 3, v0
    s_mul_i32 s3, s2, 1250
    v_min_u32 v172, 1247, v172
    v_add_lshl_u32 v173, v172, s3, 2
    v_lshrrev_b32 v12, 6, v0
    v_and_b32 v13, 255, v0
    v_lshlrev_b32 v13, 2, v13
    v_mov_b32 v16, 0
    v_readfirstlane_b32 s24, v12
    ds_write_b32 v13, v16 offset:0
    v_lshlrev_b32 v174, 1, v173
    s_waitcnt lgkmcnt(0)
    global_load_dwordx3 v[132:134], v173, s[8:9]
    s_load_dword s26, s[22:23], 0
    s_barrier
    global_load_dwordx3 v[136:138], v173, s[6:7]
    global_load_dwordx4 v[140:143], v174, s[10:11]
    global_load_dwordx2 v[144:145], v174, s[10:11] offset:16
    v_lshlrev_b32 v188, 4, v0
    v_and_b32 v11, 63, v0
    s_lshl_b32 s30, s24, 10
    s_lshl_b32 s3, s3, 5
    s_add_u32 s12, s12, s3
    s_addc_u32 s13, s13, 0
    v_add_u32 v189, 8192, v188
    v_add_u32 v190, 16384, v188
    v_add_u32 v191, 24576, v188
    v_add_u32 v192, 32768, v188
    v_add_u32 v193, 40960, v188
    v_min_u32 v175, 39984, v192
    v_lshlrev_b32 v1, 4, v11
    s_barrier
    s_add_u32 m0, s30, 112384
    s_nop 0
    global_load_lds_dwordx4 v188, s[12:13]
    s_add_u32 m0, s30, 120576
    s_nop 0
    global_load_lds_dwordx4 v189, s[12:13]
    s_cmp_eq_u32 s24, 7
    s_cbranch_scc0 L_nocpf
    s_cmp_lt_u32 s2, 8
    s_cbranch_scc0 L_nocpf
    s_getpc_b64 s[68:69]
L_pc:
    v_and_b32 v18, 63, v0
    v_lshlrev_b32 v18, 7, v18
    v_mov_b32 v19, 0
    v_lshl_add_u64 v[20:21], v[18:19], 0, s[68:69]
    global_load_dword v204, v[20:21], off
    v_min_u32 v18, L_end-L_pc-8192, v18
    v_add_u32 v18, 8192, v18
    v_lshl_add_u64 v[20:21], v[18:19], 0, s[68:69]
    global_load_dword v205, v[20:21], off
L_nocpf:
    v_lshlrev_b32 v194, 2, v0
    v_lshlrev_b32 v14, 3, v0
    v_mov_b32 v16, 0
    v_mov_b32 v17, 0
    v_mov_b32 v15, 0x00300000
    ds_write_b64 v14, v[16:17] offset:16128
    ds_write_b32 v194, v15 offset:20224
    ds_write_b32 v194, v15 offset:22272
    ds_write_b32 v194, v15 offset:24320
    v_lshrrev_b32 v195, 1, v0
    v_lshlrev_b32 v195, 2, v195
    v_cmp_gt_u32 vcc, 416, v0
    s_mov_b64 s[36:37], vcc
    v_cmp_gt_u32 vcc, 417, v0
    s_mov_b64 s[38:39], vcc
    v_mov_b32 v12, 1
    s_movk_i32 s40, 1250
    s_mov_b32 s41, 63232
    s_lshr_b32 s27, s24, 2
    s_mov_b32 s28, 0
    s_waitcnt vmcnt(5)
    s_mov_b64 exec, s[38:39]
    v_and_b32 v153, 7, v133
    v_bfe_u32 v161, v133, 3, 5
    v_lshl_add_u32 v147, v153, 5, v161
    v_lshlrev_b32 v147, 2, v147
    ds_add_rtn_u32 v150, v147, v12 offset:0
    v_and_b32 v154, 7, v134
    v_bfe_u32 v162, v134, 3, 5
    v_lshl_add_u32 v148, v154, 5, v162
    v_lshlrev_b32 v148, 2, v148
    ds_add_rtn_u32 v151, v148, v12 offset:0
    s_mov_b64 exec, s[36:37]
    v_and_b32 v152, 7, v132
    v_bfe_u32 v160, v132, 3, 5
    v_lshl_add_u32 v146, v152, 5, v160
    v_lshlrev_b32 v146, 2, v146
    ds_add_rtn_u32 v149, v146, v12 offset:0
    s_mov_b64 exec, -1
    s_add_u32 m0, s30, 128768
    s_nop 0
    global_load_lds_dwordx4 v190, s[12:13]
    s_add_u32 m0, s30, 136960
    s_nop 0
    global_load_lds_dwordx4 v191, s[12:13]
    s_add_u32 m0, s30, 145152
    s_nop 0
    global_load_lds_dwordx4 v175, s[12:13]
    s_waitcnt lgkmcnt(0)
    s_barrier
    ds_read_b128 v[164:167], v1 offset:0
    s_mul_i32 s3, s2, 1280
    s_add_u32 s26, s26, 1
    s_waitcnt lgkmcnt(0)
    v_add_u32 v180, v164, v165
    v_add3_u32 v180, v180, v166, v167
    v_mov_b32 v181, v180
    v_lshrrev_b32 v132, 8, v132
    v_lshlrev_b32 v156, 26, v132
    v_add_u32_dpp v181, v181, v181 row_shr:1 row_mask:0xf bank_mask:0xf
    v_lshl_add_u32 v132, v132, 4, v156
    v_add_lshl_u32 v177, v172, 0, 5
    v_add_u32_dpp v181, v181, v181 row_shr:2 row_mask:0xf bank_mask:0xf
    v_lshrrev_b32 v133, 8, v133
    v_lshlrev_b32 v157, 26, v133
    v_add_u32_dpp v181, v181, v181 row_shr:4 row_mask:0xf bank_mask:0xf
    v_lshl_add_u32 v133, v133, 4, v157
    v_add_lshl_u32 v178, v172, 1, 5
    v_add_u32_dpp v181, v181, v181 row_shr:8 row_mask:0xf bank_mask:0xf
    v_lshrrev_b32 v134, 8, v134
    v_lshlrev_b32 v158, 26, v134
    v_add_u32_dpp v181, v181, v181 row_bcast:15 row_mask:0xa bank_mask:0xf
    v_lshl_add_u32 v134, v134, 4, v158
    v_add_lshl_u32 v179, v172, 2, 5
    v_add_u32_dpp v181, v181, v181 row_bcast:31 row_mask:0xc bank_mask:0xf
    v_sub_u32 v168, v181, v180
    v_add_u32 v169, v168, v164
    v_add_u32 v170, v169, v165
    v_add_u32 v171, v170, v166
    ds_write_b128 v1, v[168:171] offset:1024
    s_mov_b64 exec, s[38:39]
    ds_read_b32 v147, v147 offset:1024
    ds_read_b32 v148, v148 offset:1024
    s_mov_b64 exec, s[36:37]
    ds_read_b32 v146, v146 offset:1024
    s_mov_b64 exec, -1
    s_waitcnt vmcnt(5)
    v_mad_u32_u24 v152, v152, s40, v136
    v_lshl_add_u32 v132, v136, 10, v132
    v_subrev_u32 v156, 10000, v152
    v_min_u32 v152, v152, v156
    v_add_u32 v152, 350, v152
    v_mul_u32_u24 v152, 151, v152
    v_lshrrev_b32 v152, 17, v152
    v_add_u32 v152, v152, v132
    v_mad_u32_u24 v153, v153, s40, v137
    v_lshl_add_u32 v133, v137, 10, v133
    v_subrev_u32 v157, 10000, v153
    v_min_u32 v153, v153, v157
    v_add_u32 v153, 350, v153
    v_mul_u32_u24 v153, 151, v153
    v_lshrrev_b32 v153, 17, v153
    v_add_u32 v153, v153, v133
    v_mad_u32_u24 v154, v154, s40, v138
    v_lshl_add_u32 v134, v138, 10, v134
    v_subrev_u32 v158, 10000, v154
    v_min_u32 v154, v154, v158
    v_add_u32 v154, 350, v154
    v_mul_u32_u24 v154, 151, v154
    v_lshrrev_b32 v154, 17, v154
    v_add_u32 v154, v154, v134
    s_mov_b64 exec, s[38:39]
    s_waitcnt lgkmcnt(0)
    v_add_lshl_u32 v147, v147, v150, 1
    v_mad_u32_u24 v183, v147, 6, s41
    ds_write_b16 v147, v178 offset:2048
    ds_write2_b32 v183, v142, v143 offset1:1
    ds_write_b32 v183, v153 offset:8
    v_add_lshl_u32 v148, v148, v151, 1
    v_mad_u32_u24 v184, v148, 6, s41
    ds_write_b16 v148, v179 offset:2048
    ds_write2_b32 v184, v144, v145 offset1:1
    ds_write_b32 v184, v154 offset:8
    s_mov_b64 exec, s[36:37]
    v_add_lshl_u32 v146, v146, v149, 1
    v_mad_u32_u24 v182, v146, 6, s41
    ds_write_b16 v146, v177 offset:2048
    ds_write2_b32 v182, v140, v141 offset1:1
    ds_write_b32 v182, v152 offset:8
    s_mov_b64 exec, -1
    s_add_u32 m0, s30, 26368
    s_nop 0
    global_load_lds_dwordx4 v188, s[18:19]
    s_add_u32 m0, s30, 34560
    s_nop 0
    global_load_lds_dwordx4 v189, s[18:19]
    s_add_u32 m0, s30, 42752
    s_nop 0
    global_load_lds_dwordx4 v190, s[18:19]
    s_add_u32 m0, s30, 50944
    s_nop 0
    global_load_lds_dwordx4 v191, s[18:19]
    s_add_u32 s70, s30, 59136
    v_min_u32 v185, 112, v1
    s_cmp_lt_u32 s24, 4
    s_cselect_b64 vcc, -1, 0
    s_cselect_b32 m0, s70, 162560
    s_cselect_b64 s[68:69], s[14:15], s[16:17]
    v_cndmask_b32 v185, v185, v188, vcc
    global_load_lds_dwordx4 v185, s[68:69]
    v_add_u32 v168, s3, v168
    v_lshl_add_u32 v196, v164, 19, v168
    v_mov_b32 v197, s26
    v_add_u32 v169, s3, v169
    v_lshl_add_u32 v198, v165, 19, v169
    v_mov_b32 v199, s26
    v_add_u32 v170, s3, v170
    v_lshl_add_u32 v200, v166, 19, v170
    v_mov_b32 v201, s26
    v_add_u32 v171, s3, v171
    v_lshl_add_u32 v202, v167, 19, v171
    v_mov_b32 v203, s26
    s_lshl_b32 s31, s2, 11
    s_add_u32 s31, s31, 4096
    v_add_u32 v186, s31, v1
    s_mul_i32 s31, s3, 12
    s_add_u32 s31, s31, 1048576
    s_add_u32 s48, s22, s31
    s_addc_u32 s49, s23, 0
    s_mov_b32 s50, 15104
    s_mov_b32 s51, 0x00020000
    s_lshl_b32 s3, s3, 5
    s_add_u32 s31, s3, 8388608
    s_add_u32 s52, s22, s31
    s_addc_u32 s53, s23, 0
    s_mov_b32 s54, 40064
    s_mov_b32 s55, 0x00020000
    v_and_b32 v172, -2, v0
    v_and_b32 v173, 16, v188
    v_add_u32 v173, 112384, v173
    s_waitcnt lgkmcnt(0)
    s_barrier
    ds_read_b128 v[132:135], v188 offset:63232
    ds_read_b128 v[136:139], v189 offset:63232
    ds_read_u16 v174, v172 offset:2048
    ds_read_u16 v175, v172 offset:2560
    ds_read_u16 v176, v172 offset:3072
    ds_read_u16 v177, v172 offset:3584
    ds_read_u16 v178, v172 offset:4096
    s_cmp_eq_u32 s24, 7
    s_cbranch_scc0 L_nopub
    global_store_dwordx4 v186, v[196:199], s[22:23] sc0 sc1
    global_store_dwordx4 v186, v[200:203], s[22:23] offset:1024 sc0 sc1
L_nopub:
    s_mul_i32 s3, s2, 32
    s_add_u32 s3, s3, 589824
    v_lshl_add_u32 v186, v11, 2, s3
    s_waitcnt lgkmcnt(6)
    buffer_store_dwordx4 v[132:135], v188, s[48:51], 0 offen sc0 sc1
    s_waitcnt lgkmcnt(5)
    buffer_store_dwordx4 v[136:139], v189, s[48:51], 0 offen sc0 sc1
    s_waitcnt lgkmcnt(0)
    v_add_u32 v174, v174, v173
    v_add_u32 v175, v175, v173
    v_add_u32 v176, v176, v173
    v_add_u32 v177, v177, v173
    v_min_u32 v178, 39968, v178
    v_and_b32 v178, -16, v178
    v_add_u32 v178, v178, v173
    v_mov_b64 v[84:85], 0
    v_mov_b64 v[86:87], 0
    v_mov_b64 v[88:89], 0
    v_mov_b64 v[90:91], 0
    v_mov_b64 v[92:93], 0
    v_mov_b64 v[94:95], 0
    v_mov_b64 v[96:97], 0
    v_mov_b64 v[98:99], 0
    v_mov_b64 v[100:101], 0
    v_mov_b64 v[102:103], 0
    v_mov_b64 v[104:105], 0
    v_mov_b64 v[106:107], 0
    v_mov_b64 v[108:109], 0
    v_mov_b64 v[110:111], 0
    v_mov_b64 v[112:113], 0
    v_mov_b64 v[114:115], 0
    v_mov_b64 v[116:117], 0
    v_mov_b64 v[118:119], 0
    v_mov_b64 v[120:121], 0
    v_mov_b64 v[122:123], 0
    v_mov_b64 v[124:125], 0
    v_mov_b64 v[126:127], 0
    v_mov_b64 v[128:129], 0
    v_mov_b64 v[130:131], 0
    v_mov_b64 v[24:25], 0
    v_mov_b64 v[26:27], 0
    v_mov_b64 v[28:29], 0
    v_mov_b64 v[30:31], 0
    s_mov_b32 s32, 0x0f0f0f0f
    s_mov_b32 s33, s32
    s_not_b64 s[34:35], s[32:33]
    v_lshrrev_b32 v2, 5, v11
    v_lshlrev_b32 v2, 4, v2
    v_and_b32 v3, 3, v11
    v_lshlrev_b32 v3, 3, v3
    v_add_u32 v3, 112384, v3
    s_sub_u32 s4, s4, 512
    s_subb_u32 s5, s5, 0
    s_mov_b32 s6, 10240512
    s_mov_b32 s7, 0x00020000
    s_add_u32 s8, s22, 1048576
    s_addc_u32 s9, s23, 0
    s_mov_b32 s10, 3932160
    s_mov_b32 s11, 0x00020000
    s_mov_b32 s101, 0
    s_cmp_lt_u32 s2, 16
    s_cbranch_scc1 L_r40
    s_cmp_eq_u32 s24, 0
    s_cselect_b32 s101, 0x245d2388, s101
    s_cmp_eq_u32 s24, 1
    s_cselect_b32 s101, 0x25753343, s101
    s_cmp_eq_u32 s24, 2
    s_cselect_b32 s101, 0x27449100, s101
    s_cmp_eq_u32 s24, 3
    s_cselect_b32 s101, 0x267d5301, s101
    s_cmp_eq_u32 s24, 4
    s_cselect_b32 s101, 0x2179a402, s101
    s_cmp_eq_u32 s24, 5
    s_cselect_b32 s101, 0x227162c6, s101
    s_cmp_eq_u32 s24, 6
    s_cselect_b32 s101, 0x206543c7, s101
    s_cmp_eq_u32 s24, 7
    s_cselect_b32 s101, 0x236d8285, s101
    s_branch L_rd
L_r40:
    s_cmp_eq_u32 s24, 0
    s_cselect_b32 s101, 0x2271a3c1, s101
    s_cmp_eq_u32 s24, 1
    s_cselect_b32 s101, 0x20750307, s101
    s_cmp_eq_u32 s24, 2
    s_cselect_b32 s101, 0x236d5205, s101
    s_cmp_eq_u32 s24, 3
    s_cselect_b32 s101, 0x27797340, s101
    s_cmp_eq_u32 s24, 4
    s_cselect_b32 s101, 0x256112c4, s101
    s_cmp_eq_u32 s24, 5
    s_cselect_b32 s101, 0x26653243, s101
    s_cmp_eq_u32 s24, 6
    s_cselect_b32 s101, 0x217d4382, s101
    s_cmp_eq_u32 s24, 7
    s_cselect_b32 s101, 0x24592286, s101
L_rd:
    s_and_b32 s3, s2, 7
    s_lshl_b32 s3, s3, 7
    s_bfe_u32 s31, s2, 196613
    s_lshl_b32 s31, s31, 4
    s_add_u32 s3, s3, s31
    s_and_b32 s31, s2, 8
    s_add_u32 s3, s3, s31
    s_and_b32 s31, s2, 16
    s_lshl_b32 s31, s31, 6
    s_add_u32 s3, s3, s31
    s_add_u32 s3, s3, 4096
    v_and_b32 v234, 255, v0
    v_lshl_add_u32 v187, v234, 11, s3
    v_mul_u32_u24 v234, 32, v234
    v_add_u32 v234, 589824, v234
    s_waitcnt vmcnt(7)
    s_barrier
    ds_read_b128 v[144:147], v174
    ds_read_b128 v[148:151], v175
    ds_read_b128 v[152:155], v176
    ds_read_b128 v[156:159], v177
    ds_read_b128 v[160:163], v178
    s_waitcnt lgkmcnt(4)
    buffer_store_dwordx4 v[144:147], v188, s[52:55], 0 offen sc0 sc1
    s_waitcnt lgkmcnt(3)
    buffer_store_dwordx4 v[148:151], v189, s[52:55], 0 offen sc0 sc1
    s_waitcnt lgkmcnt(2)
    buffer_store_dwordx4 v[152:155], v190, s[52:55], 0 offen sc0 sc1
    s_waitcnt lgkmcnt(1)
    buffer_store_dwordx4 v[156:159], v191, s[52:55], 0 offen sc0 sc1
    s_waitcnt lgkmcnt(0)
    buffer_store_dwordx4 v[160:163], v192, s[52:55], 0 offen sc0 sc1
    s_add_u32 s12, s22, 8388608
    s_addc_u32 s13, s23, 0
    s_mov_b32 s14, 10485760
    s_mov_b32 s15, 0x00020000
    s_mov_b32 s16, s20
    s_mov_b32 s17, s21
    s_mov_b32 s18, 10240000
    s_mov_b32 s19, 0x00020000
    s_waitcnt vmcnt(0)
    s_barrier
    s_cmp_eq_u32 s24, 0
    s_cbranch_scc0 L_noflag
    s_mov_b64 exec, 0xff
    global_store_dword v186, v197, s[22:23] sc0 sc1
    s_mov_b64 exec, -1
L_noflag:
    s_barrier
    s_cmp_eq_u32 s27, 0
    s_cbranch_scc0 L_np0
    global_load_dwordx2 v[206:207], v187, s[22:23] sc1
L_np0:
    s_cmp_eq_u32 s27, 0
    s_cbranch_scc1 L_pfa
    s_sub_u32 s3, 0, s2
    s_and_b32 s3, s3, 7
    s_mul_i32 s3, s3, 1280000
    s_lshr_b32 s31, s2, 3
    s_mul_i32 s31, s31, 16640
    s_add_u32 s3, s3, s31
    s_add_u32 s3, s3, 512
    v_and_b32 v208, 255, v0
    v_cmp_gt_u32 vcc, 130, v208
    v_lshlrev_b32 v208, 7, v208
    v_mov_b32 v209, 0x7fffff00
    v_cndmask_b32 v208, v209, v208, vcc
    buffer_load_dword v210, v208, s[4:7], s3 offen
L_pfa:
    v_lshrrev_b32 v12, 5, v11
    v_and_b32 v13, 31, v11
    v_lshlrev_b32 v13, 2, v13
    v_lshl_add_u32 v12, v12, 11, v13
    s_and_b32 s3, s24, 3
    s_lshl_b32 s31, s3, 9
    s_lshl_b32 s68, s27, 7
    s_add_u32 s31, s31, s68
    v_add_u32 v12, s31, v12
    ds_read_b32 v132, v12 offset:59136
    ds_read_b32 v133, v12 offset:59392
    s_lshl_b32 s3, s3, 2
    s_lshl_b32 s31, s27, 10
    s_add_u32 s3, s3, s31
    v_add_u32 v16, s3, v1
    v_and_b32 v14, 3, v11
    v_bfe_u32 v15, v11, 2, 2
    v_lshlrev_b32 v15, 1, v15
    v_lshl_add_u32 v14, v14, 5, v15
    v_add_u32 v14, 162560, v14
    s_mov_b32 s68, 0xbfb8aa3b
    s_mov_b32 s69, s68
    ds_read_u16 v18, v14 offset:0
    ds_read_u16 v19, v14 offset:8
    ds_read_u16 v20, v14 offset:16
    ds_read_u16 v21, v14 offset:24
    s_waitcnt lgkmcnt(4)
    v_lshlrev_b32 v22, 16, v132
    v_lshlrev_b32 v23, 16, v133
    v_and_b32 v132, 0xffff0000, v132
    v_and_b32 v133, 0xffff0000, v133
    v_pk_mul_f32 v[22:23], v[22:23], s[68:69]
    v_pk_mul_f32 v[132:133], v[132:133], s[68:69]
    v_cvt_pk_bf16_f32 v134, v22, v23
    v_cvt_pk_bf16_f32 v135, v132, v133
    ds_write_b32 v16, v134 offset:8192
    ds_write_b32 v16, v135 offset:10240
    s_waitcnt lgkmcnt(0)
    v_lshl_or_b32 v228, v19, 16, v18
    v_lshl_or_b32 v229, v21, 16, v20
    s_mov_b32 s70, 0x05040100
    s_mov_b32 s71, 0x07060302
    s_and_b32 s3, s24, 3
    s_lshl_b32 s3, s3, 6
    v_lshrrev_b32 v16, 4, v11
    v_and_b32 v17, 15, v11
    v_lshl_add_u32 v17, v17, 2, s3
    v_lshl_add_u32 v16, v16, 11, v17
    ds_read_b32 v148, v16 offset:26368
    ds_read_b32 v149, v16 offset:26624
    ds_read_b32 v150, v16 offset:26880
    ds_read_b32 v151, v16 offset:27136
    ds_read_b32 v152, v16 offset:27392
    ds_read_b32 v153, v16 offset:27648
    ds_read_b32 v154, v16 offset:27904
    ds_read_b32 v155, v16 offset:28160
    s_waitcnt lgkmcnt(7)
    ds_read_b32 v156, v16 offset:34560
    ds_read_b32 v157, v16 offset:34816
    ds_read_b32 v158, v16 offset:35072
    ds_read_b32 v159, v16 offset:35328
    ds_read_b32 v160, v16 offset:35584
    ds_read_b32 v161, v16 offset:35840
    ds_read_b32 v162, v16 offset:36096
    ds_read_b32 v163, v16 offset:36352
    s_waitcnt lgkmcnt(8)
    v_perm_b32 v52, v149, v148, s70
    v_perm_b32 v56, v149, v148, s71
    v_perm_b32 v53, v151, v150, s70
    v_perm_b32 v57, v151, v150, s71
    v_perm_b32 v54, v153, v152, s70
    v_perm_b32 v58, v153, v152, s71
    v_perm_b32 v55, v155, v154, s70
    v_perm_b32 v59, v155, v154, s71
    s_waitcnt lgkmcnt(7)
    ds_read_b32 v148, v16 offset:42752
    ds_read_b32 v149, v16 offset:43008
    ds_read_b32 v150, v16 offset:43264
    ds_read_b32 v151, v16 offset:43520
    ds_read_b32 v152, v16 offset:43776
    ds_read_b32 v153, v16 offset:44032
    ds_read_b32 v154, v16 offset:44288
    ds_read_b32 v155, v16 offset:44544
    s_waitcnt lgkmcnt(8)
    v_perm_b32 v60, v157, v156, s70
    v_perm_b32 v64, v157, v156, s71
    v_perm_b32 v61, v159, v158, s70
    v_perm_b32 v65, v159, v158, s71
    v_perm_b32 v62, v161, v160, s70
    v_perm_b32 v66, v161, v160, s71
    v_perm_b32 v63, v163, v162, s70
    v_perm_b32 v67, v163, v162, s71
    s_waitcnt lgkmcnt(7)
    ds_read_b32 v156, v16 offset:50944
    ds_read_b32 v157, v16 offset:51200
    ds_read_b32 v158, v16 offset:51456
    ds_read_b32 v159, v16 offset:51712
    ds_read_b32 v160, v16 offset:51968
    ds_read_b32 v161, v16 offset:52224
    ds_read_b32 v162, v16 offset:52480
    ds_read_b32 v163, v16 offset:52736
    s_waitcnt lgkmcnt(8)
    v_perm_b32 v68, v149, v148, s70
    v_perm_b32 v72, v149, v148, s71
    v_perm_b32 v69, v151, v150, s70
    v_perm_b32 v73, v151, v150, s71
    v_perm_b32 v70, v153, v152, s70
    v_perm_b32 v74, v153, v152, s71
    v_perm_b32 v71, v155, v154, s70
    v_perm_b32 v75, v155, v154, s71
    s_waitcnt lgkmcnt(0)
    v_perm_b32 v76, v157, v156, s70
    v_perm_b32 v80, v157, v156, s71
    v_perm_b32 v77, v159, v158, s70
    v_perm_b32 v81, v159, v158, s71
    v_perm_b32 v78, v161, v160, s70
    v_perm_b32 v82, v161, v160, s71
    v_perm_b32 v79, v163, v162, s70
    v_perm_b32 v83, v163, v162, s71
    s_cmp_eq_u32 s27, 0
    s_cbranch_scc0 L_round
    s_mov_b32 s3, 0
    s_branch L_poll1
L_poll:
    global_load_dwordx2 v[206:207], v187, s[22:23] sc1
L_poll1:
    s_add_u32 s3, s3, 1
    s_waitcnt vmcnt(0)
    v_cmpx_ne_u32 vcc, s26, v207
    s_cbranch_execz L_pok
    s_cmp_lt_u32 s3, 4000000
    s_cbranch_scc1 L_poll
    v_mov_b32 v206, 0
L_pok:
    s_mov_b64 exec, -1
    v_add_u32 v14, 161536, v194
    ds_write_b32 v14, v206
L_round:
    v_add_u32 v15, 161536, v1
    s_and_b32 s31, s24, 3
    v_mov_b32 v148, 0
    s_waitcnt lgkmcnt(0)
    s_barrier
    ds_read_b128 v[140:143], v15
    s_cmp_lg_u32 s28, 0
    s_cbranch_scc1 L_npe
    s_cmp_eq_u32 s27, 0
    s_cbranch_scc1 L_npe
    global_load_dword v206, v234, s[22:23] sc1
L_npe:
    v_mul_u32_u24 v135, 12, v0
    v_add_u32 v136, 6144, v135
    v_add_u32 v137, 12288, v135
    s_waitcnt lgkmcnt(0)
    v_lshrrev_b32 v144, 19, v140
    v_lshrrev_b32 v145, 19, v141
    v_lshrrev_b32 v146, 19, v142
    v_lshrrev_b32 v147, 19, v143
    v_add_u32 v150, v144, v145
    v_add3_u32 v12, v150, v146, v147
    v_add_u32 v13, s28, v12
    v_mov_b32 v149, v144
    v_add_u32_dpp v12, v12, v12 row_shr:1 row_mask:0xf bank_mask:0xf
    v_add_u32 v151, v150, v146
    s_set_gpr_idx_on s31, gpr_idx(SRC0)
    v_mov_b32 v14, v140
    v_mov_b32 v15, v144
    v_mov_b32 v16, v148
    s_set_gpr_idx_off
    v_add_u32_dpp v12, v12, v12 row_shr:2 row_mask:0xf bank_mask:0xf
    v_and_b32 v14, 0x7ffff, v14
    v_sub_u32 v16, v16, v13
    v_add_u32_dpp v12, v12, v12 row_shr:4 row_mask:0xf bank_mask:0xf
    v_subrev_u32 v17, s27, v15
    s_mov_b32 s31, s27
    v_add_u32_dpp v12, v12, v12 row_shr:8 row_mask:0xf bank_mask:0xf
    s_nop 1
    v_add_u32_dpp v12, v12, v12 row_bcast:15 row_mask:0xa bank_mask:0xf
    s_nop 1
    v_add_u32_dpp v12, v12, v12 row_bcast:31 row_mask:0xc bank_mask:0xf
    v_add_u32 v16, v16, v12
    v_readlane_b32 s25, v12, 63
    v_sub_u32 v14, v14, v16
    v_add_lshl_u32 v18, v16, s27, 2
    s_cmp_gt_u32 s25, 1536
    s_cbranch_scc1 L_exp
    v_cmpx_lt_i32 vcc, 0, v17
    ds_write_b32 v18, v14 offset:20224
    v_cmpx_lt_i32 vcc, 2, v17
    ds_write_b32 v18, v14 offset:20232
    v_cmpx_lt_i32 vcc, 4, v17
    ds_write_b32 v18, v14 offset:20240
    v_cmpx_lt_i32 vcc, 6, v17
    ds_write_b32 v18, v14 offset:20248
    v_cmpx_lt_i32 vcc, 8, v17
    ds_write_b32 v18, v14 offset:20256
    v_cmpx_lt_i32 vcc, 10, v17
    ds_write_b32 v18, v14 offset:20264
    v_cmpx_lt_i32 vcc, 12, v17
    s_cbranch_execz L_expd
    s_add_u32 s31, s31, 12
L_exp:
    s_mov_b64 exec, -1
    v_cmp_lt_u32 vcc, s31, v15
    s_cbranch_vccz L_expd
    v_add_u32 v19, s31, v16
    s_movk_i32 s3, 1536
    v_cmp_gt_u32 s[68:69], s3, v19
    v_lshlrev_b32 v19, 2, v19
    s_and_b64 exec, vcc, s[68:69]
    ds_write_b32 v19, v14 offset:20224
    s_add_u32 s31, s31, 2
    s_branch L_exp
L_expd:
    s_mov_b64 exec, -1
    s_cmp_eq_u32 s27, 0
    s_cbranch_scc1 L_fok
    s_cmp_lg_u32 s28, 0
    s_cbranch_scc1 L_fok
    s_mov_b32 s3, 0
    s_waitcnt vmcnt(0)
    s_branch L_fp1
L_fp:
    global_load_dword v206, v234, s[22:23] sc1
    s_add_u32 s3, s3, 1
    s_waitcnt vmcnt(0)
L_fp1:
    v_cmpx_ne_u32 vcc, s26, v206
    s_cbranch_execz L_fok
    s_cmp_lt_u32 s3, 4000000
    s_cbranch_scc1 L_fp
    s_branch L_giveup
L_fok:
    s_mov_b64 exec, -1
    s_waitcnt lgkmcnt(0)
    s_barrier
    ds_read_b32 v132, v194 offset:20224
    ds_read_b32 v133, v194 offset:22272
    ds_read_b32 v134, v194 offset:24320
    ds_read_b32 v152, v195 offset:20224
    ds_read_b32 v153, v195 offset:21248
    ds_read_b32 v154, v195 offset:22272
    ds_read_b32 v155, v195 offset:23296
    ds_read_b32 v156, v195 offset:24320
    ds_read_b32 v157, v195 offset:25344
    s_waitcnt lgkmcnt(8)
    v_mad_i32_i24 v132, v132, 12, v135
    buffer_load_dwordx3 v[140:142], v132, s[8:11], 0 offen sc1
    s_waitcnt lgkmcnt(7)
    v_mad_i32_i24 v133, v133, 12, v136
    buffer_load_dwordx3 v[144:146], v133, s[8:11], 0 offen sc1
    s_waitcnt lgkmcnt(6)
    v_mad_i32_i24 v134, v134, 12, v137
    buffer_load_dwordx3 v[148:150], v134, s[8:11], 0 offen sc1
    s_waitcnt lgkmcnt(0)
    v_lshl_add_u32 v152, v152, 5, v188
    v_lshl_add_u32 v153, v153, 5, v189
    v_lshl_add_u32 v154, v154, 5, v190
    v_lshl_add_u32 v155, v155, 5, v191
    v_lshl_add_u32 v156, v156, 5, v192
    v_lshl_add_u32 v157, v157, 5, v193
    s_barrier
    s_add_u32 m0, s30, 63232
    s_nop 0
    buffer_load_dwordx4 v152, s[12:15], 0 offen sc1 lds
    s_sub_u32 s29, s25, s28
    s_min_u32 s29, s29, 1536
    s_lshl_b32 s3, s29, 4
    v_cmp_gt_u32 s[56:57], s3, v188
    v_lshlrev_b32 v159, 1, v188
    v_mov_b32 v143, 0
    v_cmp_gt_u32 s[58:59], s3, v189
    v_lshlrev_b32 v161, 1, v189
    v_mov_b32 v147, 0
    v_cmp_gt_u32 s[60:61], s3, v190
    v_lshlrev_b32 v163, 1, v190
    v_mov_b32 v151, 0
    v_and_b32 v4, 15, v11
    v_lshrrev_b32 v13, 4, v11
    s_mul_i32 s3, s27, 23040
    v_mul_u32_u24 v232, 288, v4
    v_lshl_add_u32 v232, v13, 4, v232
    v_add_u32 v232, s3, v232
    s_mul_i32 s68, s27, 5120
    s_add_u32 s68, s68, s2
    s_lshl_b32 s68, s68, 10
    s_and_b32 s3, s24, 3
    s_lshl_b32 s3, s3, 8
    s_add_u32 s68, s68, s3
    v_lshl_add_u32 v233, v13, 18, s68
    v_lshl_add_u32 v233, v4, 4, v233
    v_lshlrev_b32 v4, 3, v4
    v_bfe_u32 v5, v11, 3, 2
    v_and_b32 v12, 3, v11
    v_lshl_add_u32 v5, v5, 2, v12
    v_lshlrev_b32 v5, 3, v5
    v_lshrrev_b32 v6, 2, v11
    v_lshlrev_b32 v6, 3, v6
    v_mul_u32_u24 v16, 52, v11
    v_lshrrev_b32 v16, 8, v16
    v_mul_u32_u24 v17, 5, v16
    v_sub_u32 v17, v11, v17
    v_mul_u32_u24 v15, 6, v17
    v_bfe_u32 v15, s101, v15, 6
    v_lshlrev_b32 v15, 2, v15
    v_lshlrev_b32 v16, 2, v16
    v_lshlrev_b32 v17, 19, v17
    v_add_u32 v17, 33554432, v17
    s_mul_i32 s3, s24, 5
    v_lshlrev_b32 v18, 2, v11
    v_add_u32 v21, s3, v11
    v_lshlrev_b32 v19, 2, v21
    v_cmp_gt_u32 vcc, 40, v11
    v_add_u32 v20, 1, v11
    v_add_u32 v21, 1, v21
    v_cndmask_b32 v20, 0, v20, vcc
    s_cmp_gt_u32 s25, 1536
    s_cselect_b32 s69, 0, 8
    v_mov_b32 v22, 8
    s_cmp_lg_u32 s28, 0
    s_cbranch_scc1 L_nofr
    ds_read_b128 v[36:39], v1 offset:8192
    ds_read_b128 v[40:43], v1 offset:9216
    ds_read_b128 v[44:47], v1 offset:10240
    ds_read_b128 v[48:51], v1 offset:11264
L_nofr:
    s_waitcnt vmcnt(3)
    s_mov_b64 exec, s[56:57]
    v_and_b32 v143, 0x3ff, v142
    v_lshrrev_b32 v12, 24, v142
    v_lshlrev_b32 v143, 2, v143
    ds_add_u32 v12, v22 offset:18688
    ds_add_rtn_u32 v132, v143, v22 offset:16128
    s_waitcnt vmcnt(2)
    s_mov_b64 exec, s[58:59]
    v_and_b32 v147, 0x3ff, v146
    v_lshrrev_b32 v13, 24, v146
    v_lshlrev_b32 v147, 2, v147
    ds_add_u32 v13, v22 offset:18688
    ds_add_rtn_u32 v133, v147, v22 offset:16128
    s_waitcnt vmcnt(1)
    s_mov_b64 exec, s[60:61]
    v_and_b32 v151, 0x3ff, v150
    v_lshrrev_b32 v14, 24, v150
    v_lshlrev_b32 v151, 2, v151
    ds_add_u32 v14, v22 offset:18688
    ds_add_rtn_u32 v134, v151, v22 offset:16128
    s_mov_b64 exec, -1
    s_add_u32 m0, s30, 71424
    s_nop 0
    buffer_load_dwordx4 v153, s[12:15], 0 offen sc1 lds
    v_mfma_f32_4x4x4_16b_bf16 v[164:167], v[228:229], v[140:141], 0 cbsz:4 abid:0
    v_mfma_f32_4x4x4_16b_bf16 v[168:171], v[228:229], v[140:141], 0 cbsz:4 abid:1
    v_mfma_f32_4x4x4_16b_bf16 v[172:175], v[228:229], v[140:141], 0 cbsz:4 abid:2
    v_mfma_f32_4x4x4_16b_bf16 v[176:179], v[228:229], v[140:141], 0 cbsz:4 abid:3
    v_add_u32 v23, 112384, v159
    s_nop 0
    v_cvt_pk_bf16_f32 v180, v164, v165
    v_cvt_pk_bf16_f32 v181, v166, v167
    v_cvt_pk_bf16_f32 v182, v168, v169
    v_cvt_pk_bf16_f32 v183, v170, v171
    v_cvt_pk_bf16_f32 v184, v172, v173
    v_cvt_pk_bf16_f32 v185, v174, v175
    v_cvt_pk_bf16_f32 v186, v176, v177
    v_cvt_pk_bf16_f32 v187, v178, v179
    s_waitcnt lgkmcnt(0)
    s_barrier
    ds_read_b32 v12, v18 offset:18688
    ds_read_b32 v13, v19 offset:18688
    ds_write_b128 v23, v[180:183]
    ds_write_b128 v23, v[184:187] offset:16
    v_lshlrev_b32 v19, 4, v19
    v_and_b32 v142, 0xfffc00, v142
    v_and_b32 v146, 0xfffc00, v146
    v_and_b32 v150, 0xfffc00, v150
    s_waitcnt lgkmcnt(2)
    v_mad_u32_u24 v21, v13, s69, v21
    v_mad_u32_u24 v20, v12, s69, v20
    v_readlane_b32 s96, v21, 0
    v_readlane_b32 s97, v21, 1
    v_readlane_b32 s98, v21, 2
    v_readlane_b32 s99, v21, 3
    v_readlane_b32 s100, v21, 4
    v_lshl_add_u32 v19, v13, 16, v19
    v_cmp_lt_u32 s[36:37], s96, v20
    v_cmp_lt_u32 s[38:39], s97, v20
    v_cmp_lt_u32 s[40:41], s98, v20
    v_cmp_lt_u32 s[42:43], s99, v20
    v_cmp_lt_u32 s[44:45], s100, v20
    s_bcnt1_i32_b64 s96, s[36:37]
    v_writelane_b32 v12, s96, 0
    s_bcnt1_i32_b64 s97, s[38:39]
    v_writelane_b32 v12, s97, 1
    s_bcnt1_i32_b64 s98, s[40:41]
    v_writelane_b32 v12, s98, 2
    s_bcnt1_i32_b64 s99, s[42:43]
    v_writelane_b32 v12, s99, 3
    s_bcnt1_i32_b64 s100, s[44:45]
    v_writelane_b32 v12, s100, 4
    s_mov_b64 exec, 31
    v_lshlrev_b32 v12, 2, v12
    ds_write_b32 v12, v19 offset:19200
    s_mov_b64 exec, -1
    s_add_u32 m0, s30, 79616
    s_nop 0
    buffer_load_dwordx4 v154, s[12:15], 0 offen sc1 lds
    s_add_u32 m0, s30, 87808
    s_nop 0
    buffer_load_dwordx4 v155, s[12:15], 0 offen sc1 lds
    s_waitcnt lgkmcnt(0)
    s_barrier
    ds_read_b32 v12, v15 offset:19200
    v_mfma_f32_4x4x4_16b_bf16 v[164:167], v[228:229], v[144:145], 0 cbsz:4 abid:0
    v_mfma_f32_4x4x4_16b_bf16 v[168:171], v[228:229], v[144:145], 0 cbsz:4 abid:1
    v_mfma_f32_4x4x4_16b_bf16 v[172:175], v[228:229], v[144:145], 0 cbsz:4 abid:2
    v_mfma_f32_4x4x4_16b_bf16 v[176:179], v[228:229], v[144:145], 0 cbsz:4 abid:3
    v_add_u32 v23, 112384, v161
    s_nop 0
    v_cvt_pk_bf16_f32 v180, v164, v165
    v_cvt_pk_bf16_f32 v181, v166, v167
    v_cvt_pk_bf16_f32 v182, v168, v169
    v_cvt_pk_bf16_f32 v183, v170, v171
    v_cvt_pk_bf16_f32 v184, v172, v173
    v_cvt_pk_bf16_f32 v185, v174, v175
    v_cvt_pk_bf16_f32 v186, v176, v177
    v_cvt_pk_bf16_f32 v187, v178, v179
    s_waitcnt lgkmcnt(0)
    v_add_u32_sdwa v16, v12, v16 dst_sel:DWORD dst_unused:UNUSED_PAD src0_sel:WORD_0 src1_sel:DWORD
    ds_read_b32 v13, v16 offset:16128
    v_readlane_b32 s96, v12, 0
    v_readlane_b32 s97, v12, 1
    v_readlane_b32 s98, v12, 2
    v_readlane_b32 s99, v12, 3
    v_readlane_b32 s100, v12, 4
    s_add_u32 s3, s96, s97
    s_add_u32 s3, s3, s98
    s_add_u32 s3, s3, s99
    s_add_u32 s3, s3, s100
    s_lshr_b32 s29, s3, 16
    s_add_u32 s3, s29, 480
    v_mov_b32 v14, s3
    v_mov_b32 v18, 0
    s_mov_b64 exec, 1
    ds_add_rtn_u32 v14, v18, v14 offset:19456
    s_mov_b64 exec, -1
    s_waitcnt lgkmcnt(1)
    v_sub_u32 v17, v17, v13
    s_nop 0
    v_add_u32_dpp v13, v13, v13 row_shr:1 row_mask:0xf bank_mask:0xf
    s_nop 1
    v_add_u32_dpp v13, v13, v13 row_shr:2 row_mask:0xf bank_mask:0xf
    v_mov_b32 v20, 2147482664
    v_mov_b32 v21, 0
    v_add_u32_dpp v13, v13, v13 row_shr:4 row_mask:0xf bank_mask:0xf
    s_sub_u32 s3, 0, s29
    s_bfe_u32 s3, s3, 65539
    s_add_u32 s3, s3, 7
    v_writelane_b32 v20, 40, s3
    v_add_u32_dpp v13, v13, v13 row_shr:8 row_mask:0xf bank_mask:0xf
    s_waitcnt lgkmcnt(0)
    v_readfirstlane_b32 s71, v14
    v_add_u32_dpp v13, v13, v13 row_bcast:15 row_mask:0xa bank_mask:0xf
    s_add_u32 s3, s71, s29
    v_lshl_add_u32 v18, v11, 3, s3
    v_add_u32_dpp v13, v13, v13 row_bcast:31 row_mask:0xc bank_mask:0xf
    s_mov_b32 exec_hi, 0x0fffffff
    v_add3_u32 v13, v13, v17, s71
    ds_write_b32 v16, v13 offset:16128
    ds_write_b64 v18, v[20:21] offset:0
    s_mov_b64 exec, -1
    ds_write_b128 v23, v[180:183]
    ds_write_b128 v23, v[184:187] offset:16
    s_add_u32 m0, s30, 96000
    s_nop 0
    buffer_load_dwordx4 v156, s[12:15], 0 offen sc1 lds
    s_waitcnt lgkmcnt(2)
    s_barrier
    ds_read_b32 v12, v143 offset:16128
    ds_read_b32 v13, v147 offset:16128
    ds_read_b32 v14, v151 offset:16128
    v_add_u32 v4, s71, v4
    v_add_u32 v5, s71, v5
    v_add_u32 v6, s71, v6
    s_lshr_b32 s29, s29, 3
    s_mov_b64 exec, s[56:57]
    s_waitcnt lgkmcnt(2)
    v_add_u32_sdwa v132, v12, v132 dst_sel:DWORD dst_unused:UNUSED_PAD src0_sel:WORD_0 src1_sel:DWORD
    v_or_b32_sdwa v158, v12, v142 dst_sel:DWORD dst_unused:UNUSED_PAD src0_sel:WORD_1 src1_sel:DWORD
    ds_write_b64 v132, v[158:159] offset:0
    s_mov_b64 exec, s[58:59]
    s_waitcnt lgkmcnt(2)
    v_add_u32_sdwa v133, v13, v133 dst_sel:DWORD dst_unused:UNUSED_PAD src0_sel:WORD_0 src1_sel:DWORD
    v_or_b32_sdwa v160, v13, v146 dst_sel:DWORD dst_unused:UNUSED_PAD src0_sel:WORD_1 src1_sel:DWORD
    ds_write_b64 v133, v[160:161] offset:0
    s_mov_b64 exec, s[60:61]
    s_waitcnt lgkmcnt(2)
    v_add_u32_sdwa v134, v14, v134 dst_sel:DWORD dst_unused:UNUSED_PAD src0_sel:WORD_0 src1_sel:DWORD
    v_or_b32_sdwa v162, v14, v150 dst_sel:DWORD dst_unused:UNUSED_PAD src0_sel:WORD_1 src1_sel:DWORD
    ds_write_b64 v134, v[162:163] offset:0
    s_mov_b64 exec, -1
    s_add_u32 m0, s30, 104192
    s_nop 0
    buffer_load_dwordx4 v157, s[12:15], 0 offen sc1 lds
    s_waitcnt lgkmcnt(0)
    s_barrier
    ds_read_b32 v12, v4
    ds_read_b32 v7, v4 offset:56
    ds_read_b32 v9, v5 offset:4
    ds_read_b32 v10, v6 offset:4
    s_cmp_eq_u64 s[60:61], 0
    s_cbranch_scc1 L_not3
    v_mfma_f32_4x4x4_16b_bf16 v[164:167], v[228:229], v[148:149], 0 cbsz:4 abid:0
    v_mfma_f32_4x4x4_16b_bf16 v[168:171], v[228:229], v[148:149], 0 cbsz:4 abid:1
    v_mfma_f32_4x4x4_16b_bf16 v[172:175], v[228:229], v[148:149], 0 cbsz:4 abid:2
    v_mfma_f32_4x4x4_16b_bf16 v[176:179], v[228:229], v[148:149], 0 cbsz:4 abid:3
    v_add_u32 v23, 112384, v163
    s_nop 0
    v_cvt_pk_bf16_f32 v180, v164, v165
    v_cvt_pk_bf16_f32 v181, v166, v167
    v_cvt_pk_bf16_f32 v182, v168, v169
    v_cvt_pk_bf16_f32 v183, v170, v171
    v_cvt_pk_bf16_f32 v184, v172, v173
    v_cvt_pk_bf16_f32 v185, v174, v175
    v_cvt_pk_bf16_f32 v186, v176, v177
    v_cvt_pk_bf16_f32 v187, v178, v179
    ds_write_b128 v23, v[180:183]
    ds_write_b128 v23, v[184:187] offset:16
    s_waitcnt lgkmcnt(2)
    s_branch L_t3
L_not3:
    s_waitcnt lgkmcnt(0)
L_t3:
    v_readlane_b32 s36, v12, 0
    v_readlane_b32 s37, v12, 1
    v_readlane_b32 s38, v12, 2
    v_readlane_b32 s39, v12, 3
    s_and_b32 s70, s36, 4294966784
    buffer_load_dwordx4 v[196:199], v1, s[4:7], s70 offen
    s_and_b32 s71, s37, 4294966784
    buffer_load_dwordx4 v[200:203], v1, s[4:7], s71 offen
    s_and_b32 s70, s38, 4294966784
    buffer_load_dwordx4 v[204:207], v1, s[4:7], s70 offen
    s_and_b32 s71, s39, 4294966784
    buffer_load_dwordx4 v[208:211], v1, s[4:7], s71 offen
    v_readlane_b32 s40, v12, 4
    v_readlane_b32 s41, v12, 5
    v_readlane_b32 s42, v12, 6
    v_add_u32 v9, v9, v2
    v_add_u32 v10, v10, v3
    v_readlane_b32 s43, v7, 0
    s_and_b32 s96, s96, 0xffff
    s_mulk_i32 s96, 18
    s_and_b32 s97, s97, 0xffff
    s_mulk_i32 s97, 18
    s_and_b32 s98, s98, 0xffff
    s_mulk_i32 s98, 18
    s_and_b32 s99, s99, 0xffff
    s_mulk_i32 s99, 18
    s_and_b32 s100, s100, 0xffff
    s_mulk_i32 s100, 18
    s_and_b32 s68, s43, 4294966784
    s_waitcnt vmcnt(4) lgkmcnt(0)
    s_barrier
    s_cmp_eq_u32 s29, 0
    s_cbranch_scc1 L_exit
    s_sub_u32 s29, s29, 1
    s_mov_b64 exec, s[32:33]
    ds_read_b128 v[24:27], v9 offset:63232
    s_mov_b64 exec, s[34:35]
    ds_read_b128 v[28:31], v9 offset:63232
    s_mov_b64 exec, -1
    ds_read_b64 v[32:33], v10
    s_and_b32 s70, s40, 4294966784
    buffer_load_dwordx4 v[212:215], v1, s[4:7], s70 offen
    s_and_b32 s71, s41, 4294966784
    buffer_load_dwordx4 v[216:219], v1, s[4:7], s71 offen
    s_waitcnt lgkmcnt(1)
    v_mfma_f32_32x32x16_bf16 v[132:147], v[24:27], v[36:39], 0
    v_mfma_f32_32x32x16_bf16 v[132:147], v[28:31], v[40:43], v[132:147]
    v_mfma_f32_32x32x16_bf16 v[148:163], v[24:27], v[44:47], 0
    v_mfma_f32_32x32x16_bf16 v[148:163], v[28:31], v[48:51], v[148:163]
    s_and_b32 s70, s42, 4294966784
    buffer_load_dwordx4 v[220:223], v1, s[4:7], s70 offen
    s_waitcnt lgkmcnt(0)
    s_nop 8
    v_exp_f32 v12, v132
    v_exp_f32 v13, v133
    v_exp_f32 v14, v148
    v_exp_f32 v15, v149
    v_pk_add_f32 v[12:13], v[12:13], 1.0 op_sel_hi:[1,0]
    v_pk_add_f32 v[14:15], v[14:15], 1.0 op_sel_hi:[1,0]
    v_rcp_f32 v12, v12
    v_rcp_f32 v13, v13
    s_nop 0
    v_pk_mul_f32 v[132:133], v[132:133], v[12:13]
L_loop:
    s_setprio 3
    ds_read_b32 v9, v5 offset:132
    ds_read_b32 v10, v6 offset:132
    ds_read_b32 v8, v4 offset:184
    s_waitcnt vmcnt(6)
    v_rcp_f32 v14, v14
    v_mfma_f32_4x4x4_16b_bf16 v[16:19], v[32:33], v[196:197], 0 cbsz:4 abid:0
    v_exp_f32 v13, v135
    v_mfma_f32_4x4x4_16b_bf16 v[20:23], v[32:33], v[198:199], 0 cbsz:4 abid:0
    v_exp_f32 v12, v134
    v_readlane_b32 s44, v7, 1
    v_rcp_f32 v15, v15
    v_pk_add_f32 v[12:13], v[12:13], 1.0 op_sel_hi:[1,0]
    v_pk_mul_f32 v[148:149], v[148:149], v[14:15]
    s_and_b32 s69, s44, 4294966784
    s_set_gpr_idx_on s36, gpr_idx(SRC2,DST)
    buffer_load_dwordx4 v[224:227], v1, s[4:7], s68 offen
    v_pk_fma_f32 v[84:85], v[132:133], v[16:17], v[84:85] op_sel_hi:[0,1,1]
    v_pk_fma_f32 v[86:87], v[132:133], v[18:19], v[86:87] op_sel_hi:[0,1,1]
    v_pk_fma_f32 v[88:89], v[148:149], v[20:21], v[88:89] op_sel_hi:[0,1,1]
    v_pk_fma_f32 v[90:91], v[148:149], v[22:23], v[90:91] op_sel_hi:[0,1,1]
    s_set_gpr_idx_off
    s_waitcnt vmcnt(6)
    v_rcp_f32 v12, v12
    v_mfma_f32_4x4x4_16b_bf16 v[16:19], v[32:33], v[200:201], 0 cbsz:4 abid:1
    v_exp_f32 v15, v151
    v_mfma_f32_4x4x4_16b_bf16 v[20:23], v[32:33], v[202:203], 0 cbsz:4 abid:1
    v_exp_f32 v14, v150
    v_readlane_b32 s45, v7, 2
    v_rcp_f32 v13, v13
    v_pk_add_f32 v[14:15], v[14:15], 1.0 op_sel_hi:[1,0]
    v_pk_mul_f32 v[134:135], v[134:135], v[12:13]
    s_and_b32 s68, s45, 4294966784
    s_set_gpr_idx_on s37, gpr_idx(SRC2,DST)
    buffer_load_dwordx4 v[196:199], v1, s[4:7], s69 offen
    v_pk_fma_f32 v[84:85], v[132:133], v[16:17], v[84:85] op_sel:[1,0,0]
    v_pk_fma_f32 v[86:87], v[132:133], v[18:19], v[86:87] op_sel:[1,0,0]
    v_pk_fma_f32 v[88:89], v[148:149], v[20:21], v[88:89] op_sel:[1,0,0]
    v_pk_fma_f32 v[90:91], v[148:149], v[22:23], v[90:91] op_sel:[1,0,0]
    s_set_gpr_idx_off
    s_cbranch_scc0 L_exit
    s_waitcnt lgkmcnt(0)
    v_add_u32 v9, v9, v2
    v_add_u32 v10, v10, v3
    s_mov_b64 exec, s[32:33]
    ds_read_b128 v[24:27], v9 offset:63232
    s_mov_b64 exec, s[34:35]
    ds_read_b128 v[28:31], v9 offset:63232
    s_mov_b64 exec, -1
    ds_read_b64 v[34:35], v10
    s_waitcnt vmcnt(6)
    v_rcp_f32 v14, v14
    v_mfma_f32_4x4x4_16b_bf16 v[16:19], v[32:33], v[204:205], 0 cbsz:4 abid:2
    v_exp_f32 v13, v137
    v_mfma_f32_4x4x4_16b_bf16 v[20:23], v[32:33], v[206:207], 0 cbsz:4 abid:2
    v_exp_f32 v12, v136
    v_readlane_b32 s46, v7, 3
    v_rcp_f32 v15, v15
    v_pk_add_f32 v[12:13], v[12:13], 1.0 op_sel_hi:[1,0]
    v_pk_mul_f32 v[150:151], v[150:151], v[14:15]
    s_and_b32 s69, s46, 4294966784
    s_set_gpr_idx_on s38, gpr_idx(SRC2,DST)
    buffer_load_dwordx4 v[200:203], v1, s[4:7], s68 offen
    v_pk_fma_f32 v[84:85], v[134:135], v[16:17], v[84:85] op_sel_hi:[0,1,1]
    v_pk_fma_f32 v[86:87], v[134:135], v[18:19], v[86:87] op_sel_hi:[0,1,1]
    v_pk_fma_f32 v[88:89], v[150:151], v[20:21], v[88:89] op_sel_hi:[0,1,1]
    v_pk_fma_f32 v[90:91], v[150:151], v[22:23], v[90:91] op_sel_hi:[0,1,1]
    s_set_gpr_idx_off
    s_waitcnt vmcnt(6)
    v_rcp_f32 v12, v12
    v_mfma_f32_4x4x4_16b_bf16 v[16:19], v[32:33], v[208:209], 0 cbsz:4 abid:3
    v_exp_f32 v15, v153
    v_mfma_f32_4x4x4_16b_bf16 v[20:23], v[32:33], v[210:211], 0 cbsz:4 abid:3
    v_exp_f32 v14, v152
    v_readlane_b32 s47, v7, 4
    v_rcp_f32 v13, v13
    v_pk_add_f32 v[14:15], v[14:15], 1.0 op_sel_hi:[1,0]
    v_pk_mul_f32 v[136:137], v[136:137], v[12:13]
    s_and_b32 s68, s47, 4294966784
    s_set_gpr_idx_on s39, gpr_idx(SRC2,DST)
    buffer_load_dwordx4 v[204:207], v1, s[4:7], s69 offen
    v_pk_fma_f32 v[84:85], v[134:135], v[16:17], v[84:85] op_sel:[1,0,0]
    v_pk_fma_f32 v[86:87], v[134:135], v[18:19], v[86:87] op_sel:[1,0,0]
    v_pk_fma_f32 v[88:89], v[150:151], v[20:21], v[88:89] op_sel:[1,0,0]
    v_pk_fma_f32 v[90:91], v[150:151], v[22:23], v[90:91] op_sel:[1,0,0]
    s_set_gpr_idx_off
    s_cbranch_scc0 L_exit
    s_setprio 2
    s_waitcnt vmcnt(6)
    v_rcp_f32 v14, v14
    v_mfma_f32_4x4x4_16b_bf16 v[16:19], v[32:33], v[212:213], 0 cbsz:4 abid:4
    v_exp_f32 v13, v139
    v_mfma_f32_4x4x4_16b_bf16 v[20:23], v[32:33], v[214:215], 0 cbsz:4 abid:4
    v_exp_f32 v12, v138
    v_readlane_b32 s48, v7, 5
    v_rcp_f32 v15, v15
    v_pk_add_f32 v[12:13], v[12:13], 1.0 op_sel_hi:[1,0]
    v_pk_mul_f32 v[152:153], v[152:153], v[14:15]
    s_and_b32 s69, s48, 4294966784
    s_set_gpr_idx_on s40, gpr_idx(SRC2,DST)
    buffer_load_dwordx4 v[208:211], v1, s[4:7], s68 offen
    v_pk_fma_f32 v[84:85], v[136:137], v[16:17], v[84:85] op_sel_hi:[0,1,1]
    v_pk_fma_f32 v[86:87], v[136:137], v[18:19], v[86:87] op_sel_hi:[0,1,1]
    v_pk_fma_f32 v[88:89], v[152:153], v[20:21], v[88:89] op_sel_hi:[0,1,1]
    v_pk_fma_f32 v[90:91], v[152:153], v[22:23], v[90:91] op_sel_hi:[0,1,1]
    s_set_gpr_idx_off
    s_waitcnt vmcnt(6) lgkmcnt(0)
    v_mfma_f32_4x4x4_16b_bf16 v[20:23], v[32:33], v[218:219], 0 cbsz:4 abid:5
    v_mfma_f32_4x4x4_16b_bf16 v[16:19], v[32:33], v[216:217], 0 cbsz:4 abid:5
    v_rcp_f32 v13, v13
    v_mfma_f32_32x32x16_bf16 v[164:179], v[24:27], v[36:39], 0
    v_exp_f32 v14, v154
    v_exp_f32 v15, v155
    v_readlane_b32 s49, v7, 6
    v_rcp_f32 v12, v12
    v_pk_add_f32 v[14:15], v[14:15], 1.0 op_sel_hi:[1,0]
    v_pk_mul_f32 v[138:139], v[138:139], v[12:13]
    s_and_b32 s68, s49, 4294966784
    s_set_gpr_idx_on s41, gpr_idx(SRC2,DST)
    buffer_load_dwordx4 v[212:215], v1, s[4:7], s69 offen
    v_pk_fma_f32 v[84:85], v[136:137], v[16:17], v[84:85] op_sel:[1,0,0]
    v_pk_fma_f32 v[86:87], v[136:137], v[18:19], v[86:87] op_sel:[1,0,0]
    v_pk_fma_f32 v[88:89], v[152:153], v[20:21], v[88:89] op_sel:[1,0,0]
    v_pk_fma_f32 v[90:91], v[152:153], v[22:23], v[90:91] op_sel:[1,0,0]
    s_set_gpr_idx_off
    s_cbranch_scc0 L_exit
    s_waitcnt vmcnt(6)
    v_rcp_f32 v14, v14
    v_mfma_f32_4x4x4_16b_bf16 v[16:19], v[32:33], v[220:221], 0 cbsz:4 abid:6
    v_exp_f32 v13, v141
    v_mfma_f32_4x4x4_16b_bf16 v[20:23], v[32:33], v[222:223], 0 cbsz:4 abid:6
    v_exp_f32 v12, v140
    v_readlane_b32 s50, v7, 7
    v_rcp_f32 v15, v15
    v_pk_add_f32 v[12:13], v[12:13], 1.0 op_sel_hi:[1,0]
    v_pk_mul_f32 v[154:155], v[154:155], v[14:15]
    s_and_b32 s69, s50, 4294966784
    s_set_gpr_idx_on s42, gpr_idx(SRC2,DST)
    buffer_load_dwordx4 v[216:219], v1, s[4:7], s68 offen
    v_pk_fma_f32 v[84:85], v[138:139], v[16:17], v[84:85] op_sel_hi:[0,1,1]
    v_pk_fma_f32 v[86:87], v[138:139], v[18:19], v[86:87] op_sel_hi:[0,1,1]
    v_pk_fma_f32 v[88:89], v[154:155], v[20:21], v[88:89] op_sel_hi:[0,1,1]
    v_pk_fma_f32 v[90:91], v[154:155], v[22:23], v[90:91] op_sel_hi:[0,1,1]
    s_set_gpr_idx_off
    s_waitcnt vmcnt(6)
    v_mfma_f32_4x4x4_16b_bf16 v[20:23], v[32:33], v[226:227], 0 cbsz:4 abid:7
    v_mfma_f32_4x4x4_16b_bf16 v[16:19], v[32:33], v[224:225], 0 cbsz:4 abid:7
    v_rcp_f32 v13, v13
    v_mfma_f32_32x32x16_bf16 v[164:179], v[28:31], v[40:43], v[164:179]
    v_exp_f32 v14, v156
    v_exp_f32 v15, v157
    v_readlane_b32 s51, v7, 8
    v_rcp_f32 v12, v12
    v_pk_add_f32 v[14:15], v[14:15], 1.0 op_sel_hi:[1,0]
    v_pk_mul_f32 v[140:141], v[140:141], v[12:13]
    s_and_b32 s68, s51, 4294966784
    s_set_gpr_idx_on s43, gpr_idx(SRC2,DST)
    buffer_load_dwordx4 v[220:223], v1, s[4:7], s69 offen
    v_pk_fma_f32 v[84:85], v[138:139], v[16:17], v[84:85] op_sel:[1,0,0]
    v_pk_fma_f32 v[86:87], v[138:139], v[18:19], v[86:87] op_sel:[1,0,0]
    v_pk_fma_f32 v[88:89], v[154:155], v[20:21], v[88:89] op_sel:[1,0,0]
    v_pk_fma_f32 v[90:91], v[154:155], v[22:23], v[90:91] op_sel:[1,0,0]
    s_set_gpr_idx_off
    s_cbranch_scc0 L_exit
    s_setprio 1
    s_waitcnt vmcnt(6)
    v_rcp_f32 v14, v14
    v_mfma_f32_4x4x4_16b_bf16 v[16:19], v[32:33], v[196:197], 0 cbsz:4 abid:8
    v_exp_f32 v13, v143
    v_mfma_f32_4x4x4_16b_bf16 v[20:23], v[32:33], v[198:199], 0 cbsz:4 abid:8
    v_exp_f32 v12, v142
    v_readlane_b32 s52, v7, 9
    v_rcp_f32 v15, v15
    v_pk_add_f32 v[12:13], v[12:13], 1.0 op_sel_hi:[1,0]
    v_pk_mul_f32 v[156:157], v[156:157], v[14:15]
    s_and_b32 s69, s52, 4294966784
    s_set_gpr_idx_on s44, gpr_idx(SRC2,DST)
    buffer_load_dwordx4 v[224:227], v1, s[4:7], s68 offen
    v_pk_fma_f32 v[84:85], v[140:141], v[16:17], v[84:85] op_sel_hi:[0,1,1]
    v_pk_fma_f32 v[86:87], v[140:141], v[18:19], v[86:87] op_sel_hi:[0,1,1]
    v_pk_fma_f32 v[88:89], v[156:157], v[20:21], v[88:89] op_sel_hi:[0,1,1]
    v_pk_fma_f32 v[90:91], v[156:157], v[22:23], v[90:91] op_sel_hi:[0,1,1]
    s_set_gpr_idx_off
    s_waitcnt vmcnt(6)
    v_mfma_f32_4x4x4_16b_bf16 v[20:23], v[32:33], v[202:203], 0 cbsz:4 abid:9
    v_mfma_f32_4x4x4_16b_bf16 v[16:19], v[32:33], v[200:201], 0 cbsz:4 abid:9
    v_rcp_f32 v13, v13
    v_mfma_f32_32x32x16_bf16 v[180:195], v[24:27], v[44:47], 0
    v_exp_f32 v14, v158
    v_exp_f32 v15, v159
    v_readlane_b32 s53, v7, 10
    v_rcp_f32 v12, v12
    v_pk_add_f32 v[14:15], v[14:15], 1.0 op_sel_hi:[1,0]
    v_pk_mul_f32 v[142:143], v[142:143], v[12:13]
    s_and_b32 s68, s53, 4294966784
    s_set_gpr_idx_on s45, gpr_idx(SRC2,DST)
    buffer_load_dwordx4 v[196:199], v1, s[4:7], s69 offen
    v_pk_fma_f32 v[84:85], v[140:141], v[16:17], v[84:85] op_sel:[1,0,0]
    v_pk_fma_f32 v[86:87], v[140:141], v[18:19], v[86:87] op_sel:[1,0,0]
    v_pk_fma_f32 v[88:89], v[156:157], v[20:21], v[88:89] op_sel:[1,0,0]
    v_pk_fma_f32 v[90:91], v[156:157], v[22:23], v[90:91] op_sel:[1,0,0]
    s_set_gpr_idx_off
    s_cbranch_scc0 L_exit
    s_waitcnt vmcnt(6)
    v_rcp_f32 v14, v14
    v_mfma_f32_4x4x4_16b_bf16 v[16:19], v[32:33], v[204:205], 0 cbsz:4 abid:10
    v_exp_f32 v13, v145
    v_mfma_f32_4x4x4_16b_bf16 v[20:23], v[32:33], v[206:207], 0 cbsz:4 abid:10
    v_exp_f32 v12, v144
    v_readlane_b32 s54, v7, 11
    v_rcp_f32 v15, v15
    v_pk_add_f32 v[12:13], v[12:13], 1.0 op_sel_hi:[1,0]
    v_pk_mul_f32 v[158:159], v[158:159], v[14:15]
    s_and_b32 s69, s54, 4294966784
    s_set_gpr_idx_on s46, gpr_idx(SRC2,DST)
    buffer_load_dwordx4 v[200:203], v1, s[4:7], s68 offen
    v_pk_fma_f32 v[84:85], v[142:143], v[16:17], v[84:85] op_sel_hi:[0,1,1]
    v_pk_fma_f32 v[86:87], v[142:143], v[18:19], v[86:87] op_sel_hi:[0,1,1]
    v_pk_fma_f32 v[88:89], v[158:159], v[20:21], v[88:89] op_sel_hi:[0,1,1]
    v_pk_fma_f32 v[90:91], v[158:159], v[22:23], v[90:91] op_sel_hi:[0,1,1]
    s_set_gpr_idx_off
    s_waitcnt vmcnt(6)
    v_mfma_f32_4x4x4_16b_bf16 v[20:23], v[32:33], v[210:211], 0 cbsz:4 abid:11
    v_mfma_f32_4x4x4_16b_bf16 v[16:19], v[32:33], v[208:209], 0 cbsz:4 abid:11
    v_rcp_f32 v13, v13
    v_mfma_f32_32x32x16_bf16 v[180:195], v[28:31], v[48:51], v[180:195]
    v_exp_f32 v14, v160
    v_exp_f32 v15, v161
    v_readlane_b32 s55, v7, 12
    v_rcp_f32 v12, v12
    v_pk_add_f32 v[14:15], v[14:15], 1.0 op_sel_hi:[1,0]
    v_pk_mul_f32 v[144:145], v[144:145], v[12:13]
    s_and_b32 s68, s55, 4294966784
    s_set_gpr_idx_on s47, gpr_idx(SRC2,DST)
    buffer_load_dwordx4 v[204:207], v1, s[4:7], s69 offen
    v_pk_fma_f32 v[84:85], v[142:143], v[16:17], v[84:85] op_sel:[1,0,0]
    v_pk_fma_f32 v[86:87], v[142:143], v[18:19], v[86:87] op_sel:[1,0,0]
    v_pk_fma_f32 v[88:89], v[158:159], v[20:21], v[88:89] op_sel:[1,0,0]
    v_pk_fma_f32 v[90:91], v[158:159], v[22:23], v[90:91] op_sel:[1,0,0]
    s_set_gpr_idx_off
    s_cbranch_scc0 L_exit
    s_setprio 0
    s_waitcnt vmcnt(6)
    v_rcp_f32 v14, v14
    v_mfma_f32_4x4x4_16b_bf16 v[16:19], v[32:33], v[212:213], 0 cbsz:4 abid:12
    v_exp_f32 v13, v147
    v_mfma_f32_4x4x4_16b_bf16 v[20:23], v[32:33], v[214:215], 0 cbsz:4 abid:12
    v_exp_f32 v12, v146
    v_readlane_b32 s56, v7, 13
    v_rcp_f32 v15, v15
    v_pk_add_f32 v[12:13], v[12:13], 1.0 op_sel_hi:[1,0]
    v_pk_mul_f32 v[160:161], v[160:161], v[14:15]
    s_and_b32 s69, s56, 4294966784
    s_set_gpr_idx_on s48, gpr_idx(SRC2,DST)
    buffer_load_dwordx4 v[208:211], v1, s[4:7], s68 offen
    v_pk_fma_f32 v[84:85], v[144:145], v[16:17], v[84:85] op_sel_hi:[0,1,1]
    v_pk_fma_f32 v[86:87], v[144:145], v[18:19], v[86:87] op_sel_hi:[0,1,1]
    v_pk_fma_f32 v[88:89], v[160:161], v[20:21], v[88:89] op_sel_hi:[0,1,1]
    v_pk_fma_f32 v[90:91], v[160:161], v[22:23], v[90:91] op_sel_hi:[0,1,1]
    s_set_gpr_idx_off
    s_waitcnt vmcnt(6)
    v_rcp_f32 v12, v12
    v_mfma_f32_4x4x4_16b_bf16 v[16:19], v[32:33], v[216:217], 0 cbsz:4 abid:13
    v_exp_f32 v15, v163
    v_mfma_f32_4x4x4_16b_bf16 v[20:23], v[32:33], v[218:219], 0 cbsz:4 abid:13
    v_exp_f32 v14, v162
    v_readlane_b32 s57, v7, 14
    v_rcp_f32 v13, v13
    v_pk_add_f32 v[14:15], v[14:15], 1.0 op_sel_hi:[1,0]
    v_pk_mul_f32 v[146:147], v[146:147], v[12:13]
    s_and_b32 s68, s57, 4294966784
    s_set_gpr_idx_on s49, gpr_idx(SRC2,DST)
    buffer_load_dwordx4 v[212:215], v1, s[4:7], s69 offen
    v_pk_fma_f32 v[84:85], v[144:145], v[16:17], v[84:85] op_sel:[1,0,0]
    v_pk_fma_f32 v[86:87], v[144:145], v[18:19], v[86:87] op_sel:[1,0,0]
    v_pk_fma_f32 v[88:89], v[160:161], v[20:21], v[88:89] op_sel:[1,0,0]
    v_pk_fma_f32 v[90:91], v[160:161], v[22:23], v[90:91] op_sel:[1,0,0]
    s_set_gpr_idx_off
    s_cbranch_scc0 L_exit
    s_waitcnt vmcnt(6)
    v_rcp_f32 v14, v14
    v_mfma_f32_4x4x4_16b_bf16 v[16:19], v[32:33], v[220:221], 0 cbsz:4 abid:14
    v_exp_f32 v13, v165
    v_mfma_f32_4x4x4_16b_bf16 v[20:23], v[32:33], v[222:223], 0 cbsz:4 abid:14
    v_exp_f32 v12, v164
    v_readlane_b32 s58, v7, 15
    v_rcp_f32 v15, v15
    v_pk_add_f32 v[12:13], v[12:13], 1.0 op_sel_hi:[1,0]
    v_pk_mul_f32 v[162:163], v[162:163], v[14:15]
    s_and_b32 s69, s58, 4294966784
    s_set_gpr_idx_on s50, gpr_idx(SRC2,DST)
    buffer_load_dwordx4 v[216:219], v1, s[4:7], s68 offen
    v_pk_fma_f32 v[84:85], v[146:147], v[16:17], v[84:85] op_sel_hi:[0,1,1]
    v_pk_fma_f32 v[86:87], v[146:147], v[18:19], v[86:87] op_sel_hi:[0,1,1]
    v_pk_fma_f32 v[88:89], v[162:163], v[20:21], v[88:89] op_sel_hi:[0,1,1]
    v_pk_fma_f32 v[90:91], v[162:163], v[22:23], v[90:91] op_sel_hi:[0,1,1]
    s_set_gpr_idx_off
    s_waitcnt vmcnt(6)
    v_rcp_f32 v12, v12
    v_mfma_f32_4x4x4_16b_bf16 v[16:19], v[32:33], v[224:225], 0 cbsz:4 abid:15
    v_exp_f32 v15, v181
    v_mfma_f32_4x4x4_16b_bf16 v[20:23], v[32:33], v[226:227], 0 cbsz:4 abid:15
    v_exp_f32 v14, v180
    v_readlane_b32 s59, v8, 0
    v_rcp_f32 v13, v13
    v_pk_add_f32 v[14:15], v[14:15], 1.0 op_sel_hi:[1,0]
    v_pk_mul_f32 v[164:165], v[164:165], v[12:13]
    s_and_b32 s68, s59, 4294966784
    s_set_gpr_idx_on s51, gpr_idx(SRC2,DST)
    buffer_load_dwordx4 v[220:223], v1, s[4:7], s69 offen
    v_pk_fma_f32 v[84:85], v[146:147], v[16:17], v[84:85] op_sel:[1,0,0]
    v_pk_fma_f32 v[86:87], v[146:147], v[18:19], v[86:87] op_sel:[1,0,0]
    v_pk_fma_f32 v[88:89], v[162:163], v[20:21], v[88:89] op_sel:[1,0,0]
    v_pk_fma_f32 v[90:91], v[162:163], v[22:23], v[90:91] op_sel:[1,0,0]
    s_set_gpr_idx_off
    s_cbranch_scc0 L_exit
    s_setprio 3
    ds_read_b32 v9, v5 offset:260
    ds_read_b32 v10, v6 offset:260
    ds_read_b32 v7, v4 offset:312
    s_waitcnt vmcnt(6)
    v_rcp_f32 v14, v14
    v_mfma_f32_4x4x4_16b_bf16 v[16:19], v[34:35], v[196:197], 0 cbsz:4 abid:0
    v_exp_f32 v13, v167
    v_mfma_f32_4x4x4_16b_bf16 v[20:23], v[34:35], v[198:199], 0 cbsz:4 abid:0
    v_exp_f32 v12, v166
    v_readlane_b32 s60, v8, 1
    v_rcp_f32 v15, v15
    v_pk_add_f32 v[12:13], v[12:13], 1.0 op_sel_hi:[1,0]
    v_pk_mul_f32 v[180:181], v[180:181], v[14:15]
    s_and_b32 s69, s60, 4294966784
    s_set_gpr_idx_on s52, gpr_idx(SRC2,DST)
    buffer_load_dwordx4 v[224:227], v1, s[4:7], s68 offen
    v_pk_fma_f32 v[84:85], v[164:165], v[16:17], v[84:85] op_sel_hi:[0,1,1]
    v_pk_fma_f32 v[86:87], v[164:165], v[18:19], v[86:87] op_sel_hi:[0,1,1]
    v_pk_fma_f32 v[88:89], v[180:181], v[20:21], v[88:89] op_sel_hi:[0,1,1]
    v_pk_fma_f32 v[90:91], v[180:181], v[22:23], v[90:91] op_sel_hi:[0,1,1]
    s_set_gpr_idx_off
    s_waitcnt vmcnt(6)
    v_rcp_f32 v12, v12
    v_mfma_f32_4x4x4_16b_bf16 v[16:19], v[34:35], v[200:201], 0 cbsz:4 abid:1
    v_exp_f32 v15, v183
    v_mfma_f32_4x4x4_16b_bf16 v[20:23], v[34:35], v[202:203], 0 cbsz:4 abid:1
    v_exp_f32 v14, v182
    v_readlane_b32 s61, v8, 2
    v_rcp_f32 v13, v13
    v_pk_add_f32 v[14:15], v[14:15], 1.0 op_sel_hi:[1,0]
    v_pk_mul_f32 v[166:167], v[166:167], v[12:13]
    s_and_b32 s68, s61, 4294966784
    s_set_gpr_idx_on s53, gpr_idx(SRC2,DST)
    buffer_load_dwordx4 v[196:199], v1, s[4:7], s69 offen
    v_pk_fma_f32 v[84:85], v[164:165], v[16:17], v[84:85] op_sel:[1,0,0]
    v_pk_fma_f32 v[86:87], v[164:165], v[18:19], v[86:87] op_sel:[1,0,0]
    v_pk_fma_f32 v[88:89], v[180:181], v[20:21], v[88:89] op_sel:[1,0,0]
    v_pk_fma_f32 v[90:91], v[180:181], v[22:23], v[90:91] op_sel:[1,0,0]
    s_set_gpr_idx_off
    s_cbranch_scc0 L_exit
    s_waitcnt lgkmcnt(0)
    v_add_u32 v9, v9, v2
    v_add_u32 v10, v10, v3
    s_mov_b64 exec, s[32:33]
    ds_read_b128 v[24:27], v9 offset:63232
    s_mov_b64 exec, s[34:35]
    ds_read_b128 v[28:31], v9 offset:63232
    s_mov_b64 exec, -1
    ds_read_b64 v[32:33], v10
    s_waitcnt vmcnt(6)
    v_rcp_f32 v14, v14
    v_mfma_f32_4x4x4_16b_bf16 v[16:19], v[34:35], v[204:205], 0 cbsz:4 abid:2
    v_exp_f32 v13, v169
    v_mfma_f32_4x4x4_16b_bf16 v[20:23], v[34:35], v[206:207], 0 cbsz:4 abid:2
    v_exp_f32 v12, v168
    v_readlane_b32 s62, v8, 3
    v_rcp_f32 v15, v15
    v_pk_add_f32 v[12:13], v[12:13], 1.0 op_sel_hi:[1,0]
    v_pk_mul_f32 v[182:183], v[182:183], v[14:15]
    s_and_b32 s69, s62, 4294966784
    s_set_gpr_idx_on s54, gpr_idx(SRC2,DST)
    buffer_load_dwordx4 v[200:203], v1, s[4:7], s68 offen
    v_pk_fma_f32 v[84:85], v[166:167], v[16:17], v[84:85] op_sel_hi:[0,1,1]
    v_pk_fma_f32 v[86:87], v[166:167], v[18:19], v[86:87] op_sel_hi:[0,1,1]
    v_pk_fma_f32 v[88:89], v[182:183], v[20:21], v[88:89] op_sel_hi:[0,1,1]
    v_pk_fma_f32 v[90:91], v[182:183], v[22:23], v[90:91] op_sel_hi:[0,1,1]
    s_set_gpr_idx_off
    s_waitcnt vmcnt(6)
    v_rcp_f32 v12, v12
    v_mfma_f32_4x4x4_16b_bf16 v[16:19], v[34:35], v[208:209], 0 cbsz:4 abid:3
    v_exp_f32 v15, v185
    v_mfma_f32_4x4x4_16b_bf16 v[20:23], v[34:35], v[210:211], 0 cbsz:4 abid:3
    v_exp_f32 v14, v184
    v_readlane_b32 s63, v8, 4
    v_rcp_f32 v13, v13
    v_pk_add_f32 v[14:15], v[14:15], 1.0 op_sel_hi:[1,0]
    v_pk_mul_f32 v[168:169], v[168:169], v[12:13]
    s_and_b32 s68, s63, 4294966784
    s_set_gpr_idx_on s55, gpr_idx(SRC2,DST)
    buffer_load_dwordx4 v[204:207], v1, s[4:7], s69 offen
    v_pk_fma_f32 v[84:85], v[166:167], v[16:17], v[84:85] op_sel:[1,0,0]
    v_pk_fma_f32 v[86:87], v[166:167], v[18:19], v[86:87] op_sel:[1,0,0]
    v_pk_fma_f32 v[88:89], v[182:183], v[20:21], v[88:89] op_sel:[1,0,0]
    v_pk_fma_f32 v[90:91], v[182:183], v[22:23], v[90:91] op_sel:[1,0,0]
    s_set_gpr_idx_off
    s_cbranch_scc0 L_exit
    s_setprio 2
    s_waitcnt vmcnt(6)
    v_rcp_f32 v14, v14
    v_mfma_f32_4x4x4_16b_bf16 v[16:19], v[34:35], v[212:213], 0 cbsz:4 abid:4
    v_exp_f32 v13, v171
    v_mfma_f32_4x4x4_16b_bf16 v[20:23], v[34:35], v[214:215], 0 cbsz:4 abid:4
    v_exp_f32 v12, v170
    v_readlane_b32 s64, v8, 5
    v_rcp_f32 v15, v15
    v_pk_add_f32 v[12:13], v[12:13], 1.0 op_sel_hi:[1,0]
    v_pk_mul_f32 v[184:185], v[184:185], v[14:15]
    s_and_b32 s69, s64, 4294966784
    s_set_gpr_idx_on s56, gpr_idx(SRC2,DST)
    buffer_load_dwordx4 v[208:211], v1, s[4:7], s68 offen
    v_pk_fma_f32 v[84:85], v[168:169], v[16:17], v[84:85] op_sel_hi:[0,1,1]
    v_pk_fma_f32 v[86:87], v[168:169], v[18:19], v[86:87] op_sel_hi:[0,1,1]
    v_pk_fma_f32 v[88:89], v[184:185], v[20:21], v[88:89] op_sel_hi:[0,1,1]
    v_pk_fma_f32 v[90:91], v[184:185], v[22:23], v[90:91] op_sel_hi:[0,1,1]
    s_set_gpr_idx_off
    s_waitcnt vmcnt(6) lgkmcnt(0)
    v_mfma_f32_4x4x4_16b_bf16 v[20:23], v[34:35], v[218:219], 0 cbsz:4 abid:5
    v_mfma_f32_4x4x4_16b_bf16 v[16:19], v[34:35], v[216:217], 0 cbsz:4 abid:5
    v_rcp_f32 v13, v13
    v_mfma_f32_32x32x16_bf16 v[132:147], v[24:27], v[36:39], 0
    v_exp_f32 v14, v186
    v_exp_f32 v15, v187
    v_readlane_b32 s65, v8, 6
    v_rcp_f32 v12, v12
    v_pk_add_f32 v[14:15], v[14:15], 1.0 op_sel_hi:[1,0]
    v_pk_mul_f32 v[170:171], v[170:171], v[12:13]
    s_and_b32 s68, s65, 4294966784
    s_set_gpr_idx_on s57, gpr_idx(SRC2,DST)
    buffer_load_dwordx4 v[212:215], v1, s[4:7], s69 offen
    v_pk_fma_f32 v[84:85], v[168:169], v[16:17], v[84:85] op_sel:[1,0,0]
    v_pk_fma_f32 v[86:87], v[168:169], v[18:19], v[86:87] op_sel:[1,0,0]
    v_pk_fma_f32 v[88:89], v[184:185], v[20:21], v[88:89] op_sel:[1,0,0]
    v_pk_fma_f32 v[90:91], v[184:185], v[22:23], v[90:91] op_sel:[1,0,0]
    s_set_gpr_idx_off
    s_cbranch_scc0 L_exit
    s_waitcnt vmcnt(6)
    v_rcp_f32 v14, v14
    v_mfma_f32_4x4x4_16b_bf16 v[16:19], v[34:35], v[220:221], 0 cbsz:4 abid:6
    v_exp_f32 v13, v173
    v_mfma_f32_4x4x4_16b_bf16 v[20:23], v[34:35], v[222:223], 0 cbsz:4 abid:6
    v_exp_f32 v12, v172
    v_readlane_b32 s66, v8, 7
    v_rcp_f32 v15, v15
    v_pk_add_f32 v[12:13], v[12:13], 1.0 op_sel_hi:[1,0]
    v_pk_mul_f32 v[186:187], v[186:187], v[14:15]
    s_and_b32 s69, s66, 4294966784
    s_set_gpr_idx_on s58, gpr_idx(SRC2,DST)
    buffer_load_dwordx4 v[216:219], v1, s[4:7], s68 offen
    v_pk_fma_f32 v[84:85], v[170:171], v[16:17], v[84:85] op_sel_hi:[0,1,1]
    v_pk_fma_f32 v[86:87], v[170:171], v[18:19], v[86:87] op_sel_hi:[0,1,1]
    v_pk_fma_f32 v[88:89], v[186:187], v[20:21], v[88:89] op_sel_hi:[0,1,1]
    v_pk_fma_f32 v[90:91], v[186:187], v[22:23], v[90:91] op_sel_hi:[0,1,1]
    s_set_gpr_idx_off
    s_waitcnt vmcnt(6)
    v_mfma_f32_4x4x4_16b_bf16 v[20:23], v[34:35], v[226:227], 0 cbsz:4 abid:7
    v_mfma_f32_4x4x4_16b_bf16 v[16:19], v[34:35], v[224:225], 0 cbsz:4 abid:7
    v_rcp_f32 v13, v13
    v_mfma_f32_32x32x16_bf16 v[132:147], v[28:31], v[40:43], v[132:147]
    v_exp_f32 v14, v188
    v_exp_f32 v15, v189
    v_readlane_b32 s67, v8, 8
    v_rcp_f32 v12, v12
    v_pk_add_f32 v[14:15], v[14:15], 1.0 op_sel_hi:[1,0]
    v_pk_mul_f32 v[172:173], v[172:173], v[12:13]
    s_and_b32 s68, s67, 4294966784
    s_set_gpr_idx_on s59, gpr_idx(SRC2,DST)
    buffer_load_dwordx4 v[220:223], v1, s[4:7], s69 offen
    v_pk_fma_f32 v[84:85], v[170:171], v[16:17], v[84:85] op_sel:[1,0,0]
    v_pk_fma_f32 v[86:87], v[170:171], v[18:19], v[86:87] op_sel:[1,0,0]
    v_pk_fma_f32 v[88:89], v[186:187], v[20:21], v[88:89] op_sel:[1,0,0]
    v_pk_fma_f32 v[90:91], v[186:187], v[22:23], v[90:91] op_sel:[1,0,0]
    s_set_gpr_idx_off
    s_cbranch_scc0 L_exit
    s_setprio 1
    s_waitcnt vmcnt(6)
    v_rcp_f32 v14, v14
    v_mfma_f32_4x4x4_16b_bf16 v[16:19], v[34:35], v[196:197], 0 cbsz:4 abid:8
    v_exp_f32 v13, v175
    v_mfma_f32_4x4x4_16b_bf16 v[20:23], v[34:35], v[198:199], 0 cbsz:4 abid:8
    v_exp_f32 v12, v174
    v_readlane_b32 s36, v8, 9
    v_rcp_f32 v15, v15
    v_pk_add_f32 v[12:13], v[12:13], 1.0 op_sel_hi:[1,0]
    v_pk_mul_f32 v[188:189], v[188:189], v[14:15]
    s_and_b32 s69, s36, 4294966784
    s_set_gpr_idx_on s60, gpr_idx(SRC2,DST)
    buffer_load_dwordx4 v[224:227], v1, s[4:7], s68 offen
    v_pk_fma_f32 v[84:85], v[172:173], v[16:17], v[84:85] op_sel_hi:[0,1,1]
    v_pk_fma_f32 v[86:87], v[172:173], v[18:19], v[86:87] op_sel_hi:[0,1,1]
    v_pk_fma_f32 v[88:89], v[188:189], v[20:21], v[88:89] op_sel_hi:[0,1,1]
    v_pk_fma_f32 v[90:91], v[188:189], v[22:23], v[90:91] op_sel_hi:[0,1,1]
    s_set_gpr_idx_off
    s_waitcnt vmcnt(6)
    v_mfma_f32_4x4x4_16b_bf16 v[20:23], v[34:35], v[202:203], 0 cbsz:4 abid:9
    v_mfma_f32_4x4x4_16b_bf16 v[16:19], v[34:35], v[200:201], 0 cbsz:4 abid:9
    v_rcp_f32 v13, v13
    v_mfma_f32_32x32x16_bf16 v[148:163], v[24:27], v[44:47], 0
    v_exp_f32 v14, v190
    v_exp_f32 v15, v191
    v_readlane_b32 s37, v8, 10
    v_rcp_f32 v12, v12
    v_pk_add_f32 v[14:15], v[14:15], 1.0 op_sel_hi:[1,0]
    v_pk_mul_f32 v[174:175], v[174:175], v[12:13]
    s_and_b32 s68, s37, 4294966784
    s_set_gpr_idx_on s61, gpr_idx(SRC2,DST)
    buffer_load_dwordx4 v[196:199], v1, s[4:7], s69 offen
    v_pk_fma_f32 v[84:85], v[172:173], v[16:17], v[84:85] op_sel:[1,0,0]
    v_pk_fma_f32 v[86:87], v[172:173], v[18:19], v[86:87] op_sel:[1,0,0]
    v_pk_fma_f32 v[88:89], v[188:189], v[20:21], v[88:89] op_sel:[1,0,0]
    v_pk_fma_f32 v[90:91], v[188:189], v[22:23], v[90:91] op_sel:[1,0,0]
    s_set_gpr_idx_off
    s_cbranch_scc0 L_exit
    s_waitcnt vmcnt(6)
    v_rcp_f32 v14, v14
    v_mfma_f32_4x4x4_16b_bf16 v[16:19], v[34:35], v[204:205], 0 cbsz:4 abid:10
    v_exp_f32 v13, v177
    v_mfma_f32_4x4x4_16b_bf16 v[20:23], v[34:35], v[206:207], 0 cbsz:4 abid:10
    v_exp_f32 v12, v176
    v_readlane_b32 s38, v8, 11
    v_rcp_f32 v15, v15
    v_pk_add_f32 v[12:13], v[12:13], 1.0 op_sel_hi:[1,0]
    v_pk_mul_f32 v[190:191], v[190:191], v[14:15]
    s_and_b32 s69, s38, 4294966784
    s_set_gpr_idx_on s62, gpr_idx(SRC2,DST)
    buffer_load_dwordx4 v[200:203], v1, s[4:7], s68 offen
    v_pk_fma_f32 v[84:85], v[174:175], v[16:17], v[84:85] op_sel_hi:[0,1,1]
    v_pk_fma_f32 v[86:87], v[174:175], v[18:19], v[86:87] op_sel_hi:[0,1,1]
    v_pk_fma_f32 v[88:89], v[190:191], v[20:21], v[88:89] op_sel_hi:[0,1,1]
    v_pk_fma_f32 v[90:91], v[190:191], v[22:23], v[90:91] op_sel_hi:[0,1,1]
    s_set_gpr_idx_off
    s_waitcnt vmcnt(6)
    v_mfma_f32_4x4x4_16b_bf16 v[20:23], v[34:35], v[210:211], 0 cbsz:4 abid:11
    v_mfma_f32_4x4x4_16b_bf16 v[16:19], v[34:35], v[208:209], 0 cbsz:4 abid:11
    v_rcp_f32 v13, v13
    v_mfma_f32_32x32x16_bf16 v[148:163], v[28:31], v[48:51], v[148:163]
    v_exp_f32 v14, v192
    v_exp_f32 v15, v193
    v_readlane_b32 s39, v8, 12
    v_rcp_f32 v12, v12
    v_pk_add_f32 v[14:15], v[14:15], 1.0 op_sel_hi:[1,0]
    v_pk_mul_f32 v[176:177], v[176:177], v[12:13]
    s_and_b32 s68, s39, 4294966784
    s_set_gpr_idx_on s63, gpr_idx(SRC2,DST)
    buffer_load_dwordx4 v[204:207], v1, s[4:7], s69 offen
    v_pk_fma_f32 v[84:85], v[174:175], v[16:17], v[84:85] op_sel:[1,0,0]
    v_pk_fma_f32 v[86:87], v[174:175], v[18:19], v[86:87] op_sel:[1,0,0]
    v_pk_fma_f32 v[88:89], v[190:191], v[20:21], v[88:89] op_sel:[1,0,0]
    v_pk_fma_f32 v[90:91], v[190:191], v[22:23], v[90:91] op_sel:[1,0,0]
    s_set_gpr_idx_off
    s_cbranch_scc0 L_exit
    s_setprio 0
    s_waitcnt vmcnt(6)
    v_rcp_f32 v14, v14
    v_mfma_f32_4x4x4_16b_bf16 v[16:19], v[34:35], v[212:213], 0 cbsz:4 abid:12
    v_exp_f32 v13, v179
    v_mfma_f32_4x4x4_16b_bf16 v[20:23], v[34:35], v[214:215], 0 cbsz:4 abid:12
    v_exp_f32 v12, v178
    v_readlane_b32 s40, v8, 13
    v_rcp_f32 v15, v15
    v_pk_add_f32 v[12:13], v[12:13], 1.0 op_sel_hi:[1,0]
    v_pk_mul_f32 v[192:193], v[192:193], v[14:15]
    s_and_b32 s69, s40, 4294966784
    s_set_gpr_idx_on s64, gpr_idx(SRC2,DST)
    buffer_load_dwordx4 v[208:211], v1, s[4:7], s68 offen
    v_pk_fma_f32 v[84:85], v[176:177], v[16:17], v[84:85] op_sel_hi:[0,1,1]
    v_pk_fma_f32 v[86:87], v[176:177], v[18:19], v[86:87] op_sel_hi:[0,1,1]
    v_pk_fma_f32 v[88:89], v[192:193], v[20:21], v[88:89] op_sel_hi:[0,1,1]
    v_pk_fma_f32 v[90:91], v[192:193], v[22:23], v[90:91] op_sel_hi:[0,1,1]
    s_set_gpr_idx_off
    s_waitcnt vmcnt(6)
    v_rcp_f32 v12, v12
    v_mfma_f32_4x4x4_16b_bf16 v[16:19], v[34:35], v[216:217], 0 cbsz:4 abid:13
    v_exp_f32 v15, v195
    v_mfma_f32_4x4x4_16b_bf16 v[20:23], v[34:35], v[218:219], 0 cbsz:4 abid:13
    v_exp_f32 v14, v194
    v_readlane_b32 s41, v8, 14
    v_rcp_f32 v13, v13
    v_pk_add_f32 v[14:15], v[14:15], 1.0 op_sel_hi:[1,0]
    v_pk_mul_f32 v[178:179], v[178:179], v[12:13]
    s_and_b32 s68, s41, 4294966784
    s_set_gpr_idx_on s65, gpr_idx(SRC2,DST)
    buffer_load_dwordx4 v[212:215], v1, s[4:7], s69 offen
    v_pk_fma_f32 v[84:85], v[176:177], v[16:17], v[84:85] op_sel:[1,0,0]
    v_pk_fma_f32 v[86:87], v[176:177], v[18:19], v[86:87] op_sel:[1,0,0]
    v_pk_fma_f32 v[88:89], v[192:193], v[20:21], v[88:89] op_sel:[1,0,0]
    v_pk_fma_f32 v[90:91], v[192:193], v[22:23], v[90:91] op_sel:[1,0,0]
    s_set_gpr_idx_off
    s_cbranch_scc0 L_exit
    s_waitcnt vmcnt(6)
    v_rcp_f32 v14, v14
    v_mfma_f32_4x4x4_16b_bf16 v[16:19], v[34:35], v[220:221], 0 cbsz:4 abid:14
    v_exp_f32 v13, v133
    v_mfma_f32_4x4x4_16b_bf16 v[20:23], v[34:35], v[222:223], 0 cbsz:4 abid:14
    v_exp_f32 v12, v132
    v_readlane_b32 s42, v8, 15
    v_rcp_f32 v15, v15
    v_pk_add_f32 v[12:13], v[12:13], 1.0 op_sel_hi:[1,0]
    v_pk_mul_f32 v[194:195], v[194:195], v[14:15]
    s_and_b32 s69, s42, 4294966784
    s_set_gpr_idx_on s66, gpr_idx(SRC2,DST)
    buffer_load_dwordx4 v[216:219], v1, s[4:7], s68 offen
    v_pk_fma_f32 v[84:85], v[178:179], v[16:17], v[84:85] op_sel_hi:[0,1,1]
    v_pk_fma_f32 v[86:87], v[178:179], v[18:19], v[86:87] op_sel_hi:[0,1,1]
    v_pk_fma_f32 v[88:89], v[194:195], v[20:21], v[88:89] op_sel_hi:[0,1,1]
    v_pk_fma_f32 v[90:91], v[194:195], v[22:23], v[90:91] op_sel_hi:[0,1,1]
    s_set_gpr_idx_off
    s_waitcnt vmcnt(6)
    v_rcp_f32 v12, v12
    v_mfma_f32_4x4x4_16b_bf16 v[16:19], v[34:35], v[224:225], 0 cbsz:4 abid:15
    v_exp_f32 v15, v149
    v_mfma_f32_4x4x4_16b_bf16 v[20:23], v[34:35], v[226:227], 0 cbsz:4 abid:15
    v_exp_f32 v14, v148
    v_readlane_b32 s43, v7, 0
    v_rcp_f32 v13, v13
    v_pk_add_f32 v[14:15], v[14:15], 1.0 op_sel_hi:[1,0]
    v_pk_mul_f32 v[132:133], v[132:133], v[12:13]
    s_and_b32 s68, s43, 4294966784
    s_set_gpr_idx_on s67, gpr_idx(SRC2,DST)
    buffer_load_dwordx4 v[220:223], v1, s[4:7], s69 offen
    v_pk_fma_f32 v[84:85], v[178:179], v[16:17], v[84:85] op_sel:[1,0,0]
    v_pk_fma_f32 v[86:87], v[178:179], v[18:19], v[86:87] op_sel:[1,0,0]
    v_pk_fma_f32 v[88:89], v[194:195], v[20:21], v[88:89] op_sel:[1,0,0]
    v_pk_fma_f32 v[90:91], v[194:195], v[22:23], v[90:91] op_sel:[1,0,0]
    s_set_gpr_idx_off
    s_cbranch_scc0 L_exit
    v_add_u32 v4, 256, v4
    v_add_u32 v5, 256, v5
    v_add_u32 v6, 256, v6
    s_branch L_loop
L_giveup:
    s_mov_b64 exec, -1
    v_mov_b64 v[164:165], 0
    v_mov_b64 v[166:167], 0
    v_add_u32 v168, 161536, v1
    ds_write_b128 v168, v[164:167]
    v_mov_b32 v172, 0x00300000
    v_mov_b32 v173, 0x00300000
    v_mov_b32 v174, 0x00300000
    v_mov_b32 v175, 0x00300000
    ds_write_b128 v1, v[172:175] offset:20224
    ds_write_b128 v1, v[172:175] offset:21248
    ds_write_b128 v1, v[172:175] offset:22272
    ds_write_b128 v1, v[172:175] offset:23296
    ds_write_b128 v1, v[172:175] offset:24320
    ds_write_b128 v1, v[172:175] offset:25344
    s_branch L_fok
L_more:
    s_waitcnt vmcnt(0) lgkmcnt(0)
    s_barrier
    v_lshlrev_b32 v188, 4, v0
    v_add_u32 v189, 8192, v188
    v_add_u32 v190, 16384, v188
    v_add_u32 v191, 24576, v188
    v_add_u32 v192, 32768, v188
    v_add_u32 v193, 40960, v188
    v_lshlrev_b32 v194, 2, v0
    v_lshlrev_b32 v14, 3, v0
    v_mov_b32 v16, 0
    v_mov_b32 v17, 0
    v_mov_b32 v15, 0x00300000
    ds_write_b64 v14, v[16:17] offset:16128
    ds_write_b32 v194, v15 offset:20224
    ds_write_b32 v194, v15 offset:22272
    ds_write_b32 v194, v15 offset:24320
    v_lshrrev_b32 v195, 1, v0
    v_lshlrev_b32 v195, 2, v195
    s_branch L_round
L_exit:
    s_add_u32 s28, s28, 1536
    s_cmp_lt_u32 s28, s25
    s_cbranch_scc1 L_more
    s_mov_b32 m0, s96
    s_mov_b32 s68, 0xbf317218
    s_mov_b32 s69, s68
    v_pk_mul_f32 v[84:85], v[84:85], s[68:69]
    v_pk_mul_f32 v[86:87], v[86:87], s[68:69]
    v_pk_mul_f32 v[88:89], v[88:89], s[68:69]
    v_pk_mul_f32 v[90:91], v[90:91], s[68:69]
    v_cvt_pk_bf16_f32 v84, v84, v88
    v_cvt_pk_bf16_f32 v85, v85, v89
    v_cvt_pk_bf16_f32 v86, v86, v90
    v_cvt_pk_bf16_f32 v87, v87, v91
    ds_write_addtid_b32 v84 offset:16128
    ds_write_addtid_b32 v85 offset:16416
    ds_write_addtid_b32 v86 offset:16704
    ds_write_addtid_b32 v87 offset:16992
    s_mov_b32 m0, s97
    v_pk_mul_f32 v[92:93], v[92:93], s[68:69]
    v_pk_mul_f32 v[94:95], v[94:95], s[68:69]
    v_pk_mul_f32 v[96:97], v[96:97], s[68:69]
    v_pk_mul_f32 v[98:99], v[98:99], s[68:69]
    v_cvt_pk_bf16_f32 v92, v92, v96
    v_cvt_pk_bf16_f32 v93, v93, v97
    v_cvt_pk_bf16_f32 v94, v94, v98
    v_cvt_pk_bf16_f32 v95, v95, v99
    ds_write_addtid_b32 v92 offset:16128
    ds_write_addtid_b32 v93 offset:16416
    ds_write_addtid_b32 v94 offset:16704
    ds_write_addtid_b32 v95 offset:16992
    s_mov_b32 m0, s98
    v_pk_mul_f32 v[100:101], v[100:101], s[68:69]
    v_pk_mul_f32 v[102:103], v[102:103], s[68:69]
    v_pk_mul_f32 v[104:105], v[104:105], s[68:69]
    v_pk_mul_f32 v[106:107], v[106:107], s[68:69]
    v_cvt_pk_bf16_f32 v100, v100, v104
    v_cvt_pk_bf16_f32 v101, v101, v105
    v_cvt_pk_bf16_f32 v102, v102, v106
    v_cvt_pk_bf16_f32 v103, v103, v107
    ds_write_addtid_b32 v100 offset:16128
    ds_write_addtid_b32 v101 offset:16416
    ds_write_addtid_b32 v102 offset:16704
    ds_write_addtid_b32 v103 offset:16992
    s_mov_b32 m0, s99
    v_pk_mul_f32 v[108:109], v[108:109], s[68:69]
    v_pk_mul_f32 v[110:111], v[110:111], s[68:69]
    v_pk_mul_f32 v[112:113], v[112:113], s[68:69]
    v_pk_mul_f32 v[114:115], v[114:115], s[68:69]
    v_cvt_pk_bf16_f32 v108, v108, v112
    v_cvt_pk_bf16_f32 v109, v109, v113
    v_cvt_pk_bf16_f32 v110, v110, v114
    v_cvt_pk_bf16_f32 v111, v111, v115
    ds_write_addtid_b32 v108 offset:16128
    ds_write_addtid_b32 v109 offset:16416
    ds_write_addtid_b32 v110 offset:16704
    ds_write_addtid_b32 v111 offset:16992
    s_mov_b32 m0, s100
    v_pk_mul_f32 v[116:117], v[116:117], s[68:69]
    v_pk_mul_f32 v[118:119], v[118:119], s[68:69]
    v_pk_mul_f32 v[120:121], v[120:121], s[68:69]
    v_pk_mul_f32 v[122:123], v[122:123], s[68:69]
    v_cvt_pk_bf16_f32 v116, v116, v120
    v_cvt_pk_bf16_f32 v117, v117, v121
    v_cvt_pk_bf16_f32 v118, v118, v122
    v_cvt_pk_bf16_f32 v119, v119, v123
    ds_write_addtid_b32 v116 offset:16128
    ds_write_addtid_b32 v117 offset:16416
    ds_write_addtid_b32 v118 offset:16704
    ds_write_addtid_b32 v119 offset:16992
    s_mov_b32 s68, 0xbf317218
    s_waitcnt lgkmcnt(0)
    s_barrier
    ds_read_b128 v[84:87], v232 offset:16128
    ds_read_b128 v[88:91], v232 offset:16192
    ds_read_b128 v[92:95], v232 offset:16256
    ds_read_b128 v[96:99], v232 offset:16320
    ds_read_b128 v[100:103], v232 offset:20736
    ds_read_b128 v[104:107], v232 offset:20800
    ds_read_b128 v[108:111], v232 offset:20864
    ds_read_b128 v[112:115], v232 offset:20928
    s_waitcnt lgkmcnt(7)
    v_mfma_f32_16x16x32_bf16 v[116:119], v[84:87], v[52:55], 0
    v_mfma_f32_16x16x32_bf16 v[120:123], v[84:87], v[56:59], 0
    s_waitcnt lgkmcnt(6)
    v_mfma_f32_16x16x32_bf16 v[116:119], v[88:91], v[60:63], v[116:119]
    v_mfma_f32_16x16x32_bf16 v[120:123], v[88:91], v[64:67], v[120:123]
    s_waitcnt lgkmcnt(5)
    v_mfma_f32_16x16x32_bf16 v[116:119], v[92:95], v[68:71], v[116:119]
    v_mfma_f32_16x16x32_bf16 v[120:123], v[92:95], v[72:75], v[120:123]
    s_waitcnt lgkmcnt(4)
    v_mfma_f32_16x16x32_bf16 v[116:119], v[96:99], v[76:79], v[116:119]
    v_mfma_f32_16x16x32_bf16 v[120:123], v[96:99], v[80:83], v[120:123]
    ds_read_b128 v[84:87], v232 offset:25344
    ds_read_b128 v[88:91], v232 offset:25408
    ds_read_b128 v[92:95], v232 offset:25472
    ds_read_b128 v[96:99], v232 offset:25536
    s_waitcnt lgkmcnt(7)
    v_mfma_f32_16x16x32_bf16 v[124:127], v[100:103], v[52:55], 0
    v_mfma_f32_16x16x32_bf16 v[128:131], v[100:103], v[56:59], 0
    s_waitcnt lgkmcnt(6)
    v_mfma_f32_16x16x32_bf16 v[124:127], v[104:107], v[60:63], v[124:127]
    v_cvt_pk_bf16_f32 v44, v116, v117
    v_cvt_pk_bf16_f32 v45, v118, v119
    v_mfma_f32_16x16x32_bf16 v[128:131], v[104:107], v[64:67], v[128:131]
    v_cvt_pk_bf16_f32 v46, v120, v121
    v_cvt_pk_bf16_f32 v47, v122, v123
    s_waitcnt lgkmcnt(5)
    v_mfma_f32_16x16x32_bf16 v[124:127], v[108:111], v[68:71], v[124:127]
    s_mov_b32 s3, 0
    buffer_store_dwordx4 v[44:47], v233, s[16:19], s3 offen sc0 sc1
    v_mfma_f32_16x16x32_bf16 v[128:131], v[108:111], v[72:75], v[128:131]
    s_waitcnt lgkmcnt(4)
    v_mfma_f32_16x16x32_bf16 v[124:127], v[112:115], v[76:79], v[124:127]
    v_mfma_f32_16x16x32_bf16 v[128:131], v[112:115], v[80:83], v[128:131]
    ds_read_b128 v[100:103], v232 offset:29952
    ds_read_b128 v[104:107], v232 offset:30016
    ds_read_b128 v[108:111], v232 offset:30080
    ds_read_b128 v[112:115], v232 offset:30144
    s_waitcnt lgkmcnt(7)
    v_mfma_f32_16x16x32_bf16 v[116:119], v[84:87], v[52:55], 0
    v_mfma_f32_16x16x32_bf16 v[120:123], v[84:87], v[56:59], 0
    s_waitcnt lgkmcnt(6)
    v_mfma_f32_16x16x32_bf16 v[116:119], v[88:91], v[60:63], v[116:119]
    v_cvt_pk_bf16_f32 v48, v124, v125
    v_cvt_pk_bf16_f32 v49, v126, v127
    v_mfma_f32_16x16x32_bf16 v[120:123], v[88:91], v[64:67], v[120:123]
    v_cvt_pk_bf16_f32 v50, v128, v129
    v_cvt_pk_bf16_f32 v51, v130, v131
    s_waitcnt lgkmcnt(5)
    v_mfma_f32_16x16x32_bf16 v[116:119], v[92:95], v[68:71], v[116:119]
    s_mov_b32 s3, 1048576
    buffer_store_dwordx4 v[48:51], v233, s[16:19], s3 offen sc0 sc1
    v_mfma_f32_16x16x32_bf16 v[120:123], v[92:95], v[72:75], v[120:123]
    s_waitcnt lgkmcnt(4)
    v_mfma_f32_16x16x32_bf16 v[116:119], v[96:99], v[76:79], v[116:119]
    v_mfma_f32_16x16x32_bf16 v[120:123], v[96:99], v[80:83], v[120:123]
    ds_read_b128 v[84:87], v232 offset:34560
    ds_read_b128 v[88:91], v232 offset:34624
    ds_read_b128 v[92:95], v232 offset:34688
    ds_read_b128 v[96:99], v232 offset:34752
    s_waitcnt lgkmcnt(7)
    v_mfma_f32_16x16x32_bf16 v[124:127], v[100:103], v[52:55], 0
    v_mfma_f32_16x16x32_bf16 v[128:131], v[100:103], v[56:59], 0
    s_waitcnt lgkmcnt(6)
    v_mfma_f32_16x16x32_bf16 v[124:127], v[104:107], v[60:63], v[124:127]
    v_cvt_pk_bf16_f32 v44, v116, v117
    v_cvt_pk_bf16_f32 v45, v118, v119
    v_mfma_f32_16x16x32_bf16 v[128:131], v[104:107], v[64:67], v[128:131]
    v_cvt_pk_bf16_f32 v46, v120, v121
    v_cvt_pk_bf16_f32 v47, v122, v123
    s_waitcnt lgkmcnt(5)
    v_mfma_f32_16x16x32_bf16 v[124:127], v[108:111], v[68:71], v[124:127]
    s_mov_b32 s3, 2097152
    buffer_store_dwordx4 v[44:47], v233, s[16:19], s3 offen sc0 sc1
    v_mfma_f32_16x16x32_bf16 v[128:131], v[108:111], v[72:75], v[128:131]
    s_waitcnt lgkmcnt(4)
    v_mfma_f32_16x16x32_bf16 v[124:127], v[112:115], v[76:79], v[124:127]
    v_mfma_f32_16x16x32_bf16 v[128:131], v[112:115], v[80:83], v[128:131]
    s_nop 3
    s_waitcnt lgkmcnt(3)
    v_mfma_f32_16x16x32_bf16 v[116:119], v[84:87], v[52:55], 0
    v_mfma_f32_16x16x32_bf16 v[120:123], v[84:87], v[56:59], 0
    s_waitcnt lgkmcnt(2)
    v_mfma_f32_16x16x32_bf16 v[116:119], v[88:91], v[60:63], v[116:119]
    v_cvt_pk_bf16_f32 v48, v124, v125
    v_cvt_pk_bf16_f32 v49, v126, v127
    v_mfma_f32_16x16x32_bf16 v[120:123], v[88:91], v[64:67], v[120:123]
    v_cvt_pk_bf16_f32 v50, v128, v129
    v_cvt_pk_bf16_f32 v51, v130, v131
    s_waitcnt lgkmcnt(1)
    v_mfma_f32_16x16x32_bf16 v[116:119], v[92:95], v[68:71], v[116:119]
    s_mov_b32 s3, 3145728
    buffer_store_dwordx4 v[48:51], v233, s[16:19], s3 offen sc0 sc1
    v_mfma_f32_16x16x32_bf16 v[120:123], v[92:95], v[72:75], v[120:123]
    s_waitcnt lgkmcnt(0)
    v_mfma_f32_16x16x32_bf16 v[116:119], v[96:99], v[76:79], v[116:119]
    v_mfma_f32_16x16x32_bf16 v[120:123], v[96:99], v[80:83], v[120:123]
    s_or_b32 s31, s2, s24
    s_cbranch_scc1 L_noep
    v_lshlrev_b32 v36, 2, v11
    v_mov_b32 v37, s26
    global_store_dword v36, v37, s[22:23] offset:0 sc0 sc1
L_noep:
    s_nop 5
    v_cvt_pk_bf16_f32 v44, v116, v117
    v_cvt_pk_bf16_f32 v45, v118, v119
    v_cvt_pk_bf16_f32 v46, v120, v121
    v_cvt_pk_bf16_f32 v47, v122, v123
    s_mov_b32 s3, 4194304
    buffer_store_dwordx4 v[44:47], v233, s[16:19], s3 offen sc0 sc1
L_end:
    s_endpgm
.section .rodata,"a"
.p2align 6
.amdhsa_kernel standalone__tensor_product_equiv_tfn__graph_kernel
  .amdhsa_next_free_vgpr 235
  .amdhsa_next_free_sgpr 102
  .amdhsa_accum_offset 236
  .amdhsa_group_segment_fixed_size 0
  .amdhsa_kernarg_size 88
  .amdhsa_user_sgpr_count 2
  .amdhsa_user_sgpr_kernarg_segment_ptr 1
  .amdhsa_system_sgpr_workgroup_id_x 1
  .amdhsa_float_denorm_mode_32 3
.end_amdhsa_kernel
```

```asm
; @launch grid=(256,1,1) block=(512,1,1) lds=163600
.amdgcn_target "amdgcn-amd-amdhsa--gfx950"
.text
.globl standalone__tensor_product_equiv_tfn__graph_kernel
.p2align 8
.type standalone__tensor_product_equiv_tfn__graph_kernel,@function
standalone__tensor_product_equiv_tfn__graph_kernel:
    s_load_dwordx16 s[4:19], s[0:1], 0
    s_load_dwordx2 s[22:23], s[0:1], 80
    s_load_dwordx2 s[20:21], s[0:1], 64
    s_cmp_ge_u32 s2, 256
    s_cbranch_scc1 L_end
    v_mul_u32_u24 v172, 3, v0
    s_mul_i32 s3, s2, 1250
    v_min_u32 v172, 1247, v172
    v_add_lshl_u32 v173, v172, s3, 2
    v_lshrrev_b32 v12, 6, v0
    v_and_b32 v13, 255, v0
    v_lshlrev_b32 v13, 2, v13
    v_mov_b32 v16, 0
    v_readfirstlane_b32 s24, v12
    ds_write_b32 v13, v16 offset:0
    v_lshlrev_b32 v174, 1, v173
    s_waitcnt lgkmcnt(0)
    global_load_dwordx3 v[132:134], v173, s[8:9]
    s_load_dword s26, s[22:23], 0
    s_barrier
    global_load_dwordx3 v[136:138], v173, s[6:7]
    global_load_dwordx4 v[140:143], v174, s[10:11]
    global_load_dwordx2 v[144:145], v174, s[10:11] offset:16
    v_lshlrev_b32 v188, 4, v0
    v_and_b32 v11, 63, v0
    s_lshl_b32 s30, s24, 10
    s_lshl_b32 s3, s3, 5
    s_add_u32 s12, s12, s3
    s_addc_u32 s13, s13, 0
    v_add_u32 v189, 8192, v188
    v_add_u32 v190, 16384, v188
    v_add_u32 v191, 24576, v188
    v_add_u32 v192, 32768, v188
    v_add_u32 v193, 40960, v188
    v_min_u32 v175, 39984, v192
    v_lshlrev_b32 v1, 4, v11
    s_barrier
    s_add_u32 m0, s30, 112384
    s_nop 0
    global_load_lds_dwordx4 v188, s[12:13]
    s_add_u32 m0, s30, 120576
    s_nop 0
    global_load_lds_dwordx4 v189, s[12:13]
    s_cmp_eq_u32 s24, 7
    s_cbranch_scc0 L_nocpf
    s_cmp_lt_u32 s2, 8
    s_cbranch_scc0 L_nocpf
    s_getpc_b64 s[68:69]
L_pc:
    v_and_b32 v18, 63, v0
    v_lshlrev_b32 v18, 7, v18
    v_mov_b32 v19, 0
    v_lshl_add_u64 v[20:21], v[18:19], 0, s[68:69]
    global_load_dword v204, v[20:21], off
    v_min_u32 v18, L_end-L_pc-8192, v18
    v_add_u32 v18, 8192, v18
    v_lshl_add_u64 v[20:21], v[18:19], 0, s[68:69]
    global_load_dword v205, v[20:21], off
L_nocpf:
    v_lshlrev_b32 v194, 2, v0
    v_lshlrev_b32 v14, 3, v0
    v_mov_b32 v16, 0
    v_mov_b32 v17, 0
    v_mov_b32 v15, 0x00300000
    ds_write_b64 v14, v[16:17] offset:16128
    ds_write_b32 v194, v15 offset:20224
    ds_write_b32 v194, v15 offset:22272
    ds_write_b32 v194, v15 offset:24320
    v_lshrrev_b32 v195, 1, v0
    v_lshlrev_b32 v195, 2, v195
    v_cmp_gt_u32 vcc, 416, v0
    s_mov_b64 s[36:37], vcc
    v_cmp_gt_u32 vcc, 417, v0
    s_mov_b64 s[38:39], vcc
    v_mov_b32 v12, 1
    s_movk_i32 s40, 1250
    s_mov_b32 s41, 63232
    s_lshr_b32 s27, s24, 2
    s_mov_b32 s28, 0
    s_waitcnt vmcnt(5)
    s_mov_b64 exec, s[38:39]
    v_and_b32 v153, 7, v133
    v_bfe_u32 v161, v133, 3, 5
    v_lshl_add_u32 v147, v153, 5, v161
    v_lshlrev_b32 v147, 2, v147
    ds_add_rtn_u32 v150, v147, v12 offset:0
    v_and_b32 v154, 7, v134
    v_bfe_u32 v162, v134, 3, 5
    v_lshl_add_u32 v148, v154, 5, v162
    v_lshlrev_b32 v148, 2, v148
    ds_add_rtn_u32 v151, v148, v12 offset:0
    s_mov_b64 exec, s[36:37]
    v_and_b32 v152, 7, v132
    v_bfe_u32 v160, v132, 3, 5
    v_lshl_add_u32 v146, v152, 5, v160
    v_lshlrev_b32 v146, 2, v146
    ds_add_rtn_u32 v149, v146, v12 offset:0
    s_mov_b64 exec, -1
    s_add_u32 m0, s30, 128768
    s_nop 0
    global_load_lds_dwordx4 v190, s[12:13]
    s_add_u32 m0, s30, 136960
    s_nop 0
    global_load_lds_dwordx4 v191, s[12:13]
    s_add_u32 m0, s30, 145152
    s_nop 0
    global_load_lds_dwordx4 v175, s[12:13]
    s_waitcnt lgkmcnt(0)
    s_barrier
    ds_read_b128 v[164:167], v1 offset:0
    s_mul_i32 s3, s2, 1280
    s_add_u32 s26, s26, 1
    s_waitcnt lgkmcnt(0)
    v_add_u32 v180, v164, v165
    v_add3_u32 v180, v180, v166, v167
    v_mov_b32 v181, v180
    v_lshrrev_b32 v132, 8, v132
    v_lshlrev_b32 v156, 26, v132
    v_add_u32_dpp v181, v181, v181 row_shr:1 row_mask:0xf bank_mask:0xf
    v_lshl_add_u32 v132, v132, 4, v156
    v_add_lshl_u32 v177, v172, 0, 5
    v_add_u32_dpp v181, v181, v181 row_shr:2 row_mask:0xf bank_mask:0xf
    v_lshrrev_b32 v133, 8, v133
    v_lshlrev_b32 v157, 26, v133
    v_add_u32_dpp v181, v181, v181 row_shr:4 row_mask:0xf bank_mask:0xf
    v_lshl_add_u32 v133, v133, 4, v157
    v_add_lshl_u32 v178, v172, 1, 5
    v_add_u32_dpp v181, v181, v181 row_shr:8 row_mask:0xf bank_mask:0xf
    v_lshrrev_b32 v134, 8, v134
    v_lshlrev_b32 v158, 26, v134
    v_add_u32_dpp v181, v181, v181 row_bcast:15 row_mask:0xa bank_mask:0xf
    v_lshl_add_u32 v134, v134, 4, v158
    v_add_lshl_u32 v179, v172, 2, 5
    v_add_u32_dpp v181, v181, v181 row_bcast:31 row_mask:0xc bank_mask:0xf
    v_sub_u32 v168, v181, v180
    v_add_u32 v169, v168, v164
    v_add_u32 v170, v169, v165
    v_add_u32 v171, v170, v166
    ds_write_b128 v1, v[168:171] offset:1024
    s_mov_b64 exec, s[38:39]
    ds_read_b32 v147, v147 offset:1024
    ds_read_b32 v148, v148 offset:1024
    s_mov_b64 exec, s[36:37]
    ds_read_b32 v146, v146 offset:1024
    s_mov_b64 exec, -1
    s_waitcnt vmcnt(5)
    v_mad_u32_u24 v152, v152, s40, v136
    v_lshl_add_u32 v132, v136, 10, v132
    v_subrev_u32 v156, 10000, v152
    v_min_u32 v152, v152, v156
    v_add_u32 v152, 350, v152
    v_mul_u32_u24 v152, 151, v152
    v_lshrrev_b32 v152, 17, v152
    v_add_u32 v152, v152, v132
    v_mad_u32_u24 v153, v153, s40, v137
    v_lshl_add_u32 v133, v137, 10, v133
    v_subrev_u32 v157, 10000, v153
    v_min_u32 v153, v153, v157
    v_add_u32 v153, 350, v153
    v_mul_u32_u24 v153, 151, v153
    v_lshrrev_b32 v153, 17, v153
    v_add_u32 v153, v153, v133
    v_mad_u32_u24 v154, v154, s40, v138
    v_lshl_add_u32 v134, v138, 10, v134
    v_subrev_u32 v158, 10000, v154
    v_min_u32 v154, v154, v158
    v_add_u32 v154, 350, v154
    v_mul_u32_u24 v154, 151, v154
    v_lshrrev_b32 v154, 17, v154
    v_add_u32 v154, v154, v134
    s_mov_b64 exec, s[38:39]
    s_waitcnt lgkmcnt(0)
    v_add_lshl_u32 v147, v147, v150, 1
    v_mad_u32_u24 v183, v147, 6, s41
    ds_write_b16 v147, v178 offset:2048
    ds_write2_b32 v183, v142, v143 offset1:1
    ds_write_b32 v183, v153 offset:8
    v_add_lshl_u32 v148, v148, v151, 1
    v_mad_u32_u24 v184, v148, 6, s41
    ds_write_b16 v148, v179 offset:2048
    ds_write2_b32 v184, v144, v145 offset1:1
    ds_write_b32 v184, v154 offset:8
    s_mov_b64 exec, s[36:37]
    v_add_lshl_u32 v146, v146, v149, 1
    v_mad_u32_u24 v182, v146, 6, s41
    ds_write_b16 v146, v177 offset:2048
    ds_write2_b32 v182, v140, v141 offset1:1
    ds_write_b32 v182, v152 offset:8
    s_mov_b64 exec, -1
    s_add_u32 m0, s30, 26368
    s_nop 0
    global_load_lds_dwordx4 v188, s[18:19]
    s_add_u32 m0, s30, 34560
    s_nop 0
    global_load_lds_dwordx4 v189, s[18:19]
    s_add_u32 m0, s30, 42752
    s_nop 0
    global_load_lds_dwordx4 v190, s[18:19]
    s_add_u32 m0, s30, 50944
    s_nop 0
    global_load_lds_dwordx4 v191, s[18:19]
    s_add_u32 s70, s30, 59136
    v_min_u32 v185, 112, v1
    s_cmp_lt_u32 s24, 4
    s_cselect_b64 vcc, -1, 0
    s_cselect_b32 m0, s70, 162560
    s_cselect_b64 s[68:69], s[14:15], s[16:17]
    v_cndmask_b32 v185, v185, v188, vcc
    global_load_lds_dwordx4 v185, s[68:69]
    v_add_u32 v168, s3, v168
    v_lshl_add_u32 v196, v164, 19, v168
    v_mov_b32 v197, s26
    v_add_u32 v169, s3, v169
    v_lshl_add_u32 v198, v165, 19, v169
    v_mov_b32 v199, s26
    v_add_u32 v170, s3, v170
    v_lshl_add_u32 v200, v166, 19, v170
    v_mov_b32 v201, s26
    v_add_u32 v171, s3, v171
    v_lshl_add_u32 v202, v167, 19, v171
    v_mov_b32 v203, s26
    s_mul_i32 s31, s2, 2048
    s_add_u32 s31, s31, 4096
    v_add_u32 v186, s31, v1
    s_mul_i32 s31, s3, 12
    s_add_u32 s31, s31, 1048576
    s_add_u32 s48, s22, s31
    s_addc_u32 s49, s23, 0
    s_mov_b32 s50, 15104
    s_mov_b32 s51, 0x00020000
    s_lshl_b32 s3, s3, 5
    s_add_u32 s31, s3, 8388608
    s_add_u32 s52, s22, s31
    s_addc_u32 s53, s23, 0
    s_mov_b32 s54, 40064
    s_mov_b32 s55, 0x00020000
    v_and_b32 v172, -2, v0
    v_and_b32 v173, 16, v188
    v_add_u32 v173, 112384, v173
    s_waitcnt lgkmcnt(0)
    s_barrier
    ds_read_b128 v[132:135], v188 offset:63232
    ds_read_b128 v[136:139], v189 offset:63232
    ds_read_u16 v174, v172 offset:2048
    ds_read_u16 v175, v172 offset:2560
    ds_read_u16 v176, v172 offset:3072
    ds_read_u16 v177, v172 offset:3584
    ds_read_u16 v178, v172 offset:4096
    s_cmp_eq_u32 s24, 7
    s_cbranch_scc0 L_nopub
    global_store_dwordx4 v186, v[196:199], s[22:23] sc0 sc1
    global_store_dwordx4 v186, v[200:203], s[22:23] offset:1024 sc0 sc1
L_nopub:
    s_mul_i32 s3, s2, 32
    s_add_u32 s3, s3, 983040
    v_lshl_add_u32 v186, v11, 2, s3
    s_waitcnt lgkmcnt(6)
    buffer_store_dwordx4 v[132:135], v188, s[48:51], 0 offen sc0 sc1
    s_waitcnt lgkmcnt(5)
    buffer_store_dwordx4 v[136:139], v189, s[48:51], 0 offen sc0 sc1
    s_waitcnt lgkmcnt(0)
    v_add_u32 v174, v174, v173
    v_add_u32 v175, v175, v173
    v_add_u32 v176, v176, v173
    v_add_u32 v177, v177, v173
    v_min_u32 v178, 39968, v178
    v_and_b32 v178, -16, v178
    v_add_u32 v178, v178, v173
    v_mov_b64 v[84:85], 0
    v_mov_b64 v[86:87], 0
    v_mov_b64 v[88:89], 0
    v_mov_b64 v[90:91], 0
    v_mov_b64 v[92:93], 0
    v_mov_b64 v[94:95], 0
    v_mov_b64 v[96:97], 0
    v_mov_b64 v[98:99], 0
    v_mov_b64 v[100:101], 0
    v_mov_b64 v[102:103], 0
    v_mov_b64 v[104:105], 0
    v_mov_b64 v[106:107], 0
    v_mov_b64 v[108:109], 0
    v_mov_b64 v[110:111], 0
    v_mov_b64 v[112:113], 0
    v_mov_b64 v[114:115], 0
    v_mov_b64 v[116:117], 0
    v_mov_b64 v[118:119], 0
    v_mov_b64 v[120:121], 0
    v_mov_b64 v[122:123], 0
    v_mov_b64 v[124:125], 0
    v_mov_b64 v[126:127], 0
    v_mov_b64 v[128:129], 0
    v_mov_b64 v[130:131], 0
    v_bfe_u32 v28, v11, 2, 1
    v_mul_u32_u24 v28, 0xaaaa, v28
    v_add_u32 v28, 0x4444, v28
    v_mov_b32 v29, 163584
    ds_write_b128 v29, v[84:87]
    v_lshrrev_b32 v2, 5, v11
    v_lshlrev_b32 v2, 4, v2
    v_and_b32 v3, 3, v11
    v_lshlrev_b32 v3, 3, v3
    v_add_u32 v3, 112384, v3
    s_sub_u32 s4, s4, 512
    s_subb_u32 s5, s5, 0
    s_mov_b32 s6, 10240512
    s_mov_b32 s7, 0x00020000
    s_add_u32 s8, s22, 1048576
    s_addc_u32 s9, s23, 0
    s_mov_b32 s10, 3932160
    s_mov_b32 s11, 0x00020000
    s_mov_b32 s101, 0
    s_cmp_lt_u32 s2, 16
    s_cbranch_scc1 L_r40
    s_cmp_eq_u32 s24, 0
    s_cselect_b32 s101, 0x245d2388, s101
    s_cmp_eq_u32 s24, 1
    s_cselect_b32 s101, 0x25753343, s101
    s_cmp_eq_u32 s24, 2
    s_cselect_b32 s101, 0x27449100, s101
    s_cmp_eq_u32 s24, 3
    s_cselect_b32 s101, 0x267d5301, s101
    s_cmp_eq_u32 s24, 4
    s_cselect_b32 s101, 0x2179a402, s101
    s_cmp_eq_u32 s24, 5
    s_cselect_b32 s101, 0x227162c6, s101
    s_cmp_eq_u32 s24, 6
    s_cselect_b32 s101, 0x206543c7, s101
    s_cmp_eq_u32 s24, 7
    s_cselect_b32 s101, 0x236d8285, s101
    s_branch L_rd
L_r40:
    s_cmp_eq_u32 s24, 0
    s_cselect_b32 s101, 0x2271a3c1, s101
    s_cmp_eq_u32 s24, 1
    s_cselect_b32 s101, 0x20750307, s101
    s_cmp_eq_u32 s24, 2
    s_cselect_b32 s101, 0x236d5205, s101
    s_cmp_eq_u32 s24, 3
    s_cselect_b32 s101, 0x27797340, s101
    s_cmp_eq_u32 s24, 4
    s_cselect_b32 s101, 0x256112c4, s101
    s_cmp_eq_u32 s24, 5
    s_cselect_b32 s101, 0x26653243, s101
    s_cmp_eq_u32 s24, 6
    s_cselect_b32 s101, 0x217d4382, s101
    s_cmp_eq_u32 s24, 7
    s_cselect_b32 s101, 0x24592286, s101
L_rd:
    s_and_b32 s3, s2, 7
    s_lshl_b32 s3, s3, 7
    s_bfe_u32 s31, s2, 196613
    s_lshl_b32 s31, s31, 4
    s_add_u32 s3, s3, s31
    s_and_b32 s31, s2, 8
    s_add_u32 s3, s3, s31
    s_and_b32 s31, s2, 16
    s_lshl_b32 s31, s31, 6
    s_add_u32 s3, s3, s31
    s_add_u32 s3, s3, 4096
    v_and_b32 v234, 255, v0
    v_mul_u32_u24 v187, 2048, v234
    v_add_u32 v187, s3, v187
    v_mul_u32_u24 v234, 32, v234
    v_add_u32 v234, 983040, v234
    s_waitcnt vmcnt(7)
    s_barrier
    ds_read_b128 v[144:147], v174
    ds_read_b128 v[148:151], v175
    ds_read_b128 v[152:155], v176
    ds_read_b128 v[156:159], v177
    ds_read_b128 v[160:163], v178
    s_waitcnt lgkmcnt(4)
    buffer_store_dwordx4 v[144:147], v188, s[52:55], 0 offen sc0 sc1
    s_waitcnt lgkmcnt(3)
    buffer_store_dwordx4 v[148:151], v189, s[52:55], 0 offen sc0 sc1
    s_waitcnt lgkmcnt(2)
    buffer_store_dwordx4 v[152:155], v190, s[52:55], 0 offen sc0 sc1
    s_waitcnt lgkmcnt(1)
    buffer_store_dwordx4 v[156:159], v191, s[52:55], 0 offen sc0 sc1
    s_waitcnt lgkmcnt(0)
    buffer_store_dwordx4 v[160:163], v192, s[52:55], 0 offen sc0 sc1
    s_add_u32 s12, s22, 8388608
    s_addc_u32 s13, s23, 0
    s_mov_b32 s14, 10485760
    s_mov_b32 s15, 0x00020000
    s_mov_b32 s16, s20
    s_mov_b32 s17, s21
    s_mov_b32 s18, 10240000
    s_mov_b32 s19, 0x00020000
    s_waitcnt vmcnt(0)
    s_barrier
    s_cmp_eq_u32 s24, 0
    s_cbranch_scc0 L_noflag
    s_mov_b64 exec, 0xff
    global_store_dword v186, v197, s[22:23] sc0 sc1
    s_mov_b64 exec, -1
L_noflag:
    s_barrier
    s_cmp_eq_u32 s27, 0
    s_cbranch_scc0 L_np0
    global_load_dwordx2 v[206:207], v187, s[22:23] sc1
L_np0:
    s_cmp_eq_u32 s27, 0
    s_cbranch_scc1 L_pfa
    s_sub_u32 s3, 0, s2
    s_and_b32 s3, s3, 7
    s_mul_i32 s3, s3, 1280000
    s_lshr_b32 s31, s2, 3
    s_mul_i32 s31, s31, 16640
    s_add_u32 s3, s3, s31
    s_add_u32 s3, s3, 512
    v_and_b32 v208, 255, v0
    v_cmp_gt_u32 vcc, 130, v208
    v_lshlrev_b32 v208, 7, v208
    v_mov_b32 v209, 0x7fffff00
    v_cndmask_b32 v208, v209, v208, vcc
    buffer_load_dword v210, v208, s[4:7], s3 offen
L_pfa:
    v_lshrrev_b32 v12, 5, v11
    v_and_b32 v13, 31, v11
    v_lshlrev_b32 v13, 2, v13
    v_lshl_add_u32 v12, v12, 10, v13
    s_and_b32 s3, s24, 2
    s_lshl_b32 s31, s3, 8
    s_lshl_b32 s68, s27, 11
    s_add_u32 s31, s31, s68
    s_and_b32 s3, s24, 1
    s_lshl_b32 s3, s3, 7
    s_add_u32 s31, s31, s3
    s_and_b32 s3, s24, 3
    v_add_u32 v12, s31, v12
    ds_read_b32 v132, v12 offset:59136
    ds_read_b32 v133, v12 offset:59392
    s_lshl_b32 s3, s3, 2
    s_lshl_b32 s31, s27, 10
    s_add_u32 s3, s3, s31
    v_add_u32 v16, s3, v1
    v_and_b32 v14, 3, v11
    v_bfe_u32 v15, v11, 2, 2
    v_lshlrev_b32 v15, 1, v15
    v_lshl_add_u32 v14, v14, 5, v15
    v_add_u32 v14, 162560, v14
    s_mov_b32 s68, 0xbfb8aa3b
    s_mov_b32 s69, s68
    ds_read_u16 v18, v14 offset:0
    ds_read_u16 v19, v14 offset:8
    ds_read_u16 v20, v14 offset:16
    ds_read_u16 v21, v14 offset:24
    s_waitcnt lgkmcnt(4)
    v_lshlrev_b32 v22, 16, v132
    v_lshlrev_b32 v23, 16, v133
    v_and_b32 v132, 0xffff0000, v132
    v_and_b32 v133, 0xffff0000, v133
    v_pk_mul_f32 v[22:23], v[22:23], s[68:69]
    v_pk_mul_f32 v[132:133], v[132:133], s[68:69]
    v_cvt_pk_bf16_f32 v134, v22, v23
    v_cvt_pk_bf16_f32 v135, v132, v133
    ds_write_b32 v16, v134 offset:8192
    ds_write_b32 v16, v135 offset:10240
    s_waitcnt lgkmcnt(0)
    v_lshl_or_b32 v228, v19, 16, v18
    v_lshl_or_b32 v229, v21, 16, v20
    s_mov_b32 s70, 0x05040100
    s_mov_b32 s71, 0x07060302
    s_and_b32 s3, s24, 3
    s_lshl_b32 s3, s3, 6
    v_lshrrev_b32 v16, 4, v11
    v_and_b32 v17, 15, v11
    v_lshl_add_u32 v17, v17, 2, s3
    v_lshl_add_u32 v16, v16, 11, v17
    ds_read_b32 v148, v16 offset:26368
    ds_read_b32 v149, v16 offset:26624
    ds_read_b32 v150, v16 offset:26880
    ds_read_b32 v151, v16 offset:27136
    ds_read_b32 v152, v16 offset:27392
    ds_read_b32 v153, v16 offset:27648
    ds_read_b32 v154, v16 offset:27904
    ds_read_b32 v155, v16 offset:28160
    s_waitcnt lgkmcnt(7)
    ds_read_b32 v156, v16 offset:34560
    ds_read_b32 v157, v16 offset:34816
    ds_read_b32 v158, v16 offset:35072
    ds_read_b32 v159, v16 offset:35328
    ds_read_b32 v160, v16 offset:35584
    ds_read_b32 v161, v16 offset:35840
    ds_read_b32 v162, v16 offset:36096
    ds_read_b32 v163, v16 offset:36352
    s_waitcnt lgkmcnt(8)
    v_perm_b32 v52, v149, v148, s70
    v_perm_b32 v56, v149, v148, s71
    v_perm_b32 v53, v151, v150, s70
    v_perm_b32 v57, v151, v150, s71
    v_perm_b32 v54, v153, v152, s70
    v_perm_b32 v58, v153, v152, s71
    v_perm_b32 v55, v155, v154, s70
    v_perm_b32 v59, v155, v154, s71
    s_waitcnt lgkmcnt(7)
    ds_read_b32 v148, v16 offset:42752
    ds_read_b32 v149, v16 offset:43008
    ds_read_b32 v150, v16 offset:43264
    ds_read_b32 v151, v16 offset:43520
    ds_read_b32 v152, v16 offset:43776
    ds_read_b32 v153, v16 offset:44032
    ds_read_b32 v154, v16 offset:44288
    ds_read_b32 v155, v16 offset:44544
    s_waitcnt lgkmcnt(8)
    v_perm_b32 v60, v157, v156, s70
    v_perm_b32 v64, v157, v156, s71
    v_perm_b32 v61, v159, v158, s70
    v_perm_b32 v65, v159, v158, s71
    v_perm_b32 v62, v161, v160, s70
    v_perm_b32 v66, v161, v160, s71
    v_perm_b32 v63, v163, v162, s70
    v_perm_b32 v67, v163, v162, s71
    s_waitcnt lgkmcnt(7)
    ds_read_b32 v156, v16 offset:50944
    ds_read_b32 v157, v16 offset:51200
    ds_read_b32 v158, v16 offset:51456
    ds_read_b32 v159, v16 offset:51712
    ds_read_b32 v160, v16 offset:51968
    ds_read_b32 v161, v16 offset:52224
    ds_read_b32 v162, v16 offset:52480
    ds_read_b32 v163, v16 offset:52736
    s_waitcnt lgkmcnt(8)
    v_perm_b32 v68, v149, v148, s70
    v_perm_b32 v72, v149, v148, s71
    v_perm_b32 v69, v151, v150, s70
    v_perm_b32 v73, v151, v150, s71
    v_perm_b32 v70, v153, v152, s70
    v_perm_b32 v74, v153, v152, s71
    v_perm_b32 v71, v155, v154, s70
    v_perm_b32 v75, v155, v154, s71
    s_waitcnt lgkmcnt(0)
    v_perm_b32 v76, v157, v156, s70
    v_perm_b32 v80, v157, v156, s71
    v_perm_b32 v77, v159, v158, s70
    v_perm_b32 v81, v159, v158, s71
    v_perm_b32 v78, v161, v160, s70
    v_perm_b32 v82, v161, v160, s71
    v_perm_b32 v79, v163, v162, s70
    v_perm_b32 v83, v163, v162, s71
    s_cmp_eq_u32 s27, 0
    s_cbranch_scc0 L_round
    s_mov_b32 s3, 0
    s_branch L_poll1
L_poll:
    global_load_dwordx2 v[206:207], v187, s[22:23] sc1
L_poll1:
    s_add_u32 s3, s3, 1
    s_waitcnt vmcnt(0)
    v_cmpx_ne_u32 vcc, s26, v207
    s_cbranch_execz L_pok
    s_cmp_lt_u32 s3, 4000000
    s_cbranch_scc1 L_poll
    v_mov_b32 v206, 0
L_pok:
    s_mov_b64 exec, -1
    v_add_u32 v14, 161536, v194
    ds_write_b32 v14, v206
L_round:
    v_add_u32 v15, 161536, v1
    s_and_b32 s31, s24, 3
    v_mov_b32 v148, 0
    s_waitcnt lgkmcnt(0)
    s_barrier
    ds_read_b128 v[140:143], v15
    s_cmp_lg_u32 s28, 0
    s_cbranch_scc1 L_npe
    s_cmp_eq_u32 s27, 0
    s_cbranch_scc1 L_npe
    global_load_dword v206, v234, s[22:23] sc1
L_npe:
    v_mul_u32_u24 v135, 12, v0
    v_add_u32 v136, 6144, v135
    v_add_u32 v137, 12288, v135
    s_waitcnt lgkmcnt(0)
    v_lshrrev_b32 v144, 19, v140
    v_lshrrev_b32 v145, 19, v141
    v_lshrrev_b32 v146, 19, v142
    v_lshrrev_b32 v147, 19, v143
    v_add_u32 v150, v144, v145
    v_add3_u32 v12, v150, v146, v147
    v_add_u32 v13, s28, v12
    v_mov_b32 v149, v144
    v_add_u32_dpp v12, v12, v12 row_shr:1 row_mask:0xf bank_mask:0xf
    v_add_u32 v151, v150, v146
    s_set_gpr_idx_on s31, gpr_idx(SRC0)
    v_mov_b32 v14, v140
    v_mov_b32 v15, v144
    v_mov_b32 v16, v148
    s_set_gpr_idx_off
    v_add_u32_dpp v12, v12, v12 row_shr:2 row_mask:0xf bank_mask:0xf
    v_and_b32 v14, 0x7ffff, v14
    v_sub_u32 v16, v16, v13
    v_add_u32_dpp v12, v12, v12 row_shr:4 row_mask:0xf bank_mask:0xf
    v_subrev_u32 v17, s27, v15
    s_mov_b32 s31, s27
    v_add_u32_dpp v12, v12, v12 row_shr:8 row_mask:0xf bank_mask:0xf
    s_nop 1
    v_add_u32_dpp v12, v12, v12 row_bcast:15 row_mask:0xa bank_mask:0xf
    s_nop 1
    v_add_u32_dpp v12, v12, v12 row_bcast:31 row_mask:0xc bank_mask:0xf
    v_add_u32 v16, v16, v12
    v_readlane_b32 s25, v12, 63
    v_sub_u32 v14, v14, v16
    v_add_lshl_u32 v18, v16, s27, 2
    s_cmp_gt_u32 s25, 1536
    s_cbranch_scc1 L_exp
    v_cmpx_lt_i32 vcc, 0, v17
    ds_write_b32 v18, v14 offset:20224
    v_cmpx_lt_i32 vcc, 2, v17
    ds_write_b32 v18, v14 offset:20232
    v_cmpx_lt_i32 vcc, 4, v17
    ds_write_b32 v18, v14 offset:20240
    v_cmpx_lt_i32 vcc, 6, v17
    ds_write_b32 v18, v14 offset:20248
    v_cmpx_lt_i32 vcc, 8, v17
    ds_write_b32 v18, v14 offset:20256
    v_cmpx_lt_i32 vcc, 10, v17
    ds_write_b32 v18, v14 offset:20264
    v_cmpx_lt_i32 vcc, 12, v17
    s_cbranch_execz L_expd
    s_add_u32 s31, s31, 12
L_exp:
    s_mov_b64 exec, -1
    v_cmp_lt_u32 vcc, s31, v15
    s_cbranch_vccz L_expd
    v_add_u32 v19, s31, v16
    s_movk_i32 s3, 1536
    v_cmp_gt_u32 s[68:69], s3, v19
    v_lshlrev_b32 v19, 2, v19
    s_and_b64 exec, vcc, s[68:69]
    ds_write_b32 v19, v14 offset:20224
    s_add_u32 s31, s31, 2
    s_branch L_exp
L_expd:
    s_mov_b64 exec, -1
    s_cmp_eq_u32 s27, 0
    s_cbranch_scc1 L_fok
    s_cmp_lg_u32 s28, 0
    s_cbranch_scc1 L_fok
    s_mov_b32 s3, 0
    s_waitcnt vmcnt(0)
    s_branch L_fp1
L_fp:
    global_load_dword v206, v234, s[22:23] sc1
    s_add_u32 s3, s3, 1
    s_waitcnt vmcnt(0)
L_fp1:
    v_cmpx_ne_u32 vcc, s26, v206
    s_cbranch_execz L_fok
    s_cmp_lt_u32 s3, 4000000
    s_cbranch_scc1 L_fp
    s_branch L_giveup
L_fok:
    s_mov_b64 exec, -1
    s_waitcnt lgkmcnt(0)
    s_barrier
    ds_read_b32 v132, v194 offset:20224
    ds_read_b32 v133, v194 offset:22272
    ds_read_b32 v134, v194 offset:24320
    ds_read_b32 v152, v195 offset:20224
    ds_read_b32 v153, v195 offset:21248
    ds_read_b32 v154, v195 offset:22272
    ds_read_b32 v155, v195 offset:23296
    ds_read_b32 v156, v195 offset:24320
    ds_read_b32 v157, v195 offset:25344
    s_waitcnt lgkmcnt(8)
    v_mad_i32_i24 v132, v132, 12, v135
    buffer_load_dwordx3 v[140:142], v132, s[8:11], 0 offen sc1
    s_waitcnt lgkmcnt(7)
    v_mad_i32_i24 v133, v133, 12, v136
    buffer_load_dwordx3 v[144:146], v133, s[8:11], 0 offen sc1
    s_waitcnt lgkmcnt(6)
    v_mad_i32_i24 v134, v134, 12, v137
    buffer_load_dwordx3 v[148:150], v134, s[8:11], 0 offen sc1
    s_waitcnt lgkmcnt(0)
    v_lshl_add_u32 v152, v152, 5, v188
    v_lshl_add_u32 v153, v153, 5, v189
    v_lshl_add_u32 v154, v154, 5, v190
    v_lshl_add_u32 v155, v155, 5, v191
    v_lshl_add_u32 v156, v156, 5, v192
    v_lshl_add_u32 v157, v157, 5, v193
    s_barrier
    s_add_u32 m0, s30, 63232
    s_nop 0
    buffer_load_dwordx4 v152, s[12:15], 0 offen sc1 lds
    s_sub_u32 s29, s25, s28
    s_min_u32 s29, s29, 1536
    s_lshl_b32 s3, s29, 4
    v_cmp_gt_u32 s[56:57], s3, v188
    v_lshlrev_b32 v159, 1, v188
    v_mov_b32 v143, 0
    v_cmp_gt_u32 s[58:59], s3, v189
    v_lshlrev_b32 v161, 1, v189
    v_mov_b32 v147, 0
    v_cmp_gt_u32 s[60:61], s3, v190
    v_lshlrev_b32 v163, 1, v190
    v_mov_b32 v151, 0
    v_and_b32 v4, 15, v11
    v_lshrrev_b32 v13, 4, v11
    s_mul_i32 s3, s27, 23040
    v_mul_u32_u24 v232, 288, v4
    v_lshl_add_u32 v232, v13, 4, v232
    v_add_u32 v232, s3, v232
    s_mul_i32 s68, s27, 5120
    s_add_u32 s68, s68, s2
    s_lshl_b32 s68, s68, 10
    s_and_b32 s3, s24, 3
    s_lshl_b32 s3, s3, 8
    s_add_u32 s68, s68, s3
    v_lshl_add_u32 v233, v13, 18, s68
    v_lshl_add_u32 v233, v4, 4, v233
    v_lshlrev_b32 v4, 3, v4
    v_bfe_u32 v5, v11, 3, 2
    v_and_b32 v12, 3, v11
    v_lshl_add_u32 v5, v5, 2, v12
    v_lshlrev_b32 v5, 3, v5
    v_lshrrev_b32 v6, 2, v11
    v_lshlrev_b32 v6, 3, v6
    v_mul_u32_u24 v16, 52, v11
    v_lshrrev_b32 v16, 8, v16
    v_mul_u32_u24 v17, 5, v16
    v_sub_u32 v17, v11, v17
    v_mul_u32_u24 v15, 6, v17
    v_bfe_u32 v15, s101, v15, 6
    v_lshlrev_b32 v15, 2, v15
    v_lshlrev_b32 v16, 2, v16
    v_lshlrev_b32 v17, 19, v17
    v_add_u32 v17, 33554432, v17
    s_mul_i32 s3, s24, 5
    v_lshlrev_b32 v18, 2, v11
    v_add_u32 v21, s3, v11
    v_lshlrev_b32 v19, 2, v21
    v_cmp_gt_u32 vcc, 40, v11
    v_add_u32 v20, 1, v11
    v_add_u32 v21, 1, v21
    v_cndmask_b32 v20, 0, v20, vcc
    s_cmp_gt_u32 s25, 1536
    s_cselect_b32 s69, 0, 8
    v_mov_b32 v22, 8
    s_cmp_lg_u32 s28, 0
    s_cbranch_scc1 L_nofr
    ds_read_b128 v[36:39], v1 offset:8192
    ds_read_b128 v[40:43], v1 offset:9216
    ds_read_b128 v[44:47], v1 offset:10240
    ds_read_b128 v[48:51], v1 offset:11264
L_nofr:
    s_waitcnt vmcnt(3)
    s_mov_b64 exec, s[56:57]
    v_and_b32 v143, 0x3ff, v142
    v_lshrrev_b32 v12, 24, v142
    v_lshlrev_b32 v143, 2, v143
    ds_add_u32 v12, v22 offset:18688
    ds_add_rtn_u32 v132, v143, v22 offset:16128
    s_waitcnt vmcnt(2)
    s_mov_b64 exec, s[58:59]
    v_and_b32 v147, 0x3ff, v146
    v_lshrrev_b32 v13, 24, v146
    v_lshlrev_b32 v147, 2, v147
    ds_add_u32 v13, v22 offset:18688
    ds_add_rtn_u32 v133, v147, v22 offset:16128
    s_waitcnt vmcnt(1)
    s_mov_b64 exec, s[60:61]
    v_and_b32 v151, 0x3ff, v150
    v_lshrrev_b32 v14, 24, v150
    v_lshlrev_b32 v151, 2, v151
    ds_add_u32 v14, v22 offset:18688
    ds_add_rtn_u32 v134, v151, v22 offset:16128
    s_mov_b64 exec, -1
    s_add_u32 m0, s30, 71424
    s_nop 0
    buffer_load_dwordx4 v153, s[12:15], 0 offen sc1 lds
    v_mfma_f32_4x4x4_16b_bf16 v[164:167], v[228:229], v[140:141], 0 cbsz:4 abid:0
    v_mfma_f32_4x4x4_16b_bf16 v[168:171], v[228:229], v[140:141], 0 cbsz:4 abid:1
    v_mfma_f32_4x4x4_16b_bf16 v[172:175], v[228:229], v[140:141], 0 cbsz:4 abid:2
    v_mfma_f32_4x4x4_16b_bf16 v[176:179], v[228:229], v[140:141], 0 cbsz:4 abid:3
    v_add_u32 v23, 112384, v159
    s_nop 0
    v_cvt_pk_bf16_f32 v180, v164, v165
    v_cvt_pk_bf16_f32 v181, v166, v167
    v_cvt_pk_bf16_f32 v182, v168, v169
    v_cvt_pk_bf16_f32 v183, v170, v171
    v_cvt_pk_bf16_f32 v184, v172, v173
    v_cvt_pk_bf16_f32 v185, v174, v175
    v_cvt_pk_bf16_f32 v186, v176, v177
    v_cvt_pk_bf16_f32 v187, v178, v179
    s_waitcnt lgkmcnt(0)
    s_barrier
    ds_read_b32 v12, v18 offset:18688
    ds_read_b32 v13, v19 offset:18688
    ds_write_b128 v23, v[180:183]
    ds_write_b128 v23, v[184:187] offset:16
    v_lshlrev_b32 v19, 4, v19
    v_and_b32 v142, 0xfffc00, v142
    v_and_b32 v146, 0xfffc00, v146
    v_and_b32 v150, 0xfffc00, v150
    s_waitcnt lgkmcnt(2)
    v_mad_u32_u24 v21, v13, s69, v21
    v_mad_u32_u24 v20, v12, s69, v20
    v_readlane_b32 s96, v21, 0
    v_readlane_b32 s97, v21, 1
    v_readlane_b32 s98, v21, 2
    v_readlane_b32 s99, v21, 3
    v_readlane_b32 s100, v21, 4
    v_lshl_add_u32 v19, v13, 16, v19
    v_cmp_lt_u32 s[36:37], s96, v20
    v_cmp_lt_u32 s[38:39], s97, v20
    v_cmp_lt_u32 s[40:41], s98, v20
    v_cmp_lt_u32 s[42:43], s99, v20
    v_cmp_lt_u32 s[44:45], s100, v20
    s_bcnt1_i32_b64 s96, s[36:37]
    v_writelane_b32 v12, s96, 0
    s_bcnt1_i32_b64 s97, s[38:39]
    v_writelane_b32 v12, s97, 1
    s_bcnt1_i32_b64 s98, s[40:41]
    v_writelane_b32 v12, s98, 2
    s_bcnt1_i32_b64 s99, s[42:43]
    v_writelane_b32 v12, s99, 3
    s_bcnt1_i32_b64 s100, s[44:45]
    v_writelane_b32 v12, s100, 4
    s_mov_b64 exec, 31
    v_lshlrev_b32 v12, 2, v12
    ds_write_b32 v12, v19 offset:19200
    s_mov_b64 exec, -1
    s_add_u32 m0, s30, 79616
    s_nop 0
    buffer_load_dwordx4 v154, s[12:15], 0 offen sc1 lds
    s_add_u32 m0, s30, 87808
    s_nop 0
    buffer_load_dwordx4 v155, s[12:15], 0 offen sc1 lds
    s_waitcnt lgkmcnt(0)
    s_barrier
    ds_read_b32 v12, v15 offset:19200
    v_mfma_f32_4x4x4_16b_bf16 v[164:167], v[228:229], v[144:145], 0 cbsz:4 abid:0
    v_mfma_f32_4x4x4_16b_bf16 v[168:171], v[228:229], v[144:145], 0 cbsz:4 abid:1
    v_mfma_f32_4x4x4_16b_bf16 v[172:175], v[228:229], v[144:145], 0 cbsz:4 abid:2
    v_mfma_f32_4x4x4_16b_bf16 v[176:179], v[228:229], v[144:145], 0 cbsz:4 abid:3
    v_add_u32 v23, 112384, v161
    s_nop 0
    v_cvt_pk_bf16_f32 v180, v164, v165
    v_cvt_pk_bf16_f32 v181, v166, v167
    v_cvt_pk_bf16_f32 v182, v168, v169
    v_cvt_pk_bf16_f32 v183, v170, v171
    v_cvt_pk_bf16_f32 v184, v172, v173
    v_cvt_pk_bf16_f32 v185, v174, v175
    v_cvt_pk_bf16_f32 v186, v176, v177
    v_cvt_pk_bf16_f32 v187, v178, v179
    s_waitcnt lgkmcnt(0)
    v_add_u32_sdwa v16, v12, v16 dst_sel:DWORD dst_unused:UNUSED_PAD src0_sel:WORD_0 src1_sel:DWORD
    ds_read_b32 v13, v16 offset:16128
    v_readlane_b32 s96, v12, 0
    v_readlane_b32 s97, v12, 1
    v_readlane_b32 s98, v12, 2
    v_readlane_b32 s99, v12, 3
    v_readlane_b32 s100, v12, 4
    s_add_u32 s3, s96, s97
    s_add_u32 s3, s3, s98
    s_add_u32 s3, s3, s99
    s_add_u32 s3, s3, s100
    s_lshr_b32 s29, s3, 16
    s_add_u32 s3, s29, 480
    v_mov_b32 v14, s3
    v_mov_b32 v18, 0
    s_mov_b64 exec, 1
    ds_add_rtn_u32 v14, v18, v14 offset:19456
    s_mov_b64 exec, -1
    s_waitcnt lgkmcnt(1)
    v_sub_u32 v17, v17, v13
    s_nop 0
    v_add_u32_dpp v13, v13, v13 row_shr:1 row_mask:0xf bank_mask:0xf
    s_nop 1
    v_add_u32_dpp v13, v13, v13 row_shr:2 row_mask:0xf bank_mask:0xf
    v_mov_b32 v20, 2147482664
    v_mov_b32 v21, 0
    v_add_u32_dpp v13, v13, v13 row_shr:4 row_mask:0xf bank_mask:0xf
    s_sub_u32 s3, 0, s29
    s_bfe_u32 s3, s3, 65539
    s_add_u32 s3, s3, 7
    v_writelane_b32 v20, 40, s3
    v_add_u32_dpp v13, v13, v13 row_shr:8 row_mask:0xf bank_mask:0xf
    s_waitcnt lgkmcnt(0)
    v_readfirstlane_b32 s71, v14
    v_add_u32_dpp v13, v13, v13 row_bcast:15 row_mask:0xa bank_mask:0xf
    s_add_u32 s3, s71, s29
    v_lshl_add_u32 v18, v11, 3, s3
    v_add_u32_dpp v13, v13, v13 row_bcast:31 row_mask:0xc bank_mask:0xf
    s_mov_b32 exec_hi, 0x0fffffff
    v_add3_u32 v13, v13, v17, s71
    ds_write_b32 v16, v13 offset:16128
    ds_write_b64 v18, v[20:21] offset:0
    s_mov_b64 exec, -1
    ds_write_b128 v23, v[180:183]
    ds_write_b128 v23, v[184:187] offset:16
    s_add_u32 m0, s30, 96000
    s_nop 0
    buffer_load_dwordx4 v156, s[12:15], 0 offen sc1 lds
    s_waitcnt lgkmcnt(2)
    s_barrier
    ds_read_b32 v12, v143 offset:16128
    ds_read_b32 v13, v147 offset:16128
    ds_read_b32 v14, v151 offset:16128
    v_add_u32 v4, s71, v4
    v_add_u32 v5, s71, v5
    v_add_u32 v6, s71, v6
    s_lshr_b32 s29, s29, 3
    s_mov_b64 exec, s[56:57]
    s_waitcnt lgkmcnt(2)
    v_add_u32_sdwa v132, v12, v132 dst_sel:DWORD dst_unused:UNUSED_PAD src0_sel:WORD_0 src1_sel:DWORD
    v_or_b32_sdwa v158, v12, v142 dst_sel:DWORD dst_unused:UNUSED_PAD src0_sel:WORD_1 src1_sel:DWORD
    ds_write_b64 v132, v[158:159] offset:0
    s_mov_b64 exec, s[58:59]
    s_waitcnt lgkmcnt(2)
    v_add_u32_sdwa v133, v13, v133 dst_sel:DWORD dst_unused:UNUSED_PAD src0_sel:WORD_0 src1_sel:DWORD
    v_or_b32_sdwa v160, v13, v146 dst_sel:DWORD dst_unused:UNUSED_PAD src0_sel:WORD_1 src1_sel:DWORD
    ds_write_b64 v133, v[160:161] offset:0
    s_mov_b64 exec, s[60:61]
    s_waitcnt lgkmcnt(2)
    v_add_u32_sdwa v134, v14, v134 dst_sel:DWORD dst_unused:UNUSED_PAD src0_sel:WORD_0 src1_sel:DWORD
    v_or_b32_sdwa v162, v14, v150 dst_sel:DWORD dst_unused:UNUSED_PAD src0_sel:WORD_1 src1_sel:DWORD
    ds_write_b64 v134, v[162:163] offset:0
    s_mov_b64 exec, -1
    s_add_u32 m0, s30, 104192
    s_nop 0
    buffer_load_dwordx4 v157, s[12:15], 0 offen sc1 lds
    s_waitcnt lgkmcnt(0)
    s_barrier
    ds_read_b32 v12, v4
    ds_read_b32 v7, v4 offset:56
    ds_read_b32 v9, v5 offset:4
    ds_read_b32 v10, v6 offset:4
    s_cmp_eq_u64 s[60:61], 0
    s_cbranch_scc1 L_not3
    v_mfma_f32_4x4x4_16b_bf16 v[164:167], v[228:229], v[148:149], 0 cbsz:4 abid:0
    v_mfma_f32_4x4x4_16b_bf16 v[168:171], v[228:229], v[148:149], 0 cbsz:4 abid:1
    v_mfma_f32_4x4x4_16b_bf16 v[172:175], v[228:229], v[148:149], 0 cbsz:4 abid:2
    v_mfma_f32_4x4x4_16b_bf16 v[176:179], v[228:229], v[148:149], 0 cbsz:4 abid:3
    v_add_u32 v23, 112384, v163
    s_nop 0
    v_cvt_pk_bf16_f32 v180, v164, v165
    v_cvt_pk_bf16_f32 v181, v166, v167
    v_cvt_pk_bf16_f32 v182, v168, v169
    v_cvt_pk_bf16_f32 v183, v170, v171
    v_cvt_pk_bf16_f32 v184, v172, v173
    v_cvt_pk_bf16_f32 v185, v174, v175
    v_cvt_pk_bf16_f32 v186, v176, v177
    v_cvt_pk_bf16_f32 v187, v178, v179
    ds_write_b128 v23, v[180:183]
    ds_write_b128 v23, v[184:187] offset:16
    s_waitcnt lgkmcnt(2)
    s_branch L_t3
L_not3:
    s_waitcnt lgkmcnt(0)
L_t3:
    v_readlane_b32 s36, v12, 0
    v_readlane_b32 s37, v12, 1
    v_readlane_b32 s38, v12, 2
    v_readlane_b32 s39, v12, 3
    s_and_b32 s70, s36, 4294966784
    buffer_load_dwordx4 v[196:199], v1, s[4:7], s70 offen
    s_and_b32 s71, s37, 4294966784
    buffer_load_dwordx4 v[200:203], v1, s[4:7], s71 offen
    s_and_b32 s70, s38, 4294966784
    buffer_load_dwordx4 v[204:207], v1, s[4:7], s70 offen
    s_and_b32 s71, s39, 4294966784
    buffer_load_dwordx4 v[208:211], v1, s[4:7], s71 offen
    v_readlane_b32 s40, v12, 4
    v_readlane_b32 s41, v12, 5
    v_readlane_b32 s42, v12, 6
    v_add_u32 v9, v9, v2
    v_add_u32 v10, v10, v3
    v_readlane_b32 s43, v7, 0
    s_and_b32 s96, s96, 0xffff
    s_mulk_i32 s96, 18
    s_and_b32 s97, s97, 0xffff
    s_mulk_i32 s97, 18
    s_and_b32 s98, s98, 0xffff
    s_mulk_i32 s98, 18
    s_and_b32 s99, s99, 0xffff
    s_mulk_i32 s99, 18
    s_and_b32 s100, s100, 0xffff
    s_mulk_i32 s100, 18
    s_and_b32 s68, s43, 4294966784
    ds_read_b128 v[132:135], v29
    ds_read_b128 v[136:139], v29
    ds_read_b128 v[140:143], v29
    ds_read_b128 v[144:147], v29
    ds_read_b128 v[148:151], v29
    ds_read_b128 v[152:155], v29
    ds_read_b128 v[156:159], v29
    ds_read_b128 v[160:163], v29
    s_waitcnt vmcnt(4) lgkmcnt(0)
    s_barrier
    s_cmp_eq_u32 s29, 0
    s_cbranch_scc1 L_exit
    s_sub_u32 s29, s29, 1
    ds_read_b128 v[24:27], v9 offset:63232
    ds_read_b64 v[32:33], v10
    s_and_b32 s70, s40, 4294966784
    buffer_load_dwordx4 v[212:215], v1, s[4:7], s70 offen
    s_and_b32 s71, s41, 4294966784
    buffer_load_dwordx4 v[216:219], v1, s[4:7], s71 offen
    s_waitcnt lgkmcnt(1)
    v_smfmac_f32_32x32x32_bf16 v[132:147], v[24:27], v[36:43], v28
    v_smfmac_f32_32x32x32_bf16 v[148:163], v[24:27], v[44:51], v28
    s_and_b32 s70, s42, 4294966784
    buffer_load_dwordx4 v[220:223], v1, s[4:7], s70 offen
    s_waitcnt lgkmcnt(0)
    s_nop 8
    v_exp_f32 v12, v132
    v_exp_f32 v13, v133
    v_exp_f32 v14, v148
    v_exp_f32 v15, v149
    v_pk_add_f32 v[12:13], v[12:13], 1.0 op_sel_hi:[1,0]
    v_pk_add_f32 v[14:15], v[14:15], 1.0 op_sel_hi:[1,0]
    v_rcp_f32 v12, v12
    v_rcp_f32 v13, v13
    s_nop 0
    v_pk_mul_f32 v[132:133], v[132:133], v[12:13]
L_loop:
    s_setprio 3
    ds_read_b32 v9, v5 offset:132
    ds_read_b32 v10, v6 offset:132
    ds_read_b32 v8, v4 offset:184
    ds_read_b128 v[164:167], v29
    s_waitcnt vmcnt(6)
    v_rcp_f32 v14, v14
    v_mfma_f32_4x4x4_16b_bf16 v[16:19], v[32:33], v[196:197], 0 cbsz:4 abid:0
    v_exp_f32 v13, v135
    v_mfma_f32_4x4x4_16b_bf16 v[20:23], v[32:33], v[198:199], 0 cbsz:4 abid:0
    v_exp_f32 v12, v134
    v_readlane_b32 s44, v7, 1
    v_rcp_f32 v15, v15
    v_pk_add_f32 v[12:13], v[12:13], 1.0 op_sel_hi:[1,0]
    v_pk_mul_f32 v[148:149], v[148:149], v[14:15]
    s_and_b32 s69, s44, 4294966784
    s_set_gpr_idx_on s36, gpr_idx(SRC2,DST)
    buffer_load_dwordx4 v[224:227], v1, s[4:7], s68 offen
    v_pk_fma_f32 v[84:85], v[132:133], v[16:17], v[84:85] op_sel_hi:[0,1,1]
    v_pk_fma_f32 v[86:87], v[132:133], v[18:19], v[86:87] op_sel_hi:[0,1,1]
    v_pk_fma_f32 v[88:89], v[148:149], v[20:21], v[88:89] op_sel_hi:[0,1,1]
    v_pk_fma_f32 v[90:91], v[148:149], v[22:23], v[90:91] op_sel_hi:[0,1,1]
    s_set_gpr_idx_off
    ds_read_b128 v[168:171], v29
    s_waitcnt vmcnt(6)
    v_rcp_f32 v12, v12
    v_mfma_f32_4x4x4_16b_bf16 v[16:19], v[32:33], v[200:201], 0 cbsz:4 abid:1
    v_exp_f32 v15, v151
    v_mfma_f32_4x4x4_16b_bf16 v[20:23], v[32:33], v[202:203], 0 cbsz:4 abid:1
    v_exp_f32 v14, v150
    v_readlane_b32 s45, v7, 2
    v_rcp_f32 v13, v13
    v_pk_add_f32 v[14:15], v[14:15], 1.0 op_sel_hi:[1,0]
    v_pk_mul_f32 v[134:135], v[134:135], v[12:13]
    s_and_b32 s68, s45, 4294966784
    s_set_gpr_idx_on s37, gpr_idx(SRC2,DST)
    buffer_load_dwordx4 v[196:199], v1, s[4:7], s69 offen
    v_pk_fma_f32 v[84:85], v[132:133], v[16:17], v[84:85] op_sel:[1,0,0]
    v_pk_fma_f32 v[86:87], v[132:133], v[18:19], v[86:87] op_sel:[1,0,0]
    v_pk_fma_f32 v[88:89], v[148:149], v[20:21], v[88:89] op_sel:[1,0,0]
    v_pk_fma_f32 v[90:91], v[148:149], v[22:23], v[90:91] op_sel:[1,0,0]
    s_set_gpr_idx_off
    s_cbranch_scc0 L_exit
    s_waitcnt lgkmcnt(0)
    v_add_u32 v9, v9, v2
    v_add_u32 v10, v10, v3
    ds_read_b128 v[24:27], v9 offset:63232
    ds_read_b64 v[34:35], v10
    ds_read_b128 v[172:175], v29
    s_waitcnt vmcnt(6)
    v_rcp_f32 v14, v14
    v_mfma_f32_4x4x4_16b_bf16 v[16:19], v[32:33], v[204:205], 0 cbsz:4 abid:2
    v_exp_f32 v13, v137
    v_mfma_f32_4x4x4_16b_bf16 v[20:23], v[32:33], v[206:207], 0 cbsz:4 abid:2
    v_exp_f32 v12, v136
    v_readlane_b32 s46, v7, 3
    v_rcp_f32 v15, v15
    v_pk_add_f32 v[12:13], v[12:13], 1.0 op_sel_hi:[1,0]
    v_pk_mul_f32 v[150:151], v[150:151], v[14:15]
    s_and_b32 s69, s46, 4294966784
    s_set_gpr_idx_on s38, gpr_idx(SRC2,DST)
    buffer_load_dwordx4 v[200:203], v1, s[4:7], s68 offen
    v_pk_fma_f32 v[84:85], v[134:135], v[16:17], v[84:85] op_sel_hi:[0,1,1]
    v_pk_fma_f32 v[86:87], v[134:135], v[18:19], v[86:87] op_sel_hi:[0,1,1]
    v_pk_fma_f32 v[88:89], v[150:151], v[20:21], v[88:89] op_sel_hi:[0,1,1]
    v_pk_fma_f32 v[90:91], v[150:151], v[22:23], v[90:91] op_sel_hi:[0,1,1]
    s_set_gpr_idx_off
    ds_read_b128 v[176:179], v29
    s_waitcnt vmcnt(6)
    v_rcp_f32 v12, v12
    v_mfma_f32_4x4x4_16b_bf16 v[16:19], v[32:33], v[208:209], 0 cbsz:4 abid:3
    v_exp_f32 v15, v153
    v_mfma_f32_4x4x4_16b_bf16 v[20:23], v[32:33], v[210:211], 0 cbsz:4 abid:3
    v_exp_f32 v14, v152
    v_readlane_b32 s47, v7, 4
    v_rcp_f32 v13, v13
    v_pk_add_f32 v[14:15], v[14:15], 1.0 op_sel_hi:[1,0]
    v_pk_mul_f32 v[136:137], v[136:137], v[12:13]
    s_and_b32 s68, s47, 4294966784
    s_set_gpr_idx_on s39, gpr_idx(SRC2,DST)
    buffer_load_dwordx4 v[204:207], v1, s[4:7], s69 offen
    v_pk_fma_f32 v[84:85], v[134:135], v[16:17], v[84:85] op_sel:[1,0,0]
    v_pk_fma_f32 v[86:87], v[134:135], v[18:19], v[86:87] op_sel:[1,0,0]
    v_pk_fma_f32 v[88:89], v[150:151], v[20:21], v[88:89] op_sel:[1,0,0]
    v_pk_fma_f32 v[90:91], v[150:151], v[22:23], v[90:91] op_sel:[1,0,0]
    s_set_gpr_idx_off
    s_cbranch_scc0 L_exit
    s_setprio 2
    ds_read_b128 v[180:183], v29
    s_waitcnt vmcnt(6)
    v_rcp_f32 v14, v14
    v_mfma_f32_4x4x4_16b_bf16 v[16:19], v[32:33], v[212:213], 0 cbsz:4 abid:4
    v_exp_f32 v13, v139
    v_mfma_f32_4x4x4_16b_bf16 v[20:23], v[32:33], v[214:215], 0 cbsz:4 abid:4
    v_exp_f32 v12, v138
    v_readlane_b32 s48, v7, 5
    v_rcp_f32 v15, v15
    v_pk_add_f32 v[12:13], v[12:13], 1.0 op_sel_hi:[1,0]
    v_pk_mul_f32 v[152:153], v[152:153], v[14:15]
    s_and_b32 s69, s48, 4294966784
    s_set_gpr_idx_on s40, gpr_idx(SRC2,DST)
    buffer_load_dwordx4 v[208:211], v1, s[4:7], s68 offen
    v_pk_fma_f32 v[84:85], v[136:137], v[16:17], v[84:85] op_sel_hi:[0,1,1]
    v_pk_fma_f32 v[86:87], v[136:137], v[18:19], v[86:87] op_sel_hi:[0,1,1]
    v_pk_fma_f32 v[88:89], v[152:153], v[20:21], v[88:89] op_sel_hi:[0,1,1]
    v_pk_fma_f32 v[90:91], v[152:153], v[22:23], v[90:91] op_sel_hi:[0,1,1]
    s_set_gpr_idx_off
    ds_read_b128 v[184:187], v29
    s_waitcnt vmcnt(6)
    v_rcp_f32 v12, v12
    v_mfma_f32_4x4x4_16b_bf16 v[16:19], v[32:33], v[216:217], 0 cbsz:4 abid:5
    v_exp_f32 v15, v155
    v_mfma_f32_4x4x4_16b_bf16 v[20:23], v[32:33], v[218:219], 0 cbsz:4 abid:5
    v_exp_f32 v14, v154
    v_readlane_b32 s49, v7, 6
    v_rcp_f32 v13, v13
    v_pk_add_f32 v[14:15], v[14:15], 1.0 op_sel_hi:[1,0]
    v_pk_mul_f32 v[138:139], v[138:139], v[12:13]
    s_and_b32 s68, s49, 4294966784
    s_set_gpr_idx_on s41, gpr_idx(SRC2,DST)
    buffer_load_dwordx4 v[212:215], v1, s[4:7], s69 offen
    v_pk_fma_f32 v[84:85], v[136:137], v[16:17], v[84:85] op_sel:[1,0,0]
    v_pk_fma_f32 v[86:87], v[136:137], v[18:19], v[86:87] op_sel:[1,0,0]
    v_pk_fma_f32 v[88:89], v[152:153], v[20:21], v[88:89] op_sel:[1,0,0]
    v_pk_fma_f32 v[90:91], v[152:153], v[22:23], v[90:91] op_sel:[1,0,0]
    s_set_gpr_idx_off
    s_cbranch_scc0 L_exit
    ds_read_b128 v[188:191], v29
    s_waitcnt vmcnt(6)
    v_rcp_f32 v14, v14
    v_mfma_f32_4x4x4_16b_bf16 v[16:19], v[32:33], v[220:221], 0 cbsz:4 abid:6
    v_exp_f32 v13, v141
    v_mfma_f32_4x4x4_16b_bf16 v[20:23], v[32:33], v[222:223], 0 cbsz:4 abid:6
    v_exp_f32 v12, v140
    v_readlane_b32 s50, v7, 7
    v_rcp_f32 v15, v15
    v_pk_add_f32 v[12:13], v[12:13], 1.0 op_sel_hi:[1,0]
    v_pk_mul_f32 v[154:155], v[154:155], v[14:15]
    s_and_b32 s69, s50, 4294966784
    s_set_gpr_idx_on s42, gpr_idx(SRC2,DST)
    buffer_load_dwordx4 v[216:219], v1, s[4:7], s68 offen
    v_pk_fma_f32 v[84:85], v[138:139], v[16:17], v[84:85] op_sel_hi:[0,1,1]
    v_pk_fma_f32 v[86:87], v[138:139], v[18:19], v[86:87] op_sel_hi:[0,1,1]
    v_pk_fma_f32 v[88:89], v[154:155], v[20:21], v[88:89] op_sel_hi:[0,1,1]
    v_pk_fma_f32 v[90:91], v[154:155], v[22:23], v[90:91] op_sel_hi:[0,1,1]
    s_set_gpr_idx_off
    ds_read_b128 v[192:195], v29
    s_waitcnt vmcnt(6)
    v_rcp_f32 v12, v12
    v_mfma_f32_4x4x4_16b_bf16 v[16:19], v[32:33], v[224:225], 0 cbsz:4 abid:7
    v_exp_f32 v15, v157
    v_mfma_f32_4x4x4_16b_bf16 v[20:23], v[32:33], v[226:227], 0 cbsz:4 abid:7
    v_exp_f32 v14, v156
    v_readlane_b32 s51, v7, 8
    v_rcp_f32 v13, v13
    v_pk_add_f32 v[14:15], v[14:15], 1.0 op_sel_hi:[1,0]
    v_pk_mul_f32 v[140:141], v[140:141], v[12:13]
    s_and_b32 s68, s51, 4294966784
    s_set_gpr_idx_on s43, gpr_idx(SRC2,DST)
    buffer_load_dwordx4 v[220:223], v1, s[4:7], s69 offen
    v_pk_fma_f32 v[84:85], v[138:139], v[16:17], v[84:85] op_sel:[1,0,0]
    v_pk_fma_f32 v[86:87], v[138:139], v[18:19], v[86:87] op_sel:[1,0,0]
    v_pk_fma_f32 v[88:89], v[154:155], v[20:21], v[88:89] op_sel:[1,0,0]
    v_pk_fma_f32 v[90:91], v[154:155], v[22:23], v[90:91] op_sel:[1,0,0]
    s_set_gpr_idx_off
    s_cbranch_scc0 L_exit
    s_setprio 1
    s_waitcnt vmcnt(6)
    v_rcp_f32 v14, v14
    v_mfma_f32_4x4x4_16b_bf16 v[16:19], v[32:33], v[196:197], 0 cbsz:4 abid:8
    v_exp_f32 v13, v143
    v_mfma_f32_4x4x4_16b_bf16 v[20:23], v[32:33], v[198:199], 0 cbsz:4 abid:8
    v_exp_f32 v12, v142
    v_readlane_b32 s52, v7, 9
    v_rcp_f32 v15, v15
    v_pk_add_f32 v[12:13], v[12:13], 1.0 op_sel_hi:[1,0]
    v_pk_mul_f32 v[156:157], v[156:157], v[14:15]
    s_and_b32 s69, s52, 4294966784
    s_set_gpr_idx_on s44, gpr_idx(SRC2,DST)
    buffer_load_dwordx4 v[224:227], v1, s[4:7], s68 offen
    v_pk_fma_f32 v[84:85], v[140:141], v[16:17], v[84:85] op_sel_hi:[0,1,1]
    v_pk_fma_f32 v[86:87], v[140:141], v[18:19], v[86:87] op_sel_hi:[0,1,1]
    v_pk_fma_f32 v[88:89], v[156:157], v[20:21], v[88:89] op_sel_hi:[0,1,1]
    v_pk_fma_f32 v[90:91], v[156:157], v[22:23], v[90:91] op_sel_hi:[0,1,1]
    s_set_gpr_idx_off
    s_waitcnt vmcnt(6) lgkmcnt(0)
    v_mfma_f32_4x4x4_16b_bf16 v[20:23], v[32:33], v[202:203], 0 cbsz:4 abid:9
    v_mfma_f32_4x4x4_16b_bf16 v[16:19], v[32:33], v[200:201], 0 cbsz:4 abid:9
    v_rcp_f32 v13, v13
    v_smfmac_f32_32x32x32_bf16 v[164:179], v[24:27], v[36:43], v28
    v_exp_f32 v14, v158
    v_exp_f32 v15, v159
    v_readlane_b32 s53, v7, 10
    v_rcp_f32 v12, v12
    v_pk_add_f32 v[14:15], v[14:15], 1.0 op_sel_hi:[1,0]
    v_pk_mul_f32 v[142:143], v[142:143], v[12:13]
    s_and_b32 s68, s53, 4294966784
    s_set_gpr_idx_on s45, gpr_idx(SRC2,DST)
    buffer_load_dwordx4 v[196:199], v1, s[4:7], s69 offen
    v_pk_fma_f32 v[84:85], v[140:141], v[16:17], v[84:85] op_sel:[1,0,0]
    v_pk_fma_f32 v[86:87], v[140:141], v[18:19], v[86:87] op_sel:[1,0,0]
    v_pk_fma_f32 v[88:89], v[156:157], v[20:21], v[88:89] op_sel:[1,0,0]
    v_pk_fma_f32 v[90:91], v[156:157], v[22:23], v[90:91] op_sel:[1,0,0]
    s_set_gpr_idx_off
    s_cbranch_scc0 L_exit
    s_waitcnt vmcnt(6)
    v_rcp_f32 v14, v14
    v_mfma_f32_4x4x4_16b_bf16 v[16:19], v[32:33], v[204:205], 0 cbsz:4 abid:10
    v_exp_f32 v13, v145
    v_mfma_f32_4x4x4_16b_bf16 v[20:23], v[32:33], v[206:207], 0 cbsz:4 abid:10
    v_exp_f32 v12, v144
    v_readlane_b32 s54, v7, 11
    v_rcp_f32 v15, v15
    v_pk_add_f32 v[12:13], v[12:13], 1.0 op_sel_hi:[1,0]
    v_pk_mul_f32 v[158:159], v[158:159], v[14:15]
    s_and_b32 s69, s54, 4294966784
    s_set_gpr_idx_on s46, gpr_idx(SRC2,DST)
    buffer_load_dwordx4 v[200:203], v1, s[4:7], s68 offen
    v_pk_fma_f32 v[84:85], v[142:143], v[16:17], v[84:85] op_sel_hi:[0,1,1]
    v_pk_fma_f32 v[86:87], v[142:143], v[18:19], v[86:87] op_sel_hi:[0,1,1]
    v_pk_fma_f32 v[88:89], v[158:159], v[20:21], v[88:89] op_sel_hi:[0,1,1]
    v_pk_fma_f32 v[90:91], v[158:159], v[22:23], v[90:91] op_sel_hi:[0,1,1]
    s_set_gpr_idx_off
    s_waitcnt vmcnt(6)
    v_mfma_f32_4x4x4_16b_bf16 v[20:23], v[32:33], v[210:211], 0 cbsz:4 abid:11
    v_mfma_f32_4x4x4_16b_bf16 v[16:19], v[32:33], v[208:209], 0 cbsz:4 abid:11
    v_rcp_f32 v13, v13
    v_smfmac_f32_32x32x32_bf16 v[180:195], v[24:27], v[44:51], v28
    v_exp_f32 v14, v160
    v_exp_f32 v15, v161
    v_readlane_b32 s55, v7, 12
    v_rcp_f32 v12, v12
    v_pk_add_f32 v[14:15], v[14:15], 1.0 op_sel_hi:[1,0]
    v_pk_mul_f32 v[144:145], v[144:145], v[12:13]
    s_and_b32 s68, s55, 4294966784
    s_set_gpr_idx_on s47, gpr_idx(SRC2,DST)
    buffer_load_dwordx4 v[204:207], v1, s[4:7], s69 offen
    v_pk_fma_f32 v[84:85], v[142:143], v[16:17], v[84:85] op_sel:[1,0,0]
    v_pk_fma_f32 v[86:87], v[142:143], v[18:19], v[86:87] op_sel:[1,0,0]
    v_pk_fma_f32 v[88:89], v[158:159], v[20:21], v[88:89] op_sel:[1,0,0]
    v_pk_fma_f32 v[90:91], v[158:159], v[22:23], v[90:91] op_sel:[1,0,0]
    s_set_gpr_idx_off
    s_cbranch_scc0 L_exit
    s_setprio 0
    s_waitcnt vmcnt(6)
    v_rcp_f32 v14, v14
    v_mfma_f32_4x4x4_16b_bf16 v[16:19], v[32:33], v[212:213], 0 cbsz:4 abid:12
    v_exp_f32 v13, v147
    v_mfma_f32_4x4x4_16b_bf16 v[20:23], v[32:33], v[214:215], 0 cbsz:4 abid:12
    v_exp_f32 v12, v146
    v_readlane_b32 s56, v7, 13
    v_rcp_f32 v15, v15
    v_pk_add_f32 v[12:13], v[12:13], 1.0 op_sel_hi:[1,0]
    v_pk_mul_f32 v[160:161], v[160:161], v[14:15]
    s_and_b32 s69, s56, 4294966784
    s_set_gpr_idx_on s48, gpr_idx(SRC2,DST)
    buffer_load_dwordx4 v[208:211], v1, s[4:7], s68 offen
    v_pk_fma_f32 v[84:85], v[144:145], v[16:17], v[84:85] op_sel_hi:[0,1,1]
    v_pk_fma_f32 v[86:87], v[144:145], v[18:19], v[86:87] op_sel_hi:[0,1,1]
    v_pk_fma_f32 v[88:89], v[160:161], v[20:21], v[88:89] op_sel_hi:[0,1,1]
    v_pk_fma_f32 v[90:91], v[160:161], v[22:23], v[90:91] op_sel_hi:[0,1,1]
    s_set_gpr_idx_off
    s_waitcnt vmcnt(6)
    v_rcp_f32 v12, v12
    v_mfma_f32_4x4x4_16b_bf16 v[16:19], v[32:33], v[216:217], 0 cbsz:4 abid:13
    v_exp_f32 v15, v163
    v_mfma_f32_4x4x4_16b_bf16 v[20:23], v[32:33], v[218:219], 0 cbsz:4 abid:13
    v_exp_f32 v14, v162
    v_readlane_b32 s57, v7, 14
    v_rcp_f32 v13, v13
    v_pk_add_f32 v[14:15], v[14:15], 1.0 op_sel_hi:[1,0]
    v_pk_mul_f32 v[146:147], v[146:147], v[12:13]
    s_and_b32 s68, s57, 4294966784
    s_set_gpr_idx_on s49, gpr_idx(SRC2,DST)
    buffer_load_dwordx4 v[212:215], v1, s[4:7], s69 offen
    v_pk_fma_f32 v[84:85], v[144:145], v[16:17], v[84:85] op_sel:[1,0,0]
    v_pk_fma_f32 v[86:87], v[144:145], v[18:19], v[86:87] op_sel:[1,0,0]
    v_pk_fma_f32 v[88:89], v[160:161], v[20:21], v[88:89] op_sel:[1,0,0]
    v_pk_fma_f32 v[90:91], v[160:161], v[22:23], v[90:91] op_sel:[1,0,0]
    s_set_gpr_idx_off
    s_cbranch_scc0 L_exit
    s_waitcnt vmcnt(6)
    v_rcp_f32 v14, v14
    v_mfma_f32_4x4x4_16b_bf16 v[16:19], v[32:33], v[220:221], 0 cbsz:4 abid:14
    v_exp_f32 v13, v165
    v_mfma_f32_4x4x4_16b_bf16 v[20:23], v[32:33], v[222:223], 0 cbsz:4 abid:14
    v_exp_f32 v12, v164
    v_readlane_b32 s58, v7, 15
    v_rcp_f32 v15, v15
    v_pk_add_f32 v[12:13], v[12:13], 1.0 op_sel_hi:[1,0]
    v_pk_mul_f32 v[162:163], v[162:163], v[14:15]
    s_and_b32 s69, s58, 4294966784
    s_set_gpr_idx_on s50, gpr_idx(SRC2,DST)
    buffer_load_dwordx4 v[216:219], v1, s[4:7], s68 offen
    v_pk_fma_f32 v[84:85], v[146:147], v[16:17], v[84:85] op_sel_hi:[0,1,1]
    v_pk_fma_f32 v[86:87], v[146:147], v[18:19], v[86:87] op_sel_hi:[0,1,1]
    v_pk_fma_f32 v[88:89], v[162:163], v[20:21], v[88:89] op_sel_hi:[0,1,1]
    v_pk_fma_f32 v[90:91], v[162:163], v[22:23], v[90:91] op_sel_hi:[0,1,1]
    s_set_gpr_idx_off
    s_waitcnt vmcnt(6)
    v_rcp_f32 v12, v12
    v_mfma_f32_4x4x4_16b_bf16 v[16:19], v[32:33], v[224:225], 0 cbsz:4 abid:15
    v_exp_f32 v15, v181
    v_mfma_f32_4x4x4_16b_bf16 v[20:23], v[32:33], v[226:227], 0 cbsz:4 abid:15
    v_exp_f32 v14, v180
    v_readlane_b32 s59, v8, 0
    v_rcp_f32 v13, v13
    v_pk_add_f32 v[14:15], v[14:15], 1.0 op_sel_hi:[1,0]
    v_pk_mul_f32 v[164:165], v[164:165], v[12:13]
    s_and_b32 s68, s59, 4294966784
    s_set_gpr_idx_on s51, gpr_idx(SRC2,DST)
    buffer_load_dwordx4 v[220:223], v1, s[4:7], s69 offen
    v_pk_fma_f32 v[84:85], v[146:147], v[16:17], v[84:85] op_sel:[1,0,0]
    v_pk_fma_f32 v[86:87], v[146:147], v[18:19], v[86:87] op_sel:[1,0,0]
    v_pk_fma_f32 v[88:89], v[162:163], v[20:21], v[88:89] op_sel:[1,0,0]
    v_pk_fma_f32 v[90:91], v[162:163], v[22:23], v[90:91] op_sel:[1,0,0]
    s_set_gpr_idx_off
    s_cbranch_scc0 L_exit
    s_setprio 3
    ds_read_b32 v9, v5 offset:260
    ds_read_b32 v10, v6 offset:260
    ds_read_b32 v7, v4 offset:312
    ds_read_b128 v[132:135], v29
    s_waitcnt vmcnt(6)
    v_rcp_f32 v14, v14
    v_mfma_f32_4x4x4_16b_bf16 v[16:19], v[34:35], v[196:197], 0 cbsz:4 abid:0
    v_exp_f32 v13, v167
    v_mfma_f32_4x4x4_16b_bf16 v[20:23], v[34:35], v[198:199], 0 cbsz:4 abid:0
    v_exp_f32 v12, v166
    v_readlane_b32 s60, v8, 1
    v_rcp_f32 v15, v15
    v_pk_add_f32 v[12:13], v[12:13], 1.0 op_sel_hi:[1,0]
    v_pk_mul_f32 v[180:181], v[180:181], v[14:15]
    s_and_b32 s69, s60, 4294966784
    s_set_gpr_idx_on s52, gpr_idx(SRC2,DST)
    buffer_load_dwordx4 v[224:227], v1, s[4:7], s68 offen
    v_pk_fma_f32 v[84:85], v[164:165], v[16:17], v[84:85] op_sel_hi:[0,1,1]
    v_pk_fma_f32 v[86:87], v[164:165], v[18:19], v[86:87] op_sel_hi:[0,1,1]
    v_pk_fma_f32 v[88:89], v[180:181], v[20:21], v[88:89] op_sel_hi:[0,1,1]
    v_pk_fma_f32 v[90:91], v[180:181], v[22:23], v[90:91] op_sel_hi:[0,1,1]
    s_set_gpr_idx_off
    ds_read_b128 v[136:139], v29
    s_waitcnt vmcnt(6)
    v_rcp_f32 v12, v12
    v_mfma_f32_4x4x4_16b_bf16 v[16:19], v[34:35], v[200:201], 0 cbsz:4 abid:1
    v_exp_f32 v15, v183
    v_mfma_f32_4x4x4_16b_bf16 v[20:23], v[34:35], v[202:203], 0 cbsz:4 abid:1
    v_exp_f32 v14, v182
    v_readlane_b32 s61, v8, 2
    v_rcp_f32 v13, v13
    v_pk_add_f32 v[14:15], v[14:15], 1.0 op_sel_hi:[1,0]
    v_pk_mul_f32 v[166:167], v[166:167], v[12:13]
    s_and_b32 s68, s61, 4294966784
    s_set_gpr_idx_on s53, gpr_idx(SRC2,DST)
    buffer_load_dwordx4 v[196:199], v1, s[4:7], s69 offen
    v_pk_fma_f32 v[84:85], v[164:165], v[16:17], v[84:85] op_sel:[1,0,0]
    v_pk_fma_f32 v[86:87], v[164:165], v[18:19], v[86:87] op_sel:[1,0,0]
    v_pk_fma_f32 v[88:89], v[180:181], v[20:21], v[88:89] op_sel:[1,0,0]
    v_pk_fma_f32 v[90:91], v[180:181], v[22:23], v[90:91] op_sel:[1,0,0]
    s_set_gpr_idx_off
    s_cbranch_scc0 L_exit
    s_waitcnt lgkmcnt(0)
    v_add_u32 v9, v9, v2
    v_add_u32 v10, v10, v3
    ds_read_b128 v[24:27], v9 offset:63232
    ds_read_b64 v[32:33], v10
    ds_read_b128 v[140:143], v29
    s_waitcnt vmcnt(6)
    v_rcp_f32 v14, v14
    v_mfma_f32_4x4x4_16b_bf16 v[16:19], v[34:35], v[204:205], 0 cbsz:4 abid:2
    v_exp_f32 v13, v169
    v_mfma_f32_4x4x4_16b_bf16 v[20:23], v[34:35], v[206:207], 0 cbsz:4 abid:2
    v_exp_f32 v12, v168
    v_readlane_b32 s62, v8, 3
    v_rcp_f32 v15, v15
    v_pk_add_f32 v[12:13], v[12:13], 1.0 op_sel_hi:[1,0]
    v_pk_mul_f32 v[182:183], v[182:183], v[14:15]
    s_and_b32 s69, s62, 4294966784
    s_set_gpr_idx_on s54, gpr_idx(SRC2,DST)
    buffer_load_dwordx4 v[200:203], v1, s[4:7], s68 offen
    v_pk_fma_f32 v[84:85], v[166:167], v[16:17], v[84:85] op_sel_hi:[0,1,1]
    v_pk_fma_f32 v[86:87], v[166:167], v[18:19], v[86:87] op_sel_hi:[0,1,1]
    v_pk_fma_f32 v[88:89], v[182:183], v[20:21], v[88:89] op_sel_hi:[0,1,1]
    v_pk_fma_f32 v[90:91], v[182:183], v[22:23], v[90:91] op_sel_hi:[0,1,1]
    s_set_gpr_idx_off
    ds_read_b128 v[144:147], v29
    s_waitcnt vmcnt(6)
    v_rcp_f32 v12, v12
    v_mfma_f32_4x4x4_16b_bf16 v[16:19], v[34:35], v[208:209], 0 cbsz:4 abid:3
    v_exp_f32 v15, v185
    v_mfma_f32_4x4x4_16b_bf16 v[20:23], v[34:35], v[210:211], 0 cbsz:4 abid:3
    v_exp_f32 v14, v184
    v_readlane_b32 s63, v8, 4
    v_rcp_f32 v13, v13
    v_pk_add_f32 v[14:15], v[14:15], 1.0 op_sel_hi:[1,0]
    v_pk_mul_f32 v[168:169], v[168:169], v[12:13]
    s_and_b32 s68, s63, 4294966784
    s_set_gpr_idx_on s55, gpr_idx(SRC2,DST)
    buffer_load_dwordx4 v[204:207], v1, s[4:7], s69 offen
    v_pk_fma_f32 v[84:85], v[166:167], v[16:17], v[84:85] op_sel:[1,0,0]
    v_pk_fma_f32 v[86:87], v[166:167], v[18:19], v[86:87] op_sel:[1,0,0]
    v_pk_fma_f32 v[88:89], v[182:183], v[20:21], v[88:89] op_sel:[1,0,0]
    v_pk_fma_f32 v[90:91], v[182:183], v[22:23], v[90:91] op_sel:[1,0,0]
    s_set_gpr_idx_off
    s_cbranch_scc0 L_exit
    s_setprio 2
    ds_read_b128 v[148:151], v29
    s_waitcnt vmcnt(6)
    v_rcp_f32 v14, v14
    v_mfma_f32_4x4x4_16b_bf16 v[16:19], v[34:35], v[212:213], 0 cbsz:4 abid:4
    v_exp_f32 v13, v171
    v_mfma_f32_4x4x4_16b_bf16 v[20:23], v[34:35], v[214:215], 0 cbsz:4 abid:4
    v_exp_f32 v12, v170
    v_readlane_b32 s64, v8, 5
    v_rcp_f32 v15, v15
    v_pk_add_f32 v[12:13], v[12:13], 1.0 op_sel_hi:[1,0]
    v_pk_mul_f32 v[184:185], v[184:185], v[14:15]
    s_and_b32 s69, s64, 4294966784
    s_set_gpr_idx_on s56, gpr_idx(SRC2,DST)
    buffer_load_dwordx4 v[208:211], v1, s[4:7], s68 offen
    v_pk_fma_f32 v[84:85], v[168:169], v[16:17], v[84:85] op_sel_hi:[0,1,1]
    v_pk_fma_f32 v[86:87], v[168:169], v[18:19], v[86:87] op_sel_hi:[0,1,1]
    v_pk_fma_f32 v[88:89], v[184:185], v[20:21], v[88:89] op_sel_hi:[0,1,1]
    v_pk_fma_f32 v[90:91], v[184:185], v[22:23], v[90:91] op_sel_hi:[0,1,1]
    s_set_gpr_idx_off
    ds_read_b128 v[152:155], v29
    s_waitcnt vmcnt(6)
    v_rcp_f32 v12, v12
    v_mfma_f32_4x4x4_16b_bf16 v[16:19], v[34:35], v[216:217], 0 cbsz:4 abid:5
    v_exp_f32 v15, v187
    v_mfma_f32_4x4x4_16b_bf16 v[20:23], v[34:35], v[218:219], 0 cbsz:4 abid:5
    v_exp_f32 v14, v186
    v_readlane_b32 s65, v8, 6
    v_rcp_f32 v13, v13
    v_pk_add_f32 v[14:15], v[14:15], 1.0 op_sel_hi:[1,0]
    v_pk_mul_f32 v[170:171], v[170:171], v[12:13]
    s_and_b32 s68, s65, 4294966784
    s_set_gpr_idx_on s57, gpr_idx(SRC2,DST)
    buffer_load_dwordx4 v[212:215], v1, s[4:7], s69 offen
    v_pk_fma_f32 v[84:85], v[168:169], v[16:17], v[84:85] op_sel:[1,0,0]
    v_pk_fma_f32 v[86:87], v[168:169], v[18:19], v[86:87] op_sel:[1,0,0]
    v_pk_fma_f32 v[88:89], v[184:185], v[20:21], v[88:89] op_sel:[1,0,0]
    v_pk_fma_f32 v[90:91], v[184:185], v[22:23], v[90:91] op_sel:[1,0,0]
    s_set_gpr_idx_off
    s_cbranch_scc0 L_exit
    ds_read_b128 v[156:159], v29
    s_waitcnt vmcnt(6)
    v_rcp_f32 v14, v14
    v_mfma_f32_4x4x4_16b_bf16 v[16:19], v[34:35], v[220:221], 0 cbsz:4 abid:6
    v_exp_f32 v13, v173
    v_mfma_f32_4x4x4_16b_bf16 v[20:23], v[34:35], v[222:223], 0 cbsz:4 abid:6
    v_exp_f32 v12, v172
    v_readlane_b32 s66, v8, 7
    v_rcp_f32 v15, v15
    v_pk_add_f32 v[12:13], v[12:13], 1.0 op_sel_hi:[1,0]
    v_pk_mul_f32 v[186:187], v[186:187], v[14:15]
    s_and_b32 s69, s66, 4294966784
    s_set_gpr_idx_on s58, gpr_idx(SRC2,DST)
    buffer_load_dwordx4 v[216:219], v1, s[4:7], s68 offen
    v_pk_fma_f32 v[84:85], v[170:171], v[16:17], v[84:85] op_sel_hi:[0,1,1]
    v_pk_fma_f32 v[86:87], v[170:171], v[18:19], v[86:87] op_sel_hi:[0,1,1]
    v_pk_fma_f32 v[88:89], v[186:187], v[20:21], v[88:89] op_sel_hi:[0,1,1]
    v_pk_fma_f32 v[90:91], v[186:187], v[22:23], v[90:91] op_sel_hi:[0,1,1]
    s_set_gpr_idx_off
    ds_read_b128 v[160:163], v29
    s_waitcnt vmcnt(6)
    v_rcp_f32 v12, v12
    v_mfma_f32_4x4x4_16b_bf16 v[16:19], v[34:35], v[224:225], 0 cbsz:4 abid:7
    v_exp_f32 v15, v189
    v_mfma_f32_4x4x4_16b_bf16 v[20:23], v[34:35], v[226:227], 0 cbsz:4 abid:7
    v_exp_f32 v14, v188
    v_readlane_b32 s67, v8, 8
    v_rcp_f32 v13, v13
    v_pk_add_f32 v[14:15], v[14:15], 1.0 op_sel_hi:[1,0]
    v_pk_mul_f32 v[172:173], v[172:173], v[12:13]
    s_and_b32 s68, s67, 4294966784
    s_set_gpr_idx_on s59, gpr_idx(SRC2,DST)
    buffer_load_dwordx4 v[220:223], v1, s[4:7], s69 offen
    v_pk_fma_f32 v[84:85], v[170:171], v[16:17], v[84:85] op_sel:[1,0,0]
    v_pk_fma_f32 v[86:87], v[170:171], v[18:19], v[86:87] op_sel:[1,0,0]
    v_pk_fma_f32 v[88:89], v[186:187], v[20:21], v[88:89] op_sel:[1,0,0]
    v_pk_fma_f32 v[90:91], v[186:187], v[22:23], v[90:91] op_sel:[1,0,0]
    s_set_gpr_idx_off
    s_cbranch_scc0 L_exit
    s_setprio 1
    s_waitcnt vmcnt(6)
    v_rcp_f32 v14, v14
    v_mfma_f32_4x4x4_16b_bf16 v[16:19], v[34:35], v[196:197], 0 cbsz:4 abid:8
    v_exp_f32 v13, v175
    v_mfma_f32_4x4x4_16b_bf16 v[20:23], v[34:35], v[198:199], 0 cbsz:4 abid:8
    v_exp_f32 v12, v174
    v_readlane_b32 s36, v8, 9
    v_rcp_f32 v15, v15
    v_pk_add_f32 v[12:13], v[12:13], 1.0 op_sel_hi:[1,0]
    v_pk_mul_f32 v[188:189], v[188:189], v[14:15]
    s_and_b32 s69, s36, 4294966784
    s_set_gpr_idx_on s60, gpr_idx(SRC2,DST)
    buffer_load_dwordx4 v[224:227], v1, s[4:7], s68 offen
    v_pk_fma_f32 v[84:85], v[172:173], v[16:17], v[84:85] op_sel_hi:[0,1,1]
    v_pk_fma_f32 v[86:87], v[172:173], v[18:19], v[86:87] op_sel_hi:[0,1,1]
    v_pk_fma_f32 v[88:89], v[188:189], v[20:21], v[88:89] op_sel_hi:[0,1,1]
    v_pk_fma_f32 v[90:91], v[188:189], v[22:23], v[90:91] op_sel_hi:[0,1,1]
    s_set_gpr_idx_off
    s_waitcnt vmcnt(6) lgkmcnt(0)
    v_mfma_f32_4x4x4_16b_bf16 v[20:23], v[34:35], v[202:203], 0 cbsz:4 abid:9
    v_mfma_f32_4x4x4_16b_bf16 v[16:19], v[34:35], v[200:201], 0 cbsz:4 abid:9
    v_rcp_f32 v13, v13
    v_smfmac_f32_32x32x32_bf16 v[132:147], v[24:27], v[36:43], v28
    v_exp_f32 v14, v190
    v_exp_f32 v15, v191
    v_readlane_b32 s37, v8, 10
    v_rcp_f32 v12, v12
    v_pk_add_f32 v[14:15], v[14:15], 1.0 op_sel_hi:[1,0]
    v_pk_mul_f32 v[174:175], v[174:175], v[12:13]
    s_and_b32 s68, s37, 4294966784
    s_set_gpr_idx_on s61, gpr_idx(SRC2,DST)
    buffer_load_dwordx4 v[196:199], v1, s[4:7], s69 offen
    v_pk_fma_f32 v[84:85], v[172:173], v[16:17], v[84:85] op_sel:[1,0,0]
    v_pk_fma_f32 v[86:87], v[172:173], v[18:19], v[86:87] op_sel:[1,0,0]
    v_pk_fma_f32 v[88:89], v[188:189], v[20:21], v[88:89] op_sel:[1,0,0]
    v_pk_fma_f32 v[90:91], v[188:189], v[22:23], v[90:91] op_sel:[1,0,0]
    s_set_gpr_idx_off
    s_cbranch_scc0 L_exit
    s_waitcnt vmcnt(6)
    v_rcp_f32 v14, v14
    v_mfma_f32_4x4x4_16b_bf16 v[16:19], v[34:35], v[204:205], 0 cbsz:4 abid:10
    v_exp_f32 v13, v177
    v_mfma_f32_4x4x4_16b_bf16 v[20:23], v[34:35], v[206:207], 0 cbsz:4 abid:10
    v_exp_f32 v12, v176
    v_readlane_b32 s38, v8, 11
    v_rcp_f32 v15, v15
    v_pk_add_f32 v[12:13], v[12:13], 1.0 op_sel_hi:[1,0]
    v_pk_mul_f32 v[190:191], v[190:191], v[14:15]
    s_and_b32 s69, s38, 4294966784
    s_set_gpr_idx_on s62, gpr_idx(SRC2,DST)
    buffer_load_dwordx4 v[200:203], v1, s[4:7], s68 offen
    v_pk_fma_f32 v[84:85], v[174:175], v[16:17], v[84:85] op_sel_hi:[0,1,1]
    v_pk_fma_f32 v[86:87], v[174:175], v[18:19], v[86:87] op_sel_hi:[0,1,1]
    v_pk_fma_f32 v[88:89], v[190:191], v[20:21], v[88:89] op_sel_hi:[0,1,1]
    v_pk_fma_f32 v[90:91], v[190:191], v[22:23], v[90:91] op_sel_hi:[0,1,1]
    s_set_gpr_idx_off
    s_waitcnt vmcnt(6)
    v_mfma_f32_4x4x4_16b_bf16 v[20:23], v[34:35], v[210:211], 0 cbsz:4 abid:11
    v_mfma_f32_4x4x4_16b_bf16 v[16:19], v[34:35], v[208:209], 0 cbsz:4 abid:11
    v_rcp_f32 v13, v13
    v_smfmac_f32_32x32x32_bf16 v[148:163], v[24:27], v[44:51], v28
    v_exp_f32 v14, v192
    v_exp_f32 v15, v193
    v_readlane_b32 s39, v8, 12
    v_rcp_f32 v12, v12
    v_pk_add_f32 v[14:15], v[14:15], 1.0 op_sel_hi:[1,0]
    v_pk_mul_f32 v[176:177], v[176:177], v[12:13]
    s_and_b32 s68, s39, 4294966784
    s_set_gpr_idx_on s63, gpr_idx(SRC2,DST)
    buffer_load_dwordx4 v[204:207], v1, s[4:7], s69 offen
    v_pk_fma_f32 v[84:85], v[174:175], v[16:17], v[84:85] op_sel:[1,0,0]
    v_pk_fma_f32 v[86:87], v[174:175], v[18:19], v[86:87] op_sel:[1,0,0]
    v_pk_fma_f32 v[88:89], v[190:191], v[20:21], v[88:89] op_sel:[1,0,0]
    v_pk_fma_f32 v[90:91], v[190:191], v[22:23], v[90:91] op_sel:[1,0,0]
    s_set_gpr_idx_off
    s_cbranch_scc0 L_exit
    s_setprio 0
    s_waitcnt vmcnt(6)
    v_rcp_f32 v14, v14
    v_mfma_f32_4x4x4_16b_bf16 v[16:19], v[34:35], v[212:213], 0 cbsz:4 abid:12
    v_exp_f32 v13, v179
    v_mfma_f32_4x4x4_16b_bf16 v[20:23], v[34:35], v[214:215], 0 cbsz:4 abid:12
    v_exp_f32 v12, v178
    v_readlane_b32 s40, v8, 13
    v_rcp_f32 v15, v15
    v_pk_add_f32 v[12:13], v[12:13], 1.0 op_sel_hi:[1,0]
    v_pk_mul_f32 v[192:193], v[192:193], v[14:15]
    s_and_b32 s69, s40, 4294966784
    s_set_gpr_idx_on s64, gpr_idx(SRC2,DST)
    buffer_load_dwordx4 v[208:211], v1, s[4:7], s68 offen
    v_pk_fma_f32 v[84:85], v[176:177], v[16:17], v[84:85] op_sel_hi:[0,1,1]
    v_pk_fma_f32 v[86:87], v[176:177], v[18:19], v[86:87] op_sel_hi:[0,1,1]
    v_pk_fma_f32 v[88:89], v[192:193], v[20:21], v[88:89] op_sel_hi:[0,1,1]
    v_pk_fma_f32 v[90:91], v[192:193], v[22:23], v[90:91] op_sel_hi:[0,1,1]
    s_set_gpr_idx_off
    s_waitcnt vmcnt(6)
    v_rcp_f32 v12, v12
    v_mfma_f32_4x4x4_16b_bf16 v[16:19], v[34:35], v[216:217], 0 cbsz:4 abid:13
    v_exp_f32 v15, v195
    v_mfma_f32_4x4x4_16b_bf16 v[20:23], v[34:35], v[218:219], 0 cbsz:4 abid:13
    v_exp_f32 v14, v194
    v_readlane_b32 s41, v8, 14
    v_rcp_f32 v13, v13
    v_pk_add_f32 v[14:15], v[14:15], 1.0 op_sel_hi:[1,0]
    v_pk_mul_f32 v[178:179], v[178:179], v[12:13]
    s_and_b32 s68, s41, 4294966784
    s_set_gpr_idx_on s65, gpr_idx(SRC2,DST)
    buffer_load_dwordx4 v[212:215], v1, s[4:7], s69 offen
    v_pk_fma_f32 v[84:85], v[176:177], v[16:17], v[84:85] op_sel:[1,0,0]
    v_pk_fma_f32 v[86:87], v[176:177], v[18:19], v[86:87] op_sel:[1,0,0]
    v_pk_fma_f32 v[88:89], v[192:193], v[20:21], v[88:89] op_sel:[1,0,0]
    v_pk_fma_f32 v[90:91], v[192:193], v[22:23], v[90:91] op_sel:[1,0,0]
    s_set_gpr_idx_off
    s_cbranch_scc0 L_exit
    s_waitcnt vmcnt(6)
    v_rcp_f32 v14, v14
    v_mfma_f32_4x4x4_16b_bf16 v[16:19], v[34:35], v[220:221], 0 cbsz:4 abid:14
    v_exp_f32 v13, v133
    v_mfma_f32_4x4x4_16b_bf16 v[20:23], v[34:35], v[222:223], 0 cbsz:4 abid:14
    v_exp_f32 v12, v132
    v_readlane_b32 s42, v8, 15
    v_rcp_f32 v15, v15
    v_pk_add_f32 v[12:13], v[12:13], 1.0 op_sel_hi:[1,0]
    v_pk_mul_f32 v[194:195], v[194:195], v[14:15]
    s_and_b32 s69, s42, 4294966784
    s_set_gpr_idx_on s66, gpr_idx(SRC2,DST)
    buffer_load_dwordx4 v[216:219], v1, s[4:7], s68 offen
    v_pk_fma_f32 v[84:85], v[178:179], v[16:17], v[84:85] op_sel_hi:[0,1,1]
    v_pk_fma_f32 v[86:87], v[178:179], v[18:19], v[86:87] op_sel_hi:[0,1,1]
    v_pk_fma_f32 v[88:89], v[194:195], v[20:21], v[88:89] op_sel_hi:[0,1,1]
    v_pk_fma_f32 v[90:91], v[194:195], v[22:23], v[90:91] op_sel_hi:[0,1,1]
    s_set_gpr_idx_off
    s_waitcnt vmcnt(6)
    v_rcp_f32 v12, v12
    v_mfma_f32_4x4x4_16b_bf16 v[16:19], v[34:35], v[224:225], 0 cbsz:4 abid:15
    v_exp_f32 v15, v149
    v_mfma_f32_4x4x4_16b_bf16 v[20:23], v[34:35], v[226:227], 0 cbsz:4 abid:15
    v_exp_f32 v14, v148
    v_readlane_b32 s43, v7, 0
    v_rcp_f32 v13, v13
    v_pk_add_f32 v[14:15], v[14:15], 1.0 op_sel_hi:[1,0]
    v_pk_mul_f32 v[132:133], v[132:133], v[12:13]
    s_and_b32 s68, s43, 4294966784
    s_set_gpr_idx_on s67, gpr_idx(SRC2,DST)
    buffer_load_dwordx4 v[220:223], v1, s[4:7], s69 offen
    v_pk_fma_f32 v[84:85], v[178:179], v[16:17], v[84:85] op_sel:[1,0,0]
    v_pk_fma_f32 v[86:87], v[178:179], v[18:19], v[86:87] op_sel:[1,0,0]
    v_pk_fma_f32 v[88:89], v[194:195], v[20:21], v[88:89] op_sel:[1,0,0]
    v_pk_fma_f32 v[90:91], v[194:195], v[22:23], v[90:91] op_sel:[1,0,0]
    s_set_gpr_idx_off
    s_cbranch_scc0 L_exit
    v_add_u32 v4, 256, v4
    v_add_u32 v5, 256, v5
    v_add_u32 v6, 256, v6
    s_branch L_loop
L_giveup:
    s_mov_b64 exec, -1
    v_mov_b64 v[164:165], 0
    v_mov_b64 v[166:167], 0
    v_add_u32 v168, 161536, v1
    ds_write_b128 v168, v[164:167]
    v_mov_b32 v172, 0x00300000
    v_mov_b32 v173, 0x00300000
    v_mov_b32 v174, 0x00300000
    v_mov_b32 v175, 0x00300000
    ds_write_b128 v1, v[172:175] offset:20224
    ds_write_b128 v1, v[172:175] offset:21248
    ds_write_b128 v1, v[172:175] offset:22272
    ds_write_b128 v1, v[172:175] offset:23296
    ds_write_b128 v1, v[172:175] offset:24320
    ds_write_b128 v1, v[172:175] offset:25344
    s_branch L_fok
L_more:
    s_waitcnt vmcnt(0) lgkmcnt(0)
    s_barrier
    v_lshlrev_b32 v188, 4, v0
    v_add_u32 v189, 8192, v188
    v_add_u32 v190, 16384, v188
    v_add_u32 v191, 24576, v188
    v_add_u32 v192, 32768, v188
    v_add_u32 v193, 40960, v188
    v_lshlrev_b32 v194, 2, v0
    v_lshlrev_b32 v14, 3, v0
    v_mov_b32 v16, 0
    v_mov_b32 v17, 0
    v_mov_b32 v15, 0x00300000
    ds_write_b64 v14, v[16:17] offset:16128
    ds_write_b32 v194, v15 offset:20224
    ds_write_b32 v194, v15 offset:22272
    ds_write_b32 v194, v15 offset:24320
    v_lshrrev_b32 v195, 1, v0
    v_lshlrev_b32 v195, 2, v195
    s_branch L_round
L_exit:
    s_add_u32 s28, s28, 1536
    s_cmp_lt_u32 s28, s25
    s_cbranch_scc1 L_more
    s_mov_b32 m0, s96
    s_mov_b32 s68, 0xbf317218
    s_mov_b32 s69, s68
    v_pk_mul_f32 v[84:85], v[84:85], s[68:69]
    v_pk_mul_f32 v[86:87], v[86:87], s[68:69]
    v_pk_mul_f32 v[88:89], v[88:89], s[68:69]
    v_pk_mul_f32 v[90:91], v[90:91], s[68:69]
    v_cvt_pk_bf16_f32 v84, v84, v88
    v_cvt_pk_bf16_f32 v85, v85, v89
    v_cvt_pk_bf16_f32 v86, v86, v90
    v_cvt_pk_bf16_f32 v87, v87, v91
    ds_write_addtid_b32 v84 offset:16128
    ds_write_addtid_b32 v85 offset:16416
    ds_write_addtid_b32 v86 offset:16704
    ds_write_addtid_b32 v87 offset:16992
    s_mov_b32 m0, s97
    v_pk_mul_f32 v[92:93], v[92:93], s[68:69]
    v_pk_mul_f32 v[94:95], v[94:95], s[68:69]
    v_pk_mul_f32 v[96:97], v[96:97], s[68:69]
    v_pk_mul_f32 v[98:99], v[98:99], s[68:69]
    v_cvt_pk_bf16_f32 v92, v92, v96
    v_cvt_pk_bf16_f32 v93, v93, v97
    v_cvt_pk_bf16_f32 v94, v94, v98
    v_cvt_pk_bf16_f32 v95, v95, v99
    ds_write_addtid_b32 v92 offset:16128
    ds_write_addtid_b32 v93 offset:16416
    ds_write_addtid_b32 v94 offset:16704
    ds_write_addtid_b32 v95 offset:16992
    s_mov_b32 m0, s98
    v_pk_mul_f32 v[100:101], v[100:101], s[68:69]
    v_pk_mul_f32 v[102:103], v[102:103], s[68:69]
    v_pk_mul_f32 v[104:105], v[104:105], s[68:69]
    v_pk_mul_f32 v[106:107], v[106:107], s[68:69]
    v_cvt_pk_bf16_f32 v100, v100, v104
    v_cvt_pk_bf16_f32 v101, v101, v105
    v_cvt_pk_bf16_f32 v102, v102, v106
    v_cvt_pk_bf16_f32 v103, v103, v107
    ds_write_addtid_b32 v100 offset:16128
    ds_write_addtid_b32 v101 offset:16416
    ds_write_addtid_b32 v102 offset:16704
    ds_write_addtid_b32 v103 offset:16992
    s_mov_b32 m0, s99
    v_pk_mul_f32 v[108:109], v[108:109], s[68:69]
    v_pk_mul_f32 v[110:111], v[110:111], s[68:69]
    v_pk_mul_f32 v[112:113], v[112:113], s[68:69]
    v_pk_mul_f32 v[114:115], v[114:115], s[68:69]
    v_cvt_pk_bf16_f32 v108, v108, v112
    v_cvt_pk_bf16_f32 v109, v109, v113
    v_cvt_pk_bf16_f32 v110, v110, v114
    v_cvt_pk_bf16_f32 v111, v111, v115
    ds_write_addtid_b32 v108 offset:16128
    ds_write_addtid_b32 v109 offset:16416
    ds_write_addtid_b32 v110 offset:16704
    ds_write_addtid_b32 v111 offset:16992
    s_mov_b32 m0, s100
    v_pk_mul_f32 v[116:117], v[116:117], s[68:69]
    v_pk_mul_f32 v[118:119], v[118:119], s[68:69]
    v_pk_mul_f32 v[120:121], v[120:121], s[68:69]
    v_pk_mul_f32 v[122:123], v[122:123], s[68:69]
    v_cvt_pk_bf16_f32 v116, v116, v120
    v_cvt_pk_bf16_f32 v117, v117, v121
    v_cvt_pk_bf16_f32 v118, v118, v122
    v_cvt_pk_bf16_f32 v119, v119, v123
    ds_write_addtid_b32 v116 offset:16128
    ds_write_addtid_b32 v117 offset:16416
    ds_write_addtid_b32 v118 offset:16704
    ds_write_addtid_b32 v119 offset:16992
    s_mov_b32 s68, 0xbf317218
    s_waitcnt lgkmcnt(0)
    s_barrier
    ds_read_b128 v[84:87], v232 offset:16128
    ds_read_b128 v[88:91], v232 offset:16192
    ds_read_b128 v[92:95], v232 offset:16256
    ds_read_b128 v[96:99], v232 offset:16320
    ds_read_b128 v[100:103], v232 offset:20736
    ds_read_b128 v[104:107], v232 offset:20800
    ds_read_b128 v[108:111], v232 offset:20864
    ds_read_b128 v[112:115], v232 offset:20928
    s_waitcnt lgkmcnt(7)
    v_mfma_f32_16x16x32_bf16 v[116:119], v[84:87], v[52:55], 0
    v_mfma_f32_16x16x32_bf16 v[120:123], v[84:87], v[56:59], 0
    s_waitcnt lgkmcnt(6)
    v_mfma_f32_16x16x32_bf16 v[116:119], v[88:91], v[60:63], v[116:119]
    v_mfma_f32_16x16x32_bf16 v[120:123], v[88:91], v[64:67], v[120:123]
    s_waitcnt lgkmcnt(5)
    v_mfma_f32_16x16x32_bf16 v[116:119], v[92:95], v[68:71], v[116:119]
    v_mfma_f32_16x16x32_bf16 v[120:123], v[92:95], v[72:75], v[120:123]
    s_waitcnt lgkmcnt(4)
    v_mfma_f32_16x16x32_bf16 v[116:119], v[96:99], v[76:79], v[116:119]
    v_mfma_f32_16x16x32_bf16 v[120:123], v[96:99], v[80:83], v[120:123]
    ds_read_b128 v[84:87], v232 offset:25344
    ds_read_b128 v[88:91], v232 offset:25408
    ds_read_b128 v[92:95], v232 offset:25472
    ds_read_b128 v[96:99], v232 offset:25536
    s_waitcnt lgkmcnt(7)
    v_mfma_f32_16x16x32_bf16 v[124:127], v[100:103], v[52:55], 0
    v_mfma_f32_16x16x32_bf16 v[128:131], v[100:103], v[56:59], 0
    s_waitcnt lgkmcnt(6)
    v_mfma_f32_16x16x32_bf16 v[124:127], v[104:107], v[60:63], v[124:127]
    v_cvt_pk_bf16_f32 v44, v116, v117
    v_cvt_pk_bf16_f32 v45, v118, v119
    v_mfma_f32_16x16x32_bf16 v[128:131], v[104:107], v[64:67], v[128:131]
    v_cvt_pk_bf16_f32 v46, v120, v121
    v_cvt_pk_bf16_f32 v47, v122, v123
    s_waitcnt lgkmcnt(5)
    v_mfma_f32_16x16x32_bf16 v[124:127], v[108:111], v[68:71], v[124:127]
    s_mov_b32 s3, 0
    buffer_store_dwordx4 v[44:47], v233, s[16:19], s3 offen sc0 sc1
    v_mfma_f32_16x16x32_bf16 v[128:131], v[108:111], v[72:75], v[128:131]
    s_waitcnt lgkmcnt(4)
    v_mfma_f32_16x16x32_bf16 v[124:127], v[112:115], v[76:79], v[124:127]
    v_mfma_f32_16x16x32_bf16 v[128:131], v[112:115], v[80:83], v[128:131]
    ds_read_b128 v[100:103], v232 offset:29952
    ds_read_b128 v[104:107], v232 offset:30016
    ds_read_b128 v[108:111], v232 offset:30080
    ds_read_b128 v[112:115], v232 offset:30144
    s_waitcnt lgkmcnt(7)
    v_mfma_f32_16x16x32_bf16 v[116:119], v[84:87], v[52:55], 0
    v_mfma_f32_16x16x32_bf16 v[120:123], v[84:87], v[56:59], 0
    s_waitcnt lgkmcnt(6)
    v_mfma_f32_16x16x32_bf16 v[116:119], v[88:91], v[60:63], v[116:119]
    v_cvt_pk_bf16_f32 v48, v124, v125
    v_cvt_pk_bf16_f32 v49, v126, v127
    v_mfma_f32_16x16x32_bf16 v[120:123], v[88:91], v[64:67], v[120:123]
    v_cvt_pk_bf16_f32 v50, v128, v129
    v_cvt_pk_bf16_f32 v51, v130, v131
    s_waitcnt lgkmcnt(5)
    v_mfma_f32_16x16x32_bf16 v[116:119], v[92:95], v[68:71], v[116:119]
    s_mov_b32 s3, 1048576
    buffer_store_dwordx4 v[48:51], v233, s[16:19], s3 offen sc0 sc1
    v_mfma_f32_16x16x32_bf16 v[120:123], v[92:95], v[72:75], v[120:123]
    s_waitcnt lgkmcnt(4)
    v_mfma_f32_16x16x32_bf16 v[116:119], v[96:99], v[76:79], v[116:119]
    v_mfma_f32_16x16x32_bf16 v[120:123], v[96:99], v[80:83], v[120:123]
    ds_read_b128 v[84:87], v232 offset:34560
    ds_read_b128 v[88:91], v232 offset:34624
    ds_read_b128 v[92:95], v232 offset:34688
    ds_read_b128 v[96:99], v232 offset:34752
    s_waitcnt lgkmcnt(7)
    v_mfma_f32_16x16x32_bf16 v[124:127], v[100:103], v[52:55], 0
    v_mfma_f32_16x16x32_bf16 v[128:131], v[100:103], v[56:59], 0
    s_waitcnt lgkmcnt(6)
    v_mfma_f32_16x16x32_bf16 v[124:127], v[104:107], v[60:63], v[124:127]
    v_cvt_pk_bf16_f32 v44, v116, v117
    v_cvt_pk_bf16_f32 v45, v118, v119
    v_mfma_f32_16x16x32_bf16 v[128:131], v[104:107], v[64:67], v[128:131]
    v_cvt_pk_bf16_f32 v46, v120, v121
    v_cvt_pk_bf16_f32 v47, v122, v123
    s_waitcnt lgkmcnt(5)
    v_mfma_f32_16x16x32_bf16 v[124:127], v[108:111], v[68:71], v[124:127]
    s_mov_b32 s3, 2097152
    buffer_store_dwordx4 v[44:47], v233, s[16:19], s3 offen sc0 sc1
    v_mfma_f32_16x16x32_bf16 v[128:131], v[108:111], v[72:75], v[128:131]
    s_waitcnt lgkmcnt(4)
    v_mfma_f32_16x16x32_bf16 v[124:127], v[112:115], v[76:79], v[124:127]
    v_mfma_f32_16x16x32_bf16 v[128:131], v[112:115], v[80:83], v[128:131]
    s_nop 3
    s_waitcnt lgkmcnt(3)
    v_mfma_f32_16x16x32_bf16 v[116:119], v[84:87], v[52:55], 0
    v_mfma_f32_16x16x32_bf16 v[120:123], v[84:87], v[56:59], 0
    s_waitcnt lgkmcnt(2)
    v_mfma_f32_16x16x32_bf16 v[116:119], v[88:91], v[60:63], v[116:119]
    v_cvt_pk_bf16_f32 v48, v124, v125
    v_cvt_pk_bf16_f32 v49, v126, v127
    v_mfma_f32_16x16x32_bf16 v[120:123], v[88:91], v[64:67], v[120:123]
    v_cvt_pk_bf16_f32 v50, v128, v129
    v_cvt_pk_bf16_f32 v51, v130, v131
    s_waitcnt lgkmcnt(1)
    v_mfma_f32_16x16x32_bf16 v[116:119], v[92:95], v[68:71], v[116:119]
    s_mov_b32 s3, 3145728
    buffer_store_dwordx4 v[48:51], v233, s[16:19], s3 offen sc0 sc1
    v_mfma_f32_16x16x32_bf16 v[120:123], v[92:95], v[72:75], v[120:123]
    s_waitcnt lgkmcnt(0)
    v_mfma_f32_16x16x32_bf16 v[116:119], v[96:99], v[76:79], v[116:119]
    v_mfma_f32_16x16x32_bf16 v[120:123], v[96:99], v[80:83], v[120:123]
    s_or_b32 s31, s2, s24
    s_cbranch_scc1 L_noep
    v_lshlrev_b32 v36, 2, v11
    v_mov_b32 v37, s26
    global_store_dword v36, v37, s[22:23] offset:0 sc0 sc1
L_noep:
    s_nop 5
    v_cvt_pk_bf16_f32 v44, v116, v117
    v_cvt_pk_bf16_f32 v45, v118, v119
    v_cvt_pk_bf16_f32 v46, v120, v121
    v_cvt_pk_bf16_f32 v47, v122, v123
    s_mov_b32 s3, 4194304
    buffer_store_dwordx4 v[44:47], v233, s[16:19], s3 offen sc0 sc1
L_end:
    s_endpgm
.section .rodata,"a"
.p2align 6
.amdhsa_kernel standalone__tensor_product_equiv_tfn__graph_kernel
  .amdhsa_next_free_vgpr 235
  .amdhsa_next_free_sgpr 102
  .amdhsa_accum_offset 236
  .amdhsa_group_segment_fixed_size 0
  .amdhsa_kernarg_size 88
  .amdhsa_user_sgpr_count 2
  .amdhsa_user_sgpr_kernarg_segment_ptr 1
  .amdhsa_system_sgpr_workgroup_id_x 1
  .amdhsa_float_denorm_mode_32 3
.end_amdhsa_kernel
```

```asm
; @launch grid=(256,1,1) block=(512,1,1) lds=163600
.amdgcn_target "amdgcn-amd-amdhsa--gfx950"
.text
.globl standalone__tensor_product_equiv_tfn__graph_kernel
.p2align 8
.type standalone__tensor_product_equiv_tfn__graph_kernel,@function
standalone__tensor_product_equiv_tfn__graph_kernel:
    s_load_dwordx16 s[4:19], s[0:1], 0
    s_load_dwordx2 s[22:23], s[0:1], 80
    s_load_dwordx2 s[20:21], s[0:1], 64
    s_cmp_ge_u32 s2, 256
    s_cbranch_scc1 L_end
    v_mul_u32_u24 v172, 3, v0
    s_mul_i32 s3, s2, 1250
    v_min_u32 v172, 1247, v172
    v_add_lshl_u32 v173, v172, s3, 2
    v_lshrrev_b32 v12, 6, v0
    v_and_b32 v13, 255, v0
    v_lshlrev_b32 v13, 2, v13
    v_mov_b32 v16, 0
    v_readfirstlane_b32 s24, v12
    ds_write_b32 v13, v16 offset:0
    v_lshlrev_b32 v174, 1, v173
    s_waitcnt lgkmcnt(0)
    global_load_dwordx3 v[132:134], v173, s[8:9]
    s_load_dword s26, s[22:23], 0
    s_barrier
    global_load_dwordx3 v[136:138], v173, s[6:7]
    global_load_dwordx4 v[140:143], v174, s[10:11]
    global_load_dwordx2 v[144:145], v174, s[10:11] offset:16
    v_lshlrev_b32 v188, 4, v0
    v_and_b32 v11, 63, v0
    s_lshl_b32 s30, s24, 10
    s_lshl_b32 s3, s3, 5
    s_add_u32 s12, s12, s3
    s_addc_u32 s13, s13, 0
    v_add_u32 v189, 8192, v188
    v_add_u32 v190, 16384, v188
    v_add_u32 v191, 24576, v188
    v_add_u32 v192, 32768, v188
    v_add_u32 v193, 40960, v188
    v_min_u32 v175, 39984, v192
    v_lshlrev_b32 v1, 4, v11
    s_barrier
    s_add_u32 m0, s30, 112384
    s_nop 0
    global_load_lds_dwordx4 v188, s[12:13]
    s_add_u32 m0, s30, 120576
    s_nop 0
    global_load_lds_dwordx4 v189, s[12:13]
    s_cmp_eq_u32 s24, 7
    s_cbranch_scc0 L_nocpf
    s_cmp_lt_u32 s2, 8
    s_cbranch_scc0 L_nocpf
    s_getpc_b64 s[68:69]
L_pc:
    v_and_b32 v18, 63, v0
    v_lshlrev_b32 v18, 7, v18
    v_mov_b32 v19, 0
    v_lshl_add_u64 v[20:21], v[18:19], 0, s[68:69]
    global_load_dword v204, v[20:21], off
    v_min_u32 v18, L_end-L_pc-8192, v18
    v_add_u32 v18, 8192, v18
    v_lshl_add_u64 v[20:21], v[18:19], 0, s[68:69]
    global_load_dword v205, v[20:21], off
L_nocpf:
    v_lshlrev_b32 v194, 2, v0
    v_lshlrev_b32 v14, 3, v0
    v_mov_b32 v16, 0
    v_mov_b32 v17, 0
    v_mov_b32 v15, 0x00300000
    ds_write_b64 v14, v[16:17] offset:16128
    ds_write_b32 v194, v15 offset:20224
    ds_write_b32 v194, v15 offset:22272
    ds_write_b32 v194, v15 offset:24320
    v_lshrrev_b32 v195, 1, v0
    v_lshlrev_b32 v195, 2, v195
    v_cmp_gt_u32 vcc, 416, v0
    s_mov_b64 s[36:37], vcc
    v_cmp_gt_u32 vcc, 417, v0
    s_mov_b64 s[38:39], vcc
    v_mov_b32 v12, 1
    s_movk_i32 s40, 1250
    s_mov_b32 s41, 63232
    s_lshr_b32 s27, s24, 2
    s_mov_b32 s28, 0
    s_waitcnt vmcnt(5)
    s_mov_b64 exec, s[38:39]
    v_and_b32 v153, 7, v133
    v_bfe_u32 v161, v133, 3, 5
    v_lshl_add_u32 v147, v153, 5, v161
    v_lshlrev_b32 v147, 2, v147
    ds_add_rtn_u32 v150, v147, v12 offset:0
    v_and_b32 v154, 7, v134
    v_bfe_u32 v162, v134, 3, 5
    v_lshl_add_u32 v148, v154, 5, v162
    v_lshlrev_b32 v148, 2, v148
    ds_add_rtn_u32 v151, v148, v12 offset:0
    s_mov_b64 exec, s[36:37]
    v_and_b32 v152, 7, v132
    v_bfe_u32 v160, v132, 3, 5
    v_lshl_add_u32 v146, v152, 5, v160
    v_lshlrev_b32 v146, 2, v146
    ds_add_rtn_u32 v149, v146, v12 offset:0
    s_mov_b64 exec, -1
    s_add_u32 m0, s30, 128768
    s_nop 0
    global_load_lds_dwordx4 v190, s[12:13]
    s_add_u32 m0, s30, 136960
    s_nop 0
    global_load_lds_dwordx4 v191, s[12:13]
    s_add_u32 m0, s30, 145152
    s_nop 0
    global_load_lds_dwordx4 v175, s[12:13]
    s_waitcnt lgkmcnt(0)
    s_barrier
    ds_read_b128 v[164:167], v1 offset:0
    s_mul_i32 s3, s2, 1280
    s_add_u32 s26, s26, 1
    s_waitcnt lgkmcnt(0)
    v_add_u32 v180, v164, v165
    v_add3_u32 v180, v180, v166, v167
    v_mov_b32 v181, v180
    v_lshrrev_b32 v132, 8, v132
    v_lshlrev_b32 v156, 26, v132
    v_add_u32_dpp v181, v181, v181 row_shr:1 row_mask:0xf bank_mask:0xf
    v_mad_u32_u24 v132, v132, 16, v156
    v_add_lshl_u32 v177, v172, 0, 5
    v_add_u32_dpp v181, v181, v181 row_shr:2 row_mask:0xf bank_mask:0xf
    v_lshrrev_b32 v133, 8, v133
    v_lshlrev_b32 v157, 26, v133
    v_add_u32_dpp v181, v181, v181 row_shr:4 row_mask:0xf bank_mask:0xf
    v_mad_u32_u24 v133, v133, 16, v157
    v_add_lshl_u32 v178, v172, 1, 5
    v_add_u32_dpp v181, v181, v181 row_shr:8 row_mask:0xf bank_mask:0xf
    v_lshrrev_b32 v134, 8, v134
    v_lshlrev_b32 v158, 26, v134
    v_add_u32_dpp v181, v181, v181 row_bcast:15 row_mask:0xa bank_mask:0xf
    v_mad_u32_u24 v134, v134, 16, v158
    v_add_lshl_u32 v179, v172, 2, 5
    v_add_u32_dpp v181, v181, v181 row_bcast:31 row_mask:0xc bank_mask:0xf
    v_sub_u32 v168, v181, v180
    v_add_u32 v169, v168, v164
    v_add_u32 v170, v169, v165
    v_add_u32 v171, v170, v166
    ds_write_b128 v1, v[168:171] offset:1024
    s_mov_b64 exec, s[38:39]
    ds_read_b32 v147, v147 offset:1024
    ds_read_b32 v148, v148 offset:1024
    s_mov_b64 exec, s[36:37]
    ds_read_b32 v146, v146 offset:1024
    s_mov_b64 exec, -1
    s_waitcnt vmcnt(5)
    v_mad_u32_u24 v152, v152, s40, v136
    v_lshl_add_u32 v132, v136, 10, v132
    v_subrev_u32 v156, 10000, v152
    v_min_u32 v152, v152, v156
    v_add_u32 v152, 350, v152
    v_mul_u32_u24 v152, 151, v152
    v_lshrrev_b32 v152, 17, v152
    v_add_u32 v152, v152, v132
    v_mad_u32_u24 v153, v153, s40, v137
    v_lshl_add_u32 v133, v137, 10, v133
    v_subrev_u32 v157, 10000, v153
    v_min_u32 v153, v153, v157
    v_add_u32 v153, 350, v153
    v_mul_u32_u24 v153, 151, v153
    v_lshrrev_b32 v153, 17, v153
    v_add_u32 v153, v153, v133
    v_mad_u32_u24 v154, v154, s40, v138
    v_lshl_add_u32 v134, v138, 10, v134
    v_subrev_u32 v158, 10000, v154
    v_min_u32 v154, v154, v158
    v_add_u32 v154, 350, v154
    v_mul_u32_u24 v154, 151, v154
    v_lshrrev_b32 v154, 17, v154
    v_add_u32 v154, v154, v134
    s_mov_b64 exec, s[38:39]
    s_waitcnt lgkmcnt(0)
    v_add_lshl_u32 v147, v147, v150, 1
    v_mad_u32_u24 v183, v147, 6, s41
    ds_write_b16 v147, v178 offset:2048
    ds_write2_b32 v183, v142, v143 offset1:1
    ds_write_b32 v183, v153 offset:8
    v_add_lshl_u32 v148, v148, v151, 1
    v_mad_u32_u24 v184, v148, 6, s41
    ds_write_b16 v148, v179 offset:2048
    ds_write2_b32 v184, v144, v145 offset1:1
    ds_write_b32 v184, v154 offset:8
    s_mov_b64 exec, s[36:37]
    v_add_lshl_u32 v146, v146, v149, 1
    v_mad_u32_u24 v182, v146, 6, s41
    ds_write_b16 v146, v177 offset:2048
    ds_write2_b32 v182, v140, v141 offset1:1
    ds_write_b32 v182, v152 offset:8
    s_mov_b64 exec, -1
    s_add_u32 m0, s30, 26368
    s_nop 0
    global_load_lds_dwordx4 v188, s[18:19]
    s_add_u32 m0, s30, 34560
    s_nop 0
    global_load_lds_dwordx4 v189, s[18:19]
    s_add_u32 m0, s30, 42752
    s_nop 0
    global_load_lds_dwordx4 v190, s[18:19]
    s_add_u32 m0, s30, 50944
    s_nop 0
    global_load_lds_dwordx4 v191, s[18:19]
    s_add_u32 s70, s30, 59136
    v_min_u32 v185, 112, v1
    s_cmp_lt_u32 s24, 4
    s_cselect_b64 vcc, -1, 0
    s_cselect_b32 m0, s70, 162560
    s_cselect_b64 s[68:69], s[14:15], s[16:17]
    v_cndmask_b32 v185, v185, v188, vcc
    global_load_lds_dwordx4 v185, s[68:69]
    v_add_u32 v168, s3, v168
    v_lshl_add_u32 v196, v164, 19, v168
    v_mov_b32 v197, s26
    v_add_u32 v169, s3, v169
    v_lshl_add_u32 v198, v165, 19, v169
    v_mov_b32 v199, s26
    v_add_u32 v170, s3, v170
    v_lshl_add_u32 v200, v166, 19, v170
    v_mov_b32 v201, s26
    v_add_u32 v171, s3, v171
    v_lshl_add_u32 v202, v167, 19, v171
    v_mov_b32 v203, s26
    s_mul_i32 s31, s2, 2048
    s_add_u32 s31, s31, 4096
    v_add_u32 v186, s31, v1
    s_mul_i32 s31, s3, 12
    s_add_u32 s31, s31, 1048576
    s_add_u32 s48, s22, s31
    s_addc_u32 s49, s23, 0
    s_mov_b32 s50, 15104
    s_mov_b32 s51, 0x00020000
    s_lshl_b32 s3, s3, 5
    s_add_u32 s31, s3, 8388608
    s_add_u32 s52, s22, s31
    s_addc_u32 s53, s23, 0
    s_mov_b32 s54, 40064
    s_mov_b32 s55, 0x00020000
    v_and_b32 v172, -2, v0
    v_and_b32 v173, 16, v188
    v_add_u32 v173, 112384, v173
    s_waitcnt lgkmcnt(0)
    s_barrier
    ds_read_b128 v[132:135], v188 offset:63232
    ds_read_b128 v[136:139], v189 offset:63232
    ds_read_u16 v174, v172 offset:2048
    ds_read_u16 v175, v172 offset:2560
    ds_read_u16 v176, v172 offset:3072
    ds_read_u16 v177, v172 offset:3584
    ds_read_u16 v178, v172 offset:4096
    s_cmp_eq_u32 s24, 7
    s_cbranch_scc0 L_nopub
    global_store_dwordx4 v186, v[196:199], s[22:23] sc0 sc1
    global_store_dwordx4 v186, v[200:203], s[22:23] offset:1024 sc0 sc1
L_nopub:
    s_mul_i32 s3, s2, 32
    s_add_u32 s3, s3, 983040
    v_lshl_add_u32 v186, v11, 2, s3
    s_waitcnt lgkmcnt(6)
    buffer_store_dwordx4 v[132:135], v188, s[48:51], 0 offen sc0 sc1
    s_waitcnt lgkmcnt(5)
    buffer_store_dwordx4 v[136:139], v189, s[48:51], 0 offen sc0 sc1
    s_waitcnt lgkmcnt(0)
    v_add_u32 v174, v174, v173
    v_add_u32 v175, v175, v173
    v_add_u32 v176, v176, v173
    v_add_u32 v177, v177, v173
    v_min_u32 v178, 39968, v178
    v_and_b32 v178, -16, v178
    v_add_u32 v178, v178, v173
    v_mov_b64 v[84:85], 0
    v_mov_b64 v[86:87], 0
    v_mov_b64 v[88:89], 0
    v_mov_b64 v[90:91], 0
    v_mov_b64 v[92:93], 0
    v_mov_b64 v[94:95], 0
    v_mov_b64 v[96:97], 0
    v_mov_b64 v[98:99], 0
    v_mov_b64 v[100:101], 0
    v_mov_b64 v[102:103], 0
    v_mov_b64 v[104:105], 0
    v_mov_b64 v[106:107], 0
    v_mov_b64 v[108:109], 0
    v_mov_b64 v[110:111], 0
    v_mov_b64 v[112:113], 0
    v_mov_b64 v[114:115], 0
    v_mov_b64 v[116:117], 0
    v_mov_b64 v[118:119], 0
    v_mov_b64 v[120:121], 0
    v_mov_b64 v[122:123], 0
    v_mov_b64 v[124:125], 0
    v_mov_b64 v[126:127], 0
    v_mov_b64 v[128:129], 0
    v_mov_b64 v[130:131], 0
    v_bfe_u32 v28, v11, 2, 1
    v_mul_u32_u24 v28, 0xaaaa, v28
    v_add_u32 v28, 0x4444, v28
    v_mov_b32 v29, 163584
    ds_write_b128 v29, v[84:87]
    v_lshrrev_b32 v2, 5, v11
    v_lshlrev_b32 v2, 4, v2
    v_and_b32 v3, 3, v11
    v_lshlrev_b32 v3, 3, v3
    v_add_u32 v3, 112384, v3
    s_sub_u32 s4, s4, 512
    s_subb_u32 s5, s5, 0
    s_mov_b32 s6, 10240512
    s_mov_b32 s7, 0x00020000
    s_add_u32 s8, s22, 1048576
    s_addc_u32 s9, s23, 0
    s_mov_b32 s10, 3932160
    s_mov_b32 s11, 0x00020000
    s_mov_b32 s101, 0
    s_cmp_lt_u32 s2, 16
    s_cbranch_scc1 L_r40
    s_cmp_eq_u32 s24, 0
    s_cselect_b32 s101, 0x245d2388, s101
    s_cmp_eq_u32 s24, 1
    s_cselect_b32 s101, 0x25753343, s101
    s_cmp_eq_u32 s24, 2
    s_cselect_b32 s101, 0x27449100, s101
    s_cmp_eq_u32 s24, 3
    s_cselect_b32 s101, 0x267d5301, s101
    s_cmp_eq_u32 s24, 4
    s_cselect_b32 s101, 0x2179a402, s101
    s_cmp_eq_u32 s24, 5
    s_cselect_b32 s101, 0x227162c6, s101
    s_cmp_eq_u32 s24, 6
    s_cselect_b32 s101, 0x206543c7, s101
    s_cmp_eq_u32 s24, 7
    s_cselect_b32 s101, 0x236d8285, s101
    s_branch L_rd
L_r40:
    s_cmp_eq_u32 s24, 0
    s_cselect_b32 s101, 0x2271a3c1, s101
    s_cmp_eq_u32 s24, 1
    s_cselect_b32 s101, 0x20750307, s101
    s_cmp_eq_u32 s24, 2
    s_cselect_b32 s101, 0x236d5205, s101
    s_cmp_eq_u32 s24, 3
    s_cselect_b32 s101, 0x27797340, s101
    s_cmp_eq_u32 s24, 4
    s_cselect_b32 s101, 0x256112c4, s101
    s_cmp_eq_u32 s24, 5
    s_cselect_b32 s101, 0x26653243, s101
    s_cmp_eq_u32 s24, 6
    s_cselect_b32 s101, 0x217d4382, s101
    s_cmp_eq_u32 s24, 7
    s_cselect_b32 s101, 0x24592286, s101
L_rd:
    s_and_b32 s3, s2, 7
    s_lshl_b32 s3, s3, 7
    s_bfe_u32 s31, s2, 196613
    s_lshl_b32 s31, s31, 4
    s_add_u32 s3, s3, s31
    s_and_b32 s31, s2, 8
    s_add_u32 s3, s3, s31
    s_and_b32 s31, s2, 16
    s_lshl_b32 s31, s31, 6
    s_add_u32 s3, s3, s31
    s_add_u32 s3, s3, 4096
    v_and_b32 v234, 255, v0
    v_mul_u32_u24 v187, 2048, v234
    v_add_u32 v187, s3, v187
    v_mul_u32_u24 v234, 32, v234
    v_add_u32 v234, 983040, v234
    s_waitcnt vmcnt(7)
    s_barrier
    ds_read_b128 v[144:147], v174
    ds_read_b128 v[148:151], v175
    ds_read_b128 v[152:155], v176
    ds_read_b128 v[156:159], v177
    ds_read_b128 v[160:163], v178
    s_waitcnt lgkmcnt(4)
    buffer_store_dwordx4 v[144:147], v188, s[52:55], 0 offen sc0 sc1
    s_waitcnt lgkmcnt(3)
    buffer_store_dwordx4 v[148:151], v189, s[52:55], 0 offen sc0 sc1
    s_waitcnt lgkmcnt(2)
    buffer_store_dwordx4 v[152:155], v190, s[52:55], 0 offen sc0 sc1
    s_waitcnt lgkmcnt(1)
    buffer_store_dwordx4 v[156:159], v191, s[52:55], 0 offen sc0 sc1
    s_waitcnt lgkmcnt(0)
    buffer_store_dwordx4 v[160:163], v192, s[52:55], 0 offen sc0 sc1
    s_add_u32 s12, s22, 8388608
    s_addc_u32 s13, s23, 0
    s_mov_b32 s14, 10485760
    s_mov_b32 s15, 0x00020000
    s_mov_b32 s16, s20
    s_mov_b32 s17, s21
    s_mov_b32 s18, 10240000
    s_mov_b32 s19, 0x00020000
    s_waitcnt vmcnt(0)
    s_barrier
    s_cmp_eq_u32 s24, 0
    s_cbranch_scc0 L_noflag
    s_mov_b64 exec, 0xff
    global_store_dword v186, v197, s[22:23] sc0 sc1
    s_mov_b64 exec, -1
L_noflag:
    s_barrier
    s_cmp_eq_u32 s27, 0
    s_cbranch_scc0 L_np0
    global_load_dwordx2 v[206:207], v187, s[22:23] sc1
L_np0:
    s_cmp_eq_u32 s27, 0
    s_cbranch_scc1 L_pfa
    s_sub_u32 s3, 0, s2
    s_and_b32 s3, s3, 7
    s_mul_i32 s3, s3, 1280000
    s_lshr_b32 s31, s2, 3
    s_mul_i32 s31, s31, 16640
    s_add_u32 s3, s3, s31
    s_add_u32 s3, s3, 512
    v_and_b32 v208, 255, v0
    v_cmp_gt_u32 vcc, 130, v208
    v_lshlrev_b32 v208, 7, v208
    v_mov_b32 v209, 0x7fffff00
    v_cndmask_b32 v208, v209, v208, vcc
    buffer_load_dword v210, v208, s[4:7], s3 offen
L_pfa:
    v_lshrrev_b32 v12, 5, v11
    v_and_b32 v13, 31, v11
    v_lshlrev_b32 v13, 2, v13
    v_lshl_add_u32 v12, v12, 10, v13
    s_and_b32 s3, s24, 2
    s_lshl_b32 s31, s3, 8
    s_lshl_b32 s68, s27, 11
    s_add_u32 s31, s31, s68
    s_and_b32 s3, s24, 1
    s_lshl_b32 s3, s3, 7
    s_add_u32 s31, s31, s3
    s_and_b32 s3, s24, 3
    v_add_u32 v12, s31, v12
    ds_read_b32 v132, v12 offset:59136
    ds_read_b32 v133, v12 offset:59392
    s_lshl_b32 s3, s3, 2
    s_lshl_b32 s31, s27, 10
    s_add_u32 s3, s3, s31
    v_add_u32 v16, s3, v1
    v_and_b32 v14, 3, v11
    v_bfe_u32 v15, v11, 2, 2
    v_lshlrev_b32 v15, 1, v15
    v_lshl_add_u32 v14, v14, 5, v15
    v_add_u32 v14, 162560, v14
    s_mov_b32 s68, 0xbfb8aa3b
    s_mov_b32 s69, s68
    ds_read_u16 v18, v14 offset:0
    ds_read_u16 v19, v14 offset:8
    ds_read_u16 v20, v14 offset:16
    ds_read_u16 v21, v14 offset:24
    s_waitcnt lgkmcnt(4)
    v_lshlrev_b32 v22, 16, v132
    v_lshlrev_b32 v23, 16, v133
    v_and_b32 v132, 0xffff0000, v132
    v_and_b32 v133, 0xffff0000, v133
    v_pk_mul_f32 v[22:23], v[22:23], s[68:69]
    v_pk_mul_f32 v[132:133], v[132:133], s[68:69]
    v_cvt_pk_bf16_f32 v134, v22, v23
    v_cvt_pk_bf16_f32 v135, v132, v133
    ds_write_b32 v16, v134 offset:8192
    ds_write_b32 v16, v135 offset:10240
    s_waitcnt lgkmcnt(0)
    v_lshl_or_b32 v228, v19, 16, v18
    v_lshl_or_b32 v229, v21, 16, v20
    s_mov_b32 s70, 0x05040100
    s_mov_b32 s71, 0x07060302
    s_and_b32 s3, s24, 3
    s_lshl_b32 s3, s3, 6
    v_lshrrev_b32 v16, 4, v11
    v_and_b32 v17, 15, v11
    v_lshl_add_u32 v17, v17, 2, s3
    v_lshl_add_u32 v16, v16, 11, v17
    ds_read_b32 v148, v16 offset:26368
    ds_read_b32 v149, v16 offset:26624
    ds_read_b32 v150, v16 offset:26880
    ds_read_b32 v151, v16 offset:27136
    ds_read_b32 v152, v16 offset:27392
    ds_read_b32 v153, v16 offset:27648
    ds_read_b32 v154, v16 offset:27904
    ds_read_b32 v155, v16 offset:28160
    s_waitcnt lgkmcnt(7)
    ds_read_b32 v156, v16 offset:34560
    ds_read_b32 v157, v16 offset:34816
    ds_read_b32 v158, v16 offset:35072
    ds_read_b32 v159, v16 offset:35328
    ds_read_b32 v160, v16 offset:35584
    ds_read_b32 v161, v16 offset:35840
    ds_read_b32 v162, v16 offset:36096
    ds_read_b32 v163, v16 offset:36352
    s_waitcnt lgkmcnt(8)
    v_perm_b32 v52, v149, v148, s70
    v_perm_b32 v56, v149, v148, s71
    v_perm_b32 v53, v151, v150, s70
    v_perm_b32 v57, v151, v150, s71
    v_perm_b32 v54, v153, v152, s70
    v_perm_b32 v58, v153, v152, s71
    v_perm_b32 v55, v155, v154, s70
    v_perm_b32 v59, v155, v154, s71
    s_waitcnt lgkmcnt(7)
    ds_read_b32 v148, v16 offset:42752
    ds_read_b32 v149, v16 offset:43008
    ds_read_b32 v150, v16 offset:43264
    ds_read_b32 v151, v16 offset:43520
    ds_read_b32 v152, v16 offset:43776
    ds_read_b32 v153, v16 offset:44032
    ds_read_b32 v154, v16 offset:44288
    ds_read_b32 v155, v16 offset:44544
    s_waitcnt lgkmcnt(8)
    v_perm_b32 v60, v157, v156, s70
    v_perm_b32 v64, v157, v156, s71
    v_perm_b32 v61, v159, v158, s70
    v_perm_b32 v65, v159, v158, s71
    v_perm_b32 v62, v161, v160, s70
    v_perm_b32 v66, v161, v160, s71
    v_perm_b32 v63, v163, v162, s70
    v_perm_b32 v67, v163, v162, s71
    s_waitcnt lgkmcnt(7)
    ds_read_b32 v156, v16 offset:50944
    ds_read_b32 v157, v16 offset:51200
    ds_read_b32 v158, v16 offset:51456
    ds_read_b32 v159, v16 offset:51712
    ds_read_b32 v160, v16 offset:51968
    ds_read_b32 v161, v16 offset:52224
    ds_read_b32 v162, v16 offset:52480
    ds_read_b32 v163, v16 offset:52736
    s_waitcnt lgkmcnt(8)
    v_perm_b32 v68, v149, v148, s70
    v_perm_b32 v72, v149, v148, s71
    v_perm_b32 v69, v151, v150, s70
    v_perm_b32 v73, v151, v150, s71
    v_perm_b32 v70, v153, v152, s70
    v_perm_b32 v74, v153, v152, s71
    v_perm_b32 v71, v155, v154, s70
    v_perm_b32 v75, v155, v154, s71
    s_waitcnt lgkmcnt(0)
    v_perm_b32 v76, v157, v156, s70
    v_perm_b32 v80, v157, v156, s71
    v_perm_b32 v77, v159, v158, s70
    v_perm_b32 v81, v159, v158, s71
    v_perm_b32 v78, v161, v160, s70
    v_perm_b32 v82, v161, v160, s71
    v_perm_b32 v79, v163, v162, s70
    v_perm_b32 v83, v163, v162, s71
    s_cmp_eq_u32 s27, 0
    s_cbranch_scc0 L_round
    s_mov_b32 s3, 0
    s_branch L_poll1
L_poll:
    global_load_dwordx2 v[206:207], v187, s[22:23] sc1
L_poll1:
    s_add_u32 s3, s3, 1
    s_waitcnt vmcnt(0)
    v_cmpx_ne_u32 vcc, s26, v207
    s_cbranch_execz L_pok
    s_cmp_lt_u32 s3, 4000000
    s_cbranch_scc1 L_poll
    v_mov_b32 v206, 0
L_pok:
    s_mov_b64 exec, -1
    v_add_u32 v14, 161536, v194
    ds_write_b32 v14, v206
L_round:
    v_add_u32 v15, 161536, v1
    s_and_b32 s31, s24, 3
    v_mov_b32 v148, 0
    s_waitcnt lgkmcnt(0)
    s_barrier
    ds_read_b128 v[140:143], v15
    s_cmp_lg_u32 s28, 0
    s_cbranch_scc1 L_npe
    s_cmp_eq_u32 s27, 0
    s_cbranch_scc1 L_npe
    global_load_dword v206, v234, s[22:23] sc1
L_npe:
    v_mul_u32_u24 v135, 12, v0
    v_add_u32 v136, 6144, v135
    v_add_u32 v137, 12288, v135
    s_waitcnt lgkmcnt(0)
    v_lshrrev_b32 v144, 19, v140
    v_lshrrev_b32 v145, 19, v141
    v_lshrrev_b32 v146, 19, v142
    v_lshrrev_b32 v147, 19, v143
    v_add_u32 v150, v144, v145
    v_add3_u32 v12, v150, v146, v147
    v_add_u32 v13, s28, v12
    v_mov_b32 v149, v144
    v_add_u32_dpp v12, v12, v12 row_shr:1 row_mask:0xf bank_mask:0xf
    v_add_u32 v151, v150, v146
    s_set_gpr_idx_on s31, gpr_idx(SRC0)
    v_mov_b32 v14, v140
    v_mov_b32 v15, v144
    v_mov_b32 v16, v148
    s_set_gpr_idx_off
    v_add_u32_dpp v12, v12, v12 row_shr:2 row_mask:0xf bank_mask:0xf
    v_and_b32 v14, 0x7ffff, v14
    v_sub_u32 v16, v16, v13
    v_add_u32_dpp v12, v12, v12 row_shr:4 row_mask:0xf bank_mask:0xf
    v_subrev_u32 v17, s27, v15
    s_mov_b32 s31, s27
    v_add_u32_dpp v12, v12, v12 row_shr:8 row_mask:0xf bank_mask:0xf
    s_nop 1
    v_add_u32_dpp v12, v12, v12 row_bcast:15 row_mask:0xa bank_mask:0xf
    s_nop 1
    v_add_u32_dpp v12, v12, v12 row_bcast:31 row_mask:0xc bank_mask:0xf
    v_add_u32 v16, v16, v12
    v_readlane_b32 s25, v12, 63
    v_sub_u32 v14, v14, v16
    v_add_lshl_u32 v18, v16, s27, 2
    s_cmp_gt_u32 s25, 1536
    s_cbranch_scc1 L_exp
    v_cmpx_lt_i32 vcc, 0, v17
    ds_write_b32 v18, v14 offset:20224
    v_cmpx_lt_i32 vcc, 2, v17
    ds_write_b32 v18, v14 offset:20232
    v_cmpx_lt_i32 vcc, 4, v17
    ds_write_b32 v18, v14 offset:20240
    v_cmpx_lt_i32 vcc, 6, v17
    ds_write_b32 v18, v14 offset:20248
    v_cmpx_lt_i32 vcc, 8, v17
    ds_write_b32 v18, v14 offset:20256
    v_cmpx_lt_i32 vcc, 10, v17
    ds_write_b32 v18, v14 offset:20264
    v_cmpx_lt_i32 vcc, 12, v17
    s_cbranch_execz L_expd
    s_add_u32 s31, s31, 12
L_exp:
    s_mov_b64 exec, -1
    v_cmp_lt_u32 vcc, s31, v15
    s_cbranch_vccz L_expd
    v_add_u32 v19, s31, v16
    s_movk_i32 s3, 1536
    v_cmp_gt_u32 s[68:69], s3, v19
    v_lshlrev_b32 v19, 2, v19
    s_and_b64 exec, vcc, s[68:69]
    ds_write_b32 v19, v14 offset:20224
    s_add_u32 s31, s31, 2
    s_branch L_exp
L_expd:
    s_mov_b64 exec, -1
    s_cmp_eq_u32 s27, 0
    s_cbranch_scc1 L_fok
    s_cmp_lg_u32 s28, 0
    s_cbranch_scc1 L_fok
    s_mov_b32 s3, 0
    s_waitcnt vmcnt(0)
    s_branch L_fp1
L_fp:
    global_load_dword v206, v234, s[22:23] sc1
    s_add_u32 s3, s3, 1
    s_waitcnt vmcnt(0)
L_fp1:
    v_cmpx_ne_u32 vcc, s26, v206
    s_cbranch_execz L_fok
    s_cmp_lt_u32 s3, 4000000
    s_cbranch_scc1 L_fp
    s_branch L_giveup
L_fok:
    s_mov_b64 exec, -1
    s_waitcnt lgkmcnt(0)
    s_barrier
    ds_read_b32 v132, v194 offset:20224
    ds_read_b32 v133, v194 offset:22272
    ds_read_b32 v134, v194 offset:24320
    ds_read_b32 v152, v195 offset:20224
    ds_read_b32 v153, v195 offset:21248
    ds_read_b32 v154, v195 offset:22272
    ds_read_b32 v155, v195 offset:23296
    ds_read_b32 v156, v195 offset:24320
    ds_read_b32 v157, v195 offset:25344
    s_waitcnt lgkmcnt(8)
    v_mad_i32_i24 v132, v132, 12, v135
    buffer_load_dwordx3 v[140:142], v132, s[8:11], 0 offen sc1
    s_waitcnt lgkmcnt(7)
    v_mad_i32_i24 v133, v133, 12, v136
    buffer_load_dwordx3 v[144:146], v133, s[8:11], 0 offen sc1
    s_waitcnt lgkmcnt(6)
    v_mad_i32_i24 v134, v134, 12, v137
    buffer_load_dwordx3 v[148:150], v134, s[8:11], 0 offen sc1
    s_waitcnt lgkmcnt(0)
    v_lshl_add_u32 v152, v152, 5, v188
    v_lshl_add_u32 v153, v153, 5, v189
    v_lshl_add_u32 v154, v154, 5, v190
    v_lshl_add_u32 v155, v155, 5, v191
    v_lshl_add_u32 v156, v156, 5, v192
    v_lshl_add_u32 v157, v157, 5, v193
    s_barrier
    s_add_u32 m0, s30, 63232
    s_nop 0
    buffer_load_dwordx4 v152, s[12:15], 0 offen sc1 lds
    s_sub_u32 s29, s25, s28
    s_min_u32 s29, s29, 1536
    s_lshl_b32 s3, s29, 4
    v_cmp_gt_u32 s[56:57], s3, v188
    v_lshlrev_b32 v159, 1, v188
    v_mov_b32 v143, 0
    v_cmp_gt_u32 s[58:59], s3, v189
    v_lshlrev_b32 v161, 1, v189
    v_mov_b32 v147, 0
    v_cmp_gt_u32 s[60:61], s3, v190
    v_lshlrev_b32 v163, 1, v190
    v_mov_b32 v151, 0
    v_and_b32 v4, 15, v11
    v_lshrrev_b32 v13, 4, v11
    s_mul_i32 s3, s27, 23040
    v_mul_u32_u24 v232, 288, v4
    v_lshl_add_u32 v232, v13, 4, v232
    v_add_u32 v232, s3, v232
    s_mul_i32 s68, s27, 5120
    s_add_u32 s68, s68, s2
    s_lshl_b32 s68, s68, 10
    s_and_b32 s3, s24, 3
    s_lshl_b32 s3, s3, 8
    s_add_u32 s68, s68, s3
    v_lshl_add_u32 v233, v13, 18, s68
    v_lshl_add_u32 v233, v4, 4, v233
    v_lshlrev_b32 v4, 3, v4
    v_bfe_u32 v5, v11, 3, 2
    v_and_b32 v12, 3, v11
    v_lshl_add_u32 v5, v5, 2, v12
    v_lshlrev_b32 v5, 3, v5
    v_lshrrev_b32 v6, 2, v11
    v_lshlrev_b32 v6, 3, v6
    v_mul_u32_u24 v16, 52, v11
    v_lshrrev_b32 v16, 8, v16
    v_mul_u32_u24 v17, 5, v16
    v_sub_u32 v17, v11, v17
    v_mul_u32_u24 v15, 6, v17
    v_bfe_u32 v15, s101, v15, 6
    v_lshlrev_b32 v15, 2, v15
    v_lshlrev_b32 v16, 2, v16
    v_lshlrev_b32 v17, 19, v17
    v_add_u32 v17, 33554432, v17
    s_mul_i32 s3, s24, 5
    v_lshlrev_b32 v18, 2, v11
    v_add_u32 v21, s3, v11
    v_lshlrev_b32 v19, 2, v21
    v_cmp_gt_u32 vcc, 40, v11
    v_add_u32 v20, 1, v11
    v_add_u32 v21, 1, v21
    v_cndmask_b32 v20, 0, v20, vcc
    s_cmp_gt_u32 s25, 1536
    s_cselect_b32 s69, 0, 8
    v_mov_b32 v22, 8
    s_cmp_lg_u32 s28, 0
    s_cbranch_scc1 L_nofr
    ds_read_b128 v[36:39], v1 offset:8192
    ds_read_b128 v[40:43], v1 offset:9216
    ds_read_b128 v[44:47], v1 offset:10240
    ds_read_b128 v[48:51], v1 offset:11264
L_nofr:
    s_waitcnt vmcnt(3)
    s_mov_b64 exec, s[56:57]
    v_and_b32 v143, 0x3ff, v142
    v_lshrrev_b32 v12, 24, v142
    v_lshlrev_b32 v143, 2, v143
    ds_add_u32 v12, v22 offset:18688
    ds_add_rtn_u32 v132, v143, v22 offset:16128
    s_waitcnt vmcnt(2)
    s_mov_b64 exec, s[58:59]
    v_and_b32 v147, 0x3ff, v146
    v_lshrrev_b32 v13, 24, v146
    v_lshlrev_b32 v147, 2, v147
    ds_add_u32 v13, v22 offset:18688
    ds_add_rtn_u32 v133, v147, v22 offset:16128
    s_waitcnt vmcnt(1)
    s_mov_b64 exec, s[60:61]
    v_and_b32 v151, 0x3ff, v150
    v_lshrrev_b32 v14, 24, v150
    v_lshlrev_b32 v151, 2, v151
    ds_add_u32 v14, v22 offset:18688
    ds_add_rtn_u32 v134, v151, v22 offset:16128
    s_mov_b64 exec, -1
    s_add_u32 m0, s30, 71424
    s_nop 0
    buffer_load_dwordx4 v153, s[12:15], 0 offen sc1 lds
    v_mfma_f32_4x4x4_16b_bf16 v[164:167], v[228:229], v[140:141], 0 cbsz:4 abid:0
    v_mfma_f32_4x4x4_16b_bf16 v[168:171], v[228:229], v[140:141], 0 cbsz:4 abid:1
    v_mfma_f32_4x4x4_16b_bf16 v[172:175], v[228:229], v[140:141], 0 cbsz:4 abid:2
    v_mfma_f32_4x4x4_16b_bf16 v[176:179], v[228:229], v[140:141], 0 cbsz:4 abid:3
    v_add_u32 v23, 112384, v159
    s_nop 0
    v_cvt_pk_bf16_f32 v180, v164, v165
    v_cvt_pk_bf16_f32 v181, v166, v167
    v_cvt_pk_bf16_f32 v182, v168, v169
    v_cvt_pk_bf16_f32 v183, v170, v171
    v_cvt_pk_bf16_f32 v184, v172, v173
    v_cvt_pk_bf16_f32 v185, v174, v175
    v_cvt_pk_bf16_f32 v186, v176, v177
    v_cvt_pk_bf16_f32 v187, v178, v179
    s_waitcnt lgkmcnt(0)
    s_barrier
    ds_read_b32 v12, v18 offset:18688
    ds_read_b32 v13, v19 offset:18688
    ds_write_b128 v23, v[180:183]
    ds_write_b128 v23, v[184:187] offset:16
    v_mul_u32_u24 v19, 16, v19
    v_and_b32 v142, 0xfffc00, v142
    v_and_b32 v146, 0xfffc00, v146
    v_and_b32 v150, 0xfffc00, v150
    s_waitcnt lgkmcnt(2)
    v_mad_u32_u24 v21, v13, s69, v21
    v_mad_u32_u24 v20, v12, s69, v20
    v_readlane_b32 s96, v21, 0
    v_readlane_b32 s97, v21, 1
    v_readlane_b32 s98, v21, 2
    v_readlane_b32 s99, v21, 3
    v_readlane_b32 s100, v21, 4
    v_lshl_add_u32 v19, v13, 16, v19
    v_cmp_lt_u32 s[36:37], s96, v20
    v_cmp_lt_u32 s[38:39], s97, v20
    v_cmp_lt_u32 s[40:41], s98, v20
    v_cmp_lt_u32 s[42:43], s99, v20
    v_cmp_lt_u32 s[44:45], s100, v20
    s_bcnt1_i32_b64 s96, s[36:37]
    v_writelane_b32 v12, s96, 0
    s_bcnt1_i32_b64 s97, s[38:39]
    v_writelane_b32 v12, s97, 1
    s_bcnt1_i32_b64 s98, s[40:41]
    v_writelane_b32 v12, s98, 2
    s_bcnt1_i32_b64 s99, s[42:43]
    v_writelane_b32 v12, s99, 3
    s_bcnt1_i32_b64 s100, s[44:45]
    v_writelane_b32 v12, s100, 4
    s_mov_b64 exec, 31
    v_lshlrev_b32 v12, 2, v12
    ds_write_b32 v12, v19 offset:19200
    s_mov_b64 exec, -1
    s_add_u32 m0, s30, 79616
    s_nop 0
    buffer_load_dwordx4 v154, s[12:15], 0 offen sc1 lds
    s_add_u32 m0, s30, 87808
    s_nop 0
    buffer_load_dwordx4 v155, s[12:15], 0 offen sc1 lds
    s_waitcnt lgkmcnt(0)
    s_barrier
    ds_read_b32 v12, v15 offset:19200
    v_mfma_f32_4x4x4_16b_bf16 v[164:167], v[228:229], v[144:145], 0 cbsz:4 abid:0
    v_mfma_f32_4x4x4_16b_bf16 v[168:171], v[228:229], v[144:145], 0 cbsz:4 abid:1
    v_mfma_f32_4x4x4_16b_bf16 v[172:175], v[228:229], v[144:145], 0 cbsz:4 abid:2
    v_mfma_f32_4x4x4_16b_bf16 v[176:179], v[228:229], v[144:145], 0 cbsz:4 abid:3
    v_add_u32 v23, 112384, v161
    s_nop 0
    v_cvt_pk_bf16_f32 v180, v164, v165
    v_cvt_pk_bf16_f32 v181, v166, v167
    v_cvt_pk_bf16_f32 v182, v168, v169
    v_cvt_pk_bf16_f32 v183, v170, v171
    v_cvt_pk_bf16_f32 v184, v172, v173
    v_cvt_pk_bf16_f32 v185, v174, v175
    v_cvt_pk_bf16_f32 v186, v176, v177
    v_cvt_pk_bf16_f32 v187, v178, v179
    s_waitcnt lgkmcnt(0)
    v_add_u32_sdwa v16, v12, v16 dst_sel:DWORD dst_unused:UNUSED_PAD src0_sel:WORD_0 src1_sel:DWORD
    ds_read_b32 v13, v16 offset:16128
    v_readlane_b32 s96, v12, 0
    v_readlane_b32 s97, v12, 1
    v_readlane_b32 s98, v12, 2
    v_readlane_b32 s99, v12, 3
    v_readlane_b32 s100, v12, 4
    s_add_u32 s3, s96, s97
    s_add_u32 s3, s3, s98
    s_add_u32 s3, s3, s99
    s_add_u32 s3, s3, s100
    s_lshr_b32 s29, s3, 16
    s_add_u32 s3, s29, 480
    v_mov_b32 v14, s3
    v_mov_b32 v18, 0
    s_mov_b64 exec, 1
    ds_add_rtn_u32 v14, v18, v14 offset:19456
    s_mov_b64 exec, -1
    s_waitcnt lgkmcnt(1)
    v_sub_u32 v17, v17, v13
    s_nop 0
    v_add_u32_dpp v13, v13, v13 row_shr:1 row_mask:0xf bank_mask:0xf
    s_nop 1
    v_add_u32_dpp v13, v13, v13 row_shr:2 row_mask:0xf bank_mask:0xf
    v_mov_b32 v20, 2147482664
    v_mov_b32 v21, 0
    v_add_u32_dpp v13, v13, v13 row_shr:4 row_mask:0xf bank_mask:0xf
    s_sub_u32 s3, 0, s29
    s_bfe_u32 s3, s3, 65539
    s_add_u32 s3, s3, 7
    v_writelane_b32 v20, 40, s3
    v_add_u32_dpp v13, v13, v13 row_shr:8 row_mask:0xf bank_mask:0xf
    s_waitcnt lgkmcnt(0)
    v_readfirstlane_b32 s71, v14
    v_add_u32_dpp v13, v13, v13 row_bcast:15 row_mask:0xa bank_mask:0xf
    s_add_u32 s3, s71, s29
    v_lshl_add_u32 v18, v11, 3, s3
    v_add_u32_dpp v13, v13, v13 row_bcast:31 row_mask:0xc bank_mask:0xf
    s_mov_b32 exec_hi, 0x0fffffff
    v_add3_u32 v13, v13, v17, s71
    ds_write_b32 v16, v13 offset:16128
    ds_write_b64 v18, v[20:21] offset:0
    s_mov_b64 exec, -1
    ds_write_b128 v23, v[180:183]
    ds_write_b128 v23, v[184:187] offset:16
    s_add_u32 m0, s30, 96000
    s_nop 0
    buffer_load_dwordx4 v156, s[12:15], 0 offen sc1 lds
    s_waitcnt lgkmcnt(2)
    s_barrier
    ds_read_b32 v12, v143 offset:16128
    ds_read_b32 v13, v147 offset:16128
    ds_read_b32 v14, v151 offset:16128
    v_add_u32 v4, s71, v4
    v_add_u32 v5, s71, v5
    v_add_u32 v6, s71, v6
    s_lshr_b32 s29, s29, 3
    s_mov_b64 exec, s[56:57]
    s_waitcnt lgkmcnt(2)
    v_add_u32_sdwa v132, v12, v132 dst_sel:DWORD dst_unused:UNUSED_PAD src0_sel:WORD_0 src1_sel:DWORD
    v_or_b32_sdwa v158, v12, v142 dst_sel:DWORD dst_unused:UNUSED_PAD src0_sel:WORD_1 src1_sel:DWORD
    ds_write_b64 v132, v[158:159] offset:0
    s_mov_b64 exec, s[58:59]
    s_waitcnt lgkmcnt(2)
    v_add_u32_sdwa v133, v13, v133 dst_sel:DWORD dst_unused:UNUSED_PAD src0_sel:WORD_0 src1_sel:DWORD
    v_or_b32_sdwa v160, v13, v146 dst_sel:DWORD dst_unused:UNUSED_PAD src0_sel:WORD_1 src1_sel:DWORD
    ds_write_b64 v133, v[160:161] offset:0
    s_mov_b64 exec, s[60:61]
    s_waitcnt lgkmcnt(2)
    v_add_u32_sdwa v134, v14, v134 dst_sel:DWORD dst_unused:UNUSED_PAD src0_sel:WORD_0 src1_sel:DWORD
    v_or_b32_sdwa v162, v14, v150 dst_sel:DWORD dst_unused:UNUSED_PAD src0_sel:WORD_1 src1_sel:DWORD
    ds_write_b64 v134, v[162:163] offset:0
    s_mov_b64 exec, -1
    s_add_u32 m0, s30, 104192
    s_nop 0
    buffer_load_dwordx4 v157, s[12:15], 0 offen sc1 lds
    s_waitcnt lgkmcnt(0)
    s_barrier
    ds_read_b32 v12, v4
    ds_read_b32 v7, v4 offset:56
    ds_read_b32 v9, v5 offset:4
    ds_read_b32 v10, v6 offset:4
    s_cmp_eq_u64 s[60:61], 0
    s_cbranch_scc1 L_not3
    v_mfma_f32_4x4x4_16b_bf16 v[164:167], v[228:229], v[148:149], 0 cbsz:4 abid:0
    v_mfma_f32_4x4x4_16b_bf16 v[168:171], v[228:229], v[148:149], 0 cbsz:4 abid:1
    v_mfma_f32_4x4x4_16b_bf16 v[172:175], v[228:229], v[148:149], 0 cbsz:4 abid:2
    v_mfma_f32_4x4x4_16b_bf16 v[176:179], v[228:229], v[148:149], 0 cbsz:4 abid:3
    v_add_u32 v23, 112384, v163
    s_nop 0
    v_cvt_pk_bf16_f32 v180, v164, v165
    v_cvt_pk_bf16_f32 v181, v166, v167
    v_cvt_pk_bf16_f32 v182, v168, v169
    v_cvt_pk_bf16_f32 v183, v170, v171
    v_cvt_pk_bf16_f32 v184, v172, v173
    v_cvt_pk_bf16_f32 v185, v174, v175
    v_cvt_pk_bf16_f32 v186, v176, v177
    v_cvt_pk_bf16_f32 v187, v178, v179
    ds_write_b128 v23, v[180:183]
    ds_write_b128 v23, v[184:187] offset:16
    s_waitcnt lgkmcnt(2)
    s_branch L_t3
L_not3:
    s_waitcnt lgkmcnt(0)
L_t3:
    v_readlane_b32 s36, v12, 0
    v_readlane_b32 s37, v12, 1
    v_readlane_b32 s38, v12, 2
    v_readlane_b32 s39, v12, 3
    s_and_b32 s70, s36, 4294966784
    buffer_load_dwordx4 v[196:199], v1, s[4:7], s70 offen
    s_and_b32 s71, s37, 4294966784
    buffer_load_dwordx4 v[200:203], v1, s[4:7], s71 offen
    s_and_b32 s70, s38, 4294966784
    buffer_load_dwordx4 v[204:207], v1, s[4:7], s70 offen
    s_and_b32 s71, s39, 4294966784
    buffer_load_dwordx4 v[208:211], v1, s[4:7], s71 offen
    v_readlane_b32 s40, v12, 4
    v_readlane_b32 s41, v12, 5
    v_readlane_b32 s42, v12, 6
    v_add_u32 v9, v9, v2
    v_add_u32 v10, v10, v3
    v_readlane_b32 s43, v7, 0
    s_and_b32 s96, s96, 0xffff
    s_mulk_i32 s96, 18
    s_and_b32 s97, s97, 0xffff
    s_mulk_i32 s97, 18
    s_and_b32 s98, s98, 0xffff
    s_mulk_i32 s98, 18
    s_and_b32 s99, s99, 0xffff
    s_mulk_i32 s99, 18
    s_and_b32 s100, s100, 0xffff
    s_mulk_i32 s100, 18
    s_and_b32 s68, s43, 4294966784
    ds_read_b128 v[132:135], v29
    ds_read_b128 v[136:139], v29
    ds_read_b128 v[140:143], v29
    ds_read_b128 v[144:147], v29
    ds_read_b128 v[148:151], v29
    ds_read_b128 v[152:155], v29
    ds_read_b128 v[156:159], v29
    ds_read_b128 v[160:163], v29
    s_waitcnt vmcnt(4) lgkmcnt(0)
    s_barrier
    s_cmp_eq_u32 s29, 0
    s_cbranch_scc1 L_exit
    s_sub_u32 s29, s29, 1
    ds_read_b128 v[24:27], v9 offset:63232
    ds_read_b64 v[32:33], v10
    s_and_b32 s70, s40, 4294966784
    buffer_load_dwordx4 v[212:215], v1, s[4:7], s70 offen
    s_and_b32 s71, s41, 4294966784
    buffer_load_dwordx4 v[216:219], v1, s[4:7], s71 offen
    s_waitcnt lgkmcnt(1)
    v_smfmac_f32_32x32x32_bf16 v[132:147], v[24:27], v[36:43], v28
    v_smfmac_f32_32x32x32_bf16 v[148:163], v[24:27], v[44:51], v28
    s_and_b32 s70, s42, 4294966784
    buffer_load_dwordx4 v[220:223], v1, s[4:7], s70 offen
    s_waitcnt lgkmcnt(0)
    s_nop 8
    v_exp_f32 v12, v132
    v_exp_f32 v13, v133
    v_exp_f32 v14, v148
    v_exp_f32 v15, v149
    v_pk_add_f32 v[12:13], v[12:13], 1.0 op_sel_hi:[1,0]
    v_pk_add_f32 v[14:15], v[14:15], 1.0 op_sel_hi:[1,0]
    v_rcp_f32 v12, v12
    v_rcp_f32 v13, v13
    s_nop 0
    v_pk_mul_f32 v[132:133], v[132:133], v[12:13]
L_loop:
    s_setprio 3
    ds_read_b32 v9, v5 offset:132
    ds_read_b32 v10, v6 offset:132
    ds_read_b32 v8, v4 offset:184
    ds_read_b128 v[164:167], v29
    s_waitcnt vmcnt(6)
    v_rcp_f32 v14, v14
    v_mfma_f32_4x4x4_16b_bf16 v[16:19], v[32:33], v[196:197], 0 cbsz:4 abid:0
    v_exp_f32 v13, v135
    v_mfma_f32_4x4x4_16b_bf16 v[20:23], v[32:33], v[198:199], 0 cbsz:4 abid:0
    v_exp_f32 v12, v134
    v_readlane_b32 s44, v7, 1
    v_rcp_f32 v15, v15
    v_pk_add_f32 v[12:13], v[12:13], 1.0 op_sel_hi:[1,0]
    v_pk_mul_f32 v[148:149], v[148:149], v[14:15]
    s_and_b32 s69, s44, 4294966784
    s_set_gpr_idx_on s36, gpr_idx(SRC2,DST)
    buffer_load_dwordx4 v[224:227], v1, s[4:7], s68 offen
    v_pk_fma_f32 v[84:85], v[132:133], v[16:17], v[84:85] op_sel_hi:[0,1,1]
    v_pk_fma_f32 v[86:87], v[132:133], v[18:19], v[86:87] op_sel_hi:[0,1,1]
    v_pk_fma_f32 v[88:89], v[148:149], v[20:21], v[88:89] op_sel_hi:[0,1,1]
    v_pk_fma_f32 v[90:91], v[148:149], v[22:23], v[90:91] op_sel_hi:[0,1,1]
    s_set_gpr_idx_off
    ds_read_b128 v[168:171], v29
    s_waitcnt vmcnt(6)
    v_rcp_f32 v12, v12
    v_mfma_f32_4x4x4_16b_bf16 v[16:19], v[32:33], v[200:201], 0 cbsz:4 abid:1
    v_exp_f32 v15, v151
    v_mfma_f32_4x4x4_16b_bf16 v[20:23], v[32:33], v[202:203], 0 cbsz:4 abid:1
    v_exp_f32 v14, v150
    v_readlane_b32 s45, v7, 2
    v_rcp_f32 v13, v13
    v_pk_add_f32 v[14:15], v[14:15], 1.0 op_sel_hi:[1,0]
    v_pk_mul_f32 v[134:135], v[134:135], v[12:13]
    s_and_b32 s68, s45, 4294966784
    s_set_gpr_idx_on s37, gpr_idx(SRC2,DST)
    buffer_load_dwordx4 v[196:199], v1, s[4:7], s69 offen
    v_pk_fma_f32 v[84:85], v[132:133], v[16:17], v[84:85] op_sel:[1,0,0]
    v_pk_fma_f32 v[86:87], v[132:133], v[18:19], v[86:87] op_sel:[1,0,0]
    v_pk_fma_f32 v[88:89], v[148:149], v[20:21], v[88:89] op_sel:[1,0,0]
    v_pk_fma_f32 v[90:91], v[148:149], v[22:23], v[90:91] op_sel:[1,0,0]
    s_set_gpr_idx_off
    s_cbranch_scc0 L_exit
    s_waitcnt lgkmcnt(0)
    v_add_u32 v9, v9, v2
    v_add_u32 v10, v10, v3
    ds_read_b128 v[24:27], v9 offset:63232
    ds_read_b64 v[34:35], v10
    ds_read_b128 v[172:175], v29
    s_waitcnt vmcnt(6)
    v_rcp_f32 v14, v14
    v_mfma_f32_4x4x4_16b_bf16 v[16:19], v[32:33], v[204:205], 0 cbsz:4 abid:2
    v_exp_f32 v13, v137
    v_mfma_f32_4x4x4_16b_bf16 v[20:23], v[32:33], v[206:207], 0 cbsz:4 abid:2
    v_exp_f32 v12, v136
    v_readlane_b32 s46, v7, 3
    v_rcp_f32 v15, v15
    v_pk_add_f32 v[12:13], v[12:13], 1.0 op_sel_hi:[1,0]
    v_pk_mul_f32 v[150:151], v[150:151], v[14:15]
    s_and_b32 s69, s46, 4294966784
    s_set_gpr_idx_on s38, gpr_idx(SRC2,DST)
    buffer_load_dwordx4 v[200:203], v1, s[4:7], s68 offen
    v_pk_fma_f32 v[84:85], v[134:135], v[16:17], v[84:85] op_sel_hi:[0,1,1]
    v_pk_fma_f32 v[86:87], v[134:135], v[18:19], v[86:87] op_sel_hi:[0,1,1]
    v_pk_fma_f32 v[88:89], v[150:151], v[20:21], v[88:89] op_sel_hi:[0,1,1]
    v_pk_fma_f32 v[90:91], v[150:151], v[22:23], v[90:91] op_sel_hi:[0,1,1]
    s_set_gpr_idx_off
    ds_read_b128 v[176:179], v29
    s_waitcnt vmcnt(6)
    v_rcp_f32 v12, v12
    v_mfma_f32_4x4x4_16b_bf16 v[16:19], v[32:33], v[208:209], 0 cbsz:4 abid:3
    v_exp_f32 v15, v153
    v_mfma_f32_4x4x4_16b_bf16 v[20:23], v[32:33], v[210:211], 0 cbsz:4 abid:3
    v_exp_f32 v14, v152
    v_readlane_b32 s47, v7, 4
    v_rcp_f32 v13, v13
    v_pk_add_f32 v[14:15], v[14:15], 1.0 op_sel_hi:[1,0]
    v_pk_mul_f32 v[136:137], v[136:137], v[12:13]
    s_and_b32 s68, s47, 4294966784
    s_set_gpr_idx_on s39, gpr_idx(SRC2,DST)
    buffer_load_dwordx4 v[204:207], v1, s[4:7], s69 offen
    v_pk_fma_f32 v[84:85], v[134:135], v[16:17], v[84:85] op_sel:[1,0,0]
    v_pk_fma_f32 v[86:87], v[134:135], v[18:19], v[86:87] op_sel:[1,0,0]
    v_pk_fma_f32 v[88:89], v[150:151], v[20:21], v[88:89] op_sel:[1,0,0]
    v_pk_fma_f32 v[90:91], v[150:151], v[22:23], v[90:91] op_sel:[1,0,0]
    s_set_gpr_idx_off
    s_cbranch_scc0 L_exit
    s_setprio 2
    ds_read_b128 v[180:183], v29
    s_waitcnt vmcnt(6)
    v_rcp_f32 v14, v14
    v_mfma_f32_4x4x4_16b_bf16 v[16:19], v[32:33], v[212:213], 0 cbsz:4 abid:4
    v_exp_f32 v13, v139
    v_mfma_f32_4x4x4_16b_bf16 v[20:23], v[32:33], v[214:215], 0 cbsz:4 abid:4
    v_exp_f32 v12, v138
    v_readlane_b32 s48, v7, 5
    v_rcp_f32 v15, v15
    v_pk_add_f32 v[12:13], v[12:13], 1.0 op_sel_hi:[1,0]
    v_pk_mul_f32 v[152:153], v[152:153], v[14:15]
    s_and_b32 s69, s48, 4294966784
    s_set_gpr_idx_on s40, gpr_idx(SRC2,DST)
    buffer_load_dwordx4 v[208:211], v1, s[4:7], s68 offen
    v_pk_fma_f32 v[84:85], v[136:137], v[16:17], v[84:85] op_sel_hi:[0,1,1]
    v_pk_fma_f32 v[86:87], v[136:137], v[18:19], v[86:87] op_sel_hi:[0,1,1]
    v_pk_fma_f32 v[88:89], v[152:153], v[20:21], v[88:89] op_sel_hi:[0,1,1]
    v_pk_fma_f32 v[90:91], v[152:153], v[22:23], v[90:91] op_sel_hi:[0,1,1]
    s_set_gpr_idx_off
    ds_read_b128 v[184:187], v29
    s_waitcnt vmcnt(6)
    v_rcp_f32 v12, v12
    v_mfma_f32_4x4x4_16b_bf16 v[16:19], v[32:33], v[216:217], 0 cbsz:4 abid:5
    v_exp_f32 v15, v155
    v_mfma_f32_4x4x4_16b_bf16 v[20:23], v[32:33], v[218:219], 0 cbsz:4 abid:5
    v_exp_f32 v14, v154
    v_readlane_b32 s49, v7, 6
    v_rcp_f32 v13, v13
    v_pk_add_f32 v[14:15], v[14:15], 1.0 op_sel_hi:[1,0]
    v_pk_mul_f32 v[138:139], v[138:139], v[12:13]
    s_and_b32 s68, s49, 4294966784
    s_set_gpr_idx_on s41, gpr_idx(SRC2,DST)
    buffer_load_dwordx4 v[212:215], v1, s[4:7], s69 offen
    v_pk_fma_f32 v[84:85], v[136:137], v[16:17], v[84:85] op_sel:[1,0,0]
    v_pk_fma_f32 v[86:87], v[136:137], v[18:19], v[86:87] op_sel:[1,0,0]
    v_pk_fma_f32 v[88:89], v[152:153], v[20:21], v[88:89] op_sel:[1,0,0]
    v_pk_fma_f32 v[90:91], v[152:153], v[22:23], v[90:91] op_sel:[1,0,0]
    s_set_gpr_idx_off
    s_cbranch_scc0 L_exit
    ds_read_b128 v[188:191], v29
    s_waitcnt vmcnt(6)
    v_rcp_f32 v14, v14
    v_mfma_f32_4x4x4_16b_bf16 v[16:19], v[32:33], v[220:221], 0 cbsz:4 abid:6
    v_exp_f32 v13, v141
    v_mfma_f32_4x4x4_16b_bf16 v[20:23], v[32:33], v[222:223], 0 cbsz:4 abid:6
    v_exp_f32 v12, v140
    v_readlane_b32 s50, v7, 7
    v_rcp_f32 v15, v15
    v_pk_add_f32 v[12:13], v[12:13], 1.0 op_sel_hi:[1,0]
    v_pk_mul_f32 v[154:155], v[154:155], v[14:15]
    s_and_b32 s69, s50, 4294966784
    s_set_gpr_idx_on s42, gpr_idx(SRC2,DST)
    buffer_load_dwordx4 v[216:219], v1, s[4:7], s68 offen
    v_pk_fma_f32 v[84:85], v[138:139], v[16:17], v[84:85] op_sel_hi:[0,1,1]
    v_pk_fma_f32 v[86:87], v[138:139], v[18:19], v[86:87] op_sel_hi:[0,1,1]
    v_pk_fma_f32 v[88:89], v[154:155], v[20:21], v[88:89] op_sel_hi:[0,1,1]
    v_pk_fma_f32 v[90:91], v[154:155], v[22:23], v[90:91] op_sel_hi:[0,1,1]
    s_set_gpr_idx_off
    ds_read_b128 v[192:195], v29
    s_waitcnt vmcnt(6)
    v_rcp_f32 v12, v12
    v_mfma_f32_4x4x4_16b_bf16 v[16:19], v[32:33], v[224:225], 0 cbsz:4 abid:7
    v_exp_f32 v15, v157
    v_mfma_f32_4x4x4_16b_bf16 v[20:23], v[32:33], v[226:227], 0 cbsz:4 abid:7
    v_exp_f32 v14, v156
    v_readlane_b32 s51, v7, 8
    v_rcp_f32 v13, v13
    v_pk_add_f32 v[14:15], v[14:15], 1.0 op_sel_hi:[1,0]
    v_pk_mul_f32 v[140:141], v[140:141], v[12:13]
    s_and_b32 s68, s51, 4294966784
    s_set_gpr_idx_on s43, gpr_idx(SRC2,DST)
    buffer_load_dwordx4 v[220:223], v1, s[4:7], s69 offen
    v_pk_fma_f32 v[84:85], v[138:139], v[16:17], v[84:85] op_sel:[1,0,0]
    v_pk_fma_f32 v[86:87], v[138:139], v[18:19], v[86:87] op_sel:[1,0,0]
    v_pk_fma_f32 v[88:89], v[154:155], v[20:21], v[88:89] op_sel:[1,0,0]
    v_pk_fma_f32 v[90:91], v[154:155], v[22:23], v[90:91] op_sel:[1,0,0]
    s_set_gpr_idx_off
    s_cbranch_scc0 L_exit
    s_setprio 1
    s_waitcnt vmcnt(6)
    v_rcp_f32 v14, v14
    v_mfma_f32_4x4x4_16b_bf16 v[16:19], v[32:33], v[196:197], 0 cbsz:4 abid:8
    v_exp_f32 v13, v143
    v_mfma_f32_4x4x4_16b_bf16 v[20:23], v[32:33], v[198:199], 0 cbsz:4 abid:8
    v_exp_f32 v12, v142
    v_readlane_b32 s52, v7, 9
    v_rcp_f32 v15, v15
    v_pk_add_f32 v[12:13], v[12:13], 1.0 op_sel_hi:[1,0]
    v_pk_mul_f32 v[156:157], v[156:157], v[14:15]
    s_and_b32 s69, s52, 4294966784
    s_set_gpr_idx_on s44, gpr_idx(SRC2,DST)
    buffer_load_dwordx4 v[224:227], v1, s[4:7], s68 offen
    v_pk_fma_f32 v[84:85], v[140:141], v[16:17], v[84:85] op_sel_hi:[0,1,1]
    v_pk_fma_f32 v[86:87], v[140:141], v[18:19], v[86:87] op_sel_hi:[0,1,1]
    v_pk_fma_f32 v[88:89], v[156:157], v[20:21], v[88:89] op_sel_hi:[0,1,1]
    v_pk_fma_f32 v[90:91], v[156:157], v[22:23], v[90:91] op_sel_hi:[0,1,1]
    s_set_gpr_idx_off
    s_waitcnt vmcnt(6) lgkmcnt(0)
    v_mfma_f32_4x4x4_16b_bf16 v[20:23], v[32:33], v[202:203], 0 cbsz:4 abid:9
    v_mfma_f32_4x4x4_16b_bf16 v[16:19], v[32:33], v[200:201], 0 cbsz:4 abid:9
    v_rcp_f32 v13, v13
    v_smfmac_f32_32x32x32_bf16 v[164:179], v[24:27], v[36:43], v28
    v_exp_f32 v14, v158
    v_exp_f32 v15, v159
    v_readlane_b32 s53, v7, 10
    v_rcp_f32 v12, v12
    v_pk_add_f32 v[14:15], v[14:15], 1.0 op_sel_hi:[1,0]
    v_pk_mul_f32 v[142:143], v[142:143], v[12:13]
    s_and_b32 s68, s53, 4294966784
    s_set_gpr_idx_on s45, gpr_idx(SRC2,DST)
    buffer_load_dwordx4 v[196:199], v1, s[4:7], s69 offen
    v_pk_fma_f32 v[84:85], v[140:141], v[16:17], v[84:85] op_sel:[1,0,0]
    v_pk_fma_f32 v[86:87], v[140:141], v[18:19], v[86:87] op_sel:[1,0,0]
    v_pk_fma_f32 v[88:89], v[156:157], v[20:21], v[88:89] op_sel:[1,0,0]
    v_pk_fma_f32 v[90:91], v[156:157], v[22:23], v[90:91] op_sel:[1,0,0]
    s_set_gpr_idx_off
    s_cbranch_scc0 L_exit
    s_waitcnt vmcnt(6)
    v_rcp_f32 v14, v14
    v_mfma_f32_4x4x4_16b_bf16 v[16:19], v[32:33], v[204:205], 0 cbsz:4 abid:10
    v_exp_f32 v13, v145
    v_mfma_f32_4x4x4_16b_bf16 v[20:23], v[32:33], v[206:207], 0 cbsz:4 abid:10
    v_exp_f32 v12, v144
    v_readlane_b32 s54, v7, 11
    v_rcp_f32 v15, v15
    v_pk_add_f32 v[12:13], v[12:13], 1.0 op_sel_hi:[1,0]
    v_pk_mul_f32 v[158:159], v[158:159], v[14:15]
    s_and_b32 s69, s54, 4294966784
    s_set_gpr_idx_on s46, gpr_idx(SRC2,DST)
    buffer_load_dwordx4 v[200:203], v1, s[4:7], s68 offen
    v_pk_fma_f32 v[84:85], v[142:143], v[16:17], v[84:85] op_sel_hi:[0,1,1]
    v_pk_fma_f32 v[86:87], v[142:143], v[18:19], v[86:87] op_sel_hi:[0,1,1]
    v_pk_fma_f32 v[88:89], v[158:159], v[20:21], v[88:89] op_sel_hi:[0,1,1]
    v_pk_fma_f32 v[90:91], v[158:159], v[22:23], v[90:91] op_sel_hi:[0,1,1]
    s_set_gpr_idx_off
    s_waitcnt vmcnt(6)
    v_mfma_f32_4x4x4_16b_bf16 v[20:23], v[32:33], v[210:211], 0 cbsz:4 abid:11
    v_mfma_f32_4x4x4_16b_bf16 v[16:19], v[32:33], v[208:209], 0 cbsz:4 abid:11
    v_rcp_f32 v13, v13
    v_smfmac_f32_32x32x32_bf16 v[180:195], v[24:27], v[44:51], v28
    v_exp_f32 v14, v160
    v_exp_f32 v15, v161
    v_readlane_b32 s55, v7, 12
    v_rcp_f32 v12, v12
    v_pk_add_f32 v[14:15], v[14:15], 1.0 op_sel_hi:[1,0]
    v_pk_mul_f32 v[144:145], v[144:145], v[12:13]
    s_and_b32 s68, s55, 4294966784
    s_set_gpr_idx_on s47, gpr_idx(SRC2,DST)
    buffer_load_dwordx4 v[204:207], v1, s[4:7], s69 offen
    v_pk_fma_f32 v[84:85], v[142:143], v[16:17], v[84:85] op_sel:[1,0,0]
    v_pk_fma_f32 v[86:87], v[142:143], v[18:19], v[86:87] op_sel:[1,0,0]
    v_pk_fma_f32 v[88:89], v[158:159], v[20:21], v[88:89] op_sel:[1,0,0]
    v_pk_fma_f32 v[90:91], v[158:159], v[22:23], v[90:91] op_sel:[1,0,0]
    s_set_gpr_idx_off
    s_cbranch_scc0 L_exit
    s_setprio 0
    s_waitcnt vmcnt(6)
    v_rcp_f32 v14, v14
    v_mfma_f32_4x4x4_16b_bf16 v[16:19], v[32:33], v[212:213], 0 cbsz:4 abid:12
    v_exp_f32 v13, v147
    v_mfma_f32_4x4x4_16b_bf16 v[20:23], v[32:33], v[214:215], 0 cbsz:4 abid:12
    v_exp_f32 v12, v146
    v_readlane_b32 s56, v7, 13
    v_rcp_f32 v15, v15
    v_pk_add_f32 v[12:13], v[12:13], 1.0 op_sel_hi:[1,0]
    v_pk_mul_f32 v[160:161], v[160:161], v[14:15]
    s_and_b32 s69, s56, 4294966784
    s_set_gpr_idx_on s48, gpr_idx(SRC2,DST)
    buffer_load_dwordx4 v[208:211], v1, s[4:7], s68 offen
    v_pk_fma_f32 v[84:85], v[144:145], v[16:17], v[84:85] op_sel_hi:[0,1,1]
    v_pk_fma_f32 v[86:87], v[144:145], v[18:19], v[86:87] op_sel_hi:[0,1,1]
    v_pk_fma_f32 v[88:89], v[160:161], v[20:21], v[88:89] op_sel_hi:[0,1,1]
    v_pk_fma_f32 v[90:91], v[160:161], v[22:23], v[90:91] op_sel_hi:[0,1,1]
    s_set_gpr_idx_off
    s_waitcnt vmcnt(6)
    v_rcp_f32 v12, v12
    v_mfma_f32_4x4x4_16b_bf16 v[16:19], v[32:33], v[216:217], 0 cbsz:4 abid:13
    v_exp_f32 v15, v163
    v_mfma_f32_4x4x4_16b_bf16 v[20:23], v[32:33], v[218:219], 0 cbsz:4 abid:13
    v_exp_f32 v14, v162
    v_readlane_b32 s57, v7, 14
    v_rcp_f32 v13, v13
    v_pk_add_f32 v[14:15], v[14:15], 1.0 op_sel_hi:[1,0]
    v_pk_mul_f32 v[146:147], v[146:147], v[12:13]
    s_and_b32 s68, s57, 4294966784
    s_set_gpr_idx_on s49, gpr_idx(SRC2,DST)
    buffer_load_dwordx4 v[212:215], v1, s[4:7], s69 offen
    v_pk_fma_f32 v[84:85], v[144:145], v[16:17], v[84:85] op_sel:[1,0,0]
    v_pk_fma_f32 v[86:87], v[144:145], v[18:19], v[86:87] op_sel:[1,0,0]
    v_pk_fma_f32 v[88:89], v[160:161], v[20:21], v[88:89] op_sel:[1,0,0]
    v_pk_fma_f32 v[90:91], v[160:161], v[22:23], v[90:91] op_sel:[1,0,0]
    s_set_gpr_idx_off
    s_cbranch_scc0 L_exit
    s_waitcnt vmcnt(6)
    v_rcp_f32 v14, v14
    v_mfma_f32_4x4x4_16b_bf16 v[16:19], v[32:33], v[220:221], 0 cbsz:4 abid:14
    v_exp_f32 v13, v165
    v_mfma_f32_4x4x4_16b_bf16 v[20:23], v[32:33], v[222:223], 0 cbsz:4 abid:14
    v_exp_f32 v12, v164
    v_readlane_b32 s58, v7, 15
    v_rcp_f32 v15, v15
    v_pk_add_f32 v[12:13], v[12:13], 1.0 op_sel_hi:[1,0]
    v_pk_mul_f32 v[162:163], v[162:163], v[14:15]
    s_and_b32 s69, s58, 4294966784
    s_set_gpr_idx_on s50, gpr_idx(SRC2,DST)
    buffer_load_dwordx4 v[216:219], v1, s[4:7], s68 offen
    v_pk_fma_f32 v[84:85], v[146:147], v[16:17], v[84:85] op_sel_hi:[0,1,1]
    v_pk_fma_f32 v[86:87], v[146:147], v[18:19], v[86:87] op_sel_hi:[0,1,1]
    v_pk_fma_f32 v[88:89], v[162:163], v[20:21], v[88:89] op_sel_hi:[0,1,1]
    v_pk_fma_f32 v[90:91], v[162:163], v[22:23], v[90:91] op_sel_hi:[0,1,1]
    s_set_gpr_idx_off
    s_waitcnt vmcnt(6)
    v_rcp_f32 v12, v12
    v_mfma_f32_4x4x4_16b_bf16 v[16:19], v[32:33], v[224:225], 0 cbsz:4 abid:15
    v_exp_f32 v15, v181
    v_mfma_f32_4x4x4_16b_bf16 v[20:23], v[32:33], v[226:227], 0 cbsz:4 abid:15
    v_exp_f32 v14, v180
    v_readlane_b32 s59, v8, 0
    v_rcp_f32 v13, v13
    v_pk_add_f32 v[14:15], v[14:15], 1.0 op_sel_hi:[1,0]
    v_pk_mul_f32 v[164:165], v[164:165], v[12:13]
    s_and_b32 s68, s59, 4294966784
    s_set_gpr_idx_on s51, gpr_idx(SRC2,DST)
    buffer_load_dwordx4 v[220:223], v1, s[4:7], s69 offen
    v_pk_fma_f32 v[84:85], v[146:147], v[16:17], v[84:85] op_sel:[1,0,0]
    v_pk_fma_f32 v[86:87], v[146:147], v[18:19], v[86:87] op_sel:[1,0,0]
    v_pk_fma_f32 v[88:89], v[162:163], v[20:21], v[88:89] op_sel:[1,0,0]
    v_pk_fma_f32 v[90:91], v[162:163], v[22:23], v[90:91] op_sel:[1,0,0]
    s_set_gpr_idx_off
    s_cbranch_scc0 L_exit
    s_setprio 3
    ds_read_b32 v9, v5 offset:260
    ds_read_b32 v10, v6 offset:260
    ds_read_b32 v7, v4 offset:312
    ds_read_b128 v[132:135], v29
    s_waitcnt vmcnt(6)
    v_rcp_f32 v14, v14
    v_mfma_f32_4x4x4_16b_bf16 v[16:19], v[34:35], v[196:197], 0 cbsz:4 abid:0
    v_exp_f32 v13, v167
    v_mfma_f32_4x4x4_16b_bf16 v[20:23], v[34:35], v[198:199], 0 cbsz:4 abid:0
    v_exp_f32 v12, v166
    v_readlane_b32 s60, v8, 1
    v_rcp_f32 v15, v15
    v_pk_add_f32 v[12:13], v[12:13], 1.0 op_sel_hi:[1,0]
    v_pk_mul_f32 v[180:181], v[180:181], v[14:15]
    s_and_b32 s69, s60, 4294966784
    s_set_gpr_idx_on s52, gpr_idx(SRC2,DST)
    buffer_load_dwordx4 v[224:227], v1, s[4:7], s68 offen
    v_pk_fma_f32 v[84:85], v[164:165], v[16:17], v[84:85] op_sel_hi:[0,1,1]
    v_pk_fma_f32 v[86:87], v[164:165], v[18:19], v[86:87] op_sel_hi:[0,1,1]
    v_pk_fma_f32 v[88:89], v[180:181], v[20:21], v[88:89] op_sel_hi:[0,1,1]
    v_pk_fma_f32 v[90:91], v[180:181], v[22:23], v[90:91] op_sel_hi:[0,1,1]
    s_set_gpr_idx_off
    ds_read_b128 v[136:139], v29
    s_waitcnt vmcnt(6)
    v_rcp_f32 v12, v12
    v_mfma_f32_4x4x4_16b_bf16 v[16:19], v[34:35], v[200:201], 0 cbsz:4 abid:1
    v_exp_f32 v15, v183
    v_mfma_f32_4x4x4_16b_bf16 v[20:23], v[34:35], v[202:203], 0 cbsz:4 abid:1
    v_exp_f32 v14, v182
    v_readlane_b32 s61, v8, 2
    v_rcp_f32 v13, v13
    v_pk_add_f32 v[14:15], v[14:15], 1.0 op_sel_hi:[1,0]
    v_pk_mul_f32 v[166:167], v[166:167], v[12:13]
    s_and_b32 s68, s61, 4294966784
    s_set_gpr_idx_on s53, gpr_idx(SRC2,DST)
    buffer_load_dwordx4 v[196:199], v1, s[4:7], s69 offen
    v_pk_fma_f32 v[84:85], v[164:165], v[16:17], v[84:85] op_sel:[1,0,0]
    v_pk_fma_f32 v[86:87], v[164:165], v[18:19], v[86:87] op_sel:[1,0,0]
    v_pk_fma_f32 v[88:89], v[180:181], v[20:21], v[88:89] op_sel:[1,0,0]
    v_pk_fma_f32 v[90:91], v[180:181], v[22:23], v[90:91] op_sel:[1,0,0]
    s_set_gpr_idx_off
    s_cbranch_scc0 L_exit
    s_waitcnt lgkmcnt(0)
    v_add_u32 v9, v9, v2
    v_add_u32 v10, v10, v3
    ds_read_b128 v[24:27], v9 offset:63232
    ds_read_b64 v[32:33], v10
    ds_read_b128 v[140:143], v29
    s_waitcnt vmcnt(6)
    v_rcp_f32 v14, v14
    v_mfma_f32_4x4x4_16b_bf16 v[16:19], v[34:35], v[204:205], 0 cbsz:4 abid:2
    v_exp_f32 v13, v169
    v_mfma_f32_4x4x4_16b_bf16 v[20:23], v[34:35], v[206:207], 0 cbsz:4 abid:2
    v_exp_f32 v12, v168
    v_readlane_b32 s62, v8, 3
    v_rcp_f32 v15, v15
    v_pk_add_f32 v[12:13], v[12:13], 1.0 op_sel_hi:[1,0]
    v_pk_mul_f32 v[182:183], v[182:183], v[14:15]
    s_and_b32 s69, s62, 4294966784
    s_set_gpr_idx_on s54, gpr_idx(SRC2,DST)
    buffer_load_dwordx4 v[200:203], v1, s[4:7], s68 offen
    v_pk_fma_f32 v[84:85], v[166:167], v[16:17], v[84:85] op_sel_hi:[0,1,1]
    v_pk_fma_f32 v[86:87], v[166:167], v[18:19], v[86:87] op_sel_hi:[0,1,1]
    v_pk_fma_f32 v[88:89], v[182:183], v[20:21], v[88:89] op_sel_hi:[0,1,1]
    v_pk_fma_f32 v[90:91], v[182:183], v[22:23], v[90:91] op_sel_hi:[0,1,1]
    s_set_gpr_idx_off
    ds_read_b128 v[144:147], v29
    s_waitcnt vmcnt(6)
    v_rcp_f32 v12, v12
    v_mfma_f32_4x4x4_16b_bf16 v[16:19], v[34:35], v[208:209], 0 cbsz:4 abid:3
    v_exp_f32 v15, v185
    v_mfma_f32_4x4x4_16b_bf16 v[20:23], v[34:35], v[210:211], 0 cbsz:4 abid:3
    v_exp_f32 v14, v184
    v_readlane_b32 s63, v8, 4
    v_rcp_f32 v13, v13
    v_pk_add_f32 v[14:15], v[14:15], 1.0 op_sel_hi:[1,0]
    v_pk_mul_f32 v[168:169], v[168:169], v[12:13]
    s_and_b32 s68, s63, 4294966784
    s_set_gpr_idx_on s55, gpr_idx(SRC2,DST)
    buffer_load_dwordx4 v[204:207], v1, s[4:7], s69 offen
    v_pk_fma_f32 v[84:85], v[166:167], v[16:17], v[84:85] op_sel:[1,0,0]
    v_pk_fma_f32 v[86:87], v[166:167], v[18:19], v[86:87] op_sel:[1,0,0]
    v_pk_fma_f32 v[88:89], v[182:183], v[20:21], v[88:89] op_sel:[1,0,0]
    v_pk_fma_f32 v[90:91], v[182:183], v[22:23], v[90:91] op_sel:[1,0,0]
    s_set_gpr_idx_off
    s_cbranch_scc0 L_exit
    s_setprio 2
    ds_read_b128 v[148:151], v29
    s_waitcnt vmcnt(6)
    v_rcp_f32 v14, v14
    v_mfma_f32_4x4x4_16b_bf16 v[16:19], v[34:35], v[212:213], 0 cbsz:4 abid:4
    v_exp_f32 v13, v171
    v_mfma_f32_4x4x4_16b_bf16 v[20:23], v[34:35], v[214:215], 0 cbsz:4 abid:4
    v_exp_f32 v12, v170
    v_readlane_b32 s64, v8, 5
    v_rcp_f32 v15, v15
    v_pk_add_f32 v[12:13], v[12:13], 1.0 op_sel_hi:[1,0]
    v_pk_mul_f32 v[184:185], v[184:185], v[14:15]
    s_and_b32 s69, s64, 4294966784
    s_set_gpr_idx_on s56, gpr_idx(SRC2,DST)
    buffer_load_dwordx4 v[208:211], v1, s[4:7], s68 offen
    v_pk_fma_f32 v[84:85], v[168:169], v[16:17], v[84:85] op_sel_hi:[0,1,1]
    v_pk_fma_f32 v[86:87], v[168:169], v[18:19], v[86:87] op_sel_hi:[0,1,1]
    v_pk_fma_f32 v[88:89], v[184:185], v[20:21], v[88:89] op_sel_hi:[0,1,1]
    v_pk_fma_f32 v[90:91], v[184:185], v[22:23], v[90:91] op_sel_hi:[0,1,1]
    s_set_gpr_idx_off
    ds_read_b128 v[152:155], v29
    s_waitcnt vmcnt(6)
    v_rcp_f32 v12, v12
    v_mfma_f32_4x4x4_16b_bf16 v[16:19], v[34:35], v[216:217], 0 cbsz:4 abid:5
    v_exp_f32 v15, v187
    v_mfma_f32_4x4x4_16b_bf16 v[20:23], v[34:35], v[218:219], 0 cbsz:4 abid:5
    v_exp_f32 v14, v186
    v_readlane_b32 s65, v8, 6
    v_rcp_f32 v13, v13
    v_pk_add_f32 v[14:15], v[14:15], 1.0 op_sel_hi:[1,0]
    v_pk_mul_f32 v[170:171], v[170:171], v[12:13]
    s_and_b32 s68, s65, 4294966784
    s_set_gpr_idx_on s57, gpr_idx(SRC2,DST)
    buffer_load_dwordx4 v[212:215], v1, s[4:7], s69 offen
    v_pk_fma_f32 v[84:85], v[168:169], v[16:17], v[84:85] op_sel:[1,0,0]
    v_pk_fma_f32 v[86:87], v[168:169], v[18:19], v[86:87] op_sel:[1,0,0]
    v_pk_fma_f32 v[88:89], v[184:185], v[20:21], v[88:89] op_sel:[1,0,0]
    v_pk_fma_f32 v[90:91], v[184:185], v[22:23], v[90:91] op_sel:[1,0,0]
    s_set_gpr_idx_off
    s_cbranch_scc0 L_exit
    ds_read_b128 v[156:159], v29
    s_waitcnt vmcnt(6)
    v_rcp_f32 v14, v14
    v_mfma_f32_4x4x4_16b_bf16 v[16:19], v[34:35], v[220:221], 0 cbsz:4 abid:6
    v_exp_f32 v13, v173
    v_mfma_f32_4x4x4_16b_bf16 v[20:23], v[34:35], v[222:223], 0 cbsz:4 abid:6
    v_exp_f32 v12, v172
    v_readlane_b32 s66, v8, 7
    v_rcp_f32 v15, v15
    v_pk_add_f32 v[12:13], v[12:13], 1.0 op_sel_hi:[1,0]
    v_pk_mul_f32 v[186:187], v[186:187], v[14:15]
    s_and_b32 s69, s66, 4294966784
    s_set_gpr_idx_on s58, gpr_idx(SRC2,DST)
    buffer_load_dwordx4 v[216:219], v1, s[4:7], s68 offen
    v_pk_fma_f32 v[84:85], v[170:171], v[16:17], v[84:85] op_sel_hi:[0,1,1]
    v_pk_fma_f32 v[86:87], v[170:171], v[18:19], v[86:87] op_sel_hi:[0,1,1]
    v_pk_fma_f32 v[88:89], v[186:187], v[20:21], v[88:89] op_sel_hi:[0,1,1]
    v_pk_fma_f32 v[90:91], v[186:187], v[22:23], v[90:91] op_sel_hi:[0,1,1]
    s_set_gpr_idx_off
    ds_read_b128 v[160:163], v29
    s_waitcnt vmcnt(6)
    v_rcp_f32 v12, v12
    v_mfma_f32_4x4x4_16b_bf16 v[16:19], v[34:35], v[224:225], 0 cbsz:4 abid:7
    v_exp_f32 v15, v189
    v_mfma_f32_4x4x4_16b_bf16 v[20:23], v[34:35], v[226:227], 0 cbsz:4 abid:7
    v_exp_f32 v14, v188
    v_readlane_b32 s67, v8, 8
    v_rcp_f32 v13, v13
    v_pk_add_f32 v[14:15], v[14:15], 1.0 op_sel_hi:[1,0]
    v_pk_mul_f32 v[172:173], v[172:173], v[12:13]
    s_and_b32 s68, s67, 4294966784
    s_set_gpr_idx_on s59, gpr_idx(SRC2,DST)
    buffer_load_dwordx4 v[220:223], v1, s[4:7], s69 offen
    v_pk_fma_f32 v[84:85], v[170:171], v[16:17], v[84:85] op_sel:[1,0,0]
    v_pk_fma_f32 v[86:87], v[170:171], v[18:19], v[86:87] op_sel:[1,0,0]
    v_pk_fma_f32 v[88:89], v[186:187], v[20:21], v[88:89] op_sel:[1,0,0]
    v_pk_fma_f32 v[90:91], v[186:187], v[22:23], v[90:91] op_sel:[1,0,0]
    s_set_gpr_idx_off
    s_cbranch_scc0 L_exit
    s_setprio 1
    s_waitcnt vmcnt(6)
    v_rcp_f32 v14, v14
    v_mfma_f32_4x4x4_16b_bf16 v[16:19], v[34:35], v[196:197], 0 cbsz:4 abid:8
    v_exp_f32 v13, v175
    v_mfma_f32_4x4x4_16b_bf16 v[20:23], v[34:35], v[198:199], 0 cbsz:4 abid:8
    v_exp_f32 v12, v174
    v_readlane_b32 s36, v8, 9
    v_rcp_f32 v15, v15
    v_pk_add_f32 v[12:13], v[12:13], 1.0 op_sel_hi:[1,0]
    v_pk_mul_f32 v[188:189], v[188:189], v[14:15]
    s_and_b32 s69, s36, 4294966784
    s_set_gpr_idx_on s60, gpr_idx(SRC2,DST)
    buffer_load_dwordx4 v[224:227], v1, s[4:7], s68 offen
    v_pk_fma_f32 v[84:85], v[172:173], v[16:17], v[84:85] op_sel_hi:[0,1,1]
    v_pk_fma_f32 v[86:87], v[172:173], v[18:19], v[86:87] op_sel_hi:[0,1,1]
    v_pk_fma_f32 v[88:89], v[188:189], v[20:21], v[88:89] op_sel_hi:[0,1,1]
    v_pk_fma_f32 v[90:91], v[188:189], v[22:23], v[90:91] op_sel_hi:[0,1,1]
    s_set_gpr_idx_off
    s_waitcnt vmcnt(6) lgkmcnt(0)
    v_mfma_f32_4x4x4_16b_bf16 v[20:23], v[34:35], v[202:203], 0 cbsz:4 abid:9
    v_mfma_f32_4x4x4_16b_bf16 v[16:19], v[34:35], v[200:201], 0 cbsz:4 abid:9
    v_rcp_f32 v13, v13
    v_smfmac_f32_32x32x32_bf16 v[132:147], v[24:27], v[36:43], v28
    v_exp_f32 v14, v190
    v_exp_f32 v15, v191
    v_readlane_b32 s37, v8, 10
    v_rcp_f32 v12, v12
    v_pk_add_f32 v[14:15], v[14:15], 1.0 op_sel_hi:[1,0]
    v_pk_mul_f32 v[174:175], v[174:175], v[12:13]
    s_and_b32 s68, s37, 4294966784
    s_set_gpr_idx_on s61, gpr_idx(SRC2,DST)
    buffer_load_dwordx4 v[196:199], v1, s[4:7], s69 offen
    v_pk_fma_f32 v[84:85], v[172:173], v[16:17], v[84:85] op_sel:[1,0,0]
    v_pk_fma_f32 v[86:87], v[172:173], v[18:19], v[86:87] op_sel:[1,0,0]
    v_pk_fma_f32 v[88:89], v[188:189], v[20:21], v[88:89] op_sel:[1,0,0]
    v_pk_fma_f32 v[90:91], v[188:189], v[22:23], v[90:91] op_sel:[1,0,0]
    s_set_gpr_idx_off
    s_cbranch_scc0 L_exit
    s_waitcnt vmcnt(6)
    v_rcp_f32 v14, v14
    v_mfma_f32_4x4x4_16b_bf16 v[16:19], v[34:35], v[204:205], 0 cbsz:4 abid:10
    v_exp_f32 v13, v177
    v_mfma_f32_4x4x4_16b_bf16 v[20:23], v[34:35], v[206:207], 0 cbsz:4 abid:10
    v_exp_f32 v12, v176
    v_readlane_b32 s38, v8, 11
    v_rcp_f32 v15, v15
    v_pk_add_f32 v[12:13], v[12:13], 1.0 op_sel_hi:[1,0]
    v_pk_mul_f32 v[190:191], v[190:191], v[14:15]
    s_and_b32 s69, s38, 4294966784
    s_set_gpr_idx_on s62, gpr_idx(SRC2,DST)
    buffer_load_dwordx4 v[200:203], v1, s[4:7], s68 offen
    v_pk_fma_f32 v[84:85], v[174:175], v[16:17], v[84:85] op_sel_hi:[0,1,1]
    v_pk_fma_f32 v[86:87], v[174:175], v[18:19], v[86:87] op_sel_hi:[0,1,1]
    v_pk_fma_f32 v[88:89], v[190:191], v[20:21], v[88:89] op_sel_hi:[0,1,1]
    v_pk_fma_f32 v[90:91], v[190:191], v[22:23], v[90:91] op_sel_hi:[0,1,1]
    s_set_gpr_idx_off
    s_waitcnt vmcnt(6)
    v_mfma_f32_4x4x4_16b_bf16 v[20:23], v[34:35], v[210:211], 0 cbsz:4 abid:11
    v_mfma_f32_4x4x4_16b_bf16 v[16:19], v[34:35], v[208:209], 0 cbsz:4 abid:11
    v_rcp_f32 v13, v13
    v_smfmac_f32_32x32x32_bf16 v[148:163], v[24:27], v[44:51], v28
    v_exp_f32 v14, v192
    v_exp_f32 v15, v193
    v_readlane_b32 s39, v8, 12
    v_rcp_f32 v12, v12
    v_pk_add_f32 v[14:15], v[14:15], 1.0 op_sel_hi:[1,0]
    v_pk_mul_f32 v[176:177], v[176:177], v[12:13]
    s_and_b32 s68, s39, 4294966784
    s_set_gpr_idx_on s63, gpr_idx(SRC2,DST)
    buffer_load_dwordx4 v[204:207], v1, s[4:7], s69 offen
    v_pk_fma_f32 v[84:85], v[174:175], v[16:17], v[84:85] op_sel:[1,0,0]
    v_pk_fma_f32 v[86:87], v[174:175], v[18:19], v[86:87] op_sel:[1,0,0]
    v_pk_fma_f32 v[88:89], v[190:191], v[20:21], v[88:89] op_sel:[1,0,0]
    v_pk_fma_f32 v[90:91], v[190:191], v[22:23], v[90:91] op_sel:[1,0,0]
    s_set_gpr_idx_off
    s_cbranch_scc0 L_exit
    s_setprio 0
    s_waitcnt vmcnt(6)
    v_rcp_f32 v14, v14
    v_mfma_f32_4x4x4_16b_bf16 v[16:19], v[34:35], v[212:213], 0 cbsz:4 abid:12
    v_exp_f32 v13, v179
    v_mfma_f32_4x4x4_16b_bf16 v[20:23], v[34:35], v[214:215], 0 cbsz:4 abid:12
    v_exp_f32 v12, v178
    v_readlane_b32 s40, v8, 13
    v_rcp_f32 v15, v15
    v_pk_add_f32 v[12:13], v[12:13], 1.0 op_sel_hi:[1,0]
    v_pk_mul_f32 v[192:193], v[192:193], v[14:15]
    s_and_b32 s69, s40, 4294966784
    s_set_gpr_idx_on s64, gpr_idx(SRC2,DST)
    buffer_load_dwordx4 v[208:211], v1, s[4:7], s68 offen
    v_pk_fma_f32 v[84:85], v[176:177], v[16:17], v[84:85] op_sel_hi:[0,1,1]
    v_pk_fma_f32 v[86:87], v[176:177], v[18:19], v[86:87] op_sel_hi:[0,1,1]
    v_pk_fma_f32 v[88:89], v[192:193], v[20:21], v[88:89] op_sel_hi:[0,1,1]
    v_pk_fma_f32 v[90:91], v[192:193], v[22:23], v[90:91] op_sel_hi:[0,1,1]
    s_set_gpr_idx_off
    s_waitcnt vmcnt(6)
    v_rcp_f32 v12, v12
    v_mfma_f32_4x4x4_16b_bf16 v[16:19], v[34:35], v[216:217], 0 cbsz:4 abid:13
    v_exp_f32 v15, v195
    v_mfma_f32_4x4x4_16b_bf16 v[20:23], v[34:35], v[218:219], 0 cbsz:4 abid:13
    v_exp_f32 v14, v194
    v_readlane_b32 s41, v8, 14
    v_rcp_f32 v13, v13
    v_pk_add_f32 v[14:15], v[14:15], 1.0 op_sel_hi:[1,0]
    v_pk_mul_f32 v[178:179], v[178:179], v[12:13]
    s_and_b32 s68, s41, 4294966784
    s_set_gpr_idx_on s65, gpr_idx(SRC2,DST)
    buffer_load_dwordx4 v[212:215], v1, s[4:7], s69 offen
    v_pk_fma_f32 v[84:85], v[176:177], v[16:17], v[84:85] op_sel:[1,0,0]
    v_pk_fma_f32 v[86:87], v[176:177], v[18:19], v[86:87] op_sel:[1,0,0]
    v_pk_fma_f32 v[88:89], v[192:193], v[20:21], v[88:89] op_sel:[1,0,0]
    v_pk_fma_f32 v[90:91], v[192:193], v[22:23], v[90:91] op_sel:[1,0,0]
    s_set_gpr_idx_off
    s_cbranch_scc0 L_exit
    s_waitcnt vmcnt(6)
    v_rcp_f32 v14, v14
    v_mfma_f32_4x4x4_16b_bf16 v[16:19], v[34:35], v[220:221], 0 cbsz:4 abid:14
    v_exp_f32 v13, v133
    v_mfma_f32_4x4x4_16b_bf16 v[20:23], v[34:35], v[222:223], 0 cbsz:4 abid:14
    v_exp_f32 v12, v132
    v_readlane_b32 s42, v8, 15
    v_rcp_f32 v15, v15
    v_pk_add_f32 v[12:13], v[12:13], 1.0 op_sel_hi:[1,0]
    v_pk_mul_f32 v[194:195], v[194:195], v[14:15]
    s_and_b32 s69, s42, 4294966784
    s_set_gpr_idx_on s66, gpr_idx(SRC2,DST)
    buffer_load_dwordx4 v[216:219], v1, s[4:7], s68 offen
    v_pk_fma_f32 v[84:85], v[178:179], v[16:17], v[84:85] op_sel_hi:[0,1,1]
    v_pk_fma_f32 v[86:87], v[178:179], v[18:19], v[86:87] op_sel_hi:[0,1,1]
    v_pk_fma_f32 v[88:89], v[194:195], v[20:21], v[88:89] op_sel_hi:[0,1,1]
    v_pk_fma_f32 v[90:91], v[194:195], v[22:23], v[90:91] op_sel_hi:[0,1,1]
    s_set_gpr_idx_off
    s_waitcnt vmcnt(6)
    v_rcp_f32 v12, v12
    v_mfma_f32_4x4x4_16b_bf16 v[16:19], v[34:35], v[224:225], 0 cbsz:4 abid:15
    v_exp_f32 v15, v149
    v_mfma_f32_4x4x4_16b_bf16 v[20:23], v[34:35], v[226:227], 0 cbsz:4 abid:15
    v_exp_f32 v14, v148
    v_readlane_b32 s43, v7, 0
    v_rcp_f32 v13, v13
    v_pk_add_f32 v[14:15], v[14:15], 1.0 op_sel_hi:[1,0]
    v_pk_mul_f32 v[132:133], v[132:133], v[12:13]
    s_and_b32 s68, s43, 4294966784
    s_set_gpr_idx_on s67, gpr_idx(SRC2,DST)
    buffer_load_dwordx4 v[220:223], v1, s[4:7], s69 offen
    v_pk_fma_f32 v[84:85], v[178:179], v[16:17], v[84:85] op_sel:[1,0,0]
    v_pk_fma_f32 v[86:87], v[178:179], v[18:19], v[86:87] op_sel:[1,0,0]
    v_pk_fma_f32 v[88:89], v[194:195], v[20:21], v[88:89] op_sel:[1,0,0]
    v_pk_fma_f32 v[90:91], v[194:195], v[22:23], v[90:91] op_sel:[1,0,0]
    s_set_gpr_idx_off
    s_cbranch_scc0 L_exit
    v_add_u32 v4, 256, v4
    v_add_u32 v5, 256, v5
    v_add_u32 v6, 256, v6
    s_branch L_loop
L_giveup:
    s_mov_b64 exec, -1
    v_mov_b64 v[164:165], 0
    v_mov_b64 v[166:167], 0
    v_add_u32 v168, 161536, v1
    ds_write_b128 v168, v[164:167]
    v_mov_b32 v172, 0x00300000
    v_mov_b32 v173, 0x00300000
    v_mov_b32 v174, 0x00300000
    v_mov_b32 v175, 0x00300000
    ds_write_b128 v1, v[172:175] offset:20224
    ds_write_b128 v1, v[172:175] offset:21248
    ds_write_b128 v1, v[172:175] offset:22272
    ds_write_b128 v1, v[172:175] offset:23296
    ds_write_b128 v1, v[172:175] offset:24320
    ds_write_b128 v1, v[172:175] offset:25344
    s_branch L_fok
L_more:
    s_waitcnt vmcnt(0) lgkmcnt(0)
    s_barrier
    v_lshlrev_b32 v188, 4, v0
    v_add_u32 v189, 8192, v188
    v_add_u32 v190, 16384, v188
    v_add_u32 v191, 24576, v188
    v_add_u32 v192, 32768, v188
    v_add_u32 v193, 40960, v188
    v_lshlrev_b32 v194, 2, v0
    v_lshlrev_b32 v14, 3, v0
    v_mov_b32 v16, 0
    v_mov_b32 v17, 0
    v_mov_b32 v15, 0x00300000
    ds_write_b64 v14, v[16:17] offset:16128
    ds_write_b32 v194, v15 offset:20224
    ds_write_b32 v194, v15 offset:22272
    ds_write_b32 v194, v15 offset:24320
    v_lshrrev_b32 v195, 1, v0
    v_lshlrev_b32 v195, 2, v195
    s_branch L_round
L_exit:
    s_add_u32 s28, s28, 1536
    s_cmp_lt_u32 s28, s25
    s_cbranch_scc1 L_more
    s_mov_b32 m0, s96
    s_mov_b32 s68, 0xbf317218
    s_mov_b32 s69, s68
    v_pk_mul_f32 v[84:85], v[84:85], s[68:69]
    v_pk_mul_f32 v[86:87], v[86:87], s[68:69]
    v_pk_mul_f32 v[88:89], v[88:89], s[68:69]
    v_pk_mul_f32 v[90:91], v[90:91], s[68:69]
    v_cvt_pk_bf16_f32 v84, v84, v88
    v_cvt_pk_bf16_f32 v85, v85, v89
    v_cvt_pk_bf16_f32 v86, v86, v90
    v_cvt_pk_bf16_f32 v87, v87, v91
    ds_write_addtid_b32 v84 offset:16128
    ds_write_addtid_b32 v85 offset:16416
    ds_write_addtid_b32 v86 offset:16704
    ds_write_addtid_b32 v87 offset:16992
    s_mov_b32 m0, s97
    v_pk_mul_f32 v[92:93], v[92:93], s[68:69]
    v_pk_mul_f32 v[94:95], v[94:95], s[68:69]
    v_pk_mul_f32 v[96:97], v[96:97], s[68:69]
    v_pk_mul_f32 v[98:99], v[98:99], s[68:69]
    v_cvt_pk_bf16_f32 v92, v92, v96
    v_cvt_pk_bf16_f32 v93, v93, v97
    v_cvt_pk_bf16_f32 v94, v94, v98
    v_cvt_pk_bf16_f32 v95, v95, v99
    ds_write_addtid_b32 v92 offset:16128
    ds_write_addtid_b32 v93 offset:16416
    ds_write_addtid_b32 v94 offset:16704
    ds_write_addtid_b32 v95 offset:16992
    s_mov_b32 m0, s98
    v_pk_mul_f32 v[100:101], v[100:101], s[68:69]
    v_pk_mul_f32 v[102:103], v[102:103], s[68:69]
    v_pk_mul_f32 v[104:105], v[104:105], s[68:69]
    v_pk_mul_f32 v[106:107], v[106:107], s[68:69]
    v_cvt_pk_bf16_f32 v100, v100, v104
    v_cvt_pk_bf16_f32 v101, v101, v105
    v_cvt_pk_bf16_f32 v102, v102, v106
    v_cvt_pk_bf16_f32 v103, v103, v107
    ds_write_addtid_b32 v100 offset:16128
    ds_write_addtid_b32 v101 offset:16416
    ds_write_addtid_b32 v102 offset:16704
    ds_write_addtid_b32 v103 offset:16992
    s_mov_b32 m0, s99
    v_pk_mul_f32 v[108:109], v[108:109], s[68:69]
    v_pk_mul_f32 v[110:111], v[110:111], s[68:69]
    v_pk_mul_f32 v[112:113], v[112:113], s[68:69]
    v_pk_mul_f32 v[114:115], v[114:115], s[68:69]
    v_cvt_pk_bf16_f32 v108, v108, v112
    v_cvt_pk_bf16_f32 v109, v109, v113
    v_cvt_pk_bf16_f32 v110, v110, v114
    v_cvt_pk_bf16_f32 v111, v111, v115
    ds_write_addtid_b32 v108 offset:16128
    ds_write_addtid_b32 v109 offset:16416
    ds_write_addtid_b32 v110 offset:16704
    ds_write_addtid_b32 v111 offset:16992
    s_mov_b32 m0, s100
    v_pk_mul_f32 v[116:117], v[116:117], s[68:69]
    v_pk_mul_f32 v[118:119], v[118:119], s[68:69]
    v_pk_mul_f32 v[120:121], v[120:121], s[68:69]
    v_pk_mul_f32 v[122:123], v[122:123], s[68:69]
    v_cvt_pk_bf16_f32 v116, v116, v120
    v_cvt_pk_bf16_f32 v117, v117, v121
    v_cvt_pk_bf16_f32 v118, v118, v122
    v_cvt_pk_bf16_f32 v119, v119, v123
    ds_write_addtid_b32 v116 offset:16128
    ds_write_addtid_b32 v117 offset:16416
    ds_write_addtid_b32 v118 offset:16704
    ds_write_addtid_b32 v119 offset:16992
    s_mov_b32 s68, 0xbf317218
    s_waitcnt lgkmcnt(0)
    s_barrier
    ds_read_b128 v[84:87], v232 offset:16128
    ds_read_b128 v[88:91], v232 offset:16192
    ds_read_b128 v[92:95], v232 offset:16256
    ds_read_b128 v[96:99], v232 offset:16320
    ds_read_b128 v[100:103], v232 offset:20736
    ds_read_b128 v[104:107], v232 offset:20800
    ds_read_b128 v[108:111], v232 offset:20864
    ds_read_b128 v[112:115], v232 offset:20928
    s_waitcnt lgkmcnt(7)
    v_mfma_f32_16x16x32_bf16 v[116:119], v[84:87], v[52:55], 0
    v_mfma_f32_16x16x32_bf16 v[120:123], v[84:87], v[56:59], 0
    s_waitcnt lgkmcnt(6)
    v_mfma_f32_16x16x32_bf16 v[116:119], v[88:91], v[60:63], v[116:119]
    v_mfma_f32_16x16x32_bf16 v[120:123], v[88:91], v[64:67], v[120:123]
    s_waitcnt lgkmcnt(5)
    v_mfma_f32_16x16x32_bf16 v[116:119], v[92:95], v[68:71], v[116:119]
    v_mfma_f32_16x16x32_bf16 v[120:123], v[92:95], v[72:75], v[120:123]
    s_waitcnt lgkmcnt(4)
    v_mfma_f32_16x16x32_bf16 v[116:119], v[96:99], v[76:79], v[116:119]
    v_mfma_f32_16x16x32_bf16 v[120:123], v[96:99], v[80:83], v[120:123]
    ds_read_b128 v[84:87], v232 offset:25344
    ds_read_b128 v[88:91], v232 offset:25408
    ds_read_b128 v[92:95], v232 offset:25472
    ds_read_b128 v[96:99], v232 offset:25536
    s_waitcnt lgkmcnt(7)
    v_mfma_f32_16x16x32_bf16 v[124:127], v[100:103], v[52:55], 0
    v_mfma_f32_16x16x32_bf16 v[128:131], v[100:103], v[56:59], 0
    s_waitcnt lgkmcnt(6)
    v_mfma_f32_16x16x32_bf16 v[124:127], v[104:107], v[60:63], v[124:127]
    v_cvt_pk_bf16_f32 v44, v116, v117
    v_cvt_pk_bf16_f32 v45, v118, v119
    v_mfma_f32_16x16x32_bf16 v[128:131], v[104:107], v[64:67], v[128:131]
    v_cvt_pk_bf16_f32 v46, v120, v121
    v_cvt_pk_bf16_f32 v47, v122, v123
    s_waitcnt lgkmcnt(5)
    v_mfma_f32_16x16x32_bf16 v[124:127], v[108:111], v[68:71], v[124:127]
    s_mov_b32 s3, 0
    buffer_store_dwordx4 v[44:47], v233, s[16:19], s3 offen sc0 sc1
    v_mfma_f32_16x16x32_bf16 v[128:131], v[108:111], v[72:75], v[128:131]
    s_waitcnt lgkmcnt(4)
    v_mfma_f32_16x16x32_bf16 v[124:127], v[112:115], v[76:79], v[124:127]
    v_mfma_f32_16x16x32_bf16 v[128:131], v[112:115], v[80:83], v[128:131]
    ds_read_b128 v[100:103], v232 offset:29952
    ds_read_b128 v[104:107], v232 offset:30016
    ds_read_b128 v[108:111], v232 offset:30080
    ds_read_b128 v[112:115], v232 offset:30144
    s_waitcnt lgkmcnt(7)
    v_mfma_f32_16x16x32_bf16 v[116:119], v[84:87], v[52:55], 0
    v_mfma_f32_16x16x32_bf16 v[120:123], v[84:87], v[56:59], 0
    s_waitcnt lgkmcnt(6)
    v_mfma_f32_16x16x32_bf16 v[116:119], v[88:91], v[60:63], v[116:119]
    v_cvt_pk_bf16_f32 v48, v124, v125
    v_cvt_pk_bf16_f32 v49, v126, v127
    v_mfma_f32_16x16x32_bf16 v[120:123], v[88:91], v[64:67], v[120:123]
    v_cvt_pk_bf16_f32 v50, v128, v129
    v_cvt_pk_bf16_f32 v51, v130, v131
    s_waitcnt lgkmcnt(5)
    v_mfma_f32_16x16x32_bf16 v[116:119], v[92:95], v[68:71], v[116:119]
    s_mov_b32 s3, 1048576
    buffer_store_dwordx4 v[48:51], v233, s[16:19], s3 offen sc0 sc1
    v_mfma_f32_16x16x32_bf16 v[120:123], v[92:95], v[72:75], v[120:123]
    s_waitcnt lgkmcnt(4)
    v_mfma_f32_16x16x32_bf16 v[116:119], v[96:99], v[76:79], v[116:119]
    v_mfma_f32_16x16x32_bf16 v[120:123], v[96:99], v[80:83], v[120:123]
    ds_read_b128 v[84:87], v232 offset:34560
    ds_read_b128 v[88:91], v232 offset:34624
    ds_read_b128 v[92:95], v232 offset:34688
    ds_read_b128 v[96:99], v232 offset:34752
    s_waitcnt lgkmcnt(7)
    v_mfma_f32_16x16x32_bf16 v[124:127], v[100:103], v[52:55], 0
    v_mfma_f32_16x16x32_bf16 v[128:131], v[100:103], v[56:59], 0
    s_waitcnt lgkmcnt(6)
    v_mfma_f32_16x16x32_bf16 v[124:127], v[104:107], v[60:63], v[124:127]
    v_cvt_pk_bf16_f32 v44, v116, v117
    v_cvt_pk_bf16_f32 v45, v118, v119
    v_mfma_f32_16x16x32_bf16 v[128:131], v[104:107], v[64:67], v[128:131]
    v_cvt_pk_bf16_f32 v46, v120, v121
    v_cvt_pk_bf16_f32 v47, v122, v123
    s_waitcnt lgkmcnt(5)
    v_mfma_f32_16x16x32_bf16 v[124:127], v[108:111], v[68:71], v[124:127]
    s_mov_b32 s3, 2097152
    buffer_store_dwordx4 v[44:47], v233, s[16:19], s3 offen sc0 sc1
    v_mfma_f32_16x16x32_bf16 v[128:131], v[108:111], v[72:75], v[128:131]
    s_waitcnt lgkmcnt(4)
    v_mfma_f32_16x16x32_bf16 v[124:127], v[112:115], v[76:79], v[124:127]
    v_mfma_f32_16x16x32_bf16 v[128:131], v[112:115], v[80:83], v[128:131]
    s_nop 3
    s_waitcnt lgkmcnt(3)
    v_mfma_f32_16x16x32_bf16 v[116:119], v[84:87], v[52:55], 0
    v_mfma_f32_16x16x32_bf16 v[120:123], v[84:87], v[56:59], 0
    s_waitcnt lgkmcnt(2)
    v_mfma_f32_16x16x32_bf16 v[116:119], v[88:91], v[60:63], v[116:119]
    v_cvt_pk_bf16_f32 v48, v124, v125
    v_cvt_pk_bf16_f32 v49, v126, v127
    v_mfma_f32_16x16x32_bf16 v[120:123], v[88:91], v[64:67], v[120:123]
    v_cvt_pk_bf16_f32 v50, v128, v129
    v_cvt_pk_bf16_f32 v51, v130, v131
    s_waitcnt lgkmcnt(1)
    v_mfma_f32_16x16x32_bf16 v[116:119], v[92:95], v[68:71], v[116:119]
    s_mov_b32 s3, 3145728
    buffer_store_dwordx4 v[48:51], v233, s[16:19], s3 offen sc0 sc1
    v_mfma_f32_16x16x32_bf16 v[120:123], v[92:95], v[72:75], v[120:123]
    s_waitcnt lgkmcnt(0)
    v_mfma_f32_16x16x32_bf16 v[116:119], v[96:99], v[76:79], v[116:119]
    v_mfma_f32_16x16x32_bf16 v[120:123], v[96:99], v[80:83], v[120:123]
    s_or_b32 s31, s2, s24
    s_cbranch_scc1 L_noep
    v_lshlrev_b32 v36, 2, v11
    v_mov_b32 v37, s26
    global_store_dword v36, v37, s[22:23] offset:0 sc0 sc1
L_noep:
    s_nop 5
    v_cvt_pk_bf16_f32 v44, v116, v117
    v_cvt_pk_bf16_f32 v45, v118, v119
    v_cvt_pk_bf16_f32 v46, v120, v121
    v_cvt_pk_bf16_f32 v47, v122, v123
    s_mov_b32 s3, 4194304
    buffer_store_dwordx4 v[44:47], v233, s[16:19], s3 offen sc0 sc1
L_end:
    s_endpgm
.section .rodata,"a"
.p2align 6
.amdhsa_kernel standalone__tensor_product_equiv_tfn__graph_kernel
  .amdhsa_next_free_vgpr 235
  .amdhsa_next_free_sgpr 102
  .amdhsa_accum_offset 236
  .amdhsa_group_segment_fixed_size 0
  .amdhsa_kernarg_size 88
  .amdhsa_user_sgpr_count 2
  .amdhsa_user_sgpr_kernarg_segment_ptr 1
  .amdhsa_system_sgpr_workgroup_id_x 1
  .amdhsa_float_denorm_mode_32 3
.end_amdhsa_kernel
```

```asm
; @launch grid=(256,1,1) block=(512,1,1) lds=163600
.amdgcn_target "amdgcn-amd-amdhsa--gfx950"
.text
.globl standalone__tensor_product_equiv_tfn__graph_kernel
.p2align 8
.type standalone__tensor_product_equiv_tfn__graph_kernel,@function
standalone__tensor_product_equiv_tfn__graph_kernel:
    s_load_dwordx16 s[4:19], s[0:1], 0
    s_load_dwordx2 s[22:23], s[0:1], 80
    s_load_dwordx2 s[20:21], s[0:1], 64
    s_cmp_ge_u32 s2, 256
    s_cbranch_scc1 L_end
    v_mul_u32_u24 v172, 3, v0
    s_mul_i32 s3, s2, 1250
    v_min_u32 v172, 1247, v172
    v_add_lshl_u32 v173, v172, s3, 2
    v_lshrrev_b32 v12, 6, v0
    v_and_b32 v13, 255, v0
    v_lshlrev_b32 v13, 2, v13
    v_mov_b32 v16, 0
    v_readfirstlane_b32 s24, v12
    ds_write_b32 v13, v16 offset:0
    v_lshlrev_b32 v174, 1, v173
    s_waitcnt lgkmcnt(0)
    global_load_dwordx3 v[132:134], v173, s[8:9]
    s_load_dword s26, s[22:23], 0
    s_barrier
    global_load_dwordx3 v[136:138], v173, s[6:7]
    global_load_dwordx4 v[140:143], v174, s[10:11]
    global_load_dwordx2 v[144:145], v174, s[10:11] offset:16
    v_lshlrev_b32 v188, 4, v0
    v_and_b32 v11, 63, v0
    s_lshl_b32 s30, s24, 10
    s_lshl_b32 s3, s3, 5
    s_add_u32 s12, s12, s3
    s_addc_u32 s13, s13, 0
    v_add_u32 v189, 8192, v188
    v_add_u32 v190, 16384, v188
    v_add_u32 v191, 24576, v188
    v_add_u32 v192, 32768, v188
    v_add_u32 v193, 40960, v188
    v_min_u32 v175, 39984, v192
    v_lshlrev_b32 v1, 4, v11
    s_barrier
    s_add_u32 m0, s30, 112384
    s_nop 0
    global_load_lds_dwordx4 v188, s[12:13]
    s_add_u32 m0, s30, 120576
    s_nop 0
    global_load_lds_dwordx4 v189, s[12:13]
    s_cmp_eq_u32 s24, 7
    s_cbranch_scc0 L_nocpf
    s_cmp_lt_u32 s2, 8
    s_cbranch_scc0 L_nocpf
    s_getpc_b64 s[68:69]
L_pc:
    v_lshlrev_b32 v18, 7, v11
    v_mov_b32 v19, 0
    v_lshl_add_u64 v[20:21], v[18:19], 0, s[68:69]
    global_load_dword v204, v[20:21], off
    v_min_u32 v18, L_end-L_pc-8192, v18
    v_add_u32 v18, 8192, v18
    v_lshl_add_u64 v[20:21], v[18:19], 0, s[68:69]
    global_load_dword v205, v[20:21], off
L_nocpf:
    v_lshlrev_b32 v194, 2, v0
    v_lshlrev_b32 v14, 3, v0
    v_mov_b32 v16, 0
    v_mov_b32 v17, 0
    v_mov_b32 v15, 0x00300000
    ds_write_b64 v14, v[16:17] offset:16128
    ds_write_b32 v194, v15 offset:20224
    ds_write_b32 v194, v15 offset:22272
    ds_write_b32 v194, v15 offset:24320
    v_lshrrev_b32 v195, 1, v0
    v_lshlrev_b32 v195, 2, v195
    v_cmp_gt_u32 vcc, 416, v0
    s_mov_b64 s[36:37], vcc
    v_cmp_gt_u32 vcc, 417, v0
    s_mov_b64 s[38:39], vcc
    v_mov_b32 v12, 1
    s_movk_i32 s40, 1250
    s_mov_b32 s41, 63232
    s_lshr_b32 s27, s24, 2
    s_mov_b32 s28, 0
    s_waitcnt vmcnt(5)
    s_mov_b64 exec, s[38:39]
    v_and_b32 v153, 7, v133
    v_bfe_u32 v150, v133, 3, 5
    v_lshl_add_u32 v147, v153, 5, v150
    v_lshlrev_b32 v147, 2, v147
    ds_add_rtn_u32 v150, v147, v12 offset:0
    v_and_b32 v154, 7, v134
    v_bfe_u32 v151, v134, 3, 5
    v_lshl_add_u32 v148, v154, 5, v151
    v_lshlrev_b32 v148, 2, v148
    ds_add_rtn_u32 v151, v148, v12 offset:0
    s_mov_b64 exec, s[36:37]
    v_and_b32 v152, 7, v132
    v_bfe_u32 v149, v132, 3, 5
    v_lshl_add_u32 v146, v152, 5, v149
    v_lshlrev_b32 v146, 2, v146
    ds_add_rtn_u32 v149, v146, v12 offset:0
    s_mov_b64 exec, -1
    s_add_u32 m0, s30, 128768
    s_nop 0
    global_load_lds_dwordx4 v190, s[12:13]
    s_add_u32 m0, s30, 136960
    s_nop 0
    global_load_lds_dwordx4 v191, s[12:13]
    s_add_u32 m0, s30, 145152
    s_nop 0
    global_load_lds_dwordx4 v175, s[12:13]
    s_waitcnt lgkmcnt(0)
    s_barrier
    ds_read_b128 v[164:167], v1 offset:0
    s_mul_i32 s3, s2, 1280
    s_add_u32 s26, s26, 1
    s_waitcnt lgkmcnt(0)
    v_add_u32 v180, v164, v165
    v_add3_u32 v180, v180, v166, v167
    v_mov_b32 v181, v180
    v_lshrrev_b32 v132, 8, v132
    v_lshlrev_b32 v132, 2, v132
    v_add_u32_dpp v181, v181, v181 row_shr:1 row_mask:0xf bank_mask:0xf
    v_add_lshl_u32 v177, v172, 0, 5
    v_lshrrev_b32 v133, 8, v133
    v_add_u32_dpp v181, v181, v181 row_shr:2 row_mask:0xf bank_mask:0xf
    v_lshlrev_b32 v133, 2, v133
    v_add_lshl_u32 v178, v172, 1, 5
    v_add_u32_dpp v181, v181, v181 row_shr:4 row_mask:0xf bank_mask:0xf
    v_lshrrev_b32 v134, 8, v134
    v_lshlrev_b32 v134, 2, v134
    v_add_u32_dpp v181, v181, v181 row_shr:8 row_mask:0xf bank_mask:0xf
    v_add_lshl_u32 v179, v172, 2, 5
    s_lshl_b32 s31, s2, 11
    v_add_u32_dpp v181, v181, v181 row_bcast:15 row_mask:0xa bank_mask:0xf
    s_add_u32 s31, s31, 4096
    v_add_u32 v212, s31, v1
    v_add_u32_dpp v181, v181, v181 row_bcast:31 row_mask:0xc bank_mask:0xf
    v_sub_u32 v168, v181, v180
    v_add_u32 v169, v168, v164
    v_add_u32 v170, v169, v165
    v_add_u32 v171, v170, v166
    ds_write_b128 v1, v[168:171] offset:1024
    s_mov_b64 exec, s[38:39]
    ds_read_b32 v147, v147 offset:1024
    ds_read_b32 v148, v148 offset:1024
    s_mov_b64 exec, s[36:37]
    ds_read_b32 v146, v146 offset:1024
    s_mov_b64 exec, -1
    s_waitcnt vmcnt(5)
    v_mad_u32_u24 v152, v152, s40, v136
    v_lshl_add_u32 v132, v136, 16, v132
    v_subrev_u32 v156, 10000, v152
    v_min_u32 v152, v152, v156
    v_add_u32 v152, 350, v152
    v_mul_u32_u24 v152, 151, v152
    v_lshrrev_b32 v152, 17, v152
    v_lshl_add_u32 v152, v152, 8, v132
    v_mad_u32_u24 v153, v153, s40, v137
    v_lshl_add_u32 v133, v137, 16, v133
    v_subrev_u32 v157, 10000, v153
    v_min_u32 v153, v153, v157
    v_add_u32 v153, 350, v153
    v_mul_u32_u24 v153, 151, v153
    v_lshrrev_b32 v153, 17, v153
    v_lshl_add_u32 v153, v153, 8, v133
    v_mad_u32_u24 v154, v154, s40, v138
    v_lshl_add_u32 v134, v138, 16, v134
    v_subrev_u32 v158, 10000, v154
    v_min_u32 v154, v154, v158
    v_add_u32 v154, 350, v154
    v_mul_u32_u24 v154, 151, v154
    v_lshrrev_b32 v154, 17, v154
    v_lshl_add_u32 v154, v154, 8, v134
    s_mov_b64 exec, s[38:39]
    s_waitcnt lgkmcnt(0)
    v_add_lshl_u32 v147, v147, v150, 1
    v_mad_u32_u24 v183, v147, 6, s41
    ds_write_b16 v147, v178 offset:2048
    ds_write2_b32 v183, v142, v143 offset1:1
    ds_write_b32 v183, v153 offset:8
    v_add_lshl_u32 v148, v148, v151, 1
    v_mad_u32_u24 v184, v148, 6, s41
    ds_write_b16 v148, v179 offset:2048
    ds_write2_b32 v184, v144, v145 offset1:1
    ds_write_b32 v184, v154 offset:8
    s_mov_b64 exec, s[36:37]
    v_add_lshl_u32 v146, v146, v149, 1
    v_mad_u32_u24 v182, v146, 6, s41
    ds_write_b16 v146, v177 offset:2048
    ds_write2_b32 v182, v140, v141 offset1:1
    ds_write_b32 v182, v152 offset:8
    s_mov_b64 exec, -1
    s_add_u32 m0, s30, 26368
    s_nop 0
    global_load_lds_dwordx4 v188, s[18:19]
    s_add_u32 m0, s30, 34560
    s_nop 0
    global_load_lds_dwordx4 v189, s[18:19]
    s_add_u32 m0, s30, 42752
    s_nop 0
    global_load_lds_dwordx4 v190, s[18:19]
    s_add_u32 m0, s30, 50944
    s_nop 0
    global_load_lds_dwordx4 v191, s[18:19]
    s_add_u32 s70, s30, 59136
    v_min_u32 v185, 112, v1
    s_cmp_lt_u32 s24, 4
    s_cselect_b64 vcc, -1, 0
    s_cselect_b32 m0, s70, 162560
    s_cselect_b64 s[68:69], s[14:15], s[16:17]
    v_cndmask_b32 v185, v185, v188, vcc
    global_load_lds_dwordx4 v185, s[68:69]
    s_mul_i32 s31, s3, 12
    s_add_u32 s31, s31, 1048576
    s_add_u32 s48, s22, s31
    s_addc_u32 s49, s23, 0
    s_mov_b32 s50, 15104
    s_mov_b32 s51, 0x00020000
    s_lshl_b32 s3, s3, 5
    s_add_u32 s31, s3, 8388608
    s_add_u32 s52, s22, s31
    s_addc_u32 s53, s23, 0
    s_mov_b32 s54, 40064
    s_mov_b32 s55, 0x00020000
    v_and_b32 v172, -2, v0
    v_and_b32 v173, 16, v188
    v_add_u32 v173, 112384, v173
    s_waitcnt lgkmcnt(0)
    s_barrier
    ds_read_b128 v[132:135], v188 offset:63232
    ds_read_b128 v[136:139], v189 offset:63232
    ds_read_u16 v174, v172 offset:2048
    ds_read_u16 v175, v172 offset:2560
    ds_read_u16 v176, v172 offset:3072
    ds_read_u16 v177, v172 offset:3584
    ds_read_u16 v178, v172 offset:4096
    s_cmp_eq_u32 s24, 7
    s_cbranch_scc0 L_norow
    s_mul_i32 s31, s2, 1280
    v_add_u32 v168, s31, v168
    v_lshl_add_u32 v196, v164, 19, v168
    v_mov_b32 v197, s26
    v_add_u32 v169, s31, v169
    v_lshl_add_u32 v198, v165, 19, v169
    v_mov_b32 v199, s26
    v_add_u32 v170, s31, v170
    v_lshl_add_u32 v200, v166, 19, v170
    v_mov_b32 v201, s26
    v_add_u32 v171, s31, v171
    v_lshl_add_u32 v202, v167, 19, v171
    v_mov_b32 v203, s26
    global_store_dwordx4 v212, v[196:199], s[22:23] sc0 sc1
    global_store_dwordx4 v212, v[200:203], s[22:23] offset:1024 sc0 sc1
L_norow:
    s_waitcnt lgkmcnt(6)
    buffer_store_dwordx4 v[132:135], v188, s[48:51], 0 offen sc0 sc1
    s_waitcnt lgkmcnt(5)
    buffer_store_dwordx4 v[136:139], v189, s[48:51], 0 offen sc0 sc1
    s_waitcnt lgkmcnt(0)
    v_add_u32 v174, v174, v173
    v_add_u32 v175, v175, v173
    v_add_u32 v176, v176, v173
    v_add_u32 v177, v177, v173
    v_min_u32 v178, 39968, v178
    v_and_b32 v178, -16, v178
    v_add_u32 v178, v178, v173
    v_mov_b64 v[84:85], 0
    v_mov_b64 v[86:87], 0
    v_mov_b64 v[88:89], 0
    v_mov_b64 v[90:91], 0
    v_mov_b64 v[92:93], 0
    v_mov_b64 v[94:95], 0
    v_mov_b64 v[96:97], 0
    v_mov_b64 v[98:99], 0
    v_mov_b64 v[100:101], 0
    v_mov_b64 v[102:103], 0
    v_mov_b64 v[104:105], 0
    v_mov_b64 v[106:107], 0
    v_mov_b64 v[108:109], 0
    v_mov_b64 v[110:111], 0
    v_mov_b64 v[112:113], 0
    v_mov_b64 v[114:115], 0
    v_mov_b64 v[116:117], 0
    v_mov_b64 v[118:119], 0
    v_mov_b64 v[120:121], 0
    v_mov_b64 v[122:123], 0
    v_mov_b64 v[124:125], 0
    v_mov_b64 v[126:127], 0
    v_mov_b64 v[128:129], 0
    v_mov_b64 v[130:131], 0
    v_bfe_u32 v28, v11, 2, 1
    v_mul_u32_u24 v28, 0xaaaa, v28
    v_add_u32 v28, 0x4444, v28
    v_mov_b32 v29, 163584
    ds_write_b128 v29, v[84:87]
    v_lshrrev_b32 v2, 5, v11
    v_lshlrev_b32 v2, 4, v2
    v_and_b32 v3, 3, v11
    v_lshlrev_b32 v3, 3, v3
    v_add_u32 v3, 112384, v3
    s_sub_u32 s4, s4, 512
    s_subb_u32 s5, s5, 0
    s_mov_b32 s6, 10240512
    s_mov_b32 s7, 0x00020000
    s_add_u32 s8, s22, 1048576
    s_addc_u32 s9, s23, 0
    s_mov_b32 s10, 3932160
    s_mov_b32 s11, 0x00020000
    s_mov_b32 s101, 0
    s_cmp_lt_u32 s2, 16
    s_cbranch_scc1 L_r40
    s_cmp_eq_u32 s24, 0
    s_cselect_b32 s101, 0x245d2388, s101
    s_cmp_eq_u32 s24, 1
    s_cselect_b32 s101, 0x25753343, s101
    s_cmp_eq_u32 s24, 2
    s_cselect_b32 s101, 0x27449100, s101
    s_cmp_eq_u32 s24, 3
    s_cselect_b32 s101, 0x267d5301, s101
    s_cmp_eq_u32 s24, 4
    s_cselect_b32 s101, 0x2179a402, s101
    s_cmp_eq_u32 s24, 5
    s_cselect_b32 s101, 0x227162c6, s101
    s_cmp_eq_u32 s24, 6
    s_cselect_b32 s101, 0x206543c7, s101
    s_cmp_eq_u32 s24, 7
    s_cselect_b32 s101, 0x236d8285, s101
    s_branch L_rd
L_r40:
    s_cmp_eq_u32 s24, 0
    s_cselect_b32 s101, 0x2271a3c1, s101
    s_cmp_eq_u32 s24, 1
    s_cselect_b32 s101, 0x20750307, s101
    s_cmp_eq_u32 s24, 2
    s_cselect_b32 s101, 0x236d5205, s101
    s_cmp_eq_u32 s24, 3
    s_cselect_b32 s101, 0x27797340, s101
    s_cmp_eq_u32 s24, 4
    s_cselect_b32 s101, 0x256112c4, s101
    s_cmp_eq_u32 s24, 5
    s_cselect_b32 s101, 0x26653243, s101
    s_cmp_eq_u32 s24, 6
    s_cselect_b32 s101, 0x217d4382, s101
    s_cmp_eq_u32 s24, 7
    s_cselect_b32 s101, 0x24592286, s101
L_rd:
    s_and_b32 s68, s2, 7
    s_lshl_b32 s68, s68, 7
    s_bfe_u32 s31, s2, 196613
    s_lshl_b32 s31, s31, 4
    s_add_u32 s68, s68, s31
    s_and_b32 s31, s2, 8
    s_add_u32 s68, s68, s31
    s_and_b32 s31, s2, 16
    s_lshl_b32 s31, s31, 6
    s_add_u32 s68, s68, s31
    s_add_u32 s68, s68, 4096
    v_and_b32 v214, 255, v0
    v_lshl_add_u32 v213, v214, 11, s68
    v_mul_u32_u24 v214, 32, v214
    v_add_u32 v214, 589824, v214
    s_mul_i32 s3, s2, 32
    s_add_u32 s3, s3, 589824
    v_lshl_add_u32 v212, v11, 2, s3
    v_mov_b32 v197, s26
    s_waitcnt vmcnt(7)
    s_barrier
    ds_read_b128 v[144:147], v174
    ds_read_b128 v[148:151], v175
    ds_read_b128 v[152:155], v176
    ds_read_b128 v[156:159], v177
    ds_read_b128 v[160:163], v178
    s_waitcnt lgkmcnt(4)
    buffer_store_dwordx4 v[144:147], v188, s[52:55], 0 offen sc0 sc1
    s_waitcnt lgkmcnt(3)
    buffer_store_dwordx4 v[148:151], v189, s[52:55], 0 offen sc0 sc1
    s_waitcnt lgkmcnt(2)
    buffer_store_dwordx4 v[152:155], v190, s[52:55], 0 offen sc0 sc1
    s_waitcnt lgkmcnt(1)
    buffer_store_dwordx4 v[156:159], v191, s[52:55], 0 offen sc0 sc1
    s_waitcnt lgkmcnt(0)
    buffer_store_dwordx4 v[160:163], v192, s[52:55], 0 offen sc0 sc1
    s_add_u32 s12, s22, 8388608
    s_addc_u32 s13, s23, 0
    s_mov_b32 s14, 10485760
    s_mov_b32 s15, 0x00020000
    s_mov_b32 s16, s20
    s_mov_b32 s17, s21
    s_mov_b32 s18, 10240000
    s_mov_b32 s19, 0x00020000
    s_waitcnt vmcnt(0) lgkmcnt(0)
    s_barrier
    s_cmp_eq_u32 s24, 0
    s_cbranch_scc0 L_noflag
    s_mov_b64 exec, 0xff
    global_store_dword v212, v197, s[22:23] sc0 sc1
    s_mov_b64 exec, -1
L_noflag:
    s_barrier
    s_cmp_eq_u32 s27, 0
    s_cbranch_scc0 L_np0
    global_load_dwordx2 v[206:207], v213, s[22:23] sc1
L_np0:
    s_cmp_eq_u32 s27, 0
    s_cbranch_scc1 L_pfa
    s_sub_u32 s3, 0, s2
    s_and_b32 s3, s3, 7
    s_mul_i32 s3, s3, 1280000
    s_lshr_b32 s31, s2, 3
    s_mul_i32 s31, s31, 16640
    s_add_u32 s3, s3, s31
    s_add_u32 s3, s3, 512
    v_and_b32 v208, 255, v0
    v_cmp_gt_u32 vcc, 130, v208
    v_lshlrev_b32 v208, 7, v208
    v_mov_b32 v209, 0x7fffff00
    v_cndmask_b32 v208, v209, v208, vcc
    buffer_load_dword v210, v208, s[4:7], s3 offen
L_pfa:
    v_lshrrev_b32 v12, 5, v11
    v_and_b32 v13, 31, v11
    v_lshlrev_b32 v13, 2, v13
    v_lshl_add_u32 v12, v12, 10, v13
    s_and_b32 s3, s24, 2
    s_lshl_b32 s31, s3, 8
    s_lshl_b32 s68, s27, 11
    s_add_u32 s31, s31, s68
    s_and_b32 s3, s24, 1
    s_lshl_b32 s3, s3, 7
    s_add_u32 s31, s31, s3
    s_and_b32 s3, s24, 3
    v_add_u32 v12, s31, v12
    ds_read_b32 v164, v12 offset:59136
    ds_read_b32 v165, v12 offset:59392
    s_lshl_b32 s3, s3, 2
    s_lshl_b32 s31, s27, 10
    s_add_u32 s3, s3, s31
    v_add_u32 v16, s3, v1
    v_and_b32 v14, 3, v11
    v_bfe_u32 v15, v11, 2, 2
    v_lshlrev_b32 v15, 1, v15
    v_lshl_add_u32 v14, v14, 5, v15
    v_add_u32 v14, 162560, v14
    s_mov_b32 s68, 0xbfb8aa3b
    s_mov_b32 s69, s68
    ds_read_u16 v18, v14 offset:0
    ds_read_u16 v19, v14 offset:8
    ds_read_u16 v20, v14 offset:16
    ds_read_u16 v21, v14 offset:24
    s_waitcnt lgkmcnt(4)
    v_lshlrev_b32 v22, 16, v164
    v_lshlrev_b32 v23, 16, v165
    v_and_b32 v164, 0xffff0000, v164
    v_and_b32 v165, 0xffff0000, v165
    v_pk_mul_f32 v[22:23], v[22:23], s[68:69]
    v_pk_mul_f32 v[164:165], v[164:165], s[68:69]
    v_cvt_pk_bf16_f32 v166, v22, v23
    v_cvt_pk_bf16_f32 v167, v164, v165
    ds_write_b32 v16, v166 offset:8192
    ds_write_b32 v16, v167 offset:10240
    s_waitcnt lgkmcnt(0)
    v_lshl_or_b32 v228, v19, 16, v18
    v_lshl_or_b32 v229, v21, 16, v20
    s_mov_b32 s70, 0x05040100
    s_mov_b32 s71, 0x07060302
    s_and_b32 s3, s24, 3
    s_lshl_b32 s3, s3, 6
    v_lshrrev_b32 v16, 4, v11
    v_and_b32 v17, 15, v11
    v_lshl_add_u32 v17, v17, 2, s3
    v_lshl_add_u32 v16, v16, 11, v17
    ds_read_b32 v168, v16 offset:26368
    ds_read_b32 v169, v16 offset:26624
    ds_read_b32 v170, v16 offset:26880
    ds_read_b32 v171, v16 offset:27136
    ds_read_b32 v172, v16 offset:27392
    ds_read_b32 v173, v16 offset:27648
    ds_read_b32 v174, v16 offset:27904
    ds_read_b32 v175, v16 offset:28160
    s_waitcnt lgkmcnt(7)
    ds_read_b32 v176, v16 offset:34560
    ds_read_b32 v177, v16 offset:34816
    ds_read_b32 v178, v16 offset:35072
    ds_read_b32 v179, v16 offset:35328
    ds_read_b32 v180, v16 offset:35584
    ds_read_b32 v181, v16 offset:35840
    ds_read_b32 v182, v16 offset:36096
    ds_read_b32 v183, v16 offset:36352
    s_waitcnt lgkmcnt(8)
    v_perm_b32 v52, v169, v168, s70
    v_perm_b32 v56, v169, v168, s71
    v_perm_b32 v53, v171, v170, s70
    v_perm_b32 v57, v171, v170, s71
    v_perm_b32 v54, v173, v172, s70
    v_perm_b32 v58, v173, v172, s71
    v_perm_b32 v55, v175, v174, s70
    v_perm_b32 v59, v175, v174, s71
    s_waitcnt lgkmcnt(7)
    ds_read_b32 v168, v16 offset:42752
    ds_read_b32 v169, v16 offset:43008
    ds_read_b32 v170, v16 offset:43264
    ds_read_b32 v171, v16 offset:43520
    ds_read_b32 v172, v16 offset:43776
    ds_read_b32 v173, v16 offset:44032
    ds_read_b32 v174, v16 offset:44288
    ds_read_b32 v175, v16 offset:44544
    s_waitcnt lgkmcnt(8)
    v_perm_b32 v60, v177, v176, s70
    v_perm_b32 v64, v177, v176, s71
    v_perm_b32 v61, v179, v178, s70
    v_perm_b32 v65, v179, v178, s71
    v_perm_b32 v62, v181, v180, s70
    v_perm_b32 v66, v181, v180, s71
    v_perm_b32 v63, v183, v182, s70
    v_perm_b32 v67, v183, v182, s71
    s_waitcnt lgkmcnt(7)
    ds_read_b32 v176, v16 offset:50944
    ds_read_b32 v177, v16 offset:51200
    ds_read_b32 v178, v16 offset:51456
    ds_read_b32 v179, v16 offset:51712
    ds_read_b32 v180, v16 offset:51968
    ds_read_b32 v181, v16 offset:52224
    ds_read_b32 v182, v16 offset:52480
    ds_read_b32 v183, v16 offset:52736
    s_waitcnt lgkmcnt(8)
    v_perm_b32 v68, v169, v168, s70
    v_perm_b32 v72, v169, v168, s71
    v_perm_b32 v69, v171, v170, s70
    v_perm_b32 v73, v171, v170, s71
    v_perm_b32 v70, v173, v172, s70
    v_perm_b32 v74, v173, v172, s71
    v_perm_b32 v71, v175, v174, s70
    v_perm_b32 v75, v175, v174, s71
    s_waitcnt lgkmcnt(0)
    v_perm_b32 v76, v177, v176, s70
    v_perm_b32 v80, v177, v176, s71
    v_perm_b32 v77, v179, v178, s70
    v_perm_b32 v81, v179, v178, s71
    v_perm_b32 v78, v181, v180, s70
    v_perm_b32 v82, v181, v180, s71
    v_perm_b32 v79, v183, v182, s70
    v_perm_b32 v83, v183, v182, s71
    s_cmp_eq_u32 s27, 0
    s_cbranch_scc0 L_polled
    s_mov_b32 s3, 0
    s_waitcnt vmcnt(0)
    s_branch L_poll1
L_poll:
    global_load_dwordx2 v[206:207], v213, s[22:23] sc1
    s_add_u32 s3, s3, 1
    s_waitcnt vmcnt(0)
L_poll1:
    v_cmpx_ne_u32 vcc, s26, v207
    s_cbranch_execz L_pok
    s_cmp_lt_u32 s3, 4000000
    s_cbranch_scc1 L_poll
    v_mov_b32 v206, 0
L_pok:
    s_mov_b64 exec, -1
    v_add_u32 v14, 161536, v194
    ds_write_b32 v14, v206
L_polled:
L_round:
    s_waitcnt lgkmcnt(0)
    s_barrier
    v_add_u32 v15, 161536, v1
    ds_read_b128 v[140:143], v15
    s_cmp_lg_u32 s28, 0
    s_cbranch_scc1 L_npe
    s_cmp_eq_u32 s27, 0
    s_cbranch_scc1 L_npe
    global_load_dword v206, v214, s[22:23] sc1
L_npe:
    s_and_b32 s31, s24, 3
    v_mov_b32 v148, 0
    v_mul_u32_u24 v135, 12, v0
    v_add_u32 v136, 6144, v135
    v_add_u32 v137, 12288, v135
    s_waitcnt lgkmcnt(0)
    v_lshrrev_b32 v144, 19, v140
    v_lshrrev_b32 v145, 19, v141
    v_lshrrev_b32 v146, 19, v142
    v_lshrrev_b32 v147, 19, v143
    v_add_u32 v150, v144, v145
    v_add3_u32 v12, v150, v146, v147
    v_add_u32 v13, s28, v12
    v_mov_b32 v149, v144
    v_add_u32_dpp v12, v12, v12 row_shr:1 row_mask:0xf bank_mask:0xf
    v_add_u32 v151, v150, v146
    s_set_gpr_idx_on s31, gpr_idx(SRC0)
    v_mov_b32 v14, v140
    v_mov_b32 v15, v144
    v_mov_b32 v16, v148
    s_set_gpr_idx_off
    v_add_u32_dpp v12, v12, v12 row_shr:2 row_mask:0xf bank_mask:0xf
    v_and_b32 v14, 0x7ffff, v14
    v_sub_u32 v16, v16, v13
    v_add_u32_dpp v12, v12, v12 row_shr:4 row_mask:0xf bank_mask:0xf
    v_subrev_u32 v17, s27, v15
    s_mov_b32 s31, s27
    v_add_u32_dpp v12, v12, v12 row_shr:8 row_mask:0xf bank_mask:0xf
    s_nop 1
    v_add_u32_dpp v12, v12, v12 row_bcast:15 row_mask:0xa bank_mask:0xf
    s_nop 1
    v_add_u32_dpp v12, v12, v12 row_bcast:31 row_mask:0xc bank_mask:0xf
    v_add_u32 v16, v16, v12
    v_readlane_b32 s25, v12, 63
    v_sub_u32 v14, v14, v16
    v_add_lshl_u32 v18, v16, s27, 2
    s_cmp_gt_u32 s25, 1536
    s_cbranch_scc1 L_exp
    v_cmpx_lt_i32 vcc, 0, v17
    ds_write_b32 v18, v14 offset:20224
    v_cmpx_lt_i32 vcc, 2, v17
    ds_write_b32 v18, v14 offset:20232
    v_cmpx_lt_i32 vcc, 4, v17
    ds_write_b32 v18, v14 offset:20240
    v_cmpx_lt_i32 vcc, 6, v17
    ds_write_b32 v18, v14 offset:20248
    v_cmpx_lt_i32 vcc, 8, v17
    ds_write_b32 v18, v14 offset:20256
    v_cmpx_lt_i32 vcc, 10, v17
    ds_write_b32 v18, v14 offset:20264
    v_cmpx_lt_i32 vcc, 12, v17
    s_cbranch_execz L_expd
    s_add_u32 s31, s31, 12
L_exp:
    s_mov_b64 exec, -1
    v_cmp_lt_u32 vcc, s31, v15
    s_cbranch_vccz L_expd
    v_add_u32 v19, s31, v16
    s_movk_i32 s3, 1536
    v_cmp_gt_u32 s[68:69], s3, v19
    v_lshlrev_b32 v19, 2, v19
    s_and_b64 exec, vcc, s[68:69]
    ds_write_b32 v19, v14 offset:20224
    s_add_u32 s31, s31, 2
    s_branch L_exp
L_expd:
    s_mov_b64 exec, -1
    s_cmp_eq_u32 s27, 0
    s_cbranch_scc1 L_fok
    s_cmp_lg_u32 s28, 0
    s_cbranch_scc1 L_fok
    s_mov_b32 s3, 0
    s_branch L_fp1
L_fp:
    global_load_dword v206, v214, s[22:23] sc1
    s_add_u32 s3, s3, 1
L_fp1:
    s_waitcnt vmcnt(0)
    v_cmpx_ne_u32 vcc, s26, v206
    s_cbranch_execz L_fok
    s_cmp_lt_u32 s3, 4000000
    s_cbranch_scc1 L_fp
    s_branch L_giveup
L_fok:
    s_mov_b64 exec, -1
    s_waitcnt lgkmcnt(0)
    s_barrier
    ds_read_b32 v132, v194 offset:20224
    ds_read_b32 v133, v194 offset:22272
    ds_read_b32 v134, v194 offset:24320
    ds_read_b32 v152, v195 offset:20224
    ds_read_b32 v153, v195 offset:21248
    ds_read_b32 v154, v195 offset:22272
    ds_read_b32 v155, v195 offset:23296
    ds_read_b32 v156, v195 offset:24320
    ds_read_b32 v157, v195 offset:25344
    s_waitcnt lgkmcnt(8)
    v_mad_i32_i24 v132, v132, 12, v135
    buffer_load_dwordx3 v[140:142], v132, s[8:11], 0 offen sc1
    s_waitcnt lgkmcnt(7)
    v_mad_i32_i24 v133, v133, 12, v136
    buffer_load_dwordx3 v[144:146], v133, s[8:11], 0 offen sc1
    s_waitcnt lgkmcnt(6)
    v_mad_i32_i24 v134, v134, 12, v137
    buffer_load_dwordx3 v[148:150], v134, s[8:11], 0 offen sc1
    s_waitcnt lgkmcnt(0)
    v_lshl_add_u32 v152, v152, 5, v188
    v_lshl_add_u32 v153, v153, 5, v189
    v_lshl_add_u32 v154, v154, 5, v190
    v_lshl_add_u32 v155, v155, 5, v191
    v_lshl_add_u32 v156, v156, 5, v192
    v_lshl_add_u32 v157, v157, 5, v193
    s_barrier
    s_add_u32 m0, s30, 63232
    s_nop 0
    buffer_load_dwordx4 v152, s[12:15], 0 offen sc1 lds
    s_sub_u32 s29, s25, s28
    s_min_u32 s29, s29, 1536
    s_lshl_b32 s3, s29, 4
    v_cmp_gt_u32 s[56:57], s3, v188
    v_lshlrev_b32 v159, 1, v188
    v_mov_b32 v143, 0
    v_cmp_gt_u32 s[58:59], s3, v189
    v_lshlrev_b32 v161, 1, v189
    v_mov_b32 v147, 0
    v_cmp_gt_u32 s[60:61], s3, v190
    v_lshlrev_b32 v163, 1, v190
    v_mov_b32 v151, 0
    v_and_b32 v4, 15, v11
    v_lshrrev_b32 v13, 4, v11
    s_mul_i32 s3, s27, 23040
    v_mul_u32_u24 v30, 288, v4
    v_lshl_add_u32 v30, v13, 4, v30
    v_add_u32 v30, s3, v30
    s_mul_i32 s68, s27, 5120
    s_add_u32 s68, s68, s2
    s_lshl_b32 s68, s68, 10
    s_and_b32 s3, s24, 3
    s_lshl_b32 s3, s3, 8
    s_add_u32 s68, s68, s3
    v_lshl_add_u32 v31, v13, 18, s68
    v_lshl_add_u32 v31, v4, 4, v31
    v_lshlrev_b32 v4, 3, v4
    v_bfe_u32 v5, v11, 3, 2
    v_and_b32 v12, 3, v11
    v_lshl_add_u32 v5, v5, 2, v12
    v_lshlrev_b32 v5, 3, v5
    v_lshrrev_b32 v6, 2, v11
    v_lshlrev_b32 v6, 3, v6
    v_mul_u32_u24 v16, 52, v11
    v_lshrrev_b32 v16, 8, v16
    v_mul_u32_u24 v17, 5, v16
    v_sub_u32 v17, v11, v17
    v_mul_u32_u24 v15, 6, v17
    v_bfe_u32 v15, s101, v15, 6
    v_lshlrev_b32 v15, 2, v15
    v_lshlrev_b32 v16, 8, v16
    v_add_lshl_u32 v17, v17, 64, 19
    s_mul_i32 s3, s24, 5
    v_lshlrev_b32 v18, 2, v11
    v_add_u32 v21, s3, v11
    v_lshlrev_b32 v19, 2, v21
    v_cmp_gt_u32 vcc, 40, v11
    v_add_u32 v20, 1, v11
    v_add_u32 v21, 1, v21
    v_cndmask_b32 v20, 0, v20, vcc
    s_cmp_gt_u32 s25, 1536
    s_cselect_b32 s69, 0, 8
    v_mov_b32 v22, 8
    s_cmp_lg_u32 s28, 0
    s_cbranch_scc1 L_nofr
    ds_read_b128 v[36:39], v1 offset:8192
    ds_read_b128 v[40:43], v1 offset:9216
    ds_read_b128 v[44:47], v1 offset:10240
    ds_read_b128 v[48:51], v1 offset:11264
L_nofr:
    s_waitcnt vmcnt(3)
    s_mov_b64 exec, s[56:57]
    v_and_b32 v12, 0xff, v142
    v_and_b32 v143, 0xffff, v142
    ds_add_u32 v12, v22 offset:19200
    ds_add_rtn_u32 v132, v143, v22 offset:16128
    s_waitcnt vmcnt(2)
    s_mov_b64 exec, s[58:59]
    v_and_b32 v13, 0xff, v146
    v_and_b32 v147, 0xffff, v146
    ds_add_u32 v13, v22 offset:19200
    ds_add_rtn_u32 v133, v147, v22 offset:16128
    s_waitcnt vmcnt(1)
    s_mov_b64 exec, s[60:61]
    v_and_b32 v14, 0xff, v150
    v_and_b32 v151, 0xffff, v150
    ds_add_u32 v14, v22 offset:19200
    ds_add_rtn_u32 v134, v151, v22 offset:16128
    s_mov_b64 exec, -1
    s_add_u32 m0, s30, 71424
    s_nop 0
    buffer_load_dwordx4 v153, s[12:15], 0 offen sc1 lds
    v_mfma_f32_4x4x4_16b_bf16 v[164:167], v[228:229], v[140:141], 0 cbsz:4 abid:0
    v_mfma_f32_4x4x4_16b_bf16 v[168:171], v[228:229], v[140:141], 0 cbsz:4 abid:1
    v_mfma_f32_4x4x4_16b_bf16 v[172:175], v[228:229], v[140:141], 0 cbsz:4 abid:2
    v_mfma_f32_4x4x4_16b_bf16 v[176:179], v[228:229], v[140:141], 0 cbsz:4 abid:3
    v_add_u32 v23, 112384, v159
    v_lshlrev_b32_sdwa v142, 10, v142 dst_sel:DWORD dst_unused:UNUSED_PAD src0_sel:DWORD src1_sel:WORD_1
    v_cvt_pk_bf16_f32 v180, v164, v165
    v_cvt_pk_bf16_f32 v181, v166, v167
    v_cvt_pk_bf16_f32 v182, v168, v169
    v_cvt_pk_bf16_f32 v183, v170, v171
    v_cvt_pk_bf16_f32 v184, v172, v173
    v_cvt_pk_bf16_f32 v185, v174, v175
    v_cvt_pk_bf16_f32 v186, v176, v177
    v_cvt_pk_bf16_f32 v187, v178, v179
    s_waitcnt lgkmcnt(0)
    s_barrier
    ds_read_b32 v12, v18 offset:19200
    ds_read_b32 v13, v19 offset:19200
    ds_write_b128 v23, v[180:183]
    ds_write_b128 v23, v[184:187] offset:16
    v_lshlrev_b32_sdwa v150, 10, v150 dst_sel:DWORD dst_unused:UNUSED_PAD src0_sel:DWORD src1_sel:WORD_1
    s_waitcnt lgkmcnt(2)
    v_mad_u32_u24 v21, v13, s69, v21
    v_mad_u32_u24 v20, v12, s69, v20
    v_readlane_b32 s96, v21, 0
    v_readlane_b32 s97, v21, 1
    v_readlane_b32 s98, v21, 2
    v_readlane_b32 s99, v21, 3
    v_readlane_b32 s100, v21, 4
    v_lshl_add_u32 v19, v13, 16, v19
    v_cmp_lt_u32 s[36:37], s96, v20
    v_cmp_lt_u32 s[38:39], s97, v20
    v_cmp_lt_u32 s[40:41], s98, v20
    v_cmp_lt_u32 s[42:43], s99, v20
    v_cmp_lt_u32 s[44:45], s100, v20
    s_bcnt1_i32_b64 s96, s[36:37]
    v_writelane_b32 v12, s96, 0
    s_bcnt1_i32_b64 s97, s[38:39]
    v_writelane_b32 v12, s97, 1
    s_bcnt1_i32_b64 s98, s[40:41]
    v_writelane_b32 v12, s98, 2
    s_bcnt1_i32_b64 s99, s[42:43]
    v_writelane_b32 v12, s99, 3
    s_bcnt1_i32_b64 s100, s[44:45]
    v_writelane_b32 v12, s100, 4
    s_mov_b64 exec, 31
    v_lshlrev_b32 v12, 2, v12
    ds_write_b32 v12, v19 offset:19712
    s_mov_b64 exec, -1
    s_add_u32 m0, s30, 79616
    s_nop 0
    buffer_load_dwordx4 v154, s[12:15], 0 offen sc1 lds
    s_add_u32 m0, s30, 87808
    s_nop 0
    buffer_load_dwordx4 v155, s[12:15], 0 offen sc1 lds
    s_waitcnt lgkmcnt(0)
    s_barrier
    ds_read_b32 v12, v15 offset:19712
    v_mfma_f32_4x4x4_16b_bf16 v[164:167], v[228:229], v[144:145], 0 cbsz:4 abid:0
    v_mfma_f32_4x4x4_16b_bf16 v[168:171], v[228:229], v[144:145], 0 cbsz:4 abid:1
    v_mfma_f32_4x4x4_16b_bf16 v[172:175], v[228:229], v[144:145], 0 cbsz:4 abid:2
    v_mfma_f32_4x4x4_16b_bf16 v[176:179], v[228:229], v[144:145], 0 cbsz:4 abid:3
    v_add_u32 v23, 112384, v161
    v_lshlrev_b32_sdwa v146, 10, v146 dst_sel:DWORD dst_unused:UNUSED_PAD src0_sel:DWORD src1_sel:WORD_1
    v_cvt_pk_bf16_f32 v180, v164, v165
    v_cvt_pk_bf16_f32 v181, v166, v167
    v_cvt_pk_bf16_f32 v182, v168, v169
    v_cvt_pk_bf16_f32 v183, v170, v171
    v_cvt_pk_bf16_f32 v184, v172, v173
    v_cvt_pk_bf16_f32 v185, v174, v175
    v_cvt_pk_bf16_f32 v186, v176, v177
    v_cvt_pk_bf16_f32 v187, v178, v179
    s_waitcnt lgkmcnt(0)
    v_add_u32_sdwa v16, v12, v16 dst_sel:DWORD dst_unused:UNUSED_PAD src0_sel:WORD_0 src1_sel:DWORD
    ds_read_b32 v13, v16 offset:16128
    v_readlane_b32 s96, v12, 0
    v_readlane_b32 s97, v12, 1
    v_readlane_b32 s98, v12, 2
    v_readlane_b32 s99, v12, 3
    v_readlane_b32 s100, v12, 4
    s_add_u32 s3, s96, s97
    s_add_u32 s3, s3, s98
    s_add_u32 s3, s3, s99
    s_add_u32 s3, s3, s100
    s_lshr_b32 s29, s3, 16
    s_add_u32 s3, s29, 480
    v_mov_b32 v14, s3
    v_mov_b32 v18, 0
    s_mov_b64 exec, 1
    ds_add_rtn_u32 v14, v18, v14 offset:19968
    s_mov_b64 exec, -1
    s_waitcnt lgkmcnt(1)
    v_sub_u32 v17, v17, v13
    s_nop 0
    v_add_u32_dpp v13, v13, v13 row_shr:1 row_mask:0xf bank_mask:0xf
    s_bfe_u32 s3, s29, 65539
    s_add_u32 s3, s3, 7
    v_add_u32_dpp v13, v13, v13 row_shr:2 row_mask:0xf bank_mask:0xf
    v_mov_b32 v20, 2147482664
    v_mov_b32 v21, 0
    v_add_u32_dpp v13, v13, v13 row_shr:4 row_mask:0xf bank_mask:0xf
    v_writelane_b32 v20, 40, s3
    s_nop 0
    v_add_u32_dpp v13, v13, v13 row_shr:8 row_mask:0xf bank_mask:0xf
    s_waitcnt lgkmcnt(0)
    v_readfirstlane_b32 s71, v14
    v_add_u32_dpp v13, v13, v13 row_bcast:15 row_mask:0xa bank_mask:0xf
    s_add_u32 s3, s71, s29
    v_lshl_add_u32 v18, v11, 3, s3
    v_add_u32_dpp v13, v13, v13 row_bcast:31 row_mask:0xc bank_mask:0xf
    s_mov_b32 exec_hi, 0x0fffffff
    v_add3_u32 v13, v13, v17, s71
    ds_write_b32 v16, v13 offset:16128
    ds_write_b64 v18, v[20:21] offset:0
    s_mov_b64 exec, -1
    ds_write_b128 v23, v[180:183]
    ds_write_b128 v23, v[184:187] offset:16
    s_add_u32 m0, s30, 96000
    s_nop 0
    buffer_load_dwordx4 v156, s[12:15], 0 offen sc1 lds
    s_waitcnt lgkmcnt(2)
    s_barrier
    ds_read_b32 v12, v143 offset:16128
    ds_read_b32 v13, v147 offset:16128
    ds_read_b32 v14, v151 offset:16128
    v_add_u32 v4, s71, v4
    v_add_u32 v5, s71, v5
    v_add_u32 v6, s71, v6
    s_mov_b64 exec, s[56:57]
    s_waitcnt lgkmcnt(2)
    v_add_u32_sdwa v132, v12, v132 dst_sel:DWORD dst_unused:UNUSED_PAD src0_sel:WORD_0 src1_sel:DWORD
    v_or_b32_sdwa v158, v12, v142 dst_sel:DWORD dst_unused:UNUSED_PAD src0_sel:WORD_1 src1_sel:DWORD
    ds_write_b64 v132, v[158:159] offset:0
    s_mov_b64 exec, s[58:59]
    s_waitcnt lgkmcnt(2)
    v_add_u32_sdwa v133, v13, v133 dst_sel:DWORD dst_unused:UNUSED_PAD src0_sel:WORD_0 src1_sel:DWORD
    v_or_b32_sdwa v160, v13, v146 dst_sel:DWORD dst_unused:UNUSED_PAD src0_sel:WORD_1 src1_sel:DWORD
    ds_write_b64 v133, v[160:161] offset:0
    s_mov_b64 exec, s[60:61]
    s_waitcnt lgkmcnt(2)
    v_add_u32_sdwa v134, v14, v134 dst_sel:DWORD dst_unused:UNUSED_PAD src0_sel:WORD_0 src1_sel:DWORD
    v_or_b32_sdwa v162, v14, v150 dst_sel:DWORD dst_unused:UNUSED_PAD src0_sel:WORD_1 src1_sel:DWORD
    ds_write_b64 v134, v[162:163] offset:0
    s_mov_b64 exec, -1
    s_add_u32 m0, s30, 104192
    s_nop 0
    buffer_load_dwordx4 v157, s[12:15], 0 offen sc1 lds
    s_waitcnt lgkmcnt(0)
    s_barrier
    ds_read_b32 v12, v4
    ds_read_b32 v7, v4 offset:56
    ds_read_b32 v9, v5 offset:4
    ds_read_b32 v10, v6 offset:4
    s_cmp_eq_u64 s[60:61], 0
    s_cbranch_scc1 L_not3
    v_mfma_f32_4x4x4_16b_bf16 v[164:167], v[228:229], v[148:149], 0 cbsz:4 abid:0
    v_mfma_f32_4x4x4_16b_bf16 v[168:171], v[228:229], v[148:149], 0 cbsz:4 abid:1
    v_mfma_f32_4x4x4_16b_bf16 v[172:175], v[228:229], v[148:149], 0 cbsz:4 abid:2
    v_mfma_f32_4x4x4_16b_bf16 v[176:179], v[228:229], v[148:149], 0 cbsz:4 abid:3
    v_add_u32 v23, 112384, v163
    s_nop 0
    v_cvt_pk_bf16_f32 v180, v164, v165
    v_cvt_pk_bf16_f32 v181, v166, v167
    v_cvt_pk_bf16_f32 v182, v168, v169
    v_cvt_pk_bf16_f32 v183, v170, v171
    v_cvt_pk_bf16_f32 v184, v172, v173
    v_cvt_pk_bf16_f32 v185, v174, v175
    v_cvt_pk_bf16_f32 v186, v176, v177
    v_cvt_pk_bf16_f32 v187, v178, v179
    ds_write_b128 v23, v[180:183]
    ds_write_b128 v23, v[184:187] offset:16
    s_waitcnt lgkmcnt(2)
    s_branch L_t3
L_not3:
    s_waitcnt lgkmcnt(0)
L_t3:
    v_readlane_b32 s36, v12, 0
    v_readlane_b32 s37, v12, 1
    v_readlane_b32 s38, v12, 2
    v_readlane_b32 s39, v12, 3
    s_and_b32 s70, s36, 4294966784
    buffer_load_dwordx4 v[196:199], v1, s[4:7], s70 offen
    s_and_b32 s71, s37, 4294966784
    buffer_load_dwordx4 v[200:203], v1, s[4:7], s71 offen
    s_and_b32 s70, s38, 4294966784
    buffer_load_dwordx4 v[204:207], v1, s[4:7], s70 offen
    s_and_b32 s71, s39, 4294966784
    buffer_load_dwordx4 v[208:211], v1, s[4:7], s71 offen
    v_readlane_b32 s40, v12, 4
    v_readlane_b32 s41, v12, 5
    v_readlane_b32 s42, v12, 6
    v_readlane_b32 s43, v12, 7
    v_add_u32 v9, v9, v2
    v_add_u32 v10, v10, v3
    s_and_b32 s68, s43, 4294966784
    ds_read_b128 v[132:135], v29
    ds_read_b128 v[136:139], v29
    ds_read_b128 v[140:143], v29
    ds_read_b128 v[144:147], v29
    ds_read_b128 v[148:151], v29
    ds_read_b128 v[152:155], v29
    ds_read_b128 v[156:159], v29
    ds_read_b128 v[160:163], v29
    s_waitcnt vmcnt(4) lgkmcnt(0)
    s_barrier
    s_cmp_eq_u32 s29, 0
    s_cbranch_scc1 L_exit
    ds_read_b128 v[24:27], v9 offset:63232
    ds_read_b64 v[32:33], v10
    s_and_b32 s70, s40, 4294966784
    buffer_load_dwordx4 v[212:215], v1, s[4:7], s70 offen
    s_and_b32 s71, s41, 4294966784
    buffer_load_dwordx4 v[216:219], v1, s[4:7], s71 offen
    s_waitcnt lgkmcnt(1)
    v_smfmac_f32_32x32x32_bf16 v[132:147], v[24:27], v[36:43], v28
    v_smfmac_f32_32x32x32_bf16 v[148:163], v[24:27], v[44:51], v28
    s_and_b32 s70, s42, 4294966784
    buffer_load_dwordx4 v[220:223], v1, s[4:7], s70 offen
    s_waitcnt lgkmcnt(0)
    s_nop 7
    v_exp_f32 v12, v132
    v_exp_f32 v13, v133
    v_exp_f32 v14, v148
    v_exp_f32 v15, v149
    v_pk_add_f32 v[12:13], v[12:13], 1.0 op_sel_hi:[1,0]
    v_pk_add_f32 v[14:15], v[14:15], 1.0 op_sel_hi:[1,0]
    v_rcp_f32 v12, v12
    v_rcp_f32 v13, v13
    s_nop 0
    v_pk_mul_f32 v[132:133], v[132:133], v[12:13]
L_loop:
    s_setprio 3
    ds_read_b32 v9, v5 offset:132
    ds_read_b32 v10, v6 offset:132
    ds_read_b32 v8, v4 offset:184
    ds_read_b128 v[164:167], v29
    s_waitcnt vmcnt(6)
    v_rcp_f32 v14, v14
    v_mfma_f32_4x4x4_16b_bf16 v[16:19], v[32:33], v[196:197], 0 cbsz:4 abid:0
    v_exp_f32 v13, v135
    v_mfma_f32_4x4x4_16b_bf16 v[20:23], v[32:33], v[198:199], 0 cbsz:4 abid:0
    v_exp_f32 v12, v134
    v_readlane_b32 s44, v7, 1
    v_rcp_f32 v15, v15
    v_pk_add_f32 v[12:13], v[12:13], 1.0 op_sel_hi:[1,0]
    v_pk_mul_f32 v[148:149], v[148:149], v[14:15]
    s_and_b32 s69, s44, 4294966784
    s_set_gpr_idx_on s36, gpr_idx(SRC2,DST)
    buffer_load_dwordx4 v[224:227], v1, s[4:7], s68 offen
    v_pk_fma_f32 v[84:85], v[132:133], v[16:17], v[84:85] op_sel_hi:[0,1,1]
    v_pk_fma_f32 v[86:87], v[132:133], v[18:19], v[86:87] op_sel_hi:[0,1,1]
    v_pk_fma_f32 v[88:89], v[148:149], v[20:21], v[88:89] op_sel_hi:[0,1,1]
    v_pk_fma_f32 v[90:91], v[148:149], v[22:23], v[90:91] op_sel_hi:[0,1,1]
    s_set_gpr_idx_off
    ds_read_b128 v[168:171], v29
    s_waitcnt vmcnt(6) lgkmcnt(2)
    v_rcp_f32 v12, v12
    v_mfma_f32_4x4x4_16b_bf16 v[16:19], v[32:33], v[200:201], 0 cbsz:4 abid:1
    v_exp_f32 v15, v151
    v_mfma_f32_4x4x4_16b_bf16 v[20:23], v[32:33], v[202:203], 0 cbsz:4 abid:1
    v_exp_f32 v14, v150
    v_readlane_b32 s45, v7, 2
    v_rcp_f32 v13, v13
    v_pk_add_f32 v[14:15], v[14:15], 1.0 op_sel_hi:[1,0]
    v_pk_mul_f32 v[134:135], v[134:135], v[12:13]
    s_and_b32 s68, s45, 4294966784
    s_set_gpr_idx_on s37, gpr_idx(SRC2,DST)
    buffer_load_dwordx4 v[196:199], v1, s[4:7], s69 offen
    v_pk_fma_f32 v[84:85], v[132:133], v[16:17], v[84:85] op_sel:[1,0,0]
    v_pk_fma_f32 v[86:87], v[132:133], v[18:19], v[86:87] op_sel:[1,0,0]
    v_pk_fma_f32 v[88:89], v[148:149], v[20:21], v[88:89] op_sel:[1,0,0]
    v_pk_fma_f32 v[90:91], v[148:149], v[22:23], v[90:91] op_sel:[1,0,0]
    s_set_gpr_idx_off
    s_cbranch_scc0 L_exit
    v_add_u32 v9, v9, v2
    v_add_u32 v10, v10, v3
    ds_read_b128 v[24:27], v9 offset:63232
    ds_read_b64 v[34:35], v10
    ds_read_b128 v[172:175], v29
    s_waitcnt vmcnt(6)
    v_rcp_f32 v14, v14
    v_mfma_f32_4x4x4_16b_bf16 v[16:19], v[32:33], v[204:205], 0 cbsz:4 abid:2
    v_exp_f32 v13, v137
    v_mfma_f32_4x4x4_16b_bf16 v[20:23], v[32:33], v[206:207], 0 cbsz:4 abid:2
    v_exp_f32 v12, v136
    v_readlane_b32 s46, v7, 3
    v_rcp_f32 v15, v15
    v_pk_add_f32 v[12:13], v[12:13], 1.0 op_sel_hi:[1,0]
    v_pk_mul_f32 v[150:151], v[150:151], v[14:15]
    s_and_b32 s69, s46, 4294966784
    s_set_gpr_idx_on s38, gpr_idx(SRC2,DST)
    buffer_load_dwordx4 v[200:203], v1, s[4:7], s68 offen
    v_pk_fma_f32 v[84:85], v[134:135], v[16:17], v[84:85] op_sel_hi:[0,1,1]
    v_pk_fma_f32 v[86:87], v[134:135], v[18:19], v[86:87] op_sel_hi:[0,1,1]
    v_pk_fma_f32 v[88:89], v[150:151], v[20:21], v[88:89] op_sel_hi:[0,1,1]
    v_pk_fma_f32 v[90:91], v[150:151], v[22:23], v[90:91] op_sel_hi:[0,1,1]
    s_set_gpr_idx_off
    ds_read_b128 v[176:179], v29
    s_waitcnt vmcnt(6)
    v_rcp_f32 v12, v12
    v_mfma_f32_4x4x4_16b_bf16 v[16:19], v[32:33], v[208:209], 0 cbsz:4 abid:3
    v_exp_f32 v15, v153
    v_mfma_f32_4x4x4_16b_bf16 v[20:23], v[32:33], v[210:211], 0 cbsz:4 abid:3
    v_exp_f32 v14, v152
    v_readlane_b32 s47, v7, 4
    v_rcp_f32 v13, v13
    v_pk_add_f32 v[14:15], v[14:15], 1.0 op_sel_hi:[1,0]
    v_pk_mul_f32 v[136:137], v[136:137], v[12:13]
    s_and_b32 s68, s47, 4294966784
    s_set_gpr_idx_on s39, gpr_idx(SRC2,DST)
    buffer_load_dwordx4 v[204:207], v1, s[4:7], s69 offen
    v_pk_fma_f32 v[84:85], v[134:135], v[16:17], v[84:85] op_sel:[1,0,0]
    v_pk_fma_f32 v[86:87], v[134:135], v[18:19], v[86:87] op_sel:[1,0,0]
    v_pk_fma_f32 v[88:89], v[150:151], v[20:21], v[88:89] op_sel:[1,0,0]
    v_pk_fma_f32 v[90:91], v[150:151], v[22:23], v[90:91] op_sel:[1,0,0]
    s_set_gpr_idx_off
    s_cbranch_scc0 L_exit
    s_setprio 2
    ds_read_b128 v[180:183], v29
    s_waitcnt vmcnt(6)
    v_rcp_f32 v14, v14
    v_mfma_f32_4x4x4_16b_bf16 v[16:19], v[32:33], v[212:213], 0 cbsz:4 abid:4
    v_exp_f32 v13, v139
    v_mfma_f32_4x4x4_16b_bf16 v[20:23], v[32:33], v[214:215], 0 cbsz:4 abid:4
    v_exp_f32 v12, v138
    v_readlane_b32 s48, v7, 5
    v_rcp_f32 v15, v15
    v_pk_add_f32 v[12:13], v[12:13], 1.0 op_sel_hi:[1,0]
    v_pk_mul_f32 v[152:153], v[152:153], v[14:15]
    s_and_b32 s69, s48, 4294966784
    s_set_gpr_idx_on s40, gpr_idx(SRC2,DST)
    buffer_load_dwordx4 v[208:211], v1, s[4:7], s68 offen
    v_pk_fma_f32 v[84:85], v[136:137], v[16:17], v[84:85] op_sel_hi:[0,1,1]
    v_pk_fma_f32 v[86:87], v[136:137], v[18:19], v[86:87] op_sel_hi:[0,1,1]
    v_pk_fma_f32 v[88:89], v[152:153], v[20:21], v[88:89] op_sel_hi:[0,1,1]
    v_pk_fma_f32 v[90:91], v[152:153], v[22:23], v[90:91] op_sel_hi:[0,1,1]
    s_set_gpr_idx_off
    ds_read_b128 v[184:187], v29
    s_waitcnt vmcnt(6)
    v_rcp_f32 v12, v12
    v_mfma_f32_4x4x4_16b_bf16 v[16:19], v[32:33], v[216:217], 0 cbsz:4 abid:5
    v_exp_f32 v15, v155
    v_mfma_f32_4x4x4_16b_bf16 v[20:23], v[32:33], v[218:219], 0 cbsz:4 abid:5
    v_exp_f32 v14, v154
    v_readlane_b32 s49, v7, 6
    v_rcp_f32 v13, v13
    v_pk_add_f32 v[14:15], v[14:15], 1.0 op_sel_hi:[1,0]
    v_pk_mul_f32 v[138:139], v[138:139], v[12:13]
    s_and_b32 s68, s49, 4294966784
    s_set_gpr_idx_on s41, gpr_idx(SRC2,DST)
    buffer_load_dwordx4 v[212:215], v1, s[4:7], s69 offen
    v_pk_fma_f32 v[84:85], v[136:137], v[16:17], v[84:85] op_sel:[1,0,0]
    v_pk_fma_f32 v[86:87], v[136:137], v[18:19], v[86:87] op_sel:[1,0,0]
    v_pk_fma_f32 v[88:89], v[152:153], v[20:21], v[88:89] op_sel:[1,0,0]
    v_pk_fma_f32 v[90:91], v[152:153], v[22:23], v[90:91] op_sel:[1,0,0]
    s_set_gpr_idx_off
    s_cbranch_scc0 L_exit
    ds_read_b128 v[188:191], v29
    s_waitcnt vmcnt(6)
    v_rcp_f32 v14, v14
    v_mfma_f32_4x4x4_16b_bf16 v[16:19], v[32:33], v[220:221], 0 cbsz:4 abid:6
    v_exp_f32 v13, v141
    v_mfma_f32_4x4x4_16b_bf16 v[20:23], v[32:33], v[222:223], 0 cbsz:4 abid:6
    v_exp_f32 v12, v140
    v_readlane_b32 s50, v7, 7
    v_rcp_f32 v15, v15
    v_pk_add_f32 v[12:13], v[12:13], 1.0 op_sel_hi:[1,0]
    v_pk_mul_f32 v[154:155], v[154:155], v[14:15]
    s_and_b32 s69, s50, 4294966784
    s_set_gpr_idx_on s42, gpr_idx(SRC2,DST)
    buffer_load_dwordx4 v[216:219], v1, s[4:7], s68 offen
    v_pk_fma_f32 v[84:85], v[138:139], v[16:17], v[84:85] op_sel_hi:[0,1,1]
    v_pk_fma_f32 v[86:87], v[138:139], v[18:19], v[86:87] op_sel_hi:[0,1,1]
    v_pk_fma_f32 v[88:89], v[154:155], v[20:21], v[88:89] op_sel_hi:[0,1,1]
    v_pk_fma_f32 v[90:91], v[154:155], v[22:23], v[90:91] op_sel_hi:[0,1,1]
    s_set_gpr_idx_off
    ds_read_b128 v[192:195], v29
    s_waitcnt vmcnt(6)
    v_rcp_f32 v12, v12
    v_mfma_f32_4x4x4_16b_bf16 v[16:19], v[32:33], v[224:225], 0 cbsz:4 abid:7
    v_exp_f32 v15, v157
    v_mfma_f32_4x4x4_16b_bf16 v[20:23], v[32:33], v[226:227], 0 cbsz:4 abid:7
    v_exp_f32 v14, v156
    v_readlane_b32 s51, v7, 8
    v_rcp_f32 v13, v13
    v_pk_add_f32 v[14:15], v[14:15], 1.0 op_sel_hi:[1,0]
    v_pk_mul_f32 v[140:141], v[140:141], v[12:13]
    s_and_b32 s68, s51, 4294966784
    s_set_gpr_idx_on s43, gpr_idx(SRC2,DST)
    buffer_load_dwordx4 v[220:223], v1, s[4:7], s69 offen
    v_pk_fma_f32 v[84:85], v[138:139], v[16:17], v[84:85] op_sel:[1,0,0]
    v_pk_fma_f32 v[86:87], v[138:139], v[18:19], v[86:87] op_sel:[1,0,0]
    v_pk_fma_f32 v[88:89], v[154:155], v[20:21], v[88:89] op_sel:[1,0,0]
    v_pk_fma_f32 v[90:91], v[154:155], v[22:23], v[90:91] op_sel:[1,0,0]
    s_set_gpr_idx_off
    s_cbranch_scc0 L_exit
    s_setprio 1
    s_waitcnt vmcnt(6)
    v_rcp_f32 v14, v14
    v_mfma_f32_4x4x4_16b_bf16 v[16:19], v[32:33], v[196:197], 0 cbsz:4 abid:8
    v_exp_f32 v13, v143
    v_mfma_f32_4x4x4_16b_bf16 v[20:23], v[32:33], v[198:199], 0 cbsz:4 abid:8
    v_exp_f32 v12, v142
    v_readlane_b32 s52, v7, 9
    v_rcp_f32 v15, v15
    v_pk_add_f32 v[12:13], v[12:13], 1.0 op_sel_hi:[1,0]
    v_pk_mul_f32 v[156:157], v[156:157], v[14:15]
    s_and_b32 s69, s52, 4294966784
    s_set_gpr_idx_on s44, gpr_idx(SRC2,DST)
    buffer_load_dwordx4 v[224:227], v1, s[4:7], s68 offen
    v_pk_fma_f32 v[84:85], v[140:141], v[16:17], v[84:85] op_sel_hi:[0,1,1]
    v_pk_fma_f32 v[86:87], v[140:141], v[18:19], v[86:87] op_sel_hi:[0,1,1]
    v_pk_fma_f32 v[88:89], v[156:157], v[20:21], v[88:89] op_sel_hi:[0,1,1]
    v_pk_fma_f32 v[90:91], v[156:157], v[22:23], v[90:91] op_sel_hi:[0,1,1]
    s_set_gpr_idx_off
    s_waitcnt vmcnt(6) lgkmcnt(0)
    v_mfma_f32_4x4x4_16b_bf16 v[20:23], v[32:33], v[202:203], 0 cbsz:4 abid:9
    v_mfma_f32_4x4x4_16b_bf16 v[16:19], v[32:33], v[200:201], 0 cbsz:4 abid:9
    v_rcp_f32 v13, v13
    v_smfmac_f32_32x32x32_bf16 v[164:179], v[24:27], v[36:43], v28
    v_exp_f32 v14, v158
    v_exp_f32 v15, v159
    v_readlane_b32 s53, v7, 10
    v_rcp_f32 v12, v12
    v_pk_add_f32 v[14:15], v[14:15], 1.0 op_sel_hi:[1,0]
    v_pk_mul_f32 v[142:143], v[142:143], v[12:13]
    s_and_b32 s68, s53, 4294966784
    s_set_gpr_idx_on s45, gpr_idx(SRC2,DST)
    buffer_load_dwordx4 v[196:199], v1, s[4:7], s69 offen
    v_pk_fma_f32 v[84:85], v[140:141], v[16:17], v[84:85] op_sel:[1,0,0]
    v_pk_fma_f32 v[86:87], v[140:141], v[18:19], v[86:87] op_sel:[1,0,0]
    v_pk_fma_f32 v[88:89], v[156:157], v[20:21], v[88:89] op_sel:[1,0,0]
    v_pk_fma_f32 v[90:91], v[156:157], v[22:23], v[90:91] op_sel:[1,0,0]
    s_set_gpr_idx_off
    s_cbranch_scc0 L_exit
    s_waitcnt vmcnt(6)
    v_rcp_f32 v14, v14
    v_mfma_f32_4x4x4_16b_bf16 v[16:19], v[32:33], v[204:205], 0 cbsz:4 abid:10
    v_exp_f32 v13, v145
    v_mfma_f32_4x4x4_16b_bf16 v[20:23], v[32:33], v[206:207], 0 cbsz:4 abid:10
    v_exp_f32 v12, v144
    v_readlane_b32 s54, v7, 11
    v_rcp_f32 v15, v15
    v_pk_add_f32 v[12:13], v[12:13], 1.0 op_sel_hi:[1,0]
    v_pk_mul_f32 v[158:159], v[158:159], v[14:15]
    s_and_b32 s69, s54, 4294966784
    s_set_gpr_idx_on s46, gpr_idx(SRC2,DST)
    buffer_load_dwordx4 v[200:203], v1, s[4:7], s68 offen
    v_pk_fma_f32 v[84:85], v[142:143], v[16:17], v[84:85] op_sel_hi:[0,1,1]
    v_pk_fma_f32 v[86:87], v[142:143], v[18:19], v[86:87] op_sel_hi:[0,1,1]
    v_pk_fma_f32 v[88:89], v[158:159], v[20:21], v[88:89] op_sel_hi:[0,1,1]
    v_pk_fma_f32 v[90:91], v[158:159], v[22:23], v[90:91] op_sel_hi:[0,1,1]
    s_set_gpr_idx_off
    s_waitcnt vmcnt(6)
    v_mfma_f32_4x4x4_16b_bf16 v[20:23], v[32:33], v[210:211], 0 cbsz:4 abid:11
    v_mfma_f32_4x4x4_16b_bf16 v[16:19], v[32:33], v[208:209], 0 cbsz:4 abid:11
    v_rcp_f32 v13, v13
    v_smfmac_f32_32x32x32_bf16 v[180:195], v[24:27], v[44:51], v28
    v_exp_f32 v14, v160
    v_exp_f32 v15, v161
    v_readlane_b32 s55, v7, 12
    v_rcp_f32 v12, v12
    v_pk_add_f32 v[14:15], v[14:15], 1.0 op_sel_hi:[1,0]
    v_pk_mul_f32 v[144:145], v[144:145], v[12:13]
    s_and_b32 s68, s55, 4294966784
    s_set_gpr_idx_on s47, gpr_idx(SRC2,DST)
    buffer_load_dwordx4 v[204:207], v1, s[4:7], s69 offen
    v_pk_fma_f32 v[84:85], v[142:143], v[16:17], v[84:85] op_sel:[1,0,0]
    v_pk_fma_f32 v[86:87], v[142:143], v[18:19], v[86:87] op_sel:[1,0,0]
    v_pk_fma_f32 v[88:89], v[158:159], v[20:21], v[88:89] op_sel:[1,0,0]
    v_pk_fma_f32 v[90:91], v[158:159], v[22:23], v[90:91] op_sel:[1,0,0]
    s_set_gpr_idx_off
    s_cbranch_scc0 L_exit
    s_setprio 0
    s_waitcnt vmcnt(6)
    v_rcp_f32 v14, v14
    v_mfma_f32_4x4x4_16b_bf16 v[16:19], v[32:33], v[212:213], 0 cbsz:4 abid:12
    v_exp_f32 v13, v147
    v_mfma_f32_4x4x4_16b_bf16 v[20:23], v[32:33], v[214:215], 0 cbsz:4 abid:12
    v_exp_f32 v12, v146
    v_readlane_b32 s56, v7, 13
    v_rcp_f32 v15, v15
    v_pk_add_f32 v[12:13], v[12:13], 1.0 op_sel_hi:[1,0]
    v_pk_mul_f32 v[160:161], v[160:161], v[14:15]
    s_and_b32 s69, s56, 4294966784
    s_set_gpr_idx_on s48, gpr_idx(SRC2,DST)
    buffer_load_dwordx4 v[208:211], v1, s[4:7], s68 offen
    v_pk_fma_f32 v[84:85], v[144:145], v[16:17], v[84:85] op_sel_hi:[0,1,1]
    v_pk_fma_f32 v[86:87], v[144:145], v[18:19], v[86:87] op_sel_hi:[0,1,1]
    v_pk_fma_f32 v[88:89], v[160:161], v[20:21], v[88:89] op_sel_hi:[0,1,1]
    v_pk_fma_f32 v[90:91], v[160:161], v[22:23], v[90:91] op_sel_hi:[0,1,1]
    s_set_gpr_idx_off
    s_waitcnt vmcnt(6)
    v_rcp_f32 v12, v12
    v_mfma_f32_4x4x4_16b_bf16 v[16:19], v[32:33], v[216:217], 0 cbsz:4 abid:13
    v_exp_f32 v15, v163
    v_mfma_f32_4x4x4_16b_bf16 v[20:23], v[32:33], v[218:219], 0 cbsz:4 abid:13
    v_exp_f32 v14, v162
    v_readlane_b32 s57, v7, 14
    v_rcp_f32 v13, v13
    v_pk_add_f32 v[14:15], v[14:15], 1.0 op_sel_hi:[1,0]
    v_pk_mul_f32 v[146:147], v[146:147], v[12:13]
    s_and_b32 s68, s57, 4294966784
    s_set_gpr_idx_on s49, gpr_idx(SRC2,DST)
    buffer_load_dwordx4 v[212:215], v1, s[4:7], s69 offen
    v_pk_fma_f32 v[84:85], v[144:145], v[16:17], v[84:85] op_sel:[1,0,0]
    v_pk_fma_f32 v[86:87], v[144:145], v[18:19], v[86:87] op_sel:[1,0,0]
    v_pk_fma_f32 v[88:89], v[160:161], v[20:21], v[88:89] op_sel:[1,0,0]
    v_pk_fma_f32 v[90:91], v[160:161], v[22:23], v[90:91] op_sel:[1,0,0]
    s_set_gpr_idx_off
    s_cbranch_scc0 L_exit
    s_waitcnt vmcnt(6)
    v_rcp_f32 v14, v14
    v_mfma_f32_4x4x4_16b_bf16 v[16:19], v[32:33], v[220:221], 0 cbsz:4 abid:14
    v_exp_f32 v13, v165
    v_mfma_f32_4x4x4_16b_bf16 v[20:23], v[32:33], v[222:223], 0 cbsz:4 abid:14
    v_exp_f32 v12, v164
    v_readlane_b32 s58, v7, 15
    v_rcp_f32 v15, v15
    v_pk_add_f32 v[12:13], v[12:13], 1.0 op_sel_hi:[1,0]
    v_pk_mul_f32 v[162:163], v[162:163], v[14:15]
    s_and_b32 s69, s58, 4294966784
    s_set_gpr_idx_on s50, gpr_idx(SRC2,DST)
    buffer_load_dwordx4 v[216:219], v1, s[4:7], s68 offen
    v_pk_fma_f32 v[84:85], v[146:147], v[16:17], v[84:85] op_sel_hi:[0,1,1]
    v_pk_fma_f32 v[86:87], v[146:147], v[18:19], v[86:87] op_sel_hi:[0,1,1]
    v_pk_fma_f32 v[88:89], v[162:163], v[20:21], v[88:89] op_sel_hi:[0,1,1]
    v_pk_fma_f32 v[90:91], v[162:163], v[22:23], v[90:91] op_sel_hi:[0,1,1]
    s_set_gpr_idx_off
    s_waitcnt vmcnt(6)
    v_rcp_f32 v12, v12
    v_mfma_f32_4x4x4_16b_bf16 v[16:19], v[32:33], v[224:225], 0 cbsz:4 abid:15
    v_exp_f32 v15, v181
    v_mfma_f32_4x4x4_16b_bf16 v[20:23], v[32:33], v[226:227], 0 cbsz:4 abid:15
    v_exp_f32 v14, v180
    v_readlane_b32 s59, v8, 0
    v_rcp_f32 v13, v13
    v_pk_add_f32 v[14:15], v[14:15], 1.0 op_sel_hi:[1,0]
    v_pk_mul_f32 v[164:165], v[164:165], v[12:13]
    s_and_b32 s68, s59, 4294966784
    s_set_gpr_idx_on s51, gpr_idx(SRC2,DST)
    buffer_load_dwordx4 v[220:223], v1, s[4:7], s69 offen
    v_pk_fma_f32 v[84:85], v[146:147], v[16:17], v[84:85] op_sel:[1,0,0]
    v_pk_fma_f32 v[86:87], v[146:147], v[18:19], v[86:87] op_sel:[1,0,0]
    v_pk_fma_f32 v[88:89], v[162:163], v[20:21], v[88:89] op_sel:[1,0,0]
    v_pk_fma_f32 v[90:91], v[162:163], v[22:23], v[90:91] op_sel:[1,0,0]
    s_set_gpr_idx_off
    s_cbranch_scc0 L_exit
    s_setprio 3
    ds_read_b32 v9, v5 offset:260
    ds_read_b32 v10, v6 offset:260
    ds_read_b32 v7, v4 offset:312
    ds_read_b128 v[132:135], v29
    s_waitcnt vmcnt(6)
    v_rcp_f32 v14, v14
    v_mfma_f32_4x4x4_16b_bf16 v[16:19], v[34:35], v[196:197], 0 cbsz:4 abid:0
    v_exp_f32 v13, v167
    v_mfma_f32_4x4x4_16b_bf16 v[20:23], v[34:35], v[198:199], 0 cbsz:4 abid:0
    v_exp_f32 v12, v166
    v_readlane_b32 s60, v8, 1
    v_rcp_f32 v15, v15
    v_pk_add_f32 v[12:13], v[12:13], 1.0 op_sel_hi:[1,0]
    v_pk_mul_f32 v[180:181], v[180:181], v[14:15]
    s_and_b32 s69, s60, 4294966784
    s_set_gpr_idx_on s52, gpr_idx(SRC2,DST)
    buffer_load_dwordx4 v[224:227], v1, s[4:7], s68 offen
    v_pk_fma_f32 v[84:85], v[164:165], v[16:17], v[84:85] op_sel_hi:[0,1,1]
    v_pk_fma_f32 v[86:87], v[164:165], v[18:19], v[86:87] op_sel_hi:[0,1,1]
    v_pk_fma_f32 v[88:89], v[180:181], v[20:21], v[88:89] op_sel_hi:[0,1,1]
    v_pk_fma_f32 v[90:91], v[180:181], v[22:23], v[90:91] op_sel_hi:[0,1,1]
    s_set_gpr_idx_off
    ds_read_b128 v[136:139], v29
    s_waitcnt vmcnt(6) lgkmcnt(2)
    v_rcp_f32 v12, v12
    v_mfma_f32_4x4x4_16b_bf16 v[16:19], v[34:35], v[200:201], 0 cbsz:4 abid:1
    v_exp_f32 v15, v183
    v_mfma_f32_4x4x4_16b_bf16 v[20:23], v[34:35], v[202:203], 0 cbsz:4 abid:1
    v_exp_f32 v14, v182
    v_readlane_b32 s61, v8, 2
    v_rcp_f32 v13, v13
    v_pk_add_f32 v[14:15], v[14:15], 1.0 op_sel_hi:[1,0]
    v_pk_mul_f32 v[166:167], v[166:167], v[12:13]
    s_and_b32 s68, s61, 4294966784
    s_set_gpr_idx_on s53, gpr_idx(SRC2,DST)
    buffer_load_dwordx4 v[196:199], v1, s[4:7], s69 offen
    v_pk_fma_f32 v[84:85], v[164:165], v[16:17], v[84:85] op_sel:[1,0,0]
    v_pk_fma_f32 v[86:87], v[164:165], v[18:19], v[86:87] op_sel:[1,0,0]
    v_pk_fma_f32 v[88:89], v[180:181], v[20:21], v[88:89] op_sel:[1,0,0]
    v_pk_fma_f32 v[90:91], v[180:181], v[22:23], v[90:91] op_sel:[1,0,0]
    s_set_gpr_idx_off
    s_cbranch_scc0 L_exit
    v_add_u32 v9, v9, v2
    v_add_u32 v10, v10, v3
    ds_read_b128 v[24:27], v9 offset:63232
    ds_read_b64 v[32:33], v10
    ds_read_b128 v[140:143], v29
    s_waitcnt vmcnt(6)
    v_rcp_f32 v14, v14
    v_mfma_f32_4x4x4_16b_bf16 v[16:19], v[34:35], v[204:205], 0 cbsz:4 abid:2
    v_exp_f32 v13, v169
    v_mfma_f32_4x4x4_16b_bf16 v[20:23], v[34:35], v[206:207], 0 cbsz:4 abid:2
    v_exp_f32 v12, v168
    v_readlane_b32 s62, v8, 3
    v_rcp_f32 v15, v15
    v_pk_add_f32 v[12:13], v[12:13], 1.0 op_sel_hi:[1,0]
    v_pk_mul_f32 v[182:183], v[182:183], v[14:15]
    s_and_b32 s69, s62, 4294966784
    s_set_gpr_idx_on s54, gpr_idx(SRC2,DST)
    buffer_load_dwordx4 v[200:203], v1, s[4:7], s68 offen
    v_pk_fma_f32 v[84:85], v[166:167], v[16:17], v[84:85] op_sel_hi:[0,1,1]
    v_pk_fma_f32 v[86:87], v[166:167], v[18:19], v[86:87] op_sel_hi:[0,1,1]
    v_pk_fma_f32 v[88:89], v[182:183], v[20:21], v[88:89] op_sel_hi:[0,1,1]
    v_pk_fma_f32 v[90:91], v[182:183], v[22:23], v[90:91] op_sel_hi:[0,1,1]
    s_set_gpr_idx_off
    ds_read_b128 v[144:147], v29
    s_waitcnt vmcnt(6)
    v_rcp_f32 v12, v12
    v_mfma_f32_4x4x4_16b_bf16 v[16:19], v[34:35], v[208:209], 0 cbsz:4 abid:3
    v_exp_f32 v15, v185
    v_mfma_f32_4x4x4_16b_bf16 v[20:23], v[34:35], v[210:211], 0 cbsz:4 abid:3
    v_exp_f32 v14, v184
    v_readlane_b32 s63, v8, 4
    v_rcp_f32 v13, v13
    v_pk_add_f32 v[14:15], v[14:15], 1.0 op_sel_hi:[1,0]
    v_pk_mul_f32 v[168:169], v[168:169], v[12:13]
    s_and_b32 s68, s63, 4294966784
    s_set_gpr_idx_on s55, gpr_idx(SRC2,DST)
    buffer_load_dwordx4 v[204:207], v1, s[4:7], s69 offen
    v_pk_fma_f32 v[84:85], v[166:167], v[16:17], v[84:85] op_sel:[1,0,0]
    v_pk_fma_f32 v[86:87], v[166:167], v[18:19], v[86:87] op_sel:[1,0,0]
    v_pk_fma_f32 v[88:89], v[182:183], v[20:21], v[88:89] op_sel:[1,0,0]
    v_pk_fma_f32 v[90:91], v[182:183], v[22:23], v[90:91] op_sel:[1,0,0]
    s_set_gpr_idx_off
    s_cbranch_scc0 L_exit
    s_setprio 2
    ds_read_b128 v[148:151], v29
    s_waitcnt vmcnt(6)
    v_rcp_f32 v14, v14
    v_mfma_f32_4x4x4_16b_bf16 v[16:19], v[34:35], v[212:213], 0 cbsz:4 abid:4
    v_exp_f32 v13, v171
    v_mfma_f32_4x4x4_16b_bf16 v[20:23], v[34:35], v[214:215], 0 cbsz:4 abid:4
    v_exp_f32 v12, v170
    v_readlane_b32 s64, v8, 5
    v_rcp_f32 v15, v15
    v_pk_add_f32 v[12:13], v[12:13], 1.0 op_sel_hi:[1,0]
    v_pk_mul_f32 v[184:185], v[184:185], v[14:15]
    s_and_b32 s69, s64, 4294966784
    s_set_gpr_idx_on s56, gpr_idx(SRC2,DST)
    buffer_load_dwordx4 v[208:211], v1, s[4:7], s68 offen
    v_pk_fma_f32 v[84:85], v[168:169], v[16:17], v[84:85] op_sel_hi:[0,1,1]
    v_pk_fma_f32 v[86:87], v[168:169], v[18:19], v[86:87] op_sel_hi:[0,1,1]
    v_pk_fma_f32 v[88:89], v[184:185], v[20:21], v[88:89] op_sel_hi:[0,1,1]
    v_pk_fma_f32 v[90:91], v[184:185], v[22:23], v[90:91] op_sel_hi:[0,1,1]
    s_set_gpr_idx_off
    ds_read_b128 v[152:155], v29
    s_waitcnt vmcnt(6)
    v_rcp_f32 v12, v12
    v_mfma_f32_4x4x4_16b_bf16 v[16:19], v[34:35], v[216:217], 0 cbsz:4 abid:5
    v_exp_f32 v15, v187
    v_mfma_f32_4x4x4_16b_bf16 v[20:23], v[34:35], v[218:219], 0 cbsz:4 abid:5
    v_exp_f32 v14, v186
    v_readlane_b32 s65, v8, 6
    v_rcp_f32 v13, v13
    v_pk_add_f32 v[14:15], v[14:15], 1.0 op_sel_hi:[1,0]
    v_pk_mul_f32 v[170:171], v[170:171], v[12:13]
    s_and_b32 s68, s65, 4294966784
    s_set_gpr_idx_on s57, gpr_idx(SRC2,DST)
    buffer_load_dwordx4 v[212:215], v1, s[4:7], s69 offen
    v_pk_fma_f32 v[84:85], v[168:169], v[16:17], v[84:85] op_sel:[1,0,0]
    v_pk_fma_f32 v[86:87], v[168:169], v[18:19], v[86:87] op_sel:[1,0,0]
    v_pk_fma_f32 v[88:89], v[184:185], v[20:21], v[88:89] op_sel:[1,0,0]
    v_pk_fma_f32 v[90:91], v[184:185], v[22:23], v[90:91] op_sel:[1,0,0]
    s_set_gpr_idx_off
    s_cbranch_scc0 L_exit
    ds_read_b128 v[156:159], v29
    s_waitcnt vmcnt(6)
    v_rcp_f32 v14, v14
    v_mfma_f32_4x4x4_16b_bf16 v[16:19], v[34:35], v[220:221], 0 cbsz:4 abid:6
    v_exp_f32 v13, v173
    v_mfma_f32_4x4x4_16b_bf16 v[20:23], v[34:35], v[222:223], 0 cbsz:4 abid:6
    v_exp_f32 v12, v172
    v_readlane_b32 s66, v8, 7
    v_rcp_f32 v15, v15
    v_pk_add_f32 v[12:13], v[12:13], 1.0 op_sel_hi:[1,0]
    v_pk_mul_f32 v[186:187], v[186:187], v[14:15]
    s_and_b32 s69, s66, 4294966784
    s_set_gpr_idx_on s58, gpr_idx(SRC2,DST)
    buffer_load_dwordx4 v[216:219], v1, s[4:7], s68 offen
    v_pk_fma_f32 v[84:85], v[170:171], v[16:17], v[84:85] op_sel_hi:[0,1,1]
    v_pk_fma_f32 v[86:87], v[170:171], v[18:19], v[86:87] op_sel_hi:[0,1,1]
    v_pk_fma_f32 v[88:89], v[186:187], v[20:21], v[88:89] op_sel_hi:[0,1,1]
    v_pk_fma_f32 v[90:91], v[186:187], v[22:23], v[90:91] op_sel_hi:[0,1,1]
    s_set_gpr_idx_off
    ds_read_b128 v[160:163], v29
    s_waitcnt vmcnt(6)
    v_rcp_f32 v12, v12
    v_mfma_f32_4x4x4_16b_bf16 v[16:19], v[34:35], v[224:225], 0 cbsz:4 abid:7
    v_exp_f32 v15, v189
    v_mfma_f32_4x4x4_16b_bf16 v[20:23], v[34:35], v[226:227], 0 cbsz:4 abid:7
    v_exp_f32 v14, v188
    v_readlane_b32 s67, v8, 8
    v_rcp_f32 v13, v13
    v_pk_add_f32 v[14:15], v[14:15], 1.0 op_sel_hi:[1,0]
    v_pk_mul_f32 v[172:173], v[172:173], v[12:13]
    s_and_b32 s68, s67, 4294966784
    s_set_gpr_idx_on s59, gpr_idx(SRC2,DST)
    buffer_load_dwordx4 v[220:223], v1, s[4:7], s69 offen
    v_pk_fma_f32 v[84:85], v[170:171], v[16:17], v[84:85] op_sel:[1,0,0]
    v_pk_fma_f32 v[86:87], v[170:171], v[18:19], v[86:87] op_sel:[1,0,0]
    v_pk_fma_f32 v[88:89], v[186:187], v[20:21], v[88:89] op_sel:[1,0,0]
    v_pk_fma_f32 v[90:91], v[186:187], v[22:23], v[90:91] op_sel:[1,0,0]
    s_set_gpr_idx_off
    s_cbranch_scc0 L_exit
    s_setprio 1
    s_waitcnt vmcnt(6)
    v_rcp_f32 v14, v14
    v_mfma_f32_4x4x4_16b_bf16 v[16:19], v[34:35], v[196:197], 0 cbsz:4 abid:8
    v_exp_f32 v13, v175
    v_mfma_f32_4x4x4_16b_bf16 v[20:23], v[34:35], v[198:199], 0 cbsz:4 abid:8
    v_exp_f32 v12, v174
    v_readlane_b32 s36, v8, 9
    v_rcp_f32 v15, v15
    v_pk_add_f32 v[12:13], v[12:13], 1.0 op_sel_hi:[1,0]
    v_pk_mul_f32 v[188:189], v[188:189], v[14:15]
    s_and_b32 s69, s36, 4294966784
    s_set_gpr_idx_on s60, gpr_idx(SRC2,DST)
    buffer_load_dwordx4 v[224:227], v1, s[4:7], s68 offen
    v_pk_fma_f32 v[84:85], v[172:173], v[16:17], v[84:85] op_sel_hi:[0,1,1]
    v_pk_fma_f32 v[86:87], v[172:173], v[18:19], v[86:87] op_sel_hi:[0,1,1]
    v_pk_fma_f32 v[88:89], v[188:189], v[20:21], v[88:89] op_sel_hi:[0,1,1]
    v_pk_fma_f32 v[90:91], v[188:189], v[22:23], v[90:91] op_sel_hi:[0,1,1]
    s_set_gpr_idx_off
    s_waitcnt vmcnt(6) lgkmcnt(0)
    v_mfma_f32_4x4x4_16b_bf16 v[20:23], v[34:35], v[202:203], 0 cbsz:4 abid:9
    v_mfma_f32_4x4x4_16b_bf16 v[16:19], v[34:35], v[200:201], 0 cbsz:4 abid:9
    v_rcp_f32 v13, v13
    v_smfmac_f32_32x32x32_bf16 v[132:147], v[24:27], v[36:43], v28
    v_exp_f32 v14, v190
    v_exp_f32 v15, v191
    v_readlane_b32 s37, v8, 10
    v_rcp_f32 v12, v12
    v_pk_add_f32 v[14:15], v[14:15], 1.0 op_sel_hi:[1,0]
    v_pk_mul_f32 v[174:175], v[174:175], v[12:13]
    s_and_b32 s68, s37, 4294966784
    s_set_gpr_idx_on s61, gpr_idx(SRC2,DST)
    buffer_load_dwordx4 v[196:199], v1, s[4:7], s69 offen
    v_pk_fma_f32 v[84:85], v[172:173], v[16:17], v[84:85] op_sel:[1,0,0]
    v_pk_fma_f32 v[86:87], v[172:173], v[18:19], v[86:87] op_sel:[1,0,0]
    v_pk_fma_f32 v[88:89], v[188:189], v[20:21], v[88:89] op_sel:[1,0,0]
    v_pk_fma_f32 v[90:91], v[188:189], v[22:23], v[90:91] op_sel:[1,0,0]
    s_set_gpr_idx_off
    s_cbranch_scc0 L_exit
    s_waitcnt vmcnt(6)
    v_rcp_f32 v14, v14
    v_mfma_f32_4x4x4_16b_bf16 v[16:19], v[34:35], v[204:205], 0 cbsz:4 abid:10
    v_exp_f32 v13, v177
    v_mfma_f32_4x4x4_16b_bf16 v[20:23], v[34:35], v[206:207], 0 cbsz:4 abid:10
    v_exp_f32 v12, v176
    v_readlane_b32 s38, v8, 11
    v_rcp_f32 v15, v15
    v_pk_add_f32 v[12:13], v[12:13], 1.0 op_sel_hi:[1,0]
    v_pk_mul_f32 v[190:191], v[190:191], v[14:15]
    s_and_b32 s69, s38, 4294966784
    s_set_gpr_idx_on s62, gpr_idx(SRC2,DST)
    buffer_load_dwordx4 v[200:203], v1, s[4:7], s68 offen
    v_pk_fma_f32 v[84:85], v[174:175], v[16:17], v[84:85] op_sel_hi:[0,1,1]
    v_pk_fma_f32 v[86:87], v[174:175], v[18:19], v[86:87] op_sel_hi:[0,1,1]
    v_pk_fma_f32 v[88:89], v[190:191], v[20:21], v[88:89] op_sel_hi:[0,1,1]
    v_pk_fma_f32 v[90:91], v[190:191], v[22:23], v[90:91] op_sel_hi:[0,1,1]
    s_set_gpr_idx_off
    s_waitcnt vmcnt(6)
    v_mfma_f32_4x4x4_16b_bf16 v[20:23], v[34:35], v[210:211], 0 cbsz:4 abid:11
    v_mfma_f32_4x4x4_16b_bf16 v[16:19], v[34:35], v[208:209], 0 cbsz:4 abid:11
    v_rcp_f32 v13, v13
    v_smfmac_f32_32x32x32_bf16 v[148:163], v[24:27], v[44:51], v28
    v_exp_f32 v14, v192
    v_exp_f32 v15, v193
    v_readlane_b32 s39, v8, 12
    v_rcp_f32 v12, v12
    v_pk_add_f32 v[14:15], v[14:15], 1.0 op_sel_hi:[1,0]
    v_pk_mul_f32 v[176:177], v[176:177], v[12:13]
    s_and_b32 s68, s39, 4294966784
    s_set_gpr_idx_on s63, gpr_idx(SRC2,DST)
    buffer_load_dwordx4 v[204:207], v1, s[4:7], s69 offen
    v_pk_fma_f32 v[84:85], v[174:175], v[16:17], v[84:85] op_sel:[1,0,0]
    v_pk_fma_f32 v[86:87], v[174:175], v[18:19], v[86:87] op_sel:[1,0,0]
    v_pk_fma_f32 v[88:89], v[190:191], v[20:21], v[88:89] op_sel:[1,0,0]
    v_pk_fma_f32 v[90:91], v[190:191], v[22:23], v[90:91] op_sel:[1,0,0]
    s_set_gpr_idx_off
    s_cbranch_scc0 L_exit
    s_setprio 0
    s_waitcnt vmcnt(6)
    v_rcp_f32 v14, v14
    v_mfma_f32_4x4x4_16b_bf16 v[16:19], v[34:35], v[212:213], 0 cbsz:4 abid:12
    v_exp_f32 v13, v179
    v_mfma_f32_4x4x4_16b_bf16 v[20:23], v[34:35], v[214:215], 0 cbsz:4 abid:12
    v_exp_f32 v12, v178
    v_readlane_b32 s40, v8, 13
    v_rcp_f32 v15, v15
    v_pk_add_f32 v[12:13], v[12:13], 1.0 op_sel_hi:[1,0]
    v_pk_mul_f32 v[192:193], v[192:193], v[14:15]
    s_and_b32 s69, s40, 4294966784
    s_set_gpr_idx_on s64, gpr_idx(SRC2,DST)
    buffer_load_dwordx4 v[208:211], v1, s[4:7], s68 offen
    v_pk_fma_f32 v[84:85], v[176:177], v[16:17], v[84:85] op_sel_hi:[0,1,1]
    v_pk_fma_f32 v[86:87], v[176:177], v[18:19], v[86:87] op_sel_hi:[0,1,1]
    v_pk_fma_f32 v[88:89], v[192:193], v[20:21], v[88:89] op_sel_hi:[0,1,1]
    v_pk_fma_f32 v[90:91], v[192:193], v[22:23], v[90:91] op_sel_hi:[0,1,1]
    s_set_gpr_idx_off
    s_waitcnt vmcnt(6)
    v_rcp_f32 v12, v12
    v_mfma_f32_4x4x4_16b_bf16 v[16:19], v[34:35], v[216:217], 0 cbsz:4 abid:13
    v_exp_f32 v15, v195
    v_mfma_f32_4x4x4_16b_bf16 v[20:23], v[34:35], v[218:219], 0 cbsz:4 abid:13
    v_exp_f32 v14, v194
    v_readlane_b32 s41, v8, 14
    v_rcp_f32 v13, v13
    v_pk_add_f32 v[14:15], v[14:15], 1.0 op_sel_hi:[1,0]
    v_pk_mul_f32 v[178:179], v[178:179], v[12:13]
    s_and_b32 s68, s41, 4294966784
    s_set_gpr_idx_on s65, gpr_idx(SRC2,DST)
    buffer_load_dwordx4 v[212:215], v1, s[4:7], s69 offen
    v_pk_fma_f32 v[84:85], v[176:177], v[16:17], v[84:85] op_sel:[1,0,0]
    v_pk_fma_f32 v[86:87], v[176:177], v[18:19], v[86:87] op_sel:[1,0,0]
    v_pk_fma_f32 v[88:89], v[192:193], v[20:21], v[88:89] op_sel:[1,0,0]
    v_pk_fma_f32 v[90:91], v[192:193], v[22:23], v[90:91] op_sel:[1,0,0]
    s_set_gpr_idx_off
    s_cbranch_scc0 L_exit
    s_waitcnt vmcnt(6)
    v_rcp_f32 v14, v14
    v_mfma_f32_4x4x4_16b_bf16 v[16:19], v[34:35], v[220:221], 0 cbsz:4 abid:14
    v_exp_f32 v13, v133
    v_mfma_f32_4x4x4_16b_bf16 v[20:23], v[34:35], v[222:223], 0 cbsz:4 abid:14
    v_exp_f32 v12, v132
    v_readlane_b32 s42, v8, 15
    v_rcp_f32 v15, v15
    v_pk_add_f32 v[12:13], v[12:13], 1.0 op_sel_hi:[1,0]
    v_pk_mul_f32 v[194:195], v[194:195], v[14:15]
    s_and_b32 s69, s42, 4294966784
    s_set_gpr_idx_on s66, gpr_idx(SRC2,DST)
    buffer_load_dwordx4 v[216:219], v1, s[4:7], s68 offen
    v_pk_fma_f32 v[84:85], v[178:179], v[16:17], v[84:85] op_sel_hi:[0,1,1]
    v_pk_fma_f32 v[86:87], v[178:179], v[18:19], v[86:87] op_sel_hi:[0,1,1]
    v_pk_fma_f32 v[88:89], v[194:195], v[20:21], v[88:89] op_sel_hi:[0,1,1]
    v_pk_fma_f32 v[90:91], v[194:195], v[22:23], v[90:91] op_sel_hi:[0,1,1]
    s_set_gpr_idx_off
    s_waitcnt vmcnt(6)
    v_rcp_f32 v12, v12
    v_mfma_f32_4x4x4_16b_bf16 v[16:19], v[34:35], v[224:225], 0 cbsz:4 abid:15
    v_exp_f32 v15, v149
    v_mfma_f32_4x4x4_16b_bf16 v[20:23], v[34:35], v[226:227], 0 cbsz:4 abid:15
    v_exp_f32 v14, v148
    v_readlane_b32 s43, v7, 0
    v_rcp_f32 v13, v13
    v_pk_add_f32 v[14:15], v[14:15], 1.0 op_sel_hi:[1,0]
    v_pk_mul_f32 v[132:133], v[132:133], v[12:13]
    s_and_b32 s68, s43, 4294966784
    s_set_gpr_idx_on s67, gpr_idx(SRC2,DST)
    buffer_load_dwordx4 v[220:223], v1, s[4:7], s69 offen
    v_pk_fma_f32 v[84:85], v[178:179], v[16:17], v[84:85] op_sel:[1,0,0]
    v_pk_fma_f32 v[86:87], v[178:179], v[18:19], v[86:87] op_sel:[1,0,0]
    v_pk_fma_f32 v[88:89], v[194:195], v[20:21], v[88:89] op_sel:[1,0,0]
    v_pk_fma_f32 v[90:91], v[194:195], v[22:23], v[90:91] op_sel:[1,0,0]
    s_set_gpr_idx_off
    s_cbranch_scc0 L_exit
    v_add_u32 v4, 256, v4
    v_add_u32 v5, 256, v5
    v_add_u32 v6, 256, v6
    s_branch L_loop
L_giveup:
    s_mov_b64 exec, -1
    v_mov_b64 v[164:165], 0
    v_mov_b64 v[166:167], 0
    v_add_u32 v168, 161536, v1
    ds_write_b128 v168, v[164:167]
    v_mov_b32 v172, 0x00300000
    v_mov_b32 v173, 0x00300000
    v_mov_b32 v174, 0x00300000
    v_mov_b32 v175, 0x00300000
    ds_write_b128 v1, v[172:175] offset:20224
    ds_write_b128 v1, v[172:175] offset:21248
    ds_write_b128 v1, v[172:175] offset:22272
    ds_write_b128 v1, v[172:175] offset:23296
    ds_write_b128 v1, v[172:175] offset:24320
    ds_write_b128 v1, v[172:175] offset:25344
    s_branch L_fok
L_more:
    s_waitcnt vmcnt(0) lgkmcnt(0)
    s_barrier
    v_lshlrev_b32 v188, 4, v0
    v_add_u32 v189, 8192, v188
    v_add_u32 v190, 16384, v188
    v_add_u32 v191, 24576, v188
    v_add_u32 v192, 32768, v188
    v_add_u32 v193, 40960, v188
    v_lshlrev_b32 v194, 2, v0
    v_lshlrev_b32 v14, 3, v0
    v_mov_b32 v16, 0
    v_mov_b32 v17, 0
    v_mov_b32 v15, 0x00300000
    ds_write_b64 v14, v[16:17] offset:16128
    ds_write_b32 v194, v15 offset:20224
    ds_write_b32 v194, v15 offset:22272
    ds_write_b32 v194, v15 offset:24320
    v_lshrrev_b32 v195, 1, v0
    v_lshlrev_b32 v195, 2, v195
    s_branch L_round
L_exit:
    s_add_u32 s28, s28, 1536
    s_cmp_lt_u32 s28, s25
    s_cbranch_scc1 L_more
    s_mov_b32 s68, 0xbf317218
    s_mov_b32 s69, s68
    s_and_b32 s3, s96, 0xffff
    s_mul_i32 m0, s3, 288
    v_pk_mul_f32 v[84:85], v[84:85], s[68:69]
    v_pk_mul_f32 v[86:87], v[86:87], s[68:69]
    v_pk_mul_f32 v[88:89], v[88:89], s[68:69]
    v_pk_mul_f32 v[90:91], v[90:91], s[68:69]
    v_cvt_pk_bf16_f32 v84, v84, v88
    v_cvt_pk_bf16_f32 v85, v85, v89
    v_cvt_pk_bf16_f32 v86, v86, v90
    v_cvt_pk_bf16_f32 v87, v87, v91
    ds_write_addtid_b32 v84 offset:16128
    ds_write_addtid_b32 v85 offset:16416
    ds_write_addtid_b32 v86 offset:16704
    ds_write_addtid_b32 v87 offset:16992
    s_and_b32 s3, s97, 0xffff
    s_mul_i32 m0, s3, 288
    v_pk_mul_f32 v[92:93], v[92:93], s[68:69]
    v_pk_mul_f32 v[94:95], v[94:95], s[68:69]
    v_pk_mul_f32 v[96:97], v[96:97], s[68:69]
    v_pk_mul_f32 v[98:99], v[98:99], s[68:69]
    v_cvt_pk_bf16_f32 v92, v92, v96
    v_cvt_pk_bf16_f32 v93, v93, v97
    v_cvt_pk_bf16_f32 v94, v94, v98
    v_cvt_pk_bf16_f32 v95, v95, v99
    ds_write_addtid_b32 v92 offset:16128
    ds_write_addtid_b32 v93 offset:16416
    ds_write_addtid_b32 v94 offset:16704
    ds_write_addtid_b32 v95 offset:16992
    s_and_b32 s3, s98, 0xffff
    s_mul_i32 m0, s3, 288
    v_pk_mul_f32 v[100:101], v[100:101], s[68:69]
    v_pk_mul_f32 v[102:103], v[102:103], s[68:69]
    v_pk_mul_f32 v[104:105], v[104:105], s[68:69]
    v_pk_mul_f32 v[106:107], v[106:107], s[68:69]
    v_cvt_pk_bf16_f32 v100, v100, v104
    v_cvt_pk_bf16_f32 v101, v101, v105
    v_cvt_pk_bf16_f32 v102, v102, v106
    v_cvt_pk_bf16_f32 v103, v103, v107
    ds_write_addtid_b32 v100 offset:16128
    ds_write_addtid_b32 v101 offset:16416
    ds_write_addtid_b32 v102 offset:16704
    ds_write_addtid_b32 v103 offset:16992
    s_and_b32 s3, s99, 0xffff
    s_mul_i32 m0, s3, 288
    v_pk_mul_f32 v[108:109], v[108:109], s[68:69]
    v_pk_mul_f32 v[110:111], v[110:111], s[68:69]
    v_pk_mul_f32 v[112:113], v[112:113], s[68:69]
    v_pk_mul_f32 v[114:115], v[114:115], s[68:69]
    v_cvt_pk_bf16_f32 v108, v108, v112
    v_cvt_pk_bf16_f32 v109, v109, v113
    v_cvt_pk_bf16_f32 v110, v110, v114
    v_cvt_pk_bf16_f32 v111, v111, v115
    ds_write_addtid_b32 v108 offset:16128
    ds_write_addtid_b32 v109 offset:16416
    ds_write_addtid_b32 v110 offset:16704
    ds_write_addtid_b32 v111 offset:16992
    s_and_b32 s3, s100, 0xffff
    s_mul_i32 m0, s3, 288
    v_pk_mul_f32 v[116:117], v[116:117], s[68:69]
    v_pk_mul_f32 v[118:119], v[118:119], s[68:69]
    v_pk_mul_f32 v[120:121], v[120:121], s[68:69]
    v_pk_mul_f32 v[122:123], v[122:123], s[68:69]
    v_cvt_pk_bf16_f32 v116, v116, v120
    v_cvt_pk_bf16_f32 v117, v117, v121
    v_cvt_pk_bf16_f32 v118, v118, v122
    v_cvt_pk_bf16_f32 v119, v119, v123
    ds_write_addtid_b32 v116 offset:16128
    ds_write_addtid_b32 v117 offset:16416
    ds_write_addtid_b32 v118 offset:16704
    ds_write_addtid_b32 v119 offset:16992
    s_waitcnt lgkmcnt(0)
    s_barrier
    ds_read_b128 v[84:87], v30 offset:16128
    ds_read_b128 v[88:91], v30 offset:16192
    ds_read_b128 v[92:95], v30 offset:16256
    ds_read_b128 v[96:99], v30 offset:16320
    ds_read_b128 v[100:103], v30 offset:20736
    ds_read_b128 v[104:107], v30 offset:20800
    ds_read_b128 v[108:111], v30 offset:20864
    ds_read_b128 v[112:115], v30 offset:20928
    s_waitcnt lgkmcnt(7)
    v_mfma_f32_16x16x32_bf16 v[116:119], v[84:87], v[52:55], 0
    v_mfma_f32_16x16x32_bf16 v[120:123], v[84:87], v[56:59], 0
    s_waitcnt lgkmcnt(6)
    v_mfma_f32_16x16x32_bf16 v[116:119], v[88:91], v[60:63], v[116:119]
    v_mfma_f32_16x16x32_bf16 v[120:123], v[88:91], v[64:67], v[120:123]
    s_waitcnt lgkmcnt(5)
    v_mfma_f32_16x16x32_bf16 v[116:119], v[92:95], v[68:71], v[116:119]
    v_mfma_f32_16x16x32_bf16 v[120:123], v[92:95], v[72:75], v[120:123]
    s_waitcnt lgkmcnt(4)
    v_mfma_f32_16x16x32_bf16 v[116:119], v[96:99], v[76:79], v[116:119]
    v_mfma_f32_16x16x32_bf16 v[120:123], v[96:99], v[80:83], v[120:123]
    ds_read_b128 v[84:87], v30 offset:25344
    ds_read_b128 v[88:91], v30 offset:25408
    ds_read_b128 v[92:95], v30 offset:25472
    ds_read_b128 v[96:99], v30 offset:25536
    s_waitcnt lgkmcnt(7)
    v_mfma_f32_16x16x32_bf16 v[124:127], v[100:103], v[52:55], 0
    v_mfma_f32_16x16x32_bf16 v[128:131], v[100:103], v[56:59], 0
    s_waitcnt lgkmcnt(6)
    v_mfma_f32_16x16x32_bf16 v[124:127], v[104:107], v[60:63], v[124:127]
    v_cvt_pk_bf16_f32 v44, v116, v117
    v_cvt_pk_bf16_f32 v45, v118, v119
    v_mfma_f32_16x16x32_bf16 v[128:131], v[104:107], v[64:67], v[128:131]
    v_cvt_pk_bf16_f32 v46, v120, v121
    v_cvt_pk_bf16_f32 v47, v122, v123
    s_waitcnt lgkmcnt(5)
    v_mfma_f32_16x16x32_bf16 v[124:127], v[108:111], v[68:71], v[124:127]
    s_mov_b32 s3, 0
    buffer_store_dwordx4 v[44:47], v31, s[16:19], s3 offen sc0 sc1
    v_mfma_f32_16x16x32_bf16 v[128:131], v[108:111], v[72:75], v[128:131]
    s_waitcnt lgkmcnt(4)
    v_mfma_f32_16x16x32_bf16 v[124:127], v[112:115], v[76:79], v[124:127]
    v_mfma_f32_16x16x32_bf16 v[128:131], v[112:115], v[80:83], v[128:131]
    ds_read_b128 v[100:103], v30 offset:29952
    ds_read_b128 v[104:107], v30 offset:30016
    ds_read_b128 v[108:111], v30 offset:30080
    ds_read_b128 v[112:115], v30 offset:30144
    s_waitcnt lgkmcnt(7)
    v_mfma_f32_16x16x32_bf16 v[116:119], v[84:87], v[52:55], 0
    v_mfma_f32_16x16x32_bf16 v[120:123], v[84:87], v[56:59], 0
    s_waitcnt lgkmcnt(6)
    v_mfma_f32_16x16x32_bf16 v[116:119], v[88:91], v[60:63], v[116:119]
    v_cvt_pk_bf16_f32 v48, v124, v125
    v_cvt_pk_bf16_f32 v49, v126, v127
    v_mfma_f32_16x16x32_bf16 v[120:123], v[88:91], v[64:67], v[120:123]
    v_cvt_pk_bf16_f32 v50, v128, v129
    v_cvt_pk_bf16_f32 v51, v130, v131
    s_waitcnt lgkmcnt(5)
    v_mfma_f32_16x16x32_bf16 v[116:119], v[92:95], v[68:71], v[116:119]
    s_mov_b32 s3, 1048576
    buffer_store_dwordx4 v[48:51], v31, s[16:19], s3 offen sc0 sc1
    v_mfma_f32_16x16x32_bf16 v[120:123], v[92:95], v[72:75], v[120:123]
    s_waitcnt lgkmcnt(4)
    v_mfma_f32_16x16x32_bf16 v[116:119], v[96:99], v[76:79], v[116:119]
    v_mfma_f32_16x16x32_bf16 v[120:123], v[96:99], v[80:83], v[120:123]
    ds_read_b128 v[84:87], v30 offset:34560
    ds_read_b128 v[88:91], v30 offset:34624
    ds_read_b128 v[92:95], v30 offset:34688
    ds_read_b128 v[96:99], v30 offset:34752
    s_waitcnt lgkmcnt(7)
    v_mfma_f32_16x16x32_bf16 v[124:127], v[100:103], v[52:55], 0
    v_mfma_f32_16x16x32_bf16 v[128:131], v[100:103], v[56:59], 0
    s_waitcnt lgkmcnt(6)
    v_mfma_f32_16x16x32_bf16 v[124:127], v[104:107], v[60:63], v[124:127]
    v_cvt_pk_bf16_f32 v44, v116, v117
    v_cvt_pk_bf16_f32 v45, v118, v119
    v_mfma_f32_16x16x32_bf16 v[128:131], v[104:107], v[64:67], v[128:131]
    v_cvt_pk_bf16_f32 v46, v120, v121
    v_cvt_pk_bf16_f32 v47, v122, v123
    s_waitcnt lgkmcnt(5)
    v_mfma_f32_16x16x32_bf16 v[124:127], v[108:111], v[68:71], v[124:127]
    s_mov_b32 s3, 2097152
    buffer_store_dwordx4 v[44:47], v31, s[16:19], s3 offen sc0 sc1
    v_mfma_f32_16x16x32_bf16 v[128:131], v[108:111], v[72:75], v[128:131]
    s_waitcnt lgkmcnt(4)
    v_mfma_f32_16x16x32_bf16 v[124:127], v[112:115], v[76:79], v[124:127]
    v_mfma_f32_16x16x32_bf16 v[128:131], v[112:115], v[80:83], v[128:131]
    s_nop 3
    s_waitcnt lgkmcnt(3)
    v_mfma_f32_16x16x32_bf16 v[116:119], v[84:87], v[52:55], 0
    v_mfma_f32_16x16x32_bf16 v[120:123], v[84:87], v[56:59], 0
    s_waitcnt lgkmcnt(2)
    v_mfma_f32_16x16x32_bf16 v[116:119], v[88:91], v[60:63], v[116:119]
    v_cvt_pk_bf16_f32 v48, v124, v125
    v_cvt_pk_bf16_f32 v49, v126, v127
    v_mfma_f32_16x16x32_bf16 v[120:123], v[88:91], v[64:67], v[120:123]
    v_cvt_pk_bf16_f32 v50, v128, v129
    v_cvt_pk_bf16_f32 v51, v130, v131
    s_waitcnt lgkmcnt(1)
    v_mfma_f32_16x16x32_bf16 v[116:119], v[92:95], v[68:71], v[116:119]
    s_mov_b32 s3, 3145728
    buffer_store_dwordx4 v[48:51], v31, s[16:19], s3 offen sc0 sc1
    v_mfma_f32_16x16x32_bf16 v[120:123], v[92:95], v[72:75], v[120:123]
    s_waitcnt lgkmcnt(0)
    v_mfma_f32_16x16x32_bf16 v[116:119], v[96:99], v[76:79], v[116:119]
    v_mfma_f32_16x16x32_bf16 v[120:123], v[96:99], v[80:83], v[120:123]
    s_or_b32 s31, s2, s24
    s_cbranch_scc1 L_noep
    v_lshlrev_b32 v36, 2, v11
    v_mov_b32 v37, s26
    global_store_dword v36, v37, s[22:23] offset:0 sc0 sc1
L_noep:
    s_nop 5
    v_cvt_pk_bf16_f32 v44, v116, v117
    v_cvt_pk_bf16_f32 v45, v118, v119
    v_cvt_pk_bf16_f32 v46, v120, v121
    v_cvt_pk_bf16_f32 v47, v122, v123
    s_mov_b32 s3, 4194304
    buffer_store_dwordx4 v[44:47], v31, s[16:19], s3 offen sc0 sc1
L_end:
    s_endpgm
.section .rodata,"a"
.p2align 6
.amdhsa_kernel standalone__tensor_product_equiv_tfn__graph_kernel
  .amdhsa_next_free_vgpr 230
  .amdhsa_next_free_sgpr 102
  .amdhsa_accum_offset 232
  .amdhsa_group_segment_fixed_size 0
  .amdhsa_kernarg_size 88
  .amdhsa_user_sgpr_count 2
  .amdhsa_user_sgpr_kernarg_segment_ptr 1
  .amdhsa_system_sgpr_workgroup_id_x 1
  .amdhsa_float_denorm_mode_32 3
.end_amdhsa_kernel
```

```asm
; @launch grid=(256,1,1) block=(512,1,1) lds=163600
.amdgcn_target "amdgcn-amd-amdhsa--gfx950"
.text
.globl standalone__tensor_product_equiv_tfn__graph_kernel
.p2align 8
.type standalone__tensor_product_equiv_tfn__graph_kernel,@function
standalone__tensor_product_equiv_tfn__graph_kernel:
    s_load_dwordx16 s[4:19], s[0:1], 0
    s_load_dwordx2 s[22:23], s[0:1], 80
    s_load_dwordx2 s[20:21], s[0:1], 64
    s_cmp_ge_u32 s2, 256
    s_cbranch_scc1 L_end
    v_mul_u32_u24 v172, 3, v0
    s_mul_i32 s3, s2, 1250
    v_min_u32 v172, 1247, v172
    v_add_lshl_u32 v173, v172, s3, 2
    v_lshrrev_b32 v12, 6, v0
    v_and_b32 v13, 255, v0
    v_lshlrev_b32 v13, 2, v13
    v_mov_b32 v16, 0
    v_readfirstlane_b32 s24, v12
    ds_write_b32 v13, v16 offset:0
    v_lshlrev_b32 v174, 1, v173
    s_waitcnt lgkmcnt(0)
    global_load_dwordx3 v[132:134], v173, s[8:9]
    s_load_dword s26, s[22:23], 0
    s_barrier
    global_load_dwordx3 v[136:138], v173, s[6:7]
    global_load_dwordx4 v[140:143], v174, s[10:11]
    global_load_dwordx2 v[144:145], v174, s[10:11] offset:16
    v_lshlrev_b32 v188, 4, v0
    v_and_b32 v11, 63, v0
    s_lshl_b32 s30, s24, 10
    s_lshl_b32 s3, s3, 5
    s_add_u32 s12, s12, s3
    s_addc_u32 s13, s13, 0
    v_add_u32 v189, 8192, v188
    v_add_u32 v190, 16384, v188
    v_add_u32 v191, 24576, v188
    v_add_u32 v192, 32768, v188
    v_add_u32 v193, 40960, v188
    v_min_u32 v175, 39984, v192
    v_lshlrev_b32 v1, 4, v11
    s_barrier
    s_add_u32 m0, s30, 112384
    s_nop 0
    global_load_lds_dwordx4 v188, s[12:13]
    s_add_u32 m0, s30, 120576
    s_nop 0
    global_load_lds_dwordx4 v189, s[12:13]
    s_cmp_eq_u32 s24, 7
    s_cbranch_scc0 L_nocpf
    s_cmp_lt_u32 s2, 8
    s_cbranch_scc0 L_nocpf
    s_getpc_b64 s[68:69]
L_pc:
    v_lshlrev_b32 v18, 7, v11
    v_mov_b32 v19, 0
    v_lshl_add_u64 v[20:21], v[18:19], 0, s[68:69]
    global_load_dword v204, v[20:21], off
    v_min_u32 v18, L_end-L_pc-8192, v18
    v_add_u32 v18, 8192, v18
    v_lshl_add_u64 v[20:21], v[18:19], 0, s[68:69]
    global_load_dword v205, v[20:21], off
L_nocpf:
    v_lshlrev_b32 v194, 2, v0
    v_lshlrev_b32 v14, 3, v0
    v_mov_b32 v16, 0
    v_mov_b32 v17, 0
    v_mov_b32 v15, 0x00300000
    ds_write_b64 v14, v[16:17] offset:16128
    ds_write_b32 v194, v15 offset:20224
    ds_write_b32 v194, v15 offset:22272
    ds_write_b32 v194, v15 offset:24320
    v_lshrrev_b32 v195, 1, v0
    v_lshlrev_b32 v195, 2, v195
    v_cmp_gt_u32 vcc, 416, v0
    s_mov_b64 s[36:37], vcc
    v_cmp_gt_u32 vcc, 417, v0
    s_mov_b64 s[38:39], vcc
    v_mov_b32 v12, 1
    s_movk_i32 s40, 1250
    s_mov_b32 s41, 63232
    s_lshr_b32 s27, s24, 2
    s_mov_b32 s28, 0
    s_waitcnt vmcnt(5)
    s_mov_b64 exec, s[38:39]
    v_and_b32 v153, 7, v133
    v_bfe_u32 v150, v133, 3, 5
    v_lshl_add_u32 v147, v153, 5, v150
    v_lshlrev_b32 v147, 2, v147
    ds_add_rtn_u32 v150, v147, v12 offset:0
    v_and_b32 v154, 7, v134
    v_bfe_u32 v151, v134, 3, 5
    v_lshl_add_u32 v148, v154, 5, v151
    v_lshlrev_b32 v148, 2, v148
    ds_add_rtn_u32 v151, v148, v12 offset:0
    s_mov_b64 exec, s[36:37]
    v_and_b32 v152, 7, v132
    v_bfe_u32 v149, v132, 3, 5
    v_lshl_add_u32 v146, v152, 5, v149
    v_lshlrev_b32 v146, 2, v146
    ds_add_rtn_u32 v149, v146, v12 offset:0
    s_mov_b64 exec, -1
    s_add_u32 m0, s30, 128768
    s_nop 0
    global_load_lds_dwordx4 v190, s[12:13]
    s_add_u32 m0, s30, 136960
    s_nop 0
    global_load_lds_dwordx4 v191, s[12:13]
    s_add_u32 m0, s30, 145152
    s_nop 0
    global_load_lds_dwordx4 v175, s[12:13]
    s_waitcnt lgkmcnt(0)
    s_barrier
    ds_read_b128 v[164:167], v1 offset:0
    s_mul_i32 s3, s2, 1280
    s_add_u32 s26, s26, 1
    s_waitcnt lgkmcnt(0)
    v_add_u32 v180, v164, v165
    v_add3_u32 v180, v180, v166, v167
    v_mov_b32 v181, v180
    v_lshrrev_b32 v132, 8, v132
    v_lshlrev_b32 v132, 2, v132
    v_add_u32_dpp v181, v181, v181 row_shr:1 row_mask:0xf bank_mask:0xf
    v_add_lshl_u32 v177, v172, 0, 5
    v_lshrrev_b32 v133, 8, v133
    v_add_u32_dpp v181, v181, v181 row_shr:2 row_mask:0xf bank_mask:0xf
    v_lshlrev_b32 v133, 2, v133
    v_add_lshl_u32 v178, v172, 1, 5
    v_add_u32_dpp v181, v181, v181 row_shr:4 row_mask:0xf bank_mask:0xf
    v_lshrrev_b32 v134, 8, v134
    v_lshlrev_b32 v134, 2, v134
    v_add_u32_dpp v181, v181, v181 row_shr:8 row_mask:0xf bank_mask:0xf
    v_add_lshl_u32 v179, v172, 2, 5
    s_lshl_b32 s31, s2, 11
    v_add_u32_dpp v181, v181, v181 row_bcast:15 row_mask:0xa bank_mask:0xf
    s_add_u32 s31, s31, 4096
    v_add_u32 v212, s31, v1
    v_add_u32_dpp v181, v181, v181 row_bcast:31 row_mask:0xc bank_mask:0xf
    v_sub_u32 v168, v181, v180
    v_add_u32 v169, v168, v164
    v_add_u32 v170, v169, v165
    v_add_u32 v171, v170, v166
    ds_write_b128 v1, v[168:171] offset:1024
    s_mov_b64 exec, s[38:39]
    ds_read_b32 v147, v147 offset:1024
    ds_read_b32 v148, v148 offset:1024
    s_mov_b64 exec, s[36:37]
    ds_read_b32 v146, v146 offset:1024
    s_mov_b64 exec, -1
    s_waitcnt vmcnt(5)
    v_mad_u32_u24 v152, v152, s40, v136
    v_lshl_add_u32 v132, v136, 16, v132
    v_subrev_u32 v156, 10000, v152
    v_min_u32 v152, v152, v156
    v_add_u32 v152, 350, v152
    v_mul_u32_u24 v152, 151, v152
    v_lshrrev_b32 v152, 17, v152
    v_lshl_add_u32 v152, v152, 8, v132
    v_mad_u32_u24 v153, v153, s40, v137
    v_lshl_add_u32 v133, v137, 16, v133
    v_subrev_u32 v157, 10000, v153
    v_min_u32 v153, v153, v157
    v_add_u32 v153, 350, v153
    v_mul_u32_u24 v153, 151, v153
    v_lshrrev_b32 v153, 17, v153
    v_lshl_add_u32 v153, v153, 8, v133
    v_mad_u32_u24 v154, v154, s40, v138
    v_lshl_add_u32 v134, v138, 16, v134
    v_subrev_u32 v158, 10000, v154
    v_min_u32 v154, v154, v158
    v_add_u32 v154, 350, v154
    v_mul_u32_u24 v154, 151, v154
    v_lshrrev_b32 v154, 17, v154
    v_lshl_add_u32 v154, v154, 8, v134
    s_mov_b64 exec, s[38:39]
    s_waitcnt lgkmcnt(0)
    v_add_lshl_u32 v147, v147, v150, 1
    v_mad_u32_u24 v183, v147, 6, s41
    ds_write_b16 v147, v178 offset:2048
    ds_write2_b32 v183, v142, v143 offset1:1
    ds_write_b32 v183, v153 offset:8
    v_add_lshl_u32 v148, v148, v151, 1
    v_mad_u32_u24 v184, v148, 6, s41
    ds_write_b16 v148, v179 offset:2048
    ds_write2_b32 v184, v144, v145 offset1:1
    ds_write_b32 v184, v154 offset:8
    s_mov_b64 exec, s[36:37]
    v_add_lshl_u32 v146, v146, v149, 1
    v_mad_u32_u24 v182, v146, 6, s41
    ds_write_b16 v146, v177 offset:2048
    ds_write2_b32 v182, v140, v141 offset1:1
    ds_write_b32 v182, v152 offset:8
    s_mov_b64 exec, -1
    s_add_u32 m0, s30, 26368
    s_nop 0
    global_load_lds_dwordx4 v188, s[18:19]
    s_add_u32 m0, s30, 34560
    s_nop 0
    global_load_lds_dwordx4 v189, s[18:19]
    s_add_u32 m0, s30, 42752
    s_nop 0
    global_load_lds_dwordx4 v190, s[18:19]
    s_add_u32 m0, s30, 50944
    s_nop 0
    global_load_lds_dwordx4 v191, s[18:19]
    s_add_u32 s70, s30, 59136
    v_min_u32 v185, 112, v1
    s_cmp_lt_u32 s24, 4
    s_cselect_b64 vcc, -1, 0
    s_cselect_b32 m0, s70, 162560
    s_cselect_b64 s[68:69], s[14:15], s[16:17]
    v_cndmask_b32 v185, v185, v188, vcc
    global_load_lds_dwordx4 v185, s[68:69]
    s_mul_i32 s31, s3, 12
    s_add_u32 s31, s31, 1048576
    s_add_u32 s48, s22, s31
    s_addc_u32 s49, s23, 0
    s_mov_b32 s50, 15104
    s_mov_b32 s51, 0x00020000
    s_lshl_b32 s3, s3, 5
    s_add_u32 s31, s3, 8388608
    s_add_u32 s52, s22, s31
    s_addc_u32 s53, s23, 0
    s_mov_b32 s54, 40064
    s_mov_b32 s55, 0x00020000
    v_and_b32 v172, -2, v0
    v_and_b32 v173, 16, v188
    v_add_u32 v173, 112384, v173
    s_waitcnt lgkmcnt(0)
    s_barrier
    ds_read_b128 v[132:135], v188 offset:63232
    ds_read_b128 v[136:139], v189 offset:63232
    ds_read_u16 v174, v172 offset:2048
    ds_read_u16 v175, v172 offset:2560
    ds_read_u16 v176, v172 offset:3072
    ds_read_u16 v177, v172 offset:3584
    ds_read_u16 v178, v172 offset:4096
    s_cmp_eq_u32 s24, 7
    s_cbranch_scc0 L_norow
    s_mul_i32 s31, s2, 1280
    v_add_u32 v168, s31, v168
    v_lshl_add_u32 v196, v164, 19, v168
    v_mov_b32 v197, s26
    v_add_u32 v169, s31, v169
    v_lshl_add_u32 v198, v165, 19, v169
    v_mov_b32 v199, s26
    v_add_u32 v170, s31, v170
    v_lshl_add_u32 v200, v166, 19, v170
    v_mov_b32 v201, s26
    v_add_u32 v171, s31, v171
    v_lshl_add_u32 v202, v167, 19, v171
    v_mov_b32 v203, s26
    global_store_dwordx4 v212, v[196:199], s[22:23] sc0 sc1
    global_store_dwordx4 v212, v[200:203], s[22:23] offset:1024 sc0 sc1
L_norow:
    s_waitcnt lgkmcnt(6)
    buffer_store_dwordx4 v[132:135], v188, s[48:51], 0 offen sc0 sc1
    s_waitcnt lgkmcnt(5)
    buffer_store_dwordx4 v[136:139], v189, s[48:51], 0 offen sc0 sc1
    s_waitcnt lgkmcnt(0)
    v_add_u32 v174, v174, v173
    v_add_u32 v175, v175, v173
    v_add_u32 v176, v176, v173
    v_add_u32 v177, v177, v173
    v_min_u32 v178, 39968, v178
    v_and_b32 v178, -16, v178
    v_add_u32 v178, v178, v173
    v_mov_b64 v[84:85], 0
    v_mov_b64 v[86:87], 0
    v_mov_b64 v[88:89], 0
    v_mov_b64 v[90:91], 0
    v_mov_b64 v[92:93], 0
    v_mov_b64 v[94:95], 0
    v_mov_b64 v[96:97], 0
    v_mov_b64 v[98:99], 0
    v_mov_b64 v[100:101], 0
    v_mov_b64 v[102:103], 0
    v_mov_b64 v[104:105], 0
    v_mov_b64 v[106:107], 0
    v_mov_b64 v[108:109], 0
    v_mov_b64 v[110:111], 0
    v_mov_b64 v[112:113], 0
    v_mov_b64 v[114:115], 0
    v_mov_b64 v[116:117], 0
    v_mov_b64 v[118:119], 0
    v_mov_b64 v[120:121], 0
    v_mov_b64 v[122:123], 0
    v_mov_b64 v[124:125], 0
    v_mov_b64 v[126:127], 0
    v_mov_b64 v[128:129], 0
    v_mov_b64 v[130:131], 0
    v_bfe_u32 v28, v11, 2, 1
    v_mul_u32_u24 v28, 0xaaaa, v28
    v_add_u32 v28, 0x4444, v28
    v_mov_b32 v29, 163584
    ds_write_b128 v29, v[84:87]
    v_lshrrev_b32 v2, 5, v11
    v_lshlrev_b32 v2, 4, v2
    v_and_b32 v3, 3, v11
    v_lshlrev_b32 v3, 3, v3
    v_add_u32 v3, 112384, v3
    s_sub_u32 s4, s4, 512
    s_subb_u32 s5, s5, 0
    s_mov_b32 s6, 10240512
    s_mov_b32 s7, 0x00020000
    s_add_u32 s8, s22, 1048576
    s_addc_u32 s9, s23, 0
    s_mov_b32 s10, 3932160
    s_mov_b32 s11, 0x00020000
    s_mov_b32 s101, 0
    s_cmp_lt_u32 s2, 16
    s_cbranch_scc1 L_r40
    s_cmp_eq_u32 s24, 0
    s_cselect_b32 s101, 0x245d2388, s101
    s_cmp_eq_u32 s24, 1
    s_cselect_b32 s101, 0x25753343, s101
    s_cmp_eq_u32 s24, 2
    s_cselect_b32 s101, 0x27449100, s101
    s_cmp_eq_u32 s24, 3
    s_cselect_b32 s101, 0x267d5301, s101
    s_cmp_eq_u32 s24, 4
    s_cselect_b32 s101, 0x2179a402, s101
    s_cmp_eq_u32 s24, 5
    s_cselect_b32 s101, 0x227162c6, s101
    s_cmp_eq_u32 s24, 6
    s_cselect_b32 s101, 0x206543c7, s101
    s_cmp_eq_u32 s24, 7
    s_cselect_b32 s101, 0x236d8285, s101
    s_branch L_rd
L_r40:
    s_cmp_eq_u32 s24, 0
    s_cselect_b32 s101, 0x2271a3c1, s101
    s_cmp_eq_u32 s24, 1
    s_cselect_b32 s101, 0x20750307, s101
    s_cmp_eq_u32 s24, 2
    s_cselect_b32 s101, 0x236d5205, s101
    s_cmp_eq_u32 s24, 3
    s_cselect_b32 s101, 0x27797340, s101
    s_cmp_eq_u32 s24, 4
    s_cselect_b32 s101, 0x256112c4, s101
    s_cmp_eq_u32 s24, 5
    s_cselect_b32 s101, 0x26653243, s101
    s_cmp_eq_u32 s24, 6
    s_cselect_b32 s101, 0x217d4382, s101
    s_cmp_eq_u32 s24, 7
    s_cselect_b32 s101, 0x24592286, s101
L_rd:
    s_and_b32 s68, s2, 7
    s_lshl_b32 s68, s68, 7
    s_bfe_u32 s31, s2, 196613
    s_lshl_b32 s31, s31, 4
    s_add_u32 s68, s68, s31
    s_and_b32 s31, s2, 8
    s_add_u32 s68, s68, s31
    s_and_b32 s31, s2, 16
    s_lshl_b32 s31, s31, 6
    s_add_u32 s68, s68, s31
    s_add_u32 s68, s68, 4096
    v_and_b32 v214, 255, v0
    v_lshl_add_u32 v213, v214, 11, s68
    v_mul_u32_u24 v214, 32, v214
    v_add_u32 v214, 589824, v214
    s_mul_i32 s3, s2, 32
    s_add_u32 s3, s3, 589824
    v_lshl_add_u32 v212, v11, 2, s3
    v_mov_b32 v197, s26
    s_waitcnt vmcnt(7)
    s_barrier
    ds_read_b128 v[144:147], v174
    ds_read_b128 v[148:151], v175
    ds_read_b128 v[152:155], v176
    ds_read_b128 v[156:159], v177
    ds_read_b128 v[160:163], v178
    s_waitcnt lgkmcnt(4)
    buffer_store_dwordx4 v[144:147], v188, s[52:55], 0 offen sc0 sc1
    s_waitcnt lgkmcnt(3)
    buffer_store_dwordx4 v[148:151], v189, s[52:55], 0 offen sc0 sc1
    s_waitcnt lgkmcnt(2)
    buffer_store_dwordx4 v[152:155], v190, s[52:55], 0 offen sc0 sc1
    s_waitcnt lgkmcnt(1)
    buffer_store_dwordx4 v[156:159], v191, s[52:55], 0 offen sc0 sc1
    s_waitcnt lgkmcnt(0)
    buffer_store_dwordx4 v[160:163], v192, s[52:55], 0 offen sc0 sc1
    s_add_u32 s12, s22, 8388608
    s_addc_u32 s13, s23, 0
    s_mov_b32 s14, 10485760
    s_mov_b32 s15, 0x00020000
    s_mov_b32 s16, s20
    s_mov_b32 s17, s21
    s_mov_b32 s18, 10240000
    s_mov_b32 s19, 0x00020000
    s_waitcnt vmcnt(0) lgkmcnt(0)
    s_barrier
    s_cmp_eq_u32 s24, 0
    s_cbranch_scc0 L_noflag
    s_mov_b64 exec, 0xff
    global_store_dword v212, v197, s[22:23] sc0 sc1
    s_mov_b64 exec, -1
L_noflag:
    s_barrier
    s_cmp_eq_u32 s27, 0
    s_cbranch_scc0 L_np0
    global_load_dwordx2 v[206:207], v213, s[22:23] sc1
L_np0:
    s_cmp_eq_u32 s27, 0
    s_cbranch_scc1 L_pfa
    s_sub_u32 s3, 0, s2
    s_and_b32 s3, s3, 7
    s_mul_i32 s3, s3, 1280000
    s_lshr_b32 s31, s2, 3
    s_mul_i32 s31, s31, 16640
    s_add_u32 s3, s3, s31
    s_add_u32 s3, s3, 512
    v_and_b32 v208, 255, v0
    v_cmp_gt_u32 vcc, 130, v208
    v_lshlrev_b32 v208, 7, v208
    v_mov_b32 v209, 0x7fffff00
    v_cndmask_b32 v208, v209, v208, vcc
    buffer_load_dword v210, v208, s[4:7], s3 offen
L_pfa:
    v_lshrrev_b32 v12, 5, v11
    v_and_b32 v13, 31, v11
    v_lshlrev_b32 v13, 2, v13
    v_lshl_add_u32 v12, v12, 10, v13
    s_and_b32 s3, s24, 2
    s_lshl_b32 s31, s3, 8
    s_lshl_b32 s68, s27, 11
    s_add_u32 s31, s31, s68
    s_and_b32 s3, s24, 1
    s_lshl_b32 s3, s3, 7
    s_add_u32 s31, s31, s3
    s_and_b32 s3, s24, 3
    v_add_u32 v12, s31, v12
    ds_read_b32 v164, v12 offset:59136
    ds_read_b32 v165, v12 offset:59392
    s_lshl_b32 s3, s3, 2
    s_lshl_b32 s31, s27, 10
    s_add_u32 s3, s3, s31
    v_add_u32 v16, s3, v1
    v_and_b32 v14, 3, v11
    v_bfe_u32 v15, v11, 2, 2
    v_lshlrev_b32 v15, 1, v15
    v_lshl_add_u32 v14, v14, 5, v15
    v_add_u32 v14, 162560, v14
    s_mov_b32 s68, 0xbfb8aa3b
    s_mov_b32 s69, s68
    ds_read_u16 v18, v14 offset:0
    ds_read_u16 v19, v14 offset:8
    ds_read_u16 v20, v14 offset:16
    ds_read_u16 v21, v14 offset:24
    s_waitcnt lgkmcnt(4)
    v_lshlrev_b32 v22, 16, v164
    v_lshlrev_b32 v23, 16, v165
    v_and_b32 v164, 0xffff0000, v164
    v_and_b32 v165, 0xffff0000, v165
    v_pk_mul_f32 v[22:23], v[22:23], s[68:69]
    v_pk_mul_f32 v[164:165], v[164:165], s[68:69]
    v_cvt_pk_bf16_f32 v166, v22, v23
    v_cvt_pk_bf16_f32 v167, v164, v165
    ds_write_b32 v16, v166 offset:8192
    ds_write_b32 v16, v167 offset:10240
    s_waitcnt lgkmcnt(0)
    v_lshl_or_b32 v228, v19, 16, v18
    v_lshl_or_b32 v229, v21, 16, v20
    s_mov_b32 s70, 0x05040100
    s_mov_b32 s71, 0x07060302
    s_and_b32 s3, s24, 3
    s_lshl_b32 s3, s3, 6
    v_lshrrev_b32 v16, 4, v11
    v_and_b32 v17, 15, v11
    v_lshl_add_u32 v17, v17, 2, s3
    v_lshl_add_u32 v16, v16, 11, v17
    ds_read_b32 v168, v16 offset:26368
    ds_read_b32 v169, v16 offset:26624
    ds_read_b32 v170, v16 offset:26880
    ds_read_b32 v171, v16 offset:27136
    ds_read_b32 v172, v16 offset:27392
    ds_read_b32 v173, v16 offset:27648
    ds_read_b32 v174, v16 offset:27904
    ds_read_b32 v175, v16 offset:28160
    s_waitcnt lgkmcnt(7)
    ds_read_b32 v176, v16 offset:34560
    ds_read_b32 v177, v16 offset:34816
    ds_read_b32 v178, v16 offset:35072
    ds_read_b32 v179, v16 offset:35328
    ds_read_b32 v180, v16 offset:35584
    ds_read_b32 v181, v16 offset:35840
    ds_read_b32 v182, v16 offset:36096
    ds_read_b32 v183, v16 offset:36352
    s_waitcnt lgkmcnt(8)
    v_perm_b32 v52, v169, v168, s70
    v_perm_b32 v56, v169, v168, s71
    v_perm_b32 v53, v171, v170, s70
    v_perm_b32 v57, v171, v170, s71
    v_perm_b32 v54, v173, v172, s70
    v_perm_b32 v58, v173, v172, s71
    v_perm_b32 v55, v175, v174, s70
    v_perm_b32 v59, v175, v174, s71
    s_waitcnt lgkmcnt(7)
    ds_read_b32 v168, v16 offset:42752
    ds_read_b32 v169, v16 offset:43008
    ds_read_b32 v170, v16 offset:43264
    ds_read_b32 v171, v16 offset:43520
    ds_read_b32 v172, v16 offset:43776
    ds_read_b32 v173, v16 offset:44032
    ds_read_b32 v174, v16 offset:44288
    ds_read_b32 v175, v16 offset:44544
    s_waitcnt lgkmcnt(8)
    v_perm_b32 v60, v177, v176, s70
    v_perm_b32 v64, v177, v176, s71
    v_perm_b32 v61, v179, v178, s70
    v_perm_b32 v65, v179, v178, s71
    v_perm_b32 v62, v181, v180, s70
    v_perm_b32 v66, v181, v180, s71
    v_perm_b32 v63, v183, v182, s70
    v_perm_b32 v67, v183, v182, s71
    s_waitcnt lgkmcnt(7)
    ds_read_b32 v176, v16 offset:50944
    ds_read_b32 v177, v16 offset:51200
    ds_read_b32 v178, v16 offset:51456
    ds_read_b32 v179, v16 offset:51712
    ds_read_b32 v180, v16 offset:51968
    ds_read_b32 v181, v16 offset:52224
    ds_read_b32 v182, v16 offset:52480
    ds_read_b32 v183, v16 offset:52736
    s_waitcnt lgkmcnt(8)
    v_perm_b32 v68, v169, v168, s70
    v_perm_b32 v72, v169, v168, s71
    v_perm_b32 v69, v171, v170, s70
    v_perm_b32 v73, v171, v170, s71
    v_perm_b32 v70, v173, v172, s70
    v_perm_b32 v74, v173, v172, s71
    v_perm_b32 v71, v175, v174, s70
    v_perm_b32 v75, v175, v174, s71
    s_waitcnt lgkmcnt(0)
    v_perm_b32 v76, v177, v176, s70
    v_perm_b32 v80, v177, v176, s71
    v_perm_b32 v77, v179, v178, s70
    v_perm_b32 v81, v179, v178, s71
    v_perm_b32 v78, v181, v180, s70
    v_perm_b32 v82, v181, v180, s71
    v_perm_b32 v79, v183, v182, s70
    v_perm_b32 v83, v183, v182, s71
    s_cmp_eq_u32 s27, 0
    s_cbranch_scc0 L_polled
    s_mov_b32 s3, 0
    s_waitcnt vmcnt(0)
    s_branch L_poll1
L_poll:
    global_load_dwordx2 v[206:207], v213, s[22:23] sc1
    s_add_u32 s3, s3, 1
    s_waitcnt vmcnt(0)
L_poll1:
    v_cmpx_ne_u32 vcc, s26, v207
    s_cbranch_execz L_pok
    s_cmp_lt_u32 s3, 4000000
    s_cbranch_scc1 L_poll
    v_mov_b32 v206, 0
L_pok:
    s_mov_b64 exec, -1
    v_add_u32 v14, 161536, v194
    ds_write_b32 v14, v206
L_polled:
L_round:
    s_waitcnt lgkmcnt(0)
    s_barrier
    v_add_u32 v15, 161536, v1
    ds_read_b128 v[140:143], v15
    s_cmp_lg_u32 s28, 0
    s_cbranch_scc1 L_npe
    s_cmp_eq_u32 s27, 0
    s_cbranch_scc1 L_npe
    global_load_dword v206, v214, s[22:23] sc1
L_npe:
    s_and_b32 s31, s24, 3
    v_mov_b32 v148, 0
    v_mul_u32_u24 v135, 12, v0
    v_add_u32 v136, 6144, v135
    v_add_u32 v137, 12288, v135
    s_waitcnt lgkmcnt(0)
    v_lshrrev_b32 v144, 19, v140
    v_lshrrev_b32 v145, 19, v141
    v_lshrrev_b32 v146, 19, v142
    v_lshrrev_b32 v147, 19, v143
    v_add_u32 v150, v144, v145
    v_add3_u32 v12, v150, v146, v147
    v_add_u32 v13, s28, v12
    v_mov_b32 v149, v144
    v_add_u32_dpp v12, v12, v12 row_shr:1 row_mask:0xf bank_mask:0xf
    v_add_u32 v151, v150, v146
    s_set_gpr_idx_on s31, gpr_idx(SRC0)
    v_mov_b32 v14, v140
    v_mov_b32 v15, v144
    v_mov_b32 v16, v148
    s_set_gpr_idx_off
    v_add_u32_dpp v12, v12, v12 row_shr:2 row_mask:0xf bank_mask:0xf
    v_and_b32 v14, 0x7ffff, v14
    v_sub_u32 v16, v16, v13
    v_add_u32_dpp v12, v12, v12 row_shr:4 row_mask:0xf bank_mask:0xf
    v_subrev_u32 v17, s27, v15
    s_mov_b32 s31, s27
    v_add_u32_dpp v12, v12, v12 row_shr:8 row_mask:0xf bank_mask:0xf
    s_nop 1
    v_add_u32_dpp v12, v12, v12 row_bcast:15 row_mask:0xa bank_mask:0xf
    s_nop 1
    v_add_u32_dpp v12, v12, v12 row_bcast:31 row_mask:0xc bank_mask:0xf
    v_add_u32 v16, v16, v12
    v_readlane_b32 s25, v12, 63
    v_sub_u32 v14, v14, v16
    v_add_lshl_u32 v18, v16, s27, 2
    s_cmp_gt_u32 s25, 1536
    s_cbranch_scc1 L_exp
    v_cmpx_lt_i32 vcc, 0, v17
    ds_write_b32 v18, v14 offset:20224
    v_cmpx_lt_i32 vcc, 2, v17
    ds_write_b32 v18, v14 offset:20232
    v_cmpx_lt_i32 vcc, 4, v17
    ds_write_b32 v18, v14 offset:20240
    v_cmpx_lt_i32 vcc, 6, v17
    ds_write_b32 v18, v14 offset:20248
    v_cmpx_lt_i32 vcc, 8, v17
    ds_write_b32 v18, v14 offset:20256
    v_cmpx_lt_i32 vcc, 10, v17
    ds_write_b32 v18, v14 offset:20264
    v_cmpx_lt_i32 vcc, 12, v17
    s_cbranch_execz L_expd
    s_add_u32 s31, s31, 12
L_exp:
    s_mov_b64 exec, -1
    v_cmp_lt_u32 vcc, s31, v15
    s_cbranch_vccz L_expd
    v_add_u32 v19, s31, v16
    s_movk_i32 s3, 1536
    v_cmp_gt_u32 s[68:69], s3, v19
    v_lshlrev_b32 v19, 2, v19
    s_and_b64 exec, vcc, s[68:69]
    ds_write_b32 v19, v14 offset:20224
    s_add_u32 s31, s31, 2
    s_branch L_exp
L_expd:
    s_mov_b64 exec, -1
    s_cmp_eq_u32 s27, 0
    s_cbranch_scc1 L_fok
    s_cmp_lg_u32 s28, 0
    s_cbranch_scc1 L_fok
    s_mov_b32 s3, 0
    s_branch L_fp1
L_fp:
    global_load_dword v206, v214, s[22:23] sc1
    s_add_u32 s3, s3, 1
L_fp1:
    s_waitcnt vmcnt(0)
    v_cmpx_ne_u32 vcc, s26, v206
    s_cbranch_execz L_fok
    s_cmp_lt_u32 s3, 4000000
    s_cbranch_scc1 L_fp
    s_branch L_giveup
L_fok:
    s_mov_b64 exec, -1
    s_waitcnt lgkmcnt(0)
    s_barrier
    ds_read_b32 v132, v194 offset:20224
    ds_read_b32 v133, v194 offset:22272
    ds_read_b32 v134, v194 offset:24320
    ds_read_b32 v152, v195 offset:20224
    ds_read_b32 v153, v195 offset:21248
    ds_read_b32 v154, v195 offset:22272
    ds_read_b32 v155, v195 offset:23296
    ds_read_b32 v156, v195 offset:24320
    ds_read_b32 v157, v195 offset:25344
    s_waitcnt lgkmcnt(8)
    v_mad_i32_i24 v132, v132, 12, v135
    buffer_load_dwordx3 v[140:142], v132, s[8:11], 0 offen sc1
    s_waitcnt lgkmcnt(7)
    v_mad_i32_i24 v133, v133, 12, v136
    buffer_load_dwordx3 v[144:146], v133, s[8:11], 0 offen sc1
    s_waitcnt lgkmcnt(6)
    v_mad_i32_i24 v134, v134, 12, v137
    buffer_load_dwordx3 v[148:150], v134, s[8:11], 0 offen sc1
    s_waitcnt lgkmcnt(0)
    v_lshl_add_u32 v152, v152, 5, v188
    v_lshl_add_u32 v153, v153, 5, v189
    v_lshl_add_u32 v154, v154, 5, v190
    v_lshl_add_u32 v155, v155, 5, v191
    v_lshl_add_u32 v156, v156, 5, v192
    v_lshl_add_u32 v157, v157, 5, v193
    s_barrier
    s_add_u32 m0, s30, 63232
    s_nop 0
    buffer_load_dwordx4 v152, s[12:15], 0 offen sc1 lds
    s_sub_u32 s29, s25, s28
    s_min_u32 s29, s29, 1536
    s_lshl_b32 s3, s29, 4
    s_max_u32 s32, s29, 1280
    s_sub_u32 s32, s32, 1280
    s_lshl_b32 s32, s32, 5
    v_cmp_gt_u32 s[56:57], s3, v188
    v_lshlrev_b32 v159, 1, v188
    v_mov_b32 v143, 0
    v_cmp_gt_u32 s[58:59], s3, v189
    v_lshlrev_b32 v161, 1, v189
    v_mov_b32 v147, 0
    v_cmp_gt_u32 s[60:61], s3, v190
    v_lshlrev_b32 v163, 1, v190
    v_mov_b32 v151, 0
    v_and_b32 v4, 15, v11
    v_lshrrev_b32 v13, 4, v11
    s_mul_i32 s3, s27, 23040
    v_mul_u32_u24 v30, 288, v4
    v_lshl_add_u32 v30, v13, 4, v30
    v_add_u32 v30, s3, v30
    s_mul_i32 s68, s27, 5120
    s_add_u32 s68, s68, s2
    s_lshl_b32 s68, s68, 10
    s_and_b32 s3, s24, 3
    s_lshl_b32 s3, s3, 8
    s_add_u32 s68, s68, s3
    v_lshl_add_u32 v31, v13, 18, s68
    v_lshl_add_u32 v31, v4, 4, v31
    v_lshlrev_b32 v4, 3, v4
    v_bfe_u32 v5, v11, 3, 2
    v_and_b32 v12, 3, v11
    v_lshl_add_u32 v5, v5, 2, v12
    v_lshlrev_b32 v5, 3, v5
    v_lshrrev_b32 v6, 2, v11
    v_lshlrev_b32 v6, 3, v6
    v_mul_u32_u24 v16, 52, v11
    v_lshrrev_b32 v16, 8, v16
    v_mul_u32_u24 v17, 5, v16
    v_sub_u32 v17, v11, v17
    v_mul_u32_u24 v15, 6, v17
    v_bfe_u32 v15, s101, v15, 6
    v_lshlrev_b32 v15, 2, v15
    v_lshlrev_b32 v16, 8, v16
    v_add_lshl_u32 v17, v17, 64, 19
    s_mul_i32 s3, s24, 5
    v_lshlrev_b32 v18, 2, v11
    v_add_u32 v21, s3, v11
    v_lshlrev_b32 v19, 2, v21
    v_cmp_gt_u32 vcc, 40, v11
    v_add_u32 v20, 1, v11
    v_add_u32 v21, 1, v21
    v_cndmask_b32 v20, 0, v20, vcc
    s_cmp_gt_u32 s25, 1536
    s_cselect_b32 s69, 0, 8
    v_mov_b32 v22, 8
    s_cmp_lg_u32 s28, 0
    s_cbranch_scc1 L_nofr
    ds_read_b128 v[36:39], v1 offset:8192
    ds_read_b128 v[40:43], v1 offset:9216
    ds_read_b128 v[44:47], v1 offset:10240
    ds_read_b128 v[48:51], v1 offset:11264
L_nofr:
    s_waitcnt vmcnt(3)
    s_mov_b64 exec, s[56:57]
    v_and_b32 v12, 0xff, v142
    v_and_b32 v143, 0xffff, v142
    ds_add_u32 v12, v22 offset:19200
    ds_add_rtn_u32 v132, v143, v22 offset:16128
    s_waitcnt vmcnt(2)
    s_mov_b64 exec, s[58:59]
    v_and_b32 v13, 0xff, v146
    v_and_b32 v147, 0xffff, v146
    ds_add_u32 v13, v22 offset:19200
    ds_add_rtn_u32 v133, v147, v22 offset:16128
    s_waitcnt vmcnt(1)
    s_mov_b64 exec, s[60:61]
    v_and_b32 v14, 0xff, v150
    v_and_b32 v151, 0xffff, v150
    ds_add_u32 v14, v22 offset:19200
    ds_add_rtn_u32 v134, v151, v22 offset:16128
    s_mov_b64 exec, -1
    s_add_u32 m0, s30, 71424
    s_nop 0
    buffer_load_dwordx4 v153, s[12:15], 0 offen sc1 lds
    v_mfma_f32_4x4x4_16b_bf16 v[164:167], v[228:229], v[140:141], 0 cbsz:4 abid:0
    v_mfma_f32_4x4x4_16b_bf16 v[168:171], v[228:229], v[140:141], 0 cbsz:4 abid:1
    v_mfma_f32_4x4x4_16b_bf16 v[172:175], v[228:229], v[140:141], 0 cbsz:4 abid:2
    v_mfma_f32_4x4x4_16b_bf16 v[176:179], v[228:229], v[140:141], 0 cbsz:4 abid:3
    v_add_u32 v23, 112384, v159
    v_lshlrev_b32_sdwa v142, 10, v142 dst_sel:DWORD dst_unused:UNUSED_PAD src0_sel:DWORD src1_sel:WORD_1
    v_cvt_pk_bf16_f32 v180, v164, v165
    v_cvt_pk_bf16_f32 v181, v166, v167
    v_cvt_pk_bf16_f32 v182, v168, v169
    v_cvt_pk_bf16_f32 v183, v170, v171
    v_cvt_pk_bf16_f32 v184, v172, v173
    v_cvt_pk_bf16_f32 v185, v174, v175
    v_cvt_pk_bf16_f32 v186, v176, v177
    v_cvt_pk_bf16_f32 v187, v178, v179
    s_waitcnt lgkmcnt(0)
    s_barrier
    ds_read_b32 v12, v18 offset:19200
    ds_read_b32 v13, v19 offset:19200
    ds_write_b128 v23, v[180:183]
    ds_write_b128 v23, v[184:187] offset:16
    v_lshlrev_b32_sdwa v150, 10, v150 dst_sel:DWORD dst_unused:UNUSED_PAD src0_sel:DWORD src1_sel:WORD_1
    s_waitcnt lgkmcnt(2)
    v_mad_u32_u24 v21, v13, s69, v21
    v_mad_u32_u24 v20, v12, s69, v20
    v_readlane_b32 s96, v21, 0
    v_readlane_b32 s97, v21, 1
    v_readlane_b32 s98, v21, 2
    v_readlane_b32 s99, v21, 3
    v_readlane_b32 s100, v21, 4
    v_lshl_add_u32 v19, v13, 16, v19
    v_cmp_lt_u32 s[36:37], s96, v20
    v_cmp_lt_u32 s[38:39], s97, v20
    v_cmp_lt_u32 s[40:41], s98, v20
    v_cmp_lt_u32 s[42:43], s99, v20
    v_cmp_lt_u32 s[44:45], s100, v20
    s_bcnt1_i32_b64 s96, s[36:37]
    v_writelane_b32 v12, s96, 0
    s_bcnt1_i32_b64 s97, s[38:39]
    v_writelane_b32 v12, s97, 1
    s_bcnt1_i32_b64 s98, s[40:41]
    v_writelane_b32 v12, s98, 2
    s_bcnt1_i32_b64 s99, s[42:43]
    v_writelane_b32 v12, s99, 3
    s_bcnt1_i32_b64 s100, s[44:45]
    v_writelane_b32 v12, s100, 4
    s_mov_b64 exec, 31
    v_lshlrev_b32 v12, 2, v12
    ds_write_b32 v12, v19 offset:19712
    s_mov_b64 exec, -1
    s_add_u32 m0, s30, 79616
    s_nop 0
    buffer_load_dwordx4 v154, s[12:15], 0 offen sc1 lds
    s_add_u32 m0, s30, 87808
    s_nop 0
    buffer_load_dwordx4 v155, s[12:15], 0 offen sc1 lds
    s_waitcnt lgkmcnt(0)
    s_barrier
    ds_read_b32 v12, v15 offset:19712
    v_mfma_f32_4x4x4_16b_bf16 v[164:167], v[228:229], v[144:145], 0 cbsz:4 abid:0
    v_mfma_f32_4x4x4_16b_bf16 v[168:171], v[228:229], v[144:145], 0 cbsz:4 abid:1
    v_mfma_f32_4x4x4_16b_bf16 v[172:175], v[228:229], v[144:145], 0 cbsz:4 abid:2
    v_mfma_f32_4x4x4_16b_bf16 v[176:179], v[228:229], v[144:145], 0 cbsz:4 abid:3
    v_add_u32 v23, 112384, v161
    v_lshlrev_b32_sdwa v146, 10, v146 dst_sel:DWORD dst_unused:UNUSED_PAD src0_sel:DWORD src1_sel:WORD_1
    v_cvt_pk_bf16_f32 v180, v164, v165
    v_cvt_pk_bf16_f32 v181, v166, v167
    v_cvt_pk_bf16_f32 v182, v168, v169
    v_cvt_pk_bf16_f32 v183, v170, v171
    v_cvt_pk_bf16_f32 v184, v172, v173
    v_cvt_pk_bf16_f32 v185, v174, v175
    v_cvt_pk_bf16_f32 v186, v176, v177
    v_cvt_pk_bf16_f32 v187, v178, v179
    s_waitcnt lgkmcnt(0)
    v_add_u32_sdwa v16, v12, v16 dst_sel:DWORD dst_unused:UNUSED_PAD src0_sel:WORD_0 src1_sel:DWORD
    ds_read_b32 v13, v16 offset:16128
    v_readlane_b32 s96, v12, 0
    v_readlane_b32 s97, v12, 1
    v_readlane_b32 s98, v12, 2
    v_readlane_b32 s99, v12, 3
    v_readlane_b32 s100, v12, 4
    s_add_u32 s3, s96, s97
    s_add_u32 s3, s3, s98
    s_add_u32 s3, s3, s99
    s_add_u32 s3, s3, s100
    s_lshr_b32 s29, s3, 16
    s_add_u32 s3, s29, 480
    v_mov_b32 v14, s3
    v_mov_b32 v18, 0
    s_mov_b64 exec, 1
    ds_add_rtn_u32 v14, v18, v14 offset:19968
    s_mov_b64 exec, -1
    s_waitcnt lgkmcnt(1)
    v_sub_u32 v17, v17, v13
    s_nop 0
    v_add_u32_dpp v13, v13, v13 row_shr:1 row_mask:0xf bank_mask:0xf
    s_bfe_u32 s3, s29, 65539
    s_add_u32 s3, s3, 7
    v_add_u32_dpp v13, v13, v13 row_shr:2 row_mask:0xf bank_mask:0xf
    v_mov_b32 v20, 2147482664
    v_mov_b32 v21, 0
    v_add_u32_dpp v13, v13, v13 row_shr:4 row_mask:0xf bank_mask:0xf
    v_writelane_b32 v20, 40, s3
    s_nop 0
    v_add_u32_dpp v13, v13, v13 row_shr:8 row_mask:0xf bank_mask:0xf
    s_waitcnt lgkmcnt(0)
    v_readfirstlane_b32 s71, v14
    v_add_u32_dpp v13, v13, v13 row_bcast:15 row_mask:0xa bank_mask:0xf
    s_add_u32 s3, s71, s29
    v_lshl_add_u32 v18, v11, 3, s3
    v_add_u32_dpp v13, v13, v13 row_bcast:31 row_mask:0xc bank_mask:0xf
    s_mov_b32 exec_hi, 0x0fffffff
    v_add3_u32 v13, v13, v17, s71
    ds_write_b32 v16, v13 offset:16128
    ds_write_b64 v18, v[20:21] offset:0
    s_mov_b64 exec, -1
    ds_write_b128 v23, v[180:183]
    ds_write_b128 v23, v[184:187] offset:16
    s_add_u32 m0, s30, 96000
    s_nop 0
    buffer_load_dwordx4 v156, s[12:15], 0 offen sc1 lds
    s_waitcnt lgkmcnt(2)
    s_barrier
    ds_read_b32 v12, v143 offset:16128
    ds_read_b32 v13, v147 offset:16128
    ds_read_b32 v14, v151 offset:16128
    v_add_u32 v4, s71, v4
    v_add_u32 v5, s71, v5
    v_add_u32 v6, s71, v6
    s_mov_b64 exec, s[56:57]
    s_waitcnt lgkmcnt(2)
    v_add_u32_sdwa v132, v12, v132 dst_sel:DWORD dst_unused:UNUSED_PAD src0_sel:WORD_0 src1_sel:DWORD
    v_or_b32_sdwa v158, v12, v142 dst_sel:DWORD dst_unused:UNUSED_PAD src0_sel:WORD_1 src1_sel:DWORD
    ds_write_b64 v132, v[158:159] offset:0
    s_mov_b64 exec, s[58:59]
    s_waitcnt lgkmcnt(2)
    v_add_u32_sdwa v133, v13, v133 dst_sel:DWORD dst_unused:UNUSED_PAD src0_sel:WORD_0 src1_sel:DWORD
    v_or_b32_sdwa v160, v13, v146 dst_sel:DWORD dst_unused:UNUSED_PAD src0_sel:WORD_1 src1_sel:DWORD
    ds_write_b64 v133, v[160:161] offset:0
    s_mov_b64 exec, s[60:61]
    s_waitcnt lgkmcnt(2)
    v_add_u32_sdwa v134, v14, v134 dst_sel:DWORD dst_unused:UNUSED_PAD src0_sel:WORD_0 src1_sel:DWORD
    v_or_b32_sdwa v162, v14, v150 dst_sel:DWORD dst_unused:UNUSED_PAD src0_sel:WORD_1 src1_sel:DWORD
    ds_write_b64 v134, v[162:163] offset:0
    s_mov_b64 exec, -1
    s_cmp_lt_u32 s30, s32
    s_cbranch_scc0 L_noef5
    s_add_u32 m0, s30, 104192
    s_nop 0
    buffer_load_dwordx4 v157, s[12:15], 0 offen sc1 lds
L_noef5:
    s_waitcnt lgkmcnt(0)
    s_barrier
    ds_read_b32 v12, v4
    ds_read_b32 v7, v4 offset:56
    ds_read_b32 v9, v5 offset:4
    ds_read_b32 v10, v6 offset:4
    s_cmp_eq_u64 s[60:61], 0
    s_cbranch_scc1 L_not3
    v_mfma_f32_4x4x4_16b_bf16 v[164:167], v[228:229], v[148:149], 0 cbsz:4 abid:0
    v_mfma_f32_4x4x4_16b_bf16 v[168:171], v[228:229], v[148:149], 0 cbsz:4 abid:1
    v_mfma_f32_4x4x4_16b_bf16 v[172:175], v[228:229], v[148:149], 0 cbsz:4 abid:2
    v_mfma_f32_4x4x4_16b_bf16 v[176:179], v[228:229], v[148:149], 0 cbsz:4 abid:3
    v_add_u32 v23, 112384, v163
    s_nop 0
    v_cvt_pk_bf16_f32 v180, v164, v165
    v_cvt_pk_bf16_f32 v181, v166, v167
    v_cvt_pk_bf16_f32 v182, v168, v169
    v_cvt_pk_bf16_f32 v183, v170, v171
    v_cvt_pk_bf16_f32 v184, v172, v173
    v_cvt_pk_bf16_f32 v185, v174, v175
    v_cvt_pk_bf16_f32 v186, v176, v177
    v_cvt_pk_bf16_f32 v187, v178, v179
    ds_write_b128 v23, v[180:183]
    ds_write_b128 v23, v[184:187] offset:16
    s_waitcnt lgkmcnt(2)
    s_branch L_t3
L_not3:
    s_waitcnt lgkmcnt(0)
L_t3:
    v_readlane_b32 s36, v12, 0
    v_readlane_b32 s37, v12, 1
    v_readlane_b32 s38, v12, 2
    v_readlane_b32 s39, v12, 3
    s_and_b32 s70, s36, 4294966784
    buffer_load_dwordx4 v[196:199], v1, s[4:7], s70 offen
    s_and_b32 s71, s37, 4294966784
    buffer_load_dwordx4 v[200:203], v1, s[4:7], s71 offen
    s_and_b32 s70, s38, 4294966784
    buffer_load_dwordx4 v[204:207], v1, s[4:7], s70 offen
    s_and_b32 s71, s39, 4294966784
    buffer_load_dwordx4 v[208:211], v1, s[4:7], s71 offen
    v_readlane_b32 s40, v12, 4
    v_readlane_b32 s41, v12, 5
    v_readlane_b32 s42, v12, 6
    v_readlane_b32 s43, v12, 7
    v_add_u32 v9, v9, v2
    v_add_u32 v10, v10, v3
    s_and_b32 s68, s43, 4294966784
    ds_read_b128 v[132:135], v29
    ds_read_b128 v[136:139], v29
    ds_read_b128 v[140:143], v29
    ds_read_b128 v[144:147], v29
    ds_read_b128 v[148:151], v29
    ds_read_b128 v[152:155], v29
    ds_read_b128 v[156:159], v29
    ds_read_b128 v[160:163], v29
    s_waitcnt vmcnt(4) lgkmcnt(0)
    s_barrier
    s_cmp_eq_u32 s29, 0
    s_cbranch_scc1 L_exit
    ds_read_b128 v[24:27], v9 offset:63232
    ds_read_b64 v[32:33], v10
    s_and_b32 s70, s40, 4294966784
    buffer_load_dwordx4 v[212:215], v1, s[4:7], s70 offen
    s_and_b32 s71, s41, 4294966784
    buffer_load_dwordx4 v[216:219], v1, s[4:7], s71 offen
    s_waitcnt lgkmcnt(1)
    v_smfmac_f32_32x32x32_bf16 v[132:147], v[24:27], v[36:43], v28
    v_smfmac_f32_32x32x32_bf16 v[148:163], v[24:27], v[44:51], v28
    s_and_b32 s70, s42, 4294966784
    buffer_load_dwordx4 v[220:223], v1, s[4:7], s70 offen
    s_waitcnt lgkmcnt(0)
    s_nop 7
    v_exp_f32 v12, v132
    v_exp_f32 v13, v133
    v_exp_f32 v14, v148
    v_exp_f32 v15, v149
    v_pk_add_f32 v[12:13], v[12:13], 1.0 op_sel_hi:[1,0]
    v_pk_add_f32 v[14:15], v[14:15], 1.0 op_sel_hi:[1,0]
    v_rcp_f32 v12, v12
    v_rcp_f32 v13, v13
    s_nop 0
    v_pk_mul_f32 v[132:133], v[132:133], v[12:13]
L_loop:
    s_setprio 3
    ds_read_b32 v9, v5 offset:132
    ds_read_b32 v10, v6 offset:132
    ds_read_b32 v8, v4 offset:184
    ds_read_b128 v[164:167], v29
    s_waitcnt vmcnt(6)
    v_rcp_f32 v14, v14
    v_mfma_f32_4x4x4_16b_bf16 v[16:19], v[32:33], v[196:197], 0 cbsz:4 abid:0
    v_exp_f32 v13, v135
    v_mfma_f32_4x4x4_16b_bf16 v[20:23], v[32:33], v[198:199], 0 cbsz:4 abid:0
    v_exp_f32 v12, v134
    v_readlane_b32 s44, v7, 1
    v_rcp_f32 v15, v15
    v_pk_add_f32 v[12:13], v[12:13], 1.0 op_sel_hi:[1,0]
    v_pk_mul_f32 v[148:149], v[148:149], v[14:15]
    s_and_b32 s69, s44, 4294966784
    s_set_gpr_idx_on s36, gpr_idx(SRC2,DST)
    buffer_load_dwordx4 v[224:227], v1, s[4:7], s68 offen
    v_pk_fma_f32 v[84:85], v[132:133], v[16:17], v[84:85] op_sel_hi:[0,1,1]
    v_pk_fma_f32 v[86:87], v[132:133], v[18:19], v[86:87] op_sel_hi:[0,1,1]
    v_pk_fma_f32 v[88:89], v[148:149], v[20:21], v[88:89] op_sel_hi:[0,1,1]
    v_pk_fma_f32 v[90:91], v[148:149], v[22:23], v[90:91] op_sel_hi:[0,1,1]
    s_set_gpr_idx_off
    ds_read_b128 v[168:171], v29
    s_waitcnt vmcnt(6) lgkmcnt(2)
    v_rcp_f32 v12, v12
    v_mfma_f32_4x4x4_16b_bf16 v[16:19], v[32:33], v[200:201], 0 cbsz:4 abid:1
    v_exp_f32 v15, v151
    v_mfma_f32_4x4x4_16b_bf16 v[20:23], v[32:33], v[202:203], 0 cbsz:4 abid:1
    v_exp_f32 v14, v150
    v_readlane_b32 s45, v7, 2
    v_rcp_f32 v13, v13
    v_pk_add_f32 v[14:15], v[14:15], 1.0 op_sel_hi:[1,0]
    v_pk_mul_f32 v[134:135], v[134:135], v[12:13]
    s_and_b32 s68, s45, 4294966784
    s_set_gpr_idx_on s37, gpr_idx(SRC2,DST)
    buffer_load_dwordx4 v[196:199], v1, s[4:7], s69 offen
    v_pk_fma_f32 v[84:85], v[132:133], v[16:17], v[84:85] op_sel:[1,0,0]
    v_pk_fma_f32 v[86:87], v[132:133], v[18:19], v[86:87] op_sel:[1,0,0]
    v_pk_fma_f32 v[88:89], v[148:149], v[20:21], v[88:89] op_sel:[1,0,0]
    v_pk_fma_f32 v[90:91], v[148:149], v[22:23], v[90:91] op_sel:[1,0,0]
    s_set_gpr_idx_off
    s_cbranch_scc0 L_exit
    v_add_u32 v9, v9, v2
    v_add_u32 v10, v10, v3
    ds_read_b128 v[24:27], v9 offset:63232
    ds_read_b64 v[34:35], v10
    ds_read_b128 v[172:175], v29
    s_waitcnt vmcnt(6)
    v_rcp_f32 v14, v14
    v_mfma_f32_4x4x4_16b_bf16 v[16:19], v[32:33], v[204:205], 0 cbsz:4 abid:2
    v_exp_f32 v13, v137
    v_mfma_f32_4x4x4_16b_bf16 v[20:23], v[32:33], v[206:207], 0 cbsz:4 abid:2
    v_exp_f32 v12, v136
    v_readlane_b32 s46, v7, 3
    v_rcp_f32 v15, v15
    v_pk_add_f32 v[12:13], v[12:13], 1.0 op_sel_hi:[1,0]
    v_pk_mul_f32 v[150:151], v[150:151], v[14:15]
    s_and_b32 s69, s46, 4294966784
    s_set_gpr_idx_on s38, gpr_idx(SRC2,DST)
    buffer_load_dwordx4 v[200:203], v1, s[4:7], s68 offen
    v_pk_fma_f32 v[84:85], v[134:135], v[16:17], v[84:85] op_sel_hi:[0,1,1]
    v_pk_fma_f32 v[86:87], v[134:135], v[18:19], v[86:87] op_sel_hi:[0,1,1]
    v_pk_fma_f32 v[88:89], v[150:151], v[20:21], v[88:89] op_sel_hi:[0,1,1]
    v_pk_fma_f32 v[90:91], v[150:151], v[22:23], v[90:91] op_sel_hi:[0,1,1]
    s_set_gpr_idx_off
    ds_read_b128 v[176:179], v29
    s_waitcnt vmcnt(6)
    v_rcp_f32 v12, v12
    v_mfma_f32_4x4x4_16b_bf16 v[16:19], v[32:33], v[208:209], 0 cbsz:4 abid:3
    v_exp_f32 v15, v153
    v_mfma_f32_4x4x4_16b_bf16 v[20:23], v[32:33], v[210:211], 0 cbsz:4 abid:3
    v_exp_f32 v14, v152
    v_readlane_b32 s47, v7, 4
    v_rcp_f32 v13, v13
    v_pk_add_f32 v[14:15], v[14:15], 1.0 op_sel_hi:[1,0]
    v_pk_mul_f32 v[136:137], v[136:137], v[12:13]
    s_and_b32 s68, s47, 4294966784
    s_set_gpr_idx_on s39, gpr_idx(SRC2,DST)
    buffer_load_dwordx4 v[204:207], v1, s[4:7], s69 offen
    v_pk_fma_f32 v[84:85], v[134:135], v[16:17], v[84:85] op_sel:[1,0,0]
    v_pk_fma_f32 v[86:87], v[134:135], v[18:19], v[86:87] op_sel:[1,0,0]
    v_pk_fma_f32 v[88:89], v[150:151], v[20:21], v[88:89] op_sel:[1,0,0]
    v_pk_fma_f32 v[90:91], v[150:151], v[22:23], v[90:91] op_sel:[1,0,0]
    s_set_gpr_idx_off
    s_cbranch_scc0 L_exit
    s_setprio 2
    ds_read_b128 v[180:183], v29
    s_waitcnt vmcnt(6)
    v_rcp_f32 v14, v14
    v_mfma_f32_4x4x4_16b_bf16 v[16:19], v[32:33], v[212:213], 0 cbsz:4 abid:4
    v_exp_f32 v13, v139
    v_mfma_f32_4x4x4_16b_bf16 v[20:23], v[32:33], v[214:215], 0 cbsz:4 abid:4
    v_exp_f32 v12, v138
    v_readlane_b32 s48, v7, 5
    v_rcp_f32 v15, v15
    v_pk_add_f32 v[12:13], v[12:13], 1.0 op_sel_hi:[1,0]
    v_pk_mul_f32 v[152:153], v[152:153], v[14:15]
    s_and_b32 s69, s48, 4294966784
    s_set_gpr_idx_on s40, gpr_idx(SRC2,DST)
    buffer_load_dwordx4 v[208:211], v1, s[4:7], s68 offen
    v_pk_fma_f32 v[84:85], v[136:137], v[16:17], v[84:85] op_sel_hi:[0,1,1]
    v_pk_fma_f32 v[86:87], v[136:137], v[18:19], v[86:87] op_sel_hi:[0,1,1]
    v_pk_fma_f32 v[88:89], v[152:153], v[20:21], v[88:89] op_sel_hi:[0,1,1]
    v_pk_fma_f32 v[90:91], v[152:153], v[22:23], v[90:91] op_sel_hi:[0,1,1]
    s_set_gpr_idx_off
    ds_read_b128 v[184:187], v29
    s_waitcnt vmcnt(6)
    v_rcp_f32 v12, v12
    v_mfma_f32_4x4x4_16b_bf16 v[16:19], v[32:33], v[216:217], 0 cbsz:4 abid:5
    v_exp_f32 v15, v155
    v_mfma_f32_4x4x4_16b_bf16 v[20:23], v[32:33], v[218:219], 0 cbsz:4 abid:5
    v_exp_f32 v14, v154
    v_readlane_b32 s49, v7, 6
    v_rcp_f32 v13, v13
    v_pk_add_f32 v[14:15], v[14:15], 1.0 op_sel_hi:[1,0]
    v_pk_mul_f32 v[138:139], v[138:139], v[12:13]
    s_and_b32 s68, s49, 4294966784
    s_set_gpr_idx_on s41, gpr_idx(SRC2,DST)
    buffer_load_dwordx4 v[212:215], v1, s[4:7], s69 offen
    v_pk_fma_f32 v[84:85], v[136:137], v[16:17], v[84:85] op_sel:[1,0,0]
    v_pk_fma_f32 v[86:87], v[136:137], v[18:19], v[86:87] op_sel:[1,0,0]
    v_pk_fma_f32 v[88:89], v[152:153], v[20:21], v[88:89] op_sel:[1,0,0]
    v_pk_fma_f32 v[90:91], v[152:153], v[22:23], v[90:91] op_sel:[1,0,0]
    s_set_gpr_idx_off
    s_cbranch_scc0 L_exit
    ds_read_b128 v[188:191], v29
    s_waitcnt vmcnt(6)
    v_rcp_f32 v14, v14
    v_mfma_f32_4x4x4_16b_bf16 v[16:19], v[32:33], v[220:221], 0 cbsz:4 abid:6
    v_exp_f32 v13, v141
    v_mfma_f32_4x4x4_16b_bf16 v[20:23], v[32:33], v[222:223], 0 cbsz:4 abid:6
    v_exp_f32 v12, v140
    v_readlane_b32 s50, v7, 7
    v_rcp_f32 v15, v15
    v_pk_add_f32 v[12:13], v[12:13], 1.0 op_sel_hi:[1,0]
    v_pk_mul_f32 v[154:155], v[154:155], v[14:15]
    s_and_b32 s69, s50, 4294966784
    s_set_gpr_idx_on s42, gpr_idx(SRC2,DST)
    buffer_load_dwordx4 v[216:219], v1, s[4:7], s68 offen
    v_pk_fma_f32 v[84:85], v[138:139], v[16:17], v[84:85] op_sel_hi:[0,1,1]
    v_pk_fma_f32 v[86:87], v[138:139], v[18:19], v[86:87] op_sel_hi:[0,1,1]
    v_pk_fma_f32 v[88:89], v[154:155], v[20:21], v[88:89] op_sel_hi:[0,1,1]
    v_pk_fma_f32 v[90:91], v[154:155], v[22:23], v[90:91] op_sel_hi:[0,1,1]
    s_set_gpr_idx_off
    ds_read_b128 v[192:195], v29
    s_waitcnt vmcnt(6)
    v_rcp_f32 v12, v12
    v_mfma_f32_4x4x4_16b_bf16 v[16:19], v[32:33], v[224:225], 0 cbsz:4 abid:7
    v_exp_f32 v15, v157
    v_mfma_f32_4x4x4_16b_bf16 v[20:23], v[32:33], v[226:227], 0 cbsz:4 abid:7
    v_exp_f32 v14, v156
    v_readlane_b32 s51, v7, 8
    v_rcp_f32 v13, v13
    v_pk_add_f32 v[14:15], v[14:15], 1.0 op_sel_hi:[1,0]
    v_pk_mul_f32 v[140:141], v[140:141], v[12:13]
    s_and_b32 s68, s51, 4294966784
    s_set_gpr_idx_on s43, gpr_idx(SRC2,DST)
    buffer_load_dwordx4 v[220:223], v1, s[4:7], s69 offen
    v_pk_fma_f32 v[84:85], v[138:139], v[16:17], v[84:85] op_sel:[1,0,0]
    v_pk_fma_f32 v[86:87], v[138:139], v[18:19], v[86:87] op_sel:[1,0,0]
    v_pk_fma_f32 v[88:89], v[154:155], v[20:21], v[88:89] op_sel:[1,0,0]
    v_pk_fma_f32 v[90:91], v[154:155], v[22:23], v[90:91] op_sel:[1,0,0]
    s_set_gpr_idx_off
    s_cbranch_scc0 L_exit
    s_setprio 1
    s_waitcnt vmcnt(6)
    v_rcp_f32 v14, v14
    v_mfma_f32_4x4x4_16b_bf16 v[16:19], v[32:33], v[196:197], 0 cbsz:4 abid:8
    v_exp_f32 v13, v143
    v_mfma_f32_4x4x4_16b_bf16 v[20:23], v[32:33], v[198:199], 0 cbsz:4 abid:8
    v_exp_f32 v12, v142
    v_readlane_b32 s52, v7, 9
    v_rcp_f32 v15, v15
    v_pk_add_f32 v[12:13], v[12:13], 1.0 op_sel_hi:[1,0]
    v_pk_mul_f32 v[156:157], v[156:157], v[14:15]
    s_and_b32 s69, s52, 4294966784
    s_set_gpr_idx_on s44, gpr_idx(SRC2,DST)
    buffer_load_dwordx4 v[224:227], v1, s[4:7], s68 offen
    v_pk_fma_f32 v[84:85], v[140:141], v[16:17], v[84:85] op_sel_hi:[0,1,1]
    v_pk_fma_f32 v[86:87], v[140:141], v[18:19], v[86:87] op_sel_hi:[0,1,1]
    v_pk_fma_f32 v[88:89], v[156:157], v[20:21], v[88:89] op_sel_hi:[0,1,1]
    v_pk_fma_f32 v[90:91], v[156:157], v[22:23], v[90:91] op_sel_hi:[0,1,1]
    s_set_gpr_idx_off
    s_waitcnt vmcnt(6) lgkmcnt(0)
    v_mfma_f32_4x4x4_16b_bf16 v[20:23], v[32:33], v[202:203], 0 cbsz:4 abid:9
    v_mfma_f32_4x4x4_16b_bf16 v[16:19], v[32:33], v[200:201], 0 cbsz:4 abid:9
    v_rcp_f32 v13, v13
    v_smfmac_f32_32x32x32_bf16 v[164:179], v[24:27], v[36:43], v28
    v_exp_f32 v14, v158
    v_exp_f32 v15, v159
    v_readlane_b32 s53, v7, 10
    v_rcp_f32 v12, v12
    v_pk_add_f32 v[14:15], v[14:15], 1.0 op_sel_hi:[1,0]
    v_pk_mul_f32 v[142:143], v[142:143], v[12:13]
    s_and_b32 s68, s53, 4294966784
    s_set_gpr_idx_on s45, gpr_idx(SRC2,DST)
    buffer_load_dwordx4 v[196:199], v1, s[4:7], s69 offen
    v_pk_fma_f32 v[84:85], v[140:141], v[16:17], v[84:85] op_sel:[1,0,0]
    v_pk_fma_f32 v[86:87], v[140:141], v[18:19], v[86:87] op_sel:[1,0,0]
    v_pk_fma_f32 v[88:89], v[156:157], v[20:21], v[88:89] op_sel:[1,0,0]
    v_pk_fma_f32 v[90:91], v[156:157], v[22:23], v[90:91] op_sel:[1,0,0]
    s_set_gpr_idx_off
    s_cbranch_scc0 L_exit
    s_waitcnt vmcnt(6)
    v_rcp_f32 v14, v14
    v_mfma_f32_4x4x4_16b_bf16 v[16:19], v[32:33], v[204:205], 0 cbsz:4 abid:10
    v_exp_f32 v13, v145
    v_mfma_f32_4x4x4_16b_bf16 v[20:23], v[32:33], v[206:207], 0 cbsz:4 abid:10
    v_exp_f32 v12, v144
    v_readlane_b32 s54, v7, 11
    v_rcp_f32 v15, v15
    v_pk_add_f32 v[12:13], v[12:13], 1.0 op_sel_hi:[1,0]
    v_pk_mul_f32 v[158:159], v[158:159], v[14:15]
    s_and_b32 s69, s54, 4294966784
    s_set_gpr_idx_on s46, gpr_idx(SRC2,DST)
    buffer_load_dwordx4 v[200:203], v1, s[4:7], s68 offen
    v_pk_fma_f32 v[84:85], v[142:143], v[16:17], v[84:85] op_sel_hi:[0,1,1]
    v_pk_fma_f32 v[86:87], v[142:143], v[18:19], v[86:87] op_sel_hi:[0,1,1]
    v_pk_fma_f32 v[88:89], v[158:159], v[20:21], v[88:89] op_sel_hi:[0,1,1]
    v_pk_fma_f32 v[90:91], v[158:159], v[22:23], v[90:91] op_sel_hi:[0,1,1]
    s_set_gpr_idx_off
    s_waitcnt vmcnt(6)
    v_mfma_f32_4x4x4_16b_bf16 v[20:23], v[32:33], v[210:211], 0 cbsz:4 abid:11
    v_mfma_f32_4x4x4_16b_bf16 v[16:19], v[32:33], v[208:209], 0 cbsz:4 abid:11
    v_rcp_f32 v13, v13
    v_smfmac_f32_32x32x32_bf16 v[180:195], v[24:27], v[44:51], v28
    v_exp_f32 v14, v160
    v_exp_f32 v15, v161
    v_readlane_b32 s55, v7, 12
    v_rcp_f32 v12, v12
    v_pk_add_f32 v[14:15], v[14:15], 1.0 op_sel_hi:[1,0]
    v_pk_mul_f32 v[144:145], v[144:145], v[12:13]
    s_and_b32 s68, s55, 4294966784
    s_set_gpr_idx_on s47, gpr_idx(SRC2,DST)
    buffer_load_dwordx4 v[204:207], v1, s[4:7], s69 offen
    v_pk_fma_f32 v[84:85], v[142:143], v[16:17], v[84:85] op_sel:[1,0,0]
    v_pk_fma_f32 v[86:87], v[142:143], v[18:19], v[86:87] op_sel:[1,0,0]
    v_pk_fma_f32 v[88:89], v[158:159], v[20:21], v[88:89] op_sel:[1,0,0]
    v_pk_fma_f32 v[90:91], v[158:159], v[22:23], v[90:91] op_sel:[1,0,0]
    s_set_gpr_idx_off
    s_cbranch_scc0 L_exit
    s_setprio 0
    s_waitcnt vmcnt(6)
    v_rcp_f32 v14, v14
    v_mfma_f32_4x4x4_16b_bf16 v[16:19], v[32:33], v[212:213], 0 cbsz:4 abid:12
    v_exp_f32 v13, v147
    v_mfma_f32_4x4x4_16b_bf16 v[20:23], v[32:33], v[214:215], 0 cbsz:4 abid:12
    v_exp_f32 v12, v146
    v_readlane_b32 s56, v7, 13
    v_rcp_f32 v15, v15
    v_pk_add_f32 v[12:13], v[12:13], 1.0 op_sel_hi:[1,0]
    v_pk_mul_f32 v[160:161], v[160:161], v[14:15]
    s_and_b32 s69, s56, 4294966784
    s_set_gpr_idx_on s48, gpr_idx(SRC2,DST)
    buffer_load_dwordx4 v[208:211], v1, s[4:7], s68 offen
    v_pk_fma_f32 v[84:85], v[144:145], v[16:17], v[84:85] op_sel_hi:[0,1,1]
    v_pk_fma_f32 v[86:87], v[144:145], v[18:19], v[86:87] op_sel_hi:[0,1,1]
    v_pk_fma_f32 v[88:89], v[160:161], v[20:21], v[88:89] op_sel_hi:[0,1,1]
    v_pk_fma_f32 v[90:91], v[160:161], v[22:23], v[90:91] op_sel_hi:[0,1,1]
    s_set_gpr_idx_off
    s_waitcnt vmcnt(6)
    v_rcp_f32 v12, v12
    v_mfma_f32_4x4x4_16b_bf16 v[16:19], v[32:33], v[216:217], 0 cbsz:4 abid:13
    v_exp_f32 v15, v163
    v_mfma_f32_4x4x4_16b_bf16 v[20:23], v[32:33], v[218:219], 0 cbsz:4 abid:13
    v_exp_f32 v14, v162
    v_readlane_b32 s57, v7, 14
    v_rcp_f32 v13, v13
    v_pk_add_f32 v[14:15], v[14:15], 1.0 op_sel_hi:[1,0]
    v_pk_mul_f32 v[146:147], v[146:147], v[12:13]
    s_and_b32 s68, s57, 4294966784
    s_set_gpr_idx_on s49, gpr_idx(SRC2,DST)
    buffer_load_dwordx4 v[212:215], v1, s[4:7], s69 offen
    v_pk_fma_f32 v[84:85], v[144:145], v[16:17], v[84:85] op_sel:[1,0,0]
    v_pk_fma_f32 v[86:87], v[144:145], v[18:19], v[86:87] op_sel:[1,0,0]
    v_pk_fma_f32 v[88:89], v[160:161], v[20:21], v[88:89] op_sel:[1,0,0]
    v_pk_fma_f32 v[90:91], v[160:161], v[22:23], v[90:91] op_sel:[1,0,0]
    s_set_gpr_idx_off
    s_cbranch_scc0 L_exit
    s_waitcnt vmcnt(6)
    v_rcp_f32 v14, v14
    v_mfma_f32_4x4x4_16b_bf16 v[16:19], v[32:33], v[220:221], 0 cbsz:4 abid:14
    v_exp_f32 v13, v165
    v_mfma_f32_4x4x4_16b_bf16 v[20:23], v[32:33], v[222:223], 0 cbsz:4 abid:14
    v_exp_f32 v12, v164
    v_readlane_b32 s58, v7, 15
    v_rcp_f32 v15, v15
    v_pk_add_f32 v[12:13], v[12:13], 1.0 op_sel_hi:[1,0]
    v_pk_mul_f32 v[162:163], v[162:163], v[14:15]
    s_and_b32 s69, s58, 4294966784
    s_set_gpr_idx_on s50, gpr_idx(SRC2,DST)
    buffer_load_dwordx4 v[216:219], v1, s[4:7], s68 offen
    v_pk_fma_f32 v[84:85], v[146:147], v[16:17], v[84:85] op_sel_hi:[0,1,1]
    v_pk_fma_f32 v[86:87], v[146:147], v[18:19], v[86:87] op_sel_hi:[0,1,1]
    v_pk_fma_f32 v[88:89], v[162:163], v[20:21], v[88:89] op_sel_hi:[0,1,1]
    v_pk_fma_f32 v[90:91], v[162:163], v[22:23], v[90:91] op_sel_hi:[0,1,1]
    s_set_gpr_idx_off
    s_waitcnt vmcnt(6)
    v_rcp_f32 v12, v12
    v_mfma_f32_4x4x4_16b_bf16 v[16:19], v[32:33], v[224:225], 0 cbsz:4 abid:15
    v_exp_f32 v15, v181
    v_mfma_f32_4x4x4_16b_bf16 v[20:23], v[32:33], v[226:227], 0 cbsz:4 abid:15
    v_exp_f32 v14, v180
    v_readlane_b32 s59, v8, 0
    v_rcp_f32 v13, v13
    v_pk_add_f32 v[14:15], v[14:15], 1.0 op_sel_hi:[1,0]
    v_pk_mul_f32 v[164:165], v[164:165], v[12:13]
    s_and_b32 s68, s59, 4294966784
    s_set_gpr_idx_on s51, gpr_idx(SRC2,DST)
    buffer_load_dwordx4 v[220:223], v1, s[4:7], s69 offen
    v_pk_fma_f32 v[84:85], v[146:147], v[16:17], v[84:85] op_sel:[1,0,0]
    v_pk_fma_f32 v[86:87], v[146:147], v[18:19], v[86:87] op_sel:[1,0,0]
    v_pk_fma_f32 v[88:89], v[162:163], v[20:21], v[88:89] op_sel:[1,0,0]
    v_pk_fma_f32 v[90:91], v[162:163], v[22:23], v[90:91] op_sel:[1,0,0]
    s_set_gpr_idx_off
    s_cbranch_scc0 L_exit
    s_setprio 3
    ds_read_b32 v9, v5 offset:260
    ds_read_b32 v10, v6 offset:260
    ds_read_b32 v7, v4 offset:312
    ds_read_b128 v[132:135], v29
    s_waitcnt vmcnt(6)
    v_rcp_f32 v14, v14
    v_mfma_f32_4x4x4_16b_bf16 v[16:19], v[34:35], v[196:197], 0 cbsz:4 abid:0
    v_exp_f32 v13, v167
    v_mfma_f32_4x4x4_16b_bf16 v[20:23], v[34:35], v[198:199], 0 cbsz:4 abid:0
    v_exp_f32 v12, v166
    v_readlane_b32 s60, v8, 1
    v_rcp_f32 v15, v15
    v_pk_add_f32 v[12:13], v[12:13], 1.0 op_sel_hi:[1,0]
    v_pk_mul_f32 v[180:181], v[180:181], v[14:15]
    s_and_b32 s69, s60, 4294966784
    s_set_gpr_idx_on s52, gpr_idx(SRC2,DST)
    buffer_load_dwordx4 v[224:227], v1, s[4:7], s68 offen
    v_pk_fma_f32 v[84:85], v[164:165], v[16:17], v[84:85] op_sel_hi:[0,1,1]
    v_pk_fma_f32 v[86:87], v[164:165], v[18:19], v[86:87] op_sel_hi:[0,1,1]
    v_pk_fma_f32 v[88:89], v[180:181], v[20:21], v[88:89] op_sel_hi:[0,1,1]
    v_pk_fma_f32 v[90:91], v[180:181], v[22:23], v[90:91] op_sel_hi:[0,1,1]
    s_set_gpr_idx_off
    ds_read_b128 v[136:139], v29
    s_waitcnt vmcnt(6) lgkmcnt(2)
    v_rcp_f32 v12, v12
    v_mfma_f32_4x4x4_16b_bf16 v[16:19], v[34:35], v[200:201], 0 cbsz:4 abid:1
    v_exp_f32 v15, v183
    v_mfma_f32_4x4x4_16b_bf16 v[20:23], v[34:35], v[202:203], 0 cbsz:4 abid:1
    v_exp_f32 v14, v182
    v_readlane_b32 s61, v8, 2
    v_rcp_f32 v13, v13
    v_pk_add_f32 v[14:15], v[14:15], 1.0 op_sel_hi:[1,0]
    v_pk_mul_f32 v[166:167], v[166:167], v[12:13]
    s_and_b32 s68, s61, 4294966784
    s_set_gpr_idx_on s53, gpr_idx(SRC2,DST)
    buffer_load_dwordx4 v[196:199], v1, s[4:7], s69 offen
    v_pk_fma_f32 v[84:85], v[164:165], v[16:17], v[84:85] op_sel:[1,0,0]
    v_pk_fma_f32 v[86:87], v[164:165], v[18:19], v[86:87] op_sel:[1,0,0]
    v_pk_fma_f32 v[88:89], v[180:181], v[20:21], v[88:89] op_sel:[1,0,0]
    v_pk_fma_f32 v[90:91], v[180:181], v[22:23], v[90:91] op_sel:[1,0,0]
    s_set_gpr_idx_off
    s_cbranch_scc0 L_exit
    v_add_u32 v9, v9, v2
    v_add_u32 v10, v10, v3
    ds_read_b128 v[24:27], v9 offset:63232
    ds_read_b64 v[32:33], v10
    ds_read_b128 v[140:143], v29
    s_waitcnt vmcnt(6)
    v_rcp_f32 v14, v14
    v_mfma_f32_4x4x4_16b_bf16 v[16:19], v[34:35], v[204:205], 0 cbsz:4 abid:2
    v_exp_f32 v13, v169
    v_mfma_f32_4x4x4_16b_bf16 v[20:23], v[34:35], v[206:207], 0 cbsz:4 abid:2
    v_exp_f32 v12, v168
    v_readlane_b32 s62, v8, 3
    v_rcp_f32 v15, v15
    v_pk_add_f32 v[12:13], v[12:13], 1.0 op_sel_hi:[1,0]
    v_pk_mul_f32 v[182:183], v[182:183], v[14:15]
    s_and_b32 s69, s62, 4294966784
    s_set_gpr_idx_on s54, gpr_idx(SRC2,DST)
    buffer_load_dwordx4 v[200:203], v1, s[4:7], s68 offen
    v_pk_fma_f32 v[84:85], v[166:167], v[16:17], v[84:85] op_sel_hi:[0,1,1]
    v_pk_fma_f32 v[86:87], v[166:167], v[18:19], v[86:87] op_sel_hi:[0,1,1]
    v_pk_fma_f32 v[88:89], v[182:183], v[20:21], v[88:89] op_sel_hi:[0,1,1]
    v_pk_fma_f32 v[90:91], v[182:183], v[22:23], v[90:91] op_sel_hi:[0,1,1]
    s_set_gpr_idx_off
    ds_read_b128 v[144:147], v29
    s_waitcnt vmcnt(6)
    v_rcp_f32 v12, v12
    v_mfma_f32_4x4x4_16b_bf16 v[16:19], v[34:35], v[208:209], 0 cbsz:4 abid:3
    v_exp_f32 v15, v185
    v_mfma_f32_4x4x4_16b_bf16 v[20:23], v[34:35], v[210:211], 0 cbsz:4 abid:3
    v_exp_f32 v14, v184
    v_readlane_b32 s63, v8, 4
    v_rcp_f32 v13, v13
    v_pk_add_f32 v[14:15], v[14:15], 1.0 op_sel_hi:[1,0]
    v_pk_mul_f32 v[168:169], v[168:169], v[12:13]
    s_and_b32 s68, s63, 4294966784
    s_set_gpr_idx_on s55, gpr_idx(SRC2,DST)
    buffer_load_dwordx4 v[204:207], v1, s[4:7], s69 offen
    v_pk_fma_f32 v[84:85], v[166:167], v[16:17], v[84:85] op_sel:[1,0,0]
    v_pk_fma_f32 v[86:87], v[166:167], v[18:19], v[86:87] op_sel:[1,0,0]
    v_pk_fma_f32 v[88:89], v[182:183], v[20:21], v[88:89] op_sel:[1,0,0]
    v_pk_fma_f32 v[90:91], v[182:183], v[22:23], v[90:91] op_sel:[1,0,0]
    s_set_gpr_idx_off
    s_cbranch_scc0 L_exit
    s_setprio 2
    ds_read_b128 v[148:151], v29
    s_waitcnt vmcnt(6)
    v_rcp_f32 v14, v14
    v_mfma_f32_4x4x4_16b_bf16 v[16:19], v[34:35], v[212:213], 0 cbsz:4 abid:4
    v_exp_f32 v13, v171
    v_mfma_f32_4x4x4_16b_bf16 v[20:23], v[34:35], v[214:215], 0 cbsz:4 abid:4
    v_exp_f32 v12, v170
    v_readlane_b32 s64, v8, 5
    v_rcp_f32 v15, v15
    v_pk_add_f32 v[12:13], v[12:13], 1.0 op_sel_hi:[1,0]
    v_pk_mul_f32 v[184:185], v[184:185], v[14:15]
    s_and_b32 s69, s64, 4294966784
    s_set_gpr_idx_on s56, gpr_idx(SRC2,DST)
    buffer_load_dwordx4 v[208:211], v1, s[4:7], s68 offen
    v_pk_fma_f32 v[84:85], v[168:169], v[16:17], v[84:85] op_sel_hi:[0,1,1]
    v_pk_fma_f32 v[86:87], v[168:169], v[18:19], v[86:87] op_sel_hi:[0,1,1]
    v_pk_fma_f32 v[88:89], v[184:185], v[20:21], v[88:89] op_sel_hi:[0,1,1]
    v_pk_fma_f32 v[90:91], v[184:185], v[22:23], v[90:91] op_sel_hi:[0,1,1]
    s_set_gpr_idx_off
    ds_read_b128 v[152:155], v29
    s_waitcnt vmcnt(6)
    v_rcp_f32 v12, v12
    v_mfma_f32_4x4x4_16b_bf16 v[16:19], v[34:35], v[216:217], 0 cbsz:4 abid:5
    v_exp_f32 v15, v187
    v_mfma_f32_4x4x4_16b_bf16 v[20:23], v[34:35], v[218:219], 0 cbsz:4 abid:5
    v_exp_f32 v14, v186
    v_readlane_b32 s65, v8, 6
    v_rcp_f32 v13, v13
    v_pk_add_f32 v[14:15], v[14:15], 1.0 op_sel_hi:[1,0]
    v_pk_mul_f32 v[170:171], v[170:171], v[12:13]
    s_and_b32 s68, s65, 4294966784
    s_set_gpr_idx_on s57, gpr_idx(SRC2,DST)
    buffer_load_dwordx4 v[212:215], v1, s[4:7], s69 offen
    v_pk_fma_f32 v[84:85], v[168:169], v[16:17], v[84:85] op_sel:[1,0,0]
    v_pk_fma_f32 v[86:87], v[168:169], v[18:19], v[86:87] op_sel:[1,0,0]
    v_pk_fma_f32 v[88:89], v[184:185], v[20:21], v[88:89] op_sel:[1,0,0]
    v_pk_fma_f32 v[90:91], v[184:185], v[22:23], v[90:91] op_sel:[1,0,0]
    s_set_gpr_idx_off
    s_cbranch_scc0 L_exit
    ds_read_b128 v[156:159], v29
    s_waitcnt vmcnt(6)
    v_rcp_f32 v14, v14
    v_mfma_f32_4x4x4_16b_bf16 v[16:19], v[34:35], v[220:221], 0 cbsz:4 abid:6
    v_exp_f32 v13, v173
    v_mfma_f32_4x4x4_16b_bf16 v[20:23], v[34:35], v[222:223], 0 cbsz:4 abid:6
    v_exp_f32 v12, v172
    v_readlane_b32 s66, v8, 7
    v_rcp_f32 v15, v15
    v_pk_add_f32 v[12:13], v[12:13], 1.0 op_sel_hi:[1,0]
    v_pk_mul_f32 v[186:187], v[186:187], v[14:15]
    s_and_b32 s69, s66, 4294966784
    s_set_gpr_idx_on s58, gpr_idx(SRC2,DST)
    buffer_load_dwordx4 v[216:219], v1, s[4:7], s68 offen
    v_pk_fma_f32 v[84:85], v[170:171], v[16:17], v[84:85] op_sel_hi:[0,1,1]
    v_pk_fma_f32 v[86:87], v[170:171], v[18:19], v[86:87] op_sel_hi:[0,1,1]
    v_pk_fma_f32 v[88:89], v[186:187], v[20:21], v[88:89] op_sel_hi:[0,1,1]
    v_pk_fma_f32 v[90:91], v[186:187], v[22:23], v[90:91] op_sel_hi:[0,1,1]
    s_set_gpr_idx_off
    ds_read_b128 v[160:163], v29
    s_waitcnt vmcnt(6)
    v_rcp_f32 v12, v12
    v_mfma_f32_4x4x4_16b_bf16 v[16:19], v[34:35], v[224:225], 0 cbsz:4 abid:7
    v_exp_f32 v15, v189
    v_mfma_f32_4x4x4_16b_bf16 v[20:23], v[34:35], v[226:227], 0 cbsz:4 abid:7
    v_exp_f32 v14, v188
    v_readlane_b32 s67, v8, 8
    v_rcp_f32 v13, v13
    v_pk_add_f32 v[14:15], v[14:15], 1.0 op_sel_hi:[1,0]
    v_pk_mul_f32 v[172:173], v[172:173], v[12:13]
    s_and_b32 s68, s67, 4294966784
    s_set_gpr_idx_on s59, gpr_idx(SRC2,DST)
    buffer_load_dwordx4 v[220:223], v1, s[4:7], s69 offen
    v_pk_fma_f32 v[84:85], v[170:171], v[16:17], v[84:85] op_sel:[1,0,0]
    v_pk_fma_f32 v[86:87], v[170:171], v[18:19], v[86:87] op_sel:[1,0,0]
    v_pk_fma_f32 v[88:89], v[186:187], v[20:21], v[88:89] op_sel:[1,0,0]
    v_pk_fma_f32 v[90:91], v[186:187], v[22:23], v[90:91] op_sel:[1,0,0]
    s_set_gpr_idx_off
    s_cbranch_scc0 L_exit
    s_setprio 1
    s_waitcnt vmcnt(6)
    v_rcp_f32 v14, v14
    v_mfma_f32_4x4x4_16b_bf16 v[16:19], v[34:35], v[196:197], 0 cbsz:4 abid:8
    v_exp_f32 v13, v175
    v_mfma_f32_4x4x4_16b_bf16 v[20:23], v[34:35], v[198:199], 0 cbsz:4 abid:8
    v_exp_f32 v12, v174
    v_readlane_b32 s36, v8, 9
    v_rcp_f32 v15, v15
    v_pk_add_f32 v[12:13], v[12:13], 1.0 op_sel_hi:[1,0]
    v_pk_mul_f32 v[188:189], v[188:189], v[14:15]
    s_and_b32 s69, s36, 4294966784
    s_set_gpr_idx_on s60, gpr_idx(SRC2,DST)
    buffer_load_dwordx4 v[224:227], v1, s[4:7], s68 offen
    v_pk_fma_f32 v[84:85], v[172:173], v[16:17], v[84:85] op_sel_hi:[0,1,1]
    v_pk_fma_f32 v[86:87], v[172:173], v[18:19], v[86:87] op_sel_hi:[0,1,1]
    v_pk_fma_f32 v[88:89], v[188:189], v[20:21], v[88:89] op_sel_hi:[0,1,1]
    v_pk_fma_f32 v[90:91], v[188:189], v[22:23], v[90:91] op_sel_hi:[0,1,1]
    s_set_gpr_idx_off
    s_waitcnt vmcnt(6) lgkmcnt(0)
    v_mfma_f32_4x4x4_16b_bf16 v[20:23], v[34:35], v[202:203], 0 cbsz:4 abid:9
    v_mfma_f32_4x4x4_16b_bf16 v[16:19], v[34:35], v[200:201], 0 cbsz:4 abid:9
    v_rcp_f32 v13, v13
    v_smfmac_f32_32x32x32_bf16 v[132:147], v[24:27], v[36:43], v28
    v_exp_f32 v14, v190
    v_exp_f32 v15, v191
    v_readlane_b32 s37, v8, 10
    v_rcp_f32 v12, v12
    v_pk_add_f32 v[14:15], v[14:15], 1.0 op_sel_hi:[1,0]
    v_pk_mul_f32 v[174:175], v[174:175], v[12:13]
    s_and_b32 s68, s37, 4294966784
    s_set_gpr_idx_on s61, gpr_idx(SRC2,DST)
    buffer_load_dwordx4 v[196:199], v1, s[4:7], s69 offen
    v_pk_fma_f32 v[84:85], v[172:173], v[16:17], v[84:85] op_sel:[1,0,0]
    v_pk_fma_f32 v[86:87], v[172:173], v[18:19], v[86:87] op_sel:[1,0,0]
    v_pk_fma_f32 v[88:89], v[188:189], v[20:21], v[88:89] op_sel:[1,0,0]
    v_pk_fma_f32 v[90:91], v[188:189], v[22:23], v[90:91] op_sel:[1,0,0]
    s_set_gpr_idx_off
    s_cbranch_scc0 L_exit
    s_waitcnt vmcnt(6)
    v_rcp_f32 v14, v14
    v_mfma_f32_4x4x4_16b_bf16 v[16:19], v[34:35], v[204:205], 0 cbsz:4 abid:10
    v_exp_f32 v13, v177
    v_mfma_f32_4x4x4_16b_bf16 v[20:23], v[34:35], v[206:207], 0 cbsz:4 abid:10
    v_exp_f32 v12, v176
    v_readlane_b32 s38, v8, 11
    v_rcp_f32 v15, v15
    v_pk_add_f32 v[12:13], v[12:13], 1.0 op_sel_hi:[1,0]
    v_pk_mul_f32 v[190:191], v[190:191], v[14:15]
    s_and_b32 s69, s38, 4294966784
    s_set_gpr_idx_on s62, gpr_idx(SRC2,DST)
    buffer_load_dwordx4 v[200:203], v1, s[4:7], s68 offen
    v_pk_fma_f32 v[84:85], v[174:175], v[16:17], v[84:85] op_sel_hi:[0,1,1]
    v_pk_fma_f32 v[86:87], v[174:175], v[18:19], v[86:87] op_sel_hi:[0,1,1]
    v_pk_fma_f32 v[88:89], v[190:191], v[20:21], v[88:89] op_sel_hi:[0,1,1]
    v_pk_fma_f32 v[90:91], v[190:191], v[22:23], v[90:91] op_sel_hi:[0,1,1]
    s_set_gpr_idx_off
    s_waitcnt vmcnt(6)
    v_mfma_f32_4x4x4_16b_bf16 v[20:23], v[34:35], v[210:211], 0 cbsz:4 abid:11
    v_mfma_f32_4x4x4_16b_bf16 v[16:19], v[34:35], v[208:209], 0 cbsz:4 abid:11
    v_rcp_f32 v13, v13
    v_smfmac_f32_32x32x32_bf16 v[148:163], v[24:27], v[44:51], v28
    v_exp_f32 v14, v192
    v_exp_f32 v15, v193
    v_readlane_b32 s39, v8, 12
    v_rcp_f32 v12, v12
    v_pk_add_f32 v[14:15], v[14:15], 1.0 op_sel_hi:[1,0]
    v_pk_mul_f32 v[176:177], v[176:177], v[12:13]
    s_and_b32 s68, s39, 4294966784
    s_set_gpr_idx_on s63, gpr_idx(SRC2,DST)
    buffer_load_dwordx4 v[204:207], v1, s[4:7], s69 offen
    v_pk_fma_f32 v[84:85], v[174:175], v[16:17], v[84:85] op_sel:[1,0,0]
    v_pk_fma_f32 v[86:87], v[174:175], v[18:19], v[86:87] op_sel:[1,0,0]
    v_pk_fma_f32 v[88:89], v[190:191], v[20:21], v[88:89] op_sel:[1,0,0]
    v_pk_fma_f32 v[90:91], v[190:191], v[22:23], v[90:91] op_sel:[1,0,0]
    s_set_gpr_idx_off
    s_cbranch_scc0 L_exit
    s_setprio 0
    s_waitcnt vmcnt(6)
    v_rcp_f32 v14, v14
    v_mfma_f32_4x4x4_16b_bf16 v[16:19], v[34:35], v[212:213], 0 cbsz:4 abid:12
    v_exp_f32 v13, v179
    v_mfma_f32_4x4x4_16b_bf16 v[20:23], v[34:35], v[214:215], 0 cbsz:4 abid:12
    v_exp_f32 v12, v178
    v_readlane_b32 s40, v8, 13
    v_rcp_f32 v15, v15
    v_pk_add_f32 v[12:13], v[12:13], 1.0 op_sel_hi:[1,0]
    v_pk_mul_f32 v[192:193], v[192:193], v[14:15]
    s_and_b32 s69, s40, 4294966784
    s_set_gpr_idx_on s64, gpr_idx(SRC2,DST)
    buffer_load_dwordx4 v[208:211], v1, s[4:7], s68 offen
    v_pk_fma_f32 v[84:85], v[176:177], v[16:17], v[84:85] op_sel_hi:[0,1,1]
    v_pk_fma_f32 v[86:87], v[176:177], v[18:19], v[86:87] op_sel_hi:[0,1,1]
    v_pk_fma_f32 v[88:89], v[192:193], v[20:21], v[88:89] op_sel_hi:[0,1,1]
    v_pk_fma_f32 v[90:91], v[192:193], v[22:23], v[90:91] op_sel_hi:[0,1,1]
    s_set_gpr_idx_off
    s_waitcnt vmcnt(6)
    v_rcp_f32 v12, v12
    v_mfma_f32_4x4x4_16b_bf16 v[16:19], v[34:35], v[216:217], 0 cbsz:4 abid:13
    v_exp_f32 v15, v195
    v_mfma_f32_4x4x4_16b_bf16 v[20:23], v[34:35], v[218:219], 0 cbsz:4 abid:13
    v_exp_f32 v14, v194
    v_readlane_b32 s41, v8, 14
    v_rcp_f32 v13, v13
    v_pk_add_f32 v[14:15], v[14:15], 1.0 op_sel_hi:[1,0]
    v_pk_mul_f32 v[178:179], v[178:179], v[12:13]
    s_and_b32 s68, s41, 4294966784
    s_set_gpr_idx_on s65, gpr_idx(SRC2,DST)
    buffer_load_dwordx4 v[212:215], v1, s[4:7], s69 offen
    v_pk_fma_f32 v[84:85], v[176:177], v[16:17], v[84:85] op_sel:[1,0,0]
    v_pk_fma_f32 v[86:87], v[176:177], v[18:19], v[86:87] op_sel:[1,0,0]
    v_pk_fma_f32 v[88:89], v[192:193], v[20:21], v[88:89] op_sel:[1,0,0]
    v_pk_fma_f32 v[90:91], v[192:193], v[22:23], v[90:91] op_sel:[1,0,0]
    s_set_gpr_idx_off
    s_cbranch_scc0 L_exit
    s_waitcnt vmcnt(6)
    v_rcp_f32 v14, v14
    v_mfma_f32_4x4x4_16b_bf16 v[16:19], v[34:35], v[220:221], 0 cbsz:4 abid:14
    v_exp_f32 v13, v133
    v_mfma_f32_4x4x4_16b_bf16 v[20:23], v[34:35], v[222:223], 0 cbsz:4 abid:14
    v_exp_f32 v12, v132
    v_readlane_b32 s42, v8, 15
    v_rcp_f32 v15, v15
    v_pk_add_f32 v[12:13], v[12:13], 1.0 op_sel_hi:[1,0]
    v_pk_mul_f32 v[194:195], v[194:195], v[14:15]
    s_and_b32 s69, s42, 4294966784
    s_set_gpr_idx_on s66, gpr_idx(SRC2,DST)
    buffer_load_dwordx4 v[216:219], v1, s[4:7], s68 offen
    v_pk_fma_f32 v[84:85], v[178:179], v[16:17], v[84:85] op_sel_hi:[0,1,1]
    v_pk_fma_f32 v[86:87], v[178:179], v[18:19], v[86:87] op_sel_hi:[0,1,1]
    v_pk_fma_f32 v[88:89], v[194:195], v[20:21], v[88:89] op_sel_hi:[0,1,1]
    v_pk_fma_f32 v[90:91], v[194:195], v[22:23], v[90:91] op_sel_hi:[0,1,1]
    s_set_gpr_idx_off
    s_waitcnt vmcnt(6)
    v_rcp_f32 v12, v12
    v_mfma_f32_4x4x4_16b_bf16 v[16:19], v[34:35], v[224:225], 0 cbsz:4 abid:15
    v_exp_f32 v15, v149
    v_mfma_f32_4x4x4_16b_bf16 v[20:23], v[34:35], v[226:227], 0 cbsz:4 abid:15
    v_exp_f32 v14, v148
    v_readlane_b32 s43, v7, 0
    v_rcp_f32 v13, v13
    v_pk_add_f32 v[14:15], v[14:15], 1.0 op_sel_hi:[1,0]
    v_pk_mul_f32 v[132:133], v[132:133], v[12:13]
    s_and_b32 s68, s43, 4294966784
    s_set_gpr_idx_on s67, gpr_idx(SRC2,DST)
    buffer_load_dwordx4 v[220:223], v1, s[4:7], s69 offen
    v_pk_fma_f32 v[84:85], v[178:179], v[16:17], v[84:85] op_sel:[1,0,0]
    v_pk_fma_f32 v[86:87], v[178:179], v[18:19], v[86:87] op_sel:[1,0,0]
    v_pk_fma_f32 v[88:89], v[194:195], v[20:21], v[88:89] op_sel:[1,0,0]
    v_pk_fma_f32 v[90:91], v[194:195], v[22:23], v[90:91] op_sel:[1,0,0]
    s_set_gpr_idx_off
    s_cbranch_scc0 L_exit
    v_add_u32 v4, 256, v4
    v_add_u32 v5, 256, v5
    v_add_u32 v6, 256, v6
    s_branch L_loop
L_giveup:
    s_mov_b64 exec, -1
    v_mov_b64 v[164:165], 0
    v_mov_b64 v[166:167], 0
    v_add_u32 v168, 161536, v1
    ds_write_b128 v168, v[164:167]
    v_mov_b32 v172, 0x00300000
    v_mov_b32 v173, 0x00300000
    v_mov_b32 v174, 0x00300000
    v_mov_b32 v175, 0x00300000
    ds_write_b128 v1, v[172:175] offset:20224
    ds_write_b128 v1, v[172:175] offset:21248
    ds_write_b128 v1, v[172:175] offset:22272
    ds_write_b128 v1, v[172:175] offset:23296
    ds_write_b128 v1, v[172:175] offset:24320
    ds_write_b128 v1, v[172:175] offset:25344
    s_branch L_fok
L_more:
    s_waitcnt vmcnt(0) lgkmcnt(0)
    s_barrier
    v_lshlrev_b32 v188, 4, v0
    v_add_u32 v189, 8192, v188
    v_add_u32 v190, 16384, v188
    v_add_u32 v191, 24576, v188
    v_add_u32 v192, 32768, v188
    v_add_u32 v193, 40960, v188
    v_lshlrev_b32 v194, 2, v0
    v_lshlrev_b32 v14, 3, v0
    v_mov_b32 v16, 0
    v_mov_b32 v17, 0
    v_mov_b32 v15, 0x00300000
    ds_write_b64 v14, v[16:17] offset:16128
    ds_write_b32 v194, v15 offset:20224
    ds_write_b32 v194, v15 offset:22272
    ds_write_b32 v194, v15 offset:24320
    v_lshrrev_b32 v195, 1, v0
    v_lshlrev_b32 v195, 2, v195
    s_branch L_round
L_exit:
    s_add_u32 s28, s28, 1536
    s_cmp_lt_u32 s28, s25
    s_cbranch_scc1 L_more
    s_mov_b32 s68, 0xbf317218
    s_mov_b32 s69, s68
    s_and_b32 s3, s96, 0xffff
    s_mul_i32 m0, s3, 288
    v_pk_mul_f32 v[84:85], v[84:85], s[68:69]
    v_pk_mul_f32 v[86:87], v[86:87], s[68:69]
    v_pk_mul_f32 v[88:89], v[88:89], s[68:69]
    v_pk_mul_f32 v[90:91], v[90:91], s[68:69]
    v_cvt_pk_bf16_f32 v84, v84, v88
    v_cvt_pk_bf16_f32 v85, v85, v89
    v_cvt_pk_bf16_f32 v86, v86, v90
    v_cvt_pk_bf16_f32 v87, v87, v91
    ds_write_addtid_b32 v84 offset:16128
    ds_write_addtid_b32 v85 offset:16416
    ds_write_addtid_b32 v86 offset:16704
    ds_write_addtid_b32 v87 offset:16992
    s_and_b32 s3, s97, 0xffff
    s_mul_i32 m0, s3, 288
    v_pk_mul_f32 v[92:93], v[92:93], s[68:69]
    v_pk_mul_f32 v[94:95], v[94:95], s[68:69]
    v_pk_mul_f32 v[96:97], v[96:97], s[68:69]
    v_pk_mul_f32 v[98:99], v[98:99], s[68:69]
    v_cvt_pk_bf16_f32 v92, v92, v96
    v_cvt_pk_bf16_f32 v93, v93, v97
    v_cvt_pk_bf16_f32 v94, v94, v98
    v_cvt_pk_bf16_f32 v95, v95, v99
    ds_write_addtid_b32 v92 offset:16128
    ds_write_addtid_b32 v93 offset:16416
    ds_write_addtid_b32 v94 offset:16704
    ds_write_addtid_b32 v95 offset:16992
    s_and_b32 s3, s98, 0xffff
    s_mul_i32 m0, s3, 288
    v_pk_mul_f32 v[100:101], v[100:101], s[68:69]
    v_pk_mul_f32 v[102:103], v[102:103], s[68:69]
    v_pk_mul_f32 v[104:105], v[104:105], s[68:69]
    v_pk_mul_f32 v[106:107], v[106:107], s[68:69]
    v_cvt_pk_bf16_f32 v100, v100, v104
    v_cvt_pk_bf16_f32 v101, v101, v105
    v_cvt_pk_bf16_f32 v102, v102, v106
    v_cvt_pk_bf16_f32 v103, v103, v107
    ds_write_addtid_b32 v100 offset:16128
    ds_write_addtid_b32 v101 offset:16416
    ds_write_addtid_b32 v102 offset:16704
    ds_write_addtid_b32 v103 offset:16992
    s_and_b32 s3, s99, 0xffff
    s_mul_i32 m0, s3, 288
    v_pk_mul_f32 v[108:109], v[108:109], s[68:69]
    v_pk_mul_f32 v[110:111], v[110:111], s[68:69]
    v_pk_mul_f32 v[112:113], v[112:113], s[68:69]
    v_pk_mul_f32 v[114:115], v[114:115], s[68:69]
    v_cvt_pk_bf16_f32 v108, v108, v112
    v_cvt_pk_bf16_f32 v109, v109, v113
    v_cvt_pk_bf16_f32 v110, v110, v114
    v_cvt_pk_bf16_f32 v111, v111, v115
    ds_write_addtid_b32 v108 offset:16128
    ds_write_addtid_b32 v109 offset:16416
    ds_write_addtid_b32 v110 offset:16704
    ds_write_addtid_b32 v111 offset:16992
    s_and_b32 s3, s100, 0xffff
    s_mul_i32 m0, s3, 288
    v_pk_mul_f32 v[116:117], v[116:117], s[68:69]
    v_pk_mul_f32 v[118:119], v[118:119], s[68:69]
    v_pk_mul_f32 v[120:121], v[120:121], s[68:69]
    v_pk_mul_f32 v[122:123], v[122:123], s[68:69]
    v_cvt_pk_bf16_f32 v116, v116, v120
    v_cvt_pk_bf16_f32 v117, v117, v121
    v_cvt_pk_bf16_f32 v118, v118, v122
    v_cvt_pk_bf16_f32 v119, v119, v123
    ds_write_addtid_b32 v116 offset:16128
    ds_write_addtid_b32 v117 offset:16416
    ds_write_addtid_b32 v118 offset:16704
    ds_write_addtid_b32 v119 offset:16992
    s_waitcnt lgkmcnt(0)
    s_barrier
    ds_read_b128 v[84:87], v30 offset:16128
    ds_read_b128 v[88:91], v30 offset:16192
    ds_read_b128 v[92:95], v30 offset:16256
    ds_read_b128 v[96:99], v30 offset:16320
    ds_read_b128 v[100:103], v30 offset:20736
    ds_read_b128 v[104:107], v30 offset:20800
    ds_read_b128 v[108:111], v30 offset:20864
    ds_read_b128 v[112:115], v30 offset:20928
    s_waitcnt lgkmcnt(7)
    v_mfma_f32_16x16x32_bf16 v[116:119], v[84:87], v[52:55], 0
    v_mfma_f32_16x16x32_bf16 v[120:123], v[84:87], v[56:59], 0
    s_waitcnt lgkmcnt(6)
    v_mfma_f32_16x16x32_bf16 v[116:119], v[88:91], v[60:63], v[116:119]
    v_mfma_f32_16x16x32_bf16 v[120:123], v[88:91], v[64:67], v[120:123]
    s_waitcnt lgkmcnt(5)
    v_mfma_f32_16x16x32_bf16 v[116:119], v[92:95], v[68:71], v[116:119]
    v_mfma_f32_16x16x32_bf16 v[120:123], v[92:95], v[72:75], v[120:123]
    s_waitcnt lgkmcnt(4)
    v_mfma_f32_16x16x32_bf16 v[116:119], v[96:99], v[76:79], v[116:119]
    v_mfma_f32_16x16x32_bf16 v[120:123], v[96:99], v[80:83], v[120:123]
    ds_read_b128 v[84:87], v30 offset:25344
    ds_read_b128 v[88:91], v30 offset:25408
    ds_read_b128 v[92:95], v30 offset:25472
    ds_read_b128 v[96:99], v30 offset:25536
    s_waitcnt lgkmcnt(7)
    v_mfma_f32_16x16x32_bf16 v[124:127], v[100:103], v[52:55], 0
    v_mfma_f32_16x16x32_bf16 v[128:131], v[100:103], v[56:59], 0
    s_waitcnt lgkmcnt(6)
    v_mfma_f32_16x16x32_bf16 v[124:127], v[104:107], v[60:63], v[124:127]
    v_cvt_pk_bf16_f32 v44, v116, v117
    v_cvt_pk_bf16_f32 v45, v118, v119
    v_mfma_f32_16x16x32_bf16 v[128:131], v[104:107], v[64:67], v[128:131]
    v_cvt_pk_bf16_f32 v46, v120, v121
    v_cvt_pk_bf16_f32 v47, v122, v123
    s_waitcnt lgkmcnt(5)
    v_mfma_f32_16x16x32_bf16 v[124:127], v[108:111], v[68:71], v[124:127]
    s_mov_b32 s3, 0
    buffer_store_dwordx4 v[44:47], v31, s[16:19], s3 offen sc0 sc1
    v_mfma_f32_16x16x32_bf16 v[128:131], v[108:111], v[72:75], v[128:131]
    s_waitcnt lgkmcnt(4)
    v_mfma_f32_16x16x32_bf16 v[124:127], v[112:115], v[76:79], v[124:127]
    v_mfma_f32_16x16x32_bf16 v[128:131], v[112:115], v[80:83], v[128:131]
    ds_read_b128 v[100:103], v30 offset:29952
    ds_read_b128 v[104:107], v30 offset:30016
    ds_read_b128 v[108:111], v30 offset:30080
    ds_read_b128 v[112:115], v30 offset:30144
    s_waitcnt lgkmcnt(7)
    v_mfma_f32_16x16x32_bf16 v[116:119], v[84:87], v[52:55], 0
    v_mfma_f32_16x16x32_bf16 v[120:123], v[84:87], v[56:59], 0
    s_waitcnt lgkmcnt(6)
    v_mfma_f32_16x16x32_bf16 v[116:119], v[88:91], v[60:63], v[116:119]
    v_cvt_pk_bf16_f32 v48, v124, v125
    v_cvt_pk_bf16_f32 v49, v126, v127
    v_mfma_f32_16x16x32_bf16 v[120:123], v[88:91], v[64:67], v[120:123]
    v_cvt_pk_bf16_f32 v50, v128, v129
    v_cvt_pk_bf16_f32 v51, v130, v131
    s_waitcnt lgkmcnt(5)
    v_mfma_f32_16x16x32_bf16 v[116:119], v[92:95], v[68:71], v[116:119]
    s_mov_b32 s3, 1048576
    buffer_store_dwordx4 v[48:51], v31, s[16:19], s3 offen sc0 sc1
    v_mfma_f32_16x16x32_bf16 v[120:123], v[92:95], v[72:75], v[120:123]
    s_waitcnt lgkmcnt(4)
    v_mfma_f32_16x16x32_bf16 v[116:119], v[96:99], v[76:79], v[116:119]
    v_mfma_f32_16x16x32_bf16 v[120:123], v[96:99], v[80:83], v[120:123]
    ds_read_b128 v[84:87], v30 offset:34560
    ds_read_b128 v[88:91], v30 offset:34624
    ds_read_b128 v[92:95], v30 offset:34688
    ds_read_b128 v[96:99], v30 offset:34752
    s_waitcnt lgkmcnt(7)
    v_mfma_f32_16x16x32_bf16 v[124:127], v[100:103], v[52:55], 0
    v_mfma_f32_16x16x32_bf16 v[128:131], v[100:103], v[56:59], 0
    s_waitcnt lgkmcnt(6)
    v_mfma_f32_16x16x32_bf16 v[124:127], v[104:107], v[60:63], v[124:127]
    v_cvt_pk_bf16_f32 v44, v116, v117
    v_cvt_pk_bf16_f32 v45, v118, v119
    v_mfma_f32_16x16x32_bf16 v[128:131], v[104:107], v[64:67], v[128:131]
    v_cvt_pk_bf16_f32 v46, v120, v121
    v_cvt_pk_bf16_f32 v47, v122, v123
    s_waitcnt lgkmcnt(5)
    v_mfma_f32_16x16x32_bf16 v[124:127], v[108:111], v[68:71], v[124:127]
    s_mov_b32 s3, 2097152
    buffer_store_dwordx4 v[44:47], v31, s[16:19], s3 offen sc0 sc1
    v_mfma_f32_16x16x32_bf16 v[128:131], v[108:111], v[72:75], v[128:131]
    s_waitcnt lgkmcnt(4)
    v_mfma_f32_16x16x32_bf16 v[124:127], v[112:115], v[76:79], v[124:127]
    v_mfma_f32_16x16x32_bf16 v[128:131], v[112:115], v[80:83], v[128:131]
    s_nop 3
    s_waitcnt lgkmcnt(3)
    v_mfma_f32_16x16x32_bf16 v[116:119], v[84:87], v[52:55], 0
    v_mfma_f32_16x16x32_bf16 v[120:123], v[84:87], v[56:59], 0
    s_waitcnt lgkmcnt(2)
    v_mfma_f32_16x16x32_bf16 v[116:119], v[88:91], v[60:63], v[116:119]
    v_cvt_pk_bf16_f32 v48, v124, v125
    v_cvt_pk_bf16_f32 v49, v126, v127
    v_mfma_f32_16x16x32_bf16 v[120:123], v[88:91], v[64:67], v[120:123]
    v_cvt_pk_bf16_f32 v50, v128, v129
    v_cvt_pk_bf16_f32 v51, v130, v131
    s_waitcnt lgkmcnt(1)
    v_mfma_f32_16x16x32_bf16 v[116:119], v[92:95], v[68:71], v[116:119]
    s_mov_b32 s3, 3145728
    buffer_store_dwordx4 v[48:51], v31, s[16:19], s3 offen sc0 sc1
    v_mfma_f32_16x16x32_bf16 v[120:123], v[92:95], v[72:75], v[120:123]
    s_waitcnt lgkmcnt(0)
    v_mfma_f32_16x16x32_bf16 v[116:119], v[96:99], v[76:79], v[116:119]
    v_mfma_f32_16x16x32_bf16 v[120:123], v[96:99], v[80:83], v[120:123]
    s_or_b32 s31, s2, s24
    s_cbranch_scc1 L_noep
    v_lshlrev_b32 v36, 2, v11
    v_mov_b32 v37, s26
    global_store_dword v36, v37, s[22:23] offset:0 sc0 sc1
L_noep:
    s_nop 5
    v_cvt_pk_bf16_f32 v44, v116, v117
    v_cvt_pk_bf16_f32 v45, v118, v119
    v_cvt_pk_bf16_f32 v46, v120, v121
    v_cvt_pk_bf16_f32 v47, v122, v123
    s_mov_b32 s3, 4194304
    buffer_store_dwordx4 v[44:47], v31, s[16:19], s3 offen sc0 sc1
L_end:
    s_endpgm
.section .rodata,"a"
.p2align 6
.amdhsa_kernel standalone__tensor_product_equiv_tfn__graph_kernel
  .amdhsa_next_free_vgpr 230
  .amdhsa_next_free_sgpr 102
  .amdhsa_accum_offset 232
  .amdhsa_group_segment_fixed_size 0
  .amdhsa_kernarg_size 88
  .amdhsa_user_sgpr_count 2
  .amdhsa_user_sgpr_kernarg_segment_ptr 1
  .amdhsa_system_sgpr_workgroup_id_x 1
  .amdhsa_float_denorm_mode_32 3
.end_amdhsa_kernel
```

```asm
; @launch grid=(256,1,1) block=(512,1,1) lds=163600
.amdgcn_target "amdgcn-amd-amdhsa--gfx950"
.text
.globl standalone__tensor_product_equiv_tfn__graph_kernel
.p2align 8
.type standalone__tensor_product_equiv_tfn__graph_kernel,@function
standalone__tensor_product_equiv_tfn__graph_kernel:
    s_load_dwordx16 s[4:19], s[0:1], 0
    s_load_dwordx2 s[22:23], s[0:1], 80
    s_load_dwordx2 s[20:21], s[0:1], 64
    s_cmp_ge_u32 s2, 256
    s_cbranch_scc1 L_end
    v_mul_u32_u24 v172, 3, v0
    s_mul_i32 s3, s2, 1250
    v_min_u32 v172, 1247, v172
    v_add_lshl_u32 v173, v172, s3, 2
    v_lshrrev_b32 v12, 6, v0
    v_and_b32 v13, 255, v0
    v_lshlrev_b32 v13, 2, v13
    v_mov_b32 v16, 0
    v_readfirstlane_b32 s24, v12
    ds_write_b32 v13, v16 offset:0
    v_lshlrev_b32 v174, 1, v173
    s_waitcnt lgkmcnt(0)
    global_load_dwordx3 v[132:134], v173, s[8:9]
    s_load_dword s26, s[22:23], 0
    s_barrier
    global_load_dwordx3 v[136:138], v173, s[6:7]
    global_load_dwordx4 v[140:143], v174, s[10:11]
    global_load_dwordx2 v[144:145], v174, s[10:11] offset:16
    v_lshlrev_b32 v188, 4, v0
    v_and_b32 v11, 63, v0
    s_lshl_b32 s30, s24, 10
    s_lshl_b32 s3, s3, 5
    s_add_u32 s12, s12, s3
    s_addc_u32 s13, s13, 0
    v_add_u32 v189, 8192, v188
    v_add_u32 v190, 16384, v188
    v_add_u32 v191, 24576, v188
    v_add_u32 v192, 32768, v188
    v_add_u32 v193, 40960, v188
    v_min_u32 v175, 39984, v192
    v_lshlrev_b32 v1, 4, v11
    s_barrier
    s_add_u32 m0, s30, 112384
    s_nop 0
    global_load_lds_dwordx4 v188, s[12:13]
    s_add_u32 m0, s30, 120576
    s_nop 0
    global_load_lds_dwordx4 v189, s[12:13]
    s_cmp_eq_u32 s24, 7
    s_cbranch_scc0 L_nocpf
    s_cmp_lt_u32 s2, 8
    s_cbranch_scc0 L_nocpf
    s_getpc_b64 s[68:69]
L_pc:
    v_lshlrev_b32 v18, 7, v11
    v_mov_b32 v19, 0
    v_lshl_add_u64 v[20:21], v[18:19], 0, s[68:69]
    global_load_dword v204, v[20:21], off
    v_min_u32 v18, L_end-L_pc-8192, v18
    v_add_u32 v18, 8192, v18
    v_lshl_add_u64 v[20:21], v[18:19], 0, s[68:69]
    global_load_dword v205, v[20:21], off
    s_mul_i32 s3, s2, 1024
    s_add_u32 s3, s3, 589824
    v_min_u32 v18, 7, v11
    v_lshl_add_u32 v18, v18, 7, s3
    global_load_dword v211, v18, s[22:23] sc1
L_nocpf:
    v_lshlrev_b32 v194, 2, v0
    v_lshlrev_b32 v14, 3, v0
    v_mov_b32 v16, 0
    v_mov_b32 v17, 0
    v_mov_b32 v15, 0x00300000
    ds_write_b64 v14, v[16:17] offset:16128
    ds_write_b32 v194, v15 offset:20224
    ds_write_b32 v194, v15 offset:22272
    ds_write_b32 v194, v15 offset:24320
    v_lshrrev_b32 v195, 1, v0
    v_lshlrev_b32 v195, 2, v195
    v_cmp_gt_u32 vcc, 416, v0
    s_mov_b64 s[36:37], vcc
    v_cmp_gt_u32 vcc, 417, v0
    s_mov_b64 s[38:39], vcc
    v_mov_b32 v12, 1
    s_movk_i32 s40, 1250
    s_mov_b32 s41, 63232
    s_lshr_b32 s27, s24, 2
    s_mov_b32 s28, 0
    s_waitcnt vmcnt(5)
    s_mov_b64 exec, s[38:39]
    v_and_b32 v153, 7, v133
    v_bfe_u32 v150, v133, 3, 5
    v_lshl_add_u32 v147, v153, 5, v150
    v_lshlrev_b32 v147, 2, v147
    ds_add_rtn_u32 v150, v147, v12 offset:0
    v_and_b32 v154, 7, v134
    v_bfe_u32 v151, v134, 3, 5
    v_lshl_add_u32 v148, v154, 5, v151
    v_lshlrev_b32 v148, 2, v148
    ds_add_rtn_u32 v151, v148, v12 offset:0
    s_mov_b64 exec, s[36:37]
    v_and_b32 v152, 7, v132
    v_bfe_u32 v149, v132, 3, 5
    v_lshl_add_u32 v146, v152, 5, v149
    v_lshlrev_b32 v146, 2, v146
    ds_add_rtn_u32 v149, v146, v12 offset:0
    s_mov_b64 exec, -1
    s_add_u32 m0, s30, 128768
    s_nop 0
    global_load_lds_dwordx4 v190, s[12:13]
    s_add_u32 m0, s30, 136960
    s_nop 0
    global_load_lds_dwordx4 v191, s[12:13]
    s_add_u32 m0, s30, 145152
    s_nop 0
    global_load_lds_dwordx4 v175, s[12:13]
    s_waitcnt lgkmcnt(0)
    s_barrier
    ds_read_b128 v[164:167], v1 offset:0
    s_mul_i32 s3, s2, 1280
    s_add_u32 s26, s26, 1
    s_waitcnt lgkmcnt(0)
    v_add_u32 v180, v164, v165
    v_add3_u32 v180, v180, v166, v167
    v_mov_b32 v181, v180
    v_lshrrev_b32 v132, 8, v132
    v_lshlrev_b32 v132, 2, v132
    v_add_u32_dpp v181, v181, v181 row_shr:1 row_mask:0xf bank_mask:0xf
    v_add_lshl_u32 v177, v172, 0, 5
    v_lshrrev_b32 v133, 8, v133
    v_add_u32_dpp v181, v181, v181 row_shr:2 row_mask:0xf bank_mask:0xf
    v_lshlrev_b32 v133, 2, v133
    v_add_lshl_u32 v178, v172, 1, 5
    v_add_u32_dpp v181, v181, v181 row_shr:4 row_mask:0xf bank_mask:0xf
    v_lshrrev_b32 v134, 8, v134
    v_lshlrev_b32 v134, 2, v134
    v_add_u32_dpp v181, v181, v181 row_shr:8 row_mask:0xf bank_mask:0xf
    v_add_lshl_u32 v179, v172, 2, 5
    s_nop 0
    v_add_u32_dpp v181, v181, v181 row_bcast:15 row_mask:0xa bank_mask:0xf
    s_nop 1
    v_add_u32_dpp v181, v181, v181 row_bcast:31 row_mask:0xc bank_mask:0xf
    v_sub_u32 v168, v181, v180
    v_add_u32 v169, v168, v164
    v_add_u32 v170, v169, v165
    v_add_u32 v171, v170, v166
    ds_write_b128 v1, v[168:171] offset:1024
    s_mov_b64 exec, s[38:39]
    ds_read_b32 v147, v147 offset:1024
    ds_read_b32 v148, v148 offset:1024
    s_mov_b64 exec, s[36:37]
    ds_read_b32 v146, v146 offset:1024
    s_mov_b64 exec, -1
    s_waitcnt vmcnt(5)
    v_mad_u32_u24 v152, v152, s40, v136
    v_lshl_add_u32 v132, v136, 16, v132
    v_subrev_u32 v156, 10000, v152
    v_min_u32 v152, v152, v156
    v_add_u32 v152, 200, v152
    v_mul_u32_u24 v152, 154, v152
    v_lshrrev_b32 v152, 17, v152
    v_lshl_add_u32 v152, v152, 8, v132
    v_mad_u32_u24 v153, v153, s40, v137
    v_lshl_add_u32 v133, v137, 16, v133
    v_subrev_u32 v157, 10000, v153
    v_min_u32 v153, v153, v157
    v_add_u32 v153, 200, v153
    v_mul_u32_u24 v153, 154, v153
    v_lshrrev_b32 v153, 17, v153
    v_lshl_add_u32 v153, v153, 8, v133
    v_mad_u32_u24 v154, v154, s40, v138
    v_lshl_add_u32 v134, v138, 16, v134
    v_subrev_u32 v158, 10000, v154
    v_min_u32 v154, v154, v158
    v_add_u32 v154, 200, v154
    v_mul_u32_u24 v154, 154, v154
    v_lshrrev_b32 v154, 17, v154
    v_lshl_add_u32 v154, v154, 8, v134
    s_mov_b64 exec, s[38:39]
    s_waitcnt lgkmcnt(0)
    v_add_lshl_u32 v147, v147, v150, 1
    v_mad_u32_u24 v183, v147, 6, s41
    ds_write_b16 v147, v178 offset:2048
    ds_write2_b32 v183, v142, v143 offset1:1
    ds_write_b32 v183, v153 offset:8
    v_add_lshl_u32 v148, v148, v151, 1
    v_mad_u32_u24 v184, v148, 6, s41
    ds_write_b16 v148, v179 offset:2048
    ds_write2_b32 v184, v144, v145 offset1:1
    ds_write_b32 v184, v154 offset:8
    s_mov_b64 exec, s[36:37]
    v_add_lshl_u32 v146, v146, v149, 1
    v_mad_u32_u24 v182, v146, 6, s41
    ds_write_b16 v146, v177 offset:2048
    ds_write2_b32 v182, v140, v141 offset1:1
    ds_write_b32 v182, v152 offset:8
    s_mov_b64 exec, -1
    s_add_u32 m0, s30, 26368
    s_nop 0
    global_load_lds_dwordx4 v188, s[18:19]
    s_add_u32 m0, s30, 34560
    s_nop 0
    global_load_lds_dwordx4 v189, s[18:19]
    s_add_u32 m0, s30, 42752
    s_nop 0
    global_load_lds_dwordx4 v190, s[18:19]
    s_add_u32 m0, s30, 50944
    s_nop 0
    global_load_lds_dwordx4 v191, s[18:19]
    s_add_u32 s70, s30, 59136
    v_min_u32 v185, 112, v1
    s_cmp_lt_u32 s24, 4
    s_cselect_b64 vcc, -1, 0
    s_cselect_b32 m0, s70, 162560
    s_cselect_b64 s[68:69], s[14:15], s[16:17]
    v_cndmask_b32 v185, v185, v188, vcc
    global_load_lds_dwordx4 v185, s[68:69]
    s_mul_i32 s31, s3, 12
    s_add_u32 s31, s31, 1048576
    s_add_u32 s48, s22, s31
    s_addc_u32 s49, s23, 0
    s_mov_b32 s50, 15104
    s_mov_b32 s51, 0x00020000
    s_lshl_b32 s3, s3, 5
    s_add_u32 s31, s3, 8388608
    s_add_u32 s52, s22, s31
    s_addc_u32 s53, s23, 0
    s_mov_b32 s54, 40064
    s_mov_b32 s55, 0x00020000
    v_and_b32 v172, -2, v0
    v_and_b32 v173, 16, v188
    v_add_u32 v173, 112384, v173
    s_waitcnt lgkmcnt(0)
    s_barrier
    ds_read_b128 v[132:135], v188 offset:63232
    ds_read_b128 v[136:139], v189 offset:63232
    ds_read_u16 v174, v172 offset:2048
    ds_read_u16 v175, v172 offset:2560
    ds_read_u16 v176, v172 offset:3072
    ds_read_u16 v177, v172 offset:3584
    ds_read_u16 v178, v172 offset:4096
    s_cmp_eq_u32 s24, 7
    s_cbranch_scc0 L_norow
    s_lshr_b32 s31, s2, 1
    s_lshl_b32 s31, s31, 11
    s_and_b32 s68, s2, 1
    s_lshl_b32 s68, s68, 6
    s_add_u32 s31, s31, s68
    s_add_u32 s31, s31, 4096
    v_lshrrev_b32 v212, 2, v11
    v_lshl_add_u32 v212, v212, 7, s31
    v_and_b32 v196, 63, v1
    v_add_u32 v212, v212, v196
    v_lshl_or_b32 v196, v169, 16, v168
    v_lshl_or_b32 v197, v171, 16, v170
    v_add_u32 v198, v171, v167
    v_mov_b32 v199, s26
    global_store_dwordx4 v212, v[196:199], s[22:23] sc0 sc1
L_norow:
    s_waitcnt lgkmcnt(6)
    buffer_store_dwordx4 v[132:135], v188, s[48:51], 0 offen sc0 sc1
    s_waitcnt lgkmcnt(5)
    buffer_store_dwordx4 v[136:139], v189, s[48:51], 0 offen sc0 sc1
    s_waitcnt lgkmcnt(0)
    v_add_u32 v174, v174, v173
    v_add_u32 v175, v175, v173
    v_add_u32 v176, v176, v173
    v_add_u32 v177, v177, v173
    v_min_u32 v178, 39968, v178
    v_and_b32 v178, -16, v178
    v_add_u32 v178, v178, v173
    v_mov_b64 v[84:85], 0
    v_mov_b64 v[86:87], 0
    v_mov_b64 v[88:89], 0
    v_mov_b64 v[90:91], 0
    v_mov_b64 v[92:93], 0
    v_mov_b64 v[94:95], 0
    v_mov_b64 v[96:97], 0
    v_mov_b64 v[98:99], 0
    v_mov_b64 v[100:101], 0
    v_mov_b64 v[102:103], 0
    v_mov_b64 v[104:105], 0
    v_mov_b64 v[106:107], 0
    v_mov_b64 v[108:109], 0
    v_mov_b64 v[110:111], 0
    v_mov_b64 v[112:113], 0
    v_mov_b64 v[114:115], 0
    v_mov_b64 v[116:117], 0
    v_mov_b64 v[118:119], 0
    v_mov_b64 v[120:121], 0
    v_mov_b64 v[122:123], 0
    v_mov_b64 v[124:125], 0
    v_mov_b64 v[126:127], 0
    v_mov_b64 v[128:129], 0
    v_mov_b64 v[130:131], 0
    v_bfe_u32 v28, v11, 2, 1
    v_mul_u32_u24 v28, 0xaaaa, v28
    v_add_u32 v28, 0x4444, v28
    v_mov_b32 v29, 163584
    ds_write_b128 v29, v[84:87]
    v_lshrrev_b32 v2, 5, v11
    v_lshlrev_b32 v2, 4, v2
    v_and_b32 v3, 3, v11
    v_lshlrev_b32 v3, 3, v3
    v_add_u32 v3, 112384, v3
    s_sub_u32 s4, s4, 512
    s_subb_u32 s5, s5, 0
    s_mov_b32 s6, 10240512
    s_mov_b32 s7, 0x00020000
    s_add_u32 s8, s22, 1048576
    s_addc_u32 s9, s23, 0
    s_mov_b32 s10, 3932160
    s_mov_b32 s11, 0x00020000
    s_mov_b32 s101, 0
    s_cmp_lt_u32 s2, 16
    s_cbranch_scc1 L_r40
    s_cmp_eq_u32 s24, 0
    s_cselect_b32 s101, 0x245d2388, s101
    s_cmp_eq_u32 s24, 1
    s_cselect_b32 s101, 0x25753343, s101
    s_cmp_eq_u32 s24, 2
    s_cselect_b32 s101, 0x27449100, s101
    s_cmp_eq_u32 s24, 3
    s_cselect_b32 s101, 0x267d5301, s101
    s_cmp_eq_u32 s24, 4
    s_cselect_b32 s101, 0x2179a402, s101
    s_cmp_eq_u32 s24, 5
    s_cselect_b32 s101, 0x227162c6, s101
    s_cmp_eq_u32 s24, 6
    s_cselect_b32 s101, 0x206543c7, s101
    s_cmp_eq_u32 s24, 7
    s_cselect_b32 s101, 0x236d8285, s101
    s_branch L_rd
L_r40:
    s_cmp_eq_u32 s24, 0
    s_cselect_b32 s101, 0x2271a3c1, s101
    s_cmp_eq_u32 s24, 1
    s_cselect_b32 s101, 0x20750307, s101
    s_cmp_eq_u32 s24, 2
    s_cselect_b32 s101, 0x236d5205, s101
    s_cmp_eq_u32 s24, 3
    s_cselect_b32 s101, 0x27797340, s101
    s_cmp_eq_u32 s24, 4
    s_cselect_b32 s101, 0x256112c4, s101
    s_cmp_eq_u32 s24, 5
    s_cselect_b32 s101, 0x26653243, s101
    s_cmp_eq_u32 s24, 6
    s_cselect_b32 s101, 0x217d4382, s101
    s_cmp_eq_u32 s24, 7
    s_cselect_b32 s101, 0x24592286, s101
L_rd:
    s_and_b32 s68, s2, 7
    s_lshl_b32 s68, s68, 3
    s_lshr_b32 s31, s2, 5
    s_add_u32 s68, s68, s31
    s_lshl_b32 s68, s68, 4
    s_lshr_b32 s31, s68, 6
    s_lshl_b32 s31, s31, 7
    s_and_b32 s68, s68, 63
    s_add_u32 s68, s68, s31
    s_add_u32 s68, s68, 4096
    v_and_b32 v214, 255, v0
    v_lshrrev_b32 v213, 1, v214
    v_lshl_add_u32 v213, v213, 11, s68
    v_and_b32 v215, 1, v0
    v_lshl_add_u32 v213, v215, 6, v213
    v_mul_u32_u24 v215, 1280, v214
    v_mul_u32_u24 v214, 32, v214
    v_add_u32 v214, 589824, v214
    s_and_b32 s33, s2, 8
    s_lshl_b32 s33, s33, 1
    s_bitcmp1_b32 s2, 4
    s_cselect_b64 s[34:35], -1, 0
    s_mul_i32 s3, s2, 32
    s_add_u32 s3, s3, 589824
    v_lshl_add_u32 v212, v11, 2, s3
    v_mov_b32 v197, s26
    s_waitcnt vmcnt(7)
    s_barrier
    ds_read_b128 v[144:147], v174
    ds_read_b128 v[148:151], v175
    ds_read_b128 v[152:155], v176
    ds_read_b128 v[156:159], v177
    ds_read_b128 v[160:163], v178
    s_waitcnt lgkmcnt(4)
    buffer_store_dwordx4 v[144:147], v188, s[52:55], 0 offen sc0 sc1
    s_waitcnt lgkmcnt(3)
    buffer_store_dwordx4 v[148:151], v189, s[52:55], 0 offen sc0 sc1
    s_waitcnt lgkmcnt(2)
    buffer_store_dwordx4 v[152:155], v190, s[52:55], 0 offen sc0 sc1
    s_waitcnt lgkmcnt(1)
    buffer_store_dwordx4 v[156:159], v191, s[52:55], 0 offen sc0 sc1
    s_waitcnt lgkmcnt(0)
    buffer_store_dwordx4 v[160:163], v192, s[52:55], 0 offen sc0 sc1
    s_add_u32 s12, s22, 8388608
    s_addc_u32 s13, s23, 0
    s_mov_b32 s14, 10485760
    s_mov_b32 s15, 0x00020000
    s_mov_b32 s16, s20
    s_mov_b32 s17, s21
    s_mov_b32 s18, 10240000
    s_mov_b32 s19, 0x00020000
    s_waitcnt vmcnt(0) lgkmcnt(0)
    s_barrier
    s_cmp_eq_u32 s24, 0
    s_cbranch_scc0 L_noflag
    s_mov_b64 exec, 0xff
    global_store_dword v212, v197, s[22:23] sc0 sc1
    s_mov_b64 exec, -1
L_noflag:
    s_barrier
    s_cmp_eq_u32 s27, 0
    s_cbranch_scc0 L_np0
    global_load_dwordx4 v[216:219], v213, s[22:23] sc1
L_np0:
    s_cmp_eq_u32 s27, 0
    s_cbranch_scc1 L_pfa
    s_sub_u32 s3, 0, s2
    s_and_b32 s3, s3, 7
    s_mul_i32 s3, s3, 1280000
    s_lshr_b32 s31, s2, 3
    s_mul_i32 s31, s31, 20992
    s_add_u32 s3, s3, s31
    s_add_u32 s3, s3, 512
    v_and_b32 v208, 255, v0
    v_cmp_gt_u32 vcc, 164, v208
    v_lshlrev_b32 v208, 7, v208
    v_mov_b32 v209, 0x7fffff00
    v_cndmask_b32 v208, v209, v208, vcc
    buffer_load_dword v210, v208, s[4:7], s3 offen
L_pfa:
    v_lshrrev_b32 v12, 5, v11
    v_and_b32 v13, 31, v11
    v_lshlrev_b32 v13, 2, v13
    v_lshl_add_u32 v12, v12, 10, v13
    s_and_b32 s3, s24, 2
    s_lshl_b32 s31, s3, 8
    s_lshl_b32 s68, s27, 11
    s_add_u32 s31, s31, s68
    s_and_b32 s3, s24, 1
    s_lshl_b32 s3, s3, 7
    s_add_u32 s31, s31, s3
    s_and_b32 s3, s24, 3
    v_add_u32 v12, s31, v12
    ds_read_b32 v164, v12 offset:59136
    ds_read_b32 v165, v12 offset:59392
    s_lshl_b32 s3, s3, 2
    s_lshl_b32 s31, s27, 10
    s_add_u32 s3, s3, s31
    v_add_u32 v16, s3, v1
    v_and_b32 v14, 3, v11
    v_bfe_u32 v15, v11, 2, 2
    v_lshlrev_b32 v15, 1, v15
    v_lshl_add_u32 v14, v14, 5, v15
    v_add_u32 v14, 162560, v14
    s_mov_b32 s68, 0xbfb8aa3b
    s_mov_b32 s69, s68
    ds_read_u16 v18, v14 offset:0
    ds_read_u16 v19, v14 offset:8
    ds_read_u16 v20, v14 offset:16
    ds_read_u16 v21, v14 offset:24
    s_waitcnt lgkmcnt(4)
    v_lshlrev_b32 v22, 16, v164
    v_lshlrev_b32 v23, 16, v165
    v_and_b32 v164, 0xffff0000, v164
    v_and_b32 v165, 0xffff0000, v165
    v_pk_mul_f32 v[22:23], v[22:23], s[68:69]
    v_pk_mul_f32 v[164:165], v[164:165], s[68:69]
    v_cvt_pk_bf16_f32 v166, v22, v23
    v_cvt_pk_bf16_f32 v167, v164, v165
    ds_write_b32 v16, v166 offset:8192
    ds_write_b32 v16, v167 offset:10240
    s_waitcnt lgkmcnt(0)
    v_lshl_or_b32 v228, v19, 16, v18
    v_lshl_or_b32 v229, v21, 16, v20
    s_mov_b32 s70, 0x05040100
    s_mov_b32 s71, 0x07060302
    s_and_b32 s3, s24, 3
    s_lshl_b32 s3, s3, 6
    v_lshrrev_b32 v16, 4, v11
    v_and_b32 v17, 15, v11
    v_lshl_add_u32 v17, v17, 2, s3
    v_lshl_add_u32 v16, v16, 11, v17
    ds_read_b32 v168, v16 offset:26368
    ds_read_b32 v169, v16 offset:26624
    ds_read_b32 v170, v16 offset:26880
    ds_read_b32 v171, v16 offset:27136
    ds_read_b32 v172, v16 offset:27392
    ds_read_b32 v173, v16 offset:27648
    ds_read_b32 v174, v16 offset:27904
    ds_read_b32 v175, v16 offset:28160
    s_waitcnt lgkmcnt(7)
    ds_read_b32 v176, v16 offset:34560
    ds_read_b32 v177, v16 offset:34816
    ds_read_b32 v178, v16 offset:35072
    ds_read_b32 v179, v16 offset:35328
    ds_read_b32 v180, v16 offset:35584
    ds_read_b32 v181, v16 offset:35840
    ds_read_b32 v182, v16 offset:36096
    ds_read_b32 v183, v16 offset:36352
    s_waitcnt lgkmcnt(8)
    v_perm_b32 v52, v169, v168, s70
    v_perm_b32 v56, v169, v168, s71
    v_perm_b32 v53, v171, v170, s70
    v_perm_b32 v57, v171, v170, s71
    v_perm_b32 v54, v173, v172, s70
    v_perm_b32 v58, v173, v172, s71
    v_perm_b32 v55, v175, v174, s70
    v_perm_b32 v59, v175, v174, s71
    s_waitcnt lgkmcnt(7)
    ds_read_b32 v168, v16 offset:42752
    ds_read_b32 v169, v16 offset:43008
    ds_read_b32 v170, v16 offset:43264
    ds_read_b32 v171, v16 offset:43520
    ds_read_b32 v172, v16 offset:43776
    ds_read_b32 v173, v16 offset:44032
    ds_read_b32 v174, v16 offset:44288
    ds_read_b32 v175, v16 offset:44544
    s_waitcnt lgkmcnt(8)
    v_perm_b32 v60, v177, v176, s70
    v_perm_b32 v64, v177, v176, s71
    v_perm_b32 v61, v179, v178, s70
    v_perm_b32 v65, v179, v178, s71
    v_perm_b32 v62, v181, v180, s70
    v_perm_b32 v66, v181, v180, s71
    v_perm_b32 v63, v183, v182, s70
    v_perm_b32 v67, v183, v182, s71
    s_waitcnt lgkmcnt(7)
    ds_read_b32 v176, v16 offset:50944
    ds_read_b32 v177, v16 offset:51200
    ds_read_b32 v178, v16 offset:51456
    ds_read_b32 v179, v16 offset:51712
    ds_read_b32 v180, v16 offset:51968
    ds_read_b32 v181, v16 offset:52224
    ds_read_b32 v182, v16 offset:52480
    ds_read_b32 v183, v16 offset:52736
    s_waitcnt lgkmcnt(8)
    v_perm_b32 v68, v169, v168, s70
    v_perm_b32 v72, v169, v168, s71
    v_perm_b32 v69, v171, v170, s70
    v_perm_b32 v73, v171, v170, s71
    v_perm_b32 v70, v173, v172, s70
    v_perm_b32 v74, v173, v172, s71
    v_perm_b32 v71, v175, v174, s70
    v_perm_b32 v75, v175, v174, s71
    s_waitcnt lgkmcnt(0)
    v_perm_b32 v76, v177, v176, s70
    v_perm_b32 v80, v177, v176, s71
    v_perm_b32 v77, v179, v178, s70
    v_perm_b32 v81, v179, v178, s71
    v_perm_b32 v78, v181, v180, s70
    v_perm_b32 v82, v181, v180, s71
    v_perm_b32 v79, v183, v182, s70
    v_perm_b32 v83, v183, v182, s71
    s_cmp_eq_u32 s27, 0
    s_cbranch_scc0 L_polled
    s_mov_b32 s3, 0
    s_waitcnt vmcnt(0)
    s_branch L_poll1
L_poll:
    global_load_dwordx4 v[216:219], v213, s[22:23] sc1
    s_add_u32 s3, s3, 1
    s_waitcnt vmcnt(0)
L_poll1:
    v_cmpx_ne_u32 vcc, s26, v219
    s_cbranch_execz L_pok
    s_cmp_lt_u32 s3, 4000000
    s_cbranch_scc1 L_poll
    v_mov_b64 v[216:217], 0
    v_mov_b32 v218, 0
L_pok:
    s_mov_b64 exec, -1
    v_cndmask_b32 v216, v216, v217, s[34:35]
    v_cndmask_b32 v217, v217, v218, s[34:35]
    v_add_u32 v14, 161536, v194
    v_alignbit_b32 v216, v217, v216, s33
    v_sub_u32_sdwa v217, v216, v216 dst_sel:DWORD dst_unused:UNUSED_PAD src0_sel:WORD_1 src1_sel:WORD_0
    v_add_u32_sdwa v216, v216, v215 dst_sel:DWORD dst_unused:UNUSED_PAD src0_sel:WORD_0 src1_sel:DWORD
    v_lshl_add_u32 v216, v217, 19, v216
    ds_write_b32 v14, v216
L_polled:
L_round:
    s_waitcnt lgkmcnt(0)
    s_barrier
    v_add_u32 v15, 161536, v1
    ds_read_b128 v[140:143], v15
    s_cmp_lg_u32 s28, 0
    s_cbranch_scc1 L_npe
    s_cmp_eq_u32 s27, 0
    s_cbranch_scc1 L_npe
    global_load_dwordx2 v[206:207], v214, s[22:23] sc1
L_npe:
    s_and_b32 s31, s24, 3
    v_mov_b32 v148, 0
    v_mul_u32_u24 v135, 12, v0
    v_add_u32 v136, 6144, v135
    v_add_u32 v137, 12288, v135
    s_waitcnt lgkmcnt(0)
    v_lshrrev_b32 v144, 19, v140
    v_lshrrev_b32 v145, 19, v141
    v_lshrrev_b32 v146, 19, v142
    v_lshrrev_b32 v147, 19, v143
    v_add_u32 v150, v144, v145
    v_add3_u32 v12, v150, v146, v147
    v_add_u32 v13, s28, v12
    v_mov_b32 v149, v144
    v_add_u32_dpp v12, v12, v12 row_shr:1 row_mask:0xf bank_mask:0xf
    v_add_u32 v151, v150, v146
    s_set_gpr_idx_on s31, gpr_idx(SRC0)
    v_mov_b32 v14, v140
    v_mov_b32 v15, v144
    v_mov_b32 v16, v148
    s_set_gpr_idx_off
    v_add_u32_dpp v12, v12, v12 row_shr:2 row_mask:0xf bank_mask:0xf
    v_and_b32 v14, 0x7ffff, v14
    v_sub_u32 v16, v16, v13
    v_add_u32_dpp v12, v12, v12 row_shr:4 row_mask:0xf bank_mask:0xf
    v_subrev_u32 v17, s27, v15
    s_mov_b32 s31, s27
    v_add_u32_dpp v12, v12, v12 row_shr:8 row_mask:0xf bank_mask:0xf
    s_nop 1
    v_add_u32_dpp v12, v12, v12 row_bcast:15 row_mask:0xa bank_mask:0xf
    s_nop 1
    v_add_u32_dpp v12, v12, v12 row_bcast:31 row_mask:0xc bank_mask:0xf
    v_add_u32 v16, v16, v12
    v_readlane_b32 s25, v12, 63
    v_sub_u32 v14, v14, v16
    v_add_lshl_u32 v18, v16, s27, 2
    s_cmp_gt_u32 s25, 1536
    s_cbranch_scc1 L_exp
    v_cmpx_lt_i32 vcc, 0, v17
    ds_write_b32 v18, v14 offset:20224
    v_cmpx_lt_i32 vcc, 2, v17
    ds_write_b32 v18, v14 offset:20232
    v_cmpx_lt_i32 vcc, 4, v17
    ds_write_b32 v18, v14 offset:20240
    v_cmpx_lt_i32 vcc, 6, v17
    ds_write_b32 v18, v14 offset:20248
    v_cmpx_lt_i32 vcc, 8, v17
    ds_write_b32 v18, v14 offset:20256
    v_cmpx_lt_i32 vcc, 10, v17
    ds_write_b32 v18, v14 offset:20264
    v_cmpx_lt_i32 vcc, 12, v17
    s_cbranch_execz L_expd
    s_add_u32 s31, s31, 12
L_exp:
    s_mov_b64 exec, -1
    v_cmp_lt_u32 vcc, s31, v15
    s_cbranch_vccz L_expd
    v_add_u32 v19, s31, v16
    s_movk_i32 s3, 1536
    v_cmp_gt_u32 s[68:69], s3, v19
    v_lshlrev_b32 v19, 2, v19
    s_and_b64 exec, vcc, s[68:69]
    ds_write_b32 v19, v14 offset:20224
    s_add_u32 s31, s31, 2
    s_branch L_exp
L_expd:
    s_mov_b64 exec, -1
    s_cmp_eq_u32 s27, 0
    s_cbranch_scc1 L_fok
    s_cmp_lg_u32 s28, 0
    s_cbranch_scc1 L_fok
    s_mov_b32 s3, 0
    s_branch L_fp1
L_fp:
    global_load_dwordx2 v[206:207], v214, s[22:23] sc1
    s_add_u32 s3, s3, 1
L_fp1:
    s_waitcnt vmcnt(0)
    v_cmpx_ne_u32 vcc, s26, v206
    s_cbranch_execz L_fok
    s_cmp_lt_u32 s3, 4000000
    s_cbranch_scc1 L_fp
    s_branch L_giveup
L_fok:
    s_mov_b64 exec, -1
    s_waitcnt lgkmcnt(0)
    s_barrier
    ds_read_b32 v132, v194 offset:20224
    ds_read_b32 v133, v194 offset:22272
    ds_read_b32 v134, v194 offset:24320
    ds_read_b32 v152, v195 offset:20224
    ds_read_b32 v153, v195 offset:21248
    ds_read_b32 v154, v195 offset:22272
    ds_read_b32 v155, v195 offset:23296
    ds_read_b32 v156, v195 offset:24320
    ds_read_b32 v157, v195 offset:25344
    s_waitcnt lgkmcnt(8)
    v_mad_i32_i24 v132, v132, 12, v135
    buffer_load_dwordx3 v[140:142], v132, s[8:11], 0 offen sc1
    s_waitcnt lgkmcnt(7)
    v_mad_i32_i24 v133, v133, 12, v136
    buffer_load_dwordx3 v[144:146], v133, s[8:11], 0 offen sc1
    s_waitcnt lgkmcnt(6)
    v_mad_i32_i24 v134, v134, 12, v137
    buffer_load_dwordx3 v[148:150], v134, s[8:11], 0 offen sc1
    s_waitcnt lgkmcnt(0)
    v_lshl_add_u32 v152, v152, 5, v188
    v_lshl_add_u32 v153, v153, 5, v189
    v_lshl_add_u32 v154, v154, 5, v190
    v_lshl_add_u32 v155, v155, 5, v191
    v_lshl_add_u32 v156, v156, 5, v192
    v_lshl_add_u32 v157, v157, 5, v193
    s_barrier
    s_add_u32 m0, s30, 63232
    s_nop 0
    buffer_load_dwordx4 v152, s[12:15], 0 offen sc1 lds
    s_sub_u32 s29, s25, s28
    s_min_u32 s29, s29, 1536
    s_lshl_b32 s3, s29, 4
    s_max_u32 s32, s29, 1280
    s_sub_u32 s32, s32, 1280
    s_lshl_b32 s32, s32, 5
    v_cmp_gt_u32 s[56:57], s3, v188
    v_lshlrev_b32 v159, 1, v188
    v_mov_b32 v143, 0
    v_cmp_gt_u32 s[58:59], s3, v189
    v_lshlrev_b32 v161, 1, v189
    v_mov_b32 v147, 0
    v_cmp_gt_u32 s[60:61], s3, v190
    v_lshlrev_b32 v163, 1, v190
    v_mov_b32 v151, 0
    v_and_b32 v4, 15, v11
    v_lshrrev_b32 v13, 4, v11
    s_mul_i32 s3, s27, 23040
    v_mul_u32_u24 v30, 288, v4
    v_lshl_add_u32 v30, v13, 4, v30
    v_add_u32 v30, s3, v30
    s_mul_i32 s68, s27, 5120
    s_add_u32 s68, s68, s2
    s_lshl_b32 s68, s68, 10
    s_and_b32 s3, s24, 3
    s_lshl_b32 s3, s3, 8
    s_add_u32 s68, s68, s3
    v_lshl_add_u32 v31, v13, 18, s68
    v_lshl_add_u32 v31, v4, 4, v31
    v_lshlrev_b32 v4, 3, v4
    v_bfe_u32 v5, v11, 3, 2
    v_and_b32 v12, 3, v11
    v_lshl_add_u32 v5, v5, 2, v12
    v_lshlrev_b32 v5, 3, v5
    v_lshrrev_b32 v6, 2, v11
    v_lshlrev_b32 v6, 3, v6
    v_mul_u32_u24 v16, 52, v11
    v_lshrrev_b32 v16, 8, v16
    v_mul_u32_u24 v17, 5, v16
    v_sub_u32 v17, v11, v17
    v_mul_u32_u24 v15, 6, v17
    v_bfe_u32 v15, s101, v15, 6
    v_lshlrev_b32 v15, 2, v15
    v_lshlrev_b32 v16, 8, v16
    v_add_lshl_u32 v17, v17, 64, 19
    s_mul_i32 s3, s24, 5
    v_lshlrev_b32 v18, 2, v11
    v_add_u32 v21, s3, v11
    v_lshlrev_b32 v19, 2, v21
    v_cmp_gt_u32 vcc, 40, v11
    v_add_u32 v20, 1, v11
    v_add_u32 v21, 1, v21
    v_cndmask_b32 v20, 0, v20, vcc
    s_cmp_gt_u32 s25, 1536
    s_cselect_b32 s69, 0, 8
    v_mov_b32 v22, 8
    s_cmp_lg_u32 s28, 0
    s_cbranch_scc1 L_nofr
    ds_read_b128 v[36:39], v1 offset:8192
    ds_read_b128 v[40:43], v1 offset:9216
    ds_read_b128 v[44:47], v1 offset:10240
    ds_read_b128 v[48:51], v1 offset:11264
L_nofr:
    s_waitcnt vmcnt(3)
    s_mov_b64 exec, s[56:57]
    v_and_b32 v12, 0xff, v142
    v_and_b32 v143, 0xffff, v142
    ds_add_u32 v12, v22 offset:19200
    ds_add_rtn_u32 v132, v143, v22 offset:16128
    s_waitcnt vmcnt(2)
    s_mov_b64 exec, s[58:59]
    v_and_b32 v13, 0xff, v146
    v_and_b32 v147, 0xffff, v146
    ds_add_u32 v13, v22 offset:19200
    ds_add_rtn_u32 v133, v147, v22 offset:16128
    s_waitcnt vmcnt(1)
    s_mov_b64 exec, s[60:61]
    v_and_b32 v14, 0xff, v150
    v_and_b32 v151, 0xffff, v150
    ds_add_u32 v14, v22 offset:19200
    ds_add_rtn_u32 v134, v151, v22 offset:16128
    s_mov_b64 exec, -1
    s_add_u32 m0, s30, 71424
    s_nop 0
    buffer_load_dwordx4 v153, s[12:15], 0 offen sc1 lds
    v_mfma_f32_4x4x4_16b_bf16 v[164:167], v[228:229], v[140:141], 0 cbsz:4 abid:0
    v_mfma_f32_4x4x4_16b_bf16 v[168:171], v[228:229], v[140:141], 0 cbsz:4 abid:1
    v_mfma_f32_4x4x4_16b_bf16 v[172:175], v[228:229], v[140:141], 0 cbsz:4 abid:2
    v_mfma_f32_4x4x4_16b_bf16 v[176:179], v[228:229], v[140:141], 0 cbsz:4 abid:3
    v_add_u32 v23, 112384, v159
    v_lshlrev_b32_sdwa v142, 10, v142 dst_sel:DWORD dst_unused:UNUSED_PAD src0_sel:DWORD src1_sel:WORD_1
    v_cvt_pk_bf16_f32 v180, v164, v165
    v_cvt_pk_bf16_f32 v181, v166, v167
    v_cvt_pk_bf16_f32 v182, v168, v169
    v_cvt_pk_bf16_f32 v183, v170, v171
    v_cvt_pk_bf16_f32 v184, v172, v173
    v_cvt_pk_bf16_f32 v185, v174, v175
    v_cvt_pk_bf16_f32 v186, v176, v177
    v_cvt_pk_bf16_f32 v187, v178, v179
    s_waitcnt lgkmcnt(0)
    s_barrier
    ds_read_b32 v12, v18 offset:19200
    ds_read_b32 v13, v19 offset:19200
    ds_write_b128 v23, v[180:183]
    ds_write_b128 v23, v[184:187] offset:16
    v_lshlrev_b32_sdwa v150, 10, v150 dst_sel:DWORD dst_unused:UNUSED_PAD src0_sel:DWORD src1_sel:WORD_1
    s_waitcnt lgkmcnt(2)
    v_mad_u32_u24 v21, v13, s69, v21
    v_mad_u32_u24 v20, v12, s69, v20
    v_readlane_b32 s96, v21, 0
    v_readlane_b32 s97, v21, 1
    v_readlane_b32 s98, v21, 2
    v_readlane_b32 s99, v21, 3
    v_readlane_b32 s100, v21, 4
    v_lshl_add_u32 v19, v13, 16, v19
    v_cmp_lt_u32 s[36:37], s96, v20
    v_cmp_lt_u32 s[38:39], s97, v20
    v_cmp_lt_u32 s[40:41], s98, v20
    v_cmp_lt_u32 s[42:43], s99, v20
    v_cmp_lt_u32 s[44:45], s100, v20
    s_bcnt1_i32_b64 s96, s[36:37]
    v_writelane_b32 v12, s96, 0
    s_bcnt1_i32_b64 s97, s[38:39]
    v_writelane_b32 v12, s97, 1
    s_bcnt1_i32_b64 s98, s[40:41]
    v_writelane_b32 v12, s98, 2
    s_bcnt1_i32_b64 s99, s[42:43]
    v_writelane_b32 v12, s99, 3
    s_bcnt1_i32_b64 s100, s[44:45]
    v_writelane_b32 v12, s100, 4
    s_mov_b64 exec, 31
    v_lshlrev_b32 v12, 2, v12
    ds_write_b32 v12, v19 offset:19712
    s_mov_b64 exec, -1
    s_add_u32 m0, s30, 79616
    s_nop 0
    buffer_load_dwordx4 v154, s[12:15], 0 offen sc1 lds
    s_add_u32 m0, s30, 87808
    s_nop 0
    buffer_load_dwordx4 v155, s[12:15], 0 offen sc1 lds
    s_waitcnt lgkmcnt(0)
    s_barrier
    ds_read_b32 v12, v15 offset:19712
    v_mfma_f32_4x4x4_16b_bf16 v[164:167], v[228:229], v[144:145], 0 cbsz:4 abid:0
    v_mfma_f32_4x4x4_16b_bf16 v[168:171], v[228:229], v[144:145], 0 cbsz:4 abid:1
    v_mfma_f32_4x4x4_16b_bf16 v[172:175], v[228:229], v[144:145], 0 cbsz:4 abid:2
    v_mfma_f32_4x4x4_16b_bf16 v[176:179], v[228:229], v[144:145], 0 cbsz:4 abid:3
    v_add_u32 v23, 112384, v161
    v_lshlrev_b32_sdwa v146, 10, v146 dst_sel:DWORD dst_unused:UNUSED_PAD src0_sel:DWORD src1_sel:WORD_1
    v_cvt_pk_bf16_f32 v180, v164, v165
    v_cvt_pk_bf16_f32 v181, v166, v167
    v_cvt_pk_bf16_f32 v182, v168, v169
    v_cvt_pk_bf16_f32 v183, v170, v171
    v_cvt_pk_bf16_f32 v184, v172, v173
    v_cvt_pk_bf16_f32 v185, v174, v175
    v_cvt_pk_bf16_f32 v186, v176, v177
    v_cvt_pk_bf16_f32 v187, v178, v179
    s_waitcnt lgkmcnt(0)
    v_add_u32_sdwa v16, v12, v16 dst_sel:DWORD dst_unused:UNUSED_PAD src0_sel:WORD_0 src1_sel:DWORD
    ds_read_b32 v13, v16 offset:16128
    v_readlane_b32 s96, v12, 0
    v_readlane_b32 s97, v12, 1
    v_readlane_b32 s98, v12, 2
    v_readlane_b32 s99, v12, 3
    v_readlane_b32 s100, v12, 4
    s_add_u32 s3, s96, s97
    s_add_u32 s3, s3, s98
    s_add_u32 s3, s3, s99
    s_add_u32 s3, s3, s100
    s_lshr_b32 s29, s3, 16
    s_add_u32 s3, s29, 480
    v_mov_b32 v14, s3
    v_mov_b32 v18, 0
    s_mov_b64 exec, 1
    ds_add_rtn_u32 v14, v18, v14 offset:19968
    s_mov_b64 exec, -1
    s_waitcnt lgkmcnt(1)
    v_sub_u32 v17, v17, v13
    s_nop 0
    v_add_u32_dpp v13, v13, v13 row_shr:1 row_mask:0xf bank_mask:0xf
    s_bfe_u32 s3, s29, 65539
    s_add_u32 s3, s3, 7
    v_add_u32_dpp v13, v13, v13 row_shr:2 row_mask:0xf bank_mask:0xf
    v_mov_b32 v20, 2147482664
    v_mov_b32 v21, 0
    v_add_u32_dpp v13, v13, v13 row_shr:4 row_mask:0xf bank_mask:0xf
    v_writelane_b32 v20, 40, s3
    s_nop 0
    v_add_u32_dpp v13, v13, v13 row_shr:8 row_mask:0xf bank_mask:0xf
    s_waitcnt lgkmcnt(0)
    v_readfirstlane_b32 s71, v14
    v_add_u32_dpp v13, v13, v13 row_bcast:15 row_mask:0xa bank_mask:0xf
    s_add_u32 s3, s71, s29
    v_lshl_add_u32 v18, v11, 3, s3
    v_add_u32_dpp v13, v13, v13 row_bcast:31 row_mask:0xc bank_mask:0xf
    s_mov_b32 exec_hi, 0x0fffffff
    v_add3_u32 v13, v13, v17, s71
    ds_write_b32 v16, v13 offset:16128
    ds_write_b64 v18, v[20:21] offset:0
    s_mov_b64 exec, -1
    ds_write_b128 v23, v[180:183]
    ds_write_b128 v23, v[184:187] offset:16
    s_add_u32 m0, s30, 96000
    s_nop 0
    buffer_load_dwordx4 v156, s[12:15], 0 offen sc1 lds
    s_waitcnt lgkmcnt(2)
    s_barrier
    ds_read_b32 v12, v143 offset:16128
    ds_read_b32 v13, v147 offset:16128
    ds_read_b32 v14, v151 offset:16128
    v_add_u32 v4, s71, v4
    v_add_u32 v5, s71, v5
    v_add_u32 v6, s71, v6
    s_mov_b64 exec, s[56:57]
    s_waitcnt lgkmcnt(2)
    v_add_u32_sdwa v132, v12, v132 dst_sel:DWORD dst_unused:UNUSED_PAD src0_sel:WORD_0 src1_sel:DWORD
    v_or_b32_sdwa v158, v12, v142 dst_sel:DWORD dst_unused:UNUSED_PAD src0_sel:WORD_1 src1_sel:DWORD
    ds_write_b64 v132, v[158:159] offset:0
    s_mov_b64 exec, s[58:59]
    s_waitcnt lgkmcnt(2)
    v_add_u32_sdwa v133, v13, v133 dst_sel:DWORD dst_unused:UNUSED_PAD src0_sel:WORD_0 src1_sel:DWORD
    v_or_b32_sdwa v160, v13, v146 dst_sel:DWORD dst_unused:UNUSED_PAD src0_sel:WORD_1 src1_sel:DWORD
    ds_write_b64 v133, v[160:161] offset:0
    s_mov_b64 exec, s[60:61]
    s_waitcnt lgkmcnt(2)
    v_add_u32_sdwa v134, v14, v134 dst_sel:DWORD dst_unused:UNUSED_PAD src0_sel:WORD_0 src1_sel:DWORD
    v_or_b32_sdwa v162, v14, v150 dst_sel:DWORD dst_unused:UNUSED_PAD src0_sel:WORD_1 src1_sel:DWORD
    ds_write_b64 v134, v[162:163] offset:0
    s_mov_b64 exec, -1
    s_cmp_lt_u32 s30, s32
    s_cbranch_scc0 L_noef5
    s_add_u32 m0, s30, 104192
    s_nop 0
    buffer_load_dwordx4 v157, s[12:15], 0 offen sc1 lds
L_noef5:
    s_waitcnt lgkmcnt(0)
    s_barrier
    ds_read_b32 v12, v4
    ds_read_b32 v7, v4 offset:56
    ds_read_b32 v9, v5 offset:4
    ds_read_b32 v10, v6 offset:4
    s_cmp_eq_u64 s[60:61], 0
    s_cbranch_scc1 L_not3
    v_mfma_f32_4x4x4_16b_bf16 v[164:167], v[228:229], v[148:149], 0 cbsz:4 abid:0
    v_mfma_f32_4x4x4_16b_bf16 v[168:171], v[228:229], v[148:149], 0 cbsz:4 abid:1
    v_mfma_f32_4x4x4_16b_bf16 v[172:175], v[228:229], v[148:149], 0 cbsz:4 abid:2
    v_mfma_f32_4x4x4_16b_bf16 v[176:179], v[228:229], v[148:149], 0 cbsz:4 abid:3
    v_add_u32 v23, 112384, v163
    s_nop 0
    v_cvt_pk_bf16_f32 v180, v164, v165
    v_cvt_pk_bf16_f32 v181, v166, v167
    v_cvt_pk_bf16_f32 v182, v168, v169
    v_cvt_pk_bf16_f32 v183, v170, v171
    v_cvt_pk_bf16_f32 v184, v172, v173
    v_cvt_pk_bf16_f32 v185, v174, v175
    v_cvt_pk_bf16_f32 v186, v176, v177
    v_cvt_pk_bf16_f32 v187, v178, v179
    ds_write_b128 v23, v[180:183]
    ds_write_b128 v23, v[184:187] offset:16
    s_waitcnt lgkmcnt(2)
    s_branch L_t3
L_not3:
    s_waitcnt lgkmcnt(0)
L_t3:
    v_readlane_b32 s36, v12, 0
    v_readlane_b32 s37, v12, 1
    v_readlane_b32 s38, v12, 2
    v_readlane_b32 s39, v12, 3
    s_and_b32 s70, s36, 4294966784
    buffer_load_dwordx4 v[196:199], v1, s[4:7], s70 offen
    s_and_b32 s71, s37, 4294966784
    buffer_load_dwordx4 v[200:203], v1, s[4:7], s71 offen
    s_and_b32 s70, s38, 4294966784
    buffer_load_dwordx4 v[204:207], v1, s[4:7], s70 offen
    s_and_b32 s71, s39, 4294966784
    buffer_load_dwordx4 v[208:211], v1, s[4:7], s71 offen
    v_readlane_b32 s40, v12, 4
    v_readlane_b32 s41, v12, 5
    v_readlane_b32 s42, v12, 6
    v_readlane_b32 s43, v12, 7
    v_add_u32 v9, v9, v2
    v_add_u32 v10, v10, v3
    s_and_b32 s68, s43, 4294966784
    ds_read_b128 v[132:135], v29
    ds_read_b128 v[136:139], v29
    ds_read_b128 v[140:143], v29
    ds_read_b128 v[144:147], v29
    ds_read_b128 v[148:151], v29
    ds_read_b128 v[152:155], v29
    ds_read_b128 v[156:159], v29
    ds_read_b128 v[160:163], v29
    s_waitcnt vmcnt(4) lgkmcnt(0)
    s_barrier
    s_cmp_eq_u32 s29, 0
    s_cbranch_scc1 L_exit
    ds_read_b128 v[24:27], v9 offset:63232
    ds_read_b64 v[32:33], v10
    s_and_b32 s70, s40, 4294966784
    buffer_load_dwordx4 v[212:215], v1, s[4:7], s70 offen
    s_and_b32 s71, s41, 4294966784
    buffer_load_dwordx4 v[216:219], v1, s[4:7], s71 offen
    s_waitcnt lgkmcnt(1)
    v_smfmac_f32_32x32x32_bf16 v[132:147], v[24:27], v[36:43], v28
    v_smfmac_f32_32x32x32_bf16 v[148:163], v[24:27], v[44:51], v28
    s_and_b32 s70, s42, 4294966784
    buffer_load_dwordx4 v[220:223], v1, s[4:7], s70 offen
    s_waitcnt lgkmcnt(0)
    s_nop 7
    v_exp_f32 v12, v132
    v_exp_f32 v13, v133
    v_exp_f32 v14, v148
    v_exp_f32 v15, v149
    v_pk_add_f32 v[12:13], v[12:13], 1.0 op_sel_hi:[1,0]
    v_pk_add_f32 v[14:15], v[14:15], 1.0 op_sel_hi:[1,0]
    v_rcp_f32 v12, v12
    v_rcp_f32 v13, v13
    s_nop 0
    v_pk_mul_f32 v[132:133], v[132:133], v[12:13]
L_loop:
    s_setprio 3
    ds_read_b32 v9, v5 offset:132
    ds_read_b32 v10, v6 offset:132
    ds_read_b32 v8, v4 offset:184
    ds_read_b128 v[164:167], v29
    s_waitcnt vmcnt(6)
    v_rcp_f32 v14, v14
    v_mfma_f32_4x4x4_16b_bf16 v[16:19], v[32:33], v[196:197], 0 cbsz:4 abid:0
    v_exp_f32 v13, v135
    v_mfma_f32_4x4x4_16b_bf16 v[20:23], v[32:33], v[198:199], 0 cbsz:4 abid:0
    v_exp_f32 v12, v134
    v_readlane_b32 s44, v7, 1
    v_rcp_f32 v15, v15
    v_pk_add_f32 v[12:13], v[12:13], 1.0 op_sel_hi:[1,0]
    v_pk_mul_f32 v[148:149], v[148:149], v[14:15]
    s_and_b32 s69, s44, 4294966784
    s_set_gpr_idx_on s36, gpr_idx(SRC2,DST)
    buffer_load_dwordx4 v[224:227], v1, s[4:7], s68 offen
    v_pk_fma_f32 v[84:85], v[132:133], v[16:17], v[84:85] op_sel_hi:[0,1,1]
    v_pk_fma_f32 v[86:87], v[132:133], v[18:19], v[86:87] op_sel_hi:[0,1,1]
    v_pk_fma_f32 v[88:89], v[148:149], v[20:21], v[88:89] op_sel_hi:[0,1,1]
    v_pk_fma_f32 v[90:91], v[148:149], v[22:23], v[90:91] op_sel_hi:[0,1,1]
    s_set_gpr_idx_off
    ds_read_b128 v[168:171], v29
    s_waitcnt vmcnt(6) lgkmcnt(2)
    v_rcp_f32 v12, v12
    v_mfma_f32_4x4x4_16b_bf16 v[16:19], v[32:33], v[200:201], 0 cbsz:4 abid:1
    v_exp_f32 v15, v151
    v_mfma_f32_4x4x4_16b_bf16 v[20:23], v[32:33], v[202:203], 0 cbsz:4 abid:1
    v_exp_f32 v14, v150
    v_readlane_b32 s45, v7, 2
    v_rcp_f32 v13, v13
    v_pk_add_f32 v[14:15], v[14:15], 1.0 op_sel_hi:[1,0]
    v_pk_mul_f32 v[134:135], v[134:135], v[12:13]
    s_and_b32 s68, s45, 4294966784
    s_set_gpr_idx_on s37, gpr_idx(SRC2,DST)
    buffer_load_dwordx4 v[196:199], v1, s[4:7], s69 offen
    v_pk_fma_f32 v[84:85], v[132:133], v[16:17], v[84:85] op_sel:[1,0,0]
    v_pk_fma_f32 v[86:87], v[132:133], v[18:19], v[86:87] op_sel:[1,0,0]
    v_pk_fma_f32 v[88:89], v[148:149], v[20:21], v[88:89] op_sel:[1,0,0]
    v_pk_fma_f32 v[90:91], v[148:149], v[22:23], v[90:91] op_sel:[1,0,0]
    s_set_gpr_idx_off
    s_cbranch_scc0 L_exit
    v_add_u32 v9, v9, v2
    v_add_u32 v10, v10, v3
    ds_read_b128 v[24:27], v9 offset:63232
    ds_read_b64 v[34:35], v10
    ds_read_b128 v[172:175], v29
    s_waitcnt vmcnt(6)
    v_rcp_f32 v14, v14
    v_mfma_f32_4x4x4_16b_bf16 v[16:19], v[32:33], v[204:205], 0 cbsz:4 abid:2
    v_exp_f32 v13, v137
    v_mfma_f32_4x4x4_16b_bf16 v[20:23], v[32:33], v[206:207], 0 cbsz:4 abid:2
    v_exp_f32 v12, v136
    v_readlane_b32 s46, v7, 3
    v_rcp_f32 v15, v15
    v_pk_add_f32 v[12:13], v[12:13], 1.0 op_sel_hi:[1,0]
    v_pk_mul_f32 v[150:151], v[150:151], v[14:15]
    s_and_b32 s69, s46, 4294966784
    s_set_gpr_idx_on s38, gpr_idx(SRC2,DST)
    buffer_load_dwordx4 v[200:203], v1, s[4:7], s68 offen
    v_pk_fma_f32 v[84:85], v[134:135], v[16:17], v[84:85] op_sel_hi:[0,1,1]
    v_pk_fma_f32 v[86:87], v[134:135], v[18:19], v[86:87] op_sel_hi:[0,1,1]
    v_pk_fma_f32 v[88:89], v[150:151], v[20:21], v[88:89] op_sel_hi:[0,1,1]
    v_pk_fma_f32 v[90:91], v[150:151], v[22:23], v[90:91] op_sel_hi:[0,1,1]
    s_set_gpr_idx_off
    ds_read_b128 v[176:179], v29
    s_waitcnt vmcnt(6)
    v_rcp_f32 v12, v12
    v_mfma_f32_4x4x4_16b_bf16 v[16:19], v[32:33], v[208:209], 0 cbsz:4 abid:3
    v_exp_f32 v15, v153
    v_mfma_f32_4x4x4_16b_bf16 v[20:23], v[32:33], v[210:211], 0 cbsz:4 abid:3
    v_exp_f32 v14, v152
    v_readlane_b32 s47, v7, 4
    v_rcp_f32 v13, v13
    v_pk_add_f32 v[14:15], v[14:15], 1.0 op_sel_hi:[1,0]
    v_pk_mul_f32 v[136:137], v[136:137], v[12:13]
    s_and_b32 s68, s47, 4294966784
    s_set_gpr_idx_on s39, gpr_idx(SRC2,DST)
    buffer_load_dwordx4 v[204:207], v1, s[4:7], s69 offen
    v_pk_fma_f32 v[84:85], v[134:135], v[16:17], v[84:85] op_sel:[1,0,0]
    v_pk_fma_f32 v[86:87], v[134:135], v[18:19], v[86:87] op_sel:[1,0,0]
    v_pk_fma_f32 v[88:89], v[150:151], v[20:21], v[88:89] op_sel:[1,0,0]
    v_pk_fma_f32 v[90:91], v[150:151], v[22:23], v[90:91] op_sel:[1,0,0]
    s_set_gpr_idx_off
    s_cbranch_scc0 L_exit
    s_setprio 2
    ds_read_b128 v[180:183], v29
    s_waitcnt vmcnt(6)
    v_rcp_f32 v14, v14
    v_mfma_f32_4x4x4_16b_bf16 v[16:19], v[32:33], v[212:213], 0 cbsz:4 abid:4
    v_exp_f32 v13, v139
    v_mfma_f32_4x4x4_16b_bf16 v[20:23], v[32:33], v[214:215], 0 cbsz:4 abid:4
    v_exp_f32 v12, v138
    v_readlane_b32 s48, v7, 5
    v_rcp_f32 v15, v15
    v_pk_add_f32 v[12:13], v[12:13], 1.0 op_sel_hi:[1,0]
    v_pk_mul_f32 v[152:153], v[152:153], v[14:15]
    s_and_b32 s69, s48, 4294966784
    s_set_gpr_idx_on s40, gpr_idx(SRC2,DST)
    buffer_load_dwordx4 v[208:211], v1, s[4:7], s68 offen
    v_pk_fma_f32 v[84:85], v[136:137], v[16:17], v[84:85] op_sel_hi:[0,1,1]
    v_pk_fma_f32 v[86:87], v[136:137], v[18:19], v[86:87] op_sel_hi:[0,1,1]
    v_pk_fma_f32 v[88:89], v[152:153], v[20:21], v[88:89] op_sel_hi:[0,1,1]
    v_pk_fma_f32 v[90:91], v[152:153], v[22:23], v[90:91] op_sel_hi:[0,1,1]
    s_set_gpr_idx_off
    ds_read_b128 v[184:187], v29
    s_waitcnt vmcnt(6)
    v_rcp_f32 v12, v12
    v_mfma_f32_4x4x4_16b_bf16 v[16:19], v[32:33], v[216:217], 0 cbsz:4 abid:5
    v_exp_f32 v15, v155
    v_mfma_f32_4x4x4_16b_bf16 v[20:23], v[32:33], v[218:219], 0 cbsz:4 abid:5
    v_exp_f32 v14, v154
    v_readlane_b32 s49, v7, 6
    v_rcp_f32 v13, v13
    v_pk_add_f32 v[14:15], v[14:15], 1.0 op_sel_hi:[1,0]
    v_pk_mul_f32 v[138:139], v[138:139], v[12:13]
    s_and_b32 s68, s49, 4294966784
    s_set_gpr_idx_on s41, gpr_idx(SRC2,DST)
    buffer_load_dwordx4 v[212:215], v1, s[4:7], s69 offen
    v_pk_fma_f32 v[84:85], v[136:137], v[16:17], v[84:85] op_sel:[1,0,0]
    v_pk_fma_f32 v[86:87], v[136:137], v[18:19], v[86:87] op_sel:[1,0,0]
    v_pk_fma_f32 v[88:89], v[152:153], v[20:21], v[88:89] op_sel:[1,0,0]
    v_pk_fma_f32 v[90:91], v[152:153], v[22:23], v[90:91] op_sel:[1,0,0]
    s_set_gpr_idx_off
    s_cbranch_scc0 L_exit
    ds_read_b128 v[188:191], v29
    s_waitcnt vmcnt(6)
    v_rcp_f32 v14, v14
    v_mfma_f32_4x4x4_16b_bf16 v[16:19], v[32:33], v[220:221], 0 cbsz:4 abid:6
    v_exp_f32 v13, v141
    v_mfma_f32_4x4x4_16b_bf16 v[20:23], v[32:33], v[222:223], 0 cbsz:4 abid:6
    v_exp_f32 v12, v140
    v_readlane_b32 s50, v7, 7
    v_rcp_f32 v15, v15
    v_pk_add_f32 v[12:13], v[12:13], 1.0 op_sel_hi:[1,0]
    v_pk_mul_f32 v[154:155], v[154:155], v[14:15]
    s_and_b32 s69, s50, 4294966784
    s_set_gpr_idx_on s42, gpr_idx(SRC2,DST)
    buffer_load_dwordx4 v[216:219], v1, s[4:7], s68 offen
    v_pk_fma_f32 v[84:85], v[138:139], v[16:17], v[84:85] op_sel_hi:[0,1,1]
    v_pk_fma_f32 v[86:87], v[138:139], v[18:19], v[86:87] op_sel_hi:[0,1,1]
    v_pk_fma_f32 v[88:89], v[154:155], v[20:21], v[88:89] op_sel_hi:[0,1,1]
    v_pk_fma_f32 v[90:91], v[154:155], v[22:23], v[90:91] op_sel_hi:[0,1,1]
    s_set_gpr_idx_off
    ds_read_b128 v[192:195], v29
    s_waitcnt vmcnt(6)
    v_rcp_f32 v12, v12
    v_mfma_f32_4x4x4_16b_bf16 v[16:19], v[32:33], v[224:225], 0 cbsz:4 abid:7
    v_exp_f32 v15, v157
    v_mfma_f32_4x4x4_16b_bf16 v[20:23], v[32:33], v[226:227], 0 cbsz:4 abid:7
    v_exp_f32 v14, v156
    v_readlane_b32 s51, v7, 8
    v_rcp_f32 v13, v13
    v_pk_add_f32 v[14:15], v[14:15], 1.0 op_sel_hi:[1,0]
    v_pk_mul_f32 v[140:141], v[140:141], v[12:13]
    s_and_b32 s68, s51, 4294966784
    s_set_gpr_idx_on s43, gpr_idx(SRC2,DST)
    buffer_load_dwordx4 v[220:223], v1, s[4:7], s69 offen
    v_pk_fma_f32 v[84:85], v[138:139], v[16:17], v[84:85] op_sel:[1,0,0]
    v_pk_fma_f32 v[86:87], v[138:139], v[18:19], v[86:87] op_sel:[1,0,0]
    v_pk_fma_f32 v[88:89], v[154:155], v[20:21], v[88:89] op_sel:[1,0,0]
    v_pk_fma_f32 v[90:91], v[154:155], v[22:23], v[90:91] op_sel:[1,0,0]
    s_set_gpr_idx_off
    s_cbranch_scc0 L_exit
    s_setprio 1
    s_waitcnt vmcnt(6)
    v_rcp_f32 v14, v14
    v_mfma_f32_4x4x4_16b_bf16 v[16:19], v[32:33], v[196:197], 0 cbsz:4 abid:8
    v_exp_f32 v13, v143
    v_mfma_f32_4x4x4_16b_bf16 v[20:23], v[32:33], v[198:199], 0 cbsz:4 abid:8
    v_exp_f32 v12, v142
    v_readlane_b32 s52, v7, 9
    v_rcp_f32 v15, v15
    v_pk_add_f32 v[12:13], v[12:13], 1.0 op_sel_hi:[1,0]
    v_pk_mul_f32 v[156:157], v[156:157], v[14:15]
    s_and_b32 s69, s52, 4294966784
    s_set_gpr_idx_on s44, gpr_idx(SRC2,DST)
    buffer_load_dwordx4 v[224:227], v1, s[4:7], s68 offen
    v_pk_fma_f32 v[84:85], v[140:141], v[16:17], v[84:85] op_sel_hi:[0,1,1]
    v_pk_fma_f32 v[86:87], v[140:141], v[18:19], v[86:87] op_sel_hi:[0,1,1]
    v_pk_fma_f32 v[88:89], v[156:157], v[20:21], v[88:89] op_sel_hi:[0,1,1]
    v_pk_fma_f32 v[90:91], v[156:157], v[22:23], v[90:91] op_sel_hi:[0,1,1]
    s_set_gpr_idx_off
    s_waitcnt vmcnt(6) lgkmcnt(0)
    v_mfma_f32_4x4x4_16b_bf16 v[20:23], v[32:33], v[202:203], 0 cbsz:4 abid:9
    v_mfma_f32_4x4x4_16b_bf16 v[16:19], v[32:33], v[200:201], 0 cbsz:4 abid:9
    v_rcp_f32 v13, v13
    v_smfmac_f32_32x32x32_bf16 v[164:179], v[24:27], v[36:43], v28
    v_exp_f32 v14, v158
    v_exp_f32 v15, v159
    v_readlane_b32 s53, v7, 10
    v_rcp_f32 v12, v12
    v_pk_add_f32 v[14:15], v[14:15], 1.0 op_sel_hi:[1,0]
    v_pk_mul_f32 v[142:143], v[142:143], v[12:13]
    s_and_b32 s68, s53, 4294966784
    s_set_gpr_idx_on s45, gpr_idx(SRC2,DST)
    buffer_load_dwordx4 v[196:199], v1, s[4:7], s69 offen
    v_pk_fma_f32 v[84:85], v[140:141], v[16:17], v[84:85] op_sel:[1,0,0]
    v_pk_fma_f32 v[86:87], v[140:141], v[18:19], v[86:87] op_sel:[1,0,0]
    v_pk_fma_f32 v[88:89], v[156:157], v[20:21], v[88:89] op_sel:[1,0,0]
    v_pk_fma_f32 v[90:91], v[156:157], v[22:23], v[90:91] op_sel:[1,0,0]
    s_set_gpr_idx_off
    s_cbranch_scc0 L_exit
    s_waitcnt vmcnt(6)
    v_rcp_f32 v14, v14
    v_mfma_f32_4x4x4_16b_bf16 v[16:19], v[32:33], v[204:205], 0 cbsz:4 abid:10
    v_exp_f32 v13, v145
    v_mfma_f32_4x4x4_16b_bf16 v[20:23], v[32:33], v[206:207], 0 cbsz:4 abid:10
    v_exp_f32 v12, v144
    v_readlane_b32 s54, v7, 11
    v_rcp_f32 v15, v15
    v_pk_add_f32 v[12:13], v[12:13], 1.0 op_sel_hi:[1,0]
    v_pk_mul_f32 v[158:159], v[158:159], v[14:15]
    s_and_b32 s69, s54, 4294966784
    s_set_gpr_idx_on s46, gpr_idx(SRC2,DST)
    buffer_load_dwordx4 v[200:203], v1, s[4:7], s68 offen
    v_pk_fma_f32 v[84:85], v[142:143], v[16:17], v[84:85] op_sel_hi:[0,1,1]
    v_pk_fma_f32 v[86:87], v[142:143], v[18:19], v[86:87] op_sel_hi:[0,1,1]
    v_pk_fma_f32 v[88:89], v[158:159], v[20:21], v[88:89] op_sel_hi:[0,1,1]
    v_pk_fma_f32 v[90:91], v[158:159], v[22:23], v[90:91] op_sel_hi:[0,1,1]
    s_set_gpr_idx_off
    s_waitcnt vmcnt(6)
    v_mfma_f32_4x4x4_16b_bf16 v[20:23], v[32:33], v[210:211], 0 cbsz:4 abid:11
    v_mfma_f32_4x4x4_16b_bf16 v[16:19], v[32:33], v[208:209], 0 cbsz:4 abid:11
    v_rcp_f32 v13, v13
    v_smfmac_f32_32x32x32_bf16 v[180:195], v[24:27], v[44:51], v28
    v_exp_f32 v14, v160
    v_exp_f32 v15, v161
    v_readlane_b32 s55, v7, 12
    v_rcp_f32 v12, v12
    v_pk_add_f32 v[14:15], v[14:15], 1.0 op_sel_hi:[1,0]
    v_pk_mul_f32 v[144:145], v[144:145], v[12:13]
    s_and_b32 s68, s55, 4294966784
    s_set_gpr_idx_on s47, gpr_idx(SRC2,DST)
    buffer_load_dwordx4 v[204:207], v1, s[4:7], s69 offen
    v_pk_fma_f32 v[84:85], v[142:143], v[16:17], v[84:85] op_sel:[1,0,0]
    v_pk_fma_f32 v[86:87], v[142:143], v[18:19], v[86:87] op_sel:[1,0,0]
    v_pk_fma_f32 v[88:89], v[158:159], v[20:21], v[88:89] op_sel:[1,0,0]
    v_pk_fma_f32 v[90:91], v[158:159], v[22:23], v[90:91] op_sel:[1,0,0]
    s_set_gpr_idx_off
    s_cbranch_scc0 L_exit
    s_setprio 0
    s_waitcnt vmcnt(6)
    v_rcp_f32 v14, v14
    v_mfma_f32_4x4x4_16b_bf16 v[16:19], v[32:33], v[212:213], 0 cbsz:4 abid:12
    v_exp_f32 v13, v147
    v_mfma_f32_4x4x4_16b_bf16 v[20:23], v[32:33], v[214:215], 0 cbsz:4 abid:12
    v_exp_f32 v12, v146
    v_readlane_b32 s56, v7, 13
    v_rcp_f32 v15, v15
    v_pk_add_f32 v[12:13], v[12:13], 1.0 op_sel_hi:[1,0]
    v_pk_mul_f32 v[160:161], v[160:161], v[14:15]
    s_and_b32 s69, s56, 4294966784
    s_set_gpr_idx_on s48, gpr_idx(SRC2,DST)
    buffer_load_dwordx4 v[208:211], v1, s[4:7], s68 offen
    v_pk_fma_f32 v[84:85], v[144:145], v[16:17], v[84:85] op_sel_hi:[0,1,1]
    v_pk_fma_f32 v[86:87], v[144:145], v[18:19], v[86:87] op_sel_hi:[0,1,1]
    v_pk_fma_f32 v[88:89], v[160:161], v[20:21], v[88:89] op_sel_hi:[0,1,1]
    v_pk_fma_f32 v[90:91], v[160:161], v[22:23], v[90:91] op_sel_hi:[0,1,1]
    s_set_gpr_idx_off
    s_waitcnt vmcnt(6)
    v_rcp_f32 v12, v12
    v_mfma_f32_4x4x4_16b_bf16 v[16:19], v[32:33], v[216:217], 0 cbsz:4 abid:13
    v_exp_f32 v15, v163
    v_mfma_f32_4x4x4_16b_bf16 v[20:23], v[32:33], v[218:219], 0 cbsz:4 abid:13
    v_exp_f32 v14, v162
    v_readlane_b32 s57, v7, 14
    v_rcp_f32 v13, v13
    v_pk_add_f32 v[14:15], v[14:15], 1.0 op_sel_hi:[1,0]
    v_pk_mul_f32 v[146:147], v[146:147], v[12:13]
    s_and_b32 s68, s57, 4294966784
    s_set_gpr_idx_on s49, gpr_idx(SRC2,DST)
    buffer_load_dwordx4 v[212:215], v1, s[4:7], s69 offen
    v_pk_fma_f32 v[84:85], v[144:145], v[16:17], v[84:85] op_sel:[1,0,0]
    v_pk_fma_f32 v[86:87], v[144:145], v[18:19], v[86:87] op_sel:[1,0,0]
    v_pk_fma_f32 v[88:89], v[160:161], v[20:21], v[88:89] op_sel:[1,0,0]
    v_pk_fma_f32 v[90:91], v[160:161], v[22:23], v[90:91] op_sel:[1,0,0]
    s_set_gpr_idx_off
    s_cbranch_scc0 L_exit
    s_waitcnt vmcnt(6)
    v_rcp_f32 v14, v14
    v_mfma_f32_4x4x4_16b_bf16 v[16:19], v[32:33], v[220:221], 0 cbsz:4 abid:14
    v_exp_f32 v13, v165
    v_mfma_f32_4x4x4_16b_bf16 v[20:23], v[32:33], v[222:223], 0 cbsz:4 abid:14
    v_exp_f32 v12, v164
    v_readlane_b32 s58, v7, 15
    v_rcp_f32 v15, v15
    v_pk_add_f32 v[12:13], v[12:13], 1.0 op_sel_hi:[1,0]
    v_pk_mul_f32 v[162:163], v[162:163], v[14:15]
    s_and_b32 s69, s58, 4294966784
    s_set_gpr_idx_on s50, gpr_idx(SRC2,DST)
    buffer_load_dwordx4 v[216:219], v1, s[4:7], s68 offen
    v_pk_fma_f32 v[84:85], v[146:147], v[16:17], v[84:85] op_sel_hi:[0,1,1]
    v_pk_fma_f32 v[86:87], v[146:147], v[18:19], v[86:87] op_sel_hi:[0,1,1]
    v_pk_fma_f32 v[88:89], v[162:163], v[20:21], v[88:89] op_sel_hi:[0,1,1]
    v_pk_fma_f32 v[90:91], v[162:163], v[22:23], v[90:91] op_sel_hi:[0,1,1]
    s_set_gpr_idx_off
    s_waitcnt vmcnt(6)
    v_rcp_f32 v12, v12
    v_mfma_f32_4x4x4_16b_bf16 v[16:19], v[32:33], v[224:225], 0 cbsz:4 abid:15
    v_exp_f32 v15, v181
    v_mfma_f32_4x4x4_16b_bf16 v[20:23], v[32:33], v[226:227], 0 cbsz:4 abid:15
    v_exp_f32 v14, v180
    v_readlane_b32 s59, v8, 0
    v_rcp_f32 v13, v13
    v_pk_add_f32 v[14:15], v[14:15], 1.0 op_sel_hi:[1,0]
    v_pk_mul_f32 v[164:165], v[164:165], v[12:13]
    s_and_b32 s68, s59, 4294966784
    s_set_gpr_idx_on s51, gpr_idx(SRC2,DST)
    buffer_load_dwordx4 v[220:223], v1, s[4:7], s69 offen
    v_pk_fma_f32 v[84:85], v[146:147], v[16:17], v[84:85] op_sel:[1,0,0]
    v_pk_fma_f32 v[86:87], v[146:147], v[18:19], v[86:87] op_sel:[1,0,0]
    v_pk_fma_f32 v[88:89], v[162:163], v[20:21], v[88:89] op_sel:[1,0,0]
    v_pk_fma_f32 v[90:91], v[162:163], v[22:23], v[90:91] op_sel:[1,0,0]
    s_set_gpr_idx_off
    s_cbranch_scc0 L_exit
    s_setprio 3
    ds_read_b32 v9, v5 offset:260
    ds_read_b32 v10, v6 offset:260
    ds_read_b32 v7, v4 offset:312
    ds_read_b128 v[132:135], v29
    s_waitcnt vmcnt(6)
    v_rcp_f32 v14, v14
    v_mfma_f32_4x4x4_16b_bf16 v[16:19], v[34:35], v[196:197], 0 cbsz:4 abid:0
    v_exp_f32 v13, v167
    v_mfma_f32_4x4x4_16b_bf16 v[20:23], v[34:35], v[198:199], 0 cbsz:4 abid:0
    v_exp_f32 v12, v166
    v_readlane_b32 s60, v8, 1
    v_rcp_f32 v15, v15
    v_pk_add_f32 v[12:13], v[12:13], 1.0 op_sel_hi:[1,0]
    v_pk_mul_f32 v[180:181], v[180:181], v[14:15]
    s_and_b32 s69, s60, 4294966784
    s_set_gpr_idx_on s52, gpr_idx(SRC2,DST)
    buffer_load_dwordx4 v[224:227], v1, s[4:7], s68 offen
    v_pk_fma_f32 v[84:85], v[164:165], v[16:17], v[84:85] op_sel_hi:[0,1,1]
    v_pk_fma_f32 v[86:87], v[164:165], v[18:19], v[86:87] op_sel_hi:[0,1,1]
    v_pk_fma_f32 v[88:89], v[180:181], v[20:21], v[88:89] op_sel_hi:[0,1,1]
    v_pk_fma_f32 v[90:91], v[180:181], v[22:23], v[90:91] op_sel_hi:[0,1,1]
    s_set_gpr_idx_off
    ds_read_b128 v[136:139], v29
    s_waitcnt vmcnt(6) lgkmcnt(2)
    v_rcp_f32 v12, v12
    v_mfma_f32_4x4x4_16b_bf16 v[16:19], v[34:35], v[200:201], 0 cbsz:4 abid:1
    v_exp_f32 v15, v183
    v_mfma_f32_4x4x4_16b_bf16 v[20:23], v[34:35], v[202:203], 0 cbsz:4 abid:1
    v_exp_f32 v14, v182
    v_readlane_b32 s61, v8, 2
    v_rcp_f32 v13, v13
    v_pk_add_f32 v[14:15], v[14:15], 1.0 op_sel_hi:[1,0]
    v_pk_mul_f32 v[166:167], v[166:167], v[12:13]
    s_and_b32 s68, s61, 4294966784
    s_set_gpr_idx_on s53, gpr_idx(SRC2,DST)
    buffer_load_dwordx4 v[196:199], v1, s[4:7], s69 offen
    v_pk_fma_f32 v[84:85], v[164:165], v[16:17], v[84:85] op_sel:[1,0,0]
    v_pk_fma_f32 v[86:87], v[164:165], v[18:19], v[86:87] op_sel:[1,0,0]
    v_pk_fma_f32 v[88:89], v[180:181], v[20:21], v[88:89] op_sel:[1,0,0]
    v_pk_fma_f32 v[90:91], v[180:181], v[22:23], v[90:91] op_sel:[1,0,0]
    s_set_gpr_idx_off
    s_cbranch_scc0 L_exit
    v_add_u32 v9, v9, v2
    v_add_u32 v10, v10, v3
    ds_read_b128 v[24:27], v9 offset:63232
    ds_read_b64 v[32:33], v10
    ds_read_b128 v[140:143], v29
    s_waitcnt vmcnt(6)
    v_rcp_f32 v14, v14
    v_mfma_f32_4x4x4_16b_bf16 v[16:19], v[34:35], v[204:205], 0 cbsz:4 abid:2
    v_exp_f32 v13, v169
    v_mfma_f32_4x4x4_16b_bf16 v[20:23], v[34:35], v[206:207], 0 cbsz:4 abid:2
    v_exp_f32 v12, v168
    v_readlane_b32 s62, v8, 3
    v_rcp_f32 v15, v15
    v_pk_add_f32 v[12:13], v[12:13], 1.0 op_sel_hi:[1,0]
    v_pk_mul_f32 v[182:183], v[182:183], v[14:15]
    s_and_b32 s69, s62, 4294966784
    s_set_gpr_idx_on s54, gpr_idx(SRC2,DST)
    buffer_load_dwordx4 v[200:203], v1, s[4:7], s68 offen
    v_pk_fma_f32 v[84:85], v[166:167], v[16:17], v[84:85] op_sel_hi:[0,1,1]
    v_pk_fma_f32 v[86:87], v[166:167], v[18:19], v[86:87] op_sel_hi:[0,1,1]
    v_pk_fma_f32 v[88:89], v[182:183], v[20:21], v[88:89] op_sel_hi:[0,1,1]
    v_pk_fma_f32 v[90:91], v[182:183], v[22:23], v[90:91] op_sel_hi:[0,1,1]
    s_set_gpr_idx_off
    ds_read_b128 v[144:147], v29
    s_waitcnt vmcnt(6)
    v_rcp_f32 v12, v12
    v_mfma_f32_4x4x4_16b_bf16 v[16:19], v[34:35], v[208:209], 0 cbsz:4 abid:3
    v_exp_f32 v15, v185
    v_mfma_f32_4x4x4_16b_bf16 v[20:23], v[34:35], v[210:211], 0 cbsz:4 abid:3
    v_exp_f32 v14, v184
    v_readlane_b32 s63, v8, 4
    v_rcp_f32 v13, v13
    v_pk_add_f32 v[14:15], v[14:15], 1.0 op_sel_hi:[1,0]
    v_pk_mul_f32 v[168:169], v[168:169], v[12:13]
    s_and_b32 s68, s63, 4294966784
    s_set_gpr_idx_on s55, gpr_idx(SRC2,DST)
    buffer_load_dwordx4 v[204:207], v1, s[4:7], s69 offen
    v_pk_fma_f32 v[84:85], v[166:167], v[16:17], v[84:85] op_sel:[1,0,0]
    v_pk_fma_f32 v[86:87], v[166:167], v[18:19], v[86:87] op_sel:[1,0,0]
    v_pk_fma_f32 v[88:89], v[182:183], v[20:21], v[88:89] op_sel:[1,0,0]
    v_pk_fma_f32 v[90:91], v[182:183], v[22:23], v[90:91] op_sel:[1,0,0]
    s_set_gpr_idx_off
    s_cbranch_scc0 L_exit
    s_setprio 2
    ds_read_b128 v[148:151], v29
    s_waitcnt vmcnt(6)
    v_rcp_f32 v14, v14
    v_mfma_f32_4x4x4_16b_bf16 v[16:19], v[34:35], v[212:213], 0 cbsz:4 abid:4
    v_exp_f32 v13, v171
    v_mfma_f32_4x4x4_16b_bf16 v[20:23], v[34:35], v[214:215], 0 cbsz:4 abid:4
    v_exp_f32 v12, v170
    v_readlane_b32 s64, v8, 5
    v_rcp_f32 v15, v15
    v_pk_add_f32 v[12:13], v[12:13], 1.0 op_sel_hi:[1,0]
    v_pk_mul_f32 v[184:185], v[184:185], v[14:15]
    s_and_b32 s69, s64, 4294966784
    s_set_gpr_idx_on s56, gpr_idx(SRC2,DST)
    buffer_load_dwordx4 v[208:211], v1, s[4:7], s68 offen
    v_pk_fma_f32 v[84:85], v[168:169], v[16:17], v[84:85] op_sel_hi:[0,1,1]
    v_pk_fma_f32 v[86:87], v[168:169], v[18:19], v[86:87] op_sel_hi:[0,1,1]
    v_pk_fma_f32 v[88:89], v[184:185], v[20:21], v[88:89] op_sel_hi:[0,1,1]
    v_pk_fma_f32 v[90:91], v[184:185], v[22:23], v[90:91] op_sel_hi:[0,1,1]
    s_set_gpr_idx_off
    ds_read_b128 v[152:155], v29
    s_waitcnt vmcnt(6)
    v_rcp_f32 v12, v12
    v_mfma_f32_4x4x4_16b_bf16 v[16:19], v[34:35], v[216:217], 0 cbsz:4 abid:5
    v_exp_f32 v15, v187
    v_mfma_f32_4x4x4_16b_bf16 v[20:23], v[34:35], v[218:219], 0 cbsz:4 abid:5
    v_exp_f32 v14, v186
    v_readlane_b32 s65, v8, 6
    v_rcp_f32 v13, v13
    v_pk_add_f32 v[14:15], v[14:15], 1.0 op_sel_hi:[1,0]
    v_pk_mul_f32 v[170:171], v[170:171], v[12:13]
    s_and_b32 s68, s65, 4294966784
    s_set_gpr_idx_on s57, gpr_idx(SRC2,DST)
    buffer_load_dwordx4 v[212:215], v1, s[4:7], s69 offen
    v_pk_fma_f32 v[84:85], v[168:169], v[16:17], v[84:85] op_sel:[1,0,0]
    v_pk_fma_f32 v[86:87], v[168:169], v[18:19], v[86:87] op_sel:[1,0,0]
    v_pk_fma_f32 v[88:89], v[184:185], v[20:21], v[88:89] op_sel:[1,0,0]
    v_pk_fma_f32 v[90:91], v[184:185], v[22:23], v[90:91] op_sel:[1,0,0]
    s_set_gpr_idx_off
    s_cbranch_scc0 L_exit
    ds_read_b128 v[156:159], v29
    s_waitcnt vmcnt(6)
    v_rcp_f32 v14, v14
    v_mfma_f32_4x4x4_16b_bf16 v[16:19], v[34:35], v[220:221], 0 cbsz:4 abid:6
    v_exp_f32 v13, v173
    v_mfma_f32_4x4x4_16b_bf16 v[20:23], v[34:35], v[222:223], 0 cbsz:4 abid:6
    v_exp_f32 v12, v172
    v_readlane_b32 s66, v8, 7
    v_rcp_f32 v15, v15
    v_pk_add_f32 v[12:13], v[12:13], 1.0 op_sel_hi:[1,0]
    v_pk_mul_f32 v[186:187], v[186:187], v[14:15]
    s_and_b32 s69, s66, 4294966784
    s_set_gpr_idx_on s58, gpr_idx(SRC2,DST)
    buffer_load_dwordx4 v[216:219], v1, s[4:7], s68 offen
    v_pk_fma_f32 v[84:85], v[170:171], v[16:17], v[84:85] op_sel_hi:[0,1,1]
    v_pk_fma_f32 v[86:87], v[170:171], v[18:19], v[86:87] op_sel_hi:[0,1,1]
    v_pk_fma_f32 v[88:89], v[186:187], v[20:21], v[88:89] op_sel_hi:[0,1,1]
    v_pk_fma_f32 v[90:91], v[186:187], v[22:23], v[90:91] op_sel_hi:[0,1,1]
    s_set_gpr_idx_off
    ds_read_b128 v[160:163], v29
    s_waitcnt vmcnt(6)
    v_rcp_f32 v12, v12
    v_mfma_f32_4x4x4_16b_bf16 v[16:19], v[34:35], v[224:225], 0 cbsz:4 abid:7
    v_exp_f32 v15, v189
    v_mfma_f32_4x4x4_16b_bf16 v[20:23], v[34:35], v[226:227], 0 cbsz:4 abid:7
    v_exp_f32 v14, v188
    v_readlane_b32 s67, v8, 8
    v_rcp_f32 v13, v13
    v_pk_add_f32 v[14:15], v[14:15], 1.0 op_sel_hi:[1,0]
    v_pk_mul_f32 v[172:173], v[172:173], v[12:13]
    s_and_b32 s68, s67, 4294966784
    s_set_gpr_idx_on s59, gpr_idx(SRC2,DST)
    buffer_load_dwordx4 v[220:223], v1, s[4:7], s69 offen
    v_pk_fma_f32 v[84:85], v[170:171], v[16:17], v[84:85] op_sel:[1,0,0]
    v_pk_fma_f32 v[86:87], v[170:171], v[18:19], v[86:87] op_sel:[1,0,0]
    v_pk_fma_f32 v[88:89], v[186:187], v[20:21], v[88:89] op_sel:[1,0,0]
    v_pk_fma_f32 v[90:91], v[186:187], v[22:23], v[90:91] op_sel:[1,0,0]
    s_set_gpr_idx_off
    s_cbranch_scc0 L_exit
    s_setprio 1
    s_waitcnt vmcnt(6)
    v_rcp_f32 v14, v14
    v_mfma_f32_4x4x4_16b_bf16 v[16:19], v[34:35], v[196:197], 0 cbsz:4 abid:8
    v_exp_f32 v13, v175
    v_mfma_f32_4x4x4_16b_bf16 v[20:23], v[34:35], v[198:199], 0 cbsz:4 abid:8
    v_exp_f32 v12, v174
    v_readlane_b32 s36, v8, 9
    v_rcp_f32 v15, v15
    v_pk_add_f32 v[12:13], v[12:13], 1.0 op_sel_hi:[1,0]
    v_pk_mul_f32 v[188:189], v[188:189], v[14:15]
    s_and_b32 s69, s36, 4294966784
    s_set_gpr_idx_on s60, gpr_idx(SRC2,DST)
    buffer_load_dwordx4 v[224:227], v1, s[4:7], s68 offen
    v_pk_fma_f32 v[84:85], v[172:173], v[16:17], v[84:85] op_sel_hi:[0,1,1]
    v_pk_fma_f32 v[86:87], v[172:173], v[18:19], v[86:87] op_sel_hi:[0,1,1]
    v_pk_fma_f32 v[88:89], v[188:189], v[20:21], v[88:89] op_sel_hi:[0,1,1]
    v_pk_fma_f32 v[90:91], v[188:189], v[22:23], v[90:91] op_sel_hi:[0,1,1]
    s_set_gpr_idx_off
    s_waitcnt vmcnt(6) lgkmcnt(0)
    v_mfma_f32_4x4x4_16b_bf16 v[20:23], v[34:35], v[202:203], 0 cbsz:4 abid:9
    v_mfma_f32_4x4x4_16b_bf16 v[16:19], v[34:35], v[200:201], 0 cbsz:4 abid:9
    v_rcp_f32 v13, v13
    v_smfmac_f32_32x32x32_bf16 v[132:147], v[24:27], v[36:43], v28
    v_exp_f32 v14, v190
    v_exp_f32 v15, v191
    v_readlane_b32 s37, v8, 10
    v_rcp_f32 v12, v12
    v_pk_add_f32 v[14:15], v[14:15], 1.0 op_sel_hi:[1,0]
    v_pk_mul_f32 v[174:175], v[174:175], v[12:13]
    s_and_b32 s68, s37, 4294966784
    s_set_gpr_idx_on s61, gpr_idx(SRC2,DST)
    buffer_load_dwordx4 v[196:199], v1, s[4:7], s69 offen
    v_pk_fma_f32 v[84:85], v[172:173], v[16:17], v[84:85] op_sel:[1,0,0]
    v_pk_fma_f32 v[86:87], v[172:173], v[18:19], v[86:87] op_sel:[1,0,0]
    v_pk_fma_f32 v[88:89], v[188:189], v[20:21], v[88:89] op_sel:[1,0,0]
    v_pk_fma_f32 v[90:91], v[188:189], v[22:23], v[90:91] op_sel:[1,0,0]
    s_set_gpr_idx_off
    s_cbranch_scc0 L_exit
    s_waitcnt vmcnt(6)
    v_rcp_f32 v14, v14
    v_mfma_f32_4x4x4_16b_bf16 v[16:19], v[34:35], v[204:205], 0 cbsz:4 abid:10
    v_exp_f32 v13, v177
    v_mfma_f32_4x4x4_16b_bf16 v[20:23], v[34:35], v[206:207], 0 cbsz:4 abid:10
    v_exp_f32 v12, v176
    v_readlane_b32 s38, v8, 11
    v_rcp_f32 v15, v15
    v_pk_add_f32 v[12:13], v[12:13], 1.0 op_sel_hi:[1,0]
    v_pk_mul_f32 v[190:191], v[190:191], v[14:15]
    s_and_b32 s69, s38, 4294966784
    s_set_gpr_idx_on s62, gpr_idx(SRC2,DST)
    buffer_load_dwordx4 v[200:203], v1, s[4:7], s68 offen
    v_pk_fma_f32 v[84:85], v[174:175], v[16:17], v[84:85] op_sel_hi:[0,1,1]
    v_pk_fma_f32 v[86:87], v[174:175], v[18:19], v[86:87] op_sel_hi:[0,1,1]
    v_pk_fma_f32 v[88:89], v[190:191], v[20:21], v[88:89] op_sel_hi:[0,1,1]
    v_pk_fma_f32 v[90:91], v[190:191], v[22:23], v[90:91] op_sel_hi:[0,1,1]
    s_set_gpr_idx_off
    s_waitcnt vmcnt(6)
    v_mfma_f32_4x4x4_16b_bf16 v[20:23], v[34:35], v[210:211], 0 cbsz:4 abid:11
    v_mfma_f32_4x4x4_16b_bf16 v[16:19], v[34:35], v[208:209], 0 cbsz:4 abid:11
    v_rcp_f32 v13, v13
    v_smfmac_f32_32x32x32_bf16 v[148:163], v[24:27], v[44:51], v28
    v_exp_f32 v14, v192
    v_exp_f32 v15, v193
    v_readlane_b32 s39, v8, 12
    v_rcp_f32 v12, v12
    v_pk_add_f32 v[14:15], v[14:15], 1.0 op_sel_hi:[1,0]
    v_pk_mul_f32 v[176:177], v[176:177], v[12:13]
    s_and_b32 s68, s39, 4294966784
    s_set_gpr_idx_on s63, gpr_idx(SRC2,DST)
    buffer_load_dwordx4 v[204:207], v1, s[4:7], s69 offen
    v_pk_fma_f32 v[84:85], v[174:175], v[16:17], v[84:85] op_sel:[1,0,0]
    v_pk_fma_f32 v[86:87], v[174:175], v[18:19], v[86:87] op_sel:[1,0,0]
    v_pk_fma_f32 v[88:89], v[190:191], v[20:21], v[88:89] op_sel:[1,0,0]
    v_pk_fma_f32 v[90:91], v[190:191], v[22:23], v[90:91] op_sel:[1,0,0]
    s_set_gpr_idx_off
    s_cbranch_scc0 L_exit
    s_setprio 0
    s_waitcnt vmcnt(6)
    v_rcp_f32 v14, v14
    v_mfma_f32_4x4x4_16b_bf16 v[16:19], v[34:35], v[212:213], 0 cbsz:4 abid:12
    v_exp_f32 v13, v179
    v_mfma_f32_4x4x4_16b_bf16 v[20:23], v[34:35], v[214:215], 0 cbsz:4 abid:12
    v_exp_f32 v12, v178
    v_readlane_b32 s40, v8, 13
    v_rcp_f32 v15, v15
    v_pk_add_f32 v[12:13], v[12:13], 1.0 op_sel_hi:[1,0]
    v_pk_mul_f32 v[192:193], v[192:193], v[14:15]
    s_and_b32 s69, s40, 4294966784
    s_set_gpr_idx_on s64, gpr_idx(SRC2,DST)
    buffer_load_dwordx4 v[208:211], v1, s[4:7], s68 offen
    v_pk_fma_f32 v[84:85], v[176:177], v[16:17], v[84:85] op_sel_hi:[0,1,1]
    v_pk_fma_f32 v[86:87], v[176:177], v[18:19], v[86:87] op_sel_hi:[0,1,1]
    v_pk_fma_f32 v[88:89], v[192:193], v[20:21], v[88:89] op_sel_hi:[0,1,1]
    v_pk_fma_f32 v[90:91], v[192:193], v[22:23], v[90:91] op_sel_hi:[0,1,1]
    s_set_gpr_idx_off
    s_waitcnt vmcnt(6)
    v_rcp_f32 v12, v12
    v_mfma_f32_4x4x4_16b_bf16 v[16:19], v[34:35], v[216:217], 0 cbsz:4 abid:13
    v_exp_f32 v15, v195
    v_mfma_f32_4x4x4_16b_bf16 v[20:23], v[34:35], v[218:219], 0 cbsz:4 abid:13
    v_exp_f32 v14, v194
    v_readlane_b32 s41, v8, 14
    v_rcp_f32 v13, v13
    v_pk_add_f32 v[14:15], v[14:15], 1.0 op_sel_hi:[1,0]
    v_pk_mul_f32 v[178:179], v[178:179], v[12:13]
    s_and_b32 s68, s41, 4294966784
    s_set_gpr_idx_on s65, gpr_idx(SRC2,DST)
    buffer_load_dwordx4 v[212:215], v1, s[4:7], s69 offen
    v_pk_fma_f32 v[84:85], v[176:177], v[16:17], v[84:85] op_sel:[1,0,0]
    v_pk_fma_f32 v[86:87], v[176:177], v[18:19], v[86:87] op_sel:[1,0,0]
    v_pk_fma_f32 v[88:89], v[192:193], v[20:21], v[88:89] op_sel:[1,0,0]
    v_pk_fma_f32 v[90:91], v[192:193], v[22:23], v[90:91] op_sel:[1,0,0]
    s_set_gpr_idx_off
    s_cbranch_scc0 L_exit
    s_waitcnt vmcnt(6)
    v_rcp_f32 v14, v14
    v_mfma_f32_4x4x4_16b_bf16 v[16:19], v[34:35], v[220:221], 0 cbsz:4 abid:14
    v_exp_f32 v13, v133
    v_mfma_f32_4x4x4_16b_bf16 v[20:23], v[34:35], v[222:223], 0 cbsz:4 abid:14
    v_exp_f32 v12, v132
    v_readlane_b32 s42, v8, 15
    v_rcp_f32 v15, v15
    v_pk_add_f32 v[12:13], v[12:13], 1.0 op_sel_hi:[1,0]
    v_pk_mul_f32 v[194:195], v[194:195], v[14:15]
    s_and_b32 s69, s42, 4294966784
    s_set_gpr_idx_on s66, gpr_idx(SRC2,DST)
    buffer_load_dwordx4 v[216:219], v1, s[4:7], s68 offen
    v_pk_fma_f32 v[84:85], v[178:179], v[16:17], v[84:85] op_sel_hi:[0,1,1]
    v_pk_fma_f32 v[86:87], v[178:179], v[18:19], v[86:87] op_sel_hi:[0,1,1]
    v_pk_fma_f32 v[88:89], v[194:195], v[20:21], v[88:89] op_sel_hi:[0,1,1]
    v_pk_fma_f32 v[90:91], v[194:195], v[22:23], v[90:91] op_sel_hi:[0,1,1]
    s_set_gpr_idx_off
    s_waitcnt vmcnt(6)
    v_rcp_f32 v12, v12
    v_mfma_f32_4x4x4_16b_bf16 v[16:19], v[34:35], v[224:225], 0 cbsz:4 abid:15
    v_exp_f32 v15, v149
    v_mfma_f32_4x4x4_16b_bf16 v[20:23], v[34:35], v[226:227], 0 cbsz:4 abid:15
    v_exp_f32 v14, v148
    v_readlane_b32 s43, v7, 0
    v_rcp_f32 v13, v13
    v_pk_add_f32 v[14:15], v[14:15], 1.0 op_sel_hi:[1,0]
    v_pk_mul_f32 v[132:133], v[132:133], v[12:13]
    s_and_b32 s68, s43, 4294966784
    s_set_gpr_idx_on s67, gpr_idx(SRC2,DST)
    buffer_load_dwordx4 v[220:223], v1, s[4:7], s69 offen
    v_pk_fma_f32 v[84:85], v[178:179], v[16:17], v[84:85] op_sel:[1,0,0]
    v_pk_fma_f32 v[86:87], v[178:179], v[18:19], v[86:87] op_sel:[1,0,0]
    v_pk_fma_f32 v[88:89], v[194:195], v[20:21], v[88:89] op_sel:[1,0,0]
    v_pk_fma_f32 v[90:91], v[194:195], v[22:23], v[90:91] op_sel:[1,0,0]
    s_set_gpr_idx_off
    s_cbranch_scc0 L_exit
    v_add_u32 v4, 256, v4
    v_add_u32 v5, 256, v5
    v_add_u32 v6, 256, v6
    s_branch L_loop
L_giveup:
    s_mov_b64 exec, -1
    v_mov_b64 v[164:165], 0
    v_mov_b64 v[166:167], 0
    v_add_u32 v168, 161536, v1
    ds_write_b128 v168, v[164:167]
    v_mov_b32 v172, 0x00300000
    v_mov_b32 v173, 0x00300000
    v_mov_b32 v174, 0x00300000
    v_mov_b32 v175, 0x00300000
    ds_write_b128 v1, v[172:175] offset:20224
    ds_write_b128 v1, v[172:175] offset:21248
    ds_write_b128 v1, v[172:175] offset:22272
    ds_write_b128 v1, v[172:175] offset:23296
    ds_write_b128 v1, v[172:175] offset:24320
    ds_write_b128 v1, v[172:175] offset:25344
    s_branch L_fok
L_more:
    s_waitcnt vmcnt(0) lgkmcnt(0)
    s_barrier
    v_lshlrev_b32 v188, 4, v0
    v_add_u32 v189, 8192, v188
    v_add_u32 v190, 16384, v188
    v_add_u32 v191, 24576, v188
    v_add_u32 v192, 32768, v188
    v_add_u32 v193, 40960, v188
    v_lshlrev_b32 v194, 2, v0
    v_lshlrev_b32 v14, 3, v0
    v_mov_b32 v16, 0
    v_mov_b32 v17, 0
    v_mov_b32 v15, 0x00300000
    ds_write_b64 v14, v[16:17] offset:16128
    ds_write_b32 v194, v15 offset:20224
    ds_write_b32 v194, v15 offset:22272
    ds_write_b32 v194, v15 offset:24320
    v_lshrrev_b32 v195, 1, v0
    v_lshlrev_b32 v195, 2, v195
    s_branch L_round
L_exit:
    s_add_u32 s28, s28, 1536
    s_cmp_lt_u32 s28, s25
    s_cbranch_scc1 L_more
    s_mov_b32 s68, 0xbf317218
    s_mov_b32 s69, s68
    s_and_b32 s3, s96, 0xffff
    s_mul_i32 m0, s3, 288
    v_pk_mul_f32 v[84:85], v[84:85], s[68:69]
    v_pk_mul_f32 v[86:87], v[86:87], s[68:69]
    v_pk_mul_f32 v[88:89], v[88:89], s[68:69]
    v_pk_mul_f32 v[90:91], v[90:91], s[68:69]
    v_cvt_pk_bf16_f32 v84, v84, v88
    v_cvt_pk_bf16_f32 v85, v85, v89
    v_cvt_pk_bf16_f32 v86, v86, v90
    v_cvt_pk_bf16_f32 v87, v87, v91
    ds_write_addtid_b32 v84 offset:16128
    ds_write_addtid_b32 v85 offset:16416
    ds_write_addtid_b32 v86 offset:16704
    ds_write_addtid_b32 v87 offset:16992
    s_and_b32 s3, s97, 0xffff
    s_mul_i32 m0, s3, 288
    v_pk_mul_f32 v[92:93], v[92:93], s[68:69]
    v_pk_mul_f32 v[94:95], v[94:95], s[68:69]
    v_pk_mul_f32 v[96:97], v[96:97], s[68:69]
    v_pk_mul_f32 v[98:99], v[98:99], s[68:69]
    v_cvt_pk_bf16_f32 v92, v92, v96
    v_cvt_pk_bf16_f32 v93, v93, v97
    v_cvt_pk_bf16_f32 v94, v94, v98
    v_cvt_pk_bf16_f32 v95, v95, v99
    ds_write_addtid_b32 v92 offset:16128
    ds_write_addtid_b32 v93 offset:16416
    ds_write_addtid_b32 v94 offset:16704
    ds_write_addtid_b32 v95 offset:16992
    s_and_b32 s3, s98, 0xffff
    s_mul_i32 m0, s3, 288
    v_pk_mul_f32 v[100:101], v[100:101], s[68:69]
    v_pk_mul_f32 v[102:103], v[102:103], s[68:69]
    v_pk_mul_f32 v[104:105], v[104:105], s[68:69]
    v_pk_mul_f32 v[106:107], v[106:107], s[68:69]
    v_cvt_pk_bf16_f32 v100, v100, v104
    v_cvt_pk_bf16_f32 v101, v101, v105
    v_cvt_pk_bf16_f32 v102, v102, v106
    v_cvt_pk_bf16_f32 v103, v103, v107
    ds_write_addtid_b32 v100 offset:16128
    ds_write_addtid_b32 v101 offset:16416
    ds_write_addtid_b32 v102 offset:16704
    ds_write_addtid_b32 v103 offset:16992
    s_and_b32 s3, s99, 0xffff
    s_mul_i32 m0, s3, 288
    v_pk_mul_f32 v[108:109], v[108:109], s[68:69]
    v_pk_mul_f32 v[110:111], v[110:111], s[68:69]
    v_pk_mul_f32 v[112:113], v[112:113], s[68:69]
    v_pk_mul_f32 v[114:115], v[114:115], s[68:69]
    v_cvt_pk_bf16_f32 v108, v108, v112
    v_cvt_pk_bf16_f32 v109, v109, v113
    v_cvt_pk_bf16_f32 v110, v110, v114
    v_cvt_pk_bf16_f32 v111, v111, v115
    ds_write_addtid_b32 v108 offset:16128
    ds_write_addtid_b32 v109 offset:16416
    ds_write_addtid_b32 v110 offset:16704
    ds_write_addtid_b32 v111 offset:16992
    s_and_b32 s3, s100, 0xffff
    s_mul_i32 m0, s3, 288
    v_pk_mul_f32 v[116:117], v[116:117], s[68:69]
    v_pk_mul_f32 v[118:119], v[118:119], s[68:69]
    v_pk_mul_f32 v[120:121], v[120:121], s[68:69]
    v_pk_mul_f32 v[122:123], v[122:123], s[68:69]
    v_cvt_pk_bf16_f32 v116, v116, v120
    v_cvt_pk_bf16_f32 v117, v117, v121
    v_cvt_pk_bf16_f32 v118, v118, v122
    v_cvt_pk_bf16_f32 v119, v119, v123
    ds_write_addtid_b32 v116 offset:16128
    ds_write_addtid_b32 v117 offset:16416
    ds_write_addtid_b32 v118 offset:16704
    ds_write_addtid_b32 v119 offset:16992
    s_waitcnt lgkmcnt(0)
    s_barrier
    ds_read_b128 v[84:87], v30 offset:16128
    ds_read_b128 v[88:91], v30 offset:16192
    ds_read_b128 v[92:95], v30 offset:16256
    ds_read_b128 v[96:99], v30 offset:16320
    ds_read_b128 v[100:103], v30 offset:20736
    ds_read_b128 v[104:107], v30 offset:20800
    ds_read_b128 v[108:111], v30 offset:20864
    ds_read_b128 v[112:115], v30 offset:20928
    s_waitcnt lgkmcnt(7)
    v_mfma_f32_16x16x32_bf16 v[116:119], v[84:87], v[52:55], 0
    v_mfma_f32_16x16x32_bf16 v[120:123], v[84:87], v[56:59], 0
    s_waitcnt lgkmcnt(6)
    v_mfma_f32_16x16x32_bf16 v[116:119], v[88:91], v[60:63], v[116:119]
    v_mfma_f32_16x16x32_bf16 v[120:123], v[88:91], v[64:67], v[120:123]
    s_waitcnt lgkmcnt(5)
    v_mfma_f32_16x16x32_bf16 v[116:119], v[92:95], v[68:71], v[116:119]
    v_mfma_f32_16x16x32_bf16 v[120:123], v[92:95], v[72:75], v[120:123]
    s_waitcnt lgkmcnt(4)
    v_mfma_f32_16x16x32_bf16 v[116:119], v[96:99], v[76:79], v[116:119]
    v_mfma_f32_16x16x32_bf16 v[120:123], v[96:99], v[80:83], v[120:123]
    ds_read_b128 v[84:87], v30 offset:25344
    ds_read_b128 v[88:91], v30 offset:25408
    ds_read_b128 v[92:95], v30 offset:25472
    ds_read_b128 v[96:99], v30 offset:25536
    s_waitcnt lgkmcnt(7)
    v_mfma_f32_16x16x32_bf16 v[124:127], v[100:103], v[52:55], 0
    v_mfma_f32_16x16x32_bf16 v[128:131], v[100:103], v[56:59], 0
    s_waitcnt lgkmcnt(6)
    v_mfma_f32_16x16x32_bf16 v[124:127], v[104:107], v[60:63], v[124:127]
    v_cvt_pk_bf16_f32 v44, v116, v117
    v_cvt_pk_bf16_f32 v45, v118, v119
    v_mfma_f32_16x16x32_bf16 v[128:131], v[104:107], v[64:67], v[128:131]
    v_cvt_pk_bf16_f32 v46, v120, v121
    v_cvt_pk_bf16_f32 v47, v122, v123
    s_waitcnt lgkmcnt(5)
    v_mfma_f32_16x16x32_bf16 v[124:127], v[108:111], v[68:71], v[124:127]
    s_mov_b32 s3, 0
    buffer_store_dwordx4 v[44:47], v31, s[16:19], s3 offen sc0 sc1
    v_mfma_f32_16x16x32_bf16 v[128:131], v[108:111], v[72:75], v[128:131]
    s_waitcnt lgkmcnt(4)
    v_mfma_f32_16x16x32_bf16 v[124:127], v[112:115], v[76:79], v[124:127]
    v_mfma_f32_16x16x32_bf16 v[128:131], v[112:115], v[80:83], v[128:131]
    ds_read_b128 v[100:103], v30 offset:29952
    ds_read_b128 v[104:107], v30 offset:30016
    ds_read_b128 v[108:111], v30 offset:30080
    ds_read_b128 v[112:115], v30 offset:30144
    s_waitcnt lgkmcnt(7)
    v_mfma_f32_16x16x32_bf16 v[116:119], v[84:87], v[52:55], 0
    v_mfma_f32_16x16x32_bf16 v[120:123], v[84:87], v[56:59], 0
    s_waitcnt lgkmcnt(6)
    v_mfma_f32_16x16x32_bf16 v[116:119], v[88:91], v[60:63], v[116:119]
    v_cvt_pk_bf16_f32 v48, v124, v125
    v_cvt_pk_bf16_f32 v49, v126, v127
    v_mfma_f32_16x16x32_bf16 v[120:123], v[88:91], v[64:67], v[120:123]
    v_cvt_pk_bf16_f32 v50, v128, v129
    v_cvt_pk_bf16_f32 v51, v130, v131
    s_waitcnt lgkmcnt(5)
    v_mfma_f32_16x16x32_bf16 v[116:119], v[92:95], v[68:71], v[116:119]
    s_mov_b32 s3, 1048576
    buffer_store_dwordx4 v[48:51], v31, s[16:19], s3 offen sc0 sc1
    v_mfma_f32_16x16x32_bf16 v[120:123], v[92:95], v[72:75], v[120:123]
    s_waitcnt lgkmcnt(4)
    v_mfma_f32_16x16x32_bf16 v[116:119], v[96:99], v[76:79], v[116:119]
    v_mfma_f32_16x16x32_bf16 v[120:123], v[96:99], v[80:83], v[120:123]
    ds_read_b128 v[84:87], v30 offset:34560
    ds_read_b128 v[88:91], v30 offset:34624
    ds_read_b128 v[92:95], v30 offset:34688
    ds_read_b128 v[96:99], v30 offset:34752
    s_waitcnt lgkmcnt(7)
    v_mfma_f32_16x16x32_bf16 v[124:127], v[100:103], v[52:55], 0
    v_mfma_f32_16x16x32_bf16 v[128:131], v[100:103], v[56:59], 0
    s_waitcnt lgkmcnt(6)
    v_mfma_f32_16x16x32_bf16 v[124:127], v[104:107], v[60:63], v[124:127]
    v_cvt_pk_bf16_f32 v44, v116, v117
    v_cvt_pk_bf16_f32 v45, v118, v119
    v_mfma_f32_16x16x32_bf16 v[128:131], v[104:107], v[64:67], v[128:131]
    v_cvt_pk_bf16_f32 v46, v120, v121
    v_cvt_pk_bf16_f32 v47, v122, v123
    s_waitcnt lgkmcnt(5)
    v_mfma_f32_16x16x32_bf16 v[124:127], v[108:111], v[68:71], v[124:127]
    s_mov_b32 s3, 2097152
    buffer_store_dwordx4 v[44:47], v31, s[16:19], s3 offen sc0 sc1
    v_mfma_f32_16x16x32_bf16 v[128:131], v[108:111], v[72:75], v[128:131]
    s_waitcnt lgkmcnt(4)
    v_mfma_f32_16x16x32_bf16 v[124:127], v[112:115], v[76:79], v[124:127]
    v_mfma_f32_16x16x32_bf16 v[128:131], v[112:115], v[80:83], v[128:131]
    s_nop 3
    s_waitcnt lgkmcnt(3)
    v_mfma_f32_16x16x32_bf16 v[116:119], v[84:87], v[52:55], 0
    v_mfma_f32_16x16x32_bf16 v[120:123], v[84:87], v[56:59], 0
    s_waitcnt lgkmcnt(2)
    v_mfma_f32_16x16x32_bf16 v[116:119], v[88:91], v[60:63], v[116:119]
    v_cvt_pk_bf16_f32 v48, v124, v125
    v_cvt_pk_bf16_f32 v49, v126, v127
    v_mfma_f32_16x16x32_bf16 v[120:123], v[88:91], v[64:67], v[120:123]
    v_cvt_pk_bf16_f32 v50, v128, v129
    v_cvt_pk_bf16_f32 v51, v130, v131
    s_waitcnt lgkmcnt(1)
    v_mfma_f32_16x16x32_bf16 v[116:119], v[92:95], v[68:71], v[116:119]
    s_mov_b32 s3, 3145728
    buffer_store_dwordx4 v[48:51], v31, s[16:19], s3 offen sc0 sc1
    v_mfma_f32_16x16x32_bf16 v[120:123], v[92:95], v[72:75], v[120:123]
    s_waitcnt lgkmcnt(0)
    v_mfma_f32_16x16x32_bf16 v[116:119], v[96:99], v[76:79], v[116:119]
    v_mfma_f32_16x16x32_bf16 v[120:123], v[96:99], v[80:83], v[120:123]
    s_or_b32 s31, s2, s24
    s_cbranch_scc1 L_noep
    v_lshlrev_b32 v36, 2, v11
    v_mov_b32 v37, s26
    global_store_dword v36, v37, s[22:23] offset:0 sc0 sc1
L_noep:
    s_nop 5
    v_cvt_pk_bf16_f32 v44, v116, v117
    v_cvt_pk_bf16_f32 v45, v118, v119
    v_cvt_pk_bf16_f32 v46, v120, v121
    v_cvt_pk_bf16_f32 v47, v122, v123
    s_mov_b32 s3, 4194304
    buffer_store_dwordx4 v[44:47], v31, s[16:19], s3 offen sc0 sc1
L_end:
    s_endpgm
.section .rodata,"a"
.p2align 6
.amdhsa_kernel standalone__tensor_product_equiv_tfn__graph_kernel
  .amdhsa_next_free_vgpr 230
  .amdhsa_next_free_sgpr 102
  .amdhsa_accum_offset 232
  .amdhsa_group_segment_fixed_size 0
  .amdhsa_kernarg_size 88
  .amdhsa_user_sgpr_count 2
  .amdhsa_user_sgpr_kernarg_segment_ptr 1
  .amdhsa_system_sgpr_workgroup_id_x 1
  .amdhsa_float_denorm_mode_32 3
.end_amdhsa_kernel
```

```asm
; @launch grid=(256,1,1) block=(512,1,1) lds=163600
.amdgcn_target "amdgcn-amd-amdhsa--gfx950"
.text
.globl standalone__tensor_product_equiv_tfn__graph_kernel
.p2align 8
.type standalone__tensor_product_equiv_tfn__graph_kernel,@function
standalone__tensor_product_equiv_tfn__graph_kernel:
    s_load_dwordx16 s[4:19], s[0:1], 0
    s_load_dwordx2 s[22:23], s[0:1], 80
    s_load_dwordx2 s[20:21], s[0:1], 64
    s_cmp_ge_u32 s2, 256
    s_cbranch_scc1 L_end
    v_mul_u32_u24 v172, 3, v0
    s_mul_i32 s3, s2, 1250
    v_min_u32 v172, 1247, v172
    v_add_lshl_u32 v173, v172, s3, 2
    v_lshrrev_b32 v12, 6, v0
    v_and_b32 v13, 255, v0
    v_lshlrev_b32 v13, 2, v13
    v_mov_b32 v16, 0
    v_readfirstlane_b32 s24, v12
    ds_write_b32 v13, v16 offset:0
    v_lshlrev_b32 v174, 1, v173
    s_waitcnt lgkmcnt(0)
    global_load_dwordx3 v[132:134], v173, s[8:9]
    s_load_dword s26, s[22:23], 0
    s_barrier
    global_load_dwordx3 v[136:138], v173, s[6:7]
    global_load_dwordx4 v[140:143], v174, s[10:11]
    global_load_dwordx2 v[144:145], v174, s[10:11] offset:16
    v_lshlrev_b32 v188, 4, v0
    v_and_b32 v11, 63, v0
    s_lshl_b32 s30, s24, 10
    s_lshl_b32 s3, s3, 5
    s_add_u32 s12, s12, s3
    s_addc_u32 s13, s13, 0
    v_add_u32 v189, 8192, v188
    v_add_u32 v190, 16384, v188
    v_add_u32 v191, 24576, v188
    v_add_u32 v192, 32768, v188
    v_add_u32 v193, 40960, v188
    v_min_u32 v175, 39984, v192
    v_lshlrev_b32 v1, 4, v11
    s_barrier
    s_add_u32 m0, s30, 112384
    s_nop 0
    global_load_lds_dwordx4 v188, s[12:13]
    s_add_u32 m0, s30, 120576
    s_nop 0
    global_load_lds_dwordx4 v189, s[12:13]
    s_cmp_eq_u32 s24, 7
    s_cbranch_scc0 L_nocpf
    s_cmp_lt_u32 s2, 8
    s_cbranch_scc0 L_nocpf
    s_getpc_b64 s[68:69]
L_pc:
    v_lshlrev_b32 v18, 7, v11
    v_mov_b32 v19, 0
    v_lshl_add_u64 v[20:21], v[18:19], 0, s[68:69]
    global_load_dword v204, v[20:21], off
    v_min_u32 v18, L_end-L_pc-8192, v18
    v_add_u32 v18, 8192, v18
    v_lshl_add_u64 v[20:21], v[18:19], 0, s[68:69]
    global_load_dword v205, v[20:21], off
    s_mul_i32 s3, s2, 512
    s_add_u32 s3, s3, 589824
    v_min_u32 v18, 3, v11
    v_lshl_add_u32 v18, v18, 7, s3
    global_load_dword v211, v18, s[22:23] sc1
L_nocpf:
    v_lshlrev_b32 v194, 2, v0
    v_lshlrev_b32 v14, 3, v0
    v_mov_b32 v16, 0
    v_mov_b32 v17, 0
    v_mov_b32 v15, 0x00300000
    ds_write_b64 v14, v[16:17] offset:16128
    ds_write_b32 v194, v15 offset:20224
    ds_write_b32 v194, v15 offset:22272
    ds_write_b32 v194, v15 offset:24320
    v_lshrrev_b32 v195, 1, v0
    v_lshlrev_b32 v195, 2, v195
    v_cmp_gt_u32 vcc, 416, v0
    s_mov_b64 s[36:37], vcc
    v_cmp_gt_u32 vcc, 417, v0
    s_mov_b64 s[38:39], vcc
    v_mov_b32 v12, 1
    s_movk_i32 s40, 1250
    s_mov_b32 s41, 63232
    s_lshr_b32 s27, s24, 2
    s_mov_b32 s28, 0
    s_waitcnt vmcnt(5)
    s_mov_b64 exec, s[38:39]
    v_and_b32 v153, 7, v133
    v_bfe_u32 v150, v133, 3, 5
    v_lshl_add_u32 v147, v153, 5, v150
    v_lshlrev_b32 v147, 2, v147
    ds_add_rtn_u32 v150, v147, v12 offset:0
    v_and_b32 v154, 7, v134
    v_bfe_u32 v151, v134, 3, 5
    v_lshl_add_u32 v148, v154, 5, v151
    v_lshlrev_b32 v148, 2, v148
    ds_add_rtn_u32 v151, v148, v12 offset:0
    s_mov_b64 exec, s[36:37]
    v_and_b32 v152, 7, v132
    v_bfe_u32 v149, v132, 3, 5
    v_lshl_add_u32 v146, v152, 5, v149
    v_lshlrev_b32 v146, 2, v146
    ds_add_rtn_u32 v149, v146, v12 offset:0
    s_mov_b64 exec, -1
    s_add_u32 m0, s30, 128768
    s_nop 0
    global_load_lds_dwordx4 v190, s[12:13]
    s_add_u32 m0, s30, 136960
    s_nop 0
    global_load_lds_dwordx4 v191, s[12:13]
    s_add_u32 m0, s30, 145152
    s_nop 0
    global_load_lds_dwordx4 v175, s[12:13]
    s_waitcnt lgkmcnt(0)
    s_barrier
    ds_read_b128 v[164:167], v1 offset:0
    s_mul_i32 s3, s2, 1280
    s_add_u32 s26, s26, 1
    s_waitcnt lgkmcnt(0)
    v_add_u32 v180, v164, v165
    v_add3_u32 v180, v180, v166, v167
    v_mov_b32 v181, v180
    v_lshrrev_b32 v132, 8, v132
    v_lshlrev_b32 v132, 2, v132
    v_add_u32_dpp v181, v181, v181 row_shr:1 row_mask:0xf bank_mask:0xf
    v_add_lshl_u32 v177, v172, 0, 5
    v_lshrrev_b32 v133, 8, v133
    v_add_u32_dpp v181, v181, v181 row_shr:2 row_mask:0xf bank_mask:0xf
    v_lshlrev_b32 v133, 2, v133
    v_add_lshl_u32 v178, v172, 1, 5
    v_add_u32_dpp v181, v181, v181 row_shr:4 row_mask:0xf bank_mask:0xf
    v_lshrrev_b32 v134, 8, v134
    v_lshlrev_b32 v134, 2, v134
    v_add_u32_dpp v181, v181, v181 row_shr:8 row_mask:0xf bank_mask:0xf
    v_add_lshl_u32 v179, v172, 2, 5
    s_nop 0
    v_add_u32_dpp v181, v181, v181 row_bcast:15 row_mask:0xa bank_mask:0xf
    s_nop 1
    v_add_u32_dpp v181, v181, v181 row_bcast:31 row_mask:0xc bank_mask:0xf
    v_sub_u32 v168, v181, v180
    v_add_u32 v169, v168, v164
    v_add_u32 v170, v169, v165
    v_add_u32 v171, v170, v166
    ds_write_b128 v1, v[168:171] offset:1024
    s_mov_b64 exec, s[38:39]
    ds_read_b32 v147, v147 offset:1024
    ds_read_b32 v148, v148 offset:1024
    s_mov_b64 exec, s[36:37]
    ds_read_b32 v146, v146 offset:1024
    s_mov_b64 exec, -1
    s_waitcnt vmcnt(5)
    v_mad_u32_u24 v152, v152, s40, v136
    v_lshl_add_u32 v132, v136, 16, v132
    v_subrev_u32 v156, 10000, v152
    v_min_u32 v152, v152, v156
    v_add_u32 v152, 200, v152
    v_mul_u32_u24 v152, 154, v152
    v_lshrrev_b32 v152, 17, v152
    v_lshl_add_u32 v152, v152, 8, v132
    v_mad_u32_u24 v153, v153, s40, v137
    v_lshl_add_u32 v133, v137, 16, v133
    v_subrev_u32 v157, 10000, v153
    v_min_u32 v153, v153, v157
    v_add_u32 v153, 200, v153
    v_mul_u32_u24 v153, 154, v153
    v_lshrrev_b32 v153, 17, v153
    v_lshl_add_u32 v153, v153, 8, v133
    v_mad_u32_u24 v154, v154, s40, v138
    v_lshl_add_u32 v134, v138, 16, v134
    v_subrev_u32 v158, 10000, v154
    v_min_u32 v154, v154, v158
    v_add_u32 v154, 200, v154
    v_mul_u32_u24 v154, 154, v154
    v_lshrrev_b32 v154, 17, v154
    v_lshl_add_u32 v154, v154, 8, v134
    s_mov_b64 exec, s[38:39]
    s_waitcnt lgkmcnt(0)
    v_add_lshl_u32 v147, v147, v150, 1
    v_mad_u32_u24 v183, v147, 6, s41
    ds_write_b16 v147, v178 offset:2048
    ds_write2_b32 v183, v142, v143 offset1:1
    ds_write_b32 v183, v153 offset:8
    v_add_lshl_u32 v148, v148, v151, 1
    v_mad_u32_u24 v184, v148, 6, s41
    ds_write_b16 v148, v179 offset:2048
    ds_write2_b32 v184, v144, v145 offset1:1
    ds_write_b32 v184, v154 offset:8
    s_mov_b64 exec, s[36:37]
    v_add_lshl_u32 v146, v146, v149, 1
    v_mad_u32_u24 v182, v146, 6, s41
    ds_write_b16 v146, v177 offset:2048
    ds_write2_b32 v182, v140, v141 offset1:1
    ds_write_b32 v182, v152 offset:8
    s_mov_b64 exec, -1
    s_add_u32 m0, s30, 26368
    s_nop 0
    global_load_lds_dwordx4 v188, s[18:19]
    s_add_u32 m0, s30, 34560
    s_nop 0
    global_load_lds_dwordx4 v189, s[18:19]
    s_add_u32 m0, s30, 42752
    s_nop 0
    global_load_lds_dwordx4 v190, s[18:19]
    s_add_u32 m0, s30, 50944
    s_nop 0
    global_load_lds_dwordx4 v191, s[18:19]
    s_add_u32 s70, s30, 59136
    v_min_u32 v185, 112, v1
    s_cmp_lt_u32 s24, 4
    s_cselect_b64 vcc, -1, 0
    s_cselect_b32 m0, s70, 162560
    s_cselect_b64 s[68:69], s[14:15], s[16:17]
    v_cndmask_b32 v185, v185, v188, vcc
    global_load_lds_dwordx4 v185, s[68:69]
    s_mul_i32 s31, s3, 12
    s_add_u32 s31, s31, 1048576
    s_add_u32 s48, s22, s31
    s_addc_u32 s49, s23, 0
    s_mov_b32 s50, 15104
    s_mov_b32 s51, 0x00020000
    s_lshl_b32 s3, s3, 5
    s_add_u32 s31, s3, 8388608
    s_add_u32 s52, s22, s31
    s_addc_u32 s53, s23, 0
    s_mov_b32 s54, 40064
    s_mov_b32 s55, 0x00020000
    v_and_b32 v172, -2, v0
    v_and_b32 v173, 16, v188
    v_add_u32 v173, 112384, v173
    s_waitcnt lgkmcnt(0)
    s_barrier
    ds_read_b128 v[132:135], v188 offset:63232
    ds_read_b128 v[136:139], v189 offset:63232
    ds_read_u16 v174, v172 offset:2048
    ds_read_u16 v175, v172 offset:2560
    ds_read_u16 v176, v172 offset:3072
    ds_read_u16 v177, v172 offset:3584
    ds_read_u16 v178, v172 offset:4096
    s_cmp_eq_u32 s24, 7
    s_cbranch_scc0 L_norow
    s_lshr_b32 s31, s2, 1
    s_lshl_b32 s31, s31, 11
    s_and_b32 s68, s2, 1
    s_lshl_b32 s68, s68, 6
    s_add_u32 s31, s31, s68
    s_add_u32 s31, s31, 4096
    v_lshrrev_b32 v212, 2, v11
    v_lshl_add_u32 v212, v212, 7, s31
    v_and_b32 v196, 63, v1
    v_add_u32 v212, v212, v196
    v_lshl_or_b32 v196, v169, 16, v168
    v_lshl_or_b32 v197, v171, 16, v170
    v_add_u32 v198, v171, v167
    v_mov_b32 v199, s26
    global_store_dwordx4 v212, v[196:199], s[22:23] sc0 sc1
L_norow:
    s_waitcnt lgkmcnt(6)
    buffer_store_dwordx4 v[132:135], v188, s[48:51], 0 offen sc0 sc1
    s_waitcnt lgkmcnt(5)
    buffer_store_dwordx4 v[136:139], v189, s[48:51], 0 offen sc0 sc1
    s_waitcnt lgkmcnt(0)
    v_add_u32 v174, v174, v173
    v_add_u32 v175, v175, v173
    v_add_u32 v176, v176, v173
    v_add_u32 v177, v177, v173
    v_min_u32 v178, 39968, v178
    v_and_b32 v178, -16, v178
    v_add_u32 v178, v178, v173
    v_mov_b64 v[84:85], 0
    v_mov_b64 v[86:87], 0
    v_mov_b64 v[88:89], 0
    v_mov_b64 v[90:91], 0
    v_mov_b64 v[92:93], 0
    v_mov_b64 v[94:95], 0
    v_mov_b64 v[96:97], 0
    v_mov_b64 v[98:99], 0
    v_mov_b64 v[100:101], 0
    v_mov_b64 v[102:103], 0
    v_mov_b64 v[104:105], 0
    v_mov_b64 v[106:107], 0
    v_mov_b64 v[108:109], 0
    v_mov_b64 v[110:111], 0
    v_mov_b64 v[112:113], 0
    v_mov_b64 v[114:115], 0
    v_mov_b64 v[116:117], 0
    v_mov_b64 v[118:119], 0
    v_mov_b64 v[120:121], 0
    v_mov_b64 v[122:123], 0
    v_mov_b64 v[124:125], 0
    v_mov_b64 v[126:127], 0
    v_mov_b64 v[128:129], 0
    v_mov_b64 v[130:131], 0
    v_bfe_u32 v28, v11, 2, 1
    v_mul_u32_u24 v28, 0xaaaa, v28
    v_add_u32 v28, 0x4444, v28
    v_mov_b32 v29, 163584
    ds_write_b128 v29, v[84:87]
    v_lshrrev_b32 v2, 5, v11
    v_lshlrev_b32 v2, 4, v2
    v_and_b32 v3, 3, v11
    v_lshlrev_b32 v3, 3, v3
    v_add_u32 v3, 112384, v3
    s_sub_u32 s4, s4, 512
    s_subb_u32 s5, s5, 0
    s_mov_b32 s6, 10240512
    s_mov_b32 s7, 0x00020000
    s_add_u32 s8, s22, 1048576
    s_addc_u32 s9, s23, 0
    s_mov_b32 s10, 3932160
    s_mov_b32 s11, 0x00020000
    s_mov_b32 s101, 0
    s_cmp_lt_u32 s2, 16
    s_cbranch_scc1 L_r40
    s_cmp_eq_u32 s24, 0
    s_cselect_b32 s101, 0x245d2388, s101
    s_cmp_eq_u32 s24, 1
    s_cselect_b32 s101, 0x25753343, s101
    s_cmp_eq_u32 s24, 2
    s_cselect_b32 s101, 0x27449100, s101
    s_cmp_eq_u32 s24, 3
    s_cselect_b32 s101, 0x267d5301, s101
    s_cmp_eq_u32 s24, 4
    s_cselect_b32 s101, 0x2179a402, s101
    s_cmp_eq_u32 s24, 5
    s_cselect_b32 s101, 0x227162c6, s101
    s_cmp_eq_u32 s24, 6
    s_cselect_b32 s101, 0x206543c7, s101
    s_cmp_eq_u32 s24, 7
    s_cselect_b32 s101, 0x236d8285, s101
    s_branch L_rd
L_r40:
    s_cmp_eq_u32 s24, 0
    s_cselect_b32 s101, 0x2271a3c1, s101
    s_cmp_eq_u32 s24, 1
    s_cselect_b32 s101, 0x20750307, s101
    s_cmp_eq_u32 s24, 2
    s_cselect_b32 s101, 0x236d5205, s101
    s_cmp_eq_u32 s24, 3
    s_cselect_b32 s101, 0x27797340, s101
    s_cmp_eq_u32 s24, 4
    s_cselect_b32 s101, 0x256112c4, s101
    s_cmp_eq_u32 s24, 5
    s_cselect_b32 s101, 0x26653243, s101
    s_cmp_eq_u32 s24, 6
    s_cselect_b32 s101, 0x217d4382, s101
    s_cmp_eq_u32 s24, 7
    s_cselect_b32 s101, 0x24592286, s101
L_rd:
    s_and_b32 s68, s2, 7
    s_lshl_b32 s68, s68, 3
    s_lshr_b32 s31, s2, 5
    s_add_u32 s68, s68, s31
    s_lshl_b32 s68, s68, 4
    s_lshr_b32 s31, s68, 6
    s_lshl_b32 s31, s31, 7
    s_and_b32 s68, s68, 63
    s_add_u32 s68, s68, s31
    s_add_u32 s68, s68, 4096
    v_and_b32 v214, 255, v0
    v_lshrrev_b32 v213, 1, v214
    v_lshl_add_u32 v213, v213, 11, s68
    v_and_b32 v215, 1, v0
    v_lshl_add_u32 v213, v215, 6, v213
    v_mul_u32_u24 v215, 1280, v214
    v_mul_u32_u24 v214, 16, v214
    v_add_u32 v214, 589824, v214
    s_and_b32 s33, s2, 8
    s_lshl_b32 s33, s33, 1
    s_bitcmp1_b32 s2, 4
    s_cselect_b64 s[34:35], -1, 0
    s_mul_i32 s3, s2, 16
    s_add_u32 s3, s3, 589824
    v_lshl_add_u32 v212, v11, 2, s3
    v_mov_b32 v197, s26
    s_waitcnt vmcnt(7)
    s_barrier
    ds_read_b128 v[144:147], v174
    ds_read_b128 v[148:151], v175
    ds_read_b128 v[152:155], v176
    ds_read_b128 v[156:159], v177
    ds_read_b128 v[160:163], v178
    s_waitcnt lgkmcnt(4)
    buffer_store_dwordx4 v[144:147], v188, s[52:55], 0 offen sc0 sc1
    s_waitcnt lgkmcnt(3)
    buffer_store_dwordx4 v[148:151], v189, s[52:55], 0 offen sc0 sc1
    s_waitcnt lgkmcnt(2)
    buffer_store_dwordx4 v[152:155], v190, s[52:55], 0 offen sc0 sc1
    s_waitcnt lgkmcnt(1)
    buffer_store_dwordx4 v[156:159], v191, s[52:55], 0 offen sc0 sc1
    s_waitcnt lgkmcnt(0)
    buffer_store_dwordx4 v[160:163], v192, s[52:55], 0 offen sc0 sc1
    s_add_u32 s12, s22, 8388608
    s_addc_u32 s13, s23, 0
    s_mov_b32 s14, 10485760
    s_mov_b32 s15, 0x00020000
    s_mov_b32 s16, s20
    s_mov_b32 s17, s21
    s_mov_b32 s18, 10240000
    s_mov_b32 s19, 0x00020000
    s_waitcnt vmcnt(0) lgkmcnt(0)
    s_barrier
    s_cmp_eq_u32 s24, 0
    s_cbranch_scc0 L_noflag
    s_mov_b64 exec, 0xf
    global_store_dword v212, v197, s[22:23] sc0 sc1
    s_mov_b64 exec, -1
L_noflag:
    s_barrier
    s_cmp_eq_u32 s27, 0
    s_cbranch_scc0 L_np0
    global_load_dwordx4 v[216:219], v213, s[22:23] sc1
L_np0:
    s_cmp_eq_u32 s27, 0
    s_cbranch_scc1 L_pfa
    s_sub_u32 s3, 0, s2
    s_and_b32 s3, s3, 7
    s_mul_i32 s3, s3, 1280000
    s_lshr_b32 s31, s2, 3
    s_mul_i32 s31, s31, 20992
    s_add_u32 s3, s3, s31
    s_add_u32 s3, s3, 512
    v_and_b32 v208, 255, v0
    v_cmp_gt_u32 vcc, 164, v208
    v_lshlrev_b32 v208, 7, v208
    v_mov_b32 v209, 0x7fffff00
    v_cndmask_b32 v208, v209, v208, vcc
    buffer_load_dword v210, v208, s[4:7], s3 offen
L_pfa:
    v_lshrrev_b32 v12, 5, v11
    v_and_b32 v13, 31, v11
    v_lshlrev_b32 v13, 2, v13
    v_lshl_add_u32 v12, v12, 10, v13
    s_and_b32 s3, s24, 2
    s_lshl_b32 s31, s3, 8
    s_lshl_b32 s68, s27, 11
    s_add_u32 s31, s31, s68
    s_and_b32 s3, s24, 1
    s_lshl_b32 s3, s3, 7
    s_add_u32 s31, s31, s3
    s_and_b32 s3, s24, 3
    v_add_u32 v12, s31, v12
    ds_read_b32 v164, v12 offset:59136
    ds_read_b32 v165, v12 offset:59392
    s_lshl_b32 s3, s3, 2
    s_lshl_b32 s31, s27, 10
    s_add_u32 s3, s3, s31
    v_add_u32 v16, s3, v1
    v_and_b32 v14, 3, v11
    v_bfe_u32 v15, v11, 2, 2
    v_lshlrev_b32 v15, 1, v15
    v_lshl_add_u32 v14, v14, 5, v15
    v_add_u32 v14, 162560, v14
    s_mov_b32 s68, 0xbfb8aa3b
    s_mov_b32 s69, s68
    ds_read_u16 v18, v14 offset:0
    ds_read_u16 v19, v14 offset:8
    ds_read_u16 v20, v14 offset:16
    ds_read_u16 v21, v14 offset:24
    s_waitcnt lgkmcnt(4)
    v_lshlrev_b32 v22, 16, v164
    v_lshlrev_b32 v23, 16, v165
    v_and_b32 v164, 0xffff0000, v164
    v_and_b32 v165, 0xffff0000, v165
    v_pk_mul_f32 v[22:23], v[22:23], s[68:69]
    v_pk_mul_f32 v[164:165], v[164:165], s[68:69]
    v_cvt_pk_bf16_f32 v166, v22, v23
    v_cvt_pk_bf16_f32 v167, v164, v165
    ds_write_b32 v16, v166 offset:8192
    ds_write_b32 v16, v167 offset:10240
    s_waitcnt lgkmcnt(0)
    v_lshl_or_b32 v228, v19, 16, v18
    v_lshl_or_b32 v229, v21, 16, v20
    s_mov_b32 s70, 0x05040100
    s_mov_b32 s71, 0x07060302
    s_and_b32 s3, s24, 3
    s_lshl_b32 s3, s3, 6
    v_lshrrev_b32 v16, 4, v11
    v_and_b32 v17, 15, v11
    v_lshl_add_u32 v17, v17, 2, s3
    v_lshl_add_u32 v16, v16, 11, v17
    ds_read_b32 v168, v16 offset:26368
    ds_read_b32 v169, v16 offset:26624
    ds_read_b32 v170, v16 offset:26880
    ds_read_b32 v171, v16 offset:27136
    ds_read_b32 v172, v16 offset:27392
    ds_read_b32 v173, v16 offset:27648
    ds_read_b32 v174, v16 offset:27904
    ds_read_b32 v175, v16 offset:28160
    s_waitcnt lgkmcnt(7)
    ds_read_b32 v176, v16 offset:34560
    ds_read_b32 v177, v16 offset:34816
    ds_read_b32 v178, v16 offset:35072
    ds_read_b32 v179, v16 offset:35328
    ds_read_b32 v180, v16 offset:35584
    ds_read_b32 v181, v16 offset:35840
    ds_read_b32 v182, v16 offset:36096
    ds_read_b32 v183, v16 offset:36352
    s_waitcnt lgkmcnt(8)
    v_perm_b32 v52, v169, v168, s70
    v_perm_b32 v56, v169, v168, s71
    v_perm_b32 v53, v171, v170, s70
    v_perm_b32 v57, v171, v170, s71
    v_perm_b32 v54, v173, v172, s70
    v_perm_b32 v58, v173, v172, s71
    v_perm_b32 v55, v175, v174, s70
    v_perm_b32 v59, v175, v174, s71
    s_waitcnt lgkmcnt(7)
    ds_read_b32 v168, v16 offset:42752
    ds_read_b32 v169, v16 offset:43008
    ds_read_b32 v170, v16 offset:43264
    ds_read_b32 v171, v16 offset:43520
    ds_read_b32 v172, v16 offset:43776
    ds_read_b32 v173, v16 offset:44032
    ds_read_b32 v174, v16 offset:44288
    ds_read_b32 v175, v16 offset:44544
    s_waitcnt lgkmcnt(8)
    v_perm_b32 v60, v177, v176, s70
    v_perm_b32 v64, v177, v176, s71
    v_perm_b32 v61, v179, v178, s70
    v_perm_b32 v65, v179, v178, s71
    v_perm_b32 v62, v181, v180, s70
    v_perm_b32 v66, v181, v180, s71
    v_perm_b32 v63, v183, v182, s70
    v_perm_b32 v67, v183, v182, s71
    s_waitcnt lgkmcnt(7)
    ds_read_b32 v176, v16 offset:50944
    ds_read_b32 v177, v16 offset:51200
    ds_read_b32 v178, v16 offset:51456
    ds_read_b32 v179, v16 offset:51712
    ds_read_b32 v180, v16 offset:51968
    ds_read_b32 v181, v16 offset:52224
    ds_read_b32 v182, v16 offset:52480
    ds_read_b32 v183, v16 offset:52736
    s_waitcnt lgkmcnt(8)
    v_perm_b32 v68, v169, v168, s70
    v_perm_b32 v72, v169, v168, s71
    v_perm_b32 v69, v171, v170, s70
    v_perm_b32 v73, v171, v170, s71
    v_perm_b32 v70, v173, v172, s70
    v_perm_b32 v74, v173, v172, s71
    v_perm_b32 v71, v175, v174, s70
    v_perm_b32 v75, v175, v174, s71
    s_waitcnt lgkmcnt(0)
    v_perm_b32 v76, v177, v176, s70
    v_perm_b32 v80, v177, v176, s71
    v_perm_b32 v77, v179, v178, s70
    v_perm_b32 v81, v179, v178, s71
    v_perm_b32 v78, v181, v180, s70
    v_perm_b32 v82, v181, v180, s71
    v_perm_b32 v79, v183, v182, s70
    v_perm_b32 v83, v183, v182, s71
    s_cmp_eq_u32 s27, 0
    s_cbranch_scc0 L_polled
    s_mov_b32 s3, 0
    s_waitcnt vmcnt(0)
    s_branch L_poll1
L_poll:
    global_load_dwordx4 v[216:219], v213, s[22:23] sc1
    s_add_u32 s3, s3, 1
    s_waitcnt vmcnt(0)
L_poll1:
    v_cmpx_ne_u32 vcc, s26, v219
    s_cbranch_execz L_pok
    s_cmp_lt_u32 s3, 4000000
    s_cbranch_scc1 L_poll
    v_mov_b64 v[216:217], 0
    v_mov_b32 v218, 0
L_pok:
    s_mov_b64 exec, -1
    v_cndmask_b32 v216, v216, v217, s[34:35]
    v_cndmask_b32 v217, v217, v218, s[34:35]
    v_add_u32 v14, 161536, v194
    v_alignbit_b32 v216, v217, v216, s33
    v_sub_u32_sdwa v217, v216, v216 dst_sel:DWORD dst_unused:UNUSED_PAD src0_sel:WORD_1 src1_sel:WORD_0
    v_add_u32_sdwa v216, v216, v215 dst_sel:DWORD dst_unused:UNUSED_PAD src0_sel:WORD_0 src1_sel:DWORD
    v_lshl_add_u32 v216, v217, 19, v216
    ds_write_b32 v14, v216
L_polled:
L_round:
    s_waitcnt lgkmcnt(0)
    s_barrier
    v_add_u32 v15, 161536, v1
    ds_read_b128 v[140:143], v15
    s_cmp_lg_u32 s28, 0
    s_cbranch_scc1 L_npe
    s_cmp_eq_u32 s27, 0
    s_cbranch_scc1 L_npe
    global_load_dwordx2 v[206:207], v214, s[22:23] sc1
L_npe:
    s_and_b32 s31, s24, 3
    v_mov_b32 v148, 0
    v_mul_u32_u24 v135, 12, v0
    v_add_u32 v136, 6144, v135
    v_add_u32 v137, 12288, v135
    s_waitcnt lgkmcnt(0)
    v_lshrrev_b32 v144, 19, v140
    v_lshrrev_b32 v145, 19, v141
    v_lshrrev_b32 v146, 19, v142
    v_lshrrev_b32 v147, 19, v143
    v_add_u32 v150, v144, v145
    v_add3_u32 v12, v150, v146, v147
    v_add_u32 v13, s28, v12
    v_mov_b32 v149, v144
    v_add_u32_dpp v12, v12, v12 row_shr:1 row_mask:0xf bank_mask:0xf
    v_add_u32 v151, v150, v146
    s_set_gpr_idx_on s31, gpr_idx(SRC0)
    v_mov_b32 v14, v140
    v_mov_b32 v15, v144
    v_mov_b32 v16, v148
    s_set_gpr_idx_off
    v_add_u32_dpp v12, v12, v12 row_shr:2 row_mask:0xf bank_mask:0xf
    v_and_b32 v14, 0x7ffff, v14
    v_sub_u32 v16, v16, v13
    v_add_u32_dpp v12, v12, v12 row_shr:4 row_mask:0xf bank_mask:0xf
    v_subrev_u32 v17, s27, v15
    s_mov_b32 s31, s27
    v_add_u32_dpp v12, v12, v12 row_shr:8 row_mask:0xf bank_mask:0xf
    s_nop 1
    v_add_u32_dpp v12, v12, v12 row_bcast:15 row_mask:0xa bank_mask:0xf
    s_nop 1
    v_add_u32_dpp v12, v12, v12 row_bcast:31 row_mask:0xc bank_mask:0xf
    v_add_u32 v16, v16, v12
    v_readlane_b32 s25, v12, 63
    v_sub_u32 v14, v14, v16
    v_add_lshl_u32 v18, v16, s27, 2
    s_cmp_gt_u32 s25, 1536
    s_cbranch_scc1 L_exp
    v_cmpx_lt_i32 vcc, 0, v17
    ds_write_b32 v18, v14 offset:20224
    v_cmpx_lt_i32 vcc, 2, v17
    ds_write_b32 v18, v14 offset:20232
    v_cmpx_lt_i32 vcc, 4, v17
    ds_write_b32 v18, v14 offset:20240
    v_cmpx_lt_i32 vcc, 6, v17
    ds_write_b32 v18, v14 offset:20248
    v_cmpx_lt_i32 vcc, 8, v17
    ds_write_b32 v18, v14 offset:20256
    v_cmpx_lt_i32 vcc, 10, v17
    ds_write_b32 v18, v14 offset:20264
    v_cmpx_lt_i32 vcc, 12, v17
    s_cbranch_execz L_expd
    s_add_u32 s31, s31, 12
L_exp:
    s_mov_b64 exec, -1
    v_cmp_lt_u32 vcc, s31, v15
    s_cbranch_vccz L_expd
    v_add_u32 v19, s31, v16
    s_movk_i32 s3, 1536
    v_cmp_gt_u32 s[68:69], s3, v19
    v_lshlrev_b32 v19, 2, v19
    s_and_b64 exec, vcc, s[68:69]
    ds_write_b32 v19, v14 offset:20224
    s_add_u32 s31, s31, 2
    s_branch L_exp
L_expd:
    s_mov_b64 exec, -1
    s_cmp_eq_u32 s27, 0
    s_cbranch_scc1 L_fok
    s_cmp_lg_u32 s28, 0
    s_cbranch_scc1 L_fok
    s_mov_b32 s3, 0
    s_branch L_fp1
L_fp:
    global_load_dwordx2 v[206:207], v214, s[22:23] sc1
    s_add_u32 s3, s3, 1
L_fp1:
    s_waitcnt vmcnt(0)
    v_cmpx_ne_u32 vcc, s26, v206
    s_cbranch_execz L_fok
    s_cmp_lt_u32 s3, 4000000
    s_cbranch_scc1 L_fp
    s_branch L_giveup
L_fok:
    s_mov_b64 exec, -1
    s_waitcnt lgkmcnt(0)
    s_barrier
    ds_read_b32 v132, v194 offset:20224
    ds_read_b32 v133, v194 offset:22272
    ds_read_b32 v134, v194 offset:24320
    ds_read_b32 v152, v195 offset:20224
    ds_read_b32 v153, v195 offset:21248
    ds_read_b32 v154, v195 offset:22272
    ds_read_b32 v155, v195 offset:23296
    ds_read_b32 v156, v195 offset:24320
    ds_read_b32 v157, v195 offset:25344
    s_waitcnt lgkmcnt(8)
    v_mad_i32_i24 v132, v132, 12, v135
    buffer_load_dwordx3 v[140:142], v132, s[8:11], 0 offen sc1
    s_waitcnt lgkmcnt(7)
    v_mad_i32_i24 v133, v133, 12, v136
    buffer_load_dwordx3 v[144:146], v133, s[8:11], 0 offen sc1
    s_waitcnt lgkmcnt(6)
    v_mad_i32_i24 v134, v134, 12, v137
    buffer_load_dwordx3 v[148:150], v134, s[8:11], 0 offen sc1
    s_waitcnt lgkmcnt(0)
    v_lshl_add_u32 v152, v152, 5, v188
    v_lshl_add_u32 v153, v153, 5, v189
    v_lshl_add_u32 v154, v154, 5, v190
    v_lshl_add_u32 v155, v155, 5, v191
    v_lshl_add_u32 v156, v156, 5, v192
    v_lshl_add_u32 v157, v157, 5, v193
    s_barrier
    s_add_u32 m0, s30, 63232
    s_nop 0
    buffer_load_dwordx4 v152, s[12:15], 0 offen sc1 lds
    s_sub_u32 s29, s25, s28
    s_min_u32 s29, s29, 1536
    s_lshl_b32 s3, s29, 4
    s_max_u32 s32, s29, 1280
    s_sub_u32 s32, s32, 1280
    s_lshl_b32 s32, s32, 5
    v_cmp_gt_u32 s[56:57], s3, v188
    v_lshlrev_b32 v159, 1, v188
    v_mov_b32 v143, 0
    v_cmp_gt_u32 s[58:59], s3, v189
    v_lshlrev_b32 v161, 1, v189
    v_mov_b32 v147, 0
    v_cmp_gt_u32 s[60:61], s3, v190
    v_lshlrev_b32 v163, 1, v190
    v_mov_b32 v151, 0
    v_and_b32 v4, 15, v11
    v_lshrrev_b32 v13, 4, v11
    s_mul_i32 s3, s27, 23040
    v_mul_u32_u24 v30, 288, v4
    v_lshl_add_u32 v30, v13, 4, v30
    v_add_u32 v30, s3, v30
    s_mul_i32 s68, s27, 5120
    s_add_u32 s68, s68, s2
    s_lshl_b32 s68, s68, 10
    s_and_b32 s3, s24, 3
    s_lshl_b32 s3, s3, 8
    s_add_u32 s68, s68, s3
    v_lshl_add_u32 v31, v13, 18, s68
    v_lshl_add_u32 v31, v4, 4, v31
    v_lshlrev_b32 v4, 3, v4
    v_bfe_u32 v5, v11, 3, 2
    v_and_b32 v12, 3, v11
    v_lshl_add_u32 v5, v5, 2, v12
    v_lshlrev_b32 v5, 3, v5
    v_lshrrev_b32 v6, 2, v11
    v_lshlrev_b32 v6, 3, v6
    v_mul_u32_u24 v16, 52, v11
    v_lshrrev_b32 v16, 8, v16
    v_mul_u32_u24 v17, 5, v16
    v_sub_u32 v17, v11, v17
    v_mul_u32_u24 v15, 6, v17
    v_bfe_u32 v15, s101, v15, 6
    v_lshlrev_b32 v15, 2, v15
    v_lshlrev_b32 v16, 8, v16
    v_add_lshl_u32 v17, v17, 64, 19
    s_mul_i32 s3, s24, 5
    v_lshlrev_b32 v18, 2, v11
    v_add_u32 v21, s3, v11
    v_lshlrev_b32 v19, 2, v21
    v_cmp_gt_u32 vcc, 40, v11
    v_add_u32 v20, 1, v11
    v_add_u32 v21, 1, v21
    v_cndmask_b32 v20, 0, v20, vcc
    s_cmp_gt_u32 s25, 1536
    s_cselect_b32 s69, 0, 8
    v_mov_b32 v22, 8
    s_cmp_lg_u32 s28, 0
    s_cbranch_scc1 L_nofr
    ds_read_b128 v[36:39], v1 offset:8192
    ds_read_b128 v[40:43], v1 offset:9216
    ds_read_b128 v[44:47], v1 offset:10240
    ds_read_b128 v[48:51], v1 offset:11264
L_nofr:
    s_waitcnt vmcnt(3)
    s_mov_b64 exec, s[56:57]
    v_and_b32 v12, 0xff, v142
    v_and_b32 v143, 0xffff, v142
    ds_add_u32 v12, v22 offset:19200
    ds_add_rtn_u32 v132, v143, v22 offset:16128
    s_waitcnt vmcnt(2)
    s_mov_b64 exec, s[58:59]
    v_and_b32 v13, 0xff, v146
    v_and_b32 v147, 0xffff, v146
    ds_add_u32 v13, v22 offset:19200
    ds_add_rtn_u32 v133, v147, v22 offset:16128
    s_waitcnt vmcnt(1)
    s_mov_b64 exec, s[60:61]
    v_and_b32 v14, 0xff, v150
    v_and_b32 v151, 0xffff, v150
    ds_add_u32 v14, v22 offset:19200
    ds_add_rtn_u32 v134, v151, v22 offset:16128
    s_mov_b64 exec, -1
    s_add_u32 m0, s30, 71424
    s_nop 0
    buffer_load_dwordx4 v153, s[12:15], 0 offen sc1 lds
    v_mfma_f32_4x4x4_16b_bf16 v[164:167], v[228:229], v[140:141], 0 cbsz:4 abid:0
    v_mfma_f32_4x4x4_16b_bf16 v[168:171], v[228:229], v[140:141], 0 cbsz:4 abid:1
    v_mfma_f32_4x4x4_16b_bf16 v[172:175], v[228:229], v[140:141], 0 cbsz:4 abid:2
    v_mfma_f32_4x4x4_16b_bf16 v[176:179], v[228:229], v[140:141], 0 cbsz:4 abid:3
    v_add_u32 v23, 112384, v159
    v_lshlrev_b32_sdwa v142, 10, v142 dst_sel:DWORD dst_unused:UNUSED_PAD src0_sel:DWORD src1_sel:WORD_1
    v_cvt_pk_bf16_f32 v180, v164, v165
    v_cvt_pk_bf16_f32 v181, v166, v167
    v_cvt_pk_bf16_f32 v182, v168, v169
    v_cvt_pk_bf16_f32 v183, v170, v171
    v_cvt_pk_bf16_f32 v184, v172, v173
    v_cvt_pk_bf16_f32 v185, v174, v175
    v_cvt_pk_bf16_f32 v186, v176, v177
    v_cvt_pk_bf16_f32 v187, v178, v179
    s_waitcnt lgkmcnt(0)
    s_barrier
    ds_read_b32 v12, v18 offset:19200
    ds_read_b32 v13, v19 offset:19200
    ds_write_b128 v23, v[180:183]
    ds_write_b128 v23, v[184:187] offset:16
    v_lshlrev_b32_sdwa v150, 10, v150 dst_sel:DWORD dst_unused:UNUSED_PAD src0_sel:DWORD src1_sel:WORD_1
    s_waitcnt lgkmcnt(2)
    v_mad_u32_u24 v21, v13, s69, v21
    v_mad_u32_u24 v20, v12, s69, v20
    v_readlane_b32 s96, v21, 0
    v_readlane_b32 s97, v21, 1
    v_readlane_b32 s98, v21, 2
    v_readlane_b32 s99, v21, 3
    v_readlane_b32 s100, v21, 4
    v_lshl_add_u32 v19, v13, 16, v19
    v_cmp_lt_u32 s[36:37], s96, v20
    v_cmp_lt_u32 s[38:39], s97, v20
    v_cmp_lt_u32 s[40:41], s98, v20
    v_cmp_lt_u32 s[42:43], s99, v20
    v_cmp_lt_u32 s[44:45], s100, v20
    s_bcnt1_i32_b64 s96, s[36:37]
    v_writelane_b32 v12, s96, 0
    s_bcnt1_i32_b64 s97, s[38:39]
    v_writelane_b32 v12, s97, 1
    s_bcnt1_i32_b64 s98, s[40:41]
    v_writelane_b32 v12, s98, 2
    s_bcnt1_i32_b64 s99, s[42:43]
    v_writelane_b32 v12, s99, 3
    s_bcnt1_i32_b64 s100, s[44:45]
    v_writelane_b32 v12, s100, 4
    s_mov_b64 exec, 31
    v_lshlrev_b32 v12, 2, v12
    ds_write_b32 v12, v19 offset:19712
    s_mov_b64 exec, -1
    s_add_u32 m0, s30, 79616
    s_nop 0
    buffer_load_dwordx4 v154, s[12:15], 0 offen sc1 lds
    s_add_u32 m0, s30, 87808
    s_nop 0
    buffer_load_dwordx4 v155, s[12:15], 0 offen sc1 lds
    s_waitcnt lgkmcnt(0)
    s_barrier
    ds_read_b32 v12, v15 offset:19712
    v_mfma_f32_4x4x4_16b_bf16 v[164:167], v[228:229], v[144:145], 0 cbsz:4 abid:0
    v_mfma_f32_4x4x4_16b_bf16 v[168:171], v[228:229], v[144:145], 0 cbsz:4 abid:1
    v_mfma_f32_4x4x4_16b_bf16 v[172:175], v[228:229], v[144:145], 0 cbsz:4 abid:2
    v_mfma_f32_4x4x4_16b_bf16 v[176:179], v[228:229], v[144:145], 0 cbsz:4 abid:3
    v_add_u32 v23, 112384, v161
    v_lshlrev_b32_sdwa v146, 10, v146 dst_sel:DWORD dst_unused:UNUSED_PAD src0_sel:DWORD src1_sel:WORD_1
    v_cvt_pk_bf16_f32 v180, v164, v165
    v_cvt_pk_bf16_f32 v181, v166, v167
    v_cvt_pk_bf16_f32 v182, v168, v169
    v_cvt_pk_bf16_f32 v183, v170, v171
    v_cvt_pk_bf16_f32 v184, v172, v173
    v_cvt_pk_bf16_f32 v185, v174, v175
    v_cvt_pk_bf16_f32 v186, v176, v177
    v_cvt_pk_bf16_f32 v187, v178, v179
    s_waitcnt lgkmcnt(0)
    v_add_u32_sdwa v16, v12, v16 dst_sel:DWORD dst_unused:UNUSED_PAD src0_sel:WORD_0 src1_sel:DWORD
    ds_read_b32 v13, v16 offset:16128
    v_readlane_b32 s96, v12, 0
    v_readlane_b32 s97, v12, 1
    v_readlane_b32 s98, v12, 2
    v_readlane_b32 s99, v12, 3
    v_readlane_b32 s100, v12, 4
    s_add_u32 s3, s96, s97
    s_add_u32 s3, s3, s98
    s_add_u32 s3, s3, s99
    s_add_u32 s3, s3, s100
    s_lshr_b32 s29, s3, 16
    s_add_u32 s3, s29, 480
    v_mov_b32 v14, s3
    v_mov_b32 v18, 0
    s_mov_b64 exec, 1
    ds_add_rtn_u32 v14, v18, v14 offset:19968
    s_mov_b64 exec, -1
    s_waitcnt lgkmcnt(1)
    v_sub_u32 v17, v17, v13
    s_nop 0
    v_add_u32_dpp v13, v13, v13 row_shr:1 row_mask:0xf bank_mask:0xf
    s_bfe_u32 s3, s29, 65539
    s_add_u32 s3, s3, 7
    v_add_u32_dpp v13, v13, v13 row_shr:2 row_mask:0xf bank_mask:0xf
    v_mov_b32 v20, 2147482664
    v_mov_b32 v21, 0
    v_add_u32_dpp v13, v13, v13 row_shr:4 row_mask:0xf bank_mask:0xf
    v_writelane_b32 v20, 40, s3
    s_nop 0
    v_add_u32_dpp v13, v13, v13 row_shr:8 row_mask:0xf bank_mask:0xf
    s_waitcnt lgkmcnt(0)
    v_readfirstlane_b32 s71, v14
    v_add_u32_dpp v13, v13, v13 row_bcast:15 row_mask:0xa bank_mask:0xf
    s_add_u32 s3, s71, s29
    v_lshl_add_u32 v18, v11, 3, s3
    v_add_u32_dpp v13, v13, v13 row_bcast:31 row_mask:0xc bank_mask:0xf
    s_mov_b32 exec_hi, 0x0fffffff
    v_add3_u32 v13, v13, v17, s71
    ds_write_b32 v16, v13 offset:16128
    ds_write_b64 v18, v[20:21] offset:0
    s_mov_b64 exec, -1
    ds_write_b128 v23, v[180:183]
    ds_write_b128 v23, v[184:187] offset:16
    s_add_u32 m0, s30, 96000
    s_nop 0
    buffer_load_dwordx4 v156, s[12:15], 0 offen sc1 lds
    s_waitcnt lgkmcnt(2)
    s_barrier
    ds_read_b32 v12, v143 offset:16128
    ds_read_b32 v13, v147 offset:16128
    ds_read_b32 v14, v151 offset:16128
    v_add_u32 v4, s71, v4
    v_add_u32 v5, s71, v5
    v_add_u32 v6, s71, v6
    s_mov_b64 exec, s[56:57]
    s_waitcnt lgkmcnt(2)
    v_add_u32_sdwa v132, v12, v132 dst_sel:DWORD dst_unused:UNUSED_PAD src0_sel:WORD_0 src1_sel:DWORD
    v_or_b32_sdwa v158, v12, v142 dst_sel:DWORD dst_unused:UNUSED_PAD src0_sel:WORD_1 src1_sel:DWORD
    ds_write_b64 v132, v[158:159] offset:0
    s_mov_b64 exec, s[58:59]
    s_waitcnt lgkmcnt(2)
    v_add_u32_sdwa v133, v13, v133 dst_sel:DWORD dst_unused:UNUSED_PAD src0_sel:WORD_0 src1_sel:DWORD
    v_or_b32_sdwa v160, v13, v146 dst_sel:DWORD dst_unused:UNUSED_PAD src0_sel:WORD_1 src1_sel:DWORD
    ds_write_b64 v133, v[160:161] offset:0
    s_mov_b64 exec, s[60:61]
    s_waitcnt lgkmcnt(2)
    v_add_u32_sdwa v134, v14, v134 dst_sel:DWORD dst_unused:UNUSED_PAD src0_sel:WORD_0 src1_sel:DWORD
    v_or_b32_sdwa v162, v14, v150 dst_sel:DWORD dst_unused:UNUSED_PAD src0_sel:WORD_1 src1_sel:DWORD
    ds_write_b64 v134, v[162:163] offset:0
    s_mov_b64 exec, -1
    s_cmp_lt_u32 s30, s32
    s_cbranch_scc0 L_noef5
    s_add_u32 m0, s30, 104192
    s_nop 0
    buffer_load_dwordx4 v157, s[12:15], 0 offen sc1 lds
L_noef5:
    s_waitcnt lgkmcnt(0)
    s_barrier
    ds_read_b32 v12, v4
    ds_read_b32 v7, v4 offset:56
    ds_read_b32 v9, v5 offset:4
    ds_read_b32 v10, v6 offset:4
    s_cmp_eq_u64 s[60:61], 0
    s_cbranch_scc1 L_not3
    v_mfma_f32_4x4x4_16b_bf16 v[164:167], v[228:229], v[148:149], 0 cbsz:4 abid:0
    v_mfma_f32_4x4x4_16b_bf16 v[168:171], v[228:229], v[148:149], 0 cbsz:4 abid:1
    v_mfma_f32_4x4x4_16b_bf16 v[172:175], v[228:229], v[148:149], 0 cbsz:4 abid:2
    v_mfma_f32_4x4x4_16b_bf16 v[176:179], v[228:229], v[148:149], 0 cbsz:4 abid:3
    v_add_u32 v23, 112384, v163
    s_nop 0
    v_cvt_pk_bf16_f32 v180, v164, v165
    v_cvt_pk_bf16_f32 v181, v166, v167
    v_cvt_pk_bf16_f32 v182, v168, v169
    v_cvt_pk_bf16_f32 v183, v170, v171
    v_cvt_pk_bf16_f32 v184, v172, v173
    v_cvt_pk_bf16_f32 v185, v174, v175
    v_cvt_pk_bf16_f32 v186, v176, v177
    v_cvt_pk_bf16_f32 v187, v178, v179
    ds_write_b128 v23, v[180:183]
    ds_write_b128 v23, v[184:187] offset:16
    s_waitcnt lgkmcnt(2)
    s_branch L_t3
L_not3:
    s_waitcnt lgkmcnt(0)
L_t3:
    v_readlane_b32 s36, v12, 0
    v_readlane_b32 s37, v12, 1
    v_readlane_b32 s38, v12, 2
    v_readlane_b32 s39, v12, 3
    s_and_b32 s70, s36, 4294966784
    buffer_load_dwordx4 v[196:199], v1, s[4:7], s70 offen
    s_and_b32 s71, s37, 4294966784
    buffer_load_dwordx4 v[200:203], v1, s[4:7], s71 offen
    s_and_b32 s70, s38, 4294966784
    buffer_load_dwordx4 v[204:207], v1, s[4:7], s70 offen
    s_and_b32 s71, s39, 4294966784
    buffer_load_dwordx4 v[208:211], v1, s[4:7], s71 offen
    v_readlane_b32 s40, v12, 4
    v_readlane_b32 s41, v12, 5
    v_readlane_b32 s42, v12, 6
    v_readlane_b32 s43, v12, 7
    v_add_u32 v9, v9, v2
    v_add_u32 v10, v10, v3
    s_and_b32 s68, s43, 4294966784
    ds_read_b128 v[132:135], v29
    ds_read_b128 v[136:139], v29
    ds_read_b128 v[140:143], v29
    ds_read_b128 v[144:147], v29
    ds_read_b128 v[148:151], v29
    ds_read_b128 v[152:155], v29
    ds_read_b128 v[156:159], v29
    ds_read_b128 v[160:163], v29
    s_waitcnt vmcnt(4) lgkmcnt(0)
    s_barrier
    s_cmp_eq_u32 s29, 0
    s_cbranch_scc1 L_exit
    ds_read_b128 v[24:27], v9 offset:63232
    ds_read_b64 v[32:33], v10
    s_and_b32 s70, s40, 4294966784
    buffer_load_dwordx4 v[212:215], v1, s[4:7], s70 offen
    s_and_b32 s71, s41, 4294966784
    buffer_load_dwordx4 v[216:219], v1, s[4:7], s71 offen
    s_waitcnt lgkmcnt(1)
    v_smfmac_f32_32x32x32_bf16 v[132:147], v[24:27], v[36:43], v28
    v_smfmac_f32_32x32x32_bf16 v[148:163], v[24:27], v[44:51], v28
    s_and_b32 s70, s42, 4294966784
    buffer_load_dwordx4 v[220:223], v1, s[4:7], s70 offen
    s_waitcnt lgkmcnt(0)
    s_nop 7
    v_exp_f32 v12, v132
    v_exp_f32 v13, v133
    v_exp_f32 v14, v148
    v_exp_f32 v15, v149
    v_pk_add_f32 v[12:13], v[12:13], 1.0 op_sel_hi:[1,0]
    v_pk_add_f32 v[14:15], v[14:15], 1.0 op_sel_hi:[1,0]
    v_rcp_f32 v12, v12
    v_rcp_f32 v13, v13
    s_nop 0
    v_pk_mul_f32 v[132:133], v[132:133], v[12:13]
L_loop:
    s_setprio 3
    ds_read_b32 v9, v5 offset:132
    ds_read_b32 v10, v6 offset:132
    ds_read_b32 v8, v4 offset:184
    ds_read_b128 v[164:167], v29
    s_waitcnt vmcnt(6)
    v_rcp_f32 v14, v14
    v_mfma_f32_4x4x4_16b_bf16 v[16:19], v[32:33], v[196:197], 0 cbsz:4 abid:0
    v_exp_f32 v13, v135
    v_mfma_f32_4x4x4_16b_bf16 v[20:23], v[32:33], v[198:199], 0 cbsz:4 abid:0
    v_exp_f32 v12, v134
    v_readlane_b32 s44, v7, 1
    v_rcp_f32 v15, v15
    v_pk_add_f32 v[12:13], v[12:13], 1.0 op_sel_hi:[1,0]
    v_pk_mul_f32 v[148:149], v[148:149], v[14:15]
    s_and_b32 s69, s44, 4294966784
    s_set_gpr_idx_on s36, gpr_idx(SRC2,DST)
    buffer_load_dwordx4 v[224:227], v1, s[4:7], s68 offen
    v_pk_fma_f32 v[84:85], v[132:133], v[16:17], v[84:85] op_sel_hi:[0,1,1]
    v_pk_fma_f32 v[86:87], v[132:133], v[18:19], v[86:87] op_sel_hi:[0,1,1]
    v_pk_fma_f32 v[88:89], v[148:149], v[20:21], v[88:89] op_sel_hi:[0,1,1]
    v_pk_fma_f32 v[90:91], v[148:149], v[22:23], v[90:91] op_sel_hi:[0,1,1]
    s_set_gpr_idx_off
    ds_read_b128 v[168:171], v29
    s_waitcnt vmcnt(6) lgkmcnt(2)
    v_rcp_f32 v12, v12
    v_mfma_f32_4x4x4_16b_bf16 v[16:19], v[32:33], v[200:201], 0 cbsz:4 abid:1
    v_exp_f32 v15, v151
    v_mfma_f32_4x4x4_16b_bf16 v[20:23], v[32:33], v[202:203], 0 cbsz:4 abid:1
    v_exp_f32 v14, v150
    v_readlane_b32 s45, v7, 2
    v_rcp_f32 v13, v13
    v_pk_add_f32 v[14:15], v[14:15], 1.0 op_sel_hi:[1,0]
    v_pk_mul_f32 v[134:135], v[134:135], v[12:13]
    s_and_b32 s68, s45, 4294966784
    s_set_gpr_idx_on s37, gpr_idx(SRC2,DST)
    buffer_load_dwordx4 v[196:199], v1, s[4:7], s69 offen
    v_pk_fma_f32 v[84:85], v[132:133], v[16:17], v[84:85] op_sel:[1,0,0]
    v_pk_fma_f32 v[86:87], v[132:133], v[18:19], v[86:87] op_sel:[1,0,0]
    v_pk_fma_f32 v[88:89], v[148:149], v[20:21], v[88:89] op_sel:[1,0,0]
    v_pk_fma_f32 v[90:91], v[148:149], v[22:23], v[90:91] op_sel:[1,0,0]
    s_set_gpr_idx_off
    s_cbranch_scc0 L_exit
    v_add_u32 v9, v9, v2
    v_add_u32 v10, v10, v3
    ds_read_b128 v[24:27], v9 offset:63232
    ds_read_b64 v[34:35], v10
    ds_read_b128 v[172:175], v29
    s_waitcnt vmcnt(6)
    v_rcp_f32 v14, v14
    v_mfma_f32_4x4x4_16b_bf16 v[16:19], v[32:33], v[204:205], 0 cbsz:4 abid:2
    v_exp_f32 v13, v137
    v_mfma_f32_4x4x4_16b_bf16 v[20:23], v[32:33], v[206:207], 0 cbsz:4 abid:2
    v_exp_f32 v12, v136
    v_readlane_b32 s46, v7, 3
    v_rcp_f32 v15, v15
    v_pk_add_f32 v[12:13], v[12:13], 1.0 op_sel_hi:[1,0]
    v_pk_mul_f32 v[150:151], v[150:151], v[14:15]
    s_and_b32 s69, s46, 4294966784
    s_set_gpr_idx_on s38, gpr_idx(SRC2,DST)
    buffer_load_dwordx4 v[200:203], v1, s[4:7], s68 offen
    v_pk_fma_f32 v[84:85], v[134:135], v[16:17], v[84:85] op_sel_hi:[0,1,1]
    v_pk_fma_f32 v[86:87], v[134:135], v[18:19], v[86:87] op_sel_hi:[0,1,1]
    v_pk_fma_f32 v[88:89], v[150:151], v[20:21], v[88:89] op_sel_hi:[0,1,1]
    v_pk_fma_f32 v[90:91], v[150:151], v[22:23], v[90:91] op_sel_hi:[0,1,1]
    s_set_gpr_idx_off
    ds_read_b128 v[176:179], v29
    s_waitcnt vmcnt(6)
    v_rcp_f32 v12, v12
    v_mfma_f32_4x4x4_16b_bf16 v[16:19], v[32:33], v[208:209], 0 cbsz:4 abid:3
    v_exp_f32 v15, v153
    v_mfma_f32_4x4x4_16b_bf16 v[20:23], v[32:33], v[210:211], 0 cbsz:4 abid:3
    v_exp_f32 v14, v152
    v_readlane_b32 s47, v7, 4
    v_rcp_f32 v13, v13
    v_pk_add_f32 v[14:15], v[14:15], 1.0 op_sel_hi:[1,0]
    v_pk_mul_f32 v[136:137], v[136:137], v[12:13]
    s_and_b32 s68, s47, 4294966784
    s_set_gpr_idx_on s39, gpr_idx(SRC2,DST)
    buffer_load_dwordx4 v[204:207], v1, s[4:7], s69 offen
    v_pk_fma_f32 v[84:85], v[134:135], v[16:17], v[84:85] op_sel:[1,0,0]
    v_pk_fma_f32 v[86:87], v[134:135], v[18:19], v[86:87] op_sel:[1,0,0]
    v_pk_fma_f32 v[88:89], v[150:151], v[20:21], v[88:89] op_sel:[1,0,0]
    v_pk_fma_f32 v[90:91], v[150:151], v[22:23], v[90:91] op_sel:[1,0,0]
    s_set_gpr_idx_off
    s_cbranch_scc0 L_exit
    s_setprio 2
    ds_read_b128 v[180:183], v29
    s_waitcnt vmcnt(6)
    v_rcp_f32 v14, v14
    v_mfma_f32_4x4x4_16b_bf16 v[16:19], v[32:33], v[212:213], 0 cbsz:4 abid:4
    v_exp_f32 v13, v139
    v_mfma_f32_4x4x4_16b_bf16 v[20:23], v[32:33], v[214:215], 0 cbsz:4 abid:4
    v_exp_f32 v12, v138
    v_readlane_b32 s48, v7, 5
    v_rcp_f32 v15, v15
    v_pk_add_f32 v[12:13], v[12:13], 1.0 op_sel_hi:[1,0]
    v_pk_mul_f32 v[152:153], v[152:153], v[14:15]
    s_and_b32 s69, s48, 4294966784
    s_set_gpr_idx_on s40, gpr_idx(SRC2,DST)
    buffer_load_dwordx4 v[208:211], v1, s[4:7], s68 offen
    v_pk_fma_f32 v[84:85], v[136:137], v[16:17], v[84:85] op_sel_hi:[0,1,1]
    v_pk_fma_f32 v[86:87], v[136:137], v[18:19], v[86:87] op_sel_hi:[0,1,1]
    v_pk_fma_f32 v[88:89], v[152:153], v[20:21], v[88:89] op_sel_hi:[0,1,1]
    v_pk_fma_f32 v[90:91], v[152:153], v[22:23], v[90:91] op_sel_hi:[0,1,1]
    s_set_gpr_idx_off
    ds_read_b128 v[184:187], v29
    s_waitcnt vmcnt(6)
    v_rcp_f32 v12, v12
    v_mfma_f32_4x4x4_16b_bf16 v[16:19], v[32:33], v[216:217], 0 cbsz:4 abid:5
    v_exp_f32 v15, v155
    v_mfma_f32_4x4x4_16b_bf16 v[20:23], v[32:33], v[218:219], 0 cbsz:4 abid:5
    v_exp_f32 v14, v154
    v_readlane_b32 s49, v7, 6
    v_rcp_f32 v13, v13
    v_pk_add_f32 v[14:15], v[14:15], 1.0 op_sel_hi:[1,0]
    v_pk_mul_f32 v[138:139], v[138:139], v[12:13]
    s_and_b32 s68, s49, 4294966784
    s_set_gpr_idx_on s41, gpr_idx(SRC2,DST)
    buffer_load_dwordx4 v[212:215], v1, s[4:7], s69 offen
    v_pk_fma_f32 v[84:85], v[136:137], v[16:17], v[84:85] op_sel:[1,0,0]
    v_pk_fma_f32 v[86:87], v[136:137], v[18:19], v[86:87] op_sel:[1,0,0]
    v_pk_fma_f32 v[88:89], v[152:153], v[20:21], v[88:89] op_sel:[1,0,0]
    v_pk_fma_f32 v[90:91], v[152:153], v[22:23], v[90:91] op_sel:[1,0,0]
    s_set_gpr_idx_off
    s_cbranch_scc0 L_exit
    ds_read_b128 v[188:191], v29
    s_waitcnt vmcnt(6)
    v_rcp_f32 v14, v14
    v_mfma_f32_4x4x4_16b_bf16 v[16:19], v[32:33], v[220:221], 0 cbsz:4 abid:6
    v_exp_f32 v13, v141
    v_mfma_f32_4x4x4_16b_bf16 v[20:23], v[32:33], v[222:223], 0 cbsz:4 abid:6
    v_exp_f32 v12, v140
    v_readlane_b32 s50, v7, 7
    v_rcp_f32 v15, v15
    v_pk_add_f32 v[12:13], v[12:13], 1.0 op_sel_hi:[1,0]
    v_pk_mul_f32 v[154:155], v[154:155], v[14:15]
    s_and_b32 s69, s50, 4294966784
    s_set_gpr_idx_on s42, gpr_idx(SRC2,DST)
    buffer_load_dwordx4 v[216:219], v1, s[4:7], s68 offen
    v_pk_fma_f32 v[84:85], v[138:139], v[16:17], v[84:85] op_sel_hi:[0,1,1]
    v_pk_fma_f32 v[86:87], v[138:139], v[18:19], v[86:87] op_sel_hi:[0,1,1]
    v_pk_fma_f32 v[88:89], v[154:155], v[20:21], v[88:89] op_sel_hi:[0,1,1]
    v_pk_fma_f32 v[90:91], v[154:155], v[22:23], v[90:91] op_sel_hi:[0,1,1]
    s_set_gpr_idx_off
    ds_read_b128 v[192:195], v29
    s_waitcnt vmcnt(6)
    v_rcp_f32 v12, v12
    v_mfma_f32_4x4x4_16b_bf16 v[16:19], v[32:33], v[224:225], 0 cbsz:4 abid:7
    v_exp_f32 v15, v157
    v_mfma_f32_4x4x4_16b_bf16 v[20:23], v[32:33], v[226:227], 0 cbsz:4 abid:7
    v_exp_f32 v14, v156
    v_readlane_b32 s51, v7, 8
    v_rcp_f32 v13, v13
    v_pk_add_f32 v[14:15], v[14:15], 1.0 op_sel_hi:[1,0]
    v_pk_mul_f32 v[140:141], v[140:141], v[12:13]
    s_and_b32 s68, s51, 4294966784
    s_set_gpr_idx_on s43, gpr_idx(SRC2,DST)
    buffer_load_dwordx4 v[220:223], v1, s[4:7], s69 offen
    v_pk_fma_f32 v[84:85], v[138:139], v[16:17], v[84:85] op_sel:[1,0,0]
    v_pk_fma_f32 v[86:87], v[138:139], v[18:19], v[86:87] op_sel:[1,0,0]
    v_pk_fma_f32 v[88:89], v[154:155], v[20:21], v[88:89] op_sel:[1,0,0]
    v_pk_fma_f32 v[90:91], v[154:155], v[22:23], v[90:91] op_sel:[1,0,0]
    s_set_gpr_idx_off
    s_cbranch_scc0 L_exit
    s_setprio 1
    s_waitcnt vmcnt(6)
    v_rcp_f32 v14, v14
    v_mfma_f32_4x4x4_16b_bf16 v[16:19], v[32:33], v[196:197], 0 cbsz:4 abid:8
    v_exp_f32 v13, v143
    v_mfma_f32_4x4x4_16b_bf16 v[20:23], v[32:33], v[198:199], 0 cbsz:4 abid:8
    v_exp_f32 v12, v142
    v_readlane_b32 s52, v7, 9
    v_rcp_f32 v15, v15
    v_pk_add_f32 v[12:13], v[12:13], 1.0 op_sel_hi:[1,0]
    v_pk_mul_f32 v[156:157], v[156:157], v[14:15]
    s_and_b32 s69, s52, 4294966784
    s_set_gpr_idx_on s44, gpr_idx(SRC2,DST)
    buffer_load_dwordx4 v[224:227], v1, s[4:7], s68 offen
    v_pk_fma_f32 v[84:85], v[140:141], v[16:17], v[84:85] op_sel_hi:[0,1,1]
    v_pk_fma_f32 v[86:87], v[140:141], v[18:19], v[86:87] op_sel_hi:[0,1,1]
    v_pk_fma_f32 v[88:89], v[156:157], v[20:21], v[88:89] op_sel_hi:[0,1,1]
    v_pk_fma_f32 v[90:91], v[156:157], v[22:23], v[90:91] op_sel_hi:[0,1,1]
    s_set_gpr_idx_off
    s_waitcnt vmcnt(6) lgkmcnt(0)
    v_mfma_f32_4x4x4_16b_bf16 v[20:23], v[32:33], v[202:203], 0 cbsz:4 abid:9
    v_mfma_f32_4x4x4_16b_bf16 v[16:19], v[32:33], v[200:201], 0 cbsz:4 abid:9
    v_rcp_f32 v13, v13
    v_smfmac_f32_32x32x32_bf16 v[164:179], v[24:27], v[36:43], v28
    v_exp_f32 v14, v158
    v_exp_f32 v15, v159
    v_readlane_b32 s53, v7, 10
    v_rcp_f32 v12, v12
    v_pk_add_f32 v[14:15], v[14:15], 1.0 op_sel_hi:[1,0]
    v_pk_mul_f32 v[142:143], v[142:143], v[12:13]
    s_and_b32 s68, s53, 4294966784
    s_set_gpr_idx_on s45, gpr_idx(SRC2,DST)
    buffer_load_dwordx4 v[196:199], v1, s[4:7], s69 offen
    v_pk_fma_f32 v[84:85], v[140:141], v[16:17], v[84:85] op_sel:[1,0,0]
    v_pk_fma_f32 v[86:87], v[140:141], v[18:19], v[86:87] op_sel:[1,0,0]
    v_pk_fma_f32 v[88:89], v[156:157], v[20:21], v[88:89] op_sel:[1,0,0]
    v_pk_fma_f32 v[90:91], v[156:157], v[22:23], v[90:91] op_sel:[1,0,0]
    s_set_gpr_idx_off
    s_cbranch_scc0 L_exit
    s_waitcnt vmcnt(6)
    v_rcp_f32 v14, v14
    v_mfma_f32_4x4x4_16b_bf16 v[16:19], v[32:33], v[204:205], 0 cbsz:4 abid:10
    v_exp_f32 v13, v145
    v_mfma_f32_4x4x4_16b_bf16 v[20:23], v[32:33], v[206:207], 0 cbsz:4 abid:10
    v_exp_f32 v12, v144
    v_readlane_b32 s54, v7, 11
    v_rcp_f32 v15, v15
    v_pk_add_f32 v[12:13], v[12:13], 1.0 op_sel_hi:[1,0]
    v_pk_mul_f32 v[158:159], v[158:159], v[14:15]
    s_and_b32 s69, s54, 4294966784
    s_set_gpr_idx_on s46, gpr_idx(SRC2,DST)
    buffer_load_dwordx4 v[200:203], v1, s[4:7], s68 offen
    v_pk_fma_f32 v[84:85], v[142:143], v[16:17], v[84:85] op_sel_hi:[0,1,1]
    v_pk_fma_f32 v[86:87], v[142:143], v[18:19], v[86:87] op_sel_hi:[0,1,1]
    v_pk_fma_f32 v[88:89], v[158:159], v[20:21], v[88:89] op_sel_hi:[0,1,1]
    v_pk_fma_f32 v[90:91], v[158:159], v[22:23], v[90:91] op_sel_hi:[0,1,1]
    s_set_gpr_idx_off
    s_waitcnt vmcnt(6)
    v_mfma_f32_4x4x4_16b_bf16 v[20:23], v[32:33], v[210:211], 0 cbsz:4 abid:11
    v_mfma_f32_4x4x4_16b_bf16 v[16:19], v[32:33], v[208:209], 0 cbsz:4 abid:11
    v_rcp_f32 v13, v13
    v_smfmac_f32_32x32x32_bf16 v[180:195], v[24:27], v[44:51], v28
    v_exp_f32 v14, v160
    v_exp_f32 v15, v161
    v_readlane_b32 s55, v7, 12
    v_rcp_f32 v12, v12
    v_pk_add_f32 v[14:15], v[14:15], 1.0 op_sel_hi:[1,0]
    v_pk_mul_f32 v[144:145], v[144:145], v[12:13]
    s_and_b32 s68, s55, 4294966784
    s_set_gpr_idx_on s47, gpr_idx(SRC2,DST)
    buffer_load_dwordx4 v[204:207], v1, s[4:7], s69 offen
    v_pk_fma_f32 v[84:85], v[142:143], v[16:17], v[84:85] op_sel:[1,0,0]
    v_pk_fma_f32 v[86:87], v[142:143], v[18:19], v[86:87] op_sel:[1,0,0]
    v_pk_fma_f32 v[88:89], v[158:159], v[20:21], v[88:89] op_sel:[1,0,0]
    v_pk_fma_f32 v[90:91], v[158:159], v[22:23], v[90:91] op_sel:[1,0,0]
    s_set_gpr_idx_off
    s_cbranch_scc0 L_exit
    s_setprio 0
    s_waitcnt vmcnt(6)
    v_rcp_f32 v14, v14
    v_mfma_f32_4x4x4_16b_bf16 v[16:19], v[32:33], v[212:213], 0 cbsz:4 abid:12
    v_exp_f32 v13, v147
    v_mfma_f32_4x4x4_16b_bf16 v[20:23], v[32:33], v[214:215], 0 cbsz:4 abid:12
    v_exp_f32 v12, v146
    v_readlane_b32 s56, v7, 13
    v_rcp_f32 v15, v15
    v_pk_add_f32 v[12:13], v[12:13], 1.0 op_sel_hi:[1,0]
    v_pk_mul_f32 v[160:161], v[160:161], v[14:15]
    s_and_b32 s69, s56, 4294966784
    s_set_gpr_idx_on s48, gpr_idx(SRC2,DST)
    buffer_load_dwordx4 v[208:211], v1, s[4:7], s68 offen
    v_pk_fma_f32 v[84:85], v[144:145], v[16:17], v[84:85] op_sel_hi:[0,1,1]
    v_pk_fma_f32 v[86:87], v[144:145], v[18:19], v[86:87] op_sel_hi:[0,1,1]
    v_pk_fma_f32 v[88:89], v[160:161], v[20:21], v[88:89] op_sel_hi:[0,1,1]
    v_pk_fma_f32 v[90:91], v[160:161], v[22:23], v[90:91] op_sel_hi:[0,1,1]
    s_set_gpr_idx_off
    s_waitcnt vmcnt(6)
    v_rcp_f32 v12, v12
    v_mfma_f32_4x4x4_16b_bf16 v[16:19], v[32:33], v[216:217], 0 cbsz:4 abid:13
    v_exp_f32 v15, v163
    v_mfma_f32_4x4x4_16b_bf16 v[20:23], v[32:33], v[218:219], 0 cbsz:4 abid:13
    v_exp_f32 v14, v162
    v_readlane_b32 s57, v7, 14
    v_rcp_f32 v13, v13
    v_pk_add_f32 v[14:15], v[14:15], 1.0 op_sel_hi:[1,0]
    v_pk_mul_f32 v[146:147], v[146:147], v[12:13]
    s_and_b32 s68, s57, 4294966784
    s_set_gpr_idx_on s49, gpr_idx(SRC2,DST)
    buffer_load_dwordx4 v[212:215], v1, s[4:7], s69 offen
    v_pk_fma_f32 v[84:85], v[144:145], v[16:17], v[84:85] op_sel:[1,0,0]
    v_pk_fma_f32 v[86:87], v[144:145], v[18:19], v[86:87] op_sel:[1,0,0]
    v_pk_fma_f32 v[88:89], v[160:161], v[20:21], v[88:89] op_sel:[1,0,0]
    v_pk_fma_f32 v[90:91], v[160:161], v[22:23], v[90:91] op_sel:[1,0,0]
    s_set_gpr_idx_off
    s_cbranch_scc0 L_exit
    s_waitcnt vmcnt(6)
    v_rcp_f32 v14, v14
    v_mfma_f32_4x4x4_16b_bf16 v[16:19], v[32:33], v[220:221], 0 cbsz:4 abid:14
    v_exp_f32 v13, v165
    v_mfma_f32_4x4x4_16b_bf16 v[20:23], v[32:33], v[222:223], 0 cbsz:4 abid:14
    v_exp_f32 v12, v164
    v_readlane_b32 s58, v7, 15
    v_rcp_f32 v15, v15
    v_pk_add_f32 v[12:13], v[12:13], 1.0 op_sel_hi:[1,0]
    v_pk_mul_f32 v[162:163], v[162:163], v[14:15]
    s_and_b32 s69, s58, 4294966784
    s_set_gpr_idx_on s50, gpr_idx(SRC2,DST)
    buffer_load_dwordx4 v[216:219], v1, s[4:7], s68 offen
    v_pk_fma_f32 v[84:85], v[146:147], v[16:17], v[84:85] op_sel_hi:[0,1,1]
    v_pk_fma_f32 v[86:87], v[146:147], v[18:19], v[86:87] op_sel_hi:[0,1,1]
    v_pk_fma_f32 v[88:89], v[162:163], v[20:21], v[88:89] op_sel_hi:[0,1,1]
    v_pk_fma_f32 v[90:91], v[162:163], v[22:23], v[90:91] op_sel_hi:[0,1,1]
    s_set_gpr_idx_off
    s_waitcnt vmcnt(6)
    v_rcp_f32 v12, v12
    v_mfma_f32_4x4x4_16b_bf16 v[16:19], v[32:33], v[224:225], 0 cbsz:4 abid:15
    v_exp_f32 v15, v181
    v_mfma_f32_4x4x4_16b_bf16 v[20:23], v[32:33], v[226:227], 0 cbsz:4 abid:15
    v_exp_f32 v14, v180
    v_readlane_b32 s59, v8, 0
    v_rcp_f32 v13, v13
    v_pk_add_f32 v[14:15], v[14:15], 1.0 op_sel_hi:[1,0]
    v_pk_mul_f32 v[164:165], v[164:165], v[12:13]
    s_and_b32 s68, s59, 4294966784
    s_set_gpr_idx_on s51, gpr_idx(SRC2,DST)
    buffer_load_dwordx4 v[220:223], v1, s[4:7], s69 offen
    v_pk_fma_f32 v[84:85], v[146:147], v[16:17], v[84:85] op_sel:[1,0,0]
    v_pk_fma_f32 v[86:87], v[146:147], v[18:19], v[86:87] op_sel:[1,0,0]
    v_pk_fma_f32 v[88:89], v[162:163], v[20:21], v[88:89] op_sel:[1,0,0]
    v_pk_fma_f32 v[90:91], v[162:163], v[22:23], v[90:91] op_sel:[1,0,0]
    s_set_gpr_idx_off
    s_cbranch_scc0 L_exit
    s_setprio 3
    ds_read_b32 v9, v5 offset:260
    ds_read_b32 v10, v6 offset:260
    ds_read_b32 v7, v4 offset:312
    ds_read_b128 v[132:135], v29
    s_waitcnt vmcnt(6)
    v_rcp_f32 v14, v14
    v_mfma_f32_4x4x4_16b_bf16 v[16:19], v[34:35], v[196:197], 0 cbsz:4 abid:0
    v_exp_f32 v13, v167
    v_mfma_f32_4x4x4_16b_bf16 v[20:23], v[34:35], v[198:199], 0 cbsz:4 abid:0
    v_exp_f32 v12, v166
    v_readlane_b32 s60, v8, 1
    v_rcp_f32 v15, v15
    v_pk_add_f32 v[12:13], v[12:13], 1.0 op_sel_hi:[1,0]
    v_pk_mul_f32 v[180:181], v[180:181], v[14:15]
    s_and_b32 s69, s60, 4294966784
    s_set_gpr_idx_on s52, gpr_idx(SRC2,DST)
    buffer_load_dwordx4 v[224:227], v1, s[4:7], s68 offen
    v_pk_fma_f32 v[84:85], v[164:165], v[16:17], v[84:85] op_sel_hi:[0,1,1]
    v_pk_fma_f32 v[86:87], v[164:165], v[18:19], v[86:87] op_sel_hi:[0,1,1]
    v_pk_fma_f32 v[88:89], v[180:181], v[20:21], v[88:89] op_sel_hi:[0,1,1]
    v_pk_fma_f32 v[90:91], v[180:181], v[22:23], v[90:91] op_sel_hi:[0,1,1]
    s_set_gpr_idx_off
    ds_read_b128 v[136:139], v29
    s_waitcnt vmcnt(6) lgkmcnt(2)
    v_rcp_f32 v12, v12
    v_mfma_f32_4x4x4_16b_bf16 v[16:19], v[34:35], v[200:201], 0 cbsz:4 abid:1
    v_exp_f32 v15, v183
    v_mfma_f32_4x4x4_16b_bf16 v[20:23], v[34:35], v[202:203], 0 cbsz:4 abid:1
    v_exp_f32 v14, v182
    v_readlane_b32 s61, v8, 2
    v_rcp_f32 v13, v13
    v_pk_add_f32 v[14:15], v[14:15], 1.0 op_sel_hi:[1,0]
    v_pk_mul_f32 v[166:167], v[166:167], v[12:13]
    s_and_b32 s68, s61, 4294966784
    s_set_gpr_idx_on s53, gpr_idx(SRC2,DST)
    buffer_load_dwordx4 v[196:199], v1, s[4:7], s69 offen
    v_pk_fma_f32 v[84:85], v[164:165], v[16:17], v[84:85] op_sel:[1,0,0]
    v_pk_fma_f32 v[86:87], v[164:165], v[18:19], v[86:87] op_sel:[1,0,0]
    v_pk_fma_f32 v[88:89], v[180:181], v[20:21], v[88:89] op_sel:[1,0,0]
    v_pk_fma_f32 v[90:91], v[180:181], v[22:23], v[90:91] op_sel:[1,0,0]
    s_set_gpr_idx_off
    s_cbranch_scc0 L_exit
    v_add_u32 v9, v9, v2
    v_add_u32 v10, v10, v3
    ds_read_b128 v[24:27], v9 offset:63232
    ds_read_b64 v[32:33], v10
    ds_read_b128 v[140:143], v29
    s_waitcnt vmcnt(6)
    v_rcp_f32 v14, v14
    v_mfma_f32_4x4x4_16b_bf16 v[16:19], v[34:35], v[204:205], 0 cbsz:4 abid:2
    v_exp_f32 v13, v169
    v_mfma_f32_4x4x4_16b_bf16 v[20:23], v[34:35], v[206:207], 0 cbsz:4 abid:2
    v_exp_f32 v12, v168
    v_readlane_b32 s62, v8, 3
    v_rcp_f32 v15, v15
    v_pk_add_f32 v[12:13], v[12:13], 1.0 op_sel_hi:[1,0]
    v_pk_mul_f32 v[182:183], v[182:183], v[14:15]
    s_and_b32 s69, s62, 4294966784
    s_set_gpr_idx_on s54, gpr_idx(SRC2,DST)
    buffer_load_dwordx4 v[200:203], v1, s[4:7], s68 offen
    v_pk_fma_f32 v[84:85], v[166:167], v[16:17], v[84:85] op_sel_hi:[0,1,1]
    v_pk_fma_f32 v[86:87], v[166:167], v[18:19], v[86:87] op_sel_hi:[0,1,1]
    v_pk_fma_f32 v[88:89], v[182:183], v[20:21], v[88:89] op_sel_hi:[0,1,1]
    v_pk_fma_f32 v[90:91], v[182:183], v[22:23], v[90:91] op_sel_hi:[0,1,1]
    s_set_gpr_idx_off
    ds_read_b128 v[144:147], v29
    s_waitcnt vmcnt(6)
    v_rcp_f32 v12, v12
    v_mfma_f32_4x4x4_16b_bf16 v[16:19], v[34:35], v[208:209], 0 cbsz:4 abid:3
    v_exp_f32 v15, v185
    v_mfma_f32_4x4x4_16b_bf16 v[20:23], v[34:35], v[210:211], 0 cbsz:4 abid:3
    v_exp_f32 v14, v184
    v_readlane_b32 s63, v8, 4
    v_rcp_f32 v13, v13
    v_pk_add_f32 v[14:15], v[14:15], 1.0 op_sel_hi:[1,0]
    v_pk_mul_f32 v[168:169], v[168:169], v[12:13]
    s_and_b32 s68, s63, 4294966784
    s_set_gpr_idx_on s55, gpr_idx(SRC2,DST)
    buffer_load_dwordx4 v[204:207], v1, s[4:7], s69 offen
    v_pk_fma_f32 v[84:85], v[166:167], v[16:17], v[84:85] op_sel:[1,0,0]
    v_pk_fma_f32 v[86:87], v[166:167], v[18:19], v[86:87] op_sel:[1,0,0]
    v_pk_fma_f32 v[88:89], v[182:183], v[20:21], v[88:89] op_sel:[1,0,0]
    v_pk_fma_f32 v[90:91], v[182:183], v[22:23], v[90:91] op_sel:[1,0,0]
    s_set_gpr_idx_off
    s_cbranch_scc0 L_exit
    s_setprio 2
    ds_read_b128 v[148:151], v29
    s_waitcnt vmcnt(6)
    v_rcp_f32 v14, v14
    v_mfma_f32_4x4x4_16b_bf16 v[16:19], v[34:35], v[212:213], 0 cbsz:4 abid:4
    v_exp_f32 v13, v171
    v_mfma_f32_4x4x4_16b_bf16 v[20:23], v[34:35], v[214:215], 0 cbsz:4 abid:4
    v_exp_f32 v12, v170
    v_readlane_b32 s64, v8, 5
    v_rcp_f32 v15, v15
    v_pk_add_f32 v[12:13], v[12:13], 1.0 op_sel_hi:[1,0]
    v_pk_mul_f32 v[184:185], v[184:185], v[14:15]
    s_and_b32 s69, s64, 4294966784
    s_set_gpr_idx_on s56, gpr_idx(SRC2,DST)
    buffer_load_dwordx4 v[208:211], v1, s[4:7], s68 offen
    v_pk_fma_f32 v[84:85], v[168:169], v[16:17], v[84:85] op_sel_hi:[0,1,1]
    v_pk_fma_f32 v[86:87], v[168:169], v[18:19], v[86:87] op_sel_hi:[0,1,1]
    v_pk_fma_f32 v[88:89], v[184:185], v[20:21], v[88:89] op_sel_hi:[0,1,1]
    v_pk_fma_f32 v[90:91], v[184:185], v[22:23], v[90:91] op_sel_hi:[0,1,1]
    s_set_gpr_idx_off
    ds_read_b128 v[152:155], v29
    s_waitcnt vmcnt(6)
    v_rcp_f32 v12, v12
    v_mfma_f32_4x4x4_16b_bf16 v[16:19], v[34:35], v[216:217], 0 cbsz:4 abid:5
    v_exp_f32 v15, v187
    v_mfma_f32_4x4x4_16b_bf16 v[20:23], v[34:35], v[218:219], 0 cbsz:4 abid:5
    v_exp_f32 v14, v186
    v_readlane_b32 s65, v8, 6
    v_rcp_f32 v13, v13
    v_pk_add_f32 v[14:15], v[14:15], 1.0 op_sel_hi:[1,0]
    v_pk_mul_f32 v[170:171], v[170:171], v[12:13]
    s_and_b32 s68, s65, 4294966784
    s_set_gpr_idx_on s57, gpr_idx(SRC2,DST)
    buffer_load_dwordx4 v[212:215], v1, s[4:7], s69 offen
    v_pk_fma_f32 v[84:85], v[168:169], v[16:17], v[84:85] op_sel:[1,0,0]
    v_pk_fma_f32 v[86:87], v[168:169], v[18:19], v[86:87] op_sel:[1,0,0]
    v_pk_fma_f32 v[88:89], v[184:185], v[20:21], v[88:89] op_sel:[1,0,0]
    v_pk_fma_f32 v[90:91], v[184:185], v[22:23], v[90:91] op_sel:[1,0,0]
    s_set_gpr_idx_off
    s_cbranch_scc0 L_exit
    ds_read_b128 v[156:159], v29
    s_waitcnt vmcnt(6)
    v_rcp_f32 v14, v14
    v_mfma_f32_4x4x4_16b_bf16 v[16:19], v[34:35], v[220:221], 0 cbsz:4 abid:6
    v_exp_f32 v13, v173
    v_mfma_f32_4x4x4_16b_bf16 v[20:23], v[34:35], v[222:223], 0 cbsz:4 abid:6
    v_exp_f32 v12, v172
    v_readlane_b32 s66, v8, 7
    v_rcp_f32 v15, v15
    v_pk_add_f32 v[12:13], v[12:13], 1.0 op_sel_hi:[1,0]
    v_pk_mul_f32 v[186:187], v[186:187], v[14:15]
    s_and_b32 s69, s66, 4294966784
    s_set_gpr_idx_on s58, gpr_idx(SRC2,DST)
    buffer_load_dwordx4 v[216:219], v1, s[4:7], s68 offen
    v_pk_fma_f32 v[84:85], v[170:171], v[16:17], v[84:85] op_sel_hi:[0,1,1]
    v_pk_fma_f32 v[86:87], v[170:171], v[18:19], v[86:87] op_sel_hi:[0,1,1]
    v_pk_fma_f32 v[88:89], v[186:187], v[20:21], v[88:89] op_sel_hi:[0,1,1]
    v_pk_fma_f32 v[90:91], v[186:187], v[22:23], v[90:91] op_sel_hi:[0,1,1]
    s_set_gpr_idx_off
    ds_read_b128 v[160:163], v29
    s_waitcnt vmcnt(6)
    v_rcp_f32 v12, v12
    v_mfma_f32_4x4x4_16b_bf16 v[16:19], v[34:35], v[224:225], 0 cbsz:4 abid:7
    v_exp_f32 v15, v189
    v_mfma_f32_4x4x4_16b_bf16 v[20:23], v[34:35], v[226:227], 0 cbsz:4 abid:7
    v_exp_f32 v14, v188
    v_readlane_b32 s67, v8, 8
    v_rcp_f32 v13, v13
    v_pk_add_f32 v[14:15], v[14:15], 1.0 op_sel_hi:[1,0]
    v_pk_mul_f32 v[172:173], v[172:173], v[12:13]
    s_and_b32 s68, s67, 4294966784
    s_set_gpr_idx_on s59, gpr_idx(SRC2,DST)
    buffer_load_dwordx4 v[220:223], v1, s[4:7], s69 offen
    v_pk_fma_f32 v[84:85], v[170:171], v[16:17], v[84:85] op_sel:[1,0,0]
    v_pk_fma_f32 v[86:87], v[170:171], v[18:19], v[86:87] op_sel:[1,0,0]
    v_pk_fma_f32 v[88:89], v[186:187], v[20:21], v[88:89] op_sel:[1,0,0]
    v_pk_fma_f32 v[90:91], v[186:187], v[22:23], v[90:91] op_sel:[1,0,0]
    s_set_gpr_idx_off
    s_cbranch_scc0 L_exit
    s_setprio 1
    s_waitcnt vmcnt(6)
    v_rcp_f32 v14, v14
    v_mfma_f32_4x4x4_16b_bf16 v[16:19], v[34:35], v[196:197], 0 cbsz:4 abid:8
    v_exp_f32 v13, v175
    v_mfma_f32_4x4x4_16b_bf16 v[20:23], v[34:35], v[198:199], 0 cbsz:4 abid:8
    v_exp_f32 v12, v174
    v_readlane_b32 s36, v8, 9
    v_rcp_f32 v15, v15
    v_pk_add_f32 v[12:13], v[12:13], 1.0 op_sel_hi:[1,0]
    v_pk_mul_f32 v[188:189], v[188:189], v[14:15]
    s_and_b32 s69, s36, 4294966784
    s_set_gpr_idx_on s60, gpr_idx(SRC2,DST)
    buffer_load_dwordx4 v[224:227], v1, s[4:7], s68 offen
    v_pk_fma_f32 v[84:85], v[172:173], v[16:17], v[84:85] op_sel_hi:[0,1,1]
    v_pk_fma_f32 v[86:87], v[172:173], v[18:19], v[86:87] op_sel_hi:[0,1,1]
    v_pk_fma_f32 v[88:89], v[188:189], v[20:21], v[88:89] op_sel_hi:[0,1,1]
    v_pk_fma_f32 v[90:91], v[188:189], v[22:23], v[90:91] op_sel_hi:[0,1,1]
    s_set_gpr_idx_off
    s_waitcnt vmcnt(6) lgkmcnt(0)
    v_mfma_f32_4x4x4_16b_bf16 v[20:23], v[34:35], v[202:203], 0 cbsz:4 abid:9
    v_mfma_f32_4x4x4_16b_bf16 v[16:19], v[34:35], v[200:201], 0 cbsz:4 abid:9
    v_rcp_f32 v13, v13
    v_smfmac_f32_32x32x32_bf16 v[132:147], v[24:27], v[36:43], v28
    v_exp_f32 v14, v190
    v_exp_f32 v15, v191
    v_readlane_b32 s37, v8, 10
    v_rcp_f32 v12, v12
    v_pk_add_f32 v[14:15], v[14:15], 1.0 op_sel_hi:[1,0]
    v_pk_mul_f32 v[174:175], v[174:175], v[12:13]
    s_and_b32 s68, s37, 4294966784
    s_set_gpr_idx_on s61, gpr_idx(SRC2,DST)
    buffer_load_dwordx4 v[196:199], v1, s[4:7], s69 offen
    v_pk_fma_f32 v[84:85], v[172:173], v[16:17], v[84:85] op_sel:[1,0,0]
    v_pk_fma_f32 v[86:87], v[172:173], v[18:19], v[86:87] op_sel:[1,0,0]
    v_pk_fma_f32 v[88:89], v[188:189], v[20:21], v[88:89] op_sel:[1,0,0]
    v_pk_fma_f32 v[90:91], v[188:189], v[22:23], v[90:91] op_sel:[1,0,0]
    s_set_gpr_idx_off
    s_cbranch_scc0 L_exit
    s_waitcnt vmcnt(6)
    v_rcp_f32 v14, v14
    v_mfma_f32_4x4x4_16b_bf16 v[16:19], v[34:35], v[204:205], 0 cbsz:4 abid:10
    v_exp_f32 v13, v177
    v_mfma_f32_4x4x4_16b_bf16 v[20:23], v[34:35], v[206:207], 0 cbsz:4 abid:10
    v_exp_f32 v12, v176
    v_readlane_b32 s38, v8, 11
    v_rcp_f32 v15, v15
    v_pk_add_f32 v[12:13], v[12:13], 1.0 op_sel_hi:[1,0]
    v_pk_mul_f32 v[190:191], v[190:191], v[14:15]
    s_and_b32 s69, s38, 4294966784
    s_set_gpr_idx_on s62, gpr_idx(SRC2,DST)
    buffer_load_dwordx4 v[200:203], v1, s[4:7], s68 offen
    v_pk_fma_f32 v[84:85], v[174:175], v[16:17], v[84:85] op_sel_hi:[0,1,1]
    v_pk_fma_f32 v[86:87], v[174:175], v[18:19], v[86:87] op_sel_hi:[0,1,1]
    v_pk_fma_f32 v[88:89], v[190:191], v[20:21], v[88:89] op_sel_hi:[0,1,1]
    v_pk_fma_f32 v[90:91], v[190:191], v[22:23], v[90:91] op_sel_hi:[0,1,1]
    s_set_gpr_idx_off
    s_waitcnt vmcnt(6)
    v_mfma_f32_4x4x4_16b_bf16 v[20:23], v[34:35], v[210:211], 0 cbsz:4 abid:11
    v_mfma_f32_4x4x4_16b_bf16 v[16:19], v[34:35], v[208:209], 0 cbsz:4 abid:11
    v_rcp_f32 v13, v13
    v_smfmac_f32_32x32x32_bf16 v[148:163], v[24:27], v[44:51], v28
    v_exp_f32 v14, v192
    v_exp_f32 v15, v193
    v_readlane_b32 s39, v8, 12
    v_rcp_f32 v12, v12
    v_pk_add_f32 v[14:15], v[14:15], 1.0 op_sel_hi:[1,0]
    v_pk_mul_f32 v[176:177], v[176:177], v[12:13]
    s_and_b32 s68, s39, 4294966784
    s_set_gpr_idx_on s63, gpr_idx(SRC2,DST)
    buffer_load_dwordx4 v[204:207], v1, s[4:7], s69 offen
    v_pk_fma_f32 v[84:85], v[174:175], v[16:17], v[84:85] op_sel:[1,0,0]
    v_pk_fma_f32 v[86:87], v[174:175], v[18:19], v[86:87] op_sel:[1,0,0]
    v_pk_fma_f32 v[88:89], v[190:191], v[20:21], v[88:89] op_sel:[1,0,0]
    v_pk_fma_f32 v[90:91], v[190:191], v[22:23], v[90:91] op_sel:[1,0,0]
    s_set_gpr_idx_off
    s_cbranch_scc0 L_exit
    s_setprio 0
    s_waitcnt vmcnt(6)
    v_rcp_f32 v14, v14
    v_mfma_f32_4x4x4_16b_bf16 v[16:19], v[34:35], v[212:213], 0 cbsz:4 abid:12
    v_exp_f32 v13, v179
    v_mfma_f32_4x4x4_16b_bf16 v[20:23], v[34:35], v[214:215], 0 cbsz:4 abid:12
    v_exp_f32 v12, v178
    v_readlane_b32 s40, v8, 13
    v_rcp_f32 v15, v15
    v_pk_add_f32 v[12:13], v[12:13], 1.0 op_sel_hi:[1,0]
    v_pk_mul_f32 v[192:193], v[192:193], v[14:15]
    s_and_b32 s69, s40, 4294966784
    s_set_gpr_idx_on s64, gpr_idx(SRC2,DST)
    buffer_load_dwordx4 v[208:211], v1, s[4:7], s68 offen
    v_pk_fma_f32 v[84:85], v[176:177], v[16:17], v[84:85] op_sel_hi:[0,1,1]
    v_pk_fma_f32 v[86:87], v[176:177], v[18:19], v[86:87] op_sel_hi:[0,1,1]
    v_pk_fma_f32 v[88:89], v[192:193], v[20:21], v[88:89] op_sel_hi:[0,1,1]
    v_pk_fma_f32 v[90:91], v[192:193], v[22:23], v[90:91] op_sel_hi:[0,1,1]
    s_set_gpr_idx_off
    s_waitcnt vmcnt(6)
    v_rcp_f32 v12, v12
    v_mfma_f32_4x4x4_16b_bf16 v[16:19], v[34:35], v[216:217], 0 cbsz:4 abid:13
    v_exp_f32 v15, v195
    v_mfma_f32_4x4x4_16b_bf16 v[20:23], v[34:35], v[218:219], 0 cbsz:4 abid:13
    v_exp_f32 v14, v194
    v_readlane_b32 s41, v8, 14
    v_rcp_f32 v13, v13
    v_pk_add_f32 v[14:15], v[14:15], 1.0 op_sel_hi:[1,0]
    v_pk_mul_f32 v[178:179], v[178:179], v[12:13]
    s_and_b32 s68, s41, 4294966784
    s_set_gpr_idx_on s65, gpr_idx(SRC2,DST)
    buffer_load_dwordx4 v[212:215], v1, s[4:7], s69 offen
    v_pk_fma_f32 v[84:85], v[176:177], v[16:17], v[84:85] op_sel:[1,0,0]
    v_pk_fma_f32 v[86:87], v[176:177], v[18:19], v[86:87] op_sel:[1,0,0]
    v_pk_fma_f32 v[88:89], v[192:193], v[20:21], v[88:89] op_sel:[1,0,0]
    v_pk_fma_f32 v[90:91], v[192:193], v[22:23], v[90:91] op_sel:[1,0,0]
    s_set_gpr_idx_off
    s_cbranch_scc0 L_exit
    s_waitcnt vmcnt(6)
    v_rcp_f32 v14, v14
    v_mfma_f32_4x4x4_16b_bf16 v[16:19], v[34:35], v[220:221], 0 cbsz:4 abid:14
    v_exp_f32 v13, v133
    v_mfma_f32_4x4x4_16b_bf16 v[20:23], v[34:35], v[222:223], 0 cbsz:4 abid:14
    v_exp_f32 v12, v132
    v_readlane_b32 s42, v8, 15
    v_rcp_f32 v15, v15
    v_pk_add_f32 v[12:13], v[12:13], 1.0 op_sel_hi:[1,0]
    v_pk_mul_f32 v[194:195], v[194:195], v[14:15]
    s_and_b32 s69, s42, 4294966784
    s_set_gpr_idx_on s66, gpr_idx(SRC2,DST)
    buffer_load_dwordx4 v[216:219], v1, s[4:7], s68 offen
    v_pk_fma_f32 v[84:85], v[178:179], v[16:17], v[84:85] op_sel_hi:[0,1,1]
    v_pk_fma_f32 v[86:87], v[178:179], v[18:19], v[86:87] op_sel_hi:[0,1,1]
    v_pk_fma_f32 v[88:89], v[194:195], v[20:21], v[88:89] op_sel_hi:[0,1,1]
    v_pk_fma_f32 v[90:91], v[194:195], v[22:23], v[90:91] op_sel_hi:[0,1,1]
    s_set_gpr_idx_off
    s_waitcnt vmcnt(6)
    v_rcp_f32 v12, v12
    v_mfma_f32_4x4x4_16b_bf16 v[16:19], v[34:35], v[224:225], 0 cbsz:4 abid:15
    v_exp_f32 v15, v149
    v_mfma_f32_4x4x4_16b_bf16 v[20:23], v[34:35], v[226:227], 0 cbsz:4 abid:15
    v_exp_f32 v14, v148
    v_readlane_b32 s43, v7, 0
    v_rcp_f32 v13, v13
    v_pk_add_f32 v[14:15], v[14:15], 1.0 op_sel_hi:[1,0]
    v_pk_mul_f32 v[132:133], v[132:133], v[12:13]
    s_and_b32 s68, s43, 4294966784
    s_set_gpr_idx_on s67, gpr_idx(SRC2,DST)
    buffer_load_dwordx4 v[220:223], v1, s[4:7], s69 offen
    v_pk_fma_f32 v[84:85], v[178:179], v[16:17], v[84:85] op_sel:[1,0,0]
    v_pk_fma_f32 v[86:87], v[178:179], v[18:19], v[86:87] op_sel:[1,0,0]
    v_pk_fma_f32 v[88:89], v[194:195], v[20:21], v[88:89] op_sel:[1,0,0]
    v_pk_fma_f32 v[90:91], v[194:195], v[22:23], v[90:91] op_sel:[1,0,0]
    s_set_gpr_idx_off
    s_cbranch_scc0 L_exit
    v_add_u32 v4, 256, v4
    v_add_u32 v5, 256, v5
    v_add_u32 v6, 256, v6
    s_branch L_loop
L_giveup:
    s_mov_b64 exec, -1
    v_mov_b64 v[164:165], 0
    v_mov_b64 v[166:167], 0
    v_add_u32 v168, 161536, v1
    ds_write_b128 v168, v[164:167]
    v_mov_b32 v172, 0x00300000
    v_mov_b32 v173, 0x00300000
    v_mov_b32 v174, 0x00300000
    v_mov_b32 v175, 0x00300000
    ds_write_b128 v1, v[172:175] offset:20224
    ds_write_b128 v1, v[172:175] offset:21248
    ds_write_b128 v1, v[172:175] offset:22272
    ds_write_b128 v1, v[172:175] offset:23296
    ds_write_b128 v1, v[172:175] offset:24320
    ds_write_b128 v1, v[172:175] offset:25344
    s_branch L_fok
L_more:
    s_waitcnt vmcnt(0) lgkmcnt(0)
    s_barrier
    v_lshlrev_b32 v188, 4, v0
    v_add_u32 v189, 8192, v188
    v_add_u32 v190, 16384, v188
    v_add_u32 v191, 24576, v188
    v_add_u32 v192, 32768, v188
    v_add_u32 v193, 40960, v188
    v_lshlrev_b32 v194, 2, v0
    v_lshlrev_b32 v14, 3, v0
    v_mov_b32 v16, 0
    v_mov_b32 v17, 0
    v_mov_b32 v15, 0x00300000
    ds_write_b64 v14, v[16:17] offset:16128
    ds_write_b32 v194, v15 offset:20224
    ds_write_b32 v194, v15 offset:22272
    ds_write_b32 v194, v15 offset:24320
    v_lshrrev_b32 v195, 1, v0
    v_lshlrev_b32 v195, 2, v195
    s_branch L_round
L_exit:
    s_add_u32 s28, s28, 1536
    s_cmp_lt_u32 s28, s25
    s_cbranch_scc1 L_more
    s_mov_b32 s68, 0xbf317218
    s_mov_b32 s69, s68
    s_and_b32 s3, s96, 0xffff
    s_mul_i32 m0, s3, 288
    v_pk_mul_f32 v[84:85], v[84:85], s[68:69]
    v_pk_mul_f32 v[86:87], v[86:87], s[68:69]
    v_pk_mul_f32 v[88:89], v[88:89], s[68:69]
    v_pk_mul_f32 v[90:91], v[90:91], s[68:69]
    v_cvt_pk_bf16_f32 v84, v84, v88
    v_cvt_pk_bf16_f32 v85, v85, v89
    v_cvt_pk_bf16_f32 v86, v86, v90
    v_cvt_pk_bf16_f32 v87, v87, v91
    ds_write_addtid_b32 v84 offset:16128
    ds_write_addtid_b32 v85 offset:16416
    ds_write_addtid_b32 v86 offset:16704
    ds_write_addtid_b32 v87 offset:16992
    s_and_b32 s3, s97, 0xffff
    s_mul_i32 m0, s3, 288
    v_pk_mul_f32 v[92:93], v[92:93], s[68:69]
    v_pk_mul_f32 v[94:95], v[94:95], s[68:69]
    v_pk_mul_f32 v[96:97], v[96:97], s[68:69]
    v_pk_mul_f32 v[98:99], v[98:99], s[68:69]
    v_cvt_pk_bf16_f32 v92, v92, v96
    v_cvt_pk_bf16_f32 v93, v93, v97
    v_cvt_pk_bf16_f32 v94, v94, v98
    v_cvt_pk_bf16_f32 v95, v95, v99
    ds_write_addtid_b32 v92 offset:16128
    ds_write_addtid_b32 v93 offset:16416
    ds_write_addtid_b32 v94 offset:16704
    ds_write_addtid_b32 v95 offset:16992
    s_and_b32 s3, s98, 0xffff
    s_mul_i32 m0, s3, 288
    v_pk_mul_f32 v[100:101], v[100:101], s[68:69]
    v_pk_mul_f32 v[102:103], v[102:103], s[68:69]
    v_pk_mul_f32 v[104:105], v[104:105], s[68:69]
    v_pk_mul_f32 v[106:107], v[106:107], s[68:69]
    v_cvt_pk_bf16_f32 v100, v100, v104
    v_cvt_pk_bf16_f32 v101, v101, v105
    v_cvt_pk_bf16_f32 v102, v102, v106
    v_cvt_pk_bf16_f32 v103, v103, v107
    ds_write_addtid_b32 v100 offset:16128
    ds_write_addtid_b32 v101 offset:16416
    ds_write_addtid_b32 v102 offset:16704
    ds_write_addtid_b32 v103 offset:16992
    s_and_b32 s3, s99, 0xffff
    s_mul_i32 m0, s3, 288
    v_pk_mul_f32 v[108:109], v[108:109], s[68:69]
    v_pk_mul_f32 v[110:111], v[110:111], s[68:69]
    v_pk_mul_f32 v[112:113], v[112:113], s[68:69]
    v_pk_mul_f32 v[114:115], v[114:115], s[68:69]
    v_cvt_pk_bf16_f32 v108, v108, v112
    v_cvt_pk_bf16_f32 v109, v109, v113
    v_cvt_pk_bf16_f32 v110, v110, v114
    v_cvt_pk_bf16_f32 v111, v111, v115
    ds_write_addtid_b32 v108 offset:16128
    ds_write_addtid_b32 v109 offset:16416
    ds_write_addtid_b32 v110 offset:16704
    ds_write_addtid_b32 v111 offset:16992
    s_and_b32 s3, s100, 0xffff
    s_mul_i32 m0, s3, 288
    v_pk_mul_f32 v[116:117], v[116:117], s[68:69]
    v_pk_mul_f32 v[118:119], v[118:119], s[68:69]
    v_pk_mul_f32 v[120:121], v[120:121], s[68:69]
    v_pk_mul_f32 v[122:123], v[122:123], s[68:69]
    v_cvt_pk_bf16_f32 v116, v116, v120
    v_cvt_pk_bf16_f32 v117, v117, v121
    v_cvt_pk_bf16_f32 v118, v118, v122
    v_cvt_pk_bf16_f32 v119, v119, v123
    ds_write_addtid_b32 v116 offset:16128
    ds_write_addtid_b32 v117 offset:16416
    ds_write_addtid_b32 v118 offset:16704
    ds_write_addtid_b32 v119 offset:16992
    s_waitcnt lgkmcnt(0)
    s_barrier
    ds_read_b128 v[84:87], v30 offset:16128
    ds_read_b128 v[88:91], v30 offset:16192
    ds_read_b128 v[92:95], v30 offset:16256
    ds_read_b128 v[96:99], v30 offset:16320
    ds_read_b128 v[100:103], v30 offset:20736
    ds_read_b128 v[104:107], v30 offset:20800
    ds_read_b128 v[108:111], v30 offset:20864
    ds_read_b128 v[112:115], v30 offset:20928
    s_waitcnt lgkmcnt(7)
    v_mfma_f32_16x16x32_bf16 v[116:119], v[84:87], v[52:55], 0
    v_mfma_f32_16x16x32_bf16 v[120:123], v[84:87], v[56:59], 0
    s_waitcnt lgkmcnt(6)
    v_mfma_f32_16x16x32_bf16 v[116:119], v[88:91], v[60:63], v[116:119]
    v_mfma_f32_16x16x32_bf16 v[120:123], v[88:91], v[64:67], v[120:123]
    s_waitcnt lgkmcnt(5)
    v_mfma_f32_16x16x32_bf16 v[116:119], v[92:95], v[68:71], v[116:119]
    v_mfma_f32_16x16x32_bf16 v[120:123], v[92:95], v[72:75], v[120:123]
    s_waitcnt lgkmcnt(4)
    v_mfma_f32_16x16x32_bf16 v[116:119], v[96:99], v[76:79], v[116:119]
    v_mfma_f32_16x16x32_bf16 v[120:123], v[96:99], v[80:83], v[120:123]
    ds_read_b128 v[84:87], v30 offset:25344
    ds_read_b128 v[88:91], v30 offset:25408
    ds_read_b128 v[92:95], v30 offset:25472
    ds_read_b128 v[96:99], v30 offset:25536
    s_waitcnt lgkmcnt(7)
    v_mfma_f32_16x16x32_bf16 v[124:127], v[100:103], v[52:55], 0
    v_mfma_f32_16x16x32_bf16 v[128:131], v[100:103], v[56:59], 0
    s_waitcnt lgkmcnt(6)
    v_mfma_f32_16x16x32_bf16 v[124:127], v[104:107], v[60:63], v[124:127]
    v_cvt_pk_bf16_f32 v44, v116, v117
    v_cvt_pk_bf16_f32 v45, v118, v119
    v_mfma_f32_16x16x32_bf16 v[128:131], v[104:107], v[64:67], v[128:131]
    v_cvt_pk_bf16_f32 v46, v120, v121
    v_cvt_pk_bf16_f32 v47, v122, v123
    s_waitcnt lgkmcnt(5)
    v_mfma_f32_16x16x32_bf16 v[124:127], v[108:111], v[68:71], v[124:127]
    s_mov_b32 s3, 0
    buffer_store_dwordx4 v[44:47], v31, s[16:19], s3 offen sc0 sc1
    v_mfma_f32_16x16x32_bf16 v[128:131], v[108:111], v[72:75], v[128:131]
    s_waitcnt lgkmcnt(4)
    v_mfma_f32_16x16x32_bf16 v[124:127], v[112:115], v[76:79], v[124:127]
    v_mfma_f32_16x16x32_bf16 v[128:131], v[112:115], v[80:83], v[128:131]
    ds_read_b128 v[100:103], v30 offset:29952
    ds_read_b128 v[104:107], v30 offset:30016
    ds_read_b128 v[108:111], v30 offset:30080
    ds_read_b128 v[112:115], v30 offset:30144
    s_waitcnt lgkmcnt(7)
    v_mfma_f32_16x16x32_bf16 v[116:119], v[84:87], v[52:55], 0
    v_mfma_f32_16x16x32_bf16 v[120:123], v[84:87], v[56:59], 0
    s_waitcnt lgkmcnt(6)
    v_mfma_f32_16x16x32_bf16 v[116:119], v[88:91], v[60:63], v[116:119]
    v_cvt_pk_bf16_f32 v48, v124, v125
    v_cvt_pk_bf16_f32 v49, v126, v127
    v_mfma_f32_16x16x32_bf16 v[120:123], v[88:91], v[64:67], v[120:123]
    v_cvt_pk_bf16_f32 v50, v128, v129
    v_cvt_pk_bf16_f32 v51, v130, v131
    s_waitcnt lgkmcnt(5)
    v_mfma_f32_16x16x32_bf16 v[116:119], v[92:95], v[68:71], v[116:119]
    s_mov_b32 s3, 1048576
    buffer_store_dwordx4 v[48:51], v31, s[16:19], s3 offen sc0 sc1
    v_mfma_f32_16x16x32_bf16 v[120:123], v[92:95], v[72:75], v[120:123]
    s_waitcnt lgkmcnt(4)
    v_mfma_f32_16x16x32_bf16 v[116:119], v[96:99], v[76:79], v[116:119]
    v_mfma_f32_16x16x32_bf16 v[120:123], v[96:99], v[80:83], v[120:123]
    ds_read_b128 v[84:87], v30 offset:34560
    ds_read_b128 v[88:91], v30 offset:34624
    ds_read_b128 v[92:95], v30 offset:34688
    ds_read_b128 v[96:99], v30 offset:34752
    s_waitcnt lgkmcnt(7)
    v_mfma_f32_16x16x32_bf16 v[124:127], v[100:103], v[52:55], 0
    v_mfma_f32_16x16x32_bf16 v[128:131], v[100:103], v[56:59], 0
    s_waitcnt lgkmcnt(6)
    v_mfma_f32_16x16x32_bf16 v[124:127], v[104:107], v[60:63], v[124:127]
    v_cvt_pk_bf16_f32 v44, v116, v117
    v_cvt_pk_bf16_f32 v45, v118, v119
    v_mfma_f32_16x16x32_bf16 v[128:131], v[104:107], v[64:67], v[128:131]
    v_cvt_pk_bf16_f32 v46, v120, v121
    v_cvt_pk_bf16_f32 v47, v122, v123
    s_waitcnt lgkmcnt(5)
    v_mfma_f32_16x16x32_bf16 v[124:127], v[108:111], v[68:71], v[124:127]
    s_mov_b32 s3, 2097152
    buffer_store_dwordx4 v[44:47], v31, s[16:19], s3 offen sc0 sc1
    v_mfma_f32_16x16x32_bf16 v[128:131], v[108:111], v[72:75], v[128:131]
    s_waitcnt lgkmcnt(4)
    v_mfma_f32_16x16x32_bf16 v[124:127], v[112:115], v[76:79], v[124:127]
    v_mfma_f32_16x16x32_bf16 v[128:131], v[112:115], v[80:83], v[128:131]
    s_nop 3
    s_waitcnt lgkmcnt(3)
    v_mfma_f32_16x16x32_bf16 v[116:119], v[84:87], v[52:55], 0
    v_mfma_f32_16x16x32_bf16 v[120:123], v[84:87], v[56:59], 0
    s_waitcnt lgkmcnt(2)
    v_mfma_f32_16x16x32_bf16 v[116:119], v[88:91], v[60:63], v[116:119]
    v_cvt_pk_bf16_f32 v48, v124, v125
    v_cvt_pk_bf16_f32 v49, v126, v127
    v_mfma_f32_16x16x32_bf16 v[120:123], v[88:91], v[64:67], v[120:123]
    v_cvt_pk_bf16_f32 v50, v128, v129
    v_cvt_pk_bf16_f32 v51, v130, v131
    s_waitcnt lgkmcnt(1)
    v_mfma_f32_16x16x32_bf16 v[116:119], v[92:95], v[68:71], v[116:119]
    s_mov_b32 s3, 3145728
    buffer_store_dwordx4 v[48:51], v31, s[16:19], s3 offen sc0 sc1
    v_mfma_f32_16x16x32_bf16 v[120:123], v[92:95], v[72:75], v[120:123]
    s_waitcnt lgkmcnt(0)
    v_mfma_f32_16x16x32_bf16 v[116:119], v[96:99], v[76:79], v[116:119]
    v_mfma_f32_16x16x32_bf16 v[120:123], v[96:99], v[80:83], v[120:123]
    s_or_b32 s31, s2, s24
    s_cbranch_scc1 L_noep
    v_lshlrev_b32 v36, 2, v11
    v_mov_b32 v37, s26
    global_store_dword v36, v37, s[22:23] offset:0 sc0 sc1
L_noep:
    s_nop 5
    v_cvt_pk_bf16_f32 v44, v116, v117
    v_cvt_pk_bf16_f32 v45, v118, v119
    v_cvt_pk_bf16_f32 v46, v120, v121
    v_cvt_pk_bf16_f32 v47, v122, v123
    s_mov_b32 s3, 4194304
    buffer_store_dwordx4 v[44:47], v31, s[16:19], s3 offen sc0 sc1
L_end:
    s_endpgm
.section .rodata,"a"
.p2align 6
.amdhsa_kernel standalone__tensor_product_equiv_tfn__graph_kernel
  .amdhsa_next_free_vgpr 230
  .amdhsa_next_free_sgpr 102
  .amdhsa_accum_offset 232
  .amdhsa_group_segment_fixed_size 0
  .amdhsa_kernarg_size 88
  .amdhsa_user_sgpr_count 2
  .amdhsa_user_sgpr_kernarg_segment_ptr 1
  .amdhsa_system_sgpr_workgroup_id_x 1
  .amdhsa_float_denorm_mode_32 3
.end_amdhsa_kernel
```
